```python
import torch

def _softmax(x, axis=-1):
    return torch.softmax(x, dim=axis)

def _gelu(x):
    return torch.nn.functional.gelu(x, approximate='tanh')

def _silu(x):
    return torch.nn.functional.silu(x)

def _sigmoid(x):
    return torch.sigmoid(x)

def _layernorm(x, axis=-1, eps=1e-05):
    m = x.mean(dim=axis, keepdim=True)
    v = x.var(dim=axis, keepdim=True, unbiased=False)
    return (x - m) / torch.sqrt(v + eps)

def _scatter_add(tgt, idx, src, axis=0):
    return tgt.clone().index_add_(axis, idx, src)

def _segment_sum(src, seg, n):
    out = torch.zeros((n,) + src.shape[1:], dtype=src.dtype)
    return out.index_add_(0, seg, src)

def _pad(x, pw):
    flat = tuple((v for pair in reversed(pw) for v in pair))
    return torch.nn.functional.pad(x, flat)
kernel_name = 'recurrent_scan__ssm_conv_h3__mixer_gmlp__prompt'

def setup_inputs():

    _w = lambda a: (lambda t: t.to(torch.bfloat16) if t.is_floating_point() else t)(torch.as_tensor(a))

    def _A_setup():
        B, S, D = (1, 2048, 640)
        ks = 4
        return {'q': _w((lambda *s: torch.randn(*s, dtype=torch.bfloat16) * 0.05)(B, S, D)), 'k': _w((lambda *s: torch.randn(*s, dtype=torch.bfloat16) * 0.2)(B, S, D)), 'v': _w((lambda *s: torch.randn(*s, dtype=torch.bfloat16) * 0.2)(B, S, D)), 'shift_k': _w((lambda *s: torch.randn(*s, dtype=torch.bfloat16) * 0.2)(D, ks) * 0.5), 'ssm_k': _w((lambda *s: torch.randn(*s, dtype=torch.bfloat16) * 0.2)(D, S) * (1.0 / S ** 0.5)), 'ssm_D': _w((lambda *s: torch.randn(*s, dtype=torch.bfloat16) * 0.2)(D))}
    _A_in = _A_setup()

    def _B_setup():
        B, S, D, F = (1, 2048, 640, 1536)
        Fh = F // 2
        return {'x': _w((lambda *s: torch.randn(*s, dtype=torch.bfloat16) * 0.05)(B, S, D)), 'w_in': _w((lambda *s: torch.randn(*s, dtype=torch.bfloat16) * 0.8)(D, 2 * Fh)), 'w_sp': _w(0.01 * (lambda *s: torch.randn(*s, dtype=torch.bfloat16) * 0.8)(S, S)), 'b_sp': _w(1.0 + 0.01 * (lambda *s: torch.randn(*s, dtype=torch.bfloat16) * 0.1)(S)), 'w_out': _w((lambda *s: torch.randn(*s, dtype=torch.bfloat16) * 0.1)(Fh, D))}
    _B_in = _B_setup()
    return {'A_q': _A_in['q'], 'A_k': _A_in['k'], 'A_v': _A_in['v'], 'A_shift_k': _A_in['shift_k'], 'A_ssm_k': _A_in['ssm_k'], 'A_ssm_D': _A_in['ssm_D'], 'B_x': _B_in['x'], 'B_w_in': _B_in['w_in'], 'B_w_sp': _B_in['w_sp'], 'B_b_sp': _B_in['b_sp'], 'B_w_out': _B_in['w_out']}

def reference(A_q, A_k, A_v, A_shift_k, A_ssm_k, A_ssm_D, B_x, B_w_in, B_w_sp, B_b_sp, B_w_out):

    def _A_ref(q, k, v, shift_k, ssm_k, ssm_D):
        B, S, D = q.shape
        ks = shift_k.shape[-1]
        k_pad = _pad(k, ((0, 0), (ks - 1, 0), (0, 0)))
        k_shift = torch.zeros_like(k)
        for t in range(ks):
            k_shift = k_shift + k_pad[:, t:t + S, :] * shift_k[:, ks - 1 - t][None, None, :]
        kv = k_shift * v
        L = 2 * S
        kv_pad = _pad(kv, ((0, 0), (0, S), (0, 0)))
        kf_pad = _pad(ssm_k, ((0, 0), (0, S)))
        kv_f = (lambda x, axes=(-2, -1): torch.fft.rfft2(x.float(), dim=axes))(kv_pad[:, None, :, :], axes=(1, 2))
        kf_f = (lambda x, axes=(-2, -1): torch.fft.rfft2(x.float(), dim=axes))(kf_pad[:, None, :], axes=(1, 2))
        kf_f = (lambda x, *d: x.permute(*d))(kf_f, 1, 2, 0)
        y_f = kv_f * kf_f[None, :, :, :]
        y = (lambda x, s, axes=(-2, -1): torch.fft.irfft2(x, s=s, dim=axes).to(torch.bfloat16))(y_f, (1, L), axes=(1, 2))[:, 0, :S, :]
        y = y + kv * ssm_D[None, None, :]
        return q * y

    def _B_ref(x, w_in, w_sp, b_sp, w_out):
        B, S, D = x.shape
        F = w_in.shape[-1]
        Fh = F // 2
        z = _gelu(torch.einsum('bsd,df->bsf', x, w_in))
        z1 = z[..., :Fh].clone()
        z2 = _layernorm(z[..., Fh:], axis=-1)
        g = torch.einsum('ts,bsf->btf', w_sp, z2) + b_sp[None, :, None]
        return torch.einsum('bsf,fd->bsd', z1 * g, w_out)
    x = A_q
    xn = _layernorm(x, axis=-1)
    s = _A_ref(xn, A_k, A_v, A_shift_k, A_ssm_k, A_ssm_D)
    g = _silu(_B_ref(xn, B_w_in, B_w_sp, B_b_sp, B_w_out))
    return x + s * g
```

```asm
; @launch kernel=k1_kernel grid=(256,1,1) block=(256,1,1) lds=163840
; @launch kernel=k2_kernel grid=(470,1,1) block=(256,1,1) lds=65536
; @launch kernel=k3_kernel grid=(256,1,1) block=(256,1,1) lds=143360
.amdgcn_target "amdgcn-amd-amdhsa--gfx950"
.text
.globl k1_kernel
.p2align 8
.type k1_kernel,@function
k1_kernel:
  s_cmp_ge_u32 s2, 256
  s_cbranch_scc1 K1_END
  s_load_dwordx4 s[60:63], s[0:1], 0
  s_load_dwordx4 s[64:67], s[0:1], 16
  s_load_dwordx2 s[68:69], s[0:1], 56
  s_load_dwordx2 s[70:71], s[0:1], 80
  s_load_dwordx4 s[72:75], s[0:1], 96
  v_and_b32 v1, 63, v0
  v_lshrrev_b32 v20, 6, v0
  v_lshrrev_b32 v2, 4, v1
  v_readfirstlane_b32 s34, v20
  v_and_b32 v3, 15, v1
  s_and_b32 s40, s2, 7
  s_lshr_b32 s41, s2, 3
  s_and_b32 s42, s41, 3
  s_lshl_b32 s32, s40, 2
  s_add_u32 s32, s32, s42
  s_lshr_b32 s33, s41, 2
  s_lshr_b32 s35, s34, 1
  s_and_b32 s36, s34, 1
  s_mov_b32 s47, 0xffff0000
  v_mul_u32_u24 v22, 6554, v1
  v_lshrrev_b32 v22, 16, v22
  v_mul_u32_u24 v21, 10, v22
  v_sub_u32 v21, v1, v21
  v_lshlrev_b32 v21, 4, v21
  v_mul_u32_u24 v23, 1280, v22
  v_add_u32 v21, v21, v23
  v_lshrrev_b32 v23, 3, v1
  v_and_b32 v24, 7, v1
  v_lshrrev_b32 v25, 1, v23
  v_xor_b32 v24, v24, v25
  s_lshl_b32 s40, s32, 6
  s_lshl_b32 s41, s34, 4
  s_add_u32 s40, s40, s41
  v_add_u32 v23, s40, v23
  v_mul_u32_u24 v23, 1280, v23
  v_lshlrev_b32 v25, 4, v24
  v_add_u32 v4, v23, v25
  v_xor_b32 v25, 64, v25
  v_add_u32 v5, v23, v25
  v_add_u32 v5, 10240, v5
  v_add_u32 v23, 0, v1
  v_mul_u32_u24 v24, 5462, v23
  v_lshrrev_b32 v24, 16, v24
  v_mul_u32_u24 v25, 12, v24
  v_sub_u32 v25, v23, v25
  v_lshrrev_b32 v26, 2, v24
  v_and_b32 v26, 2, v26
  v_xor_b32 v25, v25, v26
  v_lshlrev_b32 v25, 4, v25
  s_lshl_b32 s41, s34, 4
  v_add_u32 v24, s41, v24
  v_mul_u32_u24 v24, 3072, v24
  v_add_u32 v6, v24, v25
  v_add_u32 v23, 64, v1
  v_mul_u32_u24 v24, 5462, v23
  v_lshrrev_b32 v24, 16, v24
  v_mul_u32_u24 v25, 12, v24
  v_sub_u32 v25, v23, v25
  v_lshrrev_b32 v26, 2, v24
  v_and_b32 v26, 2, v26
  v_xor_b32 v25, v25, v26
  v_lshlrev_b32 v25, 4, v25
  s_lshl_b32 s41, s34, 4
  v_add_u32 v24, s41, v24
  v_mul_u32_u24 v24, 3072, v24
  v_add_u32 v7, v24, v25
  v_add_u32 v23, 128, v1
  v_mul_u32_u24 v24, 5462, v23
  v_lshrrev_b32 v24, 16, v24
  v_mul_u32_u24 v25, 12, v24
  v_sub_u32 v25, v23, v25
  v_lshrrev_b32 v26, 2, v24
  v_and_b32 v26, 2, v26
  v_xor_b32 v25, v25, v26
  v_lshlrev_b32 v25, 4, v25
  s_lshl_b32 s41, s34, 4
  v_add_u32 v24, s41, v24
  v_mul_u32_u24 v24, 3072, v24
  v_add_u32 v8, v24, v25
  s_waitcnt lgkmcnt(0)
  s_mov_b32 s8, s60
  s_and_b32 s9, s61, 0xffff
  s_mov_b32 s10, 2621440
  s_mov_b32 s11, 0x20000
  s_mov_b32 s20, s62
  s_and_b32 s21, s63, 0xffff
  s_mov_b32 s22, 2621440
  s_mov_b32 s23, 0x20000
  s_mov_b32 s24, s64
  s_and_b32 s25, s65, 0xffff
  s_mov_b32 s26, 2621440
  s_mov_b32 s27, 0x20000
  s_mov_b32 s12, s68
  s_and_b32 s13, s69, 0xffff
  s_mov_b32 s14, 1966080
  s_mov_b32 s15, 0x20000
  s_mov_b32 s16, s74
  s_and_b32 s17, s75, 0xffff
  s_mov_b32 s18, 17825792
  s_mov_b32 s19, 0x20000
  s_mov_b32 s56, s72
  s_and_b32 s57, s73, 0xffff
  s_mov_b32 s58, 256
  s_mov_b32 s59, 0x20000
  s_mov_b64 s[52:53], exec
  s_mov_b32 exec_lo, 0xffffffff
  s_mov_b32 exec_hi, 0xfffffff
  s_lshl_b32 s40, s32, 6
  s_mul_i32 s41, s34, 18
  s_add_u32 s40, s40, s41
  s_mul_i32 s42, s33, 160
  s_mul_i32 s39, s40, 1280
  s_add_u32 s39, s39, s42
  s_mul_i32 s41, s34, 2880
  s_add_u32 s54, s41, 139264
  v_mov_b32 v23, v21
  s_sub_u32 s41, s39, 3840
  s_cmp_eq_u32 s40, 0
  s_cbranch_scc0 K1_NONNEG
  v_subrev_u32 v23, 3840, v21
  v_cmp_gt_u32 vcc, 3, v22
  v_mov_b32 v24, 0x80000000
  s_nop 0
  v_cndmask_b32 v23, v23, v24, vcc
  s_mov_b32 s41, s39
K1_NONNEG:
  s_mov_b32 m0, s54
  s_nop 0
  buffer_load_dwordx4 v23, s[20:23], s41 offen lds
  s_add_u32 s41, s39, 3840
  s_add_u32 m0, s54, 960
  s_nop 0
  buffer_load_dwordx4 v21, s[20:23], s41 offen lds
  s_add_u32 s41, s39, 11520
  s_add_u32 m0, s54, 1920
  s_nop 0
  buffer_load_dwordx4 v21, s[20:23], s41 offen lds
  s_add_u32 s41, s39, 0
  s_add_u32 m0, s54, 11520
  s_nop 0
  buffer_load_dwordx4 v21, s[24:27], s41 offen lds
  s_add_u32 s41, s39, 7680
  s_add_u32 m0, s54, 12480
  s_nop 0
  buffer_load_dwordx4 v21, s[24:27], s41 offen lds
  s_add_u32 s41, s39, 15360
  s_add_u32 m0, s54, 13440
  s_nop 0
  buffer_load_dwordx4 v21, s[24:27], s41 offen lds
  s_mov_b64 exec, s[52:53]
  s_mov_b32 s28, s66
  s_and_b32 s29, s67, 0xffff
  s_mov_b32 s30, 5120
  s_mov_b32 s31, 0x20000
  v_lshlrev_b32 v23, 4, v1
  s_mul_i32 s41, s33, 640
  buffer_load_dwordx4 v[200:203], v23, s[28:31], s41 offen
  s_lshl_b32 s40, s2, 2
  s_add_u32 s40, s40, s34
  s_mul_i32 s41, s40, 2731
  s_lshr_b32 s41, s41, 16
  s_mul_i32 s42, s41, 24
  s_sub_u32 s42, s40, s42
  s_mov_b32 s76, s40
  s_mov_b32 s28, s70
  s_and_b32 s29, s71, 0xffff
  s_mov_b32 s30, 983040
  s_mov_b32 s31, 0x20000
  v_mul_u32_u24 v23, 5120, v2
  v_lshlrev_b32 v24, 1, v3
  v_add_u32 v23, v23, v24
  s_lshl_b32 s41, s41, 5
  s_mul_i32 s42, s42, 40960
  s_add_u32 s41, s41, s42
  s_add_u32 s42, s41, 20480
  buffer_load_ushort v240, v23, s[28:31], s41 offen offset:0
  buffer_load_ushort v241, v23, s[28:31], s41 offen offset:1280
  buffer_load_ushort v242, v23, s[28:31], s41 offen offset:2560
  buffer_load_ushort v243, v23, s[28:31], s41 offen offset:3840
  buffer_load_ushort v244, v23, s[28:31], s42 offen offset:0
  buffer_load_ushort v245, v23, s[28:31], s42 offen offset:1280
  buffer_load_ushort v246, v23, s[28:31], s42 offen offset:2560
  buffer_load_ushort v247, v23, s[28:31], s42 offen offset:3840
  s_mul_i32 s43, s33, 192
  s_mov_b32 s44, s43
  s_add_u32 s43, s43, 1536
  s_lshl_b32 s40, s34, 11
  s_add_u32 m0, s40, 73728
  s_movk_i32 s41, 0
  buffer_load_dwordx4 v4, s[8:11], s41 offen lds
  s_add_u32 m0, s40, 74752
  s_nop 0
  buffer_load_dwordx4 v5, s[8:11], s41 offen lds
  s_add_u32 s39, s43, 0
  s_mov_b32 s45, 0
  s_mul_i32 s40, s34, 3072
  s_add_u32 s40, s40, s45
  s_mov_b32 m0, s40
  s_nop 0
  buffer_load_dwordx4 v6, s[12:15], s39 offen lds
  s_add_u32 m0, s40, 1024
  s_nop 0
  buffer_load_dwordx4 v7, s[12:15], s39 offen lds
  s_add_u32 m0, s40, 2048
  s_nop 0
  buffer_load_dwordx4 v8, s[12:15], s39 offen lds
  s_lshl_b32 s40, s34, 11
  s_add_u32 m0, s40, 81920
  s_movk_i32 s41, 128
  buffer_load_dwordx4 v4, s[8:11], s41 offen lds
  s_add_u32 m0, s40, 82944
  s_nop 0
  buffer_load_dwordx4 v5, s[8:11], s41 offen lds
  s_add_u32 s39, s43, 196608
  s_mov_b32 s45, 12288
  s_mul_i32 s40, s34, 3072
  s_add_u32 s40, s40, s45
  s_mov_b32 m0, s40
  s_nop 0
  buffer_load_dwordx4 v6, s[12:15], s39 offen lds
  s_add_u32 m0, s40, 1024
  s_nop 0
  buffer_load_dwordx4 v7, s[12:15], s39 offen lds
  s_add_u32 m0, s40, 2048
  s_nop 0
  buffer_load_dwordx4 v8, s[12:15], s39 offen lds
  s_lshl_b32 s40, s34, 11
  s_add_u32 m0, s40, 90112
  s_movk_i32 s41, 256
  buffer_load_dwordx4 v4, s[8:11], s41 offen lds
  s_add_u32 m0, s40, 91136
  s_nop 0
  buffer_load_dwordx4 v5, s[8:11], s41 offen lds
  s_add_u32 s39, s43, 393216
  s_mov_b32 s45, 24576
  s_mul_i32 s40, s34, 3072
  s_add_u32 s40, s40, s45
  s_mov_b32 m0, s40
  s_nop 0
  buffer_load_dwordx4 v6, s[12:15], s39 offen lds
  s_add_u32 m0, s40, 1024
  s_nop 0
  buffer_load_dwordx4 v7, s[12:15], s39 offen lds
  s_add_u32 m0, s40, 2048
  s_nop 0
  buffer_load_dwordx4 v8, s[12:15], s39 offen lds
  s_lshl_b32 s40, s34, 11
  s_add_u32 m0, s40, 98304
  s_movk_i32 s41, 384
  buffer_load_dwordx4 v4, s[8:11], s41 offen lds
  s_add_u32 m0, s40, 99328
  s_nop 0
  buffer_load_dwordx4 v5, s[8:11], s41 offen lds
  s_add_u32 s39, s43, 589824
  s_mov_b32 s45, 36864
  s_mul_i32 s40, s34, 3072
  s_add_u32 s40, s40, s45
  s_mov_b32 m0, s40
  s_nop 0
  buffer_load_dwordx4 v6, s[12:15], s39 offen lds
  s_add_u32 m0, s40, 1024
  s_nop 0
  buffer_load_dwordx4 v7, s[12:15], s39 offen lds
  s_add_u32 m0, s40, 2048
  s_nop 0
  buffer_load_dwordx4 v8, s[12:15], s39 offen lds
  s_lshl_b32 s40, s34, 11
  s_add_u32 m0, s40, 106496
  s_movk_i32 s41, 512
  buffer_load_dwordx4 v4, s[8:11], s41 offen lds
  s_add_u32 m0, s40, 107520
  s_nop 0
  buffer_load_dwordx4 v5, s[8:11], s41 offen lds
  s_add_u32 s39, s43, 786432
  s_mov_b32 s45, 49152
  s_mul_i32 s40, s34, 3072
  s_add_u32 s40, s40, s45
  s_mov_b32 m0, s40
  s_nop 0
  buffer_load_dwordx4 v6, s[12:15], s39 offen lds
  s_add_u32 m0, s40, 1024
  s_nop 0
  buffer_load_dwordx4 v7, s[12:15], s39 offen lds
  s_add_u32 m0, s40, 2048
  s_nop 0
  buffer_load_dwordx4 v8, s[12:15], s39 offen lds
  s_lshl_b32 s40, s34, 11
  s_add_u32 m0, s40, 114688
  s_movk_i32 s41, 640
  buffer_load_dwordx4 v4, s[8:11], s41 offen lds
  s_add_u32 m0, s40, 115712
  s_nop 0
  buffer_load_dwordx4 v5, s[8:11], s41 offen lds
  s_add_u32 s39, s43, 983040
  s_mov_b32 s45, 61440
  s_mul_i32 s40, s34, 3072
  s_add_u32 s40, s40, s45
  s_mov_b32 m0, s40
  s_nop 0
  buffer_load_dwordx4 v6, s[12:15], s39 offen lds
  s_add_u32 m0, s40, 1024
  s_nop 0
  buffer_load_dwordx4 v7, s[12:15], s39 offen lds
  s_add_u32 m0, s40, 2048
  s_nop 0
  buffer_load_dwordx4 v8, s[12:15], s39 offen lds
  s_lshl_b32 s40, s34, 11
  s_add_u32 m0, s40, 122880
  s_movk_i32 s41, 768
  buffer_load_dwordx4 v4, s[8:11], s41 offen lds
  s_add_u32 m0, s40, 123904
  s_nop 0
  buffer_load_dwordx4 v5, s[8:11], s41 offen lds
  s_lshl_b32 s40, s34, 11
  s_add_u32 m0, s40, 131072
  s_movk_i32 s41, 896
  buffer_load_dwordx4 v4, s[8:11], s41 offen lds
  s_add_u32 m0, s40, 132096
  s_nop 0
  buffer_load_dwordx4 v5, s[8:11], s41 offen lds
  v_lshrrev_b32 v23, 1, v3
  v_xor_b32 v23, v23, v2
  v_lshlrev_b32 v23, 4, v23
  v_lshlrev_b32 v24, 7, v3
  v_add_u32 v23, v23, v24
  s_lshl_b32 s40, s35, 12
  s_lshl_b32 s41, s36, 11
  s_add_u32 s40, s40, s41
  s_add_u32 s40, s40, 73728
  v_add_u32 v10, s40, v23
  v_xor_b32 v24, 64, v23
  v_add_u32 v11, s40, v24
  s_xor_b32 s41, s41, 2048
  s_lshl_b32 s40, s35, 12
  s_add_u32 s40, s40, s41
  s_add_u32 s40, s40, 73728
  v_add_u32 v12, s40, v23
  v_add_u32 v13, s40, v24
  v_lshrrev_b32 v23, 2, v1
  v_and_b32 v23, 3, v23
  v_lshlrev_b32 v24, 3, v2
  v_add_u32 v23, v23, v24
  v_mul_u32_u24 v23, 192, v23
  v_and_b32 v24, 3, v1
  v_lshlrev_b32 v24, 3, v24
  v_add_u32 v23, v23, v24
  v_and_b32 v25, 1, v2
  s_mul_i32 s40, s36, 3
  s_add_u32 s41, s40, 0
  v_xor_b32 v24, s41, v25
  v_lshlrev_b32 v24, 5, v24
  v_add_u32 v14, v23, v24
  s_add_u32 s41, s40, 1
  v_xor_b32 v24, s41, v25
  v_lshlrev_b32 v24, 5, v24
  v_add_u32 v15, v23, v24
  s_add_u32 s41, s40, 2
  v_xor_b32 v24, s41, v25
  v_lshlrev_b32 v24, 5, v24
  v_add_u32 v16, v23, v24
  v_mov_b32 v108, 0x3f803f80
  v_mov_b32 v109, 0x3f803f80
  v_mov_b32 v110, 0x3f803f80
  v_mov_b32 v111, 0x3f803f80
  s_mov_b32 s48, 0xbdd2d3e8
  s_mov_b32 s49, 0xbdd2d3e8
  s_mov_b32 s50, 1.0
  s_mov_b32 s51, 1.0
  s_waitcnt vmcnt(34)
  s_barrier
  v_lshlrev_b32 v208, 16, v200
  v_lshlrev_b32 v209, 16, v202
  v_and_b32 v210, s47, v200
  v_and_b32 v211, s47, v202
  v_lshlrev_b32 v212, 16, v201
  v_lshlrev_b32 v213, 16, v203
  v_and_b32 v214, s47, v201
  v_and_b32 v215, s47, v203
  s_cmp_ge_u32 s76, 960
  s_cbranch_scc1 K1_NOWOF
  v_lshl_or_b32 v204, v241, 16, v240
  v_lshl_or_b32 v205, v243, 16, v242
  v_lshl_or_b32 v206, v245, 16, v244
  v_lshl_or_b32 v207, v247, 16, v246
  v_lshlrev_b32 v23, 4, v1
  s_lshl_b32 s40, s76, 10
  s_add_u32 s40, s40, 15728640
  buffer_store_dwordx4 v[204:207], v23, s[16:19], s40 offen
K1_NOWOF:
  s_mul_i32 s40, s34, 2560
  s_add_u32 s40, s40, 139264
  v_lshlrev_b32 v23, 2, v1
  v_min_u32 v23, 156, v23
  v_add_u32 v23, s40, v23
  ds_read_b32 v128, v23 offset:0
  ds_read_b32 v129, v23 offset:160
  ds_read_b32 v130, v23 offset:320
  ds_read_b32 v131, v23 offset:480
  ds_read_b32 v132, v23 offset:640
  ds_read_b32 v133, v23 offset:800
  ds_read_b32 v134, v23 offset:960
  ds_read_b32 v135, v23 offset:1120
  ds_read_b32 v136, v23 offset:1280
  ds_read_b32 v137, v23 offset:1440
  ds_read_b32 v138, v23 offset:1600
  ds_read_b32 v139, v23 offset:1760
  s_waitcnt lgkmcnt(8)
  ds_read_b32 v140, v23 offset:1920
  ds_read_b32 v141, v23 offset:2080
  ds_read_b32 v142, v23 offset:2240
  ds_read_b32 v143, v23 offset:2400
  ds_read_b32 v144, v23 offset:2560
  ds_read_b32 v145, v23 offset:2720
  ds_read_b32 v146, v23 offset:2880
  s_waitcnt lgkmcnt(0)
  ds_read_b32 v147, v23 offset:11520
  ds_read_b32 v148, v23 offset:11680
  ds_read_b32 v149, v23 offset:11840
  ds_read_b32 v150, v23 offset:12000
  ds_read_b32 v151, v23 offset:12160
  ds_read_b32 v152, v23 offset:12320
  ds_read_b32 v153, v23 offset:12480
  ds_read_b32 v154, v23 offset:12640
  ds_read_b32 v155, v23 offset:12800
  ds_read_b32 v156, v23 offset:12960
  ds_read_b32 v157, v23 offset:13120
  ds_read_b32 v158, v23 offset:13280
  ds_read_b32 v159, v23 offset:13440
  ds_read_b32 v160, v23 offset:13600
  s_waitcnt lgkmcnt(8)
  ds_read_b32 v161, v23 offset:13760
  ds_read_b32 v162, v23 offset:13920
  v_lshlrev_b32 v164, 16, v128
  v_and_b32 v165, s47, v128
  v_lshlrev_b32 v166, 16, v129
  v_and_b32 v167, s47, v129
  v_lshlrev_b32 v168, 16, v130
  v_and_b32 v169, s47, v130
  v_lshlrev_b32 v170, 16, v131
  v_and_b32 v171, s47, v131
  v_lshlrev_b32 v172, 16, v132
  v_and_b32 v173, s47, v132
  v_lshlrev_b32 v174, 16, v133
  v_and_b32 v175, s47, v133
  v_lshlrev_b32 v176, 16, v134
  v_and_b32 v177, s47, v134
  v_lshlrev_b32 v178, 16, v135
  v_and_b32 v179, s47, v135
  v_lshlrev_b32 v180, 16, v136
  v_and_b32 v181, s47, v136
  v_lshlrev_b32 v182, 16, v137
  v_and_b32 v183, s47, v137
  v_lshlrev_b32 v184, 16, v138
  v_and_b32 v185, s47, v138
  v_lshlrev_b32 v186, 16, v139
  v_and_b32 v187, s47, v139
  v_lshlrev_b32 v188, 16, v140
  v_and_b32 v189, s47, v140
  v_lshlrev_b32 v190, 16, v141
  v_and_b32 v191, s47, v141
  v_lshlrev_b32 v192, 16, v142
  v_and_b32 v193, s47, v142
  v_lshlrev_b32 v194, 16, v143
  v_and_b32 v195, s47, v143
  v_lshlrev_b32 v196, 16, v144
  v_and_b32 v197, s47, v144
  v_lshlrev_b32 v198, 16, v145
  v_and_b32 v199, s47, v145
  v_lshlrev_b32 v200, 16, v146
  v_and_b32 v201, s47, v146
  s_waitcnt lgkmcnt(0)
  v_pk_mul_f32 v[216:217], v[214:215], v[164:165]
  v_pk_fma_f32 v[216:217], v[212:213], v[166:167], v[216:217]
  v_pk_fma_f32 v[216:217], v[210:211], v[168:169], v[216:217]
  v_pk_fma_f32 v[216:217], v[208:209], v[170:171], v[216:217]
  v_lshlrev_b32 v24, 16, v147
  v_and_b32 v25, s47, v147
  v_pk_mul_f32 v[216:217], v[216:217], v[24:25]
  v_pk_mul_f32 v[218:219], v[214:215], v[166:167]
  v_pk_fma_f32 v[218:219], v[212:213], v[168:169], v[218:219]
  v_pk_fma_f32 v[218:219], v[210:211], v[170:171], v[218:219]
  v_pk_fma_f32 v[218:219], v[208:209], v[172:173], v[218:219]
  v_lshlrev_b32 v24, 16, v148
  v_and_b32 v25, s47, v148
  v_pk_mul_f32 v[218:219], v[218:219], v[24:25]
  v_pk_mul_f32 v[220:221], v[214:215], v[168:169]
  v_pk_fma_f32 v[220:221], v[212:213], v[170:171], v[220:221]
  v_pk_fma_f32 v[220:221], v[210:211], v[172:173], v[220:221]
  v_pk_fma_f32 v[220:221], v[208:209], v[174:175], v[220:221]
  v_lshlrev_b32 v24, 16, v149
  v_and_b32 v25, s47, v149
  v_pk_mul_f32 v[220:221], v[220:221], v[24:25]
  v_pk_mul_f32 v[222:223], v[214:215], v[170:171]
  v_pk_fma_f32 v[222:223], v[212:213], v[172:173], v[222:223]
  v_pk_fma_f32 v[222:223], v[210:211], v[174:175], v[222:223]
  v_pk_fma_f32 v[222:223], v[208:209], v[176:177], v[222:223]
  v_lshlrev_b32 v24, 16, v150
  v_and_b32 v25, s47, v150
  v_pk_mul_f32 v[222:223], v[222:223], v[24:25]
  v_pk_mul_f32 v[224:225], v[214:215], v[172:173]
  v_pk_fma_f32 v[224:225], v[212:213], v[174:175], v[224:225]
  v_pk_fma_f32 v[224:225], v[210:211], v[176:177], v[224:225]
  v_pk_fma_f32 v[224:225], v[208:209], v[178:179], v[224:225]
  v_lshlrev_b32 v24, 16, v151
  v_and_b32 v25, s47, v151
  v_pk_mul_f32 v[224:225], v[224:225], v[24:25]
  v_pk_mul_f32 v[226:227], v[214:215], v[174:175]
  v_pk_fma_f32 v[226:227], v[212:213], v[176:177], v[226:227]
  v_pk_fma_f32 v[226:227], v[210:211], v[178:179], v[226:227]
  v_pk_fma_f32 v[226:227], v[208:209], v[180:181], v[226:227]
  v_lshlrev_b32 v24, 16, v152
  v_and_b32 v25, s47, v152
  v_pk_mul_f32 v[226:227], v[226:227], v[24:25]
  v_pk_mul_f32 v[228:229], v[214:215], v[176:177]
  v_pk_fma_f32 v[228:229], v[212:213], v[178:179], v[228:229]
  v_pk_fma_f32 v[228:229], v[210:211], v[180:181], v[228:229]
  v_pk_fma_f32 v[228:229], v[208:209], v[182:183], v[228:229]
  v_lshlrev_b32 v24, 16, v153
  v_and_b32 v25, s47, v153
  v_pk_mul_f32 v[228:229], v[228:229], v[24:25]
  v_pk_mul_f32 v[230:231], v[214:215], v[178:179]
  v_pk_fma_f32 v[230:231], v[212:213], v[180:181], v[230:231]
  v_pk_fma_f32 v[230:231], v[210:211], v[182:183], v[230:231]
  v_pk_fma_f32 v[230:231], v[208:209], v[184:185], v[230:231]
  v_lshlrev_b32 v24, 16, v154
  v_and_b32 v25, s47, v154
  v_pk_mul_f32 v[230:231], v[230:231], v[24:25]
  v_pk_mul_f32 v[232:233], v[214:215], v[180:181]
  v_pk_fma_f32 v[232:233], v[212:213], v[182:183], v[232:233]
  v_pk_fma_f32 v[232:233], v[210:211], v[184:185], v[232:233]
  v_pk_fma_f32 v[232:233], v[208:209], v[186:187], v[232:233]
  v_lshlrev_b32 v24, 16, v155
  v_and_b32 v25, s47, v155
  v_pk_mul_f32 v[232:233], v[232:233], v[24:25]
  v_pk_mul_f32 v[234:235], v[214:215], v[182:183]
  v_pk_fma_f32 v[234:235], v[212:213], v[184:185], v[234:235]
  v_pk_fma_f32 v[234:235], v[210:211], v[186:187], v[234:235]
  v_pk_fma_f32 v[234:235], v[208:209], v[188:189], v[234:235]
  v_lshlrev_b32 v24, 16, v156
  v_and_b32 v25, s47, v156
  v_pk_mul_f32 v[234:235], v[234:235], v[24:25]
  v_pk_mul_f32 v[236:237], v[214:215], v[184:185]
  v_pk_fma_f32 v[236:237], v[212:213], v[186:187], v[236:237]
  v_pk_fma_f32 v[236:237], v[210:211], v[188:189], v[236:237]
  v_pk_fma_f32 v[236:237], v[208:209], v[190:191], v[236:237]
  v_lshlrev_b32 v24, 16, v157
  v_and_b32 v25, s47, v157
  v_pk_mul_f32 v[236:237], v[236:237], v[24:25]
  v_pk_mul_f32 v[238:239], v[214:215], v[186:187]
  v_pk_fma_f32 v[238:239], v[212:213], v[188:189], v[238:239]
  v_pk_fma_f32 v[238:239], v[210:211], v[190:191], v[238:239]
  v_pk_fma_f32 v[238:239], v[208:209], v[192:193], v[238:239]
  v_lshlrev_b32 v24, 16, v158
  v_and_b32 v25, s47, v158
  v_pk_mul_f32 v[238:239], v[238:239], v[24:25]
  v_pk_mul_f32 v[240:241], v[214:215], v[188:189]
  v_pk_fma_f32 v[240:241], v[212:213], v[190:191], v[240:241]
  v_pk_fma_f32 v[240:241], v[210:211], v[192:193], v[240:241]
  v_pk_fma_f32 v[240:241], v[208:209], v[194:195], v[240:241]
  v_lshlrev_b32 v24, 16, v159
  v_and_b32 v25, s47, v159
  v_pk_mul_f32 v[240:241], v[240:241], v[24:25]
  v_pk_mul_f32 v[242:243], v[214:215], v[190:191]
  v_pk_fma_f32 v[242:243], v[212:213], v[192:193], v[242:243]
  v_pk_fma_f32 v[242:243], v[210:211], v[194:195], v[242:243]
  v_pk_fma_f32 v[242:243], v[208:209], v[196:197], v[242:243]
  v_lshlrev_b32 v24, 16, v160
  v_and_b32 v25, s47, v160
  v_pk_mul_f32 v[242:243], v[242:243], v[24:25]
  v_pk_mul_f32 v[244:245], v[214:215], v[192:193]
  v_pk_fma_f32 v[244:245], v[212:213], v[194:195], v[244:245]
  v_pk_fma_f32 v[244:245], v[210:211], v[196:197], v[244:245]
  v_pk_fma_f32 v[244:245], v[208:209], v[198:199], v[244:245]
  v_lshlrev_b32 v24, 16, v161
  v_and_b32 v25, s47, v161
  v_pk_mul_f32 v[244:245], v[244:245], v[24:25]
  v_pk_mul_f32 v[246:247], v[214:215], v[194:195]
  v_pk_fma_f32 v[246:247], v[212:213], v[196:197], v[246:247]
  v_pk_fma_f32 v[246:247], v[210:211], v[198:199], v[246:247]
  v_pk_fma_f32 v[246:247], v[208:209], v[200:201], v[246:247]
  v_lshlrev_b32 v24, 16, v162
  v_and_b32 v25, s47, v162
  v_pk_mul_f32 v[246:247], v[246:247], v[24:25]
  v_cvt_pk_bf16_f32 v128, v230, v228
  v_cvt_pk_bf16_f32 v129, v226, v224
  v_cvt_pk_bf16_f32 v130, v222, v220
  v_cvt_pk_bf16_f32 v131, v218, v216
  v_cvt_pk_bf16_f32 v132, v246, v244
  v_cvt_pk_bf16_f32 v133, v242, v240
  v_cvt_pk_bf16_f32 v134, v238, v236
  v_cvt_pk_bf16_f32 v135, v234, v232
  v_cvt_pk_bf16_f32 v136, v231, v229
  v_cvt_pk_bf16_f32 v137, v227, v225
  v_cvt_pk_bf16_f32 v138, v223, v221
  v_cvt_pk_bf16_f32 v139, v219, v217
  v_cvt_pk_bf16_f32 v140, v247, v245
  v_cvt_pk_bf16_f32 v141, v243, v241
  v_cvt_pk_bf16_f32 v142, v239, v237
  v_cvt_pk_bf16_f32 v143, v235, v233
  v_lshlrev_b32 v23, 13, v1
  s_mul_i32 s40, s33, 327680
  s_lshl_b32 s41, s32, 7
  s_add_u32 s40, s40, s41
  s_lshl_b32 s41, s34, 5
  s_add_u32 s40, s40, s41
  s_add_u32 s40, s40, 6291456
  s_add_u32 s41, s40, 4096
  s_mov_b32 exec_lo, 0xffffffff
  s_mov_b32 exec_hi, 0xff
  buffer_store_dwordx4 v[128:131], v23, s[16:19], s40 offen
  buffer_store_dwordx4 v[132:135], v23, s[16:19], s40 offen offset:16
  buffer_store_dwordx4 v[136:139], v23, s[16:19], s41 offen
  buffer_store_dwordx4 v[140:143], v23, s[16:19], s41 offen offset:16
  s_mov_b64 exec, s[52:53]
  s_barrier
  s_lshl_b32 s40, s34, 11
  s_add_u32 m0, s40, 139264
  s_movk_i32 s41, 1024
  buffer_load_dwordx4 v4, s[8:11], s41 offen lds
  s_add_u32 m0, s40, 140288
  s_nop 0
  buffer_load_dwordx4 v5, s[8:11], s41 offen lds
  s_lshl_b32 s40, s34, 11
  s_add_u32 m0, s40, 147456
  s_movk_i32 s41, 1152
  buffer_load_dwordx4 v4, s[8:11], s41 offen lds
  s_add_u32 m0, s40, 148480
  s_nop 0
  buffer_load_dwordx4 v5, s[8:11], s41 offen lds
  v_mov_b32 v72, 0
  v_mov_b32 v73, 0
  v_mov_b32 v74, 0
  v_mov_b32 v75, 0
  v_mov_b32 v76, 0
  v_mov_b32 v77, 0
  v_mov_b32 v78, 0
  v_mov_b32 v79, 0
  v_mov_b32 v80, 0
  v_mov_b32 v81, 0
  v_mov_b32 v82, 0
  v_mov_b32 v83, 0
  v_mov_b32 v84, 0
  v_mov_b32 v85, 0
  v_mov_b32 v86, 0
  v_mov_b32 v87, 0
  v_mov_b32 v88, 0
  v_mov_b32 v89, 0
  v_mov_b32 v90, 0
  v_mov_b32 v91, 0
  v_mov_b32 v92, 0
  v_mov_b32 v93, 0
  v_mov_b32 v94, 0
  v_mov_b32 v95, 0
  v_mov_b32 v96, 0
  v_mov_b32 v97, 0
  v_mov_b32 v98, 0
  v_mov_b32 v99, 0
  v_mov_b32 v100, 0
  v_mov_b32 v101, 0
  v_mov_b32 v102, 0
  v_mov_b32 v103, 0
  v_mov_b32 v104, 0
  v_mov_b32 v105, 0
  v_mov_b32 v106, 0
  v_mov_b32 v107, 0
  v_mov_b32 v112, 0
  v_mov_b32 v113, 0
  v_mov_b32 v114, 0
  v_mov_b32 v115, 0
  s_waitcnt vmcnt(37)
  s_barrier
  s_mov_b32 s37, 0
  s_mov_b32 s46, 0
  v_add_u32 v17, s46, v14
  v_add_u32 v18, s46, v15
  v_add_u32 v19, s46, v16
  ds_read_b128 v[32:35], v10
  ds_read_b128 v[36:39], v12
  ds_read_b64_tr_b16 v[48:49], v17 offset:0
  ds_read_b64_tr_b16 v[50:51], v17 offset:768
  ds_read_b64_tr_b16 v[52:53], v18 offset:0
  ds_read_b64_tr_b16 v[54:55], v18 offset:768
  ds_read_b64_tr_b16 v[56:57], v19 offset:0
  ds_read_b64_tr_b16 v[58:59], v19 offset:768
K1_LOOP1:
  ds_read_b128 v[40:43], v11
  ds_read_b128 v[44:47], v13
  ds_read_b64_tr_b16 v[60:61], v17 offset:6144
  ds_read_b64_tr_b16 v[62:63], v17 offset:6912
  ds_read_b64_tr_b16 v[64:65], v18 offset:6144
  ds_read_b64_tr_b16 v[66:67], v18 offset:6912
  ds_read_b64_tr_b16 v[68:69], v19 offset:6144
  ds_read_b64_tr_b16 v[70:71], v19 offset:6912
  s_waitcnt lgkmcnt(8)
  v_mfma_f32_16x16x32_bf16 v[72:75], v[32:35], v[48:51], v[72:75]
  v_dot2c_f32_bf16 v112, v32, v108
  v_dot2c_f32_bf16 v114, v32, v32
  v_mfma_f32_16x16x32_bf16 v[76:79], v[32:35], v[52:55], v[76:79]
  v_dot2c_f32_bf16 v112, v33, v108
  v_dot2c_f32_bf16 v114, v33, v33
  v_mfma_f32_16x16x32_bf16 v[80:83], v[32:35], v[56:59], v[80:83]
  v_dot2c_f32_bf16 v112, v34, v108
  v_dot2c_f32_bf16 v114, v34, v34
  v_dot2c_f32_bf16 v113, v35, v108
  v_dot2c_f32_bf16 v115, v35, v35
  v_mfma_f32_16x16x32_bf16 v[84:87], v[36:39], v[48:51], v[84:87]
  v_mfma_f32_16x16x32_bf16 v[88:91], v[36:39], v[52:55], v[88:91]
  v_mfma_f32_16x16x32_bf16 v[92:95], v[36:39], v[56:59], v[92:95]
  s_cmp_eq_u32 s35, 0
  s_cbranch_scc0 K1_SK_1a
  v_mfma_f32_16x16x32_bf16 v[96:99], v[108:111], v[48:51], v[96:99]
  v_mfma_f32_16x16x32_bf16 v[100:103], v[108:111], v[52:55], v[100:103]
  v_mfma_f32_16x16x32_bf16 v[104:107], v[108:111], v[56:59], v[104:107]
K1_SK_1a:
  s_waitcnt lgkmcnt(0)
  s_cmp_lt_u32 s37, 5
  s_cbranch_scc1 K1_W25
  s_waitcnt vmcnt(12)
  s_branch K1_WD
K1_W25:
  s_waitcnt vmcnt(25)
K1_WD:
  s_barrier
  s_add_u32 s38, s37, 6
  s_mul_i32 s39, s38, 196608
  s_add_u32 s39, s39, s43
  s_cmp_lt_u32 s38, 10
  s_cbranch_scc1 K1_OFF1
  s_sub_u32 s39, s38, 10
  s_mul_i32 s39, s39, 196608
  s_add_u32 s39, s39, s44
  s_cmp_lt_u32 s38, 20
  s_cselect_b32 s39, s39, 0x80000000
K1_OFF1:
  s_mul_i32 s40, s34, 3072
  s_add_u32 s40, s40, s46
  s_mov_b32 m0, s40
  s_nop 0
  buffer_load_dwordx4 v6, s[12:15], s39 offen lds
  s_add_u32 m0, s40, 1024
  s_nop 0
  buffer_load_dwordx4 v7, s[12:15], s39 offen lds
  s_add_u32 m0, s40, 2048
  s_nop 0
  buffer_load_dwordx4 v8, s[12:15], s39 offen lds
  s_add_u32 s46, s46, 12288
  s_cmp_eq_u32 s46, 73728
  s_cselect_b32 s46, 0, s46
  v_add_u32 v17, s46, v14
  v_add_u32 v18, s46, v15
  v_add_u32 v19, s46, v16
  s_movk_i32 s41, 8192
  s_cmp_eq_u32 s37, 9
  s_cselect_b32 s40, 4294893568, s41
  v_add_u32 v10, s40, v10
  v_add_u32 v11, s40, v11
  v_add_u32 v12, s40, v12
  v_add_u32 v13, s40, v13
  ds_read_b128 v[32:35], v10
  ds_read_b128 v[36:39], v12
  ds_read_b64_tr_b16 v[48:49], v17 offset:0
  ds_read_b64_tr_b16 v[50:51], v17 offset:768
  ds_read_b64_tr_b16 v[52:53], v18 offset:0
  ds_read_b64_tr_b16 v[54:55], v18 offset:768
  ds_read_b64_tr_b16 v[56:57], v19 offset:0
  ds_read_b64_tr_b16 v[58:59], v19 offset:768
  v_mfma_f32_16x16x32_bf16 v[72:75], v[40:43], v[60:63], v[72:75]
  v_dot2c_f32_bf16 v112, v40, v108
  v_dot2c_f32_bf16 v114, v40, v40
  v_mfma_f32_16x16x32_bf16 v[76:79], v[40:43], v[64:67], v[76:79]
  v_dot2c_f32_bf16 v112, v41, v108
  v_dot2c_f32_bf16 v114, v41, v41
  v_mfma_f32_16x16x32_bf16 v[80:83], v[40:43], v[68:71], v[80:83]
  v_dot2c_f32_bf16 v112, v42, v108
  v_dot2c_f32_bf16 v114, v42, v42
  v_dot2c_f32_bf16 v113, v43, v108
  v_dot2c_f32_bf16 v115, v43, v43
  v_mfma_f32_16x16x32_bf16 v[84:87], v[44:47], v[60:63], v[84:87]
  v_mfma_f32_16x16x32_bf16 v[88:91], v[44:47], v[64:67], v[88:91]
  v_mfma_f32_16x16x32_bf16 v[92:95], v[44:47], v[68:71], v[92:95]
  s_cmp_eq_u32 s35, 1
  s_cbranch_scc0 K1_SK_1b
  v_mfma_f32_16x16x32_bf16 v[96:99], v[108:111], v[60:63], v[96:99]
  v_mfma_f32_16x16x32_bf16 v[100:103], v[108:111], v[64:67], v[100:103]
  v_mfma_f32_16x16x32_bf16 v[104:107], v[108:111], v[68:71], v[104:107]
K1_SK_1b:
  s_add_u32 s37, s37, 1
  s_cmp_lt_u32 s37, 10
  s_cbranch_scc1 K1_LOOP1
  v_add_f32 v112, v112, v113
  v_add_f32 v114, v114, v115
  v_mov_b32 v20, v112
  s_nop 1
  v_permlane32_swap_b32 v112, v20
  v_add_f32 v112, v112, v20
  v_mov_b32 v20, v112
  s_nop 1
  v_permlane16_swap_b32 v112, v20
  v_add_f32 v112, v112, v20
  v_mov_b32 v20, v114
  s_nop 1
  v_permlane32_swap_b32 v114, v20
  v_add_f32 v114, v114, v20
  v_mov_b32 v20, v114
  s_nop 1
  v_permlane16_swap_b32 v114, v20
  v_add_f32 v114, v114, v20
  v_mul_f32 v22, 0x3acccccd, v112
  v_mul_f32 v24, 0x3acccccd, v114
  v_fma_f32 v24, -v22, v22, v24
  v_max_f32 v24, 0, v24
  v_cvt_pk_bf16_f32 v22, v22, v22
  v_lshlrev_b32 v22, 16, v22
  v_cvt_pk_bf16_f32 v24, v24, v24
  v_lshlrev_b32 v24, 16, v24
  v_add_f32 v24, 0x3727c5ac, v24
  v_cvt_pk_bf16_f32 v24, v24, v24
  v_lshlrev_b32 v24, 16, v24
  v_sqrt_f32 v24, v24
  s_nop 0
  v_cvt_pk_bf16_f32 v24, v24, v24
  v_lshlrev_b32 v24, 16, v24
  v_rcp_f32 v23, v24
  s_lshl_b32 s40, s35, 5
  s_lshl_b32 s41, s36, 4
  s_add_u32 s40, s40, s41
  v_add_u32 v24, s40, v3
  v_lshlrev_b32 v25, 2, v24
  v_add_u32 v25, 155648, v25
  ds_write_b32 v25, v22
  ds_write_b32 v25, v23 offset:256
  s_cmp_eq_u32 s33, 0
  s_cbranch_scc0 K1_NOST1
  s_lshl_b32 s41, s32, 9
  s_add_u32 s41, s41, 16777216
  v_lshlrev_b32 v24, 3, v24
  s_mov_b32 exec_lo, 0xffff
  s_mov_b32 exec_hi, 0x0
  buffer_store_dwordx2 v[22:23], v24, s[16:19], s41 offen
  s_mov_b64 exec, s[52:53]
K1_NOST1:
  s_mul_i32 s40, s34, 192
  s_add_u32 s40, s40, 156160
  v_lshlrev_b32 v24, 2, v3
  v_add_u32 v24, s40, v24
  ds_write_b32 v24, v96 offset:0
  ds_write_b32 v24, v100 offset:64
  ds_write_b32 v24, v104 offset:128
  s_waitcnt lgkmcnt(0)
  s_barrier
  s_xor_b32 s41, s34, 2
  s_mul_i32 s41, s41, 192
  s_add_u32 s41, s41, 156160
  v_lshlrev_b32 v24, 2, v3
  v_add_u32 v24, s41, v24
  ds_read_b32 v128, v24 offset:0
  ds_read_b32 v130, v24 offset:64
  ds_read_b32 v132, v24 offset:128
  s_lshl_b32 s40, s35, 7
  s_lshl_b32 s41, s36, 6
  s_add_u32 s40, s40, s41
  s_add_u32 s40, s40, 155648
  v_lshlrev_b32 v25, 4, v2
  v_add_u32 v25, s40, v25
  v_xor_b32 v26, 64, v25
  ds_read_b128 v[136:139], v25
  ds_read_b128 v[140:143], v26
  ds_read_b128 v[144:147], v25 offset:256
  ds_read_b128 v[148:151], v26 offset:256
  v_mov_b32 v152, 0xc0135761
  v_mov_b32 v153, 0xc0135761
  s_waitcnt lgkmcnt(0)
  v_add_f32 v128, v128, v96
  v_sub_f32 v128, 0, v128
  v_add_f32 v130, v130, v100
  v_sub_f32 v130, 0, v130
  v_add_f32 v132, v132, v104
  v_sub_f32 v132, 0, v132
  v_mov_b32 v154, 0
  v_mov_b32 v155, 0
  v_mov_b32 v156, 0
  v_mov_b32 v157, 0
  v_mov_b32 v158, 0
  v_mov_b32 v159, 0
  v_mov_b32 v160, 0
  v_mov_b32 v161, 0
  v_mov_b32 v162, 0
  v_mov_b32 v163, 0
  v_mov_b32 v164, 0
  v_mov_b32 v165, 0
  v_mov_b32 v166, 0
  v_mov_b32 v167, 0
  v_mov_b32 v168, 0
  v_mov_b32 v169, 0
  v_pk_fma_f32 v[72:73], v[136:137], v[128:129], v[72:73] op_sel_hi:[1,0,1]
  v_pk_mul_f32 v[72:73], v[72:73], v[144:145]
  v_pk_mul_f32 v[172:173], v[72:73], v[72:73]
  v_pk_fma_f32 v[172:173], v[172:173], s[48:49], v[152:153]
  v_pk_mul_f32 v[172:173], v[172:173], v[72:73]
  v_exp_f32 v172, v172
  v_exp_f32 v173, v173
  s_nop 0
  v_pk_add_f32 v[172:173], v[172:173], s[50:51]
  v_rcp_f32 v172, v172
  v_rcp_f32 v173, v173
  s_nop 0
  v_pk_mul_f32 v[172:173], v[172:173], v[72:73]
  v_cvt_pk_bf16_f32 v116, v172, v173
  v_pk_add_f32 v[154:155], v[154:155], v[172:173]
  v_pk_fma_f32 v[162:163], v[172:173], v[172:173], v[162:163]
  v_pk_fma_f32 v[74:75], v[138:139], v[128:129], v[74:75] op_sel_hi:[1,0,1]
  v_pk_mul_f32 v[74:75], v[74:75], v[146:147]
  v_pk_mul_f32 v[176:177], v[74:75], v[74:75]
  v_pk_fma_f32 v[176:177], v[176:177], s[48:49], v[152:153]
  v_pk_mul_f32 v[176:177], v[176:177], v[74:75]
  v_exp_f32 v176, v176
  v_exp_f32 v177, v177
  s_nop 0
  v_pk_add_f32 v[176:177], v[176:177], s[50:51]
  v_rcp_f32 v176, v176
  v_rcp_f32 v177, v177
  s_nop 0
  v_pk_mul_f32 v[176:177], v[176:177], v[74:75]
  v_cvt_pk_bf16_f32 v117, v176, v177
  v_pk_add_f32 v[156:157], v[156:157], v[176:177]
  v_pk_fma_f32 v[164:165], v[176:177], v[176:177], v[164:165]
  v_pk_fma_f32 v[84:85], v[140:141], v[128:129], v[84:85] op_sel_hi:[1,0,1]
  v_pk_mul_f32 v[84:85], v[84:85], v[148:149]
  v_pk_mul_f32 v[172:173], v[84:85], v[84:85]
  v_pk_fma_f32 v[172:173], v[172:173], s[48:49], v[152:153]
  v_pk_mul_f32 v[172:173], v[172:173], v[84:85]
  v_exp_f32 v172, v172
  v_exp_f32 v173, v173
  s_nop 0
  v_pk_add_f32 v[172:173], v[172:173], s[50:51]
  v_rcp_f32 v172, v172
  v_rcp_f32 v173, v173
  s_nop 0
  v_pk_mul_f32 v[172:173], v[172:173], v[84:85]
  v_cvt_pk_bf16_f32 v118, v172, v173
  v_pk_add_f32 v[158:159], v[158:159], v[172:173]
  v_pk_fma_f32 v[166:167], v[172:173], v[172:173], v[166:167]
  v_pk_fma_f32 v[86:87], v[142:143], v[128:129], v[86:87] op_sel_hi:[1,0,1]
  v_pk_mul_f32 v[86:87], v[86:87], v[150:151]
  v_pk_mul_f32 v[176:177], v[86:87], v[86:87]
  v_pk_fma_f32 v[176:177], v[176:177], s[48:49], v[152:153]
  v_pk_mul_f32 v[176:177], v[176:177], v[86:87]
  v_exp_f32 v176, v176
  v_exp_f32 v177, v177
  s_nop 0
  v_pk_add_f32 v[176:177], v[176:177], s[50:51]
  v_rcp_f32 v176, v176
  v_rcp_f32 v177, v177
  s_nop 0
  v_pk_mul_f32 v[176:177], v[176:177], v[86:87]
  v_cvt_pk_bf16_f32 v119, v176, v177
  v_pk_add_f32 v[160:161], v[160:161], v[176:177]
  v_pk_fma_f32 v[168:169], v[176:177], v[176:177], v[168:169]
  v_pk_fma_f32 v[76:77], v[136:137], v[130:131], v[76:77] op_sel_hi:[1,0,1]
  v_pk_mul_f32 v[76:77], v[76:77], v[144:145]
  v_pk_mul_f32 v[172:173], v[76:77], v[76:77]
  v_pk_fma_f32 v[172:173], v[172:173], s[48:49], v[152:153]
  v_pk_mul_f32 v[172:173], v[172:173], v[76:77]
  v_exp_f32 v172, v172
  v_exp_f32 v173, v173
  s_nop 0
  v_pk_add_f32 v[172:173], v[172:173], s[50:51]
  v_rcp_f32 v172, v172
  v_rcp_f32 v173, v173
  s_nop 0
  v_pk_mul_f32 v[172:173], v[172:173], v[76:77]
  v_cvt_pk_bf16_f32 v120, v172, v173
  v_pk_add_f32 v[154:155], v[154:155], v[172:173]
  v_pk_fma_f32 v[162:163], v[172:173], v[172:173], v[162:163]
  v_pk_fma_f32 v[78:79], v[138:139], v[130:131], v[78:79] op_sel_hi:[1,0,1]
  v_pk_mul_f32 v[78:79], v[78:79], v[146:147]
  v_pk_mul_f32 v[176:177], v[78:79], v[78:79]
  v_pk_fma_f32 v[176:177], v[176:177], s[48:49], v[152:153]
  v_pk_mul_f32 v[176:177], v[176:177], v[78:79]
  v_exp_f32 v176, v176
  v_exp_f32 v177, v177
  s_nop 0
  v_pk_add_f32 v[176:177], v[176:177], s[50:51]
  v_rcp_f32 v176, v176
  v_rcp_f32 v177, v177
  s_nop 0
  v_pk_mul_f32 v[176:177], v[176:177], v[78:79]
  v_cvt_pk_bf16_f32 v121, v176, v177
  v_pk_add_f32 v[156:157], v[156:157], v[176:177]
  v_pk_fma_f32 v[164:165], v[176:177], v[176:177], v[164:165]
  v_pk_fma_f32 v[88:89], v[140:141], v[130:131], v[88:89] op_sel_hi:[1,0,1]
  v_pk_mul_f32 v[88:89], v[88:89], v[148:149]
  v_pk_mul_f32 v[172:173], v[88:89], v[88:89]
  v_pk_fma_f32 v[172:173], v[172:173], s[48:49], v[152:153]
  v_pk_mul_f32 v[172:173], v[172:173], v[88:89]
  v_exp_f32 v172, v172
  v_exp_f32 v173, v173
  s_nop 0
  v_pk_add_f32 v[172:173], v[172:173], s[50:51]
  v_rcp_f32 v172, v172
  v_rcp_f32 v173, v173
  s_nop 0
  v_pk_mul_f32 v[172:173], v[172:173], v[88:89]
  v_cvt_pk_bf16_f32 v122, v172, v173
  v_pk_add_f32 v[158:159], v[158:159], v[172:173]
  v_pk_fma_f32 v[166:167], v[172:173], v[172:173], v[166:167]
  v_pk_fma_f32 v[90:91], v[142:143], v[130:131], v[90:91] op_sel_hi:[1,0,1]
  v_pk_mul_f32 v[90:91], v[90:91], v[150:151]
  v_pk_mul_f32 v[176:177], v[90:91], v[90:91]
  v_pk_fma_f32 v[176:177], v[176:177], s[48:49], v[152:153]
  v_pk_mul_f32 v[176:177], v[176:177], v[90:91]
  v_exp_f32 v176, v176
  v_exp_f32 v177, v177
  s_nop 0
  v_pk_add_f32 v[176:177], v[176:177], s[50:51]
  v_rcp_f32 v176, v176
  v_rcp_f32 v177, v177
  s_nop 0
  v_pk_mul_f32 v[176:177], v[176:177], v[90:91]
  v_cvt_pk_bf16_f32 v123, v176, v177
  v_pk_add_f32 v[160:161], v[160:161], v[176:177]
  v_pk_fma_f32 v[168:169], v[176:177], v[176:177], v[168:169]
  v_pk_fma_f32 v[80:81], v[136:137], v[132:133], v[80:81] op_sel_hi:[1,0,1]
  v_pk_mul_f32 v[80:81], v[80:81], v[144:145]
  v_pk_mul_f32 v[172:173], v[80:81], v[80:81]
  v_pk_fma_f32 v[172:173], v[172:173], s[48:49], v[152:153]
  v_pk_mul_f32 v[172:173], v[172:173], v[80:81]
  v_exp_f32 v172, v172
  v_exp_f32 v173, v173
  s_nop 0
  v_pk_add_f32 v[172:173], v[172:173], s[50:51]
  v_rcp_f32 v172, v172
  v_rcp_f32 v173, v173
  s_nop 0
  v_pk_mul_f32 v[172:173], v[172:173], v[80:81]
  v_cvt_pk_bf16_f32 v124, v172, v173
  v_pk_add_f32 v[154:155], v[154:155], v[172:173]
  v_pk_fma_f32 v[162:163], v[172:173], v[172:173], v[162:163]
  v_pk_fma_f32 v[82:83], v[138:139], v[132:133], v[82:83] op_sel_hi:[1,0,1]
  v_pk_mul_f32 v[82:83], v[82:83], v[146:147]
  v_pk_mul_f32 v[176:177], v[82:83], v[82:83]
  v_pk_fma_f32 v[176:177], v[176:177], s[48:49], v[152:153]
  v_pk_mul_f32 v[176:177], v[176:177], v[82:83]
  v_exp_f32 v176, v176
  v_exp_f32 v177, v177
  s_nop 0
  v_pk_add_f32 v[176:177], v[176:177], s[50:51]
  v_rcp_f32 v176, v176
  v_rcp_f32 v177, v177
  s_nop 0
  v_pk_mul_f32 v[176:177], v[176:177], v[82:83]
  v_cvt_pk_bf16_f32 v125, v176, v177
  v_pk_add_f32 v[156:157], v[156:157], v[176:177]
  v_pk_fma_f32 v[164:165], v[176:177], v[176:177], v[164:165]
  v_pk_fma_f32 v[92:93], v[140:141], v[132:133], v[92:93] op_sel_hi:[1,0,1]
  v_pk_mul_f32 v[92:93], v[92:93], v[148:149]
  v_pk_mul_f32 v[172:173], v[92:93], v[92:93]
  v_pk_fma_f32 v[172:173], v[172:173], s[48:49], v[152:153]
  v_pk_mul_f32 v[172:173], v[172:173], v[92:93]
  v_exp_f32 v172, v172
  v_exp_f32 v173, v173
  s_nop 0
  v_pk_add_f32 v[172:173], v[172:173], s[50:51]
  v_rcp_f32 v172, v172
  v_rcp_f32 v173, v173
  s_nop 0
  v_pk_mul_f32 v[172:173], v[172:173], v[92:93]
  v_cvt_pk_bf16_f32 v126, v172, v173
  v_pk_add_f32 v[158:159], v[158:159], v[172:173]
  v_pk_fma_f32 v[166:167], v[172:173], v[172:173], v[166:167]
  v_pk_fma_f32 v[94:95], v[142:143], v[132:133], v[94:95] op_sel_hi:[1,0,1]
  v_pk_mul_f32 v[94:95], v[94:95], v[150:151]
  v_pk_mul_f32 v[176:177], v[94:95], v[94:95]
  v_pk_fma_f32 v[176:177], v[176:177], s[48:49], v[152:153]
  v_pk_mul_f32 v[176:177], v[176:177], v[94:95]
  v_exp_f32 v176, v176
  v_exp_f32 v177, v177
  s_nop 0
  v_pk_add_f32 v[176:177], v[176:177], s[50:51]
  v_rcp_f32 v176, v176
  v_rcp_f32 v177, v177
  s_nop 0
  v_pk_mul_f32 v[176:177], v[176:177], v[94:95]
  v_cvt_pk_bf16_f32 v127, v176, v177
  v_pk_add_f32 v[160:161], v[160:161], v[176:177]
  v_pk_fma_f32 v[168:169], v[176:177], v[176:177], v[168:169]
  v_add_f32_dpp v154, v154, v154 row_ror:8 row_mask:0xf bank_mask:0xf
  v_add_f32_dpp v155, v155, v155 row_ror:8 row_mask:0xf bank_mask:0xf
  v_add_f32_dpp v156, v156, v156 row_ror:8 row_mask:0xf bank_mask:0xf
  v_add_f32_dpp v157, v157, v157 row_ror:8 row_mask:0xf bank_mask:0xf
  v_add_f32_dpp v158, v158, v158 row_ror:8 row_mask:0xf bank_mask:0xf
  v_add_f32_dpp v159, v159, v159 row_ror:8 row_mask:0xf bank_mask:0xf
  v_add_f32_dpp v160, v160, v160 row_ror:8 row_mask:0xf bank_mask:0xf
  v_add_f32_dpp v161, v161, v161 row_ror:8 row_mask:0xf bank_mask:0xf
  v_add_f32_dpp v162, v162, v162 row_ror:8 row_mask:0xf bank_mask:0xf
  v_add_f32_dpp v163, v163, v163 row_ror:8 row_mask:0xf bank_mask:0xf
  v_add_f32_dpp v164, v164, v164 row_ror:8 row_mask:0xf bank_mask:0xf
  v_add_f32_dpp v165, v165, v165 row_ror:8 row_mask:0xf bank_mask:0xf
  v_add_f32_dpp v166, v166, v166 row_ror:8 row_mask:0xf bank_mask:0xf
  v_add_f32_dpp v167, v167, v167 row_ror:8 row_mask:0xf bank_mask:0xf
  v_add_f32_dpp v168, v168, v168 row_ror:8 row_mask:0xf bank_mask:0xf
  v_add_f32_dpp v169, v169, v169 row_ror:8 row_mask:0xf bank_mask:0xf
  v_add_f32_dpp v154, v154, v154 row_ror:4 row_mask:0xf bank_mask:0xf
  v_add_f32_dpp v155, v155, v155 row_ror:4 row_mask:0xf bank_mask:0xf
  v_add_f32_dpp v156, v156, v156 row_ror:4 row_mask:0xf bank_mask:0xf
  v_add_f32_dpp v157, v157, v157 row_ror:4 row_mask:0xf bank_mask:0xf
  v_add_f32_dpp v158, v158, v158 row_ror:4 row_mask:0xf bank_mask:0xf
  v_add_f32_dpp v159, v159, v159 row_ror:4 row_mask:0xf bank_mask:0xf
  v_add_f32_dpp v160, v160, v160 row_ror:4 row_mask:0xf bank_mask:0xf
  v_add_f32_dpp v161, v161, v161 row_ror:4 row_mask:0xf bank_mask:0xf
  v_add_f32_dpp v162, v162, v162 row_ror:4 row_mask:0xf bank_mask:0xf
  v_add_f32_dpp v163, v163, v163 row_ror:4 row_mask:0xf bank_mask:0xf
  v_add_f32_dpp v164, v164, v164 row_ror:4 row_mask:0xf bank_mask:0xf
  v_add_f32_dpp v165, v165, v165 row_ror:4 row_mask:0xf bank_mask:0xf
  v_add_f32_dpp v166, v166, v166 row_ror:4 row_mask:0xf bank_mask:0xf
  v_add_f32_dpp v167, v167, v167 row_ror:4 row_mask:0xf bank_mask:0xf
  v_add_f32_dpp v168, v168, v168 row_ror:4 row_mask:0xf bank_mask:0xf
  v_add_f32_dpp v169, v169, v169 row_ror:4 row_mask:0xf bank_mask:0xf
  v_add_f32_dpp v154, v154, v154 row_ror:2 row_mask:0xf bank_mask:0xf
  v_add_f32_dpp v155, v155, v155 row_ror:2 row_mask:0xf bank_mask:0xf
  v_add_f32_dpp v156, v156, v156 row_ror:2 row_mask:0xf bank_mask:0xf
  v_add_f32_dpp v157, v157, v157 row_ror:2 row_mask:0xf bank_mask:0xf
  v_add_f32_dpp v158, v158, v158 row_ror:2 row_mask:0xf bank_mask:0xf
  v_add_f32_dpp v159, v159, v159 row_ror:2 row_mask:0xf bank_mask:0xf
  v_add_f32_dpp v160, v160, v160 row_ror:2 row_mask:0xf bank_mask:0xf
  v_add_f32_dpp v161, v161, v161 row_ror:2 row_mask:0xf bank_mask:0xf
  v_add_f32_dpp v162, v162, v162 row_ror:2 row_mask:0xf bank_mask:0xf
  v_add_f32_dpp v163, v163, v163 row_ror:2 row_mask:0xf bank_mask:0xf
  v_add_f32_dpp v164, v164, v164 row_ror:2 row_mask:0xf bank_mask:0xf
  v_add_f32_dpp v165, v165, v165 row_ror:2 row_mask:0xf bank_mask:0xf
  v_add_f32_dpp v166, v166, v166 row_ror:2 row_mask:0xf bank_mask:0xf
  v_add_f32_dpp v167, v167, v167 row_ror:2 row_mask:0xf bank_mask:0xf
  v_add_f32_dpp v168, v168, v168 row_ror:2 row_mask:0xf bank_mask:0xf
  v_add_f32_dpp v169, v169, v169 row_ror:2 row_mask:0xf bank_mask:0xf
  v_add_f32_dpp v154, v154, v154 row_ror:1 row_mask:0xf bank_mask:0xf
  v_add_f32_dpp v155, v155, v155 row_ror:1 row_mask:0xf bank_mask:0xf
  v_add_f32_dpp v156, v156, v156 row_ror:1 row_mask:0xf bank_mask:0xf
  v_add_f32_dpp v157, v157, v157 row_ror:1 row_mask:0xf bank_mask:0xf
  v_add_f32_dpp v158, v158, v158 row_ror:1 row_mask:0xf bank_mask:0xf
  v_add_f32_dpp v159, v159, v159 row_ror:1 row_mask:0xf bank_mask:0xf
  v_add_f32_dpp v160, v160, v160 row_ror:1 row_mask:0xf bank_mask:0xf
  v_add_f32_dpp v161, v161, v161 row_ror:1 row_mask:0xf bank_mask:0xf
  v_add_f32_dpp v162, v162, v162 row_ror:1 row_mask:0xf bank_mask:0xf
  v_add_f32_dpp v163, v163, v163 row_ror:1 row_mask:0xf bank_mask:0xf
  v_add_f32_dpp v164, v164, v164 row_ror:1 row_mask:0xf bank_mask:0xf
  v_add_f32_dpp v165, v165, v165 row_ror:1 row_mask:0xf bank_mask:0xf
  v_add_f32_dpp v166, v166, v166 row_ror:1 row_mask:0xf bank_mask:0xf
  v_add_f32_dpp v167, v167, v167 row_ror:1 row_mask:0xf bank_mask:0xf
  v_add_f32_dpp v168, v168, v168 row_ror:1 row_mask:0xf bank_mask:0xf
  v_add_f32_dpp v169, v169, v169 row_ror:1 row_mask:0xf bank_mask:0xf
  s_lshl_b32 s40, s36, 8
  s_add_u32 s40, s40, 1280
  v_add_u32 v25, s40, v25
  v_add_u32 v26, s40, v26
  s_mov_b32 exec_lo, 0x10001
  s_mov_b32 exec_hi, 0x10001
  ds_write_b128 v25, v[154:157]
  ds_write_b128 v26, v[158:161]
  ds_write_b128 v25, v[162:165] offset:512
  ds_write_b128 v26, v[166:169] offset:512
  s_mov_b64 exec, s[52:53]
  v_mov_b32 v72, 0
  v_mov_b32 v73, 0
  v_mov_b32 v74, 0
  v_mov_b32 v75, 0
  v_mov_b32 v76, 0
  v_mov_b32 v77, 0
  v_mov_b32 v78, 0
  v_mov_b32 v79, 0
  v_mov_b32 v80, 0
  v_mov_b32 v81, 0
  v_mov_b32 v82, 0
  v_mov_b32 v83, 0
  v_mov_b32 v84, 0
  v_mov_b32 v85, 0
  v_mov_b32 v86, 0
  v_mov_b32 v87, 0
  v_mov_b32 v88, 0
  v_mov_b32 v89, 0
  v_mov_b32 v90, 0
  v_mov_b32 v91, 0
  v_mov_b32 v92, 0
  v_mov_b32 v93, 0
  v_mov_b32 v94, 0
  v_mov_b32 v95, 0
  v_mov_b32 v96, 0
  v_mov_b32 v97, 0
  v_mov_b32 v98, 0
  v_mov_b32 v99, 0
  v_mov_b32 v100, 0
  v_mov_b32 v101, 0
  v_mov_b32 v102, 0
  v_mov_b32 v103, 0
  v_mov_b32 v104, 0
  v_mov_b32 v105, 0
  v_mov_b32 v106, 0
  v_mov_b32 v107, 0
  s_waitcnt lgkmcnt(0)
  s_barrier
  s_cmp_eq_u32 s34, 0
  s_cbranch_scc0 K1_NOPUB
  v_lshlrev_b32 v20, 2, v1
  v_add_u32 v20, 156928, v20
  ds_read_b32 v22, v20
  ds_read_b32 v24, v20 offset:256
  ds_read_b32 v23, v20 offset:512
  ds_read_b32 v25, v20 offset:768
  s_lshl_b32 s40, s32, 3
  s_add_u32 s40, s40, s33
  s_lshl_b32 s40, s40, 9
  s_add_u32 s40, s40, 16842752
  v_lshlrev_b32 v21, 3, v1
  s_waitcnt lgkmcnt(0)
  v_add_f32 v22, v22, v24
  v_add_f32 v23, v23, v25
  buffer_store_dwordx2 v[22:23], v21, s[16:19], s40 offen sc1
K1_NOPUB:
K1_LOOP2:
  ds_read_b128 v[40:43], v11
  ds_read_b128 v[44:47], v13
  ds_read_b64_tr_b16 v[60:61], v17 offset:6144
  ds_read_b64_tr_b16 v[62:63], v17 offset:6912
  ds_read_b64_tr_b16 v[64:65], v18 offset:6144
  ds_read_b64_tr_b16 v[66:67], v18 offset:6912
  ds_read_b64_tr_b16 v[68:69], v19 offset:6144
  ds_read_b64_tr_b16 v[70:71], v19 offset:6912
  s_waitcnt lgkmcnt(8)
  v_mfma_f32_16x16x32_bf16 v[72:75], v[48:51], v[32:35], v[72:75]
  v_mfma_f32_16x16x32_bf16 v[76:79], v[52:55], v[32:35], v[76:79]
  v_mfma_f32_16x16x32_bf16 v[80:83], v[56:59], v[32:35], v[80:83]
  v_mfma_f32_16x16x32_bf16 v[84:87], v[48:51], v[36:39], v[84:87]
  v_mfma_f32_16x16x32_bf16 v[88:91], v[52:55], v[36:39], v[88:91]
  v_mfma_f32_16x16x32_bf16 v[92:95], v[56:59], v[36:39], v[92:95]
  s_cmp_eq_u32 s35, 0
  s_cbranch_scc0 K1_SK_2a
  v_mfma_f32_16x16x32_bf16 v[96:99], v[48:51], v[108:111], v[96:99]
  v_mfma_f32_16x16x32_bf16 v[100:103], v[52:55], v[108:111], v[100:103]
  v_mfma_f32_16x16x32_bf16 v[104:107], v[56:59], v[108:111], v[104:107]
K1_SK_2a:
  s_waitcnt lgkmcnt(0)
  s_waitcnt vmcnt(12)
  s_barrier
  s_add_u32 s38, s37, 6
  s_mul_i32 s39, s38, 196608
  s_add_u32 s39, s39, s43
  s_cmp_lt_u32 s38, 10
  s_cbranch_scc1 K1_OFF2
  s_sub_u32 s39, s38, 10
  s_mul_i32 s39, s39, 196608
  s_add_u32 s39, s39, s44
  s_cmp_lt_u32 s38, 20
  s_cselect_b32 s39, s39, 0x80000000
K1_OFF2:
  s_mul_i32 s40, s34, 3072
  s_add_u32 s40, s40, s46
  s_mov_b32 m0, s40
  s_nop 0
  buffer_load_dwordx4 v6, s[12:15], s39 offen lds
  s_add_u32 m0, s40, 1024
  s_nop 0
  buffer_load_dwordx4 v7, s[12:15], s39 offen lds
  s_add_u32 m0, s40, 2048
  s_nop 0
  buffer_load_dwordx4 v8, s[12:15], s39 offen lds
  s_cmp_eq_u32 s37, 12
  s_cbranch_scc0 K1_NOFLAG
  s_cmp_eq_u32 s34, 0
  s_cbranch_scc0 K1_NOFLAG
  s_waitcnt vmcnt(9)
  s_lshl_b32 s40, s32, 2
  v_mov_b32 v20, s40
  v_mov_b32 v21, 1
  s_mov_b32 exec_lo, 0x1
  s_mov_b32 exec_hi, 0x0
  buffer_atomic_add v21, v20, s[56:59], 0 offen sc1
  s_mov_b64 exec, s[52:53]
K1_NOFLAG:
  s_add_u32 s46, s46, 12288
  s_cmp_eq_u32 s46, 73728
  s_cselect_b32 s46, 0, s46
  v_add_u32 v17, s46, v14
  v_add_u32 v18, s46, v15
  v_add_u32 v19, s46, v16
  s_movk_i32 s41, 8192
  s_cmp_eq_u32 s37, 9
  s_cselect_b32 s40, 4294893568, s41
  v_add_u32 v10, s40, v10
  v_add_u32 v11, s40, v11
  v_add_u32 v12, s40, v12
  v_add_u32 v13, s40, v13
  ds_read_b128 v[32:35], v10
  ds_read_b128 v[36:39], v12
  ds_read_b64_tr_b16 v[48:49], v17 offset:0
  ds_read_b64_tr_b16 v[50:51], v17 offset:768
  ds_read_b64_tr_b16 v[52:53], v18 offset:0
  ds_read_b64_tr_b16 v[54:55], v18 offset:768
  ds_read_b64_tr_b16 v[56:57], v19 offset:0
  ds_read_b64_tr_b16 v[58:59], v19 offset:768
  v_mfma_f32_16x16x32_bf16 v[72:75], v[60:63], v[40:43], v[72:75]
  v_mfma_f32_16x16x32_bf16 v[76:79], v[64:67], v[40:43], v[76:79]
  v_mfma_f32_16x16x32_bf16 v[80:83], v[68:71], v[40:43], v[80:83]
  v_mfma_f32_16x16x32_bf16 v[84:87], v[60:63], v[44:47], v[84:87]
  v_mfma_f32_16x16x32_bf16 v[88:91], v[64:67], v[44:47], v[88:91]
  v_mfma_f32_16x16x32_bf16 v[92:95], v[68:71], v[44:47], v[92:95]
  s_cmp_eq_u32 s35, 1
  s_cbranch_scc0 K1_SK_2b
  v_mfma_f32_16x16x32_bf16 v[96:99], v[60:63], v[108:111], v[96:99]
  v_mfma_f32_16x16x32_bf16 v[100:103], v[64:67], v[108:111], v[100:103]
  v_mfma_f32_16x16x32_bf16 v[104:107], v[68:71], v[108:111], v[104:107]
K1_SK_2b:
  s_add_u32 s37, s37, 1
  s_cmp_lt_u32 s37, 20
  s_cbranch_scc1 K1_LOOP2
  s_lshl_b32 s40, s32, 2
  v_mov_b32 v28, s40
  buffer_load_dword v29, v28, s[56:59], 0 offen sc1
  s_mul_i32 s40, s34, 192
  s_add_u32 s40, s40, 156160
  v_lshlrev_b32 v24, 4, v2
  v_add_u32 v25, s40, v24
  s_mov_b32 exec_lo, 0x10001
  s_mov_b32 exec_hi, 0x10001
  ds_write_b128 v25, v[96:99] offset:0
  ds_write_b128 v25, v[100:103] offset:64
  ds_write_b128 v25, v[104:107] offset:128
  s_mov_b64 exec, s[52:53]
  s_waitcnt lgkmcnt(0)
  s_barrier
  s_xor_b32 s41, s34, 2
  s_mul_i32 s41, s41, 192
  s_add_u32 s41, s41, 156160
  v_add_u32 v25, s41, v24
  ds_read_b128 v[128:131], v25 offset:0
  ds_read_b128 v[132:135], v25 offset:64
  ds_read_b128 v[136:139], v25 offset:128
  s_lshl_b32 s40, s35, 7
  s_lshl_b32 s41, s36, 6
  s_add_u32 s40, s40, s41
  s_add_u32 s40, s40, 155648
  v_lshlrev_b32 v26, 2, v3
  v_add_u32 v26, s40, v26
  v_xor_b32 v27, 64, v26
  ds_read_b32 v140, v26
  ds_read_b32 v142, v27
  ds_read_b32 v144, v26 offset:256
  ds_read_b32 v146, v27 offset:256
  s_waitcnt lgkmcnt(0)
  v_add_f32 v128, v128, v96
  v_sub_f32 v128, 0, v128
  v_add_f32 v129, v129, v97
  v_sub_f32 v129, 0, v129
  v_add_f32 v130, v130, v98
  v_sub_f32 v130, 0, v130
  v_add_f32 v131, v131, v99
  v_sub_f32 v131, 0, v131
  v_add_f32 v132, v132, v100
  v_sub_f32 v132, 0, v132
  v_add_f32 v133, v133, v101
  v_sub_f32 v133, 0, v133
  v_add_f32 v134, v134, v102
  v_sub_f32 v134, 0, v134
  v_add_f32 v135, v135, v103
  v_sub_f32 v135, 0, v135
  v_add_f32 v136, v136, v104
  v_sub_f32 v136, 0, v136
  v_add_f32 v137, v137, v105
  v_sub_f32 v137, 0, v137
  v_add_f32 v138, v138, v106
  v_sub_f32 v138, 0, v138
  v_add_f32 v139, v139, v107
  v_sub_f32 v139, 0, v139
  s_lshl_b32 s40, s32, 2
  s_lshl_b32 s41, s35, 1
  s_add_u32 s40, s40, s41
  s_add_u32 s41, s40, s36
  s_xor_b32 s42, s41, 1
  s_mul_i32 s39, s33, 6
  s_mul_i32 s38, s36, 3
  s_add_u32 s39, s39, s38
  s_mul_i32 s41, s41, 48
  s_add_u32 s41, s41, s39
  s_lshl_b32 s41, s41, 9
  s_add_u32 s41, s41, 0
  s_mul_i32 s42, s42, 48
  s_add_u32 s42, s42, s39
  s_lshl_b32 s42, s42, 9
  s_add_u32 s42, s42, 0
  v_lshlrev_b32 v26, 3, v1
  v_pk_fma_f32 v[72:73], v[128:129], v[140:141], v[72:73] op_sel_hi:[1,0,1]
  v_pk_mul_f32 v[72:73], v[72:73], v[144:145] op_sel_hi:[1,0]
  v_pk_mul_f32 v[172:173], v[72:73], v[72:73]
  v_pk_fma_f32 v[172:173], v[172:173], s[48:49], v[152:153]
  v_pk_mul_f32 v[172:173], v[172:173], v[72:73]
  v_exp_f32 v172, v172
  v_exp_f32 v173, v173
  s_nop 0
  v_pk_add_f32 v[172:173], v[172:173], s[50:51]
  v_rcp_f32 v172, v172
  v_rcp_f32 v173, v173
  s_nop 0
  v_pk_mul_f32 v[172:173], v[172:173], v[72:73]
  v_cvt_pk_bf16_f32 v180, v172, v173
  v_pk_fma_f32 v[74:75], v[130:131], v[140:141], v[74:75] op_sel_hi:[1,0,1]
  v_pk_mul_f32 v[74:75], v[74:75], v[144:145] op_sel_hi:[1,0]
  v_pk_mul_f32 v[176:177], v[74:75], v[74:75]
  v_pk_fma_f32 v[176:177], v[176:177], s[48:49], v[152:153]
  v_pk_mul_f32 v[176:177], v[176:177], v[74:75]
  v_exp_f32 v176, v176
  v_exp_f32 v177, v177
  s_nop 0
  v_pk_add_f32 v[176:177], v[176:177], s[50:51]
  v_rcp_f32 v176, v176
  v_rcp_f32 v177, v177
  s_nop 0
  v_pk_mul_f32 v[176:177], v[176:177], v[74:75]
  v_cvt_pk_bf16_f32 v181, v176, v177
  buffer_store_dwordx2 v[180:181], v26, s[16:19], s41 offen offset:0
  v_pk_fma_f32 v[76:77], v[132:133], v[140:141], v[76:77] op_sel_hi:[1,0,1]
  v_pk_mul_f32 v[76:77], v[76:77], v[144:145] op_sel_hi:[1,0]
  v_pk_mul_f32 v[172:173], v[76:77], v[76:77]
  v_pk_fma_f32 v[172:173], v[172:173], s[48:49], v[152:153]
  v_pk_mul_f32 v[172:173], v[172:173], v[76:77]
  v_exp_f32 v172, v172
  v_exp_f32 v173, v173
  s_nop 0
  v_pk_add_f32 v[172:173], v[172:173], s[50:51]
  v_rcp_f32 v172, v172
  v_rcp_f32 v173, v173
  s_nop 0
  v_pk_mul_f32 v[172:173], v[172:173], v[76:77]
  v_cvt_pk_bf16_f32 v182, v172, v173
  v_pk_fma_f32 v[78:79], v[134:135], v[140:141], v[78:79] op_sel_hi:[1,0,1]
  v_pk_mul_f32 v[78:79], v[78:79], v[144:145] op_sel_hi:[1,0]
  v_pk_mul_f32 v[176:177], v[78:79], v[78:79]
  v_pk_fma_f32 v[176:177], v[176:177], s[48:49], v[152:153]
  v_pk_mul_f32 v[176:177], v[176:177], v[78:79]
  v_exp_f32 v176, v176
  v_exp_f32 v177, v177
  s_nop 0
  v_pk_add_f32 v[176:177], v[176:177], s[50:51]
  v_rcp_f32 v176, v176
  v_rcp_f32 v177, v177
  s_nop 0
  v_pk_mul_f32 v[176:177], v[176:177], v[78:79]
  v_cvt_pk_bf16_f32 v183, v176, v177
  buffer_store_dwordx2 v[182:183], v26, s[16:19], s41 offen offset:512
  v_pk_fma_f32 v[80:81], v[136:137], v[140:141], v[80:81] op_sel_hi:[1,0,1]
  v_pk_mul_f32 v[80:81], v[80:81], v[144:145] op_sel_hi:[1,0]
  v_pk_mul_f32 v[172:173], v[80:81], v[80:81]
  v_pk_fma_f32 v[172:173], v[172:173], s[48:49], v[152:153]
  v_pk_mul_f32 v[172:173], v[172:173], v[80:81]
  v_exp_f32 v172, v172
  v_exp_f32 v173, v173
  s_nop 0
  v_pk_add_f32 v[172:173], v[172:173], s[50:51]
  v_rcp_f32 v172, v172
  v_rcp_f32 v173, v173
  s_nop 0
  v_pk_mul_f32 v[172:173], v[172:173], v[80:81]
  v_cvt_pk_bf16_f32 v184, v172, v173
  v_pk_fma_f32 v[82:83], v[138:139], v[140:141], v[82:83] op_sel_hi:[1,0,1]
  v_pk_mul_f32 v[82:83], v[82:83], v[144:145] op_sel_hi:[1,0]
  v_pk_mul_f32 v[176:177], v[82:83], v[82:83]
  v_pk_fma_f32 v[176:177], v[176:177], s[48:49], v[152:153]
  v_pk_mul_f32 v[176:177], v[176:177], v[82:83]
  v_exp_f32 v176, v176
  v_exp_f32 v177, v177
  s_nop 0
  v_pk_add_f32 v[176:177], v[176:177], s[50:51]
  v_rcp_f32 v176, v176
  v_rcp_f32 v177, v177
  s_nop 0
  v_pk_mul_f32 v[176:177], v[176:177], v[82:83]
  v_cvt_pk_bf16_f32 v185, v176, v177
  buffer_store_dwordx2 v[184:185], v26, s[16:19], s41 offen offset:1024
  s_waitcnt vmcnt(3)
K1_POLL:
  v_readfirstlane_b32 s38, v29
  s_nop 0
  s_cmp_ge_u32 s38, 8
  s_cbranch_scc1 K1_POLLED
  s_sleep 2
  buffer_load_dword v29, v28, s[56:59], 0 offen sc1
  s_waitcnt vmcnt(0)
  s_branch K1_POLL
K1_POLLED:
  v_and_b32 v29, 31, v1
  s_lshl_b32 s38, s35, 5
  v_add_u32 v29, s38, v29
  v_lshlrev_b32 v29, 3, v29
  s_lshl_b32 s38, s32, 12
  s_add_u32 s38, s38, 16842752
  buffer_load_dwordx2 v[192:193], v29, s[16:19], s38 offen offset:0 sc1
  buffer_load_dwordx2 v[194:195], v29, s[16:19], s38 offen offset:512 sc1
  buffer_load_dwordx2 v[196:197], v29, s[16:19], s38 offen offset:1024 sc1
  buffer_load_dwordx2 v[198:199], v29, s[16:19], s38 offen offset:1536 sc1
  buffer_load_dwordx2 v[200:201], v29, s[16:19], s38 offen offset:2048 sc1
  buffer_load_dwordx2 v[202:203], v29, s[16:19], s38 offen offset:2560 sc1
  buffer_load_dwordx2 v[204:205], v29, s[16:19], s38 offen offset:3072 sc1
  buffer_load_dwordx2 v[206:207], v29, s[16:19], s38 offen offset:3584 sc1
  v_pk_fma_f32 v[84:85], v[128:129], v[142:143], v[84:85] op_sel_hi:[1,0,1]
  v_pk_mul_f32 v[84:85], v[84:85], v[146:147] op_sel_hi:[1,0]
  v_pk_mul_f32 v[172:173], v[84:85], v[84:85]
  v_pk_fma_f32 v[172:173], v[172:173], s[48:49], v[152:153]
  v_pk_mul_f32 v[172:173], v[172:173], v[84:85]
  v_exp_f32 v172, v172
  v_exp_f32 v173, v173
  s_nop 0
  v_pk_add_f32 v[172:173], v[172:173], s[50:51]
  v_rcp_f32 v172, v172
  v_rcp_f32 v173, v173
  s_nop 0
  v_pk_mul_f32 v[172:173], v[172:173], v[84:85]
  v_cvt_pk_bf16_f32 v186, v172, v173
  v_pk_fma_f32 v[86:87], v[130:131], v[142:143], v[86:87] op_sel_hi:[1,0,1]
  v_pk_mul_f32 v[86:87], v[86:87], v[146:147] op_sel_hi:[1,0]
  v_pk_mul_f32 v[176:177], v[86:87], v[86:87]
  v_pk_fma_f32 v[176:177], v[176:177], s[48:49], v[152:153]
  v_pk_mul_f32 v[176:177], v[176:177], v[86:87]
  v_exp_f32 v176, v176
  v_exp_f32 v177, v177
  s_nop 0
  v_pk_add_f32 v[176:177], v[176:177], s[50:51]
  v_rcp_f32 v176, v176
  v_rcp_f32 v177, v177
  s_nop 0
  v_pk_mul_f32 v[176:177], v[176:177], v[86:87]
  v_cvt_pk_bf16_f32 v187, v176, v177
  buffer_store_dwordx2 v[186:187], v26, s[16:19], s42 offen offset:0
  v_pk_fma_f32 v[88:89], v[132:133], v[142:143], v[88:89] op_sel_hi:[1,0,1]
  v_pk_mul_f32 v[88:89], v[88:89], v[146:147] op_sel_hi:[1,0]
  v_pk_mul_f32 v[172:173], v[88:89], v[88:89]
  v_pk_fma_f32 v[172:173], v[172:173], s[48:49], v[152:153]
  v_pk_mul_f32 v[172:173], v[172:173], v[88:89]
  v_exp_f32 v172, v172
  v_exp_f32 v173, v173
  s_nop 0
  v_pk_add_f32 v[172:173], v[172:173], s[50:51]
  v_rcp_f32 v172, v172
  v_rcp_f32 v173, v173
  s_nop 0
  v_pk_mul_f32 v[172:173], v[172:173], v[88:89]
  v_cvt_pk_bf16_f32 v188, v172, v173
  v_pk_fma_f32 v[90:91], v[134:135], v[142:143], v[90:91] op_sel_hi:[1,0,1]
  v_pk_mul_f32 v[90:91], v[90:91], v[146:147] op_sel_hi:[1,0]
  v_pk_mul_f32 v[176:177], v[90:91], v[90:91]
  v_pk_fma_f32 v[176:177], v[176:177], s[48:49], v[152:153]
  v_pk_mul_f32 v[176:177], v[176:177], v[90:91]
  v_exp_f32 v176, v176
  v_exp_f32 v177, v177
  s_nop 0
  v_pk_add_f32 v[176:177], v[176:177], s[50:51]
  v_rcp_f32 v176, v176
  v_rcp_f32 v177, v177
  s_nop 0
  v_pk_mul_f32 v[176:177], v[176:177], v[90:91]
  v_cvt_pk_bf16_f32 v189, v176, v177
  buffer_store_dwordx2 v[188:189], v26, s[16:19], s42 offen offset:512
  v_pk_fma_f32 v[92:93], v[136:137], v[142:143], v[92:93] op_sel_hi:[1,0,1]
  v_pk_mul_f32 v[92:93], v[92:93], v[146:147] op_sel_hi:[1,0]
  v_pk_mul_f32 v[172:173], v[92:93], v[92:93]
  v_pk_fma_f32 v[172:173], v[172:173], s[48:49], v[152:153]
  v_pk_mul_f32 v[172:173], v[172:173], v[92:93]
  v_exp_f32 v172, v172
  v_exp_f32 v173, v173
  s_nop 0
  v_pk_add_f32 v[172:173], v[172:173], s[50:51]
  v_rcp_f32 v172, v172
  v_rcp_f32 v173, v173
  s_nop 0
  v_pk_mul_f32 v[172:173], v[172:173], v[92:93]
  v_cvt_pk_bf16_f32 v190, v172, v173
  v_pk_fma_f32 v[94:95], v[138:139], v[142:143], v[94:95] op_sel_hi:[1,0,1]
  v_pk_mul_f32 v[94:95], v[94:95], v[146:147] op_sel_hi:[1,0]
  v_pk_mul_f32 v[176:177], v[94:95], v[94:95]
  v_pk_fma_f32 v[176:177], v[176:177], s[48:49], v[152:153]
  v_pk_mul_f32 v[176:177], v[176:177], v[94:95]
  v_exp_f32 v176, v176
  v_exp_f32 v177, v177
  s_nop 0
  v_pk_add_f32 v[176:177], v[176:177], s[50:51]
  v_rcp_f32 v176, v176
  v_rcp_f32 v177, v177
  s_nop 0
  v_pk_mul_f32 v[176:177], v[176:177], v[94:95]
  v_cvt_pk_bf16_f32 v191, v176, v177
  buffer_store_dwordx2 v[190:191], v26, s[16:19], s42 offen offset:1024
  s_waitcnt vmcnt(3)
  v_pk_add_f32 v[192:193], v[192:193], v[194:195]
  v_pk_add_f32 v[192:193], v[192:193], v[196:197]
  v_pk_add_f32 v[192:193], v[192:193], v[198:199]
  v_pk_add_f32 v[192:193], v[192:193], v[200:201]
  v_pk_add_f32 v[192:193], v[192:193], v[202:203]
  v_pk_add_f32 v[192:193], v[192:193], v[204:205]
  v_pk_add_f32 v[192:193], v[192:193], v[206:207]
  v_mul_f32 v22, 0x3aaaaaab, v192
  v_mul_f32 v24, 0x3aaaaaab, v193
  v_fma_f32 v24, -v22, v22, v24
  v_max_f32 v24, 0, v24
  v_cvt_pk_bf16_f32 v22, v22, v22
  v_lshlrev_b32 v22, 16, v22
  v_cvt_pk_bf16_f32 v24, v24, v24
  v_lshlrev_b32 v24, 16, v24
  v_add_f32 v24, 0x3727c5ac, v24
  v_cvt_pk_bf16_f32 v24, v24, v24
  v_lshlrev_b32 v24, 16, v24
  v_sqrt_f32 v24, v24
  s_nop 0
  v_cvt_pk_bf16_f32 v24, v24, v24
  v_lshlrev_b32 v24, 16, v24
  v_rcp_f32 v23, v24
  s_nop 0
  v_mul_f32 v22, v22, v23
  v_sub_f32 v22, 0, v22
  s_lshl_b32 s40, s34, 8
  s_add_u32 s40, s40, 157952
  v_and_b32 v24, 31, v1
  v_lshlrev_b32 v24, 2, v24
  v_add_u32 v24, s40, v24
  ds_write_b32 v24, v22
  ds_write_b32 v24, v23 offset:128
  s_lshl_b32 s41, s36, 6
  s_add_u32 s40, s40, s41
  v_lshlrev_b32 v25, 4, v2
  v_add_u32 v25, s40, v25
  v_xor_b32 v26, 64, v25
  s_waitcnt lgkmcnt(0)
  ds_read_b128 v[136:139], v25
  ds_read_b128 v[140:143], v26
  ds_read_b128 v[144:147], v25 offset:128
  ds_read_b128 v[148:151], v26 offset:128
  s_mul_i32 s40, s33, 6
  s_mul_i32 s41, s36, 3
  s_add_u32 s40, s40, s41
  s_lshl_b32 s40, s40, 6
  s_lshl_b32 s41, s32, 1
  s_add_u32 s40, s40, s41
  s_add_u32 s40, s40, s35
  s_lshl_b32 s40, s40, 10
  s_add_u32 s40, s40, 3145728
  v_and_b32 v27, 1, v2
  v_lshlrev_b32 v27, 1, v27
  v_lshrrev_b32 v28, 1, v2
  v_or_b32 v27, v27, v28
  s_lshl_b32 s41, s36, 1
  v_xor_b32 v27, s41, v27
  v_lshlrev_b32 v27, 4, v27
  v_add_u32 v27, v27, v3
  v_lshlrev_b32 v27, 4, v27
  s_waitcnt lgkmcnt(0)
  v_lshlrev_b32 v172, 16, v116
  v_and_b32 v173, s47, v116
  v_pk_fma_f32 v[172:173], v[172:173], v[144:145], v[136:137]
  v_cvt_pk_bf16_f32 v116, v172, v173
  v_lshlrev_b32 v176, 16, v117
  v_and_b32 v177, s47, v117
  v_pk_fma_f32 v[176:177], v[176:177], v[146:147], v[138:139]
  v_cvt_pk_bf16_f32 v117, v176, v177
  v_lshlrev_b32 v172, 16, v118
  v_and_b32 v173, s47, v118
  v_pk_fma_f32 v[172:173], v[172:173], v[148:149], v[140:141]
  v_cvt_pk_bf16_f32 v118, v172, v173
  v_lshlrev_b32 v176, 16, v119
  v_and_b32 v177, s47, v119
  v_pk_fma_f32 v[176:177], v[176:177], v[150:151], v[142:143]
  v_cvt_pk_bf16_f32 v119, v176, v177
  v_permlane16_swap_b32 v116, v118
  s_nop 0
  v_permlane16_swap_b32 v117, v119
  s_add_u32 s41, s40, 0
  buffer_store_dwordx4 v[116:119], v27, s[16:19], s41 offen
  v_lshlrev_b32 v172, 16, v120
  v_and_b32 v173, s47, v120
  v_pk_fma_f32 v[172:173], v[172:173], v[144:145], v[136:137]
  v_cvt_pk_bf16_f32 v120, v172, v173
  v_lshlrev_b32 v176, 16, v121
  v_and_b32 v177, s47, v121
  v_pk_fma_f32 v[176:177], v[176:177], v[146:147], v[138:139]
  v_cvt_pk_bf16_f32 v121, v176, v177
  v_lshlrev_b32 v172, 16, v122
  v_and_b32 v173, s47, v122
  v_pk_fma_f32 v[172:173], v[172:173], v[148:149], v[140:141]
  v_cvt_pk_bf16_f32 v122, v172, v173
  v_lshlrev_b32 v176, 16, v123
  v_and_b32 v177, s47, v123
  v_pk_fma_f32 v[176:177], v[176:177], v[150:151], v[142:143]
  v_cvt_pk_bf16_f32 v123, v176, v177
  v_permlane16_swap_b32 v120, v122
  s_nop 0
  v_permlane16_swap_b32 v121, v123
  s_add_u32 s41, s40, 65536
  buffer_store_dwordx4 v[120:123], v27, s[16:19], s41 offen
  v_lshlrev_b32 v172, 16, v124
  v_and_b32 v173, s47, v124
  v_pk_fma_f32 v[172:173], v[172:173], v[144:145], v[136:137]
  v_cvt_pk_bf16_f32 v124, v172, v173
  v_lshlrev_b32 v176, 16, v125
  v_and_b32 v177, s47, v125
  v_pk_fma_f32 v[176:177], v[176:177], v[146:147], v[138:139]
  v_cvt_pk_bf16_f32 v125, v176, v177
  v_lshlrev_b32 v172, 16, v126
  v_and_b32 v173, s47, v126
  v_pk_fma_f32 v[172:173], v[172:173], v[148:149], v[140:141]
  v_cvt_pk_bf16_f32 v126, v172, v173
  v_lshlrev_b32 v176, 16, v127
  v_and_b32 v177, s47, v127
  v_pk_fma_f32 v[176:177], v[176:177], v[150:151], v[142:143]
  v_cvt_pk_bf16_f32 v127, v176, v177
  v_permlane16_swap_b32 v124, v126
  s_nop 0
  v_permlane16_swap_b32 v125, v127
  s_add_u32 s41, s40, 131072
  buffer_store_dwordx4 v[124:127], v27, s[16:19], s41 offen
K1_END:
  s_endpgm

.section .rodata,"a"
.p2align 6
.amdhsa_kernel k1_kernel
  .amdhsa_next_free_vgpr 256
  .amdhsa_next_free_sgpr 96
  .amdhsa_accum_offset 256
  .amdhsa_group_segment_fixed_size 0
  .amdhsa_kernarg_size 112
  .amdhsa_user_sgpr_count 2
  .amdhsa_user_sgpr_kernarg_segment_ptr 1
  .amdhsa_system_sgpr_workgroup_id_x 1
  .amdhsa_float_denorm_mode_32 3
.end_amdhsa_kernel
.text
.globl k2_kernel
.p2align 8
.type k2_kernel,@function
k2_kernel:
  s_cmp_ge_u32 s2, 470
  s_cbranch_scc1 K2_END
  s_cmp_ge_u32 s2, 256
  s_cbranch_scc1 K2_CONV
  s_load_dwordx4 s[36:39], s[0:1], 64
  s_load_dwordx2 s[40:41], s[0:1], 104
  v_and_b32 v1, 63, v0
  v_lshrrev_b32 v14, 6, v0
  v_lshrrev_b32 v2, 4, v1
  v_readfirstlane_b32 s22, v14
  v_and_b32 v3, 15, v1
  s_and_b32 s28, s2, 7
  s_lshr_b32 s29, s2, 3
  s_lshr_b32 s20, s28, 1
  s_lshl_b32 s20, s20, 3
  s_and_b32 s30, s29, 7
  s_add_u32 s20, s20, s30
  s_and_b32 s21, s28, 1
  s_lshl_b32 s21, s21, 2
  s_lshr_b32 s30, s29, 3
  s_add_u32 s21, s21, s30
  s_and_b32 s23, s22, 1
  s_lshr_b32 s24, s22, 1
  s_mov_b32 s32, 0xffff0000
  s_lshl_b32 s28, s20, 6
  s_lshl_b32 s29, s22, 4
  s_add_u32 s28, s28, s29
  v_add_u32 v14, 0, v2
  v_xor_b32 v15, v14, v3
  v_lshlrev_b32 v15, 4, v15
  v_add_u32 v14, s28, v14
  v_lshlrev_b32 v14, 12, v14
  v_add_u32 v4, v14, v15
  v_add_u32 v14, 4, v2
  v_xor_b32 v15, v14, v3
  v_lshlrev_b32 v15, 4, v15
  v_add_u32 v14, s28, v14
  v_lshlrev_b32 v14, 12, v14
  v_add_u32 v5, v14, v15
  v_add_u32 v14, 8, v2
  v_xor_b32 v15, v14, v3
  v_lshlrev_b32 v15, 4, v15
  v_add_u32 v14, s28, v14
  v_lshlrev_b32 v14, 12, v14
  v_add_u32 v6, v14, v15
  v_add_u32 v14, 12, v2
  v_xor_b32 v15, v14, v3
  v_lshlrev_b32 v15, 4, v15
  v_add_u32 v14, s28, v14
  v_lshlrev_b32 v14, 12, v14
  v_add_u32 v7, v14, v15
  v_xor_b32 v14, v2, v3
  v_lshlrev_b32 v14, 4, v14
  s_lshl_b32 s28, s24, 6
  v_xor_b32 v14, s28, v14
  v_lshlrev_b32 v15, 8, v3
  v_add_u32 v8, v14, v15
  v_xor_b32 v9, 128, v8
  s_mul_i32 s28, s21, 6
  s_mul_i32 s29, s23, 3
  s_add_u32 s28, s28, s29
  s_mov_b32 s31, s28
  s_mov_b32 s33, s28
  s_lshl_b32 s28, s28, 16
  s_add_u32 s28, s28, 3145728
  v_lshlrev_b32 v14, 4, v1
  s_add_u32 s29, s28, 0
  v_add_u32 v10, s29, v14
  s_add_u32 s29, s28, 65536
  v_add_u32 v11, s29, v14
  s_add_u32 s29, s28, 131072
  v_add_u32 v12, s29, v14
  s_waitcnt lgkmcnt(0)
  s_mov_b32 s8, s36
  s_and_b32 s9, s37, 0xffff
  s_mov_b32 s10, 8388608
  s_mov_b32 s11, 0x20000
  s_mov_b32 s16, s38
  s_and_b32 s17, s39, 0xffff
  s_mov_b32 s18, 4096
  s_mov_b32 s19, 0x20000
  s_mov_b32 s12, s40
  s_and_b32 s13, s41, 0xffff
  s_mov_b32 s14, 17825792
  s_mov_b32 s15, 0x20000
  s_lshl_b32 s28, s20, 2
  s_lshl_b32 s29, s24, 1
  s_add_u32 s28, s28, s29
  s_mov_b32 s34, s28
  s_mul_i32 s29, s28, 48
  s_add_u32 s29, s29, s33
  s_lshl_b32 s29, s29, 9
  s_add_u32 s29, s29, 0
  s_add_u32 s30, s29, 24576
  v_lshlrev_b32 v14, 3, v1
  buffer_load_dwordx2 v[24:25], v14, s[12:15], s29 offen offset:0
  buffer_load_dwordx2 v[26:27], v14, s[12:15], s29 offen offset:512
  buffer_load_dwordx2 v[28:29], v14, s[12:15], s29 offen offset:1024
  buffer_load_dwordx2 v[30:31], v14, s[12:15], s30 offen offset:0
  buffer_load_dwordx2 v[32:33], v14, s[12:15], s30 offen offset:512
  buffer_load_dwordx2 v[34:35], v14, s[12:15], s30 offen offset:1024
  v_lshlrev_b32 v15, 1, v3
  s_lshl_b32 s28, s28, 5
  buffer_load_ushort v36, v15, s[16:19], s28 offen
  buffer_load_ushort v37, v15, s[16:19], s28 offen offset:32
  s_lshl_b32 s31, s22, 12
  s_mov_b32 s26, 0
  s_lshl_b32 s27, s24, 10
  s_add_u32 s28, s27, 0
  buffer_load_dwordx4 v[120:123], v10, s[12:15], s28 offen
  buffer_load_dwordx4 v[124:127], v11, s[12:15], s28 offen
  buffer_load_dwordx4 v[128:131], v12, s[12:15], s28 offen
  s_add_u32 s28, s26, 0
  s_add_u32 m0, s31, 0
  s_nop 0
  buffer_load_dwordx4 v4, s[8:11], s28 offen lds
  s_add_u32 m0, s31, 1024
  s_nop 0
  buffer_load_dwordx4 v5, s[8:11], s28 offen lds
  s_add_u32 m0, s31, 2048
  s_nop 0
  buffer_load_dwordx4 v6, s[8:11], s28 offen lds
  s_add_u32 m0, s31, 3072
  s_nop 0
  buffer_load_dwordx4 v7, s[8:11], s28 offen lds
  s_add_u32 s28, s27, 2048
  buffer_load_dwordx4 v[132:135], v10, s[12:15], s28 offen
  buffer_load_dwordx4 v[136:139], v11, s[12:15], s28 offen
  buffer_load_dwordx4 v[140:143], v12, s[12:15], s28 offen
  s_add_u32 s28, s27, 4096
  buffer_load_dwordx4 v[144:147], v10, s[12:15], s28 offen
  buffer_load_dwordx4 v[148:151], v11, s[12:15], s28 offen
  buffer_load_dwordx4 v[152:155], v12, s[12:15], s28 offen
  s_add_u32 s28, s26, 256
  s_add_u32 m0, s31, 16384
  s_nop 0
  buffer_load_dwordx4 v4, s[8:11], s28 offen lds
  s_add_u32 m0, s31, 17408
  s_nop 0
  buffer_load_dwordx4 v5, s[8:11], s28 offen lds
  s_add_u32 m0, s31, 18432
  s_nop 0
  buffer_load_dwordx4 v6, s[8:11], s28 offen lds
  s_add_u32 m0, s31, 19456
  s_nop 0
  buffer_load_dwordx4 v7, s[8:11], s28 offen lds
  s_add_u32 s28, s27, 6144
  buffer_load_dwordx4 v[156:159], v10, s[12:15], s28 offen
  buffer_load_dwordx4 v[160:163], v11, s[12:15], s28 offen
  buffer_load_dwordx4 v[164:167], v12, s[12:15], s28 offen
  s_add_u32 s28, s27, 8192
  buffer_load_dwordx4 v[168:171], v10, s[12:15], s28 offen
  buffer_load_dwordx4 v[172:175], v11, s[12:15], s28 offen
  buffer_load_dwordx4 v[176:179], v12, s[12:15], s28 offen
  s_add_u32 s28, s26, 512
  s_add_u32 m0, s31, 32768
  s_nop 0
  buffer_load_dwordx4 v4, s[8:11], s28 offen lds
  s_add_u32 m0, s31, 33792
  s_nop 0
  buffer_load_dwordx4 v5, s[8:11], s28 offen lds
  s_add_u32 m0, s31, 34816
  s_nop 0
  buffer_load_dwordx4 v6, s[8:11], s28 offen lds
  s_add_u32 m0, s31, 35840
  s_nop 0
  buffer_load_dwordx4 v7, s[8:11], s28 offen lds
  s_add_u32 s28, s27, 10240
  buffer_load_dwordx4 v[180:183], v10, s[12:15], s28 offen
  buffer_load_dwordx4 v[184:187], v11, s[12:15], s28 offen
  buffer_load_dwordx4 v[188:191], v12, s[12:15], s28 offen
  s_add_u32 s28, s27, 12288
  buffer_load_dwordx4 v[192:195], v10, s[12:15], s28 offen
  buffer_load_dwordx4 v[196:199], v11, s[12:15], s28 offen
  buffer_load_dwordx4 v[200:203], v12, s[12:15], s28 offen
  s_add_u32 s28, s26, 768
  s_add_u32 m0, s31, 49152
  s_nop 0
  buffer_load_dwordx4 v4, s[8:11], s28 offen lds
  s_add_u32 m0, s31, 50176
  s_nop 0
  buffer_load_dwordx4 v5, s[8:11], s28 offen lds
  s_add_u32 m0, s31, 51200
  s_nop 0
  buffer_load_dwordx4 v6, s[8:11], s28 offen lds
  s_add_u32 m0, s31, 52224
  s_nop 0
  buffer_load_dwordx4 v7, s[8:11], s28 offen lds
  s_add_u32 s28, s27, 14336
  buffer_load_dwordx4 v[204:207], v10, s[12:15], s28 offen
  buffer_load_dwordx4 v[208:211], v11, s[12:15], s28 offen
  buffer_load_dwordx4 v[212:215], v12, s[12:15], s28 offen
  v_mov_b32 v72, 0
  v_mov_b32 v73, 0
  v_mov_b32 v74, 0
  v_mov_b32 v75, 0
  v_mov_b32 v76, 0
  v_mov_b32 v77, 0
  v_mov_b32 v78, 0
  v_mov_b32 v79, 0
  v_mov_b32 v80, 0
  v_mov_b32 v81, 0
  v_mov_b32 v82, 0
  v_mov_b32 v83, 0
  v_mov_b32 v84, 0
  v_mov_b32 v85, 0
  v_mov_b32 v86, 0
  v_mov_b32 v87, 0
  v_mov_b32 v88, 0
  v_mov_b32 v89, 0
  v_mov_b32 v90, 0
  v_mov_b32 v91, 0
  v_mov_b32 v92, 0
  v_mov_b32 v93, 0
  v_mov_b32 v94, 0
  v_mov_b32 v95, 0
  v_mov_b32 v96, 0
  v_mov_b32 v97, 0
  v_mov_b32 v98, 0
  v_mov_b32 v99, 0
  v_mov_b32 v100, 0
  v_mov_b32 v101, 0
  v_mov_b32 v102, 0
  v_mov_b32 v103, 0
  v_mov_b32 v104, 0
  v_mov_b32 v105, 0
  v_mov_b32 v106, 0
  v_mov_b32 v107, 0
  v_mov_b32 v108, 0
  v_mov_b32 v109, 0
  v_mov_b32 v110, 0
  v_mov_b32 v111, 0
  v_mov_b32 v112, 0
  v_mov_b32 v113, 0
  v_mov_b32 v114, 0
  v_mov_b32 v115, 0
  v_mov_b32 v116, 0
  v_mov_b32 v117, 0
  v_mov_b32 v118, 0
  v_mov_b32 v119, 0
  s_waitcnt vmcnt(30)
  s_barrier
  ds_read_b128 v[40:43], v8 offset:0
  ds_read_b128 v[44:47], v8 offset:4096
  ds_read_b128 v[48:51], v8 offset:8192
  ds_read_b128 v[52:55], v8 offset:12288
  s_mov_b32 s25, 0
K2_LOOP:
  s_add_u32 s28, s25, 1
  s_lshl_b32 s26, s28, 10
  s_lshl_b32 s27, s28, 14
  s_lshl_b32 s29, s24, 10
  s_add_u32 s27, s27, s29
  s_cmp_lt_u32 s25, 3
  s_cselect_b32 s26, s26, 0x80000000
  s_cselect_b32 s27, s27, 0x80000000
  ds_read_b128 v[56:59], v9 offset:0
  ds_read_b128 v[60:63], v9 offset:4096
  ds_read_b128 v[64:67], v9 offset:8192
  ds_read_b128 v[68:71], v9 offset:12288
  s_waitcnt lgkmcnt(4)
  v_mfma_f32_16x16x32_bf16 v[72:75], v[120:123], v[40:43], v[72:75]
  v_mfma_f32_16x16x32_bf16 v[76:79], v[120:123], v[44:47], v[76:79]
  v_mfma_f32_16x16x32_bf16 v[80:83], v[120:123], v[48:51], v[80:83]
  v_mfma_f32_16x16x32_bf16 v[84:87], v[120:123], v[52:55], v[84:87]
  v_mfma_f32_16x16x32_bf16 v[88:91], v[124:127], v[40:43], v[88:91]
  v_mfma_f32_16x16x32_bf16 v[92:95], v[124:127], v[44:47], v[92:95]
  v_mfma_f32_16x16x32_bf16 v[96:99], v[124:127], v[48:51], v[96:99]
  v_mfma_f32_16x16x32_bf16 v[100:103], v[124:127], v[52:55], v[100:103]
  v_mfma_f32_16x16x32_bf16 v[104:107], v[128:131], v[40:43], v[104:107]
  v_mfma_f32_16x16x32_bf16 v[108:111], v[128:131], v[44:47], v[108:111]
  v_mfma_f32_16x16x32_bf16 v[112:115], v[128:131], v[48:51], v[112:115]
  v_mfma_f32_16x16x32_bf16 v[116:119], v[128:131], v[52:55], v[116:119]
  s_add_u32 s28, s27, 0
  buffer_load_dwordx4 v[120:123], v10, s[12:15], s28 offen
  buffer_load_dwordx4 v[124:127], v11, s[12:15], s28 offen
  buffer_load_dwordx4 v[128:131], v12, s[12:15], s28 offen
  s_waitcnt vmcnt(23) lgkmcnt(0)
  s_barrier
  s_add_u32 s28, s26, 0
  s_add_u32 m0, s31, 0
  s_nop 0
  buffer_load_dwordx4 v4, s[8:11], s28 offen lds
  s_add_u32 m0, s31, 1024
  s_nop 0
  buffer_load_dwordx4 v5, s[8:11], s28 offen lds
  s_add_u32 m0, s31, 2048
  s_nop 0
  buffer_load_dwordx4 v6, s[8:11], s28 offen lds
  s_add_u32 m0, s31, 3072
  s_nop 0
  buffer_load_dwordx4 v7, s[8:11], s28 offen lds
  ds_read_b128 v[40:43], v8 offset:16384
  ds_read_b128 v[44:47], v8 offset:20480
  ds_read_b128 v[48:51], v8 offset:24576
  ds_read_b128 v[52:55], v8 offset:28672
  v_mfma_f32_16x16x32_bf16 v[72:75], v[132:135], v[56:59], v[72:75]
  v_mfma_f32_16x16x32_bf16 v[76:79], v[132:135], v[60:63], v[76:79]
  v_mfma_f32_16x16x32_bf16 v[80:83], v[132:135], v[64:67], v[80:83]
  v_mfma_f32_16x16x32_bf16 v[84:87], v[132:135], v[68:71], v[84:87]
  v_mfma_f32_16x16x32_bf16 v[88:91], v[136:139], v[56:59], v[88:91]
  v_mfma_f32_16x16x32_bf16 v[92:95], v[136:139], v[60:63], v[92:95]
  v_mfma_f32_16x16x32_bf16 v[96:99], v[136:139], v[64:67], v[96:99]
  v_mfma_f32_16x16x32_bf16 v[100:103], v[136:139], v[68:71], v[100:103]
  v_mfma_f32_16x16x32_bf16 v[104:107], v[140:143], v[56:59], v[104:107]
  v_mfma_f32_16x16x32_bf16 v[108:111], v[140:143], v[60:63], v[108:111]
  v_mfma_f32_16x16x32_bf16 v[112:115], v[140:143], v[64:67], v[112:115]
  v_mfma_f32_16x16x32_bf16 v[116:119], v[140:143], v[68:71], v[116:119]
  s_add_u32 s28, s27, 2048
  buffer_load_dwordx4 v[132:135], v10, s[12:15], s28 offen
  buffer_load_dwordx4 v[136:139], v11, s[12:15], s28 offen
  buffer_load_dwordx4 v[140:143], v12, s[12:15], s28 offen
  ds_read_b128 v[56:59], v9 offset:16384
  ds_read_b128 v[60:63], v9 offset:20480
  ds_read_b128 v[64:67], v9 offset:24576
  ds_read_b128 v[68:71], v9 offset:28672
  s_waitcnt lgkmcnt(4)
  v_mfma_f32_16x16x32_bf16 v[72:75], v[144:147], v[40:43], v[72:75]
  v_mfma_f32_16x16x32_bf16 v[76:79], v[144:147], v[44:47], v[76:79]
  v_mfma_f32_16x16x32_bf16 v[80:83], v[144:147], v[48:51], v[80:83]
  v_mfma_f32_16x16x32_bf16 v[84:87], v[144:147], v[52:55], v[84:87]
  v_mfma_f32_16x16x32_bf16 v[88:91], v[148:151], v[40:43], v[88:91]
  v_mfma_f32_16x16x32_bf16 v[92:95], v[148:151], v[44:47], v[92:95]
  v_mfma_f32_16x16x32_bf16 v[96:99], v[148:151], v[48:51], v[96:99]
  v_mfma_f32_16x16x32_bf16 v[100:103], v[148:151], v[52:55], v[100:103]
  v_mfma_f32_16x16x32_bf16 v[104:107], v[152:155], v[40:43], v[104:107]
  v_mfma_f32_16x16x32_bf16 v[108:111], v[152:155], v[44:47], v[108:111]
  v_mfma_f32_16x16x32_bf16 v[112:115], v[152:155], v[48:51], v[112:115]
  v_mfma_f32_16x16x32_bf16 v[116:119], v[152:155], v[52:55], v[116:119]
  s_add_u32 s28, s27, 4096
  buffer_load_dwordx4 v[144:147], v10, s[12:15], s28 offen
  buffer_load_dwordx4 v[148:151], v11, s[12:15], s28 offen
  buffer_load_dwordx4 v[152:155], v12, s[12:15], s28 offen
  s_waitcnt vmcnt(23) lgkmcnt(0)
  s_barrier
  s_add_u32 s28, s26, 256
  s_add_u32 m0, s31, 16384
  s_nop 0
  buffer_load_dwordx4 v4, s[8:11], s28 offen lds
  s_add_u32 m0, s31, 17408
  s_nop 0
  buffer_load_dwordx4 v5, s[8:11], s28 offen lds
  s_add_u32 m0, s31, 18432
  s_nop 0
  buffer_load_dwordx4 v6, s[8:11], s28 offen lds
  s_add_u32 m0, s31, 19456
  s_nop 0
  buffer_load_dwordx4 v7, s[8:11], s28 offen lds
  ds_read_b128 v[40:43], v8 offset:32768
  ds_read_b128 v[44:47], v8 offset:36864
  ds_read_b128 v[48:51], v8 offset:40960
  ds_read_b128 v[52:55], v8 offset:45056
  v_mfma_f32_16x16x32_bf16 v[72:75], v[156:159], v[56:59], v[72:75]
  v_mfma_f32_16x16x32_bf16 v[76:79], v[156:159], v[60:63], v[76:79]
  v_mfma_f32_16x16x32_bf16 v[80:83], v[156:159], v[64:67], v[80:83]
  v_mfma_f32_16x16x32_bf16 v[84:87], v[156:159], v[68:71], v[84:87]
  v_mfma_f32_16x16x32_bf16 v[88:91], v[160:163], v[56:59], v[88:91]
  v_mfma_f32_16x16x32_bf16 v[92:95], v[160:163], v[60:63], v[92:95]
  v_mfma_f32_16x16x32_bf16 v[96:99], v[160:163], v[64:67], v[96:99]
  v_mfma_f32_16x16x32_bf16 v[100:103], v[160:163], v[68:71], v[100:103]
  v_mfma_f32_16x16x32_bf16 v[104:107], v[164:167], v[56:59], v[104:107]
  v_mfma_f32_16x16x32_bf16 v[108:111], v[164:167], v[60:63], v[108:111]
  v_mfma_f32_16x16x32_bf16 v[112:115], v[164:167], v[64:67], v[112:115]
  v_mfma_f32_16x16x32_bf16 v[116:119], v[164:167], v[68:71], v[116:119]
  s_add_u32 s28, s27, 6144
  buffer_load_dwordx4 v[156:159], v10, s[12:15], s28 offen
  buffer_load_dwordx4 v[160:163], v11, s[12:15], s28 offen
  buffer_load_dwordx4 v[164:167], v12, s[12:15], s28 offen
  ds_read_b128 v[56:59], v9 offset:32768
  ds_read_b128 v[60:63], v9 offset:36864
  ds_read_b128 v[64:67], v9 offset:40960
  ds_read_b128 v[68:71], v9 offset:45056
  s_waitcnt lgkmcnt(4)
  v_mfma_f32_16x16x32_bf16 v[72:75], v[168:171], v[40:43], v[72:75]
  v_mfma_f32_16x16x32_bf16 v[76:79], v[168:171], v[44:47], v[76:79]
  v_mfma_f32_16x16x32_bf16 v[80:83], v[168:171], v[48:51], v[80:83]
  v_mfma_f32_16x16x32_bf16 v[84:87], v[168:171], v[52:55], v[84:87]
  v_mfma_f32_16x16x32_bf16 v[88:91], v[172:175], v[40:43], v[88:91]
  v_mfma_f32_16x16x32_bf16 v[92:95], v[172:175], v[44:47], v[92:95]
  v_mfma_f32_16x16x32_bf16 v[96:99], v[172:175], v[48:51], v[96:99]
  v_mfma_f32_16x16x32_bf16 v[100:103], v[172:175], v[52:55], v[100:103]
  v_mfma_f32_16x16x32_bf16 v[104:107], v[176:179], v[40:43], v[104:107]
  v_mfma_f32_16x16x32_bf16 v[108:111], v[176:179], v[44:47], v[108:111]
  v_mfma_f32_16x16x32_bf16 v[112:115], v[176:179], v[48:51], v[112:115]
  v_mfma_f32_16x16x32_bf16 v[116:119], v[176:179], v[52:55], v[116:119]
  s_add_u32 s28, s27, 8192
  buffer_load_dwordx4 v[168:171], v10, s[12:15], s28 offen
  buffer_load_dwordx4 v[172:175], v11, s[12:15], s28 offen
  buffer_load_dwordx4 v[176:179], v12, s[12:15], s28 offen
  s_waitcnt vmcnt(23) lgkmcnt(0)
  s_barrier
  s_add_u32 s28, s26, 512
  s_add_u32 m0, s31, 32768
  s_nop 0
  buffer_load_dwordx4 v4, s[8:11], s28 offen lds
  s_add_u32 m0, s31, 33792
  s_nop 0
  buffer_load_dwordx4 v5, s[8:11], s28 offen lds
  s_add_u32 m0, s31, 34816
  s_nop 0
  buffer_load_dwordx4 v6, s[8:11], s28 offen lds
  s_add_u32 m0, s31, 35840
  s_nop 0
  buffer_load_dwordx4 v7, s[8:11], s28 offen lds
  ds_read_b128 v[40:43], v8 offset:49152
  ds_read_b128 v[44:47], v8 offset:53248
  ds_read_b128 v[48:51], v8 offset:57344
  ds_read_b128 v[52:55], v8 offset:61440
  v_mfma_f32_16x16x32_bf16 v[72:75], v[180:183], v[56:59], v[72:75]
  v_mfma_f32_16x16x32_bf16 v[76:79], v[180:183], v[60:63], v[76:79]
  v_mfma_f32_16x16x32_bf16 v[80:83], v[180:183], v[64:67], v[80:83]
  v_mfma_f32_16x16x32_bf16 v[84:87], v[180:183], v[68:71], v[84:87]
  v_mfma_f32_16x16x32_bf16 v[88:91], v[184:187], v[56:59], v[88:91]
  v_mfma_f32_16x16x32_bf16 v[92:95], v[184:187], v[60:63], v[92:95]
  v_mfma_f32_16x16x32_bf16 v[96:99], v[184:187], v[64:67], v[96:99]
  v_mfma_f32_16x16x32_bf16 v[100:103], v[184:187], v[68:71], v[100:103]
  v_mfma_f32_16x16x32_bf16 v[104:107], v[188:191], v[56:59], v[104:107]
  v_mfma_f32_16x16x32_bf16 v[108:111], v[188:191], v[60:63], v[108:111]
  v_mfma_f32_16x16x32_bf16 v[112:115], v[188:191], v[64:67], v[112:115]
  v_mfma_f32_16x16x32_bf16 v[116:119], v[188:191], v[68:71], v[116:119]
  s_add_u32 s28, s27, 10240
  buffer_load_dwordx4 v[180:183], v10, s[12:15], s28 offen
  buffer_load_dwordx4 v[184:187], v11, s[12:15], s28 offen
  buffer_load_dwordx4 v[188:191], v12, s[12:15], s28 offen
  ds_read_b128 v[56:59], v9 offset:49152
  ds_read_b128 v[60:63], v9 offset:53248
  ds_read_b128 v[64:67], v9 offset:57344
  ds_read_b128 v[68:71], v9 offset:61440
  s_waitcnt lgkmcnt(4)
  v_mfma_f32_16x16x32_bf16 v[72:75], v[192:195], v[40:43], v[72:75]
  v_mfma_f32_16x16x32_bf16 v[76:79], v[192:195], v[44:47], v[76:79]
  v_mfma_f32_16x16x32_bf16 v[80:83], v[192:195], v[48:51], v[80:83]
  v_mfma_f32_16x16x32_bf16 v[84:87], v[192:195], v[52:55], v[84:87]
  v_mfma_f32_16x16x32_bf16 v[88:91], v[196:199], v[40:43], v[88:91]
  v_mfma_f32_16x16x32_bf16 v[92:95], v[196:199], v[44:47], v[92:95]
  v_mfma_f32_16x16x32_bf16 v[96:99], v[196:199], v[48:51], v[96:99]
  v_mfma_f32_16x16x32_bf16 v[100:103], v[196:199], v[52:55], v[100:103]
  v_mfma_f32_16x16x32_bf16 v[104:107], v[200:203], v[40:43], v[104:107]
  v_mfma_f32_16x16x32_bf16 v[108:111], v[200:203], v[44:47], v[108:111]
  v_mfma_f32_16x16x32_bf16 v[112:115], v[200:203], v[48:51], v[112:115]
  v_mfma_f32_16x16x32_bf16 v[116:119], v[200:203], v[52:55], v[116:119]
  s_add_u32 s28, s27, 12288
  buffer_load_dwordx4 v[192:195], v10, s[12:15], s28 offen
  buffer_load_dwordx4 v[196:199], v11, s[12:15], s28 offen
  buffer_load_dwordx4 v[200:203], v12, s[12:15], s28 offen
  s_waitcnt vmcnt(23) lgkmcnt(0)
  s_barrier
  s_add_u32 s28, s26, 768
  s_add_u32 m0, s31, 49152
  s_nop 0
  buffer_load_dwordx4 v4, s[8:11], s28 offen lds
  s_add_u32 m0, s31, 50176
  s_nop 0
  buffer_load_dwordx4 v5, s[8:11], s28 offen lds
  s_add_u32 m0, s31, 51200
  s_nop 0
  buffer_load_dwordx4 v6, s[8:11], s28 offen lds
  s_add_u32 m0, s31, 52224
  s_nop 0
  buffer_load_dwordx4 v7, s[8:11], s28 offen lds
  ds_read_b128 v[40:43], v8 offset:0
  ds_read_b128 v[44:47], v8 offset:4096
  ds_read_b128 v[48:51], v8 offset:8192
  ds_read_b128 v[52:55], v8 offset:12288
  v_mfma_f32_16x16x32_bf16 v[72:75], v[204:207], v[56:59], v[72:75]
  v_mfma_f32_16x16x32_bf16 v[76:79], v[204:207], v[60:63], v[76:79]
  v_mfma_f32_16x16x32_bf16 v[80:83], v[204:207], v[64:67], v[80:83]
  v_mfma_f32_16x16x32_bf16 v[84:87], v[204:207], v[68:71], v[84:87]
  v_mfma_f32_16x16x32_bf16 v[88:91], v[208:211], v[56:59], v[88:91]
  v_mfma_f32_16x16x32_bf16 v[92:95], v[208:211], v[60:63], v[92:95]
  v_mfma_f32_16x16x32_bf16 v[96:99], v[208:211], v[64:67], v[96:99]
  v_mfma_f32_16x16x32_bf16 v[100:103], v[208:211], v[68:71], v[100:103]
  v_mfma_f32_16x16x32_bf16 v[104:107], v[212:215], v[56:59], v[104:107]
  v_mfma_f32_16x16x32_bf16 v[108:111], v[212:215], v[60:63], v[108:111]
  v_mfma_f32_16x16x32_bf16 v[112:115], v[212:215], v[64:67], v[112:115]
  v_mfma_f32_16x16x32_bf16 v[116:119], v[212:215], v[68:71], v[116:119]
  s_add_u32 s28, s27, 14336
  buffer_load_dwordx4 v[204:207], v10, s[12:15], s28 offen
  buffer_load_dwordx4 v[208:211], v11, s[12:15], s28 offen
  buffer_load_dwordx4 v[212:215], v12, s[12:15], s28 offen
  s_add_u32 s25, s25, 1
  s_cmp_lt_u32 s25, 4
  s_cbranch_scc1 K2_LOOP
  s_waitcnt vmcnt(0) lgkmcnt(0)
  s_barrier
  s_mul_i32 s28, s22, 6144
  v_lshlrev_b32 v14, 4, v1
  v_add_u32 v15, s28, v14
  s_xor_b32 s29, s22, 2
  s_mul_i32 s29, s29, 6144
  v_add_u32 v16, s29, v14
  s_cmp_eq_u32 s24, 0
  s_cbranch_scc0 K2_KH1
  ds_write_b128 v15, v[80:83] offset:0
  ds_write_b128 v15, v[84:87] offset:1024
  ds_write_b128 v15, v[96:99] offset:2048
  ds_write_b128 v15, v[100:103] offset:3072
  ds_write_b128 v15, v[112:115] offset:4096
  ds_write_b128 v15, v[116:119] offset:5120
  v_mov_b32 v120, v72
  v_mov_b32 v121, v73
  v_mov_b32 v122, v74
  v_mov_b32 v123, v75
  v_mov_b32 v124, v76
  v_mov_b32 v125, v77
  v_mov_b32 v126, v78
  v_mov_b32 v127, v79
  v_mov_b32 v128, v88
  v_mov_b32 v129, v89
  v_mov_b32 v130, v90
  v_mov_b32 v131, v91
  v_mov_b32 v132, v92
  v_mov_b32 v133, v93
  v_mov_b32 v134, v94
  v_mov_b32 v135, v95
  v_mov_b32 v136, v104
  v_mov_b32 v137, v105
  v_mov_b32 v138, v106
  v_mov_b32 v139, v107
  v_mov_b32 v140, v108
  v_mov_b32 v141, v109
  v_mov_b32 v142, v110
  v_mov_b32 v143, v111
  s_branch K2_KHD
K2_KH1:
  ds_write_b128 v15, v[72:75] offset:0
  ds_write_b128 v15, v[76:79] offset:1024
  ds_write_b128 v15, v[88:91] offset:2048
  ds_write_b128 v15, v[92:95] offset:3072
  ds_write_b128 v15, v[104:107] offset:4096
  ds_write_b128 v15, v[108:111] offset:5120
  v_mov_b32 v120, v80
  v_mov_b32 v121, v81
  v_mov_b32 v122, v82
  v_mov_b32 v123, v83
  v_mov_b32 v124, v84
  v_mov_b32 v125, v85
  v_mov_b32 v126, v86
  v_mov_b32 v127, v87
  v_mov_b32 v128, v96
  v_mov_b32 v129, v97
  v_mov_b32 v130, v98
  v_mov_b32 v131, v99
  v_mov_b32 v132, v100
  v_mov_b32 v133, v101
  v_mov_b32 v134, v102
  v_mov_b32 v135, v103
  v_mov_b32 v136, v112
  v_mov_b32 v137, v113
  v_mov_b32 v138, v114
  v_mov_b32 v139, v115
  v_mov_b32 v140, v116
  v_mov_b32 v141, v117
  v_mov_b32 v142, v118
  v_mov_b32 v143, v119
K2_KHD:
  s_waitcnt lgkmcnt(0)
  s_barrier
  ds_read_b128 v[40:43], v16 offset:0
  ds_read_b128 v[44:47], v16 offset:1024
  ds_read_b128 v[48:51], v16 offset:2048
  ds_read_b128 v[52:55], v16 offset:3072
  ds_read_b128 v[56:59], v16 offset:4096
  ds_read_b128 v[60:63], v16 offset:5120
  v_lshlrev_b32 v18, 16, v36
  v_lshlrev_b32 v20, 16, v37
  v_lshlrev_b32 v22, 4, v1
  s_waitcnt lgkmcnt(0)
  s_add_u32 s28, s33, 0
  s_lshr_b32 s29, s28, 1
  s_and_b32 s28, s28, 1
  s_lshl_b32 s28, s28, 3
  s_lshl_b32 s29, s29, 10
  s_add_u32 s28, s28, s29
  s_mul_i32 s29, s34, 24576
  s_add_u32 s28, s28, s29
  s_add_u32 s28, s28, 12582912
  s_add_u32 s29, s28, 24576
  v_pk_add_f32 v[120:121], v[120:121], v[40:41]
  v_pk_add_f32 v[120:121], v[120:121], v[18:19] op_sel_hi:[1,0]
  v_lshlrev_b32 v40, 16, v24
  v_and_b32 v41, s32, v24
  v_pk_mul_f32 v[120:121], v[120:121], v[40:41]
  v_cvt_pk_bf16_f32 v24, v120, v121
  v_pk_add_f32 v[122:123], v[122:123], v[42:43]
  v_pk_add_f32 v[122:123], v[122:123], v[18:19] op_sel_hi:[1,0]
  v_lshlrev_b32 v42, 16, v25
  v_and_b32 v43, s32, v25
  v_pk_mul_f32 v[122:123], v[122:123], v[42:43]
  v_cvt_pk_bf16_f32 v25, v122, v123
  buffer_store_dwordx2 v[24:25], v22, s[12:15], s28 offen
  v_pk_add_f32 v[124:125], v[124:125], v[44:45]
  v_pk_add_f32 v[124:125], v[124:125], v[20:21] op_sel_hi:[1,0]
  v_lshlrev_b32 v44, 16, v30
  v_and_b32 v45, s32, v30
  v_pk_mul_f32 v[124:125], v[124:125], v[44:45]
  v_cvt_pk_bf16_f32 v30, v124, v125
  v_pk_add_f32 v[126:127], v[126:127], v[46:47]
  v_pk_add_f32 v[126:127], v[126:127], v[20:21] op_sel_hi:[1,0]
  v_lshlrev_b32 v46, 16, v31
  v_and_b32 v47, s32, v31
  v_pk_mul_f32 v[126:127], v[126:127], v[46:47]
  v_cvt_pk_bf16_f32 v31, v126, v127
  buffer_store_dwordx2 v[30:31], v22, s[12:15], s29 offen
  s_add_u32 s28, s33, 1
  s_lshr_b32 s29, s28, 1
  s_and_b32 s28, s28, 1
  s_lshl_b32 s28, s28, 3
  s_lshl_b32 s29, s29, 10
  s_add_u32 s28, s28, s29
  s_mul_i32 s29, s34, 24576
  s_add_u32 s28, s28, s29
  s_add_u32 s28, s28, 12582912
  s_add_u32 s29, s28, 24576
  v_pk_add_f32 v[128:129], v[128:129], v[48:49]
  v_pk_add_f32 v[128:129], v[128:129], v[18:19] op_sel_hi:[1,0]
  v_lshlrev_b32 v48, 16, v26
  v_and_b32 v49, s32, v26
  v_pk_mul_f32 v[128:129], v[128:129], v[48:49]
  v_cvt_pk_bf16_f32 v26, v128, v129
  v_pk_add_f32 v[130:131], v[130:131], v[50:51]
  v_pk_add_f32 v[130:131], v[130:131], v[18:19] op_sel_hi:[1,0]
  v_lshlrev_b32 v50, 16, v27
  v_and_b32 v51, s32, v27
  v_pk_mul_f32 v[130:131], v[130:131], v[50:51]
  v_cvt_pk_bf16_f32 v27, v130, v131
  buffer_store_dwordx2 v[26:27], v22, s[12:15], s28 offen
  v_pk_add_f32 v[132:133], v[132:133], v[52:53]
  v_pk_add_f32 v[132:133], v[132:133], v[20:21] op_sel_hi:[1,0]
  v_lshlrev_b32 v52, 16, v32
  v_and_b32 v53, s32, v32
  v_pk_mul_f32 v[132:133], v[132:133], v[52:53]
  v_cvt_pk_bf16_f32 v32, v132, v133
  v_pk_add_f32 v[134:135], v[134:135], v[54:55]
  v_pk_add_f32 v[134:135], v[134:135], v[20:21] op_sel_hi:[1,0]
  v_lshlrev_b32 v54, 16, v33
  v_and_b32 v55, s32, v33
  v_pk_mul_f32 v[134:135], v[134:135], v[54:55]
  v_cvt_pk_bf16_f32 v33, v134, v135
  buffer_store_dwordx2 v[32:33], v22, s[12:15], s29 offen
  s_add_u32 s28, s33, 2
  s_lshr_b32 s29, s28, 1
  s_and_b32 s28, s28, 1
  s_lshl_b32 s28, s28, 3
  s_lshl_b32 s29, s29, 10
  s_add_u32 s28, s28, s29
  s_mul_i32 s29, s34, 24576
  s_add_u32 s28, s28, s29
  s_add_u32 s28, s28, 12582912
  s_add_u32 s29, s28, 24576
  v_pk_add_f32 v[136:137], v[136:137], v[56:57]
  v_pk_add_f32 v[136:137], v[136:137], v[18:19] op_sel_hi:[1,0]
  v_lshlrev_b32 v56, 16, v28
  v_and_b32 v57, s32, v28
  v_pk_mul_f32 v[136:137], v[136:137], v[56:57]
  v_cvt_pk_bf16_f32 v28, v136, v137
  v_pk_add_f32 v[138:139], v[138:139], v[58:59]
  v_pk_add_f32 v[138:139], v[138:139], v[18:19] op_sel_hi:[1,0]
  v_lshlrev_b32 v58, 16, v29
  v_and_b32 v59, s32, v29
  v_pk_mul_f32 v[138:139], v[138:139], v[58:59]
  v_cvt_pk_bf16_f32 v29, v138, v139
  buffer_store_dwordx2 v[28:29], v22, s[12:15], s28 offen
  v_pk_add_f32 v[140:141], v[140:141], v[60:61]
  v_pk_add_f32 v[140:141], v[140:141], v[20:21] op_sel_hi:[1,0]
  v_lshlrev_b32 v60, 16, v34
  v_and_b32 v61, s32, v34
  v_pk_mul_f32 v[140:141], v[140:141], v[60:61]
  v_cvt_pk_bf16_f32 v34, v140, v141
  v_pk_add_f32 v[142:143], v[142:143], v[62:63]
  v_pk_add_f32 v[142:143], v[142:143], v[20:21] op_sel_hi:[1,0]
  v_lshlrev_b32 v62, 16, v35
  v_and_b32 v63, s32, v35
  v_pk_mul_f32 v[142:143], v[142:143], v[62:63]
  v_cvt_pk_bf16_f32 v35, v142, v143
  buffer_store_dwordx2 v[34:35], v22, s[12:15], s29 offen
  s_endpgm
K2_CONV:
  v_lshrrev_b32 v6, 6, v0
  v_and_b32 v1, 63, v0
  v_readfirstlane_b32 s20, v6
  s_sub_u32 s23, s2, 256
  s_mul_i32 s21, s23, 3
  s_add_u32 s21, s21, s20
  s_cmp_ge_u32 s20, 3
  s_cbranch_scc1 K2_END
  s_cmp_ge_u32 s21, 640
  s_cbranch_scc1 K2_END
  s_load_dwordx4 s[36:39], s[0:1], 32
  s_load_dwordx2 s[40:41], s[0:1], 104
  v_lshrrev_b32 v2, 4, v1
  v_and_b32 v3, 15, v1
  s_mul_i32 s22, s20, 21248
  s_mov_b32 s26, 0xffff0000
  s_mov_b64 s[28:29], exec
  s_waitcnt lgkmcnt(0)
  s_lshl_b32 s23, s21, 12
  s_add_u32 s8, s36, s23
  s_addc_u32 s9, s37, 0
  s_and_b32 s9, s9, 0xffff
  s_mov_b32 s10, 4096
  s_mov_b32 s11, 0x20000
  s_mov_b32 s12, s40
  s_and_b32 s13, s41, 0xffff
  s_mov_b32 s14, 17825792
  s_mov_b32 s15, 0x20000
  s_mov_b32 s16, s38
  s_and_b32 s17, s39, 0xffff
  s_mov_b32 s18, 1280
  s_mov_b32 s19, 0x20000
  v_lshlrev_b32 v6, 4, v1
  s_lshl_b32 s23, s21, 12
  s_add_u32 s23, s23, 6291456
  s_add_u32 m0, s22, 17152
  s_add_u32 s24, s23, 0
  buffer_load_dwordx4 v6, s[12:15], s24 offen lds
  s_add_u32 m0, s22, 18176
  s_add_u32 s24, s23, 1024
  buffer_load_dwordx4 v6, s[12:15], s24 offen lds
  s_add_u32 m0, s22, 19200
  s_add_u32 s24, s23, 2048
  buffer_load_dwordx4 v6, s[12:15], s24 offen lds
  s_add_u32 m0, s22, 20224
  s_add_u32 s24, s23, 3072
  buffer_load_dwordx4 v6, s[12:15], s24 offen lds
  buffer_load_dwordx4 v[16:19], v6, s[8:11], 0 offen offset:0
  buffer_load_dwordx2 v[20:21], v6, s[8:11], 0 offen offset:16
  buffer_load_dwordx4 v[22:25], v6, s[8:11], 0 offen offset:1024
  buffer_load_dwordx2 v[26:27], v6, s[8:11], 0 offen offset:1040
  buffer_load_dwordx4 v[28:31], v6, s[8:11], 0 offen offset:2048
  buffer_load_dwordx2 v[32:33], v6, s[8:11], 0 offen offset:2064
  buffer_load_dwordx4 v[34:37], v6, s[8:11], 0 offen offset:3072
  buffer_load_dwordx2 v[38:39], v6, s[8:11], 0 offen offset:3088
  v_mov_b32 v7, 0
  buffer_load_dwordx2 v[44:45], v7, s[8:11], 0 offen
  s_lshl_b32 s23, s21, 1
  buffer_load_ushort v46, v7, s[16:19], s23 offen
  v_mov_b32 v8, 0
  v_mov_b32 v9, 0
  v_lshlrev_b32 v10, 3, v1
  v_add_u32 v10, s22, v10
  ds_write_b64 v10, v[8:9] offset:16640
  v_add_u32 v10, 1, v3
  v_and_b32 v10, 3, v10
  v_lshrrev_b32 v11, 1, v2
  v_and_b32 v12, 1, v2
  v_lshlrev_b32 v13, 4, v11
  v_add_u32 v13, v13, v3
  v_lshlrev_b32 v14, 3, v12
  v_sub_u32 v13, v13, v14
  v_add_u32 v13, 9, v13
  v_sub_u32 v13, v13, v10
  v_lshlrev_b32 v13, 1, v13
  v_mul_u32_u24 v10, 4160, v10
  v_add_u32 v13, v13, v10
  v_add_u32 v4, s22, v13
  v_sub_u32 v13, v3, v11
  v_lshlrev_b32 v13, 1, v13
  v_add_u32 v13, v13, v12
  v_lshlrev_b32 v13, 4, v13
  s_add_u32 s23, s22, 17152
  v_add_u32 v5, s23, v13
  v_lshlrev_b32 v10, 4, v1
  v_add_u32 v10, s22, v10
  s_waitcnt vmcnt(0)
  v_alignbit_b32 v80, v17, v16, 16
  v_alignbit_b32 v81, v18, v17, 16
  v_alignbit_b32 v82, v19, v18, 16
  v_alignbit_b32 v83, v20, v19, 16
  v_mov_b32 v84, v17
  v_mov_b32 v85, v18
  v_mov_b32 v86, v19
  v_mov_b32 v87, v20
  v_mov_b32 v88, v81
  v_mov_b32 v89, v82
  v_mov_b32 v90, v83
  v_alignbit_b32 v91, v21, v20, 16
  ds_write_b128 v10, v[16:19] offset:32
  ds_write_b128 v10, v[80:83] offset:4192
  ds_write_b128 v10, v[84:87] offset:8352
  ds_write_b128 v10, v[88:91] offset:12512
  s_waitcnt lgkmcnt(4)
  v_alignbit_b32 v92, v23, v22, 16
  v_alignbit_b32 v93, v24, v23, 16
  v_alignbit_b32 v94, v25, v24, 16
  v_alignbit_b32 v95, v26, v25, 16
  v_mov_b32 v96, v23
  v_mov_b32 v97, v24
  v_mov_b32 v98, v25
  v_mov_b32 v99, v26
  v_mov_b32 v100, v93
  v_mov_b32 v101, v94
  v_mov_b32 v102, v95
  v_alignbit_b32 v103, v27, v26, 16
  ds_write_b128 v10, v[22:25] offset:1056
  ds_write_b128 v10, v[92:95] offset:5216
  ds_write_b128 v10, v[96:99] offset:9376
  ds_write_b128 v10, v[100:103] offset:13536
  s_waitcnt lgkmcnt(4)
  v_alignbit_b32 v104, v29, v28, 16
  v_alignbit_b32 v105, v30, v29, 16
  v_alignbit_b32 v106, v31, v30, 16
  v_alignbit_b32 v107, v32, v31, 16
  v_mov_b32 v108, v29
  v_mov_b32 v109, v30
  v_mov_b32 v110, v31
  v_mov_b32 v111, v32
  v_mov_b32 v112, v105
  v_mov_b32 v113, v106
  v_mov_b32 v114, v107
  v_alignbit_b32 v115, v33, v32, 16
  ds_write_b128 v10, v[28:31] offset:2080
  ds_write_b128 v10, v[104:107] offset:6240
  ds_write_b128 v10, v[108:111] offset:10400
  ds_write_b128 v10, v[112:115] offset:14560
  s_waitcnt lgkmcnt(4)
  v_alignbit_b32 v116, v35, v34, 16
  v_alignbit_b32 v117, v36, v35, 16
  v_alignbit_b32 v118, v37, v36, 16
  v_alignbit_b32 v119, v38, v37, 16
  v_mov_b32 v120, v35
  v_mov_b32 v121, v36
  v_mov_b32 v122, v37
  v_mov_b32 v123, v38
  v_mov_b32 v124, v117
  v_mov_b32 v125, v118
  v_mov_b32 v126, v119
  v_alignbit_b32 v127, v39, v38, 16
  ds_write_b128 v10, v[34:37] offset:3104
  ds_write_b128 v10, v[116:119] offset:7264
  ds_write_b128 v10, v[120:123] offset:11424
  ds_write_b128 v10, v[124:127] offset:15584
  s_waitcnt lgkmcnt(4)
  v_mov_b32 v40, 0
  v_mov_b32 v41, 0
  v_mov_b32 v42, 0
  v_mov_b32 v43, 0
  v_cmp_eq_u32 vcc, 1, v1
  s_nop 1
  v_cndmask_b32 v44, 0, v44, vcc
  v_cndmask_b32 v45, 0, v45, vcc
  s_mov_b32 exec_lo, 0x3
  s_mov_b32 exec_hi, 0x0
  v_alignbit_b32 v128, v41, v40, 16
  v_alignbit_b32 v129, v42, v41, 16
  v_alignbit_b32 v130, v43, v42, 16
  v_alignbit_b32 v131, v44, v43, 16
  v_mov_b32 v132, v41
  v_mov_b32 v133, v42
  v_mov_b32 v134, v43
  v_mov_b32 v135, v44
  v_mov_b32 v136, v129
  v_mov_b32 v137, v130
  v_mov_b32 v138, v131
  v_alignbit_b32 v139, v45, v44, 16
  ds_write_b128 v10, v[40:43] offset:0
  ds_write_b128 v10, v[128:131] offset:4160
  ds_write_b128 v10, v[132:135] offset:8320
  ds_write_b128 v10, v[136:139] offset:12480
  s_mov_b64 exec, s[28:29]
  v_lshlrev_b32 v46, 16, v46
  v_mov_b32 v48, 0
  v_mov_b32 v49, 0
  v_mov_b32 v50, 0
  v_mov_b32 v51, 0
  v_mov_b32 v52, 0
  v_mov_b32 v53, 0
  v_mov_b32 v54, 0
  v_mov_b32 v55, 0
  v_mov_b32 v56, 0
  v_mov_b32 v57, 0
  v_mov_b32 v58, 0
  v_mov_b32 v59, 0
  v_mov_b32 v60, 0
  v_mov_b32 v61, 0
  v_mov_b32 v62, 0
  v_mov_b32 v63, 0
  v_mov_b32 v64, 0
  v_mov_b32 v65, 0
  v_mov_b32 v66, 0
  v_mov_b32 v67, 0
  v_mov_b32 v68, 0
  v_mov_b32 v69, 0
  v_mov_b32 v70, 0
  v_mov_b32 v71, 0
  v_mov_b32 v72, 0
  v_mov_b32 v73, 0
  v_mov_b32 v74, 0
  v_mov_b32 v75, 0
  v_mov_b32 v76, 0
  v_mov_b32 v77, 0
  v_mov_b32 v78, 0
  v_mov_b32 v79, 0
  s_waitcnt lgkmcnt(0)
  ds_read_b64 v[80:81], v4 offset:0
  ds_read_b64 v[82:83], v4 offset:8
  ds_read_b128 v[144:147], v5 offset:0
  ds_read_b64 v[84:85], v4 offset:512
  ds_read_b64 v[86:87], v4 offset:520
  ds_read_b128 v[148:151], v5 offset:512
  ds_read_b64 v[88:89], v4 offset:1024
  ds_read_b64 v[90:91], v4 offset:1032
  s_waitcnt lgkmcnt(7)
  ds_read_b128 v[152:155], v5 offset:1024
  ds_read_b64 v[92:93], v4 offset:1536
  ds_read_b64 v[94:95], v4 offset:1544
  ds_read_b128 v[156:159], v5 offset:1536
  ds_read_b64 v[96:97], v4 offset:2048
  ds_read_b64 v[98:99], v4 offset:2056
  ds_read_b128 v[160:163], v5 offset:2048
  ds_read_b64 v[100:101], v4 offset:2560
  s_waitcnt lgkmcnt(7)
  ds_read_b64 v[102:103], v4 offset:2568
  ds_read_b128 v[164:167], v5 offset:2560
  ds_read_b64 v[104:105], v4 offset:3072
  ds_read_b64 v[106:107], v4 offset:3080
  ds_read_b128 v[168:171], v5 offset:3072
  ds_read_b64 v[108:109], v4 offset:3584
  ds_read_b64 v[110:111], v4 offset:3592
  ds_read_b128 v[172:175], v5 offset:3584
  s_waitcnt lgkmcnt(7)
  s_mov_b32 s25, 0
K2_CLOOP:
  v_add_u32 v4, 64, v4
  v_subrev_u32 v5, 64, v5
  s_waitcnt lgkmcnt(0)
  ds_read_b64 v[112:113], v4 offset:0
  ds_read_b64 v[114:115], v4 offset:8
  ds_read_b128 v[176:179], v5 offset:0
  ds_read_b64 v[116:117], v4 offset:512
  ds_read_b64 v[118:119], v4 offset:520
  ds_read_b128 v[180:183], v5 offset:512
  ds_read_b64 v[120:121], v4 offset:1024
  ds_read_b64 v[122:123], v4 offset:1032
  v_mfma_f32_16x16x32_bf16 v[48:51], v[80:83], v[144:147], v[48:51]
  v_mfma_f32_16x16x32_bf16 v[52:55], v[80:83], v[148:151], v[52:55]
  v_mfma_f32_16x16x32_bf16 v[56:59], v[80:83], v[152:155], v[56:59]
  v_mfma_f32_16x16x32_bf16 v[60:63], v[80:83], v[156:159], v[60:63]
  v_mfma_f32_16x16x32_bf16 v[64:67], v[80:83], v[160:163], v[64:67]
  v_mfma_f32_16x16x32_bf16 v[68:71], v[80:83], v[164:167], v[68:71]
  v_mfma_f32_16x16x32_bf16 v[72:75], v[80:83], v[168:171], v[72:75]
  v_mfma_f32_16x16x32_bf16 v[76:79], v[80:83], v[172:175], v[76:79]
  v_mfma_f32_16x16x32_bf16 v[52:55], v[84:87], v[144:147], v[52:55]
  v_mfma_f32_16x16x32_bf16 v[56:59], v[84:87], v[148:151], v[56:59]
  v_mfma_f32_16x16x32_bf16 v[60:63], v[84:87], v[152:155], v[60:63]
  v_mfma_f32_16x16x32_bf16 v[64:67], v[84:87], v[156:159], v[64:67]
  s_waitcnt lgkmcnt(7)
  ds_read_b128 v[184:187], v5 offset:1024
  ds_read_b64 v[124:125], v4 offset:1536
  ds_read_b64 v[126:127], v4 offset:1544
  ds_read_b128 v[188:191], v5 offset:1536
  ds_read_b64 v[128:129], v4 offset:2048
  ds_read_b64 v[130:131], v4 offset:2056
  ds_read_b128 v[192:195], v5 offset:2048
  ds_read_b64 v[132:133], v4 offset:2560
  v_mfma_f32_16x16x32_bf16 v[68:71], v[84:87], v[160:163], v[68:71]
  v_mfma_f32_16x16x32_bf16 v[72:75], v[84:87], v[164:167], v[72:75]
  v_mfma_f32_16x16x32_bf16 v[76:79], v[84:87], v[168:171], v[76:79]
  v_mfma_f32_16x16x32_bf16 v[56:59], v[88:91], v[144:147], v[56:59]
  v_mfma_f32_16x16x32_bf16 v[60:63], v[88:91], v[148:151], v[60:63]
  v_mfma_f32_16x16x32_bf16 v[64:67], v[88:91], v[152:155], v[64:67]
  v_mfma_f32_16x16x32_bf16 v[68:71], v[88:91], v[156:159], v[68:71]
  v_mfma_f32_16x16x32_bf16 v[72:75], v[88:91], v[160:163], v[72:75]
  v_mfma_f32_16x16x32_bf16 v[76:79], v[88:91], v[164:167], v[76:79]
  v_mfma_f32_16x16x32_bf16 v[60:63], v[92:95], v[144:147], v[60:63]
  v_mfma_f32_16x16x32_bf16 v[64:67], v[92:95], v[148:151], v[64:67]
  v_mfma_f32_16x16x32_bf16 v[68:71], v[92:95], v[152:155], v[68:71]
  s_waitcnt lgkmcnt(7)
  ds_read_b64 v[134:135], v4 offset:2568
  ds_read_b128 v[196:199], v5 offset:2560
  ds_read_b64 v[136:137], v4 offset:3072
  ds_read_b64 v[138:139], v4 offset:3080
  ds_read_b128 v[200:203], v5 offset:3072
  ds_read_b64 v[140:141], v4 offset:3584
  ds_read_b64 v[142:143], v4 offset:3592
  ds_read_b128 v[204:207], v5 offset:3584
  v_mfma_f32_16x16x32_bf16 v[72:75], v[92:95], v[156:159], v[72:75]
  v_mfma_f32_16x16x32_bf16 v[76:79], v[92:95], v[160:163], v[76:79]
  v_mfma_f32_16x16x32_bf16 v[64:67], v[96:99], v[144:147], v[64:67]
  v_mfma_f32_16x16x32_bf16 v[68:71], v[96:99], v[148:151], v[68:71]
  v_mfma_f32_16x16x32_bf16 v[72:75], v[96:99], v[152:155], v[72:75]
  v_mfma_f32_16x16x32_bf16 v[76:79], v[96:99], v[156:159], v[76:79]
  v_mfma_f32_16x16x32_bf16 v[68:71], v[100:103], v[144:147], v[68:71]
  v_mfma_f32_16x16x32_bf16 v[72:75], v[100:103], v[148:151], v[72:75]
  v_mfma_f32_16x16x32_bf16 v[76:79], v[100:103], v[152:155], v[76:79]
  v_mfma_f32_16x16x32_bf16 v[72:75], v[104:107], v[144:147], v[72:75]
  v_mfma_f32_16x16x32_bf16 v[76:79], v[104:107], v[148:151], v[76:79]
  v_mfma_f32_16x16x32_bf16 v[76:79], v[108:111], v[144:147], v[76:79]
  v_add_u32 v4, 64, v4
  v_subrev_u32 v5, 64, v5
  s_waitcnt lgkmcnt(0)
  ds_read_b64 v[80:81], v4 offset:0
  ds_read_b64 v[82:83], v4 offset:8
  ds_read_b128 v[144:147], v5 offset:0
  ds_read_b64 v[84:85], v4 offset:512
  ds_read_b64 v[86:87], v4 offset:520
  ds_read_b128 v[148:151], v5 offset:512
  ds_read_b64 v[88:89], v4 offset:1024
  ds_read_b64 v[90:91], v4 offset:1032
  v_mfma_f32_16x16x32_bf16 v[48:51], v[112:115], v[176:179], v[48:51]
  v_mfma_f32_16x16x32_bf16 v[52:55], v[112:115], v[180:183], v[52:55]
  v_mfma_f32_16x16x32_bf16 v[56:59], v[112:115], v[184:187], v[56:59]
  v_mfma_f32_16x16x32_bf16 v[60:63], v[112:115], v[188:191], v[60:63]
  v_mfma_f32_16x16x32_bf16 v[64:67], v[112:115], v[192:195], v[64:67]
  v_mfma_f32_16x16x32_bf16 v[68:71], v[112:115], v[196:199], v[68:71]
  v_mfma_f32_16x16x32_bf16 v[72:75], v[112:115], v[200:203], v[72:75]
  v_mfma_f32_16x16x32_bf16 v[76:79], v[112:115], v[204:207], v[76:79]
  v_mfma_f32_16x16x32_bf16 v[52:55], v[116:119], v[176:179], v[52:55]
  v_mfma_f32_16x16x32_bf16 v[56:59], v[116:119], v[180:183], v[56:59]
  v_mfma_f32_16x16x32_bf16 v[60:63], v[116:119], v[184:187], v[60:63]
  v_mfma_f32_16x16x32_bf16 v[64:67], v[116:119], v[188:191], v[64:67]
  s_waitcnt lgkmcnt(7)
  ds_read_b128 v[152:155], v5 offset:1024
  ds_read_b64 v[92:93], v4 offset:1536
  ds_read_b64 v[94:95], v4 offset:1544
  ds_read_b128 v[156:159], v5 offset:1536
  ds_read_b64 v[96:97], v4 offset:2048
  ds_read_b64 v[98:99], v4 offset:2056
  ds_read_b128 v[160:163], v5 offset:2048
  ds_read_b64 v[100:101], v4 offset:2560
  v_mfma_f32_16x16x32_bf16 v[68:71], v[116:119], v[192:195], v[68:71]
  v_mfma_f32_16x16x32_bf16 v[72:75], v[116:119], v[196:199], v[72:75]
  v_mfma_f32_16x16x32_bf16 v[76:79], v[116:119], v[200:203], v[76:79]
  v_mfma_f32_16x16x32_bf16 v[56:59], v[120:123], v[176:179], v[56:59]
  v_mfma_f32_16x16x32_bf16 v[60:63], v[120:123], v[180:183], v[60:63]
  v_mfma_f32_16x16x32_bf16 v[64:67], v[120:123], v[184:187], v[64:67]
  v_mfma_f32_16x16x32_bf16 v[68:71], v[120:123], v[188:191], v[68:71]
  v_mfma_f32_16x16x32_bf16 v[72:75], v[120:123], v[192:195], v[72:75]
  v_mfma_f32_16x16x32_bf16 v[76:79], v[120:123], v[196:199], v[76:79]
  v_mfma_f32_16x16x32_bf16 v[60:63], v[124:127], v[176:179], v[60:63]
  v_mfma_f32_16x16x32_bf16 v[64:67], v[124:127], v[180:183], v[64:67]
  v_mfma_f32_16x16x32_bf16 v[68:71], v[124:127], v[184:187], v[68:71]
  s_waitcnt lgkmcnt(7)
  ds_read_b64 v[102:103], v4 offset:2568
  ds_read_b128 v[164:167], v5 offset:2560
  ds_read_b64 v[104:105], v4 offset:3072
  ds_read_b64 v[106:107], v4 offset:3080
  ds_read_b128 v[168:171], v5 offset:3072
  ds_read_b64 v[108:109], v4 offset:3584
  ds_read_b64 v[110:111], v4 offset:3592
  ds_read_b128 v[172:175], v5 offset:3584
  v_mfma_f32_16x16x32_bf16 v[72:75], v[124:127], v[188:191], v[72:75]
  v_mfma_f32_16x16x32_bf16 v[76:79], v[124:127], v[192:195], v[76:79]
  v_mfma_f32_16x16x32_bf16 v[64:67], v[128:131], v[176:179], v[64:67]
  v_mfma_f32_16x16x32_bf16 v[68:71], v[128:131], v[180:183], v[68:71]
  v_mfma_f32_16x16x32_bf16 v[72:75], v[128:131], v[184:187], v[72:75]
  v_mfma_f32_16x16x32_bf16 v[76:79], v[128:131], v[188:191], v[76:79]
  v_mfma_f32_16x16x32_bf16 v[68:71], v[132:135], v[176:179], v[68:71]
  v_mfma_f32_16x16x32_bf16 v[72:75], v[132:135], v[180:183], v[72:75]
  v_mfma_f32_16x16x32_bf16 v[76:79], v[132:135], v[184:187], v[76:79]
  v_mfma_f32_16x16x32_bf16 v[72:75], v[136:139], v[176:179], v[72:75]
  v_mfma_f32_16x16x32_bf16 v[76:79], v[136:139], v[180:183], v[76:79]
  v_mfma_f32_16x16x32_bf16 v[76:79], v[140:143], v[176:179], v[76:79]
  s_add_u32 s25, s25, 2
  s_cmp_lt_u32 s25, 8
  s_cbranch_scc1 K2_CLOOP
  s_waitcnt lgkmcnt(0)
  v_lshlrev_b32 v6, 5, v3
  v_lshrrev_b32 v7, 1, v2
  v_lshlrev_b32 v7, 4, v7
  v_add_u32 v6, v6, v7
  v_and_b32 v7, 1, v2
  v_xor_b32 v7, 1, v7
  v_lshlrev_b32 v7, 3, v7
  v_add_u32 v6, v6, v7
  s_add_u32 s23, s22, 17152
  v_add_u32 v6, s23, v6
  ds_read_b64 v[80:81], v6 offset:0
  ds_read_b64 v[82:83], v6 offset:512
  ds_read_b64 v[84:85], v6 offset:1024
  ds_read_b64 v[86:87], v6 offset:1536
  ds_read_b64 v[88:89], v6 offset:2048
  ds_read_b64 v[90:91], v6 offset:2560
  ds_read_b64 v[92:93], v6 offset:3072
  ds_read_b64 v[94:95], v6 offset:3584
  v_lshlrev_b32 v8, 5, v3
  v_lshlrev_b32 v9, 3, v2
  v_add_u32 v8, v8, v9
  s_lshl_b32 s23, s21, 12
  s_add_u32 s23, s23, 9437184
  s_waitcnt lgkmcnt(0)
  v_and_b32 v144, s26, v81
  v_lshlrev_b32 v145, 16, v81
  v_and_b32 v146, s26, v80
  v_lshlrev_b32 v147, 16, v80
  v_pk_fma_f32 v[48:49], v[144:145], v[46:47], v[48:49] op_sel_hi:[1,0,1]
  v_pk_fma_f32 v[50:51], v[146:147], v[46:47], v[50:51] op_sel_hi:[1,0,1]
  v_cvt_pk_bf16_f32 v148, v48, v49
  v_cvt_pk_bf16_f32 v149, v50, v51
  buffer_store_dwordx2 v[148:149], v8, s[12:15], s23 offen offset:0
  v_and_b32 v152, s26, v83
  v_lshlrev_b32 v153, 16, v83
  v_and_b32 v154, s26, v82
  v_lshlrev_b32 v155, 16, v82
  v_pk_fma_f32 v[52:53], v[152:153], v[46:47], v[52:53] op_sel_hi:[1,0,1]
  v_pk_fma_f32 v[54:55], v[154:155], v[46:47], v[54:55] op_sel_hi:[1,0,1]
  v_cvt_pk_bf16_f32 v156, v52, v53
  v_cvt_pk_bf16_f32 v157, v54, v55
  buffer_store_dwordx2 v[156:157], v8, s[12:15], s23 offen offset:512
  v_and_b32 v160, s26, v85
  v_lshlrev_b32 v161, 16, v85
  v_and_b32 v162, s26, v84
  v_lshlrev_b32 v163, 16, v84
  v_pk_fma_f32 v[56:57], v[160:161], v[46:47], v[56:57] op_sel_hi:[1,0,1]
  v_pk_fma_f32 v[58:59], v[162:163], v[46:47], v[58:59] op_sel_hi:[1,0,1]
  v_cvt_pk_bf16_f32 v164, v56, v57
  v_cvt_pk_bf16_f32 v165, v58, v59
  buffer_store_dwordx2 v[164:165], v8, s[12:15], s23 offen offset:1024
  v_and_b32 v168, s26, v87
  v_lshlrev_b32 v169, 16, v87
  v_and_b32 v170, s26, v86
  v_lshlrev_b32 v171, 16, v86
  v_pk_fma_f32 v[60:61], v[168:169], v[46:47], v[60:61] op_sel_hi:[1,0,1]
  v_pk_fma_f32 v[62:63], v[170:171], v[46:47], v[62:63] op_sel_hi:[1,0,1]
  v_cvt_pk_bf16_f32 v172, v60, v61
  v_cvt_pk_bf16_f32 v173, v62, v63
  buffer_store_dwordx2 v[172:173], v8, s[12:15], s23 offen offset:1536
  v_and_b32 v176, s26, v89
  v_lshlrev_b32 v177, 16, v89
  v_and_b32 v178, s26, v88
  v_lshlrev_b32 v179, 16, v88
  v_pk_fma_f32 v[64:65], v[176:177], v[46:47], v[64:65] op_sel_hi:[1,0,1]
  v_pk_fma_f32 v[66:67], v[178:179], v[46:47], v[66:67] op_sel_hi:[1,0,1]
  v_cvt_pk_bf16_f32 v180, v64, v65
  v_cvt_pk_bf16_f32 v181, v66, v67
  buffer_store_dwordx2 v[180:181], v8, s[12:15], s23 offen offset:2048
  v_and_b32 v184, s26, v91
  v_lshlrev_b32 v185, 16, v91
  v_and_b32 v186, s26, v90
  v_lshlrev_b32 v187, 16, v90
  v_pk_fma_f32 v[68:69], v[184:185], v[46:47], v[68:69] op_sel_hi:[1,0,1]
  v_pk_fma_f32 v[70:71], v[186:187], v[46:47], v[70:71] op_sel_hi:[1,0,1]
  v_cvt_pk_bf16_f32 v188, v68, v69
  v_cvt_pk_bf16_f32 v189, v70, v71
  buffer_store_dwordx2 v[188:189], v8, s[12:15], s23 offen offset:2560
  v_and_b32 v192, s26, v93
  v_lshlrev_b32 v193, 16, v93
  v_and_b32 v194, s26, v92
  v_lshlrev_b32 v195, 16, v92
  v_pk_fma_f32 v[72:73], v[192:193], v[46:47], v[72:73] op_sel_hi:[1,0,1]
  v_pk_fma_f32 v[74:75], v[194:195], v[46:47], v[74:75] op_sel_hi:[1,0,1]
  v_cvt_pk_bf16_f32 v196, v72, v73
  v_cvt_pk_bf16_f32 v197, v74, v75
  buffer_store_dwordx2 v[196:197], v8, s[12:15], s23 offen offset:3072
  v_and_b32 v200, s26, v95
  v_lshlrev_b32 v201, 16, v95
  v_and_b32 v202, s26, v94
  v_lshlrev_b32 v203, 16, v94
  v_pk_fma_f32 v[76:77], v[200:201], v[46:47], v[76:77] op_sel_hi:[1,0,1]
  v_pk_fma_f32 v[78:79], v[202:203], v[46:47], v[78:79] op_sel_hi:[1,0,1]
  v_cvt_pk_bf16_f32 v204, v76, v77
  v_cvt_pk_bf16_f32 v205, v78, v79
  buffer_store_dwordx2 v[204:205], v8, s[12:15], s23 offen offset:3584
K2_END:
  s_endpgm

.section .rodata,"a"
.p2align 6
.amdhsa_kernel k2_kernel
  .amdhsa_next_free_vgpr 256
  .amdhsa_next_free_sgpr 96
  .amdhsa_accum_offset 256
  .amdhsa_group_segment_fixed_size 0
  .amdhsa_kernarg_size 112
  .amdhsa_user_sgpr_count 2
  .amdhsa_user_sgpr_kernarg_segment_ptr 1
  .amdhsa_system_sgpr_workgroup_id_x 1
  .amdhsa_float_denorm_mode_32 3
.end_amdhsa_kernel
.text
.globl k3_kernel
.p2align 8
.type k3_kernel,@function
k3_kernel:
  s_cmp_ge_u32 s2, 256
  s_cbranch_scc1 K3_END
  s_load_dwordx2 s[36:37], s[0:1], 0
  s_load_dwordx2 s[38:39], s[0:1], 88
  s_load_dwordx2 s[40:41], s[0:1], 104
  v_and_b32 v1, 63, v0
  v_lshrrev_b32 v12, 6, v0
  v_lshrrev_b32 v2, 4, v1
  v_readfirstlane_b32 s22, v12
  v_and_b32 v3, 15, v1
  v_lshlrev_b32 v4, 4, v1
  s_and_b32 s23, s2, 7
  s_lshr_b32 s24, s2, 3
  s_lshr_b32 s20, s23, 1
  s_lshl_b32 s20, s20, 3
  s_and_b32 s25, s24, 7
  s_add_u32 s20, s20, s25
  s_and_b32 s21, s23, 1
  s_lshl_b32 s21, s21, 2
  s_lshr_b32 s25, s24, 3
  s_add_u32 s21, s21, s25
  s_mov_b32 s26, 0xffff0000
  s_mov_b64 s[28:29], exec
  s_waitcnt lgkmcnt(0)
  s_mov_b32 s8, s36
  s_and_b32 s9, s37, 0xffff
  s_mov_b32 s10, 2621440
  s_mov_b32 s11, 0x20000
  s_mov_b32 s16, s38
  s_and_b32 s17, s39, 0xffff
  s_mov_b32 s18, 2621440
  s_mov_b32 s19, 0x20000
  s_mov_b32 s12, s40
  s_and_b32 s13, s41, 0xffff
  s_mov_b32 s14, 17825792
  s_mov_b32 s15, 0x20000
  s_lshl_b32 s34, s20, 2
  s_add_u32 s34, s34, s22
  s_mul_i32 s35, s34, 24576
  s_add_u32 s35, s35, 12582912
  s_mul_i32 s33, s21, 122880
  s_lshl_b32 s23, s22, 10
  s_add_u32 s33, s33, s23
  s_add_u32 s33, s33, 15728640
  s_mul_i32 s25, s22, 5120
  s_add_u32 m0, s25, 0
  s_add_u32 s23, s33, 0
  buffer_load_dwordx4 v4, s[12:15], s23 offen lds
  s_add_u32 m0, s25, 1024
  s_add_u32 s23, s33, 24576
  buffer_load_dwordx4 v4, s[12:15], s23 offen lds
  s_add_u32 m0, s25, 2048
  s_add_u32 s23, s33, 49152
  buffer_load_dwordx4 v4, s[12:15], s23 offen lds
  s_add_u32 m0, s25, 3072
  s_add_u32 s23, s33, 73728
  buffer_load_dwordx4 v4, s[12:15], s23 offen lds
  s_add_u32 m0, s25, 4096
  s_add_u32 s23, s33, 98304
  buffer_load_dwordx4 v4, s[12:15], s23 offen lds
  s_add_u32 s23, s35, 0
  buffer_load_dwordx4 v[88:91], v4, s[12:15], s23 offen offset:0
  buffer_load_dwordx4 v[92:95], v4, s[12:15], s23 offen offset:1024
  buffer_load_dwordx4 v[96:99], v4, s[12:15], s23 offen offset:2048
  buffer_load_dwordx4 v[100:103], v4, s[12:15], s23 offen offset:3072
  s_add_u32 m0, s25, 20480
  s_add_u32 s23, s33, 4096
  buffer_load_dwordx4 v4, s[12:15], s23 offen lds
  s_add_u32 m0, s25, 21504
  s_add_u32 s23, s33, 28672
  buffer_load_dwordx4 v4, s[12:15], s23 offen lds
  s_add_u32 m0, s25, 22528
  s_add_u32 s23, s33, 53248
  buffer_load_dwordx4 v4, s[12:15], s23 offen lds
  s_add_u32 m0, s25, 23552
  s_add_u32 s23, s33, 77824
  buffer_load_dwordx4 v4, s[12:15], s23 offen lds
  s_add_u32 m0, s25, 24576
  s_add_u32 s23, s33, 102400
  buffer_load_dwordx4 v4, s[12:15], s23 offen lds
  s_add_u32 s23, s35, 4096
  buffer_load_dwordx4 v[104:107], v4, s[12:15], s23 offen offset:0
  buffer_load_dwordx4 v[108:111], v4, s[12:15], s23 offen offset:1024
  buffer_load_dwordx4 v[112:115], v4, s[12:15], s23 offen offset:2048
  buffer_load_dwordx4 v[116:119], v4, s[12:15], s23 offen offset:3072
  s_add_u32 m0, s25, 40960
  s_add_u32 s23, s33, 8192
  buffer_load_dwordx4 v4, s[12:15], s23 offen lds
  s_add_u32 m0, s25, 41984
  s_add_u32 s23, s33, 32768
  buffer_load_dwordx4 v4, s[12:15], s23 offen lds
  s_add_u32 m0, s25, 43008
  s_add_u32 s23, s33, 57344
  buffer_load_dwordx4 v4, s[12:15], s23 offen lds
  s_add_u32 m0, s25, 44032
  s_add_u32 s23, s33, 81920
  buffer_load_dwordx4 v4, s[12:15], s23 offen lds
  s_add_u32 m0, s25, 45056
  s_add_u32 s23, s33, 106496
  buffer_load_dwordx4 v4, s[12:15], s23 offen lds
  s_add_u32 s23, s35, 8192
  buffer_load_dwordx4 v[120:123], v4, s[12:15], s23 offen offset:0
  buffer_load_dwordx4 v[124:127], v4, s[12:15], s23 offen offset:1024
  buffer_load_dwordx4 v[128:131], v4, s[12:15], s23 offen offset:2048
  buffer_load_dwordx4 v[132:135], v4, s[12:15], s23 offen offset:3072
  s_add_u32 m0, s25, 61440
  s_add_u32 s23, s33, 12288
  buffer_load_dwordx4 v4, s[12:15], s23 offen lds
  s_add_u32 m0, s25, 62464
  s_add_u32 s23, s33, 36864
  buffer_load_dwordx4 v4, s[12:15], s23 offen lds
  s_add_u32 m0, s25, 63488
  s_add_u32 s23, s33, 61440
  buffer_load_dwordx4 v4, s[12:15], s23 offen lds
  s_add_u32 m0, s25, 64512
  s_add_u32 s23, s33, 86016
  buffer_load_dwordx4 v4, s[12:15], s23 offen lds
  s_add_u32 m0, s25, 65536
  s_add_u32 s23, s33, 110592
  buffer_load_dwordx4 v4, s[12:15], s23 offen lds
  s_add_u32 s23, s35, 12288
  buffer_load_dwordx4 v[136:139], v4, s[12:15], s23 offen offset:0
  buffer_load_dwordx4 v[140:143], v4, s[12:15], s23 offen offset:1024
  buffer_load_dwordx4 v[144:147], v4, s[12:15], s23 offen offset:2048
  buffer_load_dwordx4 v[148:151], v4, s[12:15], s23 offen offset:3072
  s_add_u32 m0, s25, 81920
  s_add_u32 s23, s33, 16384
  buffer_load_dwordx4 v4, s[12:15], s23 offen lds
  s_add_u32 m0, s25, 82944
  s_add_u32 s23, s33, 40960
  buffer_load_dwordx4 v4, s[12:15], s23 offen lds
  s_add_u32 m0, s25, 83968
  s_add_u32 s23, s33, 65536
  buffer_load_dwordx4 v4, s[12:15], s23 offen lds
  s_add_u32 m0, s25, 84992
  s_add_u32 s23, s33, 90112
  buffer_load_dwordx4 v4, s[12:15], s23 offen lds
  s_add_u32 m0, s25, 86016
  s_add_u32 s23, s33, 114688
  buffer_load_dwordx4 v4, s[12:15], s23 offen lds
  s_add_u32 s23, s35, 16384
  buffer_load_dwordx4 v[152:155], v4, s[12:15], s23 offen offset:0
  buffer_load_dwordx4 v[156:159], v4, s[12:15], s23 offen offset:1024
  buffer_load_dwordx4 v[160:163], v4, s[12:15], s23 offen offset:2048
  buffer_load_dwordx4 v[164:167], v4, s[12:15], s23 offen offset:3072
  s_add_u32 m0, s25, 102400
  s_add_u32 s23, s33, 20480
  buffer_load_dwordx4 v4, s[12:15], s23 offen lds
  s_add_u32 m0, s25, 103424
  s_add_u32 s23, s33, 45056
  buffer_load_dwordx4 v4, s[12:15], s23 offen lds
  s_add_u32 m0, s25, 104448
  s_add_u32 s23, s33, 69632
  buffer_load_dwordx4 v4, s[12:15], s23 offen lds
  s_add_u32 m0, s25, 105472
  s_add_u32 s23, s33, 94208
  buffer_load_dwordx4 v4, s[12:15], s23 offen lds
  s_add_u32 m0, s25, 106496
  s_add_u32 s23, s33, 118784
  buffer_load_dwordx4 v4, s[12:15], s23 offen lds
  s_add_u32 s23, s35, 20480
  buffer_load_dwordx4 v[168:171], v4, s[12:15], s23 offen offset:0
  buffer_load_dwordx4 v[172:175], v4, s[12:15], s23 offen offset:1024
  buffer_load_dwordx4 v[176:179], v4, s[12:15], s23 offen offset:2048
  buffer_load_dwordx4 v[180:183], v4, s[12:15], s23 offen offset:3072
  s_lshl_b32 s23, s34, 4
  s_mul_i32 s23, s23, 1280
  s_mul_i32 s24, s21, 160
  s_add_u32 s23, s23, s24
  v_add_u32 v12, 0, v1
  v_mul_u32_u24 v13, 6554, v12
  v_lshrrev_b32 v13, 16, v13
  v_mul_u32_u24 v14, 10, v13
  v_sub_u32 v14, v12, v14
  v_lshlrev_b32 v14, 4, v14
  v_mul_u32_u24 v13, 1280, v13
  v_add_u32 v13, v13, v14
  v_add_u32 v5, s23, v13
  v_lshrrev_b32 v13, 1, v12
  v_lshlrev_b32 v13, 12, v13
  v_and_b32 v14, 1, v12
  v_lshlrev_b32 v14, 4, v14
  v_add_u32 v8, v13, v14
  v_add_u32 v12, 64, v1
  v_mul_u32_u24 v13, 6554, v12
  v_lshrrev_b32 v13, 16, v13
  v_mul_u32_u24 v14, 10, v13
  v_sub_u32 v14, v12, v14
  v_lshlrev_b32 v14, 4, v14
  v_mul_u32_u24 v13, 1280, v13
  v_add_u32 v13, v13, v14
  v_add_u32 v6, s23, v13
  v_lshrrev_b32 v13, 1, v12
  v_lshlrev_b32 v13, 12, v13
  v_and_b32 v14, 1, v12
  v_lshlrev_b32 v14, 4, v14
  v_add_u32 v9, v13, v14
  v_add_u32 v12, 128, v1
  v_mul_u32_u24 v13, 6554, v12
  v_lshrrev_b32 v13, 16, v13
  v_mul_u32_u24 v14, 10, v13
  v_sub_u32 v14, v12, v14
  v_lshlrev_b32 v14, 4, v14
  v_mul_u32_u24 v13, 1280, v13
  v_add_u32 v13, v13, v14
  v_add_u32 v7, s23, v13
  v_lshrrev_b32 v13, 1, v12
  v_lshlrev_b32 v13, 12, v13
  v_and_b32 v14, 1, v12
  v_lshlrev_b32 v14, 4, v14
  v_add_u32 v10, v13, v14
  s_mul_i32 s44, s22, 2560
  s_mul_i32 s45, s21, 327680
  s_lshl_b32 s24, s34, 5
  s_add_u32 s45, s45, s24
  s_add_u32 s45, s45, 9437184
  s_add_u32 m0, s44, 122880
  s_nop 0
  buffer_load_dwordx4 v5, s[8:11], 0 offen lds
  s_add_u32 m0, s44, 133120
  s_nop 0
  buffer_load_dwordx4 v8, s[12:15], s45 offen lds
  s_add_u32 m0, s44, 123904
  s_nop 0
  buffer_load_dwordx4 v6, s[8:11], 0 offen lds
  s_add_u32 m0, s44, 134144
  s_nop 0
  buffer_load_dwordx4 v9, s[12:15], s45 offen lds
  s_mov_b32 exec_lo, 0xffffffff
  s_mov_b32 exec_hi, 0x0
  s_add_u32 m0, s44, 124928
  s_nop 0
  buffer_load_dwordx4 v7, s[8:11], 0 offen lds
  s_add_u32 m0, s44, 135168
  s_nop 0
  buffer_load_dwordx4 v10, s[12:15], s45 offen lds
  s_mov_b64 exec, s[28:29]
  v_lshlrev_b32 v12, 3, v3
  s_lshl_b32 s23, s34, 7
  s_add_u32 s23, s23, 16777216
  buffer_load_dwordx2 v[24:25], v12, s[12:15], s23 offen
  v_mov_b32 v68, 0
  v_mov_b32 v69, 0
  v_mov_b32 v70, 0
  v_mov_b32 v71, 0
  v_mov_b32 v72, 0
  v_mov_b32 v73, 0
  v_mov_b32 v74, 0
  v_mov_b32 v75, 0
  v_mov_b32 v76, 0
  v_mov_b32 v77, 0
  v_mov_b32 v78, 0
  v_mov_b32 v79, 0
  v_mov_b32 v80, 0
  v_mov_b32 v81, 0
  v_mov_b32 v82, 0
  v_mov_b32 v83, 0
  v_mov_b32 v84, 0
  v_mov_b32 v85, 0
  v_mov_b32 v86, 0
  v_mov_b32 v87, 0
  v_add_u32 v20, 65536, v4
  s_waitcnt vmcnt(52)
  s_barrier
  ds_read_b128 v[28:31], v4 offset:0
  ds_read_b128 v[32:35], v4 offset:1024
  ds_read_b128 v[36:39], v4 offset:2048
  ds_read_b128 v[40:43], v4 offset:3072
  ds_read_b128 v[44:47], v4 offset:4096
  ds_read_b128 v[48:51], v4 offset:5120
  ds_read_b128 v[52:55], v4 offset:6144
  ds_read_b128 v[56:59], v4 offset:7168
  ds_read_b128 v[60:63], v4 offset:8192
  ds_read_b128 v[64:67], v4 offset:9216
  s_waitcnt lgkmcnt(5)
  v_mfma_f32_16x16x32_bf16 v[68:71], v[28:31], v[88:91], v[68:71]
  v_mfma_f32_16x16x32_bf16 v[72:75], v[32:35], v[88:91], v[72:75]
  v_mfma_f32_16x16x32_bf16 v[76:79], v[36:39], v[88:91], v[76:79]
  v_mfma_f32_16x16x32_bf16 v[80:83], v[40:43], v[88:91], v[80:83]
  v_mfma_f32_16x16x32_bf16 v[84:87], v[44:47], v[88:91], v[84:87]
  ds_read_b128 v[28:31], v4 offset:10240
  ds_read_b128 v[32:35], v4 offset:11264
  ds_read_b128 v[36:39], v4 offset:12288
  ds_read_b128 v[40:43], v4 offset:13312
  ds_read_b128 v[44:47], v4 offset:14336
  s_waitcnt lgkmcnt(5)
  v_mfma_f32_16x16x32_bf16 v[68:71], v[48:51], v[92:95], v[68:71]
  v_mfma_f32_16x16x32_bf16 v[72:75], v[52:55], v[92:95], v[72:75]
  v_mfma_f32_16x16x32_bf16 v[76:79], v[56:59], v[92:95], v[76:79]
  v_mfma_f32_16x16x32_bf16 v[80:83], v[60:63], v[92:95], v[80:83]
  v_mfma_f32_16x16x32_bf16 v[84:87], v[64:67], v[92:95], v[84:87]
  ds_read_b128 v[48:51], v4 offset:15360
  ds_read_b128 v[52:55], v4 offset:16384
  ds_read_b128 v[56:59], v4 offset:17408
  ds_read_b128 v[60:63], v4 offset:18432
  ds_read_b128 v[64:67], v4 offset:19456
  s_waitcnt lgkmcnt(5)
  v_mfma_f32_16x16x32_bf16 v[68:71], v[28:31], v[96:99], v[68:71]
  v_mfma_f32_16x16x32_bf16 v[72:75], v[32:35], v[96:99], v[72:75]
  v_mfma_f32_16x16x32_bf16 v[76:79], v[36:39], v[96:99], v[76:79]
  v_mfma_f32_16x16x32_bf16 v[80:83], v[40:43], v[96:99], v[80:83]
  v_mfma_f32_16x16x32_bf16 v[84:87], v[44:47], v[96:99], v[84:87]
  s_waitcnt vmcnt(43)
  s_barrier
  ds_read_b128 v[28:31], v4 offset:20480
  ds_read_b128 v[32:35], v4 offset:21504
  ds_read_b128 v[36:39], v4 offset:22528
  ds_read_b128 v[40:43], v4 offset:23552
  ds_read_b128 v[44:47], v4 offset:24576
  s_waitcnt lgkmcnt(5)
  v_mfma_f32_16x16x32_bf16 v[68:71], v[48:51], v[100:103], v[68:71]
  v_mfma_f32_16x16x32_bf16 v[72:75], v[52:55], v[100:103], v[72:75]
  v_mfma_f32_16x16x32_bf16 v[76:79], v[56:59], v[100:103], v[76:79]
  v_mfma_f32_16x16x32_bf16 v[80:83], v[60:63], v[100:103], v[80:83]
  v_mfma_f32_16x16x32_bf16 v[84:87], v[64:67], v[100:103], v[84:87]
  ds_read_b128 v[48:51], v4 offset:25600
  ds_read_b128 v[52:55], v4 offset:26624
  ds_read_b128 v[56:59], v4 offset:27648
  ds_read_b128 v[60:63], v4 offset:28672
  ds_read_b128 v[64:67], v4 offset:29696
  s_waitcnt lgkmcnt(5)
  v_mfma_f32_16x16x32_bf16 v[68:71], v[28:31], v[104:107], v[68:71]
  v_mfma_f32_16x16x32_bf16 v[72:75], v[32:35], v[104:107], v[72:75]
  v_mfma_f32_16x16x32_bf16 v[76:79], v[36:39], v[104:107], v[76:79]
  v_mfma_f32_16x16x32_bf16 v[80:83], v[40:43], v[104:107], v[80:83]
  v_mfma_f32_16x16x32_bf16 v[84:87], v[44:47], v[104:107], v[84:87]
  ds_read_b128 v[28:31], v4 offset:30720
  ds_read_b128 v[32:35], v4 offset:31744
  ds_read_b128 v[36:39], v4 offset:32768
  ds_read_b128 v[40:43], v4 offset:33792
  ds_read_b128 v[44:47], v4 offset:34816
  s_waitcnt lgkmcnt(5)
  v_mfma_f32_16x16x32_bf16 v[68:71], v[48:51], v[108:111], v[68:71]
  v_mfma_f32_16x16x32_bf16 v[72:75], v[52:55], v[108:111], v[72:75]
  v_mfma_f32_16x16x32_bf16 v[76:79], v[56:59], v[108:111], v[76:79]
  v_mfma_f32_16x16x32_bf16 v[80:83], v[60:63], v[108:111], v[80:83]
  v_mfma_f32_16x16x32_bf16 v[84:87], v[64:67], v[108:111], v[84:87]
  ds_read_b128 v[48:51], v4 offset:35840
  ds_read_b128 v[52:55], v4 offset:36864
  ds_read_b128 v[56:59], v4 offset:37888
  ds_read_b128 v[60:63], v4 offset:38912
  ds_read_b128 v[64:67], v4 offset:39936
  s_waitcnt lgkmcnt(5)
  v_mfma_f32_16x16x32_bf16 v[68:71], v[28:31], v[112:115], v[68:71]
  v_mfma_f32_16x16x32_bf16 v[72:75], v[32:35], v[112:115], v[72:75]
  v_mfma_f32_16x16x32_bf16 v[76:79], v[36:39], v[112:115], v[76:79]
  v_mfma_f32_16x16x32_bf16 v[80:83], v[40:43], v[112:115], v[80:83]
  v_mfma_f32_16x16x32_bf16 v[84:87], v[44:47], v[112:115], v[84:87]
  s_waitcnt vmcnt(34)
  s_barrier
  ds_read_b128 v[28:31], v4 offset:40960
  ds_read_b128 v[32:35], v4 offset:41984
  ds_read_b128 v[36:39], v4 offset:43008
  ds_read_b128 v[40:43], v4 offset:44032
  ds_read_b128 v[44:47], v4 offset:45056
  s_waitcnt lgkmcnt(5)
  v_mfma_f32_16x16x32_bf16 v[68:71], v[48:51], v[116:119], v[68:71]
  v_mfma_f32_16x16x32_bf16 v[72:75], v[52:55], v[116:119], v[72:75]
  v_mfma_f32_16x16x32_bf16 v[76:79], v[56:59], v[116:119], v[76:79]
  v_mfma_f32_16x16x32_bf16 v[80:83], v[60:63], v[116:119], v[80:83]
  v_mfma_f32_16x16x32_bf16 v[84:87], v[64:67], v[116:119], v[84:87]
  ds_read_b128 v[48:51], v4 offset:46080
  ds_read_b128 v[52:55], v4 offset:47104
  ds_read_b128 v[56:59], v4 offset:48128
  ds_read_b128 v[60:63], v4 offset:49152
  ds_read_b128 v[64:67], v4 offset:50176
  s_waitcnt lgkmcnt(5)
  v_mfma_f32_16x16x32_bf16 v[68:71], v[28:31], v[120:123], v[68:71]
  v_mfma_f32_16x16x32_bf16 v[72:75], v[32:35], v[120:123], v[72:75]
  v_mfma_f32_16x16x32_bf16 v[76:79], v[36:39], v[120:123], v[76:79]
  v_mfma_f32_16x16x32_bf16 v[80:83], v[40:43], v[120:123], v[80:83]
  v_mfma_f32_16x16x32_bf16 v[84:87], v[44:47], v[120:123], v[84:87]
  ds_read_b128 v[28:31], v4 offset:51200
  ds_read_b128 v[32:35], v4 offset:52224
  ds_read_b128 v[36:39], v4 offset:53248
  ds_read_b128 v[40:43], v4 offset:54272
  ds_read_b128 v[44:47], v4 offset:55296
  s_waitcnt lgkmcnt(5)
  v_mfma_f32_16x16x32_bf16 v[68:71], v[48:51], v[124:127], v[68:71]
  v_mfma_f32_16x16x32_bf16 v[72:75], v[52:55], v[124:127], v[72:75]
  v_mfma_f32_16x16x32_bf16 v[76:79], v[56:59], v[124:127], v[76:79]
  v_mfma_f32_16x16x32_bf16 v[80:83], v[60:63], v[124:127], v[80:83]
  v_mfma_f32_16x16x32_bf16 v[84:87], v[64:67], v[124:127], v[84:87]
  ds_read_b128 v[48:51], v4 offset:56320
  ds_read_b128 v[52:55], v4 offset:57344
  ds_read_b128 v[56:59], v4 offset:58368
  ds_read_b128 v[60:63], v4 offset:59392
  ds_read_b128 v[64:67], v4 offset:60416
  s_waitcnt lgkmcnt(5)
  v_mfma_f32_16x16x32_bf16 v[68:71], v[28:31], v[128:131], v[68:71]
  v_mfma_f32_16x16x32_bf16 v[72:75], v[32:35], v[128:131], v[72:75]
  v_mfma_f32_16x16x32_bf16 v[76:79], v[36:39], v[128:131], v[76:79]
  v_mfma_f32_16x16x32_bf16 v[80:83], v[40:43], v[128:131], v[80:83]
  v_mfma_f32_16x16x32_bf16 v[84:87], v[44:47], v[128:131], v[84:87]
  s_waitcnt vmcnt(25)
  s_barrier
  ds_read_b128 v[28:31], v4 offset:61440
  ds_read_b128 v[32:35], v4 offset:62464
  ds_read_b128 v[36:39], v4 offset:63488
  ds_read_b128 v[40:43], v4 offset:64512
  ds_read_b128 v[44:47], v20 offset:0
  s_waitcnt lgkmcnt(5)
  v_mfma_f32_16x16x32_bf16 v[68:71], v[48:51], v[132:135], v[68:71]
  v_mfma_f32_16x16x32_bf16 v[72:75], v[52:55], v[132:135], v[72:75]
  v_mfma_f32_16x16x32_bf16 v[76:79], v[56:59], v[132:135], v[76:79]
  v_mfma_f32_16x16x32_bf16 v[80:83], v[60:63], v[132:135], v[80:83]
  v_mfma_f32_16x16x32_bf16 v[84:87], v[64:67], v[132:135], v[84:87]
  ds_read_b128 v[48:51], v20 offset:1024
  ds_read_b128 v[52:55], v20 offset:2048
  ds_read_b128 v[56:59], v20 offset:3072
  ds_read_b128 v[60:63], v20 offset:4096
  ds_read_b128 v[64:67], v20 offset:5120
  s_waitcnt lgkmcnt(5)
  v_mfma_f32_16x16x32_bf16 v[68:71], v[28:31], v[136:139], v[68:71]
  v_mfma_f32_16x16x32_bf16 v[72:75], v[32:35], v[136:139], v[72:75]
  v_mfma_f32_16x16x32_bf16 v[76:79], v[36:39], v[136:139], v[76:79]
  v_mfma_f32_16x16x32_bf16 v[80:83], v[40:43], v[136:139], v[80:83]
  v_mfma_f32_16x16x32_bf16 v[84:87], v[44:47], v[136:139], v[84:87]
  ds_read_b128 v[28:31], v20 offset:6144
  ds_read_b128 v[32:35], v20 offset:7168
  ds_read_b128 v[36:39], v20 offset:8192
  ds_read_b128 v[40:43], v20 offset:9216
  ds_read_b128 v[44:47], v20 offset:10240
  s_waitcnt lgkmcnt(5)
  v_mfma_f32_16x16x32_bf16 v[68:71], v[48:51], v[140:143], v[68:71]
  v_mfma_f32_16x16x32_bf16 v[72:75], v[52:55], v[140:143], v[72:75]
  v_mfma_f32_16x16x32_bf16 v[76:79], v[56:59], v[140:143], v[76:79]
  v_mfma_f32_16x16x32_bf16 v[80:83], v[60:63], v[140:143], v[80:83]
  v_mfma_f32_16x16x32_bf16 v[84:87], v[64:67], v[140:143], v[84:87]
  ds_read_b128 v[48:51], v20 offset:11264
  ds_read_b128 v[52:55], v20 offset:12288
  ds_read_b128 v[56:59], v20 offset:13312
  ds_read_b128 v[60:63], v20 offset:14336
  ds_read_b128 v[64:67], v20 offset:15360
  s_waitcnt lgkmcnt(5)
  v_mfma_f32_16x16x32_bf16 v[68:71], v[28:31], v[144:147], v[68:71]
  v_mfma_f32_16x16x32_bf16 v[72:75], v[32:35], v[144:147], v[72:75]
  v_mfma_f32_16x16x32_bf16 v[76:79], v[36:39], v[144:147], v[76:79]
  v_mfma_f32_16x16x32_bf16 v[80:83], v[40:43], v[144:147], v[80:83]
  v_mfma_f32_16x16x32_bf16 v[84:87], v[44:47], v[144:147], v[84:87]
  s_waitcnt vmcnt(16)
  s_barrier
  ds_read_b128 v[28:31], v20 offset:16384
  ds_read_b128 v[32:35], v20 offset:17408
  ds_read_b128 v[36:39], v20 offset:18432
  ds_read_b128 v[40:43], v20 offset:19456
  ds_read_b128 v[44:47], v20 offset:20480
  s_waitcnt lgkmcnt(5)
  v_mfma_f32_16x16x32_bf16 v[68:71], v[48:51], v[148:151], v[68:71]
  v_mfma_f32_16x16x32_bf16 v[72:75], v[52:55], v[148:151], v[72:75]
  v_mfma_f32_16x16x32_bf16 v[76:79], v[56:59], v[148:151], v[76:79]
  v_mfma_f32_16x16x32_bf16 v[80:83], v[60:63], v[148:151], v[80:83]
  v_mfma_f32_16x16x32_bf16 v[84:87], v[64:67], v[148:151], v[84:87]
  ds_read_b128 v[48:51], v20 offset:21504
  ds_read_b128 v[52:55], v20 offset:22528
  ds_read_b128 v[56:59], v20 offset:23552
  ds_read_b128 v[60:63], v20 offset:24576
  ds_read_b128 v[64:67], v20 offset:25600
  s_waitcnt lgkmcnt(5)
  v_mfma_f32_16x16x32_bf16 v[68:71], v[28:31], v[152:155], v[68:71]
  v_mfma_f32_16x16x32_bf16 v[72:75], v[32:35], v[152:155], v[72:75]
  v_mfma_f32_16x16x32_bf16 v[76:79], v[36:39], v[152:155], v[76:79]
  v_mfma_f32_16x16x32_bf16 v[80:83], v[40:43], v[152:155], v[80:83]
  v_mfma_f32_16x16x32_bf16 v[84:87], v[44:47], v[152:155], v[84:87]
  ds_read_b128 v[28:31], v20 offset:26624
  ds_read_b128 v[32:35], v20 offset:27648
  ds_read_b128 v[36:39], v20 offset:28672
  ds_read_b128 v[40:43], v20 offset:29696
  ds_read_b128 v[44:47], v20 offset:30720
  s_waitcnt lgkmcnt(5)
  v_mfma_f32_16x16x32_bf16 v[68:71], v[48:51], v[156:159], v[68:71]
  v_mfma_f32_16x16x32_bf16 v[72:75], v[52:55], v[156:159], v[72:75]
  v_mfma_f32_16x16x32_bf16 v[76:79], v[56:59], v[156:159], v[76:79]
  v_mfma_f32_16x16x32_bf16 v[80:83], v[60:63], v[156:159], v[80:83]
  v_mfma_f32_16x16x32_bf16 v[84:87], v[64:67], v[156:159], v[84:87]
  ds_read_b128 v[48:51], v20 offset:31744
  ds_read_b128 v[52:55], v20 offset:32768
  ds_read_b128 v[56:59], v20 offset:33792
  ds_read_b128 v[60:63], v20 offset:34816
  ds_read_b128 v[64:67], v20 offset:35840
  s_waitcnt lgkmcnt(5)
  v_mfma_f32_16x16x32_bf16 v[68:71], v[28:31], v[160:163], v[68:71]
  v_mfma_f32_16x16x32_bf16 v[72:75], v[32:35], v[160:163], v[72:75]
  v_mfma_f32_16x16x32_bf16 v[76:79], v[36:39], v[160:163], v[76:79]
  v_mfma_f32_16x16x32_bf16 v[80:83], v[40:43], v[160:163], v[80:83]
  v_mfma_f32_16x16x32_bf16 v[84:87], v[44:47], v[160:163], v[84:87]
  s_waitcnt vmcnt(7)
  s_barrier
  ds_read_b128 v[28:31], v20 offset:36864
  ds_read_b128 v[32:35], v20 offset:37888
  ds_read_b128 v[36:39], v20 offset:38912
  ds_read_b128 v[40:43], v20 offset:39936
  ds_read_b128 v[44:47], v20 offset:40960
  s_waitcnt lgkmcnt(5)
  v_mfma_f32_16x16x32_bf16 v[68:71], v[48:51], v[164:167], v[68:71]
  v_mfma_f32_16x16x32_bf16 v[72:75], v[52:55], v[164:167], v[72:75]
  v_mfma_f32_16x16x32_bf16 v[76:79], v[56:59], v[164:167], v[76:79]
  v_mfma_f32_16x16x32_bf16 v[80:83], v[60:63], v[164:167], v[80:83]
  v_mfma_f32_16x16x32_bf16 v[84:87], v[64:67], v[164:167], v[84:87]
  ds_read_b128 v[48:51], v20 offset:41984
  ds_read_b128 v[52:55], v20 offset:43008
  ds_read_b128 v[56:59], v20 offset:44032
  ds_read_b128 v[60:63], v20 offset:45056
  ds_read_b128 v[64:67], v20 offset:46080
  s_waitcnt lgkmcnt(5)
  v_mfma_f32_16x16x32_bf16 v[68:71], v[28:31], v[168:171], v[68:71]
  v_mfma_f32_16x16x32_bf16 v[72:75], v[32:35], v[168:171], v[72:75]
  v_mfma_f32_16x16x32_bf16 v[76:79], v[36:39], v[168:171], v[76:79]
  v_mfma_f32_16x16x32_bf16 v[80:83], v[40:43], v[168:171], v[80:83]
  v_mfma_f32_16x16x32_bf16 v[84:87], v[44:47], v[168:171], v[84:87]
  ds_read_b128 v[28:31], v20 offset:47104
  ds_read_b128 v[32:35], v20 offset:48128
  ds_read_b128 v[36:39], v20 offset:49152
  ds_read_b128 v[40:43], v20 offset:50176
  ds_read_b128 v[44:47], v20 offset:51200
  s_waitcnt lgkmcnt(5)
  v_mfma_f32_16x16x32_bf16 v[68:71], v[48:51], v[172:175], v[68:71]
  v_mfma_f32_16x16x32_bf16 v[72:75], v[52:55], v[172:175], v[72:75]
  v_mfma_f32_16x16x32_bf16 v[76:79], v[56:59], v[172:175], v[76:79]
  v_mfma_f32_16x16x32_bf16 v[80:83], v[60:63], v[172:175], v[80:83]
  v_mfma_f32_16x16x32_bf16 v[84:87], v[64:67], v[172:175], v[84:87]
  ds_read_b128 v[48:51], v20 offset:52224
  ds_read_b128 v[52:55], v20 offset:53248
  ds_read_b128 v[56:59], v20 offset:54272
  ds_read_b128 v[60:63], v20 offset:55296
  ds_read_b128 v[64:67], v20 offset:56320
  s_waitcnt lgkmcnt(5)
  v_mfma_f32_16x16x32_bf16 v[68:71], v[28:31], v[176:179], v[68:71]
  v_mfma_f32_16x16x32_bf16 v[72:75], v[32:35], v[176:179], v[72:75]
  v_mfma_f32_16x16x32_bf16 v[76:79], v[36:39], v[176:179], v[76:79]
  v_mfma_f32_16x16x32_bf16 v[80:83], v[40:43], v[176:179], v[80:83]
  v_mfma_f32_16x16x32_bf16 v[84:87], v[44:47], v[176:179], v[84:87]
  s_waitcnt lgkmcnt(0)
  v_mfma_f32_16x16x32_bf16 v[68:71], v[48:51], v[180:183], v[68:71]
  v_mfma_f32_16x16x32_bf16 v[72:75], v[52:55], v[180:183], v[72:75]
  v_mfma_f32_16x16x32_bf16 v[76:79], v[56:59], v[180:183], v[76:79]
  v_mfma_f32_16x16x32_bf16 v[80:83], v[60:63], v[180:183], v[80:83]
  v_mfma_f32_16x16x32_bf16 v[84:87], v[64:67], v[180:183], v[84:87]
  s_waitcnt vmcnt(0)
  v_mul_u32_u24 v12, 160, v3
  v_lshlrev_b32 v13, 3, v2
  v_add_u32 v12, v12, v13
  s_add_u32 s23, s44, 122880
  v_add_u32 v12, s23, v12
  v_lshlrev_b32 v13, 7, v2
  v_lshlrev_b32 v14, 3, v3
  v_add_u32 v13, v13, v14
  s_add_u32 s23, s44, 133120
  v_add_u32 v13, s23, v13
  ds_read_b64 v[184:185], v12 offset:0
  ds_read_b64_tr_b16 v[194:195], v13 offset:0
  ds_read_b64 v[186:187], v12 offset:32
  ds_read_b64_tr_b16 v[196:197], v13 offset:512
  ds_read_b64 v[188:189], v12 offset:64
  ds_read_b64_tr_b16 v[198:199], v13 offset:1024
  ds_read_b64 v[190:191], v12 offset:96
  ds_read_b64_tr_b16 v[200:201], v13 offset:1536
  ds_read_b64 v[192:193], v12 offset:128
  ds_read_b64_tr_b16 v[202:203], v13 offset:2048
  v_sub_f32 v14, 0, v24
  v_mov_b32 v16, v25
  s_mov_b32 s30, 1.0
  s_mov_b32 s31, 1.0
  s_mov_b32 s32, 0xbfb8aa3b
  v_mov_b32 v18, s32
  v_mov_b32 v19, s32
  s_waitcnt lgkmcnt(0)
  v_lshlrev_b32 v204, 16, v184
  v_and_b32 v205, s26, v184
  v_lshlrev_b32 v206, 16, v194
  v_and_b32 v207, s26, v194
  v_pk_mul_f32 v[208:209], v[68:69], v[18:19]
  v_exp_f32 v208, v208
  v_exp_f32 v209, v209
  v_pk_add_f32 v[210:211], v[204:205], v[14:15] op_sel_hi:[1,0]
  v_pk_add_f32 v[208:209], v[208:209], s[30:31]
  v_pk_mul_f32 v[210:211], v[210:211], v[16:17] op_sel_hi:[1,0]
  v_rcp_f32 v208, v208
  v_rcp_f32 v209, v209
  v_pk_mul_f32 v[210:211], v[210:211], v[206:207]
  v_pk_mul_f32 v[208:209], v[208:209], v[68:69]
  v_pk_fma_f32 v[210:211], v[210:211], v[208:209], v[204:205]
  v_cvt_pk_bf16_f32 v184, v210, v211
  v_lshlrev_b32 v212, 16, v185
  v_and_b32 v213, s26, v185
  v_lshlrev_b32 v214, 16, v195
  v_and_b32 v215, s26, v195
  v_pk_mul_f32 v[216:217], v[70:71], v[18:19]
  v_exp_f32 v216, v216
  v_exp_f32 v217, v217
  v_pk_add_f32 v[218:219], v[212:213], v[14:15] op_sel_hi:[1,0]
  v_pk_add_f32 v[216:217], v[216:217], s[30:31]
  v_pk_mul_f32 v[218:219], v[218:219], v[16:17] op_sel_hi:[1,0]
  v_rcp_f32 v216, v216
  v_rcp_f32 v217, v217
  v_pk_mul_f32 v[218:219], v[218:219], v[214:215]
  v_pk_mul_f32 v[216:217], v[216:217], v[70:71]
  v_pk_fma_f32 v[218:219], v[218:219], v[216:217], v[212:213]
  v_cvt_pk_bf16_f32 v185, v218, v219
  ds_write_b64 v12, v[184:185] offset:0
  v_lshlrev_b32 v204, 16, v186
  v_and_b32 v205, s26, v186
  v_lshlrev_b32 v206, 16, v196
  v_and_b32 v207, s26, v196
  v_pk_mul_f32 v[208:209], v[72:73], v[18:19]
  v_exp_f32 v208, v208
  v_exp_f32 v209, v209
  v_pk_add_f32 v[210:211], v[204:205], v[14:15] op_sel_hi:[1,0]
  v_pk_add_f32 v[208:209], v[208:209], s[30:31]
  v_pk_mul_f32 v[210:211], v[210:211], v[16:17] op_sel_hi:[1,0]
  v_rcp_f32 v208, v208
  v_rcp_f32 v209, v209
  v_pk_mul_f32 v[210:211], v[210:211], v[206:207]
  v_pk_mul_f32 v[208:209], v[208:209], v[72:73]
  v_pk_fma_f32 v[210:211], v[210:211], v[208:209], v[204:205]
  v_cvt_pk_bf16_f32 v186, v210, v211
  v_lshlrev_b32 v212, 16, v187
  v_and_b32 v213, s26, v187
  v_lshlrev_b32 v214, 16, v197
  v_and_b32 v215, s26, v197
  v_pk_mul_f32 v[216:217], v[74:75], v[18:19]
  v_exp_f32 v216, v216
  v_exp_f32 v217, v217
  v_pk_add_f32 v[218:219], v[212:213], v[14:15] op_sel_hi:[1,0]
  v_pk_add_f32 v[216:217], v[216:217], s[30:31]
  v_pk_mul_f32 v[218:219], v[218:219], v[16:17] op_sel_hi:[1,0]
  v_rcp_f32 v216, v216
  v_rcp_f32 v217, v217
  v_pk_mul_f32 v[218:219], v[218:219], v[214:215]
  v_pk_mul_f32 v[216:217], v[216:217], v[74:75]
  v_pk_fma_f32 v[218:219], v[218:219], v[216:217], v[212:213]
  v_cvt_pk_bf16_f32 v187, v218, v219
  ds_write_b64 v12, v[186:187] offset:32
  v_lshlrev_b32 v204, 16, v188
  v_and_b32 v205, s26, v188
  v_lshlrev_b32 v206, 16, v198
  v_and_b32 v207, s26, v198
  v_pk_mul_f32 v[208:209], v[76:77], v[18:19]
  v_exp_f32 v208, v208
  v_exp_f32 v209, v209
  v_pk_add_f32 v[210:211], v[204:205], v[14:15] op_sel_hi:[1,0]
  v_pk_add_f32 v[208:209], v[208:209], s[30:31]
  v_pk_mul_f32 v[210:211], v[210:211], v[16:17] op_sel_hi:[1,0]
  v_rcp_f32 v208, v208
  v_rcp_f32 v209, v209
  v_pk_mul_f32 v[210:211], v[210:211], v[206:207]
  v_pk_mul_f32 v[208:209], v[208:209], v[76:77]
  v_pk_fma_f32 v[210:211], v[210:211], v[208:209], v[204:205]
  v_cvt_pk_bf16_f32 v188, v210, v211
  v_lshlrev_b32 v212, 16, v189
  v_and_b32 v213, s26, v189
  v_lshlrev_b32 v214, 16, v199
  v_and_b32 v215, s26, v199
  v_pk_mul_f32 v[216:217], v[78:79], v[18:19]
  v_exp_f32 v216, v216
  v_exp_f32 v217, v217
  v_pk_add_f32 v[218:219], v[212:213], v[14:15] op_sel_hi:[1,0]
  v_pk_add_f32 v[216:217], v[216:217], s[30:31]
  v_pk_mul_f32 v[218:219], v[218:219], v[16:17] op_sel_hi:[1,0]
  v_rcp_f32 v216, v216
  v_rcp_f32 v217, v217
  v_pk_mul_f32 v[218:219], v[218:219], v[214:215]
  v_pk_mul_f32 v[216:217], v[216:217], v[78:79]
  v_pk_fma_f32 v[218:219], v[218:219], v[216:217], v[212:213]
  v_cvt_pk_bf16_f32 v189, v218, v219
  ds_write_b64 v12, v[188:189] offset:64
  v_lshlrev_b32 v204, 16, v190
  v_and_b32 v205, s26, v190
  v_lshlrev_b32 v206, 16, v200
  v_and_b32 v207, s26, v200
  v_pk_mul_f32 v[208:209], v[80:81], v[18:19]
  v_exp_f32 v208, v208
  v_exp_f32 v209, v209
  v_pk_add_f32 v[210:211], v[204:205], v[14:15] op_sel_hi:[1,0]
  v_pk_add_f32 v[208:209], v[208:209], s[30:31]
  v_pk_mul_f32 v[210:211], v[210:211], v[16:17] op_sel_hi:[1,0]
  v_rcp_f32 v208, v208
  v_rcp_f32 v209, v209
  v_pk_mul_f32 v[210:211], v[210:211], v[206:207]
  v_pk_mul_f32 v[208:209], v[208:209], v[80:81]
  v_pk_fma_f32 v[210:211], v[210:211], v[208:209], v[204:205]
  v_cvt_pk_bf16_f32 v190, v210, v211
  v_lshlrev_b32 v212, 16, v191
  v_and_b32 v213, s26, v191
  v_lshlrev_b32 v214, 16, v201
  v_and_b32 v215, s26, v201
  v_pk_mul_f32 v[216:217], v[82:83], v[18:19]
  v_exp_f32 v216, v216
  v_exp_f32 v217, v217
  v_pk_add_f32 v[218:219], v[212:213], v[14:15] op_sel_hi:[1,0]
  v_pk_add_f32 v[216:217], v[216:217], s[30:31]
  v_pk_mul_f32 v[218:219], v[218:219], v[16:17] op_sel_hi:[1,0]
  v_rcp_f32 v216, v216
  v_rcp_f32 v217, v217
  v_pk_mul_f32 v[218:219], v[218:219], v[214:215]
  v_pk_mul_f32 v[216:217], v[216:217], v[82:83]
  v_pk_fma_f32 v[218:219], v[218:219], v[216:217], v[212:213]
  v_cvt_pk_bf16_f32 v191, v218, v219
  ds_write_b64 v12, v[190:191] offset:96
  v_lshlrev_b32 v204, 16, v192
  v_and_b32 v205, s26, v192
  v_lshlrev_b32 v206, 16, v202
  v_and_b32 v207, s26, v202
  v_pk_mul_f32 v[208:209], v[84:85], v[18:19]
  v_exp_f32 v208, v208
  v_exp_f32 v209, v209
  v_pk_add_f32 v[210:211], v[204:205], v[14:15] op_sel_hi:[1,0]
  v_pk_add_f32 v[208:209], v[208:209], s[30:31]
  v_pk_mul_f32 v[210:211], v[210:211], v[16:17] op_sel_hi:[1,0]
  v_rcp_f32 v208, v208
  v_rcp_f32 v209, v209
  v_pk_mul_f32 v[210:211], v[210:211], v[206:207]
  v_pk_mul_f32 v[208:209], v[208:209], v[84:85]
  v_pk_fma_f32 v[210:211], v[210:211], v[208:209], v[204:205]
  v_cvt_pk_bf16_f32 v192, v210, v211
  v_lshlrev_b32 v212, 16, v193
  v_and_b32 v213, s26, v193
  v_lshlrev_b32 v214, 16, v203
  v_and_b32 v215, s26, v203
  v_pk_mul_f32 v[216:217], v[86:87], v[18:19]
  v_exp_f32 v216, v216
  v_exp_f32 v217, v217
  v_pk_add_f32 v[218:219], v[212:213], v[14:15] op_sel_hi:[1,0]
  v_pk_add_f32 v[216:217], v[216:217], s[30:31]
  v_pk_mul_f32 v[218:219], v[218:219], v[16:17] op_sel_hi:[1,0]
  v_rcp_f32 v216, v216
  v_rcp_f32 v217, v217
  v_pk_mul_f32 v[218:219], v[218:219], v[214:215]
  v_pk_mul_f32 v[216:217], v[216:217], v[86:87]
  v_pk_fma_f32 v[218:219], v[218:219], v[216:217], v[212:213]
  v_cvt_pk_bf16_f32 v193, v218, v219
  ds_write_b64 v12, v[192:193] offset:128
  s_waitcnt lgkmcnt(0)
  s_add_u32 s23, s44, 122880
  v_add_u32 v13, s23, v4
  ds_read_b128 v[220:223], v13 offset:0
  ds_read_b128 v[224:227], v13 offset:1024
  ds_read_b128 v[228:231], v13 offset:2048
  s_waitcnt lgkmcnt(0)
  buffer_store_dwordx4 v[220:223], v5, s[16:19], 0 offen
  buffer_store_dwordx4 v[224:227], v6, s[16:19], 0 offen
  s_mov_b32 exec_lo, 0xffffffff
  s_mov_b32 exec_hi, 0x0
  buffer_store_dwordx4 v[228:231], v7, s[16:19], 0 offen
K3_END:
  s_endpgm

.section .rodata,"a"
.p2align 6
.amdhsa_kernel k3_kernel
  .amdhsa_next_free_vgpr 256
  .amdhsa_next_free_sgpr 96
  .amdhsa_accum_offset 256
  .amdhsa_group_segment_fixed_size 0
  .amdhsa_kernarg_size 112
  .amdhsa_user_sgpr_count 2
  .amdhsa_user_sgpr_kernarg_segment_ptr 1
  .amdhsa_system_sgpr_workgroup_id_x 1
  .amdhsa_float_denorm_mode_32 3
.end_amdhsa_kernel
.text
```

```asm
; @launch kernel=k1_kernel grid=(256,1,1) block=(768,1,1) lds=150528
; @launch kernel=k2_kernel grid=(470,1,1) block=(256,1,1) lds=65536
; @launch kernel=k3_kernel grid=(256,1,1) block=(256,1,1) lds=143360
.amdgcn_target "amdgcn-amd-amdhsa--gfx950"
.text
.globl k1_kernel
.p2align 8
.type k1_kernel,@function
k1_kernel:
  s_cmp_ge_u32 s2, 256
  s_cbranch_scc1 K1_END
  s_load_dwordx4 s[60:63], s[0:1], 0
  s_load_dwordx4 s[64:67], s[0:1], 16
  s_load_dwordx2 s[68:69], s[0:1], 56
  s_load_dwordx2 s[70:71], s[0:1], 80
  s_load_dwordx4 s[72:75], s[0:1], 96
  s_load_dwordx2 s[78:79], s[0:1], 64
  v_and_b32 v1, 63, v0
  v_lshrrev_b32 v14, 6, v0
  v_lshrrev_b32 v2, 4, v1
  v_readfirstlane_b32 s34, v14
  v_and_b32 v3, 15, v1
  s_and_b32 s40, s2, 7
  s_lshr_b32 s41, s2, 3
  s_lshr_b32 s32, s40, 1
  s_lshl_b32 s32, s32, 3
  s_lshr_b32 s42, s41, 2
  s_add_u32 s32, s32, s42
  s_and_b32 s33, s40, 1
  s_lshl_b32 s33, s33, 2
  s_and_b32 s42, s41, 3
  s_add_u32 s33, s33, s42
  s_and_b32 s55, s34, 3
  s_lshr_b32 s35, s55, 1
  s_and_b32 s36, s55, 1
  s_mov_b32 s47, 0xffff0000
  s_mov_b64 s[52:53], exec
  s_mul_i32 s44, s33, 192
  s_add_u32 s43, s44, 1536
  s_cmp_ge_u32 s34, 8
  s_cbranch_scc0 K1_AB
  s_lshl_b32 s40, s32, 6
  s_lshl_b32 s41, s55, 3
  s_add_u32 s40, s40, s41
  s_lshl_b32 s45, s55, 10
  v_lshrrev_b32 v30, 3, v1
  v_add_u32 v32, s41, v30
  v_lshrrev_b32 v31, 1, v32
  v_xor_b32 v31, v31, v1
  v_and_b32 v31, 7, v31
  v_lshlrev_b32 v31, 4, v31
  v_add_u32 v30, s40, v30
  v_mul_u32_u24 v30, 1280, v30
  v_add_u32 v8, v30, v31
  v_add_u32 v9, 40960, v8
  s_waitcnt lgkmcnt(0)
  s_mov_b32 s8, s60
  s_and_b32 s9, s61, 0xffff
  s_mov_b32 s10, 2621440
  s_mov_b32 s11, 0x20000
  s_movk_i32 s38, 0
  s_add_u32 m0, s45, 61440
  s_nop 0
  buffer_load_dwordx4 v8, s[8:11], s38 offen lds
  s_add_u32 m0, s45, 65536
  s_nop 0
  buffer_load_dwordx4 v9, s[8:11], s38 offen lds
  s_lshl_b32 s40, s55, 6
  s_add_u32 s40, s40, 0
  v_add_u32 v30, s40, v1
  v_mul_u32_u24 v31, 5462, v30
  v_lshrrev_b32 v31, 16, v31
  v_mul_u32_u24 v32, 12, v31
  v_sub_u32 v32, v30, v32
  v_lshrrev_b32 v33, 2, v31
  v_and_b32 v33, 2, v33
  v_xor_b32 v32, v32, v33
  v_lshlrev_b32 v32, 4, v32
  v_mul_u32_u24 v31, 3072, v31
  v_add_u32 v12, v31, v32
  s_lshl_b32 s40, s55, 6
  s_add_u32 s40, s40, 256
  v_add_u32 v30, s40, v1
  v_mul_u32_u24 v31, 5462, v30
  v_lshrrev_b32 v31, 16, v31
  v_mul_u32_u24 v32, 12, v31
  v_sub_u32 v32, v30, v32
  v_lshrrev_b32 v33, 2, v31
  v_and_b32 v33, 2, v33
  v_xor_b32 v32, v32, v33
  v_lshlrev_b32 v32, 4, v32
  v_mul_u32_u24 v31, 3072, v31
  v_add_u32 v13, v31, v32
  s_lshl_b32 s40, s55, 6
  s_add_u32 s40, s40, 512
  v_add_u32 v30, s40, v1
  v_mul_u32_u24 v31, 5462, v30
  v_lshrrev_b32 v31, 16, v31
  v_mul_u32_u24 v32, 12, v31
  v_sub_u32 v32, v30, v32
  v_lshrrev_b32 v33, 2, v31
  v_and_b32 v33, 2, v33
  v_xor_b32 v32, v32, v33
  v_lshlrev_b32 v32, 4, v32
  v_mul_u32_u24 v31, 3072, v31
  v_add_u32 v14, v31, v32
  s_mov_b32 s12, s68
  s_and_b32 s13, s69, 0xffff
  s_mov_b32 s14, 1966080
  s_mov_b32 s15, 0x20000
  s_add_u32 s39, s43, 0
  s_add_u32 m0, s45, 0
  s_nop 0
  buffer_load_dwordx4 v12, s[12:15], s39 offen lds
  s_add_u32 m0, s45, 4096
  s_nop 0
  buffer_load_dwordx4 v13, s[12:15], s39 offen lds
  s_add_u32 m0, s45, 8192
  s_nop 0
  buffer_load_dwordx4 v14, s[12:15], s39 offen lds
  v_mul_u32_u24 v5, 6554, v1
  v_lshrrev_b32 v5, 16, v5
  v_mul_u32_u24 v4, 10, v5
  v_sub_u32 v4, v1, v4
  v_lshlrev_b32 v4, 4, v4
  v_mul_u32_u24 v30, 1280, v5
  v_add_u32 v4, v4, v30
  s_mov_b32 s20, s62
  s_and_b32 s21, s63, 0xffff
  s_mov_b32 s22, 2621440
  s_mov_b32 s23, 0x20000
  s_mov_b32 s24, s64
  s_and_b32 s25, s65, 0xffff
  s_mov_b32 s26, 2621440
  s_mov_b32 s27, 0x20000
  s_mov_b32 exec_lo, 0xffffffff
  s_mov_b32 exec_hi, 0xfffffff
  s_lshl_b32 s40, s32, 6
  s_mul_i32 s41, s55, 6
  s_add_u32 s40, s40, s41
  s_mul_i32 s70, s40, 1280
  s_mul_i32 s41, s33, 160
  s_add_u32 s70, s70, s41
  s_mul_i32 s71, s55, 960
  s_add_u32 s71, s71, 126976
  v_mov_b32 v30, v4
  s_sub_u32 s72, s70, 3840
  s_cmp_eq_u32 s40, 0
  s_cbranch_scc0 K1_NONNEG
  v_subrev_u32 v30, 3840, v4
  v_cmp_gt_u32 vcc, 3, v5
  v_mov_b32 v31, 0x80000000
  s_nop 0
  v_cndmask_b32 v30, v30, v31, vcc
  s_mov_b32 s72, s70
K1_NONNEG:
  s_add_u32 m0, s71, 0
  s_nop 0
  buffer_load_dwordx4 v30, s[20:23], s72 offen lds
  s_add_u32 m0, s71, 11520
  s_nop 0
  buffer_load_dwordx4 v4, s[24:27], s70 offen lds
  s_add_u32 s70, s70, 30720
  s_sub_u32 s72, s70, 3840
  s_add_u32 m0, s71, 3840
  s_nop 0
  buffer_load_dwordx4 v4, s[20:23], s72 offen lds
  s_add_u32 m0, s71, 15360
  s_nop 0
  buffer_load_dwordx4 v4, s[24:27], s70 offen lds
  s_add_u32 s70, s70, 30720
  s_sub_u32 s72, s70, 3840
  s_add_u32 m0, s71, 7680
  s_nop 0
  buffer_load_dwordx4 v4, s[20:23], s72 offen lds
  s_add_u32 m0, s71, 19200
  s_nop 0
  buffer_load_dwordx4 v4, s[24:27], s70 offen lds
  s_add_u32 s70, s70, 30720
  s_sub_u32 s72, s70, 3840
  s_mov_b64 exec, s[52:53]
  s_movk_i32 s38, 128
  s_add_u32 m0, s45, 69632
  s_nop 0
  buffer_load_dwordx4 v8, s[8:11], s38 offen lds
  s_add_u32 m0, s45, 73728
  s_nop 0
  buffer_load_dwordx4 v9, s[8:11], s38 offen lds
  s_add_u32 s39, s43, 196608
  s_add_u32 m0, s45, 12288
  s_nop 0
  buffer_load_dwordx4 v12, s[12:15], s39 offen lds
  s_add_u32 m0, s45, 16384
  s_nop 0
  buffer_load_dwordx4 v13, s[12:15], s39 offen lds
  s_add_u32 m0, s45, 20480
  s_nop 0
  buffer_load_dwordx4 v14, s[12:15], s39 offen lds
  s_waitcnt vmcnt(11)
  s_barrier
  s_movk_i32 s38, 256
  s_add_u32 m0, s45, 77824
  s_nop 0
  buffer_load_dwordx4 v8, s[8:11], s38 offen lds
  s_add_u32 m0, s45, 81920
  s_nop 0
  buffer_load_dwordx4 v9, s[8:11], s38 offen lds
  s_add_u32 s39, s43, 393216
  s_add_u32 m0, s45, 24576
  s_nop 0
  buffer_load_dwordx4 v12, s[12:15], s39 offen lds
  s_add_u32 m0, s45, 28672
  s_nop 0
  buffer_load_dwordx4 v13, s[12:15], s39 offen lds
  s_add_u32 m0, s45, 32768
  s_nop 0
  buffer_load_dwordx4 v14, s[12:15], s39 offen lds
  s_movk_i32 s38, 384
  s_add_u32 m0, s45, 86016
  s_nop 0
  buffer_load_dwordx4 v8, s[8:11], s38 offen lds
  s_add_u32 m0, s45, 90112
  s_nop 0
  buffer_load_dwordx4 v9, s[8:11], s38 offen lds
  s_add_u32 s39, s43, 589824
  s_add_u32 m0, s45, 36864
  s_nop 0
  buffer_load_dwordx4 v12, s[12:15], s39 offen lds
  s_add_u32 m0, s45, 40960
  s_nop 0
  buffer_load_dwordx4 v13, s[12:15], s39 offen lds
  s_add_u32 m0, s45, 45056
  s_nop 0
  buffer_load_dwordx4 v14, s[12:15], s39 offen lds
  s_waitcnt vmcnt(10)
  s_barrier
  s_movk_i32 s38, 512
  s_add_u32 m0, s45, 94208
  s_nop 0
  buffer_load_dwordx4 v8, s[8:11], s38 offen lds
  s_add_u32 m0, s45, 98304
  s_nop 0
  buffer_load_dwordx4 v9, s[8:11], s38 offen lds
  s_add_u32 s39, s43, 786432
  s_add_u32 m0, s45, 49152
  s_nop 0
  buffer_load_dwordx4 v12, s[12:15], s39 offen lds
  s_add_u32 m0, s45, 53248
  s_nop 0
  buffer_load_dwordx4 v13, s[12:15], s39 offen lds
  s_add_u32 m0, s45, 57344
  s_nop 0
  buffer_load_dwordx4 v14, s[12:15], s39 offen lds
  s_movk_i32 s38, 640
  s_add_u32 m0, s45, 102400
  s_nop 0
  buffer_load_dwordx4 v8, s[8:11], s38 offen lds
  s_add_u32 m0, s45, 106496
  s_nop 0
  buffer_load_dwordx4 v9, s[8:11], s38 offen lds
  s_add_u32 s39, s43, 983040
  s_add_u32 m0, s45, 0
  s_nop 0
  buffer_load_dwordx4 v12, s[12:15], s39 offen lds
  s_add_u32 m0, s45, 4096
  s_nop 0
  buffer_load_dwordx4 v13, s[12:15], s39 offen lds
  s_add_u32 m0, s45, 8192
  s_nop 0
  buffer_load_dwordx4 v14, s[12:15], s39 offen lds
  s_waitcnt vmcnt(15)
  s_barrier
  s_movk_i32 s38, 768
  s_add_u32 m0, s45, 110592
  s_nop 0
  buffer_load_dwordx4 v8, s[8:11], s38 offen lds
  s_add_u32 m0, s45, 114688
  s_nop 0
  buffer_load_dwordx4 v9, s[8:11], s38 offen lds
  s_add_u32 s39, s43, 1179648
  s_add_u32 m0, s45, 12288
  s_nop 0
  buffer_load_dwordx4 v12, s[12:15], s39 offen lds
  s_add_u32 m0, s45, 16384
  s_nop 0
  buffer_load_dwordx4 v13, s[12:15], s39 offen lds
  s_add_u32 m0, s45, 20480
  s_nop 0
  buffer_load_dwordx4 v14, s[12:15], s39 offen lds
  s_waitcnt vmcnt(15)
  s_barrier
  s_movk_i32 s38, 896
  s_add_u32 m0, s45, 118784
  s_nop 0
  buffer_load_dwordx4 v8, s[8:11], s38 offen lds
  s_add_u32 m0, s45, 122880
  s_nop 0
  buffer_load_dwordx4 v9, s[8:11], s38 offen lds
  s_add_u32 s39, s43, 1376256
  s_add_u32 m0, s45, 24576
  s_nop 0
  buffer_load_dwordx4 v12, s[12:15], s39 offen lds
  s_add_u32 m0, s45, 28672
  s_nop 0
  buffer_load_dwordx4 v13, s[12:15], s39 offen lds
  s_add_u32 m0, s45, 32768
  s_nop 0
  buffer_load_dwordx4 v14, s[12:15], s39 offen lds
  s_waitcnt vmcnt(15)
  s_barrier
  s_movk_i32 s38, 1024
  s_add_u32 m0, s45, 126976
  s_nop 0
  buffer_load_dwordx4 v8, s[8:11], s38 offen lds
  s_add_u32 m0, s45, 131072
  s_nop 0
  buffer_load_dwordx4 v9, s[8:11], s38 offen lds
  s_add_u32 s39, s43, 1572864
  s_add_u32 m0, s45, 36864
  s_nop 0
  buffer_load_dwordx4 v12, s[12:15], s39 offen lds
  s_add_u32 m0, s45, 40960
  s_nop 0
  buffer_load_dwordx4 v13, s[12:15], s39 offen lds
  s_add_u32 m0, s45, 45056
  s_nop 0
  buffer_load_dwordx4 v14, s[12:15], s39 offen lds
  s_waitcnt vmcnt(15)
  s_barrier
  s_movk_i32 s38, 1152
  s_add_u32 m0, s45, 135168
  s_nop 0
  buffer_load_dwordx4 v8, s[8:11], s38 offen lds
  s_add_u32 m0, s45, 139264
  s_nop 0
  buffer_load_dwordx4 v9, s[8:11], s38 offen lds
  s_add_u32 s39, s43, 1769472
  s_add_u32 m0, s45, 49152
  s_nop 0
  buffer_load_dwordx4 v12, s[12:15], s39 offen lds
  s_add_u32 m0, s45, 53248
  s_nop 0
  buffer_load_dwordx4 v13, s[12:15], s39 offen lds
  s_add_u32 m0, s45, 57344
  s_nop 0
  buffer_load_dwordx4 v14, s[12:15], s39 offen lds
  s_waitcnt vmcnt(15)
  s_barrier
  s_add_u32 s39, s44, 0
  s_add_u32 m0, s45, 0
  s_nop 0
  buffer_load_dwordx4 v12, s[12:15], s39 offen lds
  s_add_u32 m0, s45, 4096
  s_nop 0
  buffer_load_dwordx4 v13, s[12:15], s39 offen lds
  s_add_u32 m0, s45, 8192
  s_nop 0
  buffer_load_dwordx4 v14, s[12:15], s39 offen lds
  s_waitcnt vmcnt(13)
  s_barrier
  s_add_u32 s39, s44, 196608
  s_add_u32 m0, s45, 12288
  s_nop 0
  buffer_load_dwordx4 v12, s[12:15], s39 offen lds
  s_add_u32 m0, s45, 16384
  s_nop 0
  buffer_load_dwordx4 v13, s[12:15], s39 offen lds
  s_add_u32 m0, s45, 20480
  s_nop 0
  buffer_load_dwordx4 v14, s[12:15], s39 offen lds
  s_waitcnt vmcnt(11)
  s_barrier
  s_add_u32 s39, s44, 393216
  s_add_u32 m0, s45, 24576
  s_nop 0
  buffer_load_dwordx4 v12, s[12:15], s39 offen lds
  s_add_u32 m0, s45, 28672
  s_nop 0
  buffer_load_dwordx4 v13, s[12:15], s39 offen lds
  s_add_u32 m0, s45, 32768
  s_nop 0
  buffer_load_dwordx4 v14, s[12:15], s39 offen lds
  s_waitcnt vmcnt(9)
  s_barrier
  s_add_u32 s39, s44, 589824
  s_add_u32 m0, s45, 36864
  s_nop 0
  buffer_load_dwordx4 v12, s[12:15], s39 offen lds
  s_add_u32 m0, s45, 40960
  s_nop 0
  buffer_load_dwordx4 v13, s[12:15], s39 offen lds
  s_add_u32 m0, s45, 45056
  s_nop 0
  buffer_load_dwordx4 v14, s[12:15], s39 offen lds
  s_waitcnt vmcnt(9)
  s_barrier
  s_add_u32 s39, s44, 786432
  s_add_u32 m0, s45, 49152
  s_nop 0
  buffer_load_dwordx4 v12, s[12:15], s39 offen lds
  s_add_u32 m0, s45, 53248
  s_nop 0
  buffer_load_dwordx4 v13, s[12:15], s39 offen lds
  s_add_u32 m0, s45, 57344
  s_nop 0
  buffer_load_dwordx4 v14, s[12:15], s39 offen lds
  s_waitcnt vmcnt(9)
  s_barrier
  s_add_u32 s39, s44, 983040
  s_add_u32 m0, s45, 0
  s_nop 0
  buffer_load_dwordx4 v12, s[12:15], s39 offen lds
  s_add_u32 m0, s45, 4096
  s_nop 0
  buffer_load_dwordx4 v13, s[12:15], s39 offen lds
  s_add_u32 m0, s45, 8192
  s_nop 0
  buffer_load_dwordx4 v14, s[12:15], s39 offen lds
  s_waitcnt vmcnt(9)
  s_barrier
  s_add_u32 s39, s44, 1179648
  s_add_u32 m0, s45, 12288
  s_nop 0
  buffer_load_dwordx4 v12, s[12:15], s39 offen lds
  s_add_u32 m0, s45, 16384
  s_nop 0
  buffer_load_dwordx4 v13, s[12:15], s39 offen lds
  s_add_u32 m0, s45, 20480
  s_nop 0
  buffer_load_dwordx4 v14, s[12:15], s39 offen lds
  s_waitcnt vmcnt(9)
  s_barrier
  s_add_u32 s39, s44, 1376256
  s_add_u32 m0, s45, 24576
  s_nop 0
  buffer_load_dwordx4 v12, s[12:15], s39 offen lds
  s_add_u32 m0, s45, 28672
  s_nop 0
  buffer_load_dwordx4 v13, s[12:15], s39 offen lds
  s_add_u32 m0, s45, 32768
  s_nop 0
  buffer_load_dwordx4 v14, s[12:15], s39 offen lds
  s_waitcnt vmcnt(9)
  s_barrier
  s_add_u32 s39, s44, 1572864
  s_add_u32 m0, s45, 36864
  s_nop 0
  buffer_load_dwordx4 v12, s[12:15], s39 offen lds
  s_add_u32 m0, s45, 40960
  s_nop 0
  buffer_load_dwordx4 v13, s[12:15], s39 offen lds
  s_add_u32 m0, s45, 45056
  s_nop 0
  buffer_load_dwordx4 v14, s[12:15], s39 offen lds
  s_waitcnt vmcnt(9)
  s_barrier
  s_add_u32 s39, s44, 1769472
  s_add_u32 m0, s45, 49152
  s_nop 0
  buffer_load_dwordx4 v12, s[12:15], s39 offen lds
  s_add_u32 m0, s45, 53248
  s_nop 0
  buffer_load_dwordx4 v13, s[12:15], s39 offen lds
  s_add_u32 m0, s45, 57344
  s_nop 0
  buffer_load_dwordx4 v14, s[12:15], s39 offen lds
  s_and_b32 s40, s2, 7
  s_lshr_b32 s40, s40, 1
  s_lshl_b32 s40, s40, 9
  s_lshr_b32 s41, s2, 3
  s_lshl_b32 s41, s41, 4
  s_add_u32 s40, s40, s41
  s_lshl_b32 s41, s55, 2
  s_add_u32 s40, s40, s41
  s_lshl_b32 s40, s40, 12
  v_lshlrev_b32 v30, 6, v1
  s_mov_b32 s20, s78
  s_and_b32 s21, s79, 0xffff
  s_mov_b32 s22, 8388608
  s_mov_b32 s23, 0x20000
  buffer_load_dword v31, v30, s[20:23], s40 offen
  s_add_u32 s40, s40, 4096
  buffer_load_dword v32, v30, s[20:23], s40 offen
  s_add_u32 s40, s40, 4096
  buffer_load_dword v33, v30, s[20:23], s40 offen
  s_add_u32 s40, s40, 4096
  buffer_load_dword v34, v30, s[20:23], s40 offen
  s_add_u32 s40, s40, 4096
  s_waitcnt vmcnt(13)
  s_barrier
  s_waitcnt vmcnt(10)
  s_barrier
  s_waitcnt vmcnt(7)
  s_barrier
  s_waitcnt vmcnt(4)
  s_barrier
  s_barrier
  s_barrier
  s_endpgm
K1_AB:
  v_lshrrev_b32 v17, 1, v3
  v_xor_b32 v17, v17, v2
  v_lshlrev_b32 v17, 4, v17
  v_lshlrev_b32 v18, 7, v3
  v_add_u32 v17, v17, v18
  v_xor_b32 v18, 64, v17
  s_lshl_b32 s40, s35, 12
  s_lshl_b32 s41, s36, 11
  s_add_u32 s42, s40, s41
  s_add_u32 s42, s42, 61440
  v_add_u32 v4, s42, v17
  v_add_u32 v5, s42, v18
  s_xor_b32 s41, s41, 2048
  s_add_u32 s42, s40, s41
  s_add_u32 s42, s42, 61440
  v_add_u32 v6, s42, v17
  v_add_u32 v7, s42, v18
  v_lshrrev_b32 v17, 2, v1
  v_and_b32 v17, 3, v17
  v_lshlrev_b32 v18, 3, v2
  v_add_u32 v17, v17, v18
  v_mul_u32_u24 v17, 192, v17
  v_and_b32 v18, 3, v1
  v_lshlrev_b32 v18, 3, v18
  v_add_u32 v17, v17, v18
  v_and_b32 v19, 1, v2
  s_mul_i32 s40, s36, 3
  s_add_u32 s41, s40, 0
  v_xor_b32 v18, s41, v19
  v_lshlrev_b32 v18, 5, v18
  v_add_u32 v8, v17, v18
  s_add_u32 s41, s40, 1
  v_xor_b32 v18, s41, v19
  v_lshlrev_b32 v18, 5, v18
  v_add_u32 v9, v17, v18
  s_add_u32 s41, s40, 2
  v_xor_b32 v18, s41, v19
  v_lshlrev_b32 v18, 5, v18
  v_add_u32 v10, v17, v18
  s_mov_b32 s48, 0xbdd2d3e8
  s_mov_b32 s49, 0xbdd2d3e8
  s_mov_b32 s50, 1.0
  s_mov_b32 s51, 1.0
  s_waitcnt lgkmcnt(0)
  s_mov_b32 s16, s74
  s_and_b32 s17, s75, 0xffff
  s_mov_b32 s18, 18874368
  s_mov_b32 s19, 0x20000
  s_mov_b32 s56, s72
  s_and_b32 s57, s73, 0xffff
  s_mov_b32 s58, 256
  s_mov_b32 s59, 0x20000
  s_cmp_ge_u32 s34, 4
  s_cbranch_scc1 K1_B
  v_mov_b32 v102, 0x3f803f80
  v_mov_b32 v103, 0x3f803f80
  v_mov_b32 v104, 0x3f803f80
  v_mov_b32 v105, 0x3f803f80
  v_mov_b32 v66, 0
  v_mov_b32 v67, 0
  v_mov_b32 v68, 0
  v_mov_b32 v69, 0
  v_mov_b32 v70, 0
  v_mov_b32 v71, 0
  v_mov_b32 v72, 0
  v_mov_b32 v73, 0
  v_mov_b32 v74, 0
  v_mov_b32 v75, 0
  v_mov_b32 v76, 0
  v_mov_b32 v77, 0
  v_mov_b32 v78, 0
  v_mov_b32 v79, 0
  v_mov_b32 v80, 0
  v_mov_b32 v81, 0
  v_mov_b32 v82, 0
  v_mov_b32 v83, 0
  v_mov_b32 v84, 0
  v_mov_b32 v85, 0
  v_mov_b32 v86, 0
  v_mov_b32 v87, 0
  v_mov_b32 v88, 0
  v_mov_b32 v89, 0
  v_mov_b32 v90, 0
  v_mov_b32 v91, 0
  v_mov_b32 v92, 0
  v_mov_b32 v93, 0
  v_mov_b32 v94, 0
  v_mov_b32 v95, 0
  v_mov_b32 v96, 0
  v_mov_b32 v97, 0
  v_mov_b32 v98, 0
  v_mov_b32 v99, 0
  v_mov_b32 v100, 0
  v_mov_b32 v101, 0
  v_mov_b32 v106, 0
  v_mov_b32 v107, 0
  v_mov_b32 v108, 0
  v_mov_b32 v109, 0
  v_mov_b32 v110, 0
  v_mov_b32 v111, 0
  v_mov_b32 v112, 0
  v_mov_b32 v113, 0
  s_barrier
  s_mov_b32 s37, 0
  ds_read_b128 v[26:29], v4 offset:0
  ds_read_b64_tr_b16 v[42:43], v8 offset:0
  ds_read_b64_tr_b16 v[44:45], v8 offset:768
  ds_read_b128 v[30:33], v6 offset:0
  ds_read_b64_tr_b16 v[46:47], v9 offset:0
  ds_read_b64_tr_b16 v[48:49], v9 offset:768
  ds_read_b64_tr_b16 v[50:51], v10 offset:0
  ds_read_b64_tr_b16 v[52:53], v10 offset:768
K1_LOOP1:
  s_waitcnt lgkmcnt(0)
  v_mfma_f32_16x16x32_bf16 v[66:69], v[26:29], v[42:45], v[66:69]
  ds_read_b128 v[34:37], v5 offset:0
  ds_read_b64_tr_b16 v[54:55], v8 offset:6144
  v_mfma_f32_16x16x32_bf16 v[78:81], v[30:33], v[42:45], v[78:81]
  ds_read_b64_tr_b16 v[56:57], v8 offset:6912
  ds_read_b128 v[38:41], v7 offset:0
  v_mfma_f32_16x16x32_bf16 v[70:73], v[26:29], v[46:49], v[70:73]
  ds_read_b64_tr_b16 v[58:59], v9 offset:6144
  ds_read_b64_tr_b16 v[60:61], v9 offset:6912
  v_mfma_f32_16x16x32_bf16 v[82:85], v[30:33], v[46:49], v[82:85]
  ds_read_b64_tr_b16 v[62:63], v10 offset:6144
  ds_read_b64_tr_b16 v[64:65], v10 offset:6912
  v_mfma_f32_16x16x32_bf16 v[74:77], v[26:29], v[50:53], v[74:77]
  v_mfma_f32_16x16x32_bf16 v[86:89], v[30:33], v[50:53], v[86:89]
  v_mfma_f32_16x16x32_bf16 v[106:109], v[102:105], v[26:29], v[106:109]
  v_mfma_f32_16x16x32_bf16 v[110:113], v[26:29], v[26:29], v[110:113]
  s_cmp_eq_u32 s35, 0
  s_cbranch_scc0 K1_SK_1a0
  v_mfma_f32_16x16x32_bf16 v[90:93], v[102:105], v[42:45], v[90:93]
  v_mfma_f32_16x16x32_bf16 v[94:97], v[102:105], v[46:49], v[94:97]
  v_mfma_f32_16x16x32_bf16 v[98:101], v[102:105], v[50:53], v[98:101]
K1_SK_1a0:
  s_waitcnt lgkmcnt(0)
  s_barrier
  v_mfma_f32_16x16x32_bf16 v[66:69], v[34:37], v[54:57], v[66:69]
  ds_read_b128 v[26:29], v4 offset:8192
  ds_read_b64_tr_b16 v[42:43], v8 offset:12288
  v_mfma_f32_16x16x32_bf16 v[78:81], v[38:41], v[54:57], v[78:81]
  ds_read_b64_tr_b16 v[44:45], v8 offset:13056
  ds_read_b128 v[30:33], v6 offset:8192
  v_mfma_f32_16x16x32_bf16 v[70:73], v[34:37], v[58:61], v[70:73]
  ds_read_b64_tr_b16 v[46:47], v9 offset:12288
  ds_read_b64_tr_b16 v[48:49], v9 offset:13056
  v_mfma_f32_16x16x32_bf16 v[82:85], v[38:41], v[58:61], v[82:85]
  ds_read_b64_tr_b16 v[50:51], v10 offset:12288
  ds_read_b64_tr_b16 v[52:53], v10 offset:13056
  v_mfma_f32_16x16x32_bf16 v[74:77], v[34:37], v[62:65], v[74:77]
  v_mfma_f32_16x16x32_bf16 v[86:89], v[38:41], v[62:65], v[86:89]
  v_mfma_f32_16x16x32_bf16 v[106:109], v[102:105], v[34:37], v[106:109]
  v_mfma_f32_16x16x32_bf16 v[110:113], v[34:37], v[34:37], v[110:113]
  s_cmp_eq_u32 s35, 1
  s_cbranch_scc0 K1_SK_1b0
  v_mfma_f32_16x16x32_bf16 v[90:93], v[102:105], v[54:57], v[90:93]
  v_mfma_f32_16x16x32_bf16 v[94:97], v[102:105], v[58:61], v[94:97]
  v_mfma_f32_16x16x32_bf16 v[98:101], v[102:105], v[62:65], v[98:101]
K1_SK_1b0:
  s_waitcnt lgkmcnt(0)
  v_mfma_f32_16x16x32_bf16 v[66:69], v[26:29], v[42:45], v[66:69]
  ds_read_b128 v[34:37], v5 offset:8192
  ds_read_b64_tr_b16 v[54:55], v8 offset:18432
  v_mfma_f32_16x16x32_bf16 v[78:81], v[30:33], v[42:45], v[78:81]
  ds_read_b64_tr_b16 v[56:57], v8 offset:19200
  ds_read_b128 v[38:41], v7 offset:8192
  v_mfma_f32_16x16x32_bf16 v[70:73], v[26:29], v[46:49], v[70:73]
  ds_read_b64_tr_b16 v[58:59], v9 offset:18432
  ds_read_b64_tr_b16 v[60:61], v9 offset:19200
  v_mfma_f32_16x16x32_bf16 v[82:85], v[30:33], v[46:49], v[82:85]
  ds_read_b64_tr_b16 v[62:63], v10 offset:18432
  ds_read_b64_tr_b16 v[64:65], v10 offset:19200
  v_mfma_f32_16x16x32_bf16 v[74:77], v[26:29], v[50:53], v[74:77]
  v_mfma_f32_16x16x32_bf16 v[86:89], v[30:33], v[50:53], v[86:89]
  v_mfma_f32_16x16x32_bf16 v[106:109], v[102:105], v[26:29], v[106:109]
  v_mfma_f32_16x16x32_bf16 v[110:113], v[26:29], v[26:29], v[110:113]
  s_cmp_eq_u32 s35, 0
  s_cbranch_scc0 K1_SK_1a1
  v_mfma_f32_16x16x32_bf16 v[90:93], v[102:105], v[42:45], v[90:93]
  v_mfma_f32_16x16x32_bf16 v[94:97], v[102:105], v[46:49], v[94:97]
  v_mfma_f32_16x16x32_bf16 v[98:101], v[102:105], v[50:53], v[98:101]
K1_SK_1a1:
  s_waitcnt lgkmcnt(0)
  s_barrier
  v_mfma_f32_16x16x32_bf16 v[66:69], v[34:37], v[54:57], v[66:69]
  ds_read_b128 v[26:29], v4 offset:16384
  ds_read_b64_tr_b16 v[42:43], v8 offset:24576
  v_mfma_f32_16x16x32_bf16 v[78:81], v[38:41], v[54:57], v[78:81]
  ds_read_b64_tr_b16 v[44:45], v8 offset:25344
  ds_read_b128 v[30:33], v6 offset:16384
  v_mfma_f32_16x16x32_bf16 v[70:73], v[34:37], v[58:61], v[70:73]
  ds_read_b64_tr_b16 v[46:47], v9 offset:24576
  ds_read_b64_tr_b16 v[48:49], v9 offset:25344
  v_mfma_f32_16x16x32_bf16 v[82:85], v[38:41], v[58:61], v[82:85]
  ds_read_b64_tr_b16 v[50:51], v10 offset:24576
  ds_read_b64_tr_b16 v[52:53], v10 offset:25344
  v_mfma_f32_16x16x32_bf16 v[74:77], v[34:37], v[62:65], v[74:77]
  v_mfma_f32_16x16x32_bf16 v[86:89], v[38:41], v[62:65], v[86:89]
  v_mfma_f32_16x16x32_bf16 v[106:109], v[102:105], v[34:37], v[106:109]
  v_mfma_f32_16x16x32_bf16 v[110:113], v[34:37], v[34:37], v[110:113]
  s_cmp_eq_u32 s35, 1
  s_cbranch_scc0 K1_SK_1b1
  v_mfma_f32_16x16x32_bf16 v[90:93], v[102:105], v[54:57], v[90:93]
  v_mfma_f32_16x16x32_bf16 v[94:97], v[102:105], v[58:61], v[94:97]
  v_mfma_f32_16x16x32_bf16 v[98:101], v[102:105], v[62:65], v[98:101]
K1_SK_1b1:
  s_waitcnt lgkmcnt(0)
  v_mfma_f32_16x16x32_bf16 v[66:69], v[26:29], v[42:45], v[66:69]
  ds_read_b128 v[34:37], v5 offset:16384
  ds_read_b64_tr_b16 v[54:55], v8 offset:30720
  v_mfma_f32_16x16x32_bf16 v[78:81], v[30:33], v[42:45], v[78:81]
  ds_read_b64_tr_b16 v[56:57], v8 offset:31488
  ds_read_b128 v[38:41], v7 offset:16384
  v_mfma_f32_16x16x32_bf16 v[70:73], v[26:29], v[46:49], v[70:73]
  ds_read_b64_tr_b16 v[58:59], v9 offset:30720
  ds_read_b64_tr_b16 v[60:61], v9 offset:31488
  v_mfma_f32_16x16x32_bf16 v[82:85], v[30:33], v[46:49], v[82:85]
  ds_read_b64_tr_b16 v[62:63], v10 offset:30720
  ds_read_b64_tr_b16 v[64:65], v10 offset:31488
  v_mfma_f32_16x16x32_bf16 v[74:77], v[26:29], v[50:53], v[74:77]
  v_mfma_f32_16x16x32_bf16 v[86:89], v[30:33], v[50:53], v[86:89]
  v_mfma_f32_16x16x32_bf16 v[106:109], v[102:105], v[26:29], v[106:109]
  v_mfma_f32_16x16x32_bf16 v[110:113], v[26:29], v[26:29], v[110:113]
  s_cmp_eq_u32 s35, 0
  s_cbranch_scc0 K1_SK_1a2
  v_mfma_f32_16x16x32_bf16 v[90:93], v[102:105], v[42:45], v[90:93]
  v_mfma_f32_16x16x32_bf16 v[94:97], v[102:105], v[46:49], v[94:97]
  v_mfma_f32_16x16x32_bf16 v[98:101], v[102:105], v[50:53], v[98:101]
K1_SK_1a2:
  s_waitcnt lgkmcnt(0)
  s_barrier
  v_mfma_f32_16x16x32_bf16 v[66:69], v[34:37], v[54:57], v[66:69]
  ds_read_b128 v[26:29], v4 offset:24576
  ds_read_b64_tr_b16 v[42:43], v8 offset:36864
  v_mfma_f32_16x16x32_bf16 v[78:81], v[38:41], v[54:57], v[78:81]
  ds_read_b64_tr_b16 v[44:45], v8 offset:37632
  ds_read_b128 v[30:33], v6 offset:24576
  v_mfma_f32_16x16x32_bf16 v[70:73], v[34:37], v[58:61], v[70:73]
  ds_read_b64_tr_b16 v[46:47], v9 offset:36864
  ds_read_b64_tr_b16 v[48:49], v9 offset:37632
  v_mfma_f32_16x16x32_bf16 v[82:85], v[38:41], v[58:61], v[82:85]
  ds_read_b64_tr_b16 v[50:51], v10 offset:36864
  ds_read_b64_tr_b16 v[52:53], v10 offset:37632
  v_mfma_f32_16x16x32_bf16 v[74:77], v[34:37], v[62:65], v[74:77]
  v_mfma_f32_16x16x32_bf16 v[86:89], v[38:41], v[62:65], v[86:89]
  v_mfma_f32_16x16x32_bf16 v[106:109], v[102:105], v[34:37], v[106:109]
  v_mfma_f32_16x16x32_bf16 v[110:113], v[34:37], v[34:37], v[110:113]
  s_cmp_eq_u32 s35, 1
  s_cbranch_scc0 K1_SK_1b2
  v_mfma_f32_16x16x32_bf16 v[90:93], v[102:105], v[54:57], v[90:93]
  v_mfma_f32_16x16x32_bf16 v[94:97], v[102:105], v[58:61], v[94:97]
  v_mfma_f32_16x16x32_bf16 v[98:101], v[102:105], v[62:65], v[98:101]
K1_SK_1b2:
  s_waitcnt lgkmcnt(0)
  v_mfma_f32_16x16x32_bf16 v[66:69], v[26:29], v[42:45], v[66:69]
  ds_read_b128 v[34:37], v5 offset:24576
  ds_read_b64_tr_b16 v[54:55], v8 offset:43008
  v_mfma_f32_16x16x32_bf16 v[78:81], v[30:33], v[42:45], v[78:81]
  ds_read_b64_tr_b16 v[56:57], v8 offset:43776
  ds_read_b128 v[38:41], v7 offset:24576
  v_mfma_f32_16x16x32_bf16 v[70:73], v[26:29], v[46:49], v[70:73]
  ds_read_b64_tr_b16 v[58:59], v9 offset:43008
  ds_read_b64_tr_b16 v[60:61], v9 offset:43776
  v_mfma_f32_16x16x32_bf16 v[82:85], v[30:33], v[46:49], v[82:85]
  ds_read_b64_tr_b16 v[62:63], v10 offset:43008
  ds_read_b64_tr_b16 v[64:65], v10 offset:43776
  v_mfma_f32_16x16x32_bf16 v[74:77], v[26:29], v[50:53], v[74:77]
  v_mfma_f32_16x16x32_bf16 v[86:89], v[30:33], v[50:53], v[86:89]
  v_mfma_f32_16x16x32_bf16 v[106:109], v[102:105], v[26:29], v[106:109]
  v_mfma_f32_16x16x32_bf16 v[110:113], v[26:29], v[26:29], v[110:113]
  s_cmp_eq_u32 s35, 0
  s_cbranch_scc0 K1_SK_1a3
  v_mfma_f32_16x16x32_bf16 v[90:93], v[102:105], v[42:45], v[90:93]
  v_mfma_f32_16x16x32_bf16 v[94:97], v[102:105], v[46:49], v[94:97]
  v_mfma_f32_16x16x32_bf16 v[98:101], v[102:105], v[50:53], v[98:101]
K1_SK_1a3:
  s_waitcnt lgkmcnt(0)
  s_barrier
  v_mfma_f32_16x16x32_bf16 v[66:69], v[34:37], v[54:57], v[66:69]
  ds_read_b128 v[26:29], v4 offset:32768
  ds_read_b64_tr_b16 v[42:43], v8 offset:49152
  v_mfma_f32_16x16x32_bf16 v[78:81], v[38:41], v[54:57], v[78:81]
  ds_read_b64_tr_b16 v[44:45], v8 offset:49920
  ds_read_b128 v[30:33], v6 offset:32768
  v_mfma_f32_16x16x32_bf16 v[70:73], v[34:37], v[58:61], v[70:73]
  ds_read_b64_tr_b16 v[46:47], v9 offset:49152
  ds_read_b64_tr_b16 v[48:49], v9 offset:49920
  v_mfma_f32_16x16x32_bf16 v[82:85], v[38:41], v[58:61], v[82:85]
  ds_read_b64_tr_b16 v[50:51], v10 offset:49152
  ds_read_b64_tr_b16 v[52:53], v10 offset:49920
  v_mfma_f32_16x16x32_bf16 v[74:77], v[34:37], v[62:65], v[74:77]
  v_mfma_f32_16x16x32_bf16 v[86:89], v[38:41], v[62:65], v[86:89]
  v_mfma_f32_16x16x32_bf16 v[106:109], v[102:105], v[34:37], v[106:109]
  v_mfma_f32_16x16x32_bf16 v[110:113], v[34:37], v[34:37], v[110:113]
  s_cmp_eq_u32 s35, 1
  s_cbranch_scc0 K1_SK_1b3
  v_mfma_f32_16x16x32_bf16 v[90:93], v[102:105], v[54:57], v[90:93]
  v_mfma_f32_16x16x32_bf16 v[94:97], v[102:105], v[58:61], v[94:97]
  v_mfma_f32_16x16x32_bf16 v[98:101], v[102:105], v[62:65], v[98:101]
K1_SK_1b3:
  s_waitcnt lgkmcnt(0)
  v_mfma_f32_16x16x32_bf16 v[66:69], v[26:29], v[42:45], v[66:69]
  ds_read_b128 v[34:37], v5 offset:32768
  ds_read_b64_tr_b16 v[54:55], v8 offset:55296
  v_mfma_f32_16x16x32_bf16 v[78:81], v[30:33], v[42:45], v[78:81]
  ds_read_b64_tr_b16 v[56:57], v8 offset:56064
  ds_read_b128 v[38:41], v7 offset:32768
  v_mfma_f32_16x16x32_bf16 v[70:73], v[26:29], v[46:49], v[70:73]
  ds_read_b64_tr_b16 v[58:59], v9 offset:55296
  ds_read_b64_tr_b16 v[60:61], v9 offset:56064
  v_mfma_f32_16x16x32_bf16 v[82:85], v[30:33], v[46:49], v[82:85]
  ds_read_b64_tr_b16 v[62:63], v10 offset:55296
  ds_read_b64_tr_b16 v[64:65], v10 offset:56064
  v_mfma_f32_16x16x32_bf16 v[74:77], v[26:29], v[50:53], v[74:77]
  v_mfma_f32_16x16x32_bf16 v[86:89], v[30:33], v[50:53], v[86:89]
  v_mfma_f32_16x16x32_bf16 v[106:109], v[102:105], v[26:29], v[106:109]
  v_mfma_f32_16x16x32_bf16 v[110:113], v[26:29], v[26:29], v[110:113]
  s_cmp_eq_u32 s35, 0
  s_cbranch_scc0 K1_SK_1a4
  v_mfma_f32_16x16x32_bf16 v[90:93], v[102:105], v[42:45], v[90:93]
  v_mfma_f32_16x16x32_bf16 v[94:97], v[102:105], v[46:49], v[94:97]
  v_mfma_f32_16x16x32_bf16 v[98:101], v[102:105], v[50:53], v[98:101]
K1_SK_1a4:
  s_waitcnt lgkmcnt(0)
  s_barrier
  v_add_u32 v4, 40960, v4
  v_add_u32 v5, 40960, v5
  v_add_u32 v6, 40960, v6
  v_add_u32 v7, 40960, v7
  v_mfma_f32_16x16x32_bf16 v[66:69], v[34:37], v[54:57], v[66:69]
  ds_read_b128 v[26:29], v4 offset:0
  ds_read_b64_tr_b16 v[42:43], v8 offset:0
  v_mfma_f32_16x16x32_bf16 v[78:81], v[38:41], v[54:57], v[78:81]
  ds_read_b64_tr_b16 v[44:45], v8 offset:768
  ds_read_b128 v[30:33], v6 offset:0
  v_mfma_f32_16x16x32_bf16 v[70:73], v[34:37], v[58:61], v[70:73]
  ds_read_b64_tr_b16 v[46:47], v9 offset:0
  ds_read_b64_tr_b16 v[48:49], v9 offset:768
  v_mfma_f32_16x16x32_bf16 v[82:85], v[38:41], v[58:61], v[82:85]
  ds_read_b64_tr_b16 v[50:51], v10 offset:0
  ds_read_b64_tr_b16 v[52:53], v10 offset:768
  v_mfma_f32_16x16x32_bf16 v[74:77], v[34:37], v[62:65], v[74:77]
  v_mfma_f32_16x16x32_bf16 v[86:89], v[38:41], v[62:65], v[86:89]
  v_mfma_f32_16x16x32_bf16 v[106:109], v[102:105], v[34:37], v[106:109]
  v_mfma_f32_16x16x32_bf16 v[110:113], v[34:37], v[34:37], v[110:113]
  s_cmp_eq_u32 s35, 1
  s_cbranch_scc0 K1_SK_1b4
  v_mfma_f32_16x16x32_bf16 v[90:93], v[102:105], v[54:57], v[90:93]
  v_mfma_f32_16x16x32_bf16 v[94:97], v[102:105], v[58:61], v[94:97]
  v_mfma_f32_16x16x32_bf16 v[98:101], v[102:105], v[62:65], v[98:101]
K1_SK_1b4:
  s_add_u32 s37, s37, 1
  s_cmp_lt_u32 s37, 2
  s_cbranch_scc1 K1_LOOP1
  s_setprio 2
  s_lshl_b32 s40, s32, 2
  v_mov_b32 v22, s40
  buffer_load_dword v23, v22, s[56:59], 0 offen sc1
  v_and_b32 v14, 3, v3
  v_cmp_eq_u32 vcc, 1, v14
  s_nop 1
  v_cndmask_b32 v110, v110, v111, vcc
  v_cmp_eq_u32 vcc, 2, v14
  s_nop 1
  v_cndmask_b32 v110, v110, v112, vcc
  v_cmp_eq_u32 vcc, 3, v14
  s_nop 1
  v_cndmask_b32 v110, v110, v113, vcc
  v_mul_f32 v16, 0x3acccccd, v106
  v_mul_f32 v18, 0x3acccccd, v110
  v_fma_f32 v18, -v16, v16, v18
  v_max_f32 v18, 0, v18
  v_cvt_pk_bf16_f32 v16, v16, v16
  v_lshlrev_b32 v16, 16, v16
  v_cvt_pk_bf16_f32 v18, v18, v18
  v_lshlrev_b32 v18, 16, v18
  v_add_f32 v18, 0x3727c5ac, v18
  v_cvt_pk_bf16_f32 v18, v18, v18
  v_lshlrev_b32 v18, 16, v18
  v_sqrt_f32 v18, v18
  s_nop 0
  v_cvt_pk_bf16_f32 v18, v18, v18
  v_lshlrev_b32 v18, 16, v18
  v_rcp_f32 v17, v18
  s_lshl_b32 s40, s35, 5
  s_lshl_b32 s41, s36, 4
  s_add_u32 s40, s40, s41
  v_add_u32 v18, s40, v3
  v_lshlrev_b32 v19, 2, v18
  v_add_u32 v19, 143360, v19
  s_mov_b32 exec_lo, 0xf0000f
  s_mov_b32 exec_hi, 0xf0000f00
  ds_write_b32 v19, v16
  ds_write_b32 v19, v17 offset:256
  s_cmp_eq_u32 s33, 0
  s_cbranch_scc0 K1_NOST1X
  s_lshl_b32 s41, s32, 9
  s_add_u32 s41, s41, 16777216
  v_lshlrev_b32 v18, 3, v18
  buffer_store_dwordx2 v[16:17], v18, s[16:19], s41 offen
K1_NOST1X:
  s_mov_b64 exec, s[52:53]
  s_mul_i32 s40, s55, 192
  s_add_u32 s40, s40, 143872
  v_lshlrev_b32 v20, 2, v3
  v_add_u32 v20, s40, v20
  ds_write_b32 v20, v90 offset:0
  ds_write_b32 v20, v94 offset:64
  ds_write_b32 v20, v98 offset:128
  s_waitcnt lgkmcnt(0)
  s_barrier
  s_xor_b32 s41, s55, 2
  s_mul_i32 s41, s41, 192
  s_add_u32 s41, s41, 143872
  v_lshlrev_b32 v18, 2, v3
  v_add_u32 v18, s41, v18
  ds_read_b32 v136, v18 offset:0
  ds_read_b32 v138, v18 offset:64
  ds_read_b32 v140, v18 offset:128
  s_lshl_b32 s40, s35, 7
  s_lshl_b32 s41, s36, 6
  s_add_u32 s40, s40, s41
  s_add_u32 s40, s40, 143360
  v_lshlrev_b32 v19, 4, v2
  v_add_u32 v19, s40, v19
  v_xor_b32 v20, 64, v19
  ds_read_b128 v[26:29], v19
  ds_read_b128 v[30:33], v20
  ds_read_b128 v[34:37], v19 offset:256
  ds_read_b128 v[38:41], v20 offset:256
  v_mov_b32 v126, 0xc0135761
  v_mov_b32 v127, 0xc0135761
  v_mov_b32 v42, 0
  v_mov_b32 v43, 0
  v_mov_b32 v44, 0
  v_mov_b32 v45, 0
  v_mov_b32 v46, 0
  v_mov_b32 v47, 0
  v_mov_b32 v48, 0
  v_mov_b32 v49, 0
  v_mov_b32 v50, 0
  v_mov_b32 v51, 0
  v_mov_b32 v52, 0
  v_mov_b32 v53, 0
  v_mov_b32 v54, 0
  v_mov_b32 v55, 0
  v_mov_b32 v56, 0
  v_mov_b32 v57, 0
  s_waitcnt lgkmcnt(0)
  v_add_f32 v136, v136, v90
  v_sub_f32 v136, 0, v136
  v_add_f32 v138, v138, v94
  v_sub_f32 v138, 0, v138
  v_add_f32 v140, v140, v98
  v_sub_f32 v140, 0, v140
  v_fma_f32 v66, v26, v136, v66
  v_fma_f32 v67, v27, v136, v67
  v_mul_f32 v66, v66, v34
  v_mul_f32 v67, v67, v35
  v_mul_f32 v128, v66, v66
  v_mul_f32 v129, v67, v67
  v_fma_f32 v128, v128, s48, v126
  v_fma_f32 v129, v129, s48, v126
  v_mul_f32 v128, v128, v66
  v_mul_f32 v129, v129, v67
  v_exp_f32 v128, v128
  v_exp_f32 v129, v129
  v_add_f32 v128, 1.0, v128
  v_add_f32 v129, 1.0, v129
  v_rcp_f32 v128, v128
  v_rcp_f32 v129, v129
  v_mul_f32 v128, v128, v66
  v_mul_f32 v129, v129, v67
  v_cvt_pk_bf16_f32 v114, v128, v129
  v_add_f32 v42, v42, v128
  v_add_f32 v43, v43, v129
  v_fma_f32 v50, v128, v128, v50
  v_fma_f32 v51, v129, v129, v51
  v_fma_f32 v68, v28, v136, v68
  v_fma_f32 v69, v29, v136, v69
  v_mul_f32 v68, v68, v36
  v_mul_f32 v69, v69, v37
  v_mul_f32 v132, v68, v68
  v_mul_f32 v133, v69, v69
  v_fma_f32 v132, v132, s48, v126
  v_fma_f32 v133, v133, s48, v126
  v_mul_f32 v132, v132, v68
  v_mul_f32 v133, v133, v69
  v_exp_f32 v132, v132
  v_exp_f32 v133, v133
  v_add_f32 v132, 1.0, v132
  v_add_f32 v133, 1.0, v133
  v_rcp_f32 v132, v132
  v_rcp_f32 v133, v133
  v_mul_f32 v132, v132, v68
  v_mul_f32 v133, v133, v69
  v_cvt_pk_bf16_f32 v115, v132, v133
  v_add_f32 v44, v44, v132
  v_add_f32 v45, v45, v133
  v_fma_f32 v52, v132, v132, v52
  v_fma_f32 v53, v133, v133, v53
  s_barrier
  v_fma_f32 v78, v30, v136, v78
  v_fma_f32 v79, v31, v136, v79
  v_mul_f32 v78, v78, v38
  v_mul_f32 v79, v79, v39
  v_mul_f32 v128, v78, v78
  v_mul_f32 v129, v79, v79
  v_fma_f32 v128, v128, s48, v126
  v_fma_f32 v129, v129, s48, v126
  v_mul_f32 v128, v128, v78
  v_mul_f32 v129, v129, v79
  v_exp_f32 v128, v128
  v_exp_f32 v129, v129
  v_add_f32 v128, 1.0, v128
  v_add_f32 v129, 1.0, v129
  v_rcp_f32 v128, v128
  v_rcp_f32 v129, v129
  v_mul_f32 v128, v128, v78
  v_mul_f32 v129, v129, v79
  v_cvt_pk_bf16_f32 v116, v128, v129
  v_add_f32 v46, v46, v128
  v_add_f32 v47, v47, v129
  v_fma_f32 v54, v128, v128, v54
  v_fma_f32 v55, v129, v129, v55
  v_fma_f32 v80, v32, v136, v80
  v_fma_f32 v81, v33, v136, v81
  v_mul_f32 v80, v80, v40
  v_mul_f32 v81, v81, v41
  v_mul_f32 v132, v80, v80
  v_mul_f32 v133, v81, v81
  v_fma_f32 v132, v132, s48, v126
  v_fma_f32 v133, v133, s48, v126
  v_mul_f32 v132, v132, v80
  v_mul_f32 v133, v133, v81
  v_exp_f32 v132, v132
  v_exp_f32 v133, v133
  v_add_f32 v132, 1.0, v132
  v_add_f32 v133, 1.0, v133
  v_rcp_f32 v132, v132
  v_rcp_f32 v133, v133
  v_mul_f32 v132, v132, v80
  v_mul_f32 v133, v133, v81
  v_cvt_pk_bf16_f32 v117, v132, v133
  v_add_f32 v48, v48, v132
  v_add_f32 v49, v49, v133
  v_fma_f32 v56, v132, v132, v56
  v_fma_f32 v57, v133, v133, v57
  v_fma_f32 v70, v26, v138, v70
  v_fma_f32 v71, v27, v138, v71
  v_mul_f32 v70, v70, v34
  v_mul_f32 v71, v71, v35
  v_mul_f32 v128, v70, v70
  v_mul_f32 v129, v71, v71
  v_fma_f32 v128, v128, s48, v126
  v_fma_f32 v129, v129, s48, v126
  v_mul_f32 v128, v128, v70
  v_mul_f32 v129, v129, v71
  v_exp_f32 v128, v128
  v_exp_f32 v129, v129
  v_add_f32 v128, 1.0, v128
  v_add_f32 v129, 1.0, v129
  v_rcp_f32 v128, v128
  v_rcp_f32 v129, v129
  v_mul_f32 v128, v128, v70
  v_mul_f32 v129, v129, v71
  v_cvt_pk_bf16_f32 v118, v128, v129
  v_add_f32 v42, v42, v128
  v_add_f32 v43, v43, v129
  v_fma_f32 v50, v128, v128, v50
  v_fma_f32 v51, v129, v129, v51
  s_barrier
  v_fma_f32 v72, v28, v138, v72
  v_fma_f32 v73, v29, v138, v73
  v_mul_f32 v72, v72, v36
  v_mul_f32 v73, v73, v37
  v_mul_f32 v132, v72, v72
  v_mul_f32 v133, v73, v73
  v_fma_f32 v132, v132, s48, v126
  v_fma_f32 v133, v133, s48, v126
  v_mul_f32 v132, v132, v72
  v_mul_f32 v133, v133, v73
  v_exp_f32 v132, v132
  v_exp_f32 v133, v133
  v_add_f32 v132, 1.0, v132
  v_add_f32 v133, 1.0, v133
  v_rcp_f32 v132, v132
  v_rcp_f32 v133, v133
  v_mul_f32 v132, v132, v72
  v_mul_f32 v133, v133, v73
  v_cvt_pk_bf16_f32 v119, v132, v133
  v_add_f32 v44, v44, v132
  v_add_f32 v45, v45, v133
  v_fma_f32 v52, v132, v132, v52
  v_fma_f32 v53, v133, v133, v53
  v_fma_f32 v82, v30, v138, v82
  v_fma_f32 v83, v31, v138, v83
  v_mul_f32 v82, v82, v38
  v_mul_f32 v83, v83, v39
  v_mul_f32 v128, v82, v82
  v_mul_f32 v129, v83, v83
  v_fma_f32 v128, v128, s48, v126
  v_fma_f32 v129, v129, s48, v126
  v_mul_f32 v128, v128, v82
  v_mul_f32 v129, v129, v83
  v_exp_f32 v128, v128
  v_exp_f32 v129, v129
  v_add_f32 v128, 1.0, v128
  v_add_f32 v129, 1.0, v129
  v_rcp_f32 v128, v128
  v_rcp_f32 v129, v129
  v_mul_f32 v128, v128, v82
  v_mul_f32 v129, v129, v83
  v_cvt_pk_bf16_f32 v120, v128, v129
  v_add_f32 v46, v46, v128
  v_add_f32 v47, v47, v129
  v_fma_f32 v54, v128, v128, v54
  v_fma_f32 v55, v129, v129, v55
  v_fma_f32 v84, v32, v138, v84
  v_fma_f32 v85, v33, v138, v85
  v_mul_f32 v84, v84, v40
  v_mul_f32 v85, v85, v41
  v_mul_f32 v132, v84, v84
  v_mul_f32 v133, v85, v85
  v_fma_f32 v132, v132, s48, v126
  v_fma_f32 v133, v133, s48, v126
  v_mul_f32 v132, v132, v84
  v_mul_f32 v133, v133, v85
  v_exp_f32 v132, v132
  v_exp_f32 v133, v133
  v_add_f32 v132, 1.0, v132
  v_add_f32 v133, 1.0, v133
  v_rcp_f32 v132, v132
  v_rcp_f32 v133, v133
  v_mul_f32 v132, v132, v84
  v_mul_f32 v133, v133, v85
  v_cvt_pk_bf16_f32 v121, v132, v133
  v_add_f32 v48, v48, v132
  v_add_f32 v49, v49, v133
  v_fma_f32 v56, v132, v132, v56
  v_fma_f32 v57, v133, v133, v57
  s_barrier
  v_fma_f32 v74, v26, v140, v74
  v_fma_f32 v75, v27, v140, v75
  v_mul_f32 v74, v74, v34
  v_mul_f32 v75, v75, v35
  v_mul_f32 v128, v74, v74
  v_mul_f32 v129, v75, v75
  v_fma_f32 v128, v128, s48, v126
  v_fma_f32 v129, v129, s48, v126
  v_mul_f32 v128, v128, v74
  v_mul_f32 v129, v129, v75
  v_exp_f32 v128, v128
  v_exp_f32 v129, v129
  v_add_f32 v128, 1.0, v128
  v_add_f32 v129, 1.0, v129
  v_rcp_f32 v128, v128
  v_rcp_f32 v129, v129
  v_mul_f32 v128, v128, v74
  v_mul_f32 v129, v129, v75
  v_cvt_pk_bf16_f32 v122, v128, v129
  v_add_f32 v42, v42, v128
  v_add_f32 v43, v43, v129
  v_fma_f32 v50, v128, v128, v50
  v_fma_f32 v51, v129, v129, v51
  v_fma_f32 v76, v28, v140, v76
  v_fma_f32 v77, v29, v140, v77
  v_mul_f32 v76, v76, v36
  v_mul_f32 v77, v77, v37
  v_mul_f32 v132, v76, v76
  v_mul_f32 v133, v77, v77
  v_fma_f32 v132, v132, s48, v126
  v_fma_f32 v133, v133, s48, v126
  v_mul_f32 v132, v132, v76
  v_mul_f32 v133, v133, v77
  v_exp_f32 v132, v132
  v_exp_f32 v133, v133
  v_add_f32 v132, 1.0, v132
  v_add_f32 v133, 1.0, v133
  v_rcp_f32 v132, v132
  v_rcp_f32 v133, v133
  v_mul_f32 v132, v132, v76
  v_mul_f32 v133, v133, v77
  v_cvt_pk_bf16_f32 v123, v132, v133
  v_add_f32 v44, v44, v132
  v_add_f32 v45, v45, v133
  v_fma_f32 v52, v132, v132, v52
  v_fma_f32 v53, v133, v133, v53
  v_fma_f32 v86, v30, v140, v86
  v_fma_f32 v87, v31, v140, v87
  v_mul_f32 v86, v86, v38
  v_mul_f32 v87, v87, v39
  v_mul_f32 v128, v86, v86
  v_mul_f32 v129, v87, v87
  v_fma_f32 v128, v128, s48, v126
  v_fma_f32 v129, v129, s48, v126
  v_mul_f32 v128, v128, v86
  v_mul_f32 v129, v129, v87
  v_exp_f32 v128, v128
  v_exp_f32 v129, v129
  v_add_f32 v128, 1.0, v128
  v_add_f32 v129, 1.0, v129
  v_rcp_f32 v128, v128
  v_rcp_f32 v129, v129
  v_mul_f32 v128, v128, v86
  v_mul_f32 v129, v129, v87
  v_cvt_pk_bf16_f32 v124, v128, v129
  v_add_f32 v46, v46, v128
  v_add_f32 v47, v47, v129
  v_fma_f32 v54, v128, v128, v54
  v_fma_f32 v55, v129, v129, v55
  s_barrier
  v_fma_f32 v88, v32, v140, v88
  v_fma_f32 v89, v33, v140, v89
  v_mul_f32 v88, v88, v40
  v_mul_f32 v89, v89, v41
  v_mul_f32 v132, v88, v88
  v_mul_f32 v133, v89, v89
  v_fma_f32 v132, v132, s48, v126
  v_fma_f32 v133, v133, s48, v126
  v_mul_f32 v132, v132, v88
  v_mul_f32 v133, v133, v89
  v_exp_f32 v132, v132
  v_exp_f32 v133, v133
  v_add_f32 v132, 1.0, v132
  v_add_f32 v133, 1.0, v133
  v_rcp_f32 v132, v132
  v_rcp_f32 v133, v133
  v_mul_f32 v132, v132, v88
  v_mul_f32 v133, v133, v89
  v_cvt_pk_bf16_f32 v125, v132, v133
  v_add_f32 v48, v48, v132
  v_add_f32 v49, v49, v133
  v_fma_f32 v56, v132, v132, v56
  v_fma_f32 v57, v133, v133, v57
  v_add_f32_dpp v42, v42, v42 row_ror:8 row_mask:0xf bank_mask:0xf
  v_add_f32_dpp v43, v43, v43 row_ror:8 row_mask:0xf bank_mask:0xf
  v_add_f32_dpp v44, v44, v44 row_ror:8 row_mask:0xf bank_mask:0xf
  v_add_f32_dpp v45, v45, v45 row_ror:8 row_mask:0xf bank_mask:0xf
  v_add_f32_dpp v46, v46, v46 row_ror:8 row_mask:0xf bank_mask:0xf
  v_add_f32_dpp v47, v47, v47 row_ror:8 row_mask:0xf bank_mask:0xf
  v_add_f32_dpp v48, v48, v48 row_ror:8 row_mask:0xf bank_mask:0xf
  v_add_f32_dpp v49, v49, v49 row_ror:8 row_mask:0xf bank_mask:0xf
  v_add_f32_dpp v50, v50, v50 row_ror:8 row_mask:0xf bank_mask:0xf
  v_add_f32_dpp v51, v51, v51 row_ror:8 row_mask:0xf bank_mask:0xf
  v_add_f32_dpp v52, v52, v52 row_ror:8 row_mask:0xf bank_mask:0xf
  v_add_f32_dpp v53, v53, v53 row_ror:8 row_mask:0xf bank_mask:0xf
  v_add_f32_dpp v54, v54, v54 row_ror:8 row_mask:0xf bank_mask:0xf
  v_add_f32_dpp v55, v55, v55 row_ror:8 row_mask:0xf bank_mask:0xf
  v_add_f32_dpp v56, v56, v56 row_ror:8 row_mask:0xf bank_mask:0xf
  v_add_f32_dpp v57, v57, v57 row_ror:8 row_mask:0xf bank_mask:0xf
  v_add_f32_dpp v42, v42, v42 row_ror:4 row_mask:0xf bank_mask:0xf
  v_add_f32_dpp v43, v43, v43 row_ror:4 row_mask:0xf bank_mask:0xf
  v_add_f32_dpp v44, v44, v44 row_ror:4 row_mask:0xf bank_mask:0xf
  v_add_f32_dpp v45, v45, v45 row_ror:4 row_mask:0xf bank_mask:0xf
  v_add_f32_dpp v46, v46, v46 row_ror:4 row_mask:0xf bank_mask:0xf
  v_add_f32_dpp v47, v47, v47 row_ror:4 row_mask:0xf bank_mask:0xf
  v_add_f32_dpp v48, v48, v48 row_ror:4 row_mask:0xf bank_mask:0xf
  v_add_f32_dpp v49, v49, v49 row_ror:4 row_mask:0xf bank_mask:0xf
  v_add_f32_dpp v50, v50, v50 row_ror:4 row_mask:0xf bank_mask:0xf
  v_add_f32_dpp v51, v51, v51 row_ror:4 row_mask:0xf bank_mask:0xf
  v_add_f32_dpp v52, v52, v52 row_ror:4 row_mask:0xf bank_mask:0xf
  v_add_f32_dpp v53, v53, v53 row_ror:4 row_mask:0xf bank_mask:0xf
  v_add_f32_dpp v54, v54, v54 row_ror:4 row_mask:0xf bank_mask:0xf
  v_add_f32_dpp v55, v55, v55 row_ror:4 row_mask:0xf bank_mask:0xf
  v_add_f32_dpp v56, v56, v56 row_ror:4 row_mask:0xf bank_mask:0xf
  v_add_f32_dpp v57, v57, v57 row_ror:4 row_mask:0xf bank_mask:0xf
  s_barrier
  v_add_f32_dpp v42, v42, v42 row_ror:2 row_mask:0xf bank_mask:0xf
  v_add_f32_dpp v43, v43, v43 row_ror:2 row_mask:0xf bank_mask:0xf
  v_add_f32_dpp v44, v44, v44 row_ror:2 row_mask:0xf bank_mask:0xf
  v_add_f32_dpp v45, v45, v45 row_ror:2 row_mask:0xf bank_mask:0xf
  v_add_f32_dpp v46, v46, v46 row_ror:2 row_mask:0xf bank_mask:0xf
  v_add_f32_dpp v47, v47, v47 row_ror:2 row_mask:0xf bank_mask:0xf
  v_add_f32_dpp v48, v48, v48 row_ror:2 row_mask:0xf bank_mask:0xf
  v_add_f32_dpp v49, v49, v49 row_ror:2 row_mask:0xf bank_mask:0xf
  v_add_f32_dpp v50, v50, v50 row_ror:2 row_mask:0xf bank_mask:0xf
  v_add_f32_dpp v51, v51, v51 row_ror:2 row_mask:0xf bank_mask:0xf
  v_add_f32_dpp v52, v52, v52 row_ror:2 row_mask:0xf bank_mask:0xf
  v_add_f32_dpp v53, v53, v53 row_ror:2 row_mask:0xf bank_mask:0xf
  v_add_f32_dpp v54, v54, v54 row_ror:2 row_mask:0xf bank_mask:0xf
  v_add_f32_dpp v55, v55, v55 row_ror:2 row_mask:0xf bank_mask:0xf
  v_add_f32_dpp v56, v56, v56 row_ror:2 row_mask:0xf bank_mask:0xf
  v_add_f32_dpp v57, v57, v57 row_ror:2 row_mask:0xf bank_mask:0xf
  v_add_f32_dpp v42, v42, v42 row_ror:1 row_mask:0xf bank_mask:0xf
  v_add_f32_dpp v43, v43, v43 row_ror:1 row_mask:0xf bank_mask:0xf
  v_add_f32_dpp v44, v44, v44 row_ror:1 row_mask:0xf bank_mask:0xf
  v_add_f32_dpp v45, v45, v45 row_ror:1 row_mask:0xf bank_mask:0xf
  v_add_f32_dpp v46, v46, v46 row_ror:1 row_mask:0xf bank_mask:0xf
  v_add_f32_dpp v47, v47, v47 row_ror:1 row_mask:0xf bank_mask:0xf
  v_add_f32_dpp v48, v48, v48 row_ror:1 row_mask:0xf bank_mask:0xf
  v_add_f32_dpp v49, v49, v49 row_ror:1 row_mask:0xf bank_mask:0xf
  v_add_f32_dpp v50, v50, v50 row_ror:1 row_mask:0xf bank_mask:0xf
  v_add_f32_dpp v51, v51, v51 row_ror:1 row_mask:0xf bank_mask:0xf
  v_add_f32_dpp v52, v52, v52 row_ror:1 row_mask:0xf bank_mask:0xf
  v_add_f32_dpp v53, v53, v53 row_ror:1 row_mask:0xf bank_mask:0xf
  v_add_f32_dpp v54, v54, v54 row_ror:1 row_mask:0xf bank_mask:0xf
  v_add_f32_dpp v55, v55, v55 row_ror:1 row_mask:0xf bank_mask:0xf
  v_add_f32_dpp v56, v56, v56 row_ror:1 row_mask:0xf bank_mask:0xf
  v_add_f32_dpp v57, v57, v57 row_ror:1 row_mask:0xf bank_mask:0xf
  s_lshl_b32 s40, s36, 8
  s_add_u32 s40, s40, 2048
  v_add_u32 v19, s40, v19
  v_add_u32 v20, s40, v20
  s_mov_b32 exec_lo, 0x10001
  s_mov_b32 exec_hi, 0x10001
  ds_write_b128 v19, v[42:45]
  ds_write_b128 v20, v[46:49]
  ds_write_b128 v19, v[50:53] offset:512
  ds_write_b128 v20, v[54:57] offset:512
  s_mov_b64 exec, s[52:53]
  s_waitcnt lgkmcnt(0)
  s_barrier
  s_cmp_eq_u32 s34, 0
  s_cbranch_scc0 K1_NOPUB
  v_lshlrev_b32 v14, 2, v1
  v_add_u32 v14, 145408, v14
  ds_read_b32 v16, v14
  ds_read_b32 v18, v14 offset:256
  ds_read_b32 v17, v14 offset:512
  ds_read_b32 v19, v14 offset:768
  s_lshl_b32 s40, s32, 3
  s_add_u32 s40, s40, s33
  s_lshl_b32 s40, s40, 9
  s_add_u32 s40, s40, 16842752
  v_lshlrev_b32 v15, 3, v1
  s_waitcnt lgkmcnt(0)
  v_add_f32 v16, v16, v18
  v_add_f32 v17, v17, v19
  v_max_f32 v17, 0, v17
  buffer_store_dwordx2 v[16:17], v15, s[16:19], s40 offen sc1
K1_NOPUB:
  s_mul_i32 s40, s33, 6
  s_mul_i32 s41, s36, 3
  s_add_u32 s40, s40, s41
  s_lshl_b32 s40, s40, 6
  s_lshl_b32 s41, s32, 1
  s_add_u32 s40, s40, s41
  s_add_u32 s40, s40, s35
  s_lshl_b32 s40, s40, 10
  s_add_u32 s39, s40, 3145728
  v_and_b32 v21, 1, v2
  v_lshlrev_b32 v21, 1, v21
  v_lshrrev_b32 v24, 1, v2
  v_or_b32 v21, v21, v24
  s_lshl_b32 s41, s36, 1
  v_xor_b32 v21, s41, v21
  v_lshlrev_b32 v21, 4, v21
  v_add_u32 v21, v21, v3
  v_lshlrev_b32 v21, 4, v21
  v_and_b32 v24, 31, v1
  s_lshl_b32 s38, s35, 5
  v_add_u32 v24, s38, v24
  v_lshlrev_b32 v24, 3, v24
  s_lshl_b32 s38, s32, 12
  s_add_u32 s38, s38, 16842752
  s_barrier
  s_barrier
  s_barrier
  s_barrier
K1_CPOLL:
  s_waitcnt vmcnt(0)
  v_readfirstlane_b32 s40, v23
  s_nop 0
  s_cmp_ge_u32 s40, 8
  s_cbranch_scc1 K1_CPOLLED
  s_sleep 4
  buffer_load_dword v23, v22, s[56:59], 0 offen sc1
  s_branch K1_CPOLL
K1_CPOLLED:
K1_POLL:
  buffer_load_dwordx2 v[42:43], v24, s[16:19], s38 offen offset:0 sc1
  buffer_load_dwordx2 v[44:45], v24, s[16:19], s38 offen offset:512 sc1
  buffer_load_dwordx2 v[46:47], v24, s[16:19], s38 offen offset:1024 sc1
  buffer_load_dwordx2 v[48:49], v24, s[16:19], s38 offen offset:1536 sc1
  buffer_load_dwordx2 v[50:51], v24, s[16:19], s38 offen offset:2048 sc1
  buffer_load_dwordx2 v[52:53], v24, s[16:19], s38 offen offset:2560 sc1
  buffer_load_dwordx2 v[54:55], v24, s[16:19], s38 offen offset:3072 sc1
  buffer_load_dwordx2 v[56:57], v24, s[16:19], s38 offen offset:3584 sc1
  s_mov_b32 s40, 0xbf800000
  s_waitcnt vmcnt(0)
  v_cmp_eq_u32 vcc, s40, v43
  v_cmp_eq_u32 s[60:61], s40, v45
  s_nop 0
  s_or_b64 vcc, vcc, s[60:61]
  v_cmp_eq_u32 s[60:61], s40, v47
  s_nop 0
  s_or_b64 vcc, vcc, s[60:61]
  v_cmp_eq_u32 s[60:61], s40, v49
  s_nop 0
  s_or_b64 vcc, vcc, s[60:61]
  v_cmp_eq_u32 s[60:61], s40, v51
  s_nop 0
  s_or_b64 vcc, vcc, s[60:61]
  v_cmp_eq_u32 s[60:61], s40, v53
  s_nop 0
  s_or_b64 vcc, vcc, s[60:61]
  v_cmp_eq_u32 s[60:61], s40, v55
  s_nop 0
  s_or_b64 vcc, vcc, s[60:61]
  v_cmp_eq_u32 s[60:61], s40, v57
  s_nop 0
  s_or_b64 vcc, vcc, s[60:61]
  s_cmp_eq_u64 vcc, 0
  s_cbranch_scc1 K1_POLLED
  s_sleep 2
  s_branch K1_POLL
K1_POLLED:
  v_pk_add_f32 v[42:43], v[42:43], v[44:45]
  v_pk_add_f32 v[42:43], v[42:43], v[46:47]
  v_pk_add_f32 v[42:43], v[42:43], v[48:49]
  v_pk_add_f32 v[42:43], v[42:43], v[50:51]
  v_pk_add_f32 v[42:43], v[42:43], v[52:53]
  v_pk_add_f32 v[42:43], v[42:43], v[54:55]
  v_pk_add_f32 v[42:43], v[42:43], v[56:57]
  v_mul_f32 v16, 0x3aaaaaab, v42
  v_mul_f32 v18, 0x3aaaaaab, v43
  v_fma_f32 v18, -v16, v16, v18
  v_max_f32 v18, 0, v18
  v_cvt_pk_bf16_f32 v16, v16, v16
  v_lshlrev_b32 v16, 16, v16
  v_cvt_pk_bf16_f32 v18, v18, v18
  v_lshlrev_b32 v18, 16, v18
  v_add_f32 v18, 0x3727c5ac, v18
  v_cvt_pk_bf16_f32 v18, v18, v18
  v_lshlrev_b32 v18, 16, v18
  v_sqrt_f32 v18, v18
  s_nop 0
  v_cvt_pk_bf16_f32 v18, v18, v18
  v_lshlrev_b32 v18, 16, v18
  v_rcp_f32 v17, v18
  s_nop 0
  v_mul_f32 v16, v16, v17
  v_sub_f32 v16, 0, v16
  s_lshl_b32 s40, s55, 8
  s_add_u32 s40, s40, 146432
  v_and_b32 v18, 31, v1
  v_lshlrev_b32 v18, 2, v18
  v_add_u32 v18, s40, v18
  ds_write_b32 v18, v16
  ds_write_b32 v18, v17 offset:128
  s_lshl_b32 s41, s36, 6
  s_add_u32 s40, s40, s41
  v_lshlrev_b32 v19, 4, v2
  v_add_u32 v19, s40, v19
  v_xor_b32 v20, 64, v19
  s_waitcnt lgkmcnt(0)
  ds_read_b128 v[26:29], v19
  ds_read_b128 v[30:33], v20
  ds_read_b128 v[34:37], v19 offset:128
  ds_read_b128 v[38:41], v20 offset:128
  s_waitcnt lgkmcnt(0)
  v_lshlrev_b32 v128, 16, v114
  v_and_b32 v129, s47, v114
  v_pk_fma_f32 v[128:129], v[128:129], v[34:35], v[26:27]
  v_cvt_pk_bf16_f32 v114, v128, v129
  v_lshlrev_b32 v132, 16, v115
  v_and_b32 v133, s47, v115
  v_pk_fma_f32 v[132:133], v[132:133], v[36:37], v[28:29]
  v_cvt_pk_bf16_f32 v115, v132, v133
  v_lshlrev_b32 v128, 16, v116
  v_and_b32 v129, s47, v116
  v_pk_fma_f32 v[128:129], v[128:129], v[38:39], v[30:31]
  v_cvt_pk_bf16_f32 v116, v128, v129
  v_lshlrev_b32 v132, 16, v117
  v_and_b32 v133, s47, v117
  v_pk_fma_f32 v[132:133], v[132:133], v[40:41], v[32:33]
  v_cvt_pk_bf16_f32 v117, v132, v133
  v_permlane16_swap_b32 v114, v116
  s_nop 0
  v_permlane16_swap_b32 v115, v117
  s_add_u32 s41, s39, 0
  buffer_store_dwordx4 v[114:117], v21, s[16:19], s41 offen
  v_lshlrev_b32 v128, 16, v118
  v_and_b32 v129, s47, v118
  v_pk_fma_f32 v[128:129], v[128:129], v[34:35], v[26:27]
  v_cvt_pk_bf16_f32 v118, v128, v129
  v_lshlrev_b32 v132, 16, v119
  v_and_b32 v133, s47, v119
  v_pk_fma_f32 v[132:133], v[132:133], v[36:37], v[28:29]
  v_cvt_pk_bf16_f32 v119, v132, v133
  v_lshlrev_b32 v128, 16, v120
  v_and_b32 v129, s47, v120
  v_pk_fma_f32 v[128:129], v[128:129], v[38:39], v[30:31]
  v_cvt_pk_bf16_f32 v120, v128, v129
  v_lshlrev_b32 v132, 16, v121
  v_and_b32 v133, s47, v121
  v_pk_fma_f32 v[132:133], v[132:133], v[40:41], v[32:33]
  v_cvt_pk_bf16_f32 v121, v132, v133
  v_permlane16_swap_b32 v118, v120
  s_nop 0
  v_permlane16_swap_b32 v119, v121
  s_add_u32 s41, s39, 65536
  buffer_store_dwordx4 v[118:121], v21, s[16:19], s41 offen
  v_lshlrev_b32 v128, 16, v122
  v_and_b32 v129, s47, v122
  v_pk_fma_f32 v[128:129], v[128:129], v[34:35], v[26:27]
  v_cvt_pk_bf16_f32 v122, v128, v129
  v_lshlrev_b32 v132, 16, v123
  v_and_b32 v133, s47, v123
  v_pk_fma_f32 v[132:133], v[132:133], v[36:37], v[28:29]
  v_cvt_pk_bf16_f32 v123, v132, v133
  v_lshlrev_b32 v128, 16, v124
  v_and_b32 v129, s47, v124
  v_pk_fma_f32 v[128:129], v[128:129], v[38:39], v[30:31]
  v_cvt_pk_bf16_f32 v124, v128, v129
  v_lshlrev_b32 v132, 16, v125
  v_and_b32 v133, s47, v125
  v_pk_fma_f32 v[132:133], v[132:133], v[40:41], v[32:33]
  v_cvt_pk_bf16_f32 v125, v132, v133
  v_permlane16_swap_b32 v122, v124
  s_nop 0
  v_permlane16_swap_b32 v123, v125
  s_add_u32 s41, s39, 131072
  buffer_store_dwordx4 v[122:125], v21, s[16:19], s41 offen
  s_endpgm
K1_B:
  s_cmp_eq_u32 s34, 4
  s_cbranch_scc0 K1_NORST
  s_lshl_b32 s40, s32, 3
  s_add_u32 s40, s40, s33
  s_lshl_b32 s40, s40, 9
  s_add_u32 s40, s40, 16842752
  v_lshlrev_b32 v15, 3, v1
  v_mov_b32 v20, 0
  v_mov_b32 v21, 0xbf800000
  buffer_store_dwordx2 v[20:21], v15, s[16:19], s40 offen sc1
K1_NORST:
  s_mov_b32 s28, s66
  s_and_b32 s29, s67, 0xffff
  s_mov_b32 s30, 5120
  s_mov_b32 s31, 0x20000
  v_lshlrev_b32 v17, 4, v1
  s_mul_i32 s41, s33, 640
  buffer_load_dwordx4 v[160:163], v17, s[28:31], s41 offen
  s_lshl_b32 s40, s2, 2
  s_add_u32 s40, s40, s55
  s_mul_i32 s41, s40, 2731
  s_lshr_b32 s41, s41, 16
  s_mul_i32 s42, s41, 24
  s_sub_u32 s42, s40, s42
  s_mov_b32 s76, s40
  s_mov_b32 s28, s70
  s_and_b32 s29, s71, 0xffff
  s_mov_b32 s30, 983040
  s_mov_b32 s31, 0x20000
  v_mul_u32_u24 v17, 5120, v2
  v_lshlrev_b32 v18, 1, v3
  v_add_u32 v17, v17, v18
  s_lshl_b32 s41, s41, 5
  s_mul_i32 s42, s42, 40960
  s_add_u32 s41, s41, s42
  s_add_u32 s42, s41, 20480
  buffer_load_ushort v152, v17, s[28:31], s41 offen offset:0
  buffer_load_ushort v153, v17, s[28:31], s41 offen offset:1280
  buffer_load_ushort v154, v17, s[28:31], s41 offen offset:2560
  buffer_load_ushort v155, v17, s[28:31], s41 offen offset:3840
  buffer_load_ushort v156, v17, s[28:31], s42 offen offset:0
  buffer_load_ushort v157, v17, s[28:31], s42 offen offset:1280
  buffer_load_ushort v158, v17, s[28:31], s42 offen offset:2560
  buffer_load_ushort v159, v17, s[28:31], s42 offen offset:3840
  s_mul_i32 s40, s55, 2560
  s_add_u32 s40, s40, 126976
  v_lshlrev_b32 v17, 2, v1
  v_min_u32 v17, 156, v17
  v_add_u32 v17, s40, v17
  s_barrier
  s_barrier
  ds_read_b32 v26, v17 offset:0
  ds_read_b32 v27, v17 offset:160
  ds_read_b32 v28, v17 offset:320
  ds_read_b32 v29, v17 offset:480
  ds_read_b32 v30, v17 offset:640
  ds_read_b32 v31, v17 offset:800
  ds_read_b32 v32, v17 offset:960
  ds_read_b32 v33, v17 offset:1120
  ds_read_b32 v34, v17 offset:1280
  ds_read_b32 v35, v17 offset:1440
  ds_read_b32 v36, v17 offset:1600
  ds_read_b32 v37, v17 offset:1760
  s_waitcnt lgkmcnt(8)
  ds_read_b32 v38, v17 offset:1920
  ds_read_b32 v39, v17 offset:2080
  ds_read_b32 v40, v17 offset:2240
  ds_read_b32 v41, v17 offset:2400
  ds_read_b32 v42, v17 offset:2560
  ds_read_b32 v43, v17 offset:2720
  ds_read_b32 v44, v17 offset:2880
  s_waitcnt lgkmcnt(4)
  ds_read_b32 v45, v17 offset:11520
  ds_read_b32 v46, v17 offset:11680
  ds_read_b32 v47, v17 offset:11840
  ds_read_b32 v48, v17 offset:12000
  ds_read_b32 v49, v17 offset:12160
  ds_read_b32 v50, v17 offset:12320
  ds_read_b32 v51, v17 offset:12480
  ds_read_b32 v52, v17 offset:12640
  ds_read_b32 v53, v17 offset:12800
  ds_read_b32 v54, v17 offset:12960
  s_waitcnt lgkmcnt(8)
  ds_read_b32 v55, v17 offset:13120
  ds_read_b32 v56, v17 offset:13280
  ds_read_b32 v57, v17 offset:13440
  ds_read_b32 v58, v17 offset:13600
  ds_read_b32 v59, v17 offset:13760
  ds_read_b32 v60, v17 offset:13920
  s_waitcnt lgkmcnt(0)
  s_barrier
  v_lshlrev_b32 v62, 16, v26
  v_and_b32 v63, s47, v26
  v_lshlrev_b32 v64, 16, v27
  v_and_b32 v65, s47, v27
  v_lshlrev_b32 v66, 16, v28
  v_and_b32 v67, s47, v28
  v_lshlrev_b32 v68, 16, v29
  v_and_b32 v69, s47, v29
  v_lshlrev_b32 v70, 16, v30
  v_and_b32 v71, s47, v30
  v_lshlrev_b32 v72, 16, v31
  v_and_b32 v73, s47, v31
  v_lshlrev_b32 v74, 16, v32
  v_and_b32 v75, s47, v32
  v_lshlrev_b32 v76, 16, v33
  v_and_b32 v77, s47, v33
  v_lshlrev_b32 v78, 16, v34
  v_and_b32 v79, s47, v34
  v_lshlrev_b32 v80, 16, v35
  v_and_b32 v81, s47, v35
  v_lshlrev_b32 v82, 16, v36
  v_and_b32 v83, s47, v36
  v_lshlrev_b32 v84, 16, v37
  v_and_b32 v85, s47, v37
  v_lshlrev_b32 v86, 16, v38
  v_and_b32 v87, s47, v38
  v_lshlrev_b32 v88, 16, v39
  v_and_b32 v89, s47, v39
  v_lshlrev_b32 v90, 16, v40
  v_and_b32 v91, s47, v40
  v_lshlrev_b32 v92, 16, v41
  v_and_b32 v93, s47, v41
  v_lshlrev_b32 v94, 16, v42
  v_and_b32 v95, s47, v42
  v_lshlrev_b32 v96, 16, v43
  v_and_b32 v97, s47, v43
  v_lshlrev_b32 v98, 16, v44
  v_and_b32 v99, s47, v44
  s_waitcnt vmcnt(8)
  v_lshlrev_b32 v100, 16, v160
  v_lshlrev_b32 v101, 16, v162
  v_and_b32 v102, s47, v160
  v_and_b32 v103, s47, v162
  v_lshlrev_b32 v104, 16, v161
  v_lshlrev_b32 v105, 16, v163
  v_and_b32 v106, s47, v161
  v_and_b32 v107, s47, v163
  s_cmp_eq_u32 s34, 4
  s_cbranch_scc0 K1_NOCNT
  s_lshl_b32 s40, s32, 2
  v_mov_b32 v20, s40
  v_mov_b32 v21, 1
  s_mov_b32 exec_lo, 0x1
  s_mov_b32 exec_hi, 0x0
  buffer_atomic_add v21, v20, s[56:59], 0 offen sc1
  s_mov_b64 exec, s[52:53]
K1_NOCNT:
  s_barrier
  v_mul_f32 v108, v106, v62
  v_mul_f32 v109, v107, v63
  v_fmac_f32 v108, v104, v64
  v_fmac_f32 v109, v105, v65
  v_fmac_f32 v108, v102, v66
  v_fmac_f32 v109, v103, v67
  v_fmac_f32 v108, v100, v68
  v_fmac_f32 v109, v101, v69
  v_lshlrev_b32 v18, 16, v45
  v_and_b32 v19, s47, v45
  v_mul_f32 v108, v108, v18
  v_mul_f32 v109, v109, v19
  v_mul_f32 v110, v106, v64
  v_mul_f32 v111, v107, v65
  v_fmac_f32 v110, v104, v66
  v_fmac_f32 v111, v105, v67
  v_fmac_f32 v110, v102, v68
  v_fmac_f32 v111, v103, v69
  v_fmac_f32 v110, v100, v70
  v_fmac_f32 v111, v101, v71
  v_lshlrev_b32 v18, 16, v46
  v_and_b32 v19, s47, v46
  v_mul_f32 v110, v110, v18
  v_mul_f32 v111, v111, v19
  v_mul_f32 v112, v106, v66
  v_mul_f32 v113, v107, v67
  v_fmac_f32 v112, v104, v68
  v_fmac_f32 v113, v105, v69
  v_fmac_f32 v112, v102, v70
  v_fmac_f32 v113, v103, v71
  v_fmac_f32 v112, v100, v72
  v_fmac_f32 v113, v101, v73
  v_lshlrev_b32 v18, 16, v47
  v_and_b32 v19, s47, v47
  v_mul_f32 v112, v112, v18
  v_mul_f32 v113, v113, v19
  s_barrier
  v_mul_f32 v114, v106, v68
  v_mul_f32 v115, v107, v69
  v_fmac_f32 v114, v104, v70
  v_fmac_f32 v115, v105, v71
  v_fmac_f32 v114, v102, v72
  v_fmac_f32 v115, v103, v73
  v_fmac_f32 v114, v100, v74
  v_fmac_f32 v115, v101, v75
  v_lshlrev_b32 v18, 16, v48
  v_and_b32 v19, s47, v48
  v_mul_f32 v114, v114, v18
  v_mul_f32 v115, v115, v19
  v_mul_f32 v116, v106, v70
  v_mul_f32 v117, v107, v71
  v_fmac_f32 v116, v104, v72
  v_fmac_f32 v117, v105, v73
  v_fmac_f32 v116, v102, v74
  v_fmac_f32 v117, v103, v75
  v_fmac_f32 v116, v100, v76
  v_fmac_f32 v117, v101, v77
  v_lshlrev_b32 v18, 16, v49
  v_and_b32 v19, s47, v49
  v_mul_f32 v116, v116, v18
  v_mul_f32 v117, v117, v19
  v_mul_f32 v118, v106, v72
  v_mul_f32 v119, v107, v73
  v_fmac_f32 v118, v104, v74
  v_fmac_f32 v119, v105, v75
  v_fmac_f32 v118, v102, v76
  v_fmac_f32 v119, v103, v77
  v_fmac_f32 v118, v100, v78
  v_fmac_f32 v119, v101, v79
  v_lshlrev_b32 v18, 16, v50
  v_and_b32 v19, s47, v50
  v_mul_f32 v118, v118, v18
  v_mul_f32 v119, v119, v19
  v_mul_f32 v120, v106, v74
  v_mul_f32 v121, v107, v75
  v_fmac_f32 v120, v104, v76
  v_fmac_f32 v121, v105, v77
  v_fmac_f32 v120, v102, v78
  v_fmac_f32 v121, v103, v79
  v_fmac_f32 v120, v100, v80
  v_fmac_f32 v121, v101, v81
  v_lshlrev_b32 v18, 16, v51
  v_and_b32 v19, s47, v51
  v_mul_f32 v120, v120, v18
  v_mul_f32 v121, v121, v19
  s_barrier
  v_mul_f32 v122, v106, v76
  v_mul_f32 v123, v107, v77
  v_fmac_f32 v122, v104, v78
  v_fmac_f32 v123, v105, v79
  v_fmac_f32 v122, v102, v80
  v_fmac_f32 v123, v103, v81
  v_fmac_f32 v122, v100, v82
  v_fmac_f32 v123, v101, v83
  v_lshlrev_b32 v18, 16, v52
  v_and_b32 v19, s47, v52
  v_mul_f32 v122, v122, v18
  v_mul_f32 v123, v123, v19
  v_mul_f32 v124, v106, v78
  v_mul_f32 v125, v107, v79
  v_fmac_f32 v124, v104, v80
  v_fmac_f32 v125, v105, v81
  v_fmac_f32 v124, v102, v82
  v_fmac_f32 v125, v103, v83
  v_fmac_f32 v124, v100, v84
  v_fmac_f32 v125, v101, v85
  v_lshlrev_b32 v18, 16, v53
  v_and_b32 v19, s47, v53
  v_mul_f32 v124, v124, v18
  v_mul_f32 v125, v125, v19
  v_mul_f32 v126, v106, v80
  v_mul_f32 v127, v107, v81
  v_fmac_f32 v126, v104, v82
  v_fmac_f32 v127, v105, v83
  v_fmac_f32 v126, v102, v84
  v_fmac_f32 v127, v103, v85
  v_fmac_f32 v126, v100, v86
  v_fmac_f32 v127, v101, v87
  v_lshlrev_b32 v18, 16, v54
  v_and_b32 v19, s47, v54
  v_mul_f32 v126, v126, v18
  v_mul_f32 v127, v127, v19
  v_mul_f32 v128, v106, v82
  v_mul_f32 v129, v107, v83
  v_fmac_f32 v128, v104, v84
  v_fmac_f32 v129, v105, v85
  v_fmac_f32 v128, v102, v86
  v_fmac_f32 v129, v103, v87
  v_fmac_f32 v128, v100, v88
  v_fmac_f32 v129, v101, v89
  v_lshlrev_b32 v18, 16, v55
  v_and_b32 v19, s47, v55
  v_mul_f32 v128, v128, v18
  v_mul_f32 v129, v129, v19
  s_barrier
  v_mul_f32 v130, v106, v84
  v_mul_f32 v131, v107, v85
  v_fmac_f32 v130, v104, v86
  v_fmac_f32 v131, v105, v87
  v_fmac_f32 v130, v102, v88
  v_fmac_f32 v131, v103, v89
  v_fmac_f32 v130, v100, v90
  v_fmac_f32 v131, v101, v91
  v_lshlrev_b32 v18, 16, v56
  v_and_b32 v19, s47, v56
  v_mul_f32 v130, v130, v18
  v_mul_f32 v131, v131, v19
  v_mul_f32 v132, v106, v86
  v_mul_f32 v133, v107, v87
  v_fmac_f32 v132, v104, v88
  v_fmac_f32 v133, v105, v89
  v_fmac_f32 v132, v102, v90
  v_fmac_f32 v133, v103, v91
  v_fmac_f32 v132, v100, v92
  v_fmac_f32 v133, v101, v93
  v_lshlrev_b32 v18, 16, v57
  v_and_b32 v19, s47, v57
  v_mul_f32 v132, v132, v18
  v_mul_f32 v133, v133, v19
  v_mul_f32 v134, v106, v88
  v_mul_f32 v135, v107, v89
  v_fmac_f32 v134, v104, v90
  v_fmac_f32 v135, v105, v91
  v_fmac_f32 v134, v102, v92
  v_fmac_f32 v135, v103, v93
  v_fmac_f32 v134, v100, v94
  v_fmac_f32 v135, v101, v95
  v_lshlrev_b32 v18, 16, v58
  v_and_b32 v19, s47, v58
  v_mul_f32 v134, v134, v18
  v_mul_f32 v135, v135, v19
  v_mul_f32 v136, v106, v90
  v_mul_f32 v137, v107, v91
  v_fmac_f32 v136, v104, v92
  v_fmac_f32 v137, v105, v93
  v_fmac_f32 v136, v102, v94
  v_fmac_f32 v137, v103, v95
  v_fmac_f32 v136, v100, v96
  v_fmac_f32 v137, v101, v97
  v_lshlrev_b32 v18, 16, v59
  v_and_b32 v19, s47, v59
  v_mul_f32 v136, v136, v18
  v_mul_f32 v137, v137, v19
  s_barrier
  v_mul_f32 v138, v106, v92
  v_mul_f32 v139, v107, v93
  v_fmac_f32 v138, v104, v94
  v_fmac_f32 v139, v105, v95
  v_fmac_f32 v138, v102, v96
  v_fmac_f32 v139, v103, v97
  v_fmac_f32 v138, v100, v98
  v_fmac_f32 v139, v101, v99
  v_lshlrev_b32 v18, 16, v60
  v_and_b32 v19, s47, v60
  v_mul_f32 v138, v138, v18
  v_mul_f32 v139, v139, v19
  v_cvt_pk_bf16_f32 v26, v122, v120
  v_cvt_pk_bf16_f32 v27, v118, v116
  v_cvt_pk_bf16_f32 v28, v114, v112
  v_cvt_pk_bf16_f32 v29, v110, v108
  v_cvt_pk_bf16_f32 v30, v138, v136
  v_cvt_pk_bf16_f32 v31, v134, v132
  v_cvt_pk_bf16_f32 v32, v130, v128
  v_cvt_pk_bf16_f32 v33, v126, v124
  v_cvt_pk_bf16_f32 v34, v123, v121
  v_cvt_pk_bf16_f32 v35, v119, v117
  v_cvt_pk_bf16_f32 v36, v115, v113
  v_cvt_pk_bf16_f32 v37, v111, v109
  v_cvt_pk_bf16_f32 v38, v139, v137
  v_cvt_pk_bf16_f32 v39, v135, v133
  v_cvt_pk_bf16_f32 v40, v131, v129
  v_cvt_pk_bf16_f32 v41, v127, v125
  v_lshlrev_b32 v17, 13, v1
  s_mul_i32 s40, s33, 327680
  s_lshl_b32 s41, s32, 7
  s_add_u32 s40, s40, s41
  s_lshl_b32 s41, s55, 5
  s_add_u32 s40, s40, s41
  s_add_u32 s40, s40, 6291456
  s_add_u32 s41, s40, 4096
  s_mov_b32 exec_lo, 0xffffffff
  s_mov_b32 exec_hi, 0xff
  buffer_store_dwordx4 v[26:29], v17, s[16:19], s40 offen
  buffer_store_dwordx4 v[30:33], v17, s[16:19], s40 offen offset:16
  buffer_store_dwordx4 v[34:37], v17, s[16:19], s41 offen
  buffer_store_dwordx4 v[38:41], v17, s[16:19], s41 offen offset:16
  s_mov_b64 exec, s[52:53]
  s_barrier
  s_cmp_ge_u32 s76, 960
  s_cbranch_scc1 K1_NOWOF
  s_waitcnt vmcnt(4)
  v_lshl_or_b32 v164, v153, 16, v152
  v_lshl_or_b32 v165, v155, 16, v154
  v_lshl_or_b32 v166, v157, 16, v156
  v_lshl_or_b32 v167, v159, 16, v158
  v_lshlrev_b32 v17, 4, v1
  s_lshl_b32 s40, s76, 10
  s_add_u32 s40, s40, 15728640
  buffer_store_dwordx4 v[164:167], v17, s[16:19], s40 offen
K1_NOWOF:
  s_barrier
  v_mov_b32 v102, 0x3f803f80
  v_mov_b32 v103, 0x3f803f80
  v_mov_b32 v104, 0x3f803f80
  v_mov_b32 v105, 0x3f803f80
  v_mov_b32 v66, 0
  v_mov_b32 v67, 0
  v_mov_b32 v68, 0
  v_mov_b32 v69, 0
  v_mov_b32 v70, 0
  v_mov_b32 v71, 0
  v_mov_b32 v72, 0
  v_mov_b32 v73, 0
  v_mov_b32 v74, 0
  v_mov_b32 v75, 0
  v_mov_b32 v76, 0
  v_mov_b32 v77, 0
  v_mov_b32 v78, 0
  v_mov_b32 v79, 0
  v_mov_b32 v80, 0
  v_mov_b32 v81, 0
  v_mov_b32 v82, 0
  v_mov_b32 v83, 0
  v_mov_b32 v84, 0
  v_mov_b32 v85, 0
  v_mov_b32 v86, 0
  v_mov_b32 v87, 0
  v_mov_b32 v88, 0
  v_mov_b32 v89, 0
  v_mov_b32 v90, 0
  v_mov_b32 v91, 0
  v_mov_b32 v92, 0
  v_mov_b32 v93, 0
  v_mov_b32 v94, 0
  v_mov_b32 v95, 0
  v_mov_b32 v96, 0
  v_mov_b32 v97, 0
  v_mov_b32 v98, 0
  v_mov_b32 v99, 0
  v_mov_b32 v100, 0
  v_mov_b32 v101, 0
  v_mov_b32 v106, 0
  v_mov_b32 v107, 0
  v_mov_b32 v108, 0
  v_mov_b32 v109, 0
  v_mov_b32 v110, 0
  v_mov_b32 v111, 0
  v_mov_b32 v112, 0
  v_mov_b32 v113, 0
  s_barrier
  s_mov_b32 s37, 0
  ds_read_b128 v[26:29], v4 offset:0
  ds_read_b64_tr_b16 v[42:43], v8 offset:0
  ds_read_b64_tr_b16 v[44:45], v8 offset:768
  ds_read_b128 v[30:33], v6 offset:0
  ds_read_b64_tr_b16 v[46:47], v9 offset:0
  ds_read_b64_tr_b16 v[48:49], v9 offset:768
  ds_read_b64_tr_b16 v[50:51], v10 offset:0
  ds_read_b64_tr_b16 v[52:53], v10 offset:768
K1_LOOP2:
  s_waitcnt lgkmcnt(0)
  v_mfma_f32_16x16x32_bf16 v[66:69], v[42:45], v[26:29], v[66:69]
  ds_read_b128 v[34:37], v5 offset:0
  ds_read_b64_tr_b16 v[54:55], v8 offset:6144
  v_mfma_f32_16x16x32_bf16 v[78:81], v[42:45], v[30:33], v[78:81]
  ds_read_b64_tr_b16 v[56:57], v8 offset:6912
  ds_read_b128 v[38:41], v7 offset:0
  v_mfma_f32_16x16x32_bf16 v[70:73], v[46:49], v[26:29], v[70:73]
  ds_read_b64_tr_b16 v[58:59], v9 offset:6144
  ds_read_b64_tr_b16 v[60:61], v9 offset:6912
  v_mfma_f32_16x16x32_bf16 v[82:85], v[46:49], v[30:33], v[82:85]
  ds_read_b64_tr_b16 v[62:63], v10 offset:6144
  ds_read_b64_tr_b16 v[64:65], v10 offset:6912
  v_mfma_f32_16x16x32_bf16 v[74:77], v[50:53], v[26:29], v[74:77]
  v_mfma_f32_16x16x32_bf16 v[86:89], v[50:53], v[30:33], v[86:89]
  s_cmp_eq_u32 s35, 0
  s_cbranch_scc0 K1_SK_2a0
  v_mfma_f32_16x16x32_bf16 v[90:93], v[42:45], v[102:105], v[90:93]
  v_mfma_f32_16x16x32_bf16 v[94:97], v[46:49], v[102:105], v[94:97]
  v_mfma_f32_16x16x32_bf16 v[98:101], v[50:53], v[102:105], v[98:101]
K1_SK_2a0:
  s_waitcnt lgkmcnt(0)
  s_barrier
  v_mfma_f32_16x16x32_bf16 v[66:69], v[54:57], v[34:37], v[66:69]
  ds_read_b128 v[26:29], v4 offset:8192
  ds_read_b64_tr_b16 v[42:43], v8 offset:12288
  v_mfma_f32_16x16x32_bf16 v[78:81], v[54:57], v[38:41], v[78:81]
  ds_read_b64_tr_b16 v[44:45], v8 offset:13056
  ds_read_b128 v[30:33], v6 offset:8192
  v_mfma_f32_16x16x32_bf16 v[70:73], v[58:61], v[34:37], v[70:73]
  ds_read_b64_tr_b16 v[46:47], v9 offset:12288
  ds_read_b64_tr_b16 v[48:49], v9 offset:13056
  v_mfma_f32_16x16x32_bf16 v[82:85], v[58:61], v[38:41], v[82:85]
  ds_read_b64_tr_b16 v[50:51], v10 offset:12288
  ds_read_b64_tr_b16 v[52:53], v10 offset:13056
  v_mfma_f32_16x16x32_bf16 v[74:77], v[62:65], v[34:37], v[74:77]
  v_mfma_f32_16x16x32_bf16 v[86:89], v[62:65], v[38:41], v[86:89]
  s_cmp_eq_u32 s35, 1
  s_cbranch_scc0 K1_SK_2b0
  v_mfma_f32_16x16x32_bf16 v[90:93], v[54:57], v[102:105], v[90:93]
  v_mfma_f32_16x16x32_bf16 v[94:97], v[58:61], v[102:105], v[94:97]
  v_mfma_f32_16x16x32_bf16 v[98:101], v[62:65], v[102:105], v[98:101]
K1_SK_2b0:
  s_waitcnt lgkmcnt(0)
  v_mfma_f32_16x16x32_bf16 v[66:69], v[42:45], v[26:29], v[66:69]
  ds_read_b128 v[34:37], v5 offset:8192
  ds_read_b64_tr_b16 v[54:55], v8 offset:18432
  v_mfma_f32_16x16x32_bf16 v[78:81], v[42:45], v[30:33], v[78:81]
  ds_read_b64_tr_b16 v[56:57], v8 offset:19200
  ds_read_b128 v[38:41], v7 offset:8192
  v_mfma_f32_16x16x32_bf16 v[70:73], v[46:49], v[26:29], v[70:73]
  ds_read_b64_tr_b16 v[58:59], v9 offset:18432
  ds_read_b64_tr_b16 v[60:61], v9 offset:19200
  v_mfma_f32_16x16x32_bf16 v[82:85], v[46:49], v[30:33], v[82:85]
  ds_read_b64_tr_b16 v[62:63], v10 offset:18432
  ds_read_b64_tr_b16 v[64:65], v10 offset:19200
  v_mfma_f32_16x16x32_bf16 v[74:77], v[50:53], v[26:29], v[74:77]
  v_mfma_f32_16x16x32_bf16 v[86:89], v[50:53], v[30:33], v[86:89]
  s_cmp_eq_u32 s35, 0
  s_cbranch_scc0 K1_SK_2a1
  v_mfma_f32_16x16x32_bf16 v[90:93], v[42:45], v[102:105], v[90:93]
  v_mfma_f32_16x16x32_bf16 v[94:97], v[46:49], v[102:105], v[94:97]
  v_mfma_f32_16x16x32_bf16 v[98:101], v[50:53], v[102:105], v[98:101]
K1_SK_2a1:
  s_waitcnt lgkmcnt(0)
  s_barrier
  v_mfma_f32_16x16x32_bf16 v[66:69], v[54:57], v[34:37], v[66:69]
  ds_read_b128 v[26:29], v4 offset:16384
  ds_read_b64_tr_b16 v[42:43], v8 offset:24576
  v_mfma_f32_16x16x32_bf16 v[78:81], v[54:57], v[38:41], v[78:81]
  ds_read_b64_tr_b16 v[44:45], v8 offset:25344
  ds_read_b128 v[30:33], v6 offset:16384
  v_mfma_f32_16x16x32_bf16 v[70:73], v[58:61], v[34:37], v[70:73]
  ds_read_b64_tr_b16 v[46:47], v9 offset:24576
  ds_read_b64_tr_b16 v[48:49], v9 offset:25344
  v_mfma_f32_16x16x32_bf16 v[82:85], v[58:61], v[38:41], v[82:85]
  ds_read_b64_tr_b16 v[50:51], v10 offset:24576
  ds_read_b64_tr_b16 v[52:53], v10 offset:25344
  v_mfma_f32_16x16x32_bf16 v[74:77], v[62:65], v[34:37], v[74:77]
  v_mfma_f32_16x16x32_bf16 v[86:89], v[62:65], v[38:41], v[86:89]
  s_cmp_eq_u32 s35, 1
  s_cbranch_scc0 K1_SK_2b1
  v_mfma_f32_16x16x32_bf16 v[90:93], v[54:57], v[102:105], v[90:93]
  v_mfma_f32_16x16x32_bf16 v[94:97], v[58:61], v[102:105], v[94:97]
  v_mfma_f32_16x16x32_bf16 v[98:101], v[62:65], v[102:105], v[98:101]
K1_SK_2b1:
  s_waitcnt lgkmcnt(0)
  v_mfma_f32_16x16x32_bf16 v[66:69], v[42:45], v[26:29], v[66:69]
  ds_read_b128 v[34:37], v5 offset:16384
  ds_read_b64_tr_b16 v[54:55], v8 offset:30720
  v_mfma_f32_16x16x32_bf16 v[78:81], v[42:45], v[30:33], v[78:81]
  ds_read_b64_tr_b16 v[56:57], v8 offset:31488
  ds_read_b128 v[38:41], v7 offset:16384
  v_mfma_f32_16x16x32_bf16 v[70:73], v[46:49], v[26:29], v[70:73]
  ds_read_b64_tr_b16 v[58:59], v9 offset:30720
  ds_read_b64_tr_b16 v[60:61], v9 offset:31488
  v_mfma_f32_16x16x32_bf16 v[82:85], v[46:49], v[30:33], v[82:85]
  ds_read_b64_tr_b16 v[62:63], v10 offset:30720
  ds_read_b64_tr_b16 v[64:65], v10 offset:31488
  v_mfma_f32_16x16x32_bf16 v[74:77], v[50:53], v[26:29], v[74:77]
  v_mfma_f32_16x16x32_bf16 v[86:89], v[50:53], v[30:33], v[86:89]
  s_cmp_eq_u32 s35, 0
  s_cbranch_scc0 K1_SK_2a2
  v_mfma_f32_16x16x32_bf16 v[90:93], v[42:45], v[102:105], v[90:93]
  v_mfma_f32_16x16x32_bf16 v[94:97], v[46:49], v[102:105], v[94:97]
  v_mfma_f32_16x16x32_bf16 v[98:101], v[50:53], v[102:105], v[98:101]
K1_SK_2a2:
  s_waitcnt lgkmcnt(0)
  s_barrier
  v_mfma_f32_16x16x32_bf16 v[66:69], v[54:57], v[34:37], v[66:69]
  ds_read_b128 v[26:29], v4 offset:24576
  ds_read_b64_tr_b16 v[42:43], v8 offset:36864
  v_mfma_f32_16x16x32_bf16 v[78:81], v[54:57], v[38:41], v[78:81]
  ds_read_b64_tr_b16 v[44:45], v8 offset:37632
  ds_read_b128 v[30:33], v6 offset:24576
  v_mfma_f32_16x16x32_bf16 v[70:73], v[58:61], v[34:37], v[70:73]
  ds_read_b64_tr_b16 v[46:47], v9 offset:36864
  ds_read_b64_tr_b16 v[48:49], v9 offset:37632
  v_mfma_f32_16x16x32_bf16 v[82:85], v[58:61], v[38:41], v[82:85]
  ds_read_b64_tr_b16 v[50:51], v10 offset:36864
  ds_read_b64_tr_b16 v[52:53], v10 offset:37632
  v_mfma_f32_16x16x32_bf16 v[74:77], v[62:65], v[34:37], v[74:77]
  v_mfma_f32_16x16x32_bf16 v[86:89], v[62:65], v[38:41], v[86:89]
  s_cmp_eq_u32 s35, 1
  s_cbranch_scc0 K1_SK_2b2
  v_mfma_f32_16x16x32_bf16 v[90:93], v[54:57], v[102:105], v[90:93]
  v_mfma_f32_16x16x32_bf16 v[94:97], v[58:61], v[102:105], v[94:97]
  v_mfma_f32_16x16x32_bf16 v[98:101], v[62:65], v[102:105], v[98:101]
K1_SK_2b2:
  s_waitcnt lgkmcnt(0)
  v_mfma_f32_16x16x32_bf16 v[66:69], v[42:45], v[26:29], v[66:69]
  ds_read_b128 v[34:37], v5 offset:24576
  ds_read_b64_tr_b16 v[54:55], v8 offset:43008
  v_mfma_f32_16x16x32_bf16 v[78:81], v[42:45], v[30:33], v[78:81]
  ds_read_b64_tr_b16 v[56:57], v8 offset:43776
  ds_read_b128 v[38:41], v7 offset:24576
  v_mfma_f32_16x16x32_bf16 v[70:73], v[46:49], v[26:29], v[70:73]
  ds_read_b64_tr_b16 v[58:59], v9 offset:43008
  ds_read_b64_tr_b16 v[60:61], v9 offset:43776
  v_mfma_f32_16x16x32_bf16 v[82:85], v[46:49], v[30:33], v[82:85]
  ds_read_b64_tr_b16 v[62:63], v10 offset:43008
  ds_read_b64_tr_b16 v[64:65], v10 offset:43776
  v_mfma_f32_16x16x32_bf16 v[74:77], v[50:53], v[26:29], v[74:77]
  v_mfma_f32_16x16x32_bf16 v[86:89], v[50:53], v[30:33], v[86:89]
  s_cmp_eq_u32 s35, 0
  s_cbranch_scc0 K1_SK_2a3
  v_mfma_f32_16x16x32_bf16 v[90:93], v[42:45], v[102:105], v[90:93]
  v_mfma_f32_16x16x32_bf16 v[94:97], v[46:49], v[102:105], v[94:97]
  v_mfma_f32_16x16x32_bf16 v[98:101], v[50:53], v[102:105], v[98:101]
K1_SK_2a3:
  s_waitcnt lgkmcnt(0)
  s_barrier
  v_mfma_f32_16x16x32_bf16 v[66:69], v[54:57], v[34:37], v[66:69]
  ds_read_b128 v[26:29], v4 offset:32768
  ds_read_b64_tr_b16 v[42:43], v8 offset:49152
  v_mfma_f32_16x16x32_bf16 v[78:81], v[54:57], v[38:41], v[78:81]
  ds_read_b64_tr_b16 v[44:45], v8 offset:49920
  ds_read_b128 v[30:33], v6 offset:32768
  v_mfma_f32_16x16x32_bf16 v[70:73], v[58:61], v[34:37], v[70:73]
  ds_read_b64_tr_b16 v[46:47], v9 offset:49152
  ds_read_b64_tr_b16 v[48:49], v9 offset:49920
  v_mfma_f32_16x16x32_bf16 v[82:85], v[58:61], v[38:41], v[82:85]
  ds_read_b64_tr_b16 v[50:51], v10 offset:49152
  ds_read_b64_tr_b16 v[52:53], v10 offset:49920
  v_mfma_f32_16x16x32_bf16 v[74:77], v[62:65], v[34:37], v[74:77]
  v_mfma_f32_16x16x32_bf16 v[86:89], v[62:65], v[38:41], v[86:89]
  s_cmp_eq_u32 s35, 1
  s_cbranch_scc0 K1_SK_2b3
  v_mfma_f32_16x16x32_bf16 v[90:93], v[54:57], v[102:105], v[90:93]
  v_mfma_f32_16x16x32_bf16 v[94:97], v[58:61], v[102:105], v[94:97]
  v_mfma_f32_16x16x32_bf16 v[98:101], v[62:65], v[102:105], v[98:101]
K1_SK_2b3:
  s_waitcnt lgkmcnt(0)
  v_mfma_f32_16x16x32_bf16 v[66:69], v[42:45], v[26:29], v[66:69]
  ds_read_b128 v[34:37], v5 offset:32768
  ds_read_b64_tr_b16 v[54:55], v8 offset:55296
  v_mfma_f32_16x16x32_bf16 v[78:81], v[42:45], v[30:33], v[78:81]
  ds_read_b64_tr_b16 v[56:57], v8 offset:56064
  ds_read_b128 v[38:41], v7 offset:32768
  v_mfma_f32_16x16x32_bf16 v[70:73], v[46:49], v[26:29], v[70:73]
  ds_read_b64_tr_b16 v[58:59], v9 offset:55296
  ds_read_b64_tr_b16 v[60:61], v9 offset:56064
  v_mfma_f32_16x16x32_bf16 v[82:85], v[46:49], v[30:33], v[82:85]
  ds_read_b64_tr_b16 v[62:63], v10 offset:55296
  ds_read_b64_tr_b16 v[64:65], v10 offset:56064
  v_mfma_f32_16x16x32_bf16 v[74:77], v[50:53], v[26:29], v[74:77]
  v_mfma_f32_16x16x32_bf16 v[86:89], v[50:53], v[30:33], v[86:89]
  s_cmp_eq_u32 s35, 0
  s_cbranch_scc0 K1_SK_2a4
  v_mfma_f32_16x16x32_bf16 v[90:93], v[42:45], v[102:105], v[90:93]
  v_mfma_f32_16x16x32_bf16 v[94:97], v[46:49], v[102:105], v[94:97]
  v_mfma_f32_16x16x32_bf16 v[98:101], v[50:53], v[102:105], v[98:101]
K1_SK_2a4:
  s_waitcnt lgkmcnt(0)
  s_barrier
  v_add_u32 v4, 40960, v4
  v_add_u32 v5, 40960, v5
  v_add_u32 v6, 40960, v6
  v_add_u32 v7, 40960, v7
  v_mfma_f32_16x16x32_bf16 v[66:69], v[54:57], v[34:37], v[66:69]
  ds_read_b128 v[26:29], v4 offset:0
  ds_read_b64_tr_b16 v[42:43], v8 offset:0
  v_mfma_f32_16x16x32_bf16 v[78:81], v[54:57], v[38:41], v[78:81]
  ds_read_b64_tr_b16 v[44:45], v8 offset:768
  ds_read_b128 v[30:33], v6 offset:0
  v_mfma_f32_16x16x32_bf16 v[70:73], v[58:61], v[34:37], v[70:73]
  ds_read_b64_tr_b16 v[46:47], v9 offset:0
  ds_read_b64_tr_b16 v[48:49], v9 offset:768
  v_mfma_f32_16x16x32_bf16 v[82:85], v[58:61], v[38:41], v[82:85]
  ds_read_b64_tr_b16 v[50:51], v10 offset:0
  ds_read_b64_tr_b16 v[52:53], v10 offset:768
  v_mfma_f32_16x16x32_bf16 v[74:77], v[62:65], v[34:37], v[74:77]
  v_mfma_f32_16x16x32_bf16 v[86:89], v[62:65], v[38:41], v[86:89]
  s_cmp_eq_u32 s35, 1
  s_cbranch_scc0 K1_SK_2b4
  v_mfma_f32_16x16x32_bf16 v[90:93], v[54:57], v[102:105], v[90:93]
  v_mfma_f32_16x16x32_bf16 v[94:97], v[58:61], v[102:105], v[94:97]
  v_mfma_f32_16x16x32_bf16 v[98:101], v[62:65], v[102:105], v[98:101]
K1_SK_2b4:
  s_add_u32 s37, s37, 1
  s_cmp_lt_u32 s37, 2
  s_cbranch_scc1 K1_LOOP2
  s_mul_i32 s40, s55, 192
  s_add_u32 s40, s40, 144640
  v_lshlrev_b32 v18, 4, v2
  v_add_u32 v19, s40, v18
  s_mov_b32 exec_lo, 0x10001
  s_mov_b32 exec_hi, 0x10001
  ds_write_b128 v19, v[90:93] offset:0
  ds_write_b128 v19, v[94:97] offset:64
  ds_write_b128 v19, v[98:101] offset:128
  s_mov_b64 exec, s[52:53]
  v_mov_b32 v126, 0xc0135761
  v_mov_b32 v127, 0xc0135761
  s_waitcnt lgkmcnt(0)
  s_barrier
  s_xor_b32 s41, s55, 2
  s_mul_i32 s41, s41, 192
  s_add_u32 s41, s41, 144640
  v_add_u32 v19, s41, v18
  ds_read_b128 v[26:29], v19 offset:0
  ds_read_b128 v[30:33], v19 offset:64
  ds_read_b128 v[34:37], v19 offset:128
  s_lshl_b32 s40, s35, 7
  s_lshl_b32 s41, s36, 6
  s_add_u32 s40, s40, s41
  s_add_u32 s40, s40, 143360
  v_lshlrev_b32 v20, 2, v3
  v_add_u32 v20, s40, v20
  v_xor_b32 v21, 64, v20
  ds_read_b32 v42, v20
  ds_read_b32 v44, v21
  ds_read_b32 v46, v20 offset:256
  ds_read_b32 v48, v21 offset:256
  s_lshl_b32 s40, s32, 2
  s_lshl_b32 s41, s35, 1
  s_add_u32 s40, s40, s41
  s_add_u32 s41, s40, s36
  s_xor_b32 s42, s41, 1
  s_mul_i32 s39, s33, 6
  s_mul_i32 s38, s36, 3
  s_add_u32 s39, s39, s38
  s_mul_i32 s41, s41, 48
  s_add_u32 s41, s41, s39
  s_lshl_b32 s41, s41, 9
  s_add_u32 s41, s41, 0
  s_mul_i32 s42, s42, 48
  s_add_u32 s42, s42, s39
  s_lshl_b32 s42, s42, 9
  s_add_u32 s42, s42, 0
  v_lshlrev_b32 v20, 3, v1
  s_waitcnt lgkmcnt(0)
  v_add_f32 v26, v26, v90
  v_sub_f32 v26, 0, v26
  v_add_f32 v27, v27, v91
  v_sub_f32 v27, 0, v27
  v_add_f32 v28, v28, v92
  v_sub_f32 v28, 0, v28
  v_add_f32 v29, v29, v93
  v_sub_f32 v29, 0, v29
  v_add_f32 v30, v30, v94
  v_sub_f32 v30, 0, v30
  v_add_f32 v31, v31, v95
  v_sub_f32 v31, 0, v31
  v_add_f32 v32, v32, v96
  v_sub_f32 v32, 0, v32
  v_add_f32 v33, v33, v97
  v_sub_f32 v33, 0, v33
  v_add_f32 v34, v34, v98
  v_sub_f32 v34, 0, v34
  v_add_f32 v35, v35, v99
  v_sub_f32 v35, 0, v35
  v_add_f32 v36, v36, v100
  v_sub_f32 v36, 0, v36
  v_add_f32 v37, v37, v101
  v_sub_f32 v37, 0, v37
  v_pk_fma_f32 v[66:67], v[26:27], v[42:43], v[66:67] op_sel_hi:[1,0,1]
  v_pk_mul_f32 v[66:67], v[66:67], v[46:47] op_sel_hi:[1,0]
  v_pk_mul_f32 v[128:129], v[66:67], v[66:67]
  v_pk_fma_f32 v[128:129], v[128:129], s[48:49], v[126:127]
  v_pk_mul_f32 v[128:129], v[128:129], v[66:67]
  v_exp_f32 v128, v128
  v_exp_f32 v129, v129
  s_nop 0
  v_pk_add_f32 v[128:129], v[128:129], s[50:51]
  v_rcp_f32 v128, v128
  v_rcp_f32 v129, v129
  s_nop 0
  v_pk_mul_f32 v[128:129], v[128:129], v[66:67]
  v_cvt_pk_bf16_f32 v114, v128, v129
  v_pk_fma_f32 v[68:69], v[28:29], v[42:43], v[68:69] op_sel_hi:[1,0,1]
  v_pk_mul_f32 v[68:69], v[68:69], v[46:47] op_sel_hi:[1,0]
  v_pk_mul_f32 v[132:133], v[68:69], v[68:69]
  v_pk_fma_f32 v[132:133], v[132:133], s[48:49], v[126:127]
  v_pk_mul_f32 v[132:133], v[132:133], v[68:69]
  v_exp_f32 v132, v132
  v_exp_f32 v133, v133
  s_nop 0
  v_pk_add_f32 v[132:133], v[132:133], s[50:51]
  v_rcp_f32 v132, v132
  v_rcp_f32 v133, v133
  s_nop 0
  v_pk_mul_f32 v[132:133], v[132:133], v[68:69]
  v_cvt_pk_bf16_f32 v115, v132, v133
  buffer_store_dwordx2 v[114:115], v20, s[16:19], s41 offen offset:0
  v_pk_fma_f32 v[70:71], v[30:31], v[42:43], v[70:71] op_sel_hi:[1,0,1]
  v_pk_mul_f32 v[70:71], v[70:71], v[46:47] op_sel_hi:[1,0]
  v_pk_mul_f32 v[128:129], v[70:71], v[70:71]
  v_pk_fma_f32 v[128:129], v[128:129], s[48:49], v[126:127]
  v_pk_mul_f32 v[128:129], v[128:129], v[70:71]
  v_exp_f32 v128, v128
  v_exp_f32 v129, v129
  s_nop 0
  v_pk_add_f32 v[128:129], v[128:129], s[50:51]
  v_rcp_f32 v128, v128
  v_rcp_f32 v129, v129
  s_nop 0
  v_pk_mul_f32 v[128:129], v[128:129], v[70:71]
  v_cvt_pk_bf16_f32 v116, v128, v129
  v_pk_fma_f32 v[72:73], v[32:33], v[42:43], v[72:73] op_sel_hi:[1,0,1]
  v_pk_mul_f32 v[72:73], v[72:73], v[46:47] op_sel_hi:[1,0]
  v_pk_mul_f32 v[132:133], v[72:73], v[72:73]
  v_pk_fma_f32 v[132:133], v[132:133], s[48:49], v[126:127]
  v_pk_mul_f32 v[132:133], v[132:133], v[72:73]
  v_exp_f32 v132, v132
  v_exp_f32 v133, v133
  s_nop 0
  v_pk_add_f32 v[132:133], v[132:133], s[50:51]
  v_rcp_f32 v132, v132
  v_rcp_f32 v133, v133
  s_nop 0
  v_pk_mul_f32 v[132:133], v[132:133], v[72:73]
  v_cvt_pk_bf16_f32 v117, v132, v133
  buffer_store_dwordx2 v[116:117], v20, s[16:19], s41 offen offset:512
  v_pk_fma_f32 v[74:75], v[34:35], v[42:43], v[74:75] op_sel_hi:[1,0,1]
  v_pk_mul_f32 v[74:75], v[74:75], v[46:47] op_sel_hi:[1,0]
  v_pk_mul_f32 v[128:129], v[74:75], v[74:75]
  v_pk_fma_f32 v[128:129], v[128:129], s[48:49], v[126:127]
  v_pk_mul_f32 v[128:129], v[128:129], v[74:75]
  v_exp_f32 v128, v128
  v_exp_f32 v129, v129
  s_nop 0
  v_pk_add_f32 v[128:129], v[128:129], s[50:51]
  v_rcp_f32 v128, v128
  v_rcp_f32 v129, v129
  s_nop 0
  v_pk_mul_f32 v[128:129], v[128:129], v[74:75]
  v_cvt_pk_bf16_f32 v118, v128, v129
  v_pk_fma_f32 v[76:77], v[36:37], v[42:43], v[76:77] op_sel_hi:[1,0,1]
  v_pk_mul_f32 v[76:77], v[76:77], v[46:47] op_sel_hi:[1,0]
  v_pk_mul_f32 v[132:133], v[76:77], v[76:77]
  v_pk_fma_f32 v[132:133], v[132:133], s[48:49], v[126:127]
  v_pk_mul_f32 v[132:133], v[132:133], v[76:77]
  v_exp_f32 v132, v132
  v_exp_f32 v133, v133
  s_nop 0
  v_pk_add_f32 v[132:133], v[132:133], s[50:51]
  v_rcp_f32 v132, v132
  v_rcp_f32 v133, v133
  s_nop 0
  v_pk_mul_f32 v[132:133], v[132:133], v[76:77]
  v_cvt_pk_bf16_f32 v119, v132, v133
  buffer_store_dwordx2 v[118:119], v20, s[16:19], s41 offen offset:1024
  v_pk_fma_f32 v[78:79], v[26:27], v[44:45], v[78:79] op_sel_hi:[1,0,1]
  v_pk_mul_f32 v[78:79], v[78:79], v[48:49] op_sel_hi:[1,0]
  v_pk_mul_f32 v[128:129], v[78:79], v[78:79]
  v_pk_fma_f32 v[128:129], v[128:129], s[48:49], v[126:127]
  v_pk_mul_f32 v[128:129], v[128:129], v[78:79]
  v_exp_f32 v128, v128
  v_exp_f32 v129, v129
  s_nop 0
  v_pk_add_f32 v[128:129], v[128:129], s[50:51]
  v_rcp_f32 v128, v128
  v_rcp_f32 v129, v129
  s_nop 0
  v_pk_mul_f32 v[128:129], v[128:129], v[78:79]
  v_cvt_pk_bf16_f32 v120, v128, v129
  v_pk_fma_f32 v[80:81], v[28:29], v[44:45], v[80:81] op_sel_hi:[1,0,1]
  v_pk_mul_f32 v[80:81], v[80:81], v[48:49] op_sel_hi:[1,0]
  v_pk_mul_f32 v[132:133], v[80:81], v[80:81]
  v_pk_fma_f32 v[132:133], v[132:133], s[48:49], v[126:127]
  v_pk_mul_f32 v[132:133], v[132:133], v[80:81]
  v_exp_f32 v132, v132
  v_exp_f32 v133, v133
  s_nop 0
  v_pk_add_f32 v[132:133], v[132:133], s[50:51]
  v_rcp_f32 v132, v132
  v_rcp_f32 v133, v133
  s_nop 0
  v_pk_mul_f32 v[132:133], v[132:133], v[80:81]
  v_cvt_pk_bf16_f32 v121, v132, v133
  buffer_store_dwordx2 v[120:121], v20, s[16:19], s42 offen offset:0
  v_pk_fma_f32 v[82:83], v[30:31], v[44:45], v[82:83] op_sel_hi:[1,0,1]
  v_pk_mul_f32 v[82:83], v[82:83], v[48:49] op_sel_hi:[1,0]
  v_pk_mul_f32 v[128:129], v[82:83], v[82:83]
  v_pk_fma_f32 v[128:129], v[128:129], s[48:49], v[126:127]
  v_pk_mul_f32 v[128:129], v[128:129], v[82:83]
  v_exp_f32 v128, v128
  v_exp_f32 v129, v129
  s_nop 0
  v_pk_add_f32 v[128:129], v[128:129], s[50:51]
  v_rcp_f32 v128, v128
  v_rcp_f32 v129, v129
  s_nop 0
  v_pk_mul_f32 v[128:129], v[128:129], v[82:83]
  v_cvt_pk_bf16_f32 v122, v128, v129
  v_pk_fma_f32 v[84:85], v[32:33], v[44:45], v[84:85] op_sel_hi:[1,0,1]
  v_pk_mul_f32 v[84:85], v[84:85], v[48:49] op_sel_hi:[1,0]
  v_pk_mul_f32 v[132:133], v[84:85], v[84:85]
  v_pk_fma_f32 v[132:133], v[132:133], s[48:49], v[126:127]
  v_pk_mul_f32 v[132:133], v[132:133], v[84:85]
  v_exp_f32 v132, v132
  v_exp_f32 v133, v133
  s_nop 0
  v_pk_add_f32 v[132:133], v[132:133], s[50:51]
  v_rcp_f32 v132, v132
  v_rcp_f32 v133, v133
  s_nop 0
  v_pk_mul_f32 v[132:133], v[132:133], v[84:85]
  v_cvt_pk_bf16_f32 v123, v132, v133
  buffer_store_dwordx2 v[122:123], v20, s[16:19], s42 offen offset:512
  v_pk_fma_f32 v[86:87], v[34:35], v[44:45], v[86:87] op_sel_hi:[1,0,1]
  v_pk_mul_f32 v[86:87], v[86:87], v[48:49] op_sel_hi:[1,0]
  v_pk_mul_f32 v[128:129], v[86:87], v[86:87]
  v_pk_fma_f32 v[128:129], v[128:129], s[48:49], v[126:127]
  v_pk_mul_f32 v[128:129], v[128:129], v[86:87]
  v_exp_f32 v128, v128
  v_exp_f32 v129, v129
  s_nop 0
  v_pk_add_f32 v[128:129], v[128:129], s[50:51]
  v_rcp_f32 v128, v128
  v_rcp_f32 v129, v129
  s_nop 0
  v_pk_mul_f32 v[128:129], v[128:129], v[86:87]
  v_cvt_pk_bf16_f32 v124, v128, v129
  v_pk_fma_f32 v[88:89], v[36:37], v[44:45], v[88:89] op_sel_hi:[1,0,1]
  v_pk_mul_f32 v[88:89], v[88:89], v[48:49] op_sel_hi:[1,0]
  v_pk_mul_f32 v[132:133], v[88:89], v[88:89]
  v_pk_fma_f32 v[132:133], v[132:133], s[48:49], v[126:127]
  v_pk_mul_f32 v[132:133], v[132:133], v[88:89]
  v_exp_f32 v132, v132
  v_exp_f32 v133, v133
  s_nop 0
  v_pk_add_f32 v[132:133], v[132:133], s[50:51]
  v_rcp_f32 v132, v132
  v_rcp_f32 v133, v133
  s_nop 0
  v_pk_mul_f32 v[132:133], v[132:133], v[88:89]
  v_cvt_pk_bf16_f32 v125, v132, v133
  buffer_store_dwordx2 v[124:125], v20, s[16:19], s42 offen offset:1024
K1_END:
  s_endpgm

.section .rodata,"a"
.p2align 6
.amdhsa_kernel k1_kernel
  .amdhsa_next_free_vgpr 168
  .amdhsa_next_free_sgpr 96
  .amdhsa_accum_offset 168
  .amdhsa_group_segment_fixed_size 0
  .amdhsa_kernarg_size 112
  .amdhsa_user_sgpr_count 2
  .amdhsa_user_sgpr_kernarg_segment_ptr 1
  .amdhsa_system_sgpr_workgroup_id_x 1
  .amdhsa_float_denorm_mode_32 3
.end_amdhsa_kernel
.text
.globl k2_kernel
.p2align 8
.type k2_kernel,@function
k2_kernel:
  s_cmp_ge_u32 s2, 470
  s_cbranch_scc1 K2_END
  s_cmp_ge_u32 s2, 256
  s_cbranch_scc1 K2_CONV
  s_load_dwordx4 s[36:39], s[0:1], 64
  s_load_dwordx2 s[40:41], s[0:1], 104
  v_and_b32 v1, 63, v0
  v_lshrrev_b32 v14, 6, v0
  v_lshrrev_b32 v2, 4, v1
  v_readfirstlane_b32 s22, v14
  v_and_b32 v3, 15, v1
  s_and_b32 s28, s2, 7
  s_lshr_b32 s29, s2, 3
  s_lshr_b32 s20, s28, 1
  s_lshl_b32 s20, s20, 3
  s_lshr_b32 s30, s29, 2
  s_add_u32 s20, s20, s30
  s_and_b32 s21, s28, 1
  s_lshl_b32 s21, s21, 2
  s_and_b32 s30, s29, 3
  s_add_u32 s21, s21, s30
  s_and_b32 s23, s22, 1
  s_lshr_b32 s24, s22, 1
  s_mov_b32 s32, 0xffff0000
  s_lshl_b32 s28, s20, 6
  s_lshl_b32 s29, s22, 4
  s_add_u32 s28, s28, s29
  v_add_u32 v14, 0, v2
  v_xor_b32 v15, v14, v3
  v_lshlrev_b32 v15, 4, v15
  v_add_u32 v14, s28, v14
  v_lshlrev_b32 v14, 12, v14
  v_add_u32 v4, v14, v15
  v_add_u32 v14, 4, v2
  v_xor_b32 v15, v14, v3
  v_lshlrev_b32 v15, 4, v15
  v_add_u32 v14, s28, v14
  v_lshlrev_b32 v14, 12, v14
  v_add_u32 v5, v14, v15
  v_add_u32 v14, 8, v2
  v_xor_b32 v15, v14, v3
  v_lshlrev_b32 v15, 4, v15
  v_add_u32 v14, s28, v14
  v_lshlrev_b32 v14, 12, v14
  v_add_u32 v6, v14, v15
  v_add_u32 v14, 12, v2
  v_xor_b32 v15, v14, v3
  v_lshlrev_b32 v15, 4, v15
  v_add_u32 v14, s28, v14
  v_lshlrev_b32 v14, 12, v14
  v_add_u32 v7, v14, v15
  v_xor_b32 v14, v2, v3
  v_lshlrev_b32 v14, 4, v14
  s_lshl_b32 s28, s24, 6
  v_xor_b32 v14, s28, v14
  v_lshlrev_b32 v15, 8, v3
  v_add_u32 v8, v14, v15
  v_xor_b32 v9, 128, v8
  s_mul_i32 s28, s21, 6
  s_mul_i32 s29, s23, 3
  s_add_u32 s28, s28, s29
  s_mov_b32 s31, s28
  s_mov_b32 s33, s28
  s_lshl_b32 s28, s28, 16
  s_add_u32 s28, s28, 3145728
  v_lshlrev_b32 v14, 4, v1
  s_add_u32 s29, s28, 0
  v_add_u32 v10, s29, v14
  s_add_u32 s29, s28, 65536
  v_add_u32 v11, s29, v14
  s_add_u32 s29, s28, 131072
  v_add_u32 v12, s29, v14
  s_waitcnt lgkmcnt(0)
  s_mov_b32 s8, s36
  s_and_b32 s9, s37, 0xffff
  s_mov_b32 s10, 8388608
  s_mov_b32 s11, 0x20000
  s_mov_b32 s16, s38
  s_and_b32 s17, s39, 0xffff
  s_mov_b32 s18, 4096
  s_mov_b32 s19, 0x20000
  s_mov_b32 s12, s40
  s_and_b32 s13, s41, 0xffff
  s_mov_b32 s14, 18874368
  s_mov_b32 s15, 0x20000
  s_lshl_b32 s31, s22, 12
  s_lshl_b32 s40, s24, 10
  s_mov_b32 s25, 0
  s_add_u32 s29, s25, 0
  s_lshl_b32 s26, s29, 8
  s_lshl_b32 s27, s29, 12
  s_add_u32 s27, s27, s40
  s_cmp_lt_u32 s29, 16
  s_cselect_b32 s26, s26, 0x80000000
  s_cselect_b32 s27, s27, 0x80000000
  s_add_u32 s35, s27, 2048
  buffer_load_dwordx4 v[120:123], v10, s[12:15], s27 offen
  buffer_load_dwordx4 v[124:127], v11, s[12:15], s27 offen
  buffer_load_dwordx4 v[128:131], v12, s[12:15], s27 offen
  s_add_u32 m0, s31, 0
  s_nop 0
  buffer_load_dwordx4 v4, s[8:11], s26 offen lds
  s_add_u32 m0, s31, 1024
  s_nop 0
  buffer_load_dwordx4 v5, s[8:11], s26 offen lds
  buffer_load_dwordx4 v[132:135], v10, s[12:15], s35 offen
  buffer_load_dwordx4 v[136:139], v11, s[12:15], s35 offen
  buffer_load_dwordx4 v[140:143], v12, s[12:15], s35 offen
  s_add_u32 m0, s31, 2048
  s_nop 0
  buffer_load_dwordx4 v6, s[8:11], s26 offen lds
  s_add_u32 m0, s31, 3072
  s_nop 0
  buffer_load_dwordx4 v7, s[8:11], s26 offen lds
  s_add_u32 s29, s25, 1
  s_lshl_b32 s26, s29, 8
  s_lshl_b32 s27, s29, 12
  s_add_u32 s27, s27, s40
  s_cmp_lt_u32 s29, 16
  s_cselect_b32 s26, s26, 0x80000000
  s_cselect_b32 s27, s27, 0x80000000
  s_add_u32 s35, s27, 2048
  buffer_load_dwordx4 v[144:147], v10, s[12:15], s27 offen
  buffer_load_dwordx4 v[148:151], v11, s[12:15], s27 offen
  buffer_load_dwordx4 v[152:155], v12, s[12:15], s27 offen
  s_add_u32 m0, s31, 16384
  s_nop 0
  buffer_load_dwordx4 v4, s[8:11], s26 offen lds
  s_add_u32 m0, s31, 17408
  s_nop 0
  buffer_load_dwordx4 v5, s[8:11], s26 offen lds
  buffer_load_dwordx4 v[156:159], v10, s[12:15], s35 offen
  buffer_load_dwordx4 v[160:163], v11, s[12:15], s35 offen
  buffer_load_dwordx4 v[164:167], v12, s[12:15], s35 offen
  s_add_u32 m0, s31, 18432
  s_nop 0
  buffer_load_dwordx4 v6, s[8:11], s26 offen lds
  s_add_u32 m0, s31, 19456
  s_nop 0
  buffer_load_dwordx4 v7, s[8:11], s26 offen lds
  s_add_u32 s29, s25, 2
  s_lshl_b32 s26, s29, 8
  s_lshl_b32 s27, s29, 12
  s_add_u32 s27, s27, s40
  s_cmp_lt_u32 s29, 16
  s_cselect_b32 s26, s26, 0x80000000
  s_cselect_b32 s27, s27, 0x80000000
  s_add_u32 s35, s27, 2048
  buffer_load_dwordx4 v[168:171], v10, s[12:15], s27 offen
  buffer_load_dwordx4 v[172:175], v11, s[12:15], s27 offen
  buffer_load_dwordx4 v[176:179], v12, s[12:15], s27 offen
  s_add_u32 m0, s31, 32768
  s_nop 0
  buffer_load_dwordx4 v4, s[8:11], s26 offen lds
  s_add_u32 m0, s31, 33792
  s_nop 0
  buffer_load_dwordx4 v5, s[8:11], s26 offen lds
  buffer_load_dwordx4 v[180:183], v10, s[12:15], s35 offen
  buffer_load_dwordx4 v[184:187], v11, s[12:15], s35 offen
  buffer_load_dwordx4 v[188:191], v12, s[12:15], s35 offen
  s_add_u32 m0, s31, 34816
  s_nop 0
  buffer_load_dwordx4 v6, s[8:11], s26 offen lds
  s_add_u32 m0, s31, 35840
  s_nop 0
  buffer_load_dwordx4 v7, s[8:11], s26 offen lds
  s_lshl_b32 s28, s20, 2
  s_lshl_b32 s29, s24, 1
  s_add_u32 s28, s28, s29
  s_mov_b32 s34, s28
  s_mul_i32 s29, s28, 48
  s_add_u32 s29, s29, s33
  s_lshl_b32 s29, s29, 9
  s_add_u32 s29, s29, 0
  s_add_u32 s30, s29, 24576
  v_lshlrev_b32 v14, 3, v1
  buffer_load_dwordx2 v[24:25], v14, s[12:15], s29 offen offset:0
  buffer_load_dwordx2 v[26:27], v14, s[12:15], s29 offen offset:512
  buffer_load_dwordx2 v[28:29], v14, s[12:15], s29 offen offset:1024
  buffer_load_dwordx2 v[30:31], v14, s[12:15], s30 offen offset:0
  buffer_load_dwordx2 v[32:33], v14, s[12:15], s30 offen offset:512
  buffer_load_dwordx2 v[34:35], v14, s[12:15], s30 offen offset:1024
  v_lshlrev_b32 v15, 1, v3
  s_lshl_b32 s28, s28, 5
  buffer_load_ushort v36, v15, s[16:19], s28 offen
  buffer_load_ushort v37, v15, s[16:19], s28 offen offset:32
  v_mov_b32 v72, 0
  v_mov_b32 v73, 0
  v_mov_b32 v74, 0
  v_mov_b32 v75, 0
  v_mov_b32 v76, 0
  v_mov_b32 v77, 0
  v_mov_b32 v78, 0
  v_mov_b32 v79, 0
  v_mov_b32 v80, 0
  v_mov_b32 v81, 0
  v_mov_b32 v82, 0
  v_mov_b32 v83, 0
  v_mov_b32 v84, 0
  v_mov_b32 v85, 0
  v_mov_b32 v86, 0
  v_mov_b32 v87, 0
  v_mov_b32 v88, 0
  v_mov_b32 v89, 0
  v_mov_b32 v90, 0
  v_mov_b32 v91, 0
  v_mov_b32 v92, 0
  v_mov_b32 v93, 0
  v_mov_b32 v94, 0
  v_mov_b32 v95, 0
  v_mov_b32 v96, 0
  v_mov_b32 v97, 0
  v_mov_b32 v98, 0
  v_mov_b32 v99, 0
  v_mov_b32 v100, 0
  v_mov_b32 v101, 0
  v_mov_b32 v102, 0
  v_mov_b32 v103, 0
  v_mov_b32 v104, 0
  v_mov_b32 v105, 0
  v_mov_b32 v106, 0
  v_mov_b32 v107, 0
  v_mov_b32 v108, 0
  v_mov_b32 v109, 0
  v_mov_b32 v110, 0
  v_mov_b32 v111, 0
  v_mov_b32 v112, 0
  v_mov_b32 v113, 0
  v_mov_b32 v114, 0
  v_mov_b32 v115, 0
  v_mov_b32 v116, 0
  v_mov_b32 v117, 0
  v_mov_b32 v118, 0
  v_mov_b32 v119, 0
  s_waitcnt vmcnt(28)
  s_barrier
  ds_read_b128 v[40:43], v8 offset:0
  ds_read_b128 v[44:47], v8 offset:4096
  ds_read_b128 v[48:51], v8 offset:8192
  ds_read_b128 v[52:55], v8 offset:12288
K2_LOOP:
  s_add_u32 s29, s25, 3
  s_lshl_b32 s26, s29, 8
  s_lshl_b32 s27, s29, 12
  s_add_u32 s27, s27, s40
  s_cmp_lt_u32 s29, 16
  s_cselect_b32 s26, s26, 0x80000000
  s_cselect_b32 s27, s27, 0x80000000
  s_add_u32 s35, s27, 2048
  s_waitcnt lgkmcnt(0)
  v_mfma_f32_16x16x32_bf16 v[72:75], v[120:123], v[40:43], v[72:75]
  ds_read_b128 v[56:59], v9 offset:0
  v_mfma_f32_16x16x32_bf16 v[88:91], v[124:127], v[40:43], v[88:91]
  ds_read_b128 v[60:63], v9 offset:4096
  v_mfma_f32_16x16x32_bf16 v[104:107], v[128:131], v[40:43], v[104:107]
  ds_read_b128 v[64:67], v9 offset:8192
  buffer_load_dwordx4 v[192:195], v10, s[12:15], s27 offen
  v_mfma_f32_16x16x32_bf16 v[76:79], v[120:123], v[44:47], v[76:79]
  ds_read_b128 v[68:71], v9 offset:12288
  v_mfma_f32_16x16x32_bf16 v[92:95], v[124:127], v[44:47], v[92:95]
  buffer_load_dwordx4 v[196:199], v11, s[12:15], s27 offen
  v_mfma_f32_16x16x32_bf16 v[108:111], v[128:131], v[44:47], v[108:111]
  v_mfma_f32_16x16x32_bf16 v[80:83], v[120:123], v[48:51], v[80:83]
  buffer_load_dwordx4 v[200:203], v12, s[12:15], s27 offen
  v_mfma_f32_16x16x32_bf16 v[96:99], v[124:127], v[48:51], v[96:99]
  v_mfma_f32_16x16x32_bf16 v[112:115], v[128:131], v[48:51], v[112:115]
  s_add_u32 m0, s31, 49152
  s_nop 0
  buffer_load_dwordx4 v4, s[8:11], s26 offen lds
  v_mfma_f32_16x16x32_bf16 v[84:87], v[120:123], v[52:55], v[84:87]
  v_mfma_f32_16x16x32_bf16 v[100:103], v[124:127], v[52:55], v[100:103]
  s_add_u32 m0, s31, 50176
  s_nop 0
  buffer_load_dwordx4 v5, s[8:11], s26 offen lds
  v_mfma_f32_16x16x32_bf16 v[116:119], v[128:131], v[52:55], v[116:119]
  s_waitcnt vmcnt(15) lgkmcnt(0)
  s_barrier
  v_mfma_f32_16x16x32_bf16 v[72:75], v[132:135], v[56:59], v[72:75]
  ds_read_b128 v[40:43], v8 offset:16384
  v_mfma_f32_16x16x32_bf16 v[88:91], v[136:139], v[56:59], v[88:91]
  ds_read_b128 v[44:47], v8 offset:20480
  v_mfma_f32_16x16x32_bf16 v[104:107], v[140:143], v[56:59], v[104:107]
  ds_read_b128 v[48:51], v8 offset:24576
  buffer_load_dwordx4 v[204:207], v10, s[12:15], s35 offen
  v_mfma_f32_16x16x32_bf16 v[76:79], v[132:135], v[60:63], v[76:79]
  ds_read_b128 v[52:55], v8 offset:28672
  v_mfma_f32_16x16x32_bf16 v[92:95], v[136:139], v[60:63], v[92:95]
  buffer_load_dwordx4 v[208:211], v11, s[12:15], s35 offen
  v_mfma_f32_16x16x32_bf16 v[108:111], v[140:143], v[60:63], v[108:111]
  v_mfma_f32_16x16x32_bf16 v[80:83], v[132:135], v[64:67], v[80:83]
  buffer_load_dwordx4 v[212:215], v12, s[12:15], s35 offen
  v_mfma_f32_16x16x32_bf16 v[96:99], v[136:139], v[64:67], v[96:99]
  v_mfma_f32_16x16x32_bf16 v[112:115], v[140:143], v[64:67], v[112:115]
  s_add_u32 m0, s31, 51200
  s_nop 0
  buffer_load_dwordx4 v6, s[8:11], s26 offen lds
  v_mfma_f32_16x16x32_bf16 v[84:87], v[132:135], v[68:71], v[84:87]
  v_mfma_f32_16x16x32_bf16 v[100:103], v[136:139], v[68:71], v[100:103]
  s_add_u32 m0, s31, 52224
  s_nop 0
  buffer_load_dwordx4 v7, s[8:11], s26 offen lds
  v_mfma_f32_16x16x32_bf16 v[116:119], v[140:143], v[68:71], v[116:119]
  s_add_u32 s29, s25, 4
  s_lshl_b32 s26, s29, 8
  s_lshl_b32 s27, s29, 12
  s_add_u32 s27, s27, s40
  s_cmp_lt_u32 s29, 16
  s_cselect_b32 s26, s26, 0x80000000
  s_cselect_b32 s27, s27, 0x80000000
  s_add_u32 s35, s27, 2048
  s_waitcnt lgkmcnt(0)
  v_mfma_f32_16x16x32_bf16 v[72:75], v[144:147], v[40:43], v[72:75]
  ds_read_b128 v[56:59], v9 offset:16384
  v_mfma_f32_16x16x32_bf16 v[88:91], v[148:151], v[40:43], v[88:91]
  ds_read_b128 v[60:63], v9 offset:20480
  v_mfma_f32_16x16x32_bf16 v[104:107], v[152:155], v[40:43], v[104:107]
  ds_read_b128 v[64:67], v9 offset:24576
  buffer_load_dwordx4 v[120:123], v10, s[12:15], s27 offen
  v_mfma_f32_16x16x32_bf16 v[76:79], v[144:147], v[44:47], v[76:79]
  ds_read_b128 v[68:71], v9 offset:28672
  v_mfma_f32_16x16x32_bf16 v[92:95], v[148:151], v[44:47], v[92:95]
  buffer_load_dwordx4 v[124:127], v11, s[12:15], s27 offen
  v_mfma_f32_16x16x32_bf16 v[108:111], v[152:155], v[44:47], v[108:111]
  v_mfma_f32_16x16x32_bf16 v[80:83], v[144:147], v[48:51], v[80:83]
  buffer_load_dwordx4 v[128:131], v12, s[12:15], s27 offen
  v_mfma_f32_16x16x32_bf16 v[96:99], v[148:151], v[48:51], v[96:99]
  v_mfma_f32_16x16x32_bf16 v[112:115], v[152:155], v[48:51], v[112:115]
  s_add_u32 m0, s31, 0
  s_nop 0
  buffer_load_dwordx4 v4, s[8:11], s26 offen lds
  v_mfma_f32_16x16x32_bf16 v[84:87], v[144:147], v[52:55], v[84:87]
  v_mfma_f32_16x16x32_bf16 v[100:103], v[148:151], v[52:55], v[100:103]
  s_add_u32 m0, s31, 1024
  s_nop 0
  buffer_load_dwordx4 v5, s[8:11], s26 offen lds
  v_mfma_f32_16x16x32_bf16 v[116:119], v[152:155], v[52:55], v[116:119]
  s_waitcnt vmcnt(15) lgkmcnt(0)
  s_barrier
  v_mfma_f32_16x16x32_bf16 v[72:75], v[156:159], v[56:59], v[72:75]
  ds_read_b128 v[40:43], v8 offset:32768
  v_mfma_f32_16x16x32_bf16 v[88:91], v[160:163], v[56:59], v[88:91]
  ds_read_b128 v[44:47], v8 offset:36864
  v_mfma_f32_16x16x32_bf16 v[104:107], v[164:167], v[56:59], v[104:107]
  ds_read_b128 v[48:51], v8 offset:40960
  buffer_load_dwordx4 v[132:135], v10, s[12:15], s35 offen
  v_mfma_f32_16x16x32_bf16 v[76:79], v[156:159], v[60:63], v[76:79]
  ds_read_b128 v[52:55], v8 offset:45056
  v_mfma_f32_16x16x32_bf16 v[92:95], v[160:163], v[60:63], v[92:95]
  buffer_load_dwordx4 v[136:139], v11, s[12:15], s35 offen
  v_mfma_f32_16x16x32_bf16 v[108:111], v[164:167], v[60:63], v[108:111]
  v_mfma_f32_16x16x32_bf16 v[80:83], v[156:159], v[64:67], v[80:83]
  buffer_load_dwordx4 v[140:143], v12, s[12:15], s35 offen
  v_mfma_f32_16x16x32_bf16 v[96:99], v[160:163], v[64:67], v[96:99]
  v_mfma_f32_16x16x32_bf16 v[112:115], v[164:167], v[64:67], v[112:115]
  s_add_u32 m0, s31, 2048
  s_nop 0
  buffer_load_dwordx4 v6, s[8:11], s26 offen lds
  v_mfma_f32_16x16x32_bf16 v[84:87], v[156:159], v[68:71], v[84:87]
  v_mfma_f32_16x16x32_bf16 v[100:103], v[160:163], v[68:71], v[100:103]
  s_add_u32 m0, s31, 3072
  s_nop 0
  buffer_load_dwordx4 v7, s[8:11], s26 offen lds
  v_mfma_f32_16x16x32_bf16 v[116:119], v[164:167], v[68:71], v[116:119]
  s_add_u32 s29, s25, 5
  s_lshl_b32 s26, s29, 8
  s_lshl_b32 s27, s29, 12
  s_add_u32 s27, s27, s40
  s_cmp_lt_u32 s29, 16
  s_cselect_b32 s26, s26, 0x80000000
  s_cselect_b32 s27, s27, 0x80000000
  s_add_u32 s35, s27, 2048
  s_waitcnt lgkmcnt(0)
  v_mfma_f32_16x16x32_bf16 v[72:75], v[168:171], v[40:43], v[72:75]
  ds_read_b128 v[56:59], v9 offset:32768
  v_mfma_f32_16x16x32_bf16 v[88:91], v[172:175], v[40:43], v[88:91]
  ds_read_b128 v[60:63], v9 offset:36864
  v_mfma_f32_16x16x32_bf16 v[104:107], v[176:179], v[40:43], v[104:107]
  ds_read_b128 v[64:67], v9 offset:40960
  buffer_load_dwordx4 v[144:147], v10, s[12:15], s27 offen
  v_mfma_f32_16x16x32_bf16 v[76:79], v[168:171], v[44:47], v[76:79]
  ds_read_b128 v[68:71], v9 offset:45056
  v_mfma_f32_16x16x32_bf16 v[92:95], v[172:175], v[44:47], v[92:95]
  buffer_load_dwordx4 v[148:151], v11, s[12:15], s27 offen
  v_mfma_f32_16x16x32_bf16 v[108:111], v[176:179], v[44:47], v[108:111]
  v_mfma_f32_16x16x32_bf16 v[80:83], v[168:171], v[48:51], v[80:83]
  buffer_load_dwordx4 v[152:155], v12, s[12:15], s27 offen
  v_mfma_f32_16x16x32_bf16 v[96:99], v[172:175], v[48:51], v[96:99]
  v_mfma_f32_16x16x32_bf16 v[112:115], v[176:179], v[48:51], v[112:115]
  s_add_u32 m0, s31, 16384
  s_nop 0
  buffer_load_dwordx4 v4, s[8:11], s26 offen lds
  v_mfma_f32_16x16x32_bf16 v[84:87], v[168:171], v[52:55], v[84:87]
  v_mfma_f32_16x16x32_bf16 v[100:103], v[172:175], v[52:55], v[100:103]
  s_add_u32 m0, s31, 17408
  s_nop 0
  buffer_load_dwordx4 v5, s[8:11], s26 offen lds
  v_mfma_f32_16x16x32_bf16 v[116:119], v[176:179], v[52:55], v[116:119]
  s_waitcnt vmcnt(15) lgkmcnt(0)
  s_barrier
  v_mfma_f32_16x16x32_bf16 v[72:75], v[180:183], v[56:59], v[72:75]
  ds_read_b128 v[40:43], v8 offset:49152
  v_mfma_f32_16x16x32_bf16 v[88:91], v[184:187], v[56:59], v[88:91]
  ds_read_b128 v[44:47], v8 offset:53248
  v_mfma_f32_16x16x32_bf16 v[104:107], v[188:191], v[56:59], v[104:107]
  ds_read_b128 v[48:51], v8 offset:57344
  buffer_load_dwordx4 v[156:159], v10, s[12:15], s35 offen
  v_mfma_f32_16x16x32_bf16 v[76:79], v[180:183], v[60:63], v[76:79]
  ds_read_b128 v[52:55], v8 offset:61440
  v_mfma_f32_16x16x32_bf16 v[92:95], v[184:187], v[60:63], v[92:95]
  buffer_load_dwordx4 v[160:163], v11, s[12:15], s35 offen
  v_mfma_f32_16x16x32_bf16 v[108:111], v[188:191], v[60:63], v[108:111]
  v_mfma_f32_16x16x32_bf16 v[80:83], v[180:183], v[64:67], v[80:83]
  buffer_load_dwordx4 v[164:167], v12, s[12:15], s35 offen
  v_mfma_f32_16x16x32_bf16 v[96:99], v[184:187], v[64:67], v[96:99]
  v_mfma_f32_16x16x32_bf16 v[112:115], v[188:191], v[64:67], v[112:115]
  s_add_u32 m0, s31, 18432
  s_nop 0
  buffer_load_dwordx4 v6, s[8:11], s26 offen lds
  v_mfma_f32_16x16x32_bf16 v[84:87], v[180:183], v[68:71], v[84:87]
  v_mfma_f32_16x16x32_bf16 v[100:103], v[184:187], v[68:71], v[100:103]
  s_add_u32 m0, s31, 19456
  s_nop 0
  buffer_load_dwordx4 v7, s[8:11], s26 offen lds
  v_mfma_f32_16x16x32_bf16 v[116:119], v[188:191], v[68:71], v[116:119]
  s_add_u32 s29, s25, 6
  s_lshl_b32 s26, s29, 8
  s_lshl_b32 s27, s29, 12
  s_add_u32 s27, s27, s40
  s_cmp_lt_u32 s29, 16
  s_cselect_b32 s26, s26, 0x80000000
  s_cselect_b32 s27, s27, 0x80000000
  s_add_u32 s35, s27, 2048
  s_waitcnt lgkmcnt(0)
  v_mfma_f32_16x16x32_bf16 v[72:75], v[192:195], v[40:43], v[72:75]
  ds_read_b128 v[56:59], v9 offset:49152
  v_mfma_f32_16x16x32_bf16 v[88:91], v[196:199], v[40:43], v[88:91]
  ds_read_b128 v[60:63], v9 offset:53248
  v_mfma_f32_16x16x32_bf16 v[104:107], v[200:203], v[40:43], v[104:107]
  ds_read_b128 v[64:67], v9 offset:57344
  buffer_load_dwordx4 v[168:171], v10, s[12:15], s27 offen
  v_mfma_f32_16x16x32_bf16 v[76:79], v[192:195], v[44:47], v[76:79]
  ds_read_b128 v[68:71], v9 offset:61440
  v_mfma_f32_16x16x32_bf16 v[92:95], v[196:199], v[44:47], v[92:95]
  buffer_load_dwordx4 v[172:175], v11, s[12:15], s27 offen
  v_mfma_f32_16x16x32_bf16 v[108:111], v[200:203], v[44:47], v[108:111]
  v_mfma_f32_16x16x32_bf16 v[80:83], v[192:195], v[48:51], v[80:83]
  buffer_load_dwordx4 v[176:179], v12, s[12:15], s27 offen
  v_mfma_f32_16x16x32_bf16 v[96:99], v[196:199], v[48:51], v[96:99]
  v_mfma_f32_16x16x32_bf16 v[112:115], v[200:203], v[48:51], v[112:115]
  s_add_u32 m0, s31, 32768
  s_nop 0
  buffer_load_dwordx4 v4, s[8:11], s26 offen lds
  v_mfma_f32_16x16x32_bf16 v[84:87], v[192:195], v[52:55], v[84:87]
  v_mfma_f32_16x16x32_bf16 v[100:103], v[196:199], v[52:55], v[100:103]
  s_add_u32 m0, s31, 33792
  s_nop 0
  buffer_load_dwordx4 v5, s[8:11], s26 offen lds
  v_mfma_f32_16x16x32_bf16 v[116:119], v[200:203], v[52:55], v[116:119]
  s_waitcnt vmcnt(15) lgkmcnt(0)
  s_barrier
  v_mfma_f32_16x16x32_bf16 v[72:75], v[204:207], v[56:59], v[72:75]
  ds_read_b128 v[40:43], v8 offset:0
  v_mfma_f32_16x16x32_bf16 v[88:91], v[208:211], v[56:59], v[88:91]
  ds_read_b128 v[44:47], v8 offset:4096
  v_mfma_f32_16x16x32_bf16 v[104:107], v[212:215], v[56:59], v[104:107]
  ds_read_b128 v[48:51], v8 offset:8192
  buffer_load_dwordx4 v[180:183], v10, s[12:15], s35 offen
  v_mfma_f32_16x16x32_bf16 v[76:79], v[204:207], v[60:63], v[76:79]
  ds_read_b128 v[52:55], v8 offset:12288
  v_mfma_f32_16x16x32_bf16 v[92:95], v[208:211], v[60:63], v[92:95]
  buffer_load_dwordx4 v[184:187], v11, s[12:15], s35 offen
  v_mfma_f32_16x16x32_bf16 v[108:111], v[212:215], v[60:63], v[108:111]
  v_mfma_f32_16x16x32_bf16 v[80:83], v[204:207], v[64:67], v[80:83]
  buffer_load_dwordx4 v[188:191], v12, s[12:15], s35 offen
  v_mfma_f32_16x16x32_bf16 v[96:99], v[208:211], v[64:67], v[96:99]
  v_mfma_f32_16x16x32_bf16 v[112:115], v[212:215], v[64:67], v[112:115]
  s_add_u32 m0, s31, 34816
  s_nop 0
  buffer_load_dwordx4 v6, s[8:11], s26 offen lds
  v_mfma_f32_16x16x32_bf16 v[84:87], v[204:207], v[68:71], v[84:87]
  v_mfma_f32_16x16x32_bf16 v[100:103], v[208:211], v[68:71], v[100:103]
  s_add_u32 m0, s31, 35840
  s_nop 0
  buffer_load_dwordx4 v7, s[8:11], s26 offen lds
  v_mfma_f32_16x16x32_bf16 v[116:119], v[212:215], v[68:71], v[116:119]
  s_add_u32 s25, s25, 4
  s_cmp_lt_u32 s25, 16
  s_cbranch_scc1 K2_LOOP
  s_waitcnt vmcnt(0) lgkmcnt(0)
  s_barrier
  s_mul_i32 s28, s22, 6144
  v_lshlrev_b32 v14, 4, v1
  v_add_u32 v15, s28, v14
  s_xor_b32 s29, s22, 2
  s_mul_i32 s29, s29, 6144
  v_add_u32 v16, s29, v14
  s_cmp_eq_u32 s24, 0
  s_cbranch_scc0 K2_KH1
  ds_write_b128 v15, v[80:83] offset:0
  ds_write_b128 v15, v[84:87] offset:1024
  ds_write_b128 v15, v[96:99] offset:2048
  ds_write_b128 v15, v[100:103] offset:3072
  ds_write_b128 v15, v[112:115] offset:4096
  ds_write_b128 v15, v[116:119] offset:5120
  v_mov_b32 v120, v72
  v_mov_b32 v121, v73
  v_mov_b32 v122, v74
  v_mov_b32 v123, v75
  v_mov_b32 v124, v76
  v_mov_b32 v125, v77
  v_mov_b32 v126, v78
  v_mov_b32 v127, v79
  v_mov_b32 v128, v88
  v_mov_b32 v129, v89
  v_mov_b32 v130, v90
  v_mov_b32 v131, v91
  v_mov_b32 v132, v92
  v_mov_b32 v133, v93
  v_mov_b32 v134, v94
  v_mov_b32 v135, v95
  v_mov_b32 v136, v104
  v_mov_b32 v137, v105
  v_mov_b32 v138, v106
  v_mov_b32 v139, v107
  v_mov_b32 v140, v108
  v_mov_b32 v141, v109
  v_mov_b32 v142, v110
  v_mov_b32 v143, v111
  s_branch K2_KHD
K2_KH1:
  ds_write_b128 v15, v[72:75] offset:0
  ds_write_b128 v15, v[76:79] offset:1024
  ds_write_b128 v15, v[88:91] offset:2048
  ds_write_b128 v15, v[92:95] offset:3072
  ds_write_b128 v15, v[104:107] offset:4096
  ds_write_b128 v15, v[108:111] offset:5120
  v_mov_b32 v120, v80
  v_mov_b32 v121, v81
  v_mov_b32 v122, v82
  v_mov_b32 v123, v83
  v_mov_b32 v124, v84
  v_mov_b32 v125, v85
  v_mov_b32 v126, v86
  v_mov_b32 v127, v87
  v_mov_b32 v128, v96
  v_mov_b32 v129, v97
  v_mov_b32 v130, v98
  v_mov_b32 v131, v99
  v_mov_b32 v132, v100
  v_mov_b32 v133, v101
  v_mov_b32 v134, v102
  v_mov_b32 v135, v103
  v_mov_b32 v136, v112
  v_mov_b32 v137, v113
  v_mov_b32 v138, v114
  v_mov_b32 v139, v115
  v_mov_b32 v140, v116
  v_mov_b32 v141, v117
  v_mov_b32 v142, v118
  v_mov_b32 v143, v119
K2_KHD:
  s_waitcnt lgkmcnt(0)
  s_barrier
  ds_read_b128 v[40:43], v16 offset:0
  ds_read_b128 v[44:47], v16 offset:1024
  ds_read_b128 v[48:51], v16 offset:2048
  ds_read_b128 v[52:55], v16 offset:3072
  ds_read_b128 v[56:59], v16 offset:4096
  ds_read_b128 v[60:63], v16 offset:5120
  v_lshlrev_b32 v18, 16, v36
  v_lshlrev_b32 v20, 16, v37
  v_lshlrev_b32 v22, 4, v1
  s_waitcnt lgkmcnt(0)
  s_add_u32 s28, s33, 0
  s_lshr_b32 s29, s28, 1
  s_and_b32 s28, s28, 1
  s_lshl_b32 s28, s28, 3
  s_lshl_b32 s29, s29, 10
  s_add_u32 s28, s28, s29
  s_mul_i32 s29, s34, 24576
  s_add_u32 s28, s28, s29
  s_add_u32 s28, s28, 12582912
  s_add_u32 s29, s28, 24576
  v_add_f32 v120, v120, v40
  v_add_f32 v121, v121, v41
  v_add_f32 v120, v120, v18
  v_add_f32 v121, v121, v18
  v_lshlrev_b32 v40, 16, v24
  v_and_b32 v41, s32, v24
  v_mul_f32 v120, v120, v40
  v_mul_f32 v121, v121, v41
  v_cvt_pk_bf16_f32 v24, v120, v121
  v_add_f32 v122, v122, v42
  v_add_f32 v123, v123, v43
  v_add_f32 v122, v122, v18
  v_add_f32 v123, v123, v18
  v_lshlrev_b32 v42, 16, v25
  v_and_b32 v43, s32, v25
  v_mul_f32 v122, v122, v42
  v_mul_f32 v123, v123, v43
  v_cvt_pk_bf16_f32 v25, v122, v123
  buffer_store_dwordx2 v[24:25], v22, s[12:15], s28 offen
  v_add_f32 v124, v124, v44
  v_add_f32 v125, v125, v45
  v_add_f32 v124, v124, v20
  v_add_f32 v125, v125, v20
  v_lshlrev_b32 v44, 16, v30
  v_and_b32 v45, s32, v30
  v_mul_f32 v124, v124, v44
  v_mul_f32 v125, v125, v45
  v_cvt_pk_bf16_f32 v30, v124, v125
  v_add_f32 v126, v126, v46
  v_add_f32 v127, v127, v47
  v_add_f32 v126, v126, v20
  v_add_f32 v127, v127, v20
  v_lshlrev_b32 v46, 16, v31
  v_and_b32 v47, s32, v31
  v_mul_f32 v126, v126, v46
  v_mul_f32 v127, v127, v47
  v_cvt_pk_bf16_f32 v31, v126, v127
  buffer_store_dwordx2 v[30:31], v22, s[12:15], s29 offen
  s_add_u32 s28, s33, 1
  s_lshr_b32 s29, s28, 1
  s_and_b32 s28, s28, 1
  s_lshl_b32 s28, s28, 3
  s_lshl_b32 s29, s29, 10
  s_add_u32 s28, s28, s29
  s_mul_i32 s29, s34, 24576
  s_add_u32 s28, s28, s29
  s_add_u32 s28, s28, 12582912
  s_add_u32 s29, s28, 24576
  v_add_f32 v128, v128, v48
  v_add_f32 v129, v129, v49
  v_add_f32 v128, v128, v18
  v_add_f32 v129, v129, v18
  v_lshlrev_b32 v48, 16, v26
  v_and_b32 v49, s32, v26
  v_mul_f32 v128, v128, v48
  v_mul_f32 v129, v129, v49
  v_cvt_pk_bf16_f32 v26, v128, v129
  v_add_f32 v130, v130, v50
  v_add_f32 v131, v131, v51
  v_add_f32 v130, v130, v18
  v_add_f32 v131, v131, v18
  v_lshlrev_b32 v50, 16, v27
  v_and_b32 v51, s32, v27
  v_mul_f32 v130, v130, v50
  v_mul_f32 v131, v131, v51
  v_cvt_pk_bf16_f32 v27, v130, v131
  buffer_store_dwordx2 v[26:27], v22, s[12:15], s28 offen
  v_add_f32 v132, v132, v52
  v_add_f32 v133, v133, v53
  v_add_f32 v132, v132, v20
  v_add_f32 v133, v133, v20
  v_lshlrev_b32 v52, 16, v32
  v_and_b32 v53, s32, v32
  v_mul_f32 v132, v132, v52
  v_mul_f32 v133, v133, v53
  v_cvt_pk_bf16_f32 v32, v132, v133
  v_add_f32 v134, v134, v54
  v_add_f32 v135, v135, v55
  v_add_f32 v134, v134, v20
  v_add_f32 v135, v135, v20
  v_lshlrev_b32 v54, 16, v33
  v_and_b32 v55, s32, v33
  v_mul_f32 v134, v134, v54
  v_mul_f32 v135, v135, v55
  v_cvt_pk_bf16_f32 v33, v134, v135
  buffer_store_dwordx2 v[32:33], v22, s[12:15], s29 offen
  s_add_u32 s28, s33, 2
  s_lshr_b32 s29, s28, 1
  s_and_b32 s28, s28, 1
  s_lshl_b32 s28, s28, 3
  s_lshl_b32 s29, s29, 10
  s_add_u32 s28, s28, s29
  s_mul_i32 s29, s34, 24576
  s_add_u32 s28, s28, s29
  s_add_u32 s28, s28, 12582912
  s_add_u32 s29, s28, 24576
  v_add_f32 v136, v136, v56
  v_add_f32 v137, v137, v57
  v_add_f32 v136, v136, v18
  v_add_f32 v137, v137, v18
  v_lshlrev_b32 v56, 16, v28
  v_and_b32 v57, s32, v28
  v_mul_f32 v136, v136, v56
  v_mul_f32 v137, v137, v57
  v_cvt_pk_bf16_f32 v28, v136, v137
  v_add_f32 v138, v138, v58
  v_add_f32 v139, v139, v59
  v_add_f32 v138, v138, v18
  v_add_f32 v139, v139, v18
  v_lshlrev_b32 v58, 16, v29
  v_and_b32 v59, s32, v29
  v_mul_f32 v138, v138, v58
  v_mul_f32 v139, v139, v59
  v_cvt_pk_bf16_f32 v29, v138, v139
  buffer_store_dwordx2 v[28:29], v22, s[12:15], s28 offen
  v_add_f32 v140, v140, v60
  v_add_f32 v141, v141, v61
  v_add_f32 v140, v140, v20
  v_add_f32 v141, v141, v20
  v_lshlrev_b32 v60, 16, v34
  v_and_b32 v61, s32, v34
  v_mul_f32 v140, v140, v60
  v_mul_f32 v141, v141, v61
  v_cvt_pk_bf16_f32 v34, v140, v141
  v_add_f32 v142, v142, v62
  v_add_f32 v143, v143, v63
  v_add_f32 v142, v142, v20
  v_add_f32 v143, v143, v20
  v_lshlrev_b32 v62, 16, v35
  v_and_b32 v63, s32, v35
  v_mul_f32 v142, v142, v62
  v_mul_f32 v143, v143, v63
  v_cvt_pk_bf16_f32 v35, v142, v143
  buffer_store_dwordx2 v[34:35], v22, s[12:15], s29 offen
  s_endpgm
K2_CONV:
  v_lshrrev_b32 v6, 6, v0
  v_and_b32 v1, 63, v0
  v_readfirstlane_b32 s20, v6
  s_sub_u32 s23, s2, 256
  s_mul_i32 s21, s23, 3
  s_add_u32 s21, s21, s20
  s_cmp_ge_u32 s20, 3
  s_cbranch_scc1 K2_END
  s_cmp_ge_u32 s21, 640
  s_cbranch_scc1 K2_END
  s_load_dwordx4 s[36:39], s[0:1], 32
  s_load_dwordx2 s[40:41], s[0:1], 104
  v_lshrrev_b32 v2, 4, v1
  v_and_b32 v3, 15, v1
  s_mul_i32 s22, s20, 21248
  s_mov_b32 s26, 0xffff0000
  s_mov_b64 s[28:29], exec
  s_waitcnt lgkmcnt(0)
  s_lshl_b32 s23, s21, 12
  s_add_u32 s8, s36, s23
  s_addc_u32 s9, s37, 0
  s_and_b32 s9, s9, 0xffff
  s_mov_b32 s10, 4096
  s_mov_b32 s11, 0x20000
  s_mov_b32 s12, s40
  s_and_b32 s13, s41, 0xffff
  s_mov_b32 s14, 18874368
  s_mov_b32 s15, 0x20000
  s_mov_b32 s16, s38
  s_and_b32 s17, s39, 0xffff
  s_mov_b32 s18, 1280
  s_mov_b32 s19, 0x20000
  v_lshlrev_b32 v6, 4, v1
  s_lshl_b32 s23, s21, 12
  s_add_u32 s23, s23, 6291456
  s_add_u32 m0, s22, 17152
  s_add_u32 s24, s23, 0
  buffer_load_dwordx4 v6, s[12:15], s24 offen lds
  s_add_u32 m0, s22, 18176
  s_add_u32 s24, s23, 1024
  buffer_load_dwordx4 v6, s[12:15], s24 offen lds
  s_add_u32 m0, s22, 19200
  s_add_u32 s24, s23, 2048
  buffer_load_dwordx4 v6, s[12:15], s24 offen lds
  s_add_u32 m0, s22, 20224
  s_add_u32 s24, s23, 3072
  buffer_load_dwordx4 v6, s[12:15], s24 offen lds
  buffer_load_dwordx4 v[16:19], v6, s[8:11], 0 offen offset:0
  buffer_load_dwordx2 v[20:21], v6, s[8:11], 0 offen offset:16
  buffer_load_dwordx4 v[22:25], v6, s[8:11], 0 offen offset:1024
  buffer_load_dwordx2 v[26:27], v6, s[8:11], 0 offen offset:1040
  buffer_load_dwordx4 v[28:31], v6, s[8:11], 0 offen offset:2048
  buffer_load_dwordx2 v[32:33], v6, s[8:11], 0 offen offset:2064
  buffer_load_dwordx4 v[34:37], v6, s[8:11], 0 offen offset:3072
  buffer_load_dwordx2 v[38:39], v6, s[8:11], 0 offen offset:3088
  v_mov_b32 v7, 0
  buffer_load_dwordx2 v[44:45], v7, s[8:11], 0 offen
  s_lshl_b32 s23, s21, 1
  buffer_load_ushort v46, v7, s[16:19], s23 offen
  v_mov_b32 v8, 0
  v_mov_b32 v9, 0
  v_lshlrev_b32 v10, 3, v1
  v_add_u32 v10, s22, v10
  ds_write_b64 v10, v[8:9] offset:16640
  v_add_u32 v10, 1, v3
  v_and_b32 v10, 3, v10
  v_lshrrev_b32 v11, 1, v2
  v_and_b32 v12, 1, v2
  v_lshlrev_b32 v13, 4, v11
  v_add_u32 v13, v13, v3
  v_lshlrev_b32 v14, 3, v12
  v_sub_u32 v13, v13, v14
  v_add_u32 v13, 9, v13
  v_sub_u32 v13, v13, v10
  v_lshlrev_b32 v13, 1, v13
  v_mul_u32_u24 v10, 4160, v10
  v_add_u32 v13, v13, v10
  v_add_u32 v4, s22, v13
  v_sub_u32 v13, v3, v11
  v_lshlrev_b32 v13, 1, v13
  v_add_u32 v13, v13, v12
  v_lshlrev_b32 v13, 4, v13
  s_add_u32 s23, s22, 17152
  v_add_u32 v5, s23, v13
  v_lshlrev_b32 v10, 4, v1
  v_add_u32 v10, s22, v10
  s_waitcnt vmcnt(0)
  v_alignbit_b32 v80, v17, v16, 16
  v_alignbit_b32 v81, v18, v17, 16
  v_alignbit_b32 v82, v19, v18, 16
  v_alignbit_b32 v83, v20, v19, 16
  v_mov_b32 v84, v17
  v_mov_b32 v85, v18
  v_mov_b32 v86, v19
  v_mov_b32 v87, v20
  v_mov_b32 v88, v81
  v_mov_b32 v89, v82
  v_mov_b32 v90, v83
  v_alignbit_b32 v91, v21, v20, 16
  ds_write_b128 v10, v[16:19] offset:32
  ds_write_b128 v10, v[80:83] offset:4192
  ds_write_b128 v10, v[84:87] offset:8352
  ds_write_b128 v10, v[88:91] offset:12512
  s_waitcnt lgkmcnt(4)
  v_alignbit_b32 v92, v23, v22, 16
  v_alignbit_b32 v93, v24, v23, 16
  v_alignbit_b32 v94, v25, v24, 16
  v_alignbit_b32 v95, v26, v25, 16
  v_mov_b32 v96, v23
  v_mov_b32 v97, v24
  v_mov_b32 v98, v25
  v_mov_b32 v99, v26
  v_mov_b32 v100, v93
  v_mov_b32 v101, v94
  v_mov_b32 v102, v95
  v_alignbit_b32 v103, v27, v26, 16
  ds_write_b128 v10, v[22:25] offset:1056
  ds_write_b128 v10, v[92:95] offset:5216
  ds_write_b128 v10, v[96:99] offset:9376
  ds_write_b128 v10, v[100:103] offset:13536
  s_waitcnt lgkmcnt(4)
  v_alignbit_b32 v104, v29, v28, 16
  v_alignbit_b32 v105, v30, v29, 16
  v_alignbit_b32 v106, v31, v30, 16
  v_alignbit_b32 v107, v32, v31, 16
  v_mov_b32 v108, v29
  v_mov_b32 v109, v30
  v_mov_b32 v110, v31
  v_mov_b32 v111, v32
  v_mov_b32 v112, v105
  v_mov_b32 v113, v106
  v_mov_b32 v114, v107
  v_alignbit_b32 v115, v33, v32, 16
  ds_write_b128 v10, v[28:31] offset:2080
  ds_write_b128 v10, v[104:107] offset:6240
  ds_write_b128 v10, v[108:111] offset:10400
  ds_write_b128 v10, v[112:115] offset:14560
  s_waitcnt lgkmcnt(4)
  v_alignbit_b32 v116, v35, v34, 16
  v_alignbit_b32 v117, v36, v35, 16
  v_alignbit_b32 v118, v37, v36, 16
  v_alignbit_b32 v119, v38, v37, 16
  v_mov_b32 v120, v35
  v_mov_b32 v121, v36
  v_mov_b32 v122, v37
  v_mov_b32 v123, v38
  v_mov_b32 v124, v117
  v_mov_b32 v125, v118
  v_mov_b32 v126, v119
  v_alignbit_b32 v127, v39, v38, 16
  ds_write_b128 v10, v[34:37] offset:3104
  ds_write_b128 v10, v[116:119] offset:7264
  ds_write_b128 v10, v[120:123] offset:11424
  ds_write_b128 v10, v[124:127] offset:15584
  s_waitcnt lgkmcnt(4)
  v_mov_b32 v40, 0
  v_mov_b32 v41, 0
  v_mov_b32 v42, 0
  v_mov_b32 v43, 0
  v_cmp_eq_u32 vcc, 1, v1
  s_nop 1
  v_cndmask_b32 v44, 0, v44, vcc
  v_cndmask_b32 v45, 0, v45, vcc
  s_mov_b32 exec_lo, 0x3
  s_mov_b32 exec_hi, 0x0
  v_alignbit_b32 v128, v41, v40, 16
  v_alignbit_b32 v129, v42, v41, 16
  v_alignbit_b32 v130, v43, v42, 16
  v_alignbit_b32 v131, v44, v43, 16
  v_mov_b32 v132, v41
  v_mov_b32 v133, v42
  v_mov_b32 v134, v43
  v_mov_b32 v135, v44
  v_mov_b32 v136, v129
  v_mov_b32 v137, v130
  v_mov_b32 v138, v131
  v_alignbit_b32 v139, v45, v44, 16
  ds_write_b128 v10, v[40:43] offset:0
  ds_write_b128 v10, v[128:131] offset:4160
  ds_write_b128 v10, v[132:135] offset:8320
  ds_write_b128 v10, v[136:139] offset:12480
  s_mov_b64 exec, s[28:29]
  v_lshlrev_b32 v46, 16, v46
  v_mov_b32 v48, 0
  v_mov_b32 v49, 0
  v_mov_b32 v50, 0
  v_mov_b32 v51, 0
  v_mov_b32 v52, 0
  v_mov_b32 v53, 0
  v_mov_b32 v54, 0
  v_mov_b32 v55, 0
  v_mov_b32 v56, 0
  v_mov_b32 v57, 0
  v_mov_b32 v58, 0
  v_mov_b32 v59, 0
  v_mov_b32 v60, 0
  v_mov_b32 v61, 0
  v_mov_b32 v62, 0
  v_mov_b32 v63, 0
  v_mov_b32 v64, 0
  v_mov_b32 v65, 0
  v_mov_b32 v66, 0
  v_mov_b32 v67, 0
  v_mov_b32 v68, 0
  v_mov_b32 v69, 0
  v_mov_b32 v70, 0
  v_mov_b32 v71, 0
  v_mov_b32 v72, 0
  v_mov_b32 v73, 0
  v_mov_b32 v74, 0
  v_mov_b32 v75, 0
  v_mov_b32 v76, 0
  v_mov_b32 v77, 0
  v_mov_b32 v78, 0
  v_mov_b32 v79, 0
  s_waitcnt lgkmcnt(0)
  ds_read_b64 v[80:81], v4 offset:0
  ds_read_b64 v[82:83], v4 offset:8
  ds_read_b128 v[144:147], v5 offset:0
  ds_read_b64 v[84:85], v4 offset:512
  ds_read_b64 v[86:87], v4 offset:520
  ds_read_b128 v[148:151], v5 offset:512
  ds_read_b64 v[88:89], v4 offset:1024
  ds_read_b64 v[90:91], v4 offset:1032
  s_waitcnt lgkmcnt(7)
  ds_read_b128 v[152:155], v5 offset:1024
  ds_read_b64 v[92:93], v4 offset:1536
  ds_read_b64 v[94:95], v4 offset:1544
  ds_read_b128 v[156:159], v5 offset:1536
  ds_read_b64 v[96:97], v4 offset:2048
  ds_read_b64 v[98:99], v4 offset:2056
  ds_read_b128 v[160:163], v5 offset:2048
  ds_read_b64 v[100:101], v4 offset:2560
  s_waitcnt lgkmcnt(7)
  ds_read_b64 v[102:103], v4 offset:2568
  ds_read_b128 v[164:167], v5 offset:2560
  ds_read_b64 v[104:105], v4 offset:3072
  ds_read_b64 v[106:107], v4 offset:3080
  ds_read_b128 v[168:171], v5 offset:3072
  ds_read_b64 v[108:109], v4 offset:3584
  ds_read_b64 v[110:111], v4 offset:3592
  ds_read_b128 v[172:175], v5 offset:3584
  s_waitcnt lgkmcnt(7)
  s_mov_b32 s25, 0
K2_CLOOP:
  v_add_u32 v4, 64, v4
  v_subrev_u32 v5, 64, v5
  s_waitcnt lgkmcnt(0)
  v_mfma_f32_16x16x32_bf16 v[48:51], v[80:83], v[144:147], v[48:51]
  ds_read_b64 v[112:113], v4 offset:0
  v_mfma_f32_16x16x32_bf16 v[52:55], v[80:83], v[148:151], v[52:55]
  ds_read_b64 v[114:115], v4 offset:8
  v_mfma_f32_16x16x32_bf16 v[56:59], v[80:83], v[152:155], v[56:59]
  ds_read_b128 v[176:179], v5 offset:0
  v_mfma_f32_16x16x32_bf16 v[60:63], v[80:83], v[156:159], v[60:63]
  ds_read_b64 v[116:117], v4 offset:512
  v_mfma_f32_16x16x32_bf16 v[64:67], v[80:83], v[160:163], v[64:67]
  ds_read_b64 v[118:119], v4 offset:520
  v_mfma_f32_16x16x32_bf16 v[68:71], v[80:83], v[164:167], v[68:71]
  ds_read_b128 v[180:183], v5 offset:512
  s_waitcnt lgkmcnt(9)
  v_mfma_f32_16x16x32_bf16 v[72:75], v[80:83], v[168:171], v[72:75]
  ds_read_b64 v[120:121], v4 offset:1024
  v_mfma_f32_16x16x32_bf16 v[76:79], v[80:83], v[172:175], v[76:79]
  ds_read_b64 v[122:123], v4 offset:1032
  v_mfma_f32_16x16x32_bf16 v[52:55], v[84:87], v[144:147], v[52:55]
  ds_read_b128 v[184:187], v5 offset:1024
  v_mfma_f32_16x16x32_bf16 v[56:59], v[84:87], v[148:151], v[56:59]
  ds_read_b64 v[124:125], v4 offset:1536
  v_mfma_f32_16x16x32_bf16 v[60:63], v[84:87], v[152:155], v[60:63]
  ds_read_b64 v[126:127], v4 offset:1544
  v_mfma_f32_16x16x32_bf16 v[64:67], v[84:87], v[156:159], v[64:67]
  ds_read_b128 v[188:191], v5 offset:1536
  s_waitcnt lgkmcnt(9)
  v_mfma_f32_16x16x32_bf16 v[68:71], v[84:87], v[160:163], v[68:71]
  ds_read_b64 v[128:129], v4 offset:2048
  v_mfma_f32_16x16x32_bf16 v[72:75], v[84:87], v[164:167], v[72:75]
  ds_read_b64 v[130:131], v4 offset:2056
  v_mfma_f32_16x16x32_bf16 v[76:79], v[84:87], v[168:171], v[76:79]
  ds_read_b128 v[192:195], v5 offset:2048
  v_mfma_f32_16x16x32_bf16 v[56:59], v[88:91], v[144:147], v[56:59]
  ds_read_b64 v[132:133], v4 offset:2560
  v_mfma_f32_16x16x32_bf16 v[60:63], v[88:91], v[148:151], v[60:63]
  ds_read_b64 v[134:135], v4 offset:2568
  v_mfma_f32_16x16x32_bf16 v[64:67], v[88:91], v[152:155], v[64:67]
  ds_read_b128 v[196:199], v5 offset:2560
  s_waitcnt lgkmcnt(9)
  v_mfma_f32_16x16x32_bf16 v[68:71], v[88:91], v[156:159], v[68:71]
  ds_read_b64 v[136:137], v4 offset:3072
  v_mfma_f32_16x16x32_bf16 v[72:75], v[88:91], v[160:163], v[72:75]
  ds_read_b64 v[138:139], v4 offset:3080
  v_mfma_f32_16x16x32_bf16 v[76:79], v[88:91], v[164:167], v[76:79]
  ds_read_b128 v[200:203], v5 offset:3072
  v_mfma_f32_16x16x32_bf16 v[60:63], v[92:95], v[144:147], v[60:63]
  ds_read_b64 v[140:141], v4 offset:3584
  v_mfma_f32_16x16x32_bf16 v[64:67], v[92:95], v[148:151], v[64:67]
  ds_read_b64 v[142:143], v4 offset:3592
  v_mfma_f32_16x16x32_bf16 v[68:71], v[92:95], v[152:155], v[68:71]
  ds_read_b128 v[204:207], v5 offset:3584
  s_waitcnt lgkmcnt(9)
  v_mfma_f32_16x16x32_bf16 v[72:75], v[92:95], v[156:159], v[72:75]
  v_mfma_f32_16x16x32_bf16 v[76:79], v[92:95], v[160:163], v[76:79]
  v_mfma_f32_16x16x32_bf16 v[64:67], v[96:99], v[144:147], v[64:67]
  v_mfma_f32_16x16x32_bf16 v[68:71], v[96:99], v[148:151], v[68:71]
  v_mfma_f32_16x16x32_bf16 v[72:75], v[96:99], v[152:155], v[72:75]
  v_mfma_f32_16x16x32_bf16 v[76:79], v[96:99], v[156:159], v[76:79]
  v_mfma_f32_16x16x32_bf16 v[68:71], v[100:103], v[144:147], v[68:71]
  v_mfma_f32_16x16x32_bf16 v[72:75], v[100:103], v[148:151], v[72:75]
  v_mfma_f32_16x16x32_bf16 v[76:79], v[100:103], v[152:155], v[76:79]
  v_mfma_f32_16x16x32_bf16 v[72:75], v[104:107], v[144:147], v[72:75]
  v_mfma_f32_16x16x32_bf16 v[76:79], v[104:107], v[148:151], v[76:79]
  v_mfma_f32_16x16x32_bf16 v[76:79], v[108:111], v[144:147], v[76:79]
  v_add_u32 v4, 64, v4
  v_subrev_u32 v5, 64, v5
  s_waitcnt lgkmcnt(0)
  v_mfma_f32_16x16x32_bf16 v[48:51], v[112:115], v[176:179], v[48:51]
  ds_read_b64 v[80:81], v4 offset:0
  v_mfma_f32_16x16x32_bf16 v[52:55], v[112:115], v[180:183], v[52:55]
  ds_read_b64 v[82:83], v4 offset:8
  v_mfma_f32_16x16x32_bf16 v[56:59], v[112:115], v[184:187], v[56:59]
  ds_read_b128 v[144:147], v5 offset:0
  v_mfma_f32_16x16x32_bf16 v[60:63], v[112:115], v[188:191], v[60:63]
  ds_read_b64 v[84:85], v4 offset:512
  v_mfma_f32_16x16x32_bf16 v[64:67], v[112:115], v[192:195], v[64:67]
  ds_read_b64 v[86:87], v4 offset:520
  v_mfma_f32_16x16x32_bf16 v[68:71], v[112:115], v[196:199], v[68:71]
  ds_read_b128 v[148:151], v5 offset:512
  s_waitcnt lgkmcnt(9)
  v_mfma_f32_16x16x32_bf16 v[72:75], v[112:115], v[200:203], v[72:75]
  ds_read_b64 v[88:89], v4 offset:1024
  v_mfma_f32_16x16x32_bf16 v[76:79], v[112:115], v[204:207], v[76:79]
  ds_read_b64 v[90:91], v4 offset:1032
  v_mfma_f32_16x16x32_bf16 v[52:55], v[116:119], v[176:179], v[52:55]
  ds_read_b128 v[152:155], v5 offset:1024
  v_mfma_f32_16x16x32_bf16 v[56:59], v[116:119], v[180:183], v[56:59]
  ds_read_b64 v[92:93], v4 offset:1536
  v_mfma_f32_16x16x32_bf16 v[60:63], v[116:119], v[184:187], v[60:63]
  ds_read_b64 v[94:95], v4 offset:1544
  v_mfma_f32_16x16x32_bf16 v[64:67], v[116:119], v[188:191], v[64:67]
  ds_read_b128 v[156:159], v5 offset:1536
  s_waitcnt lgkmcnt(9)
  v_mfma_f32_16x16x32_bf16 v[68:71], v[116:119], v[192:195], v[68:71]
  ds_read_b64 v[96:97], v4 offset:2048
  v_mfma_f32_16x16x32_bf16 v[72:75], v[116:119], v[196:199], v[72:75]
  ds_read_b64 v[98:99], v4 offset:2056
  v_mfma_f32_16x16x32_bf16 v[76:79], v[116:119], v[200:203], v[76:79]
  ds_read_b128 v[160:163], v5 offset:2048
  v_mfma_f32_16x16x32_bf16 v[56:59], v[120:123], v[176:179], v[56:59]
  ds_read_b64 v[100:101], v4 offset:2560
  v_mfma_f32_16x16x32_bf16 v[60:63], v[120:123], v[180:183], v[60:63]
  ds_read_b64 v[102:103], v4 offset:2568
  v_mfma_f32_16x16x32_bf16 v[64:67], v[120:123], v[184:187], v[64:67]
  ds_read_b128 v[164:167], v5 offset:2560
  s_waitcnt lgkmcnt(9)
  v_mfma_f32_16x16x32_bf16 v[68:71], v[120:123], v[188:191], v[68:71]
  ds_read_b64 v[104:105], v4 offset:3072
  v_mfma_f32_16x16x32_bf16 v[72:75], v[120:123], v[192:195], v[72:75]
  ds_read_b64 v[106:107], v4 offset:3080
  v_mfma_f32_16x16x32_bf16 v[76:79], v[120:123], v[196:199], v[76:79]
  ds_read_b128 v[168:171], v5 offset:3072
  v_mfma_f32_16x16x32_bf16 v[60:63], v[124:127], v[176:179], v[60:63]
  ds_read_b64 v[108:109], v4 offset:3584
  v_mfma_f32_16x16x32_bf16 v[64:67], v[124:127], v[180:183], v[64:67]
  ds_read_b64 v[110:111], v4 offset:3592
  v_mfma_f32_16x16x32_bf16 v[68:71], v[124:127], v[184:187], v[68:71]
  ds_read_b128 v[172:175], v5 offset:3584
  s_waitcnt lgkmcnt(9)
  v_mfma_f32_16x16x32_bf16 v[72:75], v[124:127], v[188:191], v[72:75]
  v_mfma_f32_16x16x32_bf16 v[76:79], v[124:127], v[192:195], v[76:79]
  v_mfma_f32_16x16x32_bf16 v[64:67], v[128:131], v[176:179], v[64:67]
  v_mfma_f32_16x16x32_bf16 v[68:71], v[128:131], v[180:183], v[68:71]
  v_mfma_f32_16x16x32_bf16 v[72:75], v[128:131], v[184:187], v[72:75]
  v_mfma_f32_16x16x32_bf16 v[76:79], v[128:131], v[188:191], v[76:79]
  v_mfma_f32_16x16x32_bf16 v[68:71], v[132:135], v[176:179], v[68:71]
  v_mfma_f32_16x16x32_bf16 v[72:75], v[132:135], v[180:183], v[72:75]
  v_mfma_f32_16x16x32_bf16 v[76:79], v[132:135], v[184:187], v[76:79]
  v_mfma_f32_16x16x32_bf16 v[72:75], v[136:139], v[176:179], v[72:75]
  v_mfma_f32_16x16x32_bf16 v[76:79], v[136:139], v[180:183], v[76:79]
  v_mfma_f32_16x16x32_bf16 v[76:79], v[140:143], v[176:179], v[76:79]
  s_add_u32 s25, s25, 2
  s_cmp_lt_u32 s25, 8
  s_cbranch_scc1 K2_CLOOP
  s_waitcnt lgkmcnt(0)
  v_lshlrev_b32 v6, 5, v3
  v_lshrrev_b32 v7, 1, v2
  v_lshlrev_b32 v7, 4, v7
  v_add_u32 v6, v6, v7
  v_and_b32 v7, 1, v2
  v_xor_b32 v7, 1, v7
  v_lshlrev_b32 v7, 3, v7
  v_add_u32 v6, v6, v7
  s_add_u32 s23, s22, 17152
  v_add_u32 v6, s23, v6
  ds_read_b64 v[80:81], v6 offset:0
  ds_read_b64 v[82:83], v6 offset:512
  ds_read_b64 v[84:85], v6 offset:1024
  ds_read_b64 v[86:87], v6 offset:1536
  ds_read_b64 v[88:89], v6 offset:2048
  ds_read_b64 v[90:91], v6 offset:2560
  ds_read_b64 v[92:93], v6 offset:3072
  ds_read_b64 v[94:95], v6 offset:3584
  v_lshlrev_b32 v8, 5, v3
  v_lshlrev_b32 v9, 3, v2
  v_add_u32 v8, v8, v9
  s_lshl_b32 s23, s21, 12
  s_add_u32 s23, s23, 9437184
  s_waitcnt lgkmcnt(0)
  v_and_b32 v144, s26, v81
  v_lshlrev_b32 v145, 16, v81
  v_and_b32 v146, s26, v80
  v_lshlrev_b32 v147, 16, v80
  v_fmac_f32 v48, v144, v46
  v_fmac_f32 v49, v145, v46
  v_fmac_f32 v50, v146, v46
  v_fmac_f32 v51, v147, v46
  v_cvt_pk_bf16_f32 v148, v48, v49
  v_cvt_pk_bf16_f32 v149, v50, v51
  buffer_store_dwordx2 v[148:149], v8, s[12:15], s23 offen offset:0
  v_and_b32 v152, s26, v83
  v_lshlrev_b32 v153, 16, v83
  v_and_b32 v154, s26, v82
  v_lshlrev_b32 v155, 16, v82
  v_fmac_f32 v52, v152, v46
  v_fmac_f32 v53, v153, v46
  v_fmac_f32 v54, v154, v46
  v_fmac_f32 v55, v155, v46
  v_cvt_pk_bf16_f32 v156, v52, v53
  v_cvt_pk_bf16_f32 v157, v54, v55
  buffer_store_dwordx2 v[156:157], v8, s[12:15], s23 offen offset:512
  v_and_b32 v160, s26, v85
  v_lshlrev_b32 v161, 16, v85
  v_and_b32 v162, s26, v84
  v_lshlrev_b32 v163, 16, v84
  v_fmac_f32 v56, v160, v46
  v_fmac_f32 v57, v161, v46
  v_fmac_f32 v58, v162, v46
  v_fmac_f32 v59, v163, v46
  v_cvt_pk_bf16_f32 v164, v56, v57
  v_cvt_pk_bf16_f32 v165, v58, v59
  buffer_store_dwordx2 v[164:165], v8, s[12:15], s23 offen offset:1024
  v_and_b32 v168, s26, v87
  v_lshlrev_b32 v169, 16, v87
  v_and_b32 v170, s26, v86
  v_lshlrev_b32 v171, 16, v86
  v_fmac_f32 v60, v168, v46
  v_fmac_f32 v61, v169, v46
  v_fmac_f32 v62, v170, v46
  v_fmac_f32 v63, v171, v46
  v_cvt_pk_bf16_f32 v172, v60, v61
  v_cvt_pk_bf16_f32 v173, v62, v63
  buffer_store_dwordx2 v[172:173], v8, s[12:15], s23 offen offset:1536
  v_and_b32 v176, s26, v89
  v_lshlrev_b32 v177, 16, v89
  v_and_b32 v178, s26, v88
  v_lshlrev_b32 v179, 16, v88
  v_fmac_f32 v64, v176, v46
  v_fmac_f32 v65, v177, v46
  v_fmac_f32 v66, v178, v46
  v_fmac_f32 v67, v179, v46
  v_cvt_pk_bf16_f32 v180, v64, v65
  v_cvt_pk_bf16_f32 v181, v66, v67
  buffer_store_dwordx2 v[180:181], v8, s[12:15], s23 offen offset:2048
  v_and_b32 v184, s26, v91
  v_lshlrev_b32 v185, 16, v91
  v_and_b32 v186, s26, v90
  v_lshlrev_b32 v187, 16, v90
  v_fmac_f32 v68, v184, v46
  v_fmac_f32 v69, v185, v46
  v_fmac_f32 v70, v186, v46
  v_fmac_f32 v71, v187, v46
  v_cvt_pk_bf16_f32 v188, v68, v69
  v_cvt_pk_bf16_f32 v189, v70, v71
  buffer_store_dwordx2 v[188:189], v8, s[12:15], s23 offen offset:2560
  v_and_b32 v192, s26, v93
  v_lshlrev_b32 v193, 16, v93
  v_and_b32 v194, s26, v92
  v_lshlrev_b32 v195, 16, v92
  v_fmac_f32 v72, v192, v46
  v_fmac_f32 v73, v193, v46
  v_fmac_f32 v74, v194, v46
  v_fmac_f32 v75, v195, v46
  v_cvt_pk_bf16_f32 v196, v72, v73
  v_cvt_pk_bf16_f32 v197, v74, v75
  buffer_store_dwordx2 v[196:197], v8, s[12:15], s23 offen offset:3072
  v_and_b32 v200, s26, v95
  v_lshlrev_b32 v201, 16, v95
  v_and_b32 v202, s26, v94
  v_lshlrev_b32 v203, 16, v94
  v_fmac_f32 v76, v200, v46
  v_fmac_f32 v77, v201, v46
  v_fmac_f32 v78, v202, v46
  v_fmac_f32 v79, v203, v46
  v_cvt_pk_bf16_f32 v204, v76, v77
  v_cvt_pk_bf16_f32 v205, v78, v79
  buffer_store_dwordx2 v[204:205], v8, s[12:15], s23 offen offset:3584
K2_END:
  s_endpgm

.section .rodata,"a"
.p2align 6
.amdhsa_kernel k2_kernel
  .amdhsa_next_free_vgpr 256
  .amdhsa_next_free_sgpr 96
  .amdhsa_accum_offset 256
  .amdhsa_group_segment_fixed_size 0
  .amdhsa_kernarg_size 112
  .amdhsa_user_sgpr_count 2
  .amdhsa_user_sgpr_kernarg_segment_ptr 1
  .amdhsa_system_sgpr_workgroup_id_x 1
  .amdhsa_float_denorm_mode_32 3
.end_amdhsa_kernel
.text
.globl k3_kernel
.p2align 8
.type k3_kernel,@function
k3_kernel:
  s_cmp_ge_u32 s2, 256
  s_cbranch_scc1 K3_END
  s_load_dwordx2 s[36:37], s[0:1], 0
  s_load_dwordx2 s[38:39], s[0:1], 88
  s_load_dwordx2 s[40:41], s[0:1], 104
  v_and_b32 v1, 63, v0
  v_lshrrev_b32 v12, 6, v0
  v_lshrrev_b32 v2, 4, v1
  v_readfirstlane_b32 s22, v12
  v_and_b32 v3, 15, v1
  v_lshlrev_b32 v4, 4, v1
  s_and_b32 s23, s2, 7
  s_lshr_b32 s24, s2, 3
  s_lshr_b32 s20, s23, 1
  s_lshl_b32 s20, s20, 3
  s_lshr_b32 s25, s24, 2
  s_add_u32 s20, s20, s25
  s_and_b32 s21, s23, 1
  s_lshl_b32 s21, s21, 2
  s_and_b32 s25, s24, 3
  s_add_u32 s21, s21, s25
  s_mov_b32 s26, 0xffff0000
  s_mov_b64 s[28:29], exec
  s_waitcnt lgkmcnt(0)
  s_mov_b32 s8, s36
  s_and_b32 s9, s37, 0xffff
  s_mov_b32 s10, 2621440
  s_mov_b32 s11, 0x20000
  s_mov_b32 s16, s38
  s_and_b32 s17, s39, 0xffff
  s_mov_b32 s18, 2621440
  s_mov_b32 s19, 0x20000
  s_mov_b32 s12, s40
  s_and_b32 s13, s41, 0xffff
  s_mov_b32 s14, 18874368
  s_mov_b32 s15, 0x20000
  s_lshl_b32 s34, s20, 2
  s_add_u32 s34, s34, s22
  s_mul_i32 s35, s34, 24576
  s_add_u32 s35, s35, 12582912
  s_mul_i32 s33, s21, 122880
  s_lshl_b32 s23, s22, 10
  s_add_u32 s33, s33, s23
  s_add_u32 s33, s33, 15728640
  s_mul_i32 s37, s22, 5120
  s_add_u32 m0, s37, 0
  s_add_u32 s23, s33, 0
  buffer_load_dwordx4 v4, s[12:15], s23 offen lds
  s_add_u32 m0, s37, 1024
  s_add_u32 s23, s33, 24576
  buffer_load_dwordx4 v4, s[12:15], s23 offen lds
  s_add_u32 m0, s37, 2048
  s_add_u32 s23, s33, 49152
  buffer_load_dwordx4 v4, s[12:15], s23 offen lds
  s_add_u32 m0, s37, 3072
  s_add_u32 s23, s33, 73728
  buffer_load_dwordx4 v4, s[12:15], s23 offen lds
  s_add_u32 m0, s37, 4096
  s_add_u32 s23, s33, 98304
  buffer_load_dwordx4 v4, s[12:15], s23 offen lds
  s_add_u32 s23, s35, 0
  buffer_load_dwordx4 v[88:91], v4, s[12:15], s23 offen offset:0
  s_add_u32 s23, s35, 0
  buffer_load_dwordx4 v[92:95], v4, s[12:15], s23 offen offset:1024
  s_add_u32 s23, s35, 0
  buffer_load_dwordx4 v[96:99], v4, s[12:15], s23 offen offset:2048
  s_add_u32 s23, s35, 0
  buffer_load_dwordx4 v[100:103], v4, s[12:15], s23 offen offset:3072
  s_add_u32 m0, s37, 20480
  s_add_u32 s23, s33, 4096
  buffer_load_dwordx4 v4, s[12:15], s23 offen lds
  s_add_u32 m0, s37, 21504
  s_add_u32 s23, s33, 28672
  buffer_load_dwordx4 v4, s[12:15], s23 offen lds
  s_add_u32 m0, s37, 22528
  s_add_u32 s23, s33, 53248
  buffer_load_dwordx4 v4, s[12:15], s23 offen lds
  s_add_u32 m0, s37, 23552
  s_add_u32 s23, s33, 77824
  buffer_load_dwordx4 v4, s[12:15], s23 offen lds
  s_add_u32 m0, s37, 24576
  s_add_u32 s23, s33, 102400
  buffer_load_dwordx4 v4, s[12:15], s23 offen lds
  s_add_u32 s23, s35, 4096
  buffer_load_dwordx4 v[104:107], v4, s[12:15], s23 offen offset:0
  s_add_u32 s23, s35, 4096
  buffer_load_dwordx4 v[108:111], v4, s[12:15], s23 offen offset:1024
  s_add_u32 s23, s35, 4096
  buffer_load_dwordx4 v[112:115], v4, s[12:15], s23 offen offset:2048
  s_add_u32 s23, s35, 4096
  buffer_load_dwordx4 v[116:119], v4, s[12:15], s23 offen offset:3072
  s_lshl_b32 s23, s34, 4
  s_mul_i32 s23, s23, 1280
  s_mul_i32 s24, s21, 160
  s_add_u32 s23, s23, s24
  v_add_u32 v12, 0, v1
  v_mul_u32_u24 v13, 6554, v12
  v_lshrrev_b32 v13, 16, v13
  v_mul_u32_u24 v14, 10, v13
  v_sub_u32 v14, v12, v14
  v_lshlrev_b32 v14, 4, v14
  v_mul_u32_u24 v13, 1280, v13
  v_add_u32 v13, v13, v14
  v_add_u32 v5, s23, v13
  v_lshrrev_b32 v13, 1, v12
  v_lshlrev_b32 v13, 12, v13
  v_and_b32 v14, 1, v12
  v_lshlrev_b32 v14, 4, v14
  v_add_u32 v8, v13, v14
  v_add_u32 v12, 64, v1
  v_mul_u32_u24 v13, 6554, v12
  v_lshrrev_b32 v13, 16, v13
  v_mul_u32_u24 v14, 10, v13
  v_sub_u32 v14, v12, v14
  v_lshlrev_b32 v14, 4, v14
  v_mul_u32_u24 v13, 1280, v13
  v_add_u32 v13, v13, v14
  v_add_u32 v6, s23, v13
  v_lshrrev_b32 v13, 1, v12
  v_lshlrev_b32 v13, 12, v13
  v_and_b32 v14, 1, v12
  v_lshlrev_b32 v14, 4, v14
  v_add_u32 v9, v13, v14
  v_add_u32 v12, 128, v1
  v_mul_u32_u24 v13, 6554, v12
  v_lshrrev_b32 v13, 16, v13
  v_mul_u32_u24 v14, 10, v13
  v_sub_u32 v14, v12, v14
  v_lshlrev_b32 v14, 4, v14
  v_mul_u32_u24 v13, 1280, v13
  v_add_u32 v13, v13, v14
  v_add_u32 v7, s23, v13
  v_lshrrev_b32 v13, 1, v12
  v_lshlrev_b32 v13, 12, v13
  v_and_b32 v14, 1, v12
  v_lshlrev_b32 v14, 4, v14
  v_add_u32 v10, v13, v14
  s_mul_i32 s44, s22, 2560
  s_mul_i32 s45, s21, 327680
  s_lshl_b32 s24, s34, 5
  s_add_u32 s45, s45, s24
  s_add_u32 s45, s45, 9437184
  v_lshlrev_b32 v21, 3, v3
  s_lshl_b32 s46, s34, 7
  s_add_u32 s46, s46, 16777216
  v_mov_b32 v68, 0
  v_mov_b32 v69, 0
  v_mov_b32 v70, 0
  v_mov_b32 v71, 0
  v_mov_b32 v72, 0
  v_mov_b32 v73, 0
  v_mov_b32 v74, 0
  v_mov_b32 v75, 0
  v_mov_b32 v76, 0
  v_mov_b32 v77, 0
  v_mov_b32 v78, 0
  v_mov_b32 v79, 0
  v_mov_b32 v80, 0
  v_mov_b32 v81, 0
  v_mov_b32 v82, 0
  v_mov_b32 v83, 0
  v_mov_b32 v84, 0
  v_mov_b32 v85, 0
  v_mov_b32 v86, 0
  v_mov_b32 v87, 0
  v_add_u32 v20, 65536, v4
  s_waitcnt vmcnt(9)
  s_barrier
  ds_read_b128 v[28:31], v4 offset:0
  ds_read_b128 v[32:35], v4 offset:1024
  ds_read_b128 v[36:39], v4 offset:2048
  ds_read_b128 v[40:43], v4 offset:3072
  ds_read_b128 v[44:47], v4 offset:4096
  s_waitcnt lgkmcnt(0)
  v_mfma_f32_16x16x32_bf16 v[68:71], v[28:31], v[88:91], v[68:71]
  ds_read_b128 v[48:51], v4 offset:5120
  v_mfma_f32_16x16x32_bf16 v[72:75], v[32:35], v[88:91], v[72:75]
  ds_read_b128 v[52:55], v4 offset:6144
  s_add_u32 m0, s37, 40960
  s_add_u32 s23, s33, 8192
  buffer_load_dwordx4 v4, s[12:15], s23 offen lds
  v_mfma_f32_16x16x32_bf16 v[76:79], v[36:39], v[88:91], v[76:79]
  ds_read_b128 v[56:59], v4 offset:7168
  s_add_u32 m0, s37, 41984
  s_add_u32 s23, s33, 32768
  buffer_load_dwordx4 v4, s[12:15], s23 offen lds
  v_mfma_f32_16x16x32_bf16 v[80:83], v[40:43], v[88:91], v[80:83]
  ds_read_b128 v[60:63], v4 offset:8192
  v_mfma_f32_16x16x32_bf16 v[84:87], v[44:47], v[88:91], v[84:87]
  ds_read_b128 v[64:67], v4 offset:9216
  s_waitcnt lgkmcnt(0)
  v_mfma_f32_16x16x32_bf16 v[68:71], v[48:51], v[92:95], v[68:71]
  ds_read_b128 v[28:31], v4 offset:10240
  v_mfma_f32_16x16x32_bf16 v[72:75], v[52:55], v[92:95], v[72:75]
  ds_read_b128 v[32:35], v4 offset:11264
  s_add_u32 m0, s37, 43008
  s_add_u32 s23, s33, 57344
  buffer_load_dwordx4 v4, s[12:15], s23 offen lds
  v_mfma_f32_16x16x32_bf16 v[76:79], v[56:59], v[92:95], v[76:79]
  ds_read_b128 v[36:39], v4 offset:12288
  s_add_u32 m0, s37, 44032
  s_add_u32 s23, s33, 81920
  buffer_load_dwordx4 v4, s[12:15], s23 offen lds
  v_mfma_f32_16x16x32_bf16 v[80:83], v[60:63], v[92:95], v[80:83]
  ds_read_b128 v[40:43], v4 offset:13312
  v_mfma_f32_16x16x32_bf16 v[84:87], v[64:67], v[92:95], v[84:87]
  ds_read_b128 v[44:47], v4 offset:14336
  s_waitcnt lgkmcnt(0)
  v_mfma_f32_16x16x32_bf16 v[68:71], v[28:31], v[96:99], v[68:71]
  ds_read_b128 v[48:51], v4 offset:15360
  v_mfma_f32_16x16x32_bf16 v[72:75], v[32:35], v[96:99], v[72:75]
  ds_read_b128 v[52:55], v4 offset:16384
  s_add_u32 m0, s37, 45056
  s_add_u32 s23, s33, 106496
  buffer_load_dwordx4 v4, s[12:15], s23 offen lds
  v_mfma_f32_16x16x32_bf16 v[76:79], v[36:39], v[96:99], v[76:79]
  ds_read_b128 v[56:59], v4 offset:17408
  s_add_u32 s23, s35, 8192
  buffer_load_dwordx4 v[120:123], v4, s[12:15], s23 offen offset:0
  v_mfma_f32_16x16x32_bf16 v[80:83], v[40:43], v[96:99], v[80:83]
  ds_read_b128 v[60:63], v4 offset:18432
  v_mfma_f32_16x16x32_bf16 v[84:87], v[44:47], v[96:99], v[84:87]
  ds_read_b128 v[64:67], v4 offset:19456
  s_waitcnt vmcnt(6) lgkmcnt(0)
  s_barrier
  v_mfma_f32_16x16x32_bf16 v[68:71], v[48:51], v[100:103], v[68:71]
  ds_read_b128 v[28:31], v4 offset:20480
  v_mfma_f32_16x16x32_bf16 v[72:75], v[52:55], v[100:103], v[72:75]
  ds_read_b128 v[32:35], v4 offset:21504
  s_add_u32 s23, s35, 8192
  buffer_load_dwordx4 v[124:127], v4, s[12:15], s23 offen offset:1024
  v_mfma_f32_16x16x32_bf16 v[76:79], v[56:59], v[100:103], v[76:79]
  ds_read_b128 v[36:39], v4 offset:22528
  s_add_u32 s23, s35, 8192
  buffer_load_dwordx4 v[128:131], v4, s[12:15], s23 offen offset:2048
  v_mfma_f32_16x16x32_bf16 v[80:83], v[60:63], v[100:103], v[80:83]
  ds_read_b128 v[40:43], v4 offset:23552
  s_add_u32 s23, s35, 8192
  buffer_load_dwordx4 v[132:135], v4, s[12:15], s23 offen offset:3072
  v_mfma_f32_16x16x32_bf16 v[84:87], v[64:67], v[100:103], v[84:87]
  ds_read_b128 v[44:47], v4 offset:24576
  s_waitcnt lgkmcnt(0)
  v_mfma_f32_16x16x32_bf16 v[68:71], v[28:31], v[104:107], v[68:71]
  ds_read_b128 v[48:51], v4 offset:25600
  v_mfma_f32_16x16x32_bf16 v[72:75], v[32:35], v[104:107], v[72:75]
  ds_read_b128 v[52:55], v4 offset:26624
  s_add_u32 m0, s37, 61440
  s_add_u32 s23, s33, 12288
  buffer_load_dwordx4 v4, s[12:15], s23 offen lds
  v_mfma_f32_16x16x32_bf16 v[76:79], v[36:39], v[104:107], v[76:79]
  ds_read_b128 v[56:59], v4 offset:27648
  s_add_u32 m0, s37, 62464
  s_add_u32 s23, s33, 36864
  buffer_load_dwordx4 v4, s[12:15], s23 offen lds
  v_mfma_f32_16x16x32_bf16 v[80:83], v[40:43], v[104:107], v[80:83]
  ds_read_b128 v[60:63], v4 offset:28672
  v_mfma_f32_16x16x32_bf16 v[84:87], v[44:47], v[104:107], v[84:87]
  ds_read_b128 v[64:67], v4 offset:29696
  s_waitcnt lgkmcnt(0)
  v_mfma_f32_16x16x32_bf16 v[68:71], v[48:51], v[108:111], v[68:71]
  ds_read_b128 v[28:31], v4 offset:30720
  v_mfma_f32_16x16x32_bf16 v[72:75], v[52:55], v[108:111], v[72:75]
  ds_read_b128 v[32:35], v4 offset:31744
  s_add_u32 m0, s37, 63488
  s_add_u32 s23, s33, 61440
  buffer_load_dwordx4 v4, s[12:15], s23 offen lds
  v_mfma_f32_16x16x32_bf16 v[76:79], v[56:59], v[108:111], v[76:79]
  ds_read_b128 v[36:39], v4 offset:32768
  s_add_u32 m0, s37, 64512
  s_add_u32 s23, s33, 86016
  buffer_load_dwordx4 v4, s[12:15], s23 offen lds
  v_mfma_f32_16x16x32_bf16 v[80:83], v[60:63], v[108:111], v[80:83]
  ds_read_b128 v[40:43], v4 offset:33792
  v_mfma_f32_16x16x32_bf16 v[84:87], v[64:67], v[108:111], v[84:87]
  ds_read_b128 v[44:47], v4 offset:34816
  s_waitcnt lgkmcnt(0)
  v_mfma_f32_16x16x32_bf16 v[68:71], v[28:31], v[112:115], v[68:71]
  ds_read_b128 v[48:51], v4 offset:35840
  v_mfma_f32_16x16x32_bf16 v[72:75], v[32:35], v[112:115], v[72:75]
  ds_read_b128 v[52:55], v4 offset:36864
  s_add_u32 m0, s37, 65536
  s_add_u32 s23, s33, 110592
  buffer_load_dwordx4 v4, s[12:15], s23 offen lds
  v_mfma_f32_16x16x32_bf16 v[76:79], v[36:39], v[112:115], v[76:79]
  ds_read_b128 v[56:59], v4 offset:37888
  s_add_u32 s23, s35, 12288
  buffer_load_dwordx4 v[136:139], v4, s[12:15], s23 offen offset:0
  v_mfma_f32_16x16x32_bf16 v[80:83], v[40:43], v[112:115], v[80:83]
  ds_read_b128 v[60:63], v4 offset:38912
  v_mfma_f32_16x16x32_bf16 v[84:87], v[44:47], v[112:115], v[84:87]
  ds_read_b128 v[64:67], v4 offset:39936
  s_waitcnt vmcnt(6) lgkmcnt(0)
  s_barrier
  v_mfma_f32_16x16x32_bf16 v[68:71], v[48:51], v[116:119], v[68:71]
  ds_read_b128 v[28:31], v4 offset:40960
  v_mfma_f32_16x16x32_bf16 v[72:75], v[52:55], v[116:119], v[72:75]
  ds_read_b128 v[32:35], v4 offset:41984
  s_add_u32 s23, s35, 12288
  buffer_load_dwordx4 v[140:143], v4, s[12:15], s23 offen offset:1024
  v_mfma_f32_16x16x32_bf16 v[76:79], v[56:59], v[116:119], v[76:79]
  ds_read_b128 v[36:39], v4 offset:43008
  s_add_u32 s23, s35, 12288
  buffer_load_dwordx4 v[144:147], v4, s[12:15], s23 offen offset:2048
  v_mfma_f32_16x16x32_bf16 v[80:83], v[60:63], v[116:119], v[80:83]
  ds_read_b128 v[40:43], v4 offset:44032
  s_add_u32 s23, s35, 12288
  buffer_load_dwordx4 v[148:151], v4, s[12:15], s23 offen offset:3072
  v_mfma_f32_16x16x32_bf16 v[84:87], v[64:67], v[116:119], v[84:87]
  ds_read_b128 v[44:47], v4 offset:45056
  s_waitcnt lgkmcnt(0)
  v_mfma_f32_16x16x32_bf16 v[68:71], v[28:31], v[120:123], v[68:71]
  ds_read_b128 v[48:51], v4 offset:46080
  v_mfma_f32_16x16x32_bf16 v[72:75], v[32:35], v[120:123], v[72:75]
  ds_read_b128 v[52:55], v4 offset:47104
  s_add_u32 m0, s37, 81920
  s_add_u32 s23, s33, 16384
  buffer_load_dwordx4 v4, s[12:15], s23 offen lds
  v_mfma_f32_16x16x32_bf16 v[76:79], v[36:39], v[120:123], v[76:79]
  ds_read_b128 v[56:59], v4 offset:48128
  s_add_u32 m0, s37, 82944
  s_add_u32 s23, s33, 40960
  buffer_load_dwordx4 v4, s[12:15], s23 offen lds
  v_mfma_f32_16x16x32_bf16 v[80:83], v[40:43], v[120:123], v[80:83]
  ds_read_b128 v[60:63], v4 offset:49152
  v_mfma_f32_16x16x32_bf16 v[84:87], v[44:47], v[120:123], v[84:87]
  ds_read_b128 v[64:67], v4 offset:50176
  s_waitcnt lgkmcnt(0)
  v_mfma_f32_16x16x32_bf16 v[68:71], v[48:51], v[124:127], v[68:71]
  ds_read_b128 v[28:31], v4 offset:51200
  v_mfma_f32_16x16x32_bf16 v[72:75], v[52:55], v[124:127], v[72:75]
  ds_read_b128 v[32:35], v4 offset:52224
  s_add_u32 m0, s37, 83968
  s_add_u32 s23, s33, 65536
  buffer_load_dwordx4 v4, s[12:15], s23 offen lds
  v_mfma_f32_16x16x32_bf16 v[76:79], v[56:59], v[124:127], v[76:79]
  ds_read_b128 v[36:39], v4 offset:53248
  s_add_u32 m0, s37, 84992
  s_add_u32 s23, s33, 90112
  buffer_load_dwordx4 v4, s[12:15], s23 offen lds
  v_mfma_f32_16x16x32_bf16 v[80:83], v[60:63], v[124:127], v[80:83]
  ds_read_b128 v[40:43], v4 offset:54272
  v_mfma_f32_16x16x32_bf16 v[84:87], v[64:67], v[124:127], v[84:87]
  ds_read_b128 v[44:47], v4 offset:55296
  s_waitcnt lgkmcnt(0)
  v_mfma_f32_16x16x32_bf16 v[68:71], v[28:31], v[128:131], v[68:71]
  ds_read_b128 v[48:51], v4 offset:56320
  v_mfma_f32_16x16x32_bf16 v[72:75], v[32:35], v[128:131], v[72:75]
  ds_read_b128 v[52:55], v4 offset:57344
  s_add_u32 m0, s37, 86016
  s_add_u32 s23, s33, 114688
  buffer_load_dwordx4 v4, s[12:15], s23 offen lds
  v_mfma_f32_16x16x32_bf16 v[76:79], v[36:39], v[128:131], v[76:79]
  ds_read_b128 v[56:59], v4 offset:58368
  s_add_u32 s23, s35, 16384
  buffer_load_dwordx4 v[152:155], v4, s[12:15], s23 offen offset:0
  v_mfma_f32_16x16x32_bf16 v[80:83], v[40:43], v[128:131], v[80:83]
  ds_read_b128 v[60:63], v4 offset:59392
  v_mfma_f32_16x16x32_bf16 v[84:87], v[44:47], v[128:131], v[84:87]
  ds_read_b128 v[64:67], v4 offset:60416
  s_waitcnt vmcnt(6) lgkmcnt(0)
  s_barrier
  v_mfma_f32_16x16x32_bf16 v[68:71], v[48:51], v[132:135], v[68:71]
  ds_read_b128 v[28:31], v4 offset:61440
  v_mfma_f32_16x16x32_bf16 v[72:75], v[52:55], v[132:135], v[72:75]
  ds_read_b128 v[32:35], v4 offset:62464
  s_add_u32 s23, s35, 16384
  buffer_load_dwordx4 v[156:159], v4, s[12:15], s23 offen offset:1024
  v_mfma_f32_16x16x32_bf16 v[76:79], v[56:59], v[132:135], v[76:79]
  ds_read_b128 v[36:39], v4 offset:63488
  s_add_u32 s23, s35, 16384
  buffer_load_dwordx4 v[160:163], v4, s[12:15], s23 offen offset:2048
  v_mfma_f32_16x16x32_bf16 v[80:83], v[60:63], v[132:135], v[80:83]
  ds_read_b128 v[40:43], v4 offset:64512
  s_add_u32 s23, s35, 16384
  buffer_load_dwordx4 v[164:167], v4, s[12:15], s23 offen offset:3072
  v_mfma_f32_16x16x32_bf16 v[84:87], v[64:67], v[132:135], v[84:87]
  ds_read_b128 v[44:47], v20 offset:0
  s_waitcnt lgkmcnt(0)
  v_mfma_f32_16x16x32_bf16 v[68:71], v[28:31], v[136:139], v[68:71]
  ds_read_b128 v[48:51], v20 offset:1024
  v_mfma_f32_16x16x32_bf16 v[72:75], v[32:35], v[136:139], v[72:75]
  ds_read_b128 v[52:55], v20 offset:2048
  s_add_u32 m0, s37, 102400
  s_add_u32 s23, s33, 20480
  buffer_load_dwordx4 v4, s[12:15], s23 offen lds
  v_mfma_f32_16x16x32_bf16 v[76:79], v[36:39], v[136:139], v[76:79]
  ds_read_b128 v[56:59], v20 offset:3072
  s_add_u32 m0, s37, 103424
  s_add_u32 s23, s33, 45056
  buffer_load_dwordx4 v4, s[12:15], s23 offen lds
  v_mfma_f32_16x16x32_bf16 v[80:83], v[40:43], v[136:139], v[80:83]
  ds_read_b128 v[60:63], v20 offset:4096
  v_mfma_f32_16x16x32_bf16 v[84:87], v[44:47], v[136:139], v[84:87]
  ds_read_b128 v[64:67], v20 offset:5120
  s_waitcnt lgkmcnt(0)
  v_mfma_f32_16x16x32_bf16 v[68:71], v[48:51], v[140:143], v[68:71]
  ds_read_b128 v[28:31], v20 offset:6144
  v_mfma_f32_16x16x32_bf16 v[72:75], v[52:55], v[140:143], v[72:75]
  ds_read_b128 v[32:35], v20 offset:7168
  s_add_u32 m0, s37, 104448
  s_add_u32 s23, s33, 69632
  buffer_load_dwordx4 v4, s[12:15], s23 offen lds
  v_mfma_f32_16x16x32_bf16 v[76:79], v[56:59], v[140:143], v[76:79]
  ds_read_b128 v[36:39], v20 offset:8192
  s_add_u32 m0, s37, 105472
  s_add_u32 s23, s33, 94208
  buffer_load_dwordx4 v4, s[12:15], s23 offen lds
  v_mfma_f32_16x16x32_bf16 v[80:83], v[60:63], v[140:143], v[80:83]
  ds_read_b128 v[40:43], v20 offset:9216
  v_mfma_f32_16x16x32_bf16 v[84:87], v[64:67], v[140:143], v[84:87]
  ds_read_b128 v[44:47], v20 offset:10240
  s_waitcnt lgkmcnt(0)
  v_mfma_f32_16x16x32_bf16 v[68:71], v[28:31], v[144:147], v[68:71]
  ds_read_b128 v[48:51], v20 offset:11264
  v_mfma_f32_16x16x32_bf16 v[72:75], v[32:35], v[144:147], v[72:75]
  ds_read_b128 v[52:55], v20 offset:12288
  s_add_u32 m0, s37, 106496
  s_add_u32 s23, s33, 118784
  buffer_load_dwordx4 v4, s[12:15], s23 offen lds
  v_mfma_f32_16x16x32_bf16 v[76:79], v[36:39], v[144:147], v[76:79]
  ds_read_b128 v[56:59], v20 offset:13312
  s_add_u32 s23, s35, 20480
  buffer_load_dwordx4 v[168:171], v4, s[12:15], s23 offen offset:0
  v_mfma_f32_16x16x32_bf16 v[80:83], v[40:43], v[144:147], v[80:83]
  ds_read_b128 v[60:63], v20 offset:14336
  v_mfma_f32_16x16x32_bf16 v[84:87], v[44:47], v[144:147], v[84:87]
  ds_read_b128 v[64:67], v20 offset:15360
  s_waitcnt vmcnt(6) lgkmcnt(0)
  s_barrier
  v_mfma_f32_16x16x32_bf16 v[68:71], v[48:51], v[148:151], v[68:71]
  ds_read_b128 v[28:31], v20 offset:16384
  v_mfma_f32_16x16x32_bf16 v[72:75], v[52:55], v[148:151], v[72:75]
  ds_read_b128 v[32:35], v20 offset:17408
  s_add_u32 s23, s35, 20480
  buffer_load_dwordx4 v[172:175], v4, s[12:15], s23 offen offset:1024
  v_mfma_f32_16x16x32_bf16 v[76:79], v[56:59], v[148:151], v[76:79]
  ds_read_b128 v[36:39], v20 offset:18432
  s_add_u32 s23, s35, 20480
  buffer_load_dwordx4 v[176:179], v4, s[12:15], s23 offen offset:2048
  v_mfma_f32_16x16x32_bf16 v[80:83], v[60:63], v[148:151], v[80:83]
  ds_read_b128 v[40:43], v20 offset:19456
  s_add_u32 s23, s35, 20480
  buffer_load_dwordx4 v[180:183], v4, s[12:15], s23 offen offset:3072
  v_mfma_f32_16x16x32_bf16 v[84:87], v[64:67], v[148:151], v[84:87]
  ds_read_b128 v[44:47], v20 offset:20480
  s_waitcnt lgkmcnt(0)
  v_mfma_f32_16x16x32_bf16 v[68:71], v[28:31], v[152:155], v[68:71]
  ds_read_b128 v[48:51], v20 offset:21504
  v_mfma_f32_16x16x32_bf16 v[72:75], v[32:35], v[152:155], v[72:75]
  ds_read_b128 v[52:55], v20 offset:22528
  s_add_u32 m0, s44, 122880
  s_nop 0
  buffer_load_dwordx4 v5, s[8:11], 0 offen lds
  v_mfma_f32_16x16x32_bf16 v[76:79], v[36:39], v[152:155], v[76:79]
  ds_read_b128 v[56:59], v20 offset:23552
  v_mfma_f32_16x16x32_bf16 v[80:83], v[40:43], v[152:155], v[80:83]
  ds_read_b128 v[60:63], v20 offset:24576
  v_mfma_f32_16x16x32_bf16 v[84:87], v[44:47], v[152:155], v[84:87]
  ds_read_b128 v[64:67], v20 offset:25600
  s_waitcnt lgkmcnt(0)
  v_mfma_f32_16x16x32_bf16 v[68:71], v[48:51], v[156:159], v[68:71]
  ds_read_b128 v[28:31], v20 offset:26624
  v_mfma_f32_16x16x32_bf16 v[72:75], v[52:55], v[156:159], v[72:75]
  ds_read_b128 v[32:35], v20 offset:27648
  s_add_u32 m0, s44, 133120
  s_nop 0
  buffer_load_dwordx4 v8, s[12:15], s45 offen lds
  v_mfma_f32_16x16x32_bf16 v[76:79], v[56:59], v[156:159], v[76:79]
  ds_read_b128 v[36:39], v20 offset:28672
  s_add_u32 m0, s44, 123904
  s_nop 0
  buffer_load_dwordx4 v6, s[8:11], 0 offen lds
  v_mfma_f32_16x16x32_bf16 v[80:83], v[60:63], v[156:159], v[80:83]
  ds_read_b128 v[40:43], v20 offset:29696
  v_mfma_f32_16x16x32_bf16 v[84:87], v[64:67], v[156:159], v[84:87]
  ds_read_b128 v[44:47], v20 offset:30720
  s_waitcnt lgkmcnt(0)
  v_mfma_f32_16x16x32_bf16 v[68:71], v[28:31], v[160:163], v[68:71]
  ds_read_b128 v[48:51], v20 offset:31744
  v_mfma_f32_16x16x32_bf16 v[72:75], v[32:35], v[160:163], v[72:75]
  ds_read_b128 v[52:55], v20 offset:32768
  s_add_u32 m0, s44, 134144
  s_nop 0
  buffer_load_dwordx4 v9, s[12:15], s45 offen lds
  v_mfma_f32_16x16x32_bf16 v[76:79], v[36:39], v[160:163], v[76:79]
  ds_read_b128 v[56:59], v20 offset:33792
  s_mov_b32 exec_hi, 0
  s_add_u32 m0, s44, 124928
  s_nop 0
  buffer_load_dwordx4 v7, s[8:11], 0 offen lds
  s_mov_b32 exec_hi, -1
  v_mfma_f32_16x16x32_bf16 v[80:83], v[40:43], v[160:163], v[80:83]
  ds_read_b128 v[60:63], v20 offset:34816
  v_mfma_f32_16x16x32_bf16 v[84:87], v[44:47], v[160:163], v[84:87]
  ds_read_b128 v[64:67], v20 offset:35840
  s_waitcnt vmcnt(5) lgkmcnt(0)
  s_barrier
  v_mfma_f32_16x16x32_bf16 v[68:71], v[48:51], v[164:167], v[68:71]
  ds_read_b128 v[28:31], v20 offset:36864
  v_mfma_f32_16x16x32_bf16 v[72:75], v[52:55], v[164:167], v[72:75]
  ds_read_b128 v[32:35], v20 offset:37888
  s_mov_b32 exec_hi, 0
  s_add_u32 m0, s44, 135168
  s_nop 0
  buffer_load_dwordx4 v10, s[12:15], s45 offen lds
  s_mov_b32 exec_hi, -1
  v_mfma_f32_16x16x32_bf16 v[76:79], v[56:59], v[164:167], v[76:79]
  ds_read_b128 v[36:39], v20 offset:38912
  buffer_load_dwordx2 v[24:25], v21, s[12:15], s46 offen
  v_mfma_f32_16x16x32_bf16 v[80:83], v[60:63], v[164:167], v[80:83]
  ds_read_b128 v[40:43], v20 offset:39936
  v_mfma_f32_16x16x32_bf16 v[84:87], v[64:67], v[164:167], v[84:87]
  ds_read_b128 v[44:47], v20 offset:40960
  s_waitcnt lgkmcnt(0)
  v_mfma_f32_16x16x32_bf16 v[68:71], v[28:31], v[168:171], v[68:71]
  ds_read_b128 v[48:51], v20 offset:41984
  v_mfma_f32_16x16x32_bf16 v[72:75], v[32:35], v[168:171], v[72:75]
  ds_read_b128 v[52:55], v20 offset:43008
  v_mfma_f32_16x16x32_bf16 v[76:79], v[36:39], v[168:171], v[76:79]
  ds_read_b128 v[56:59], v20 offset:44032
  v_mfma_f32_16x16x32_bf16 v[80:83], v[40:43], v[168:171], v[80:83]
  ds_read_b128 v[60:63], v20 offset:45056
  v_mfma_f32_16x16x32_bf16 v[84:87], v[44:47], v[168:171], v[84:87]
  ds_read_b128 v[64:67], v20 offset:46080
  s_waitcnt lgkmcnt(0)
  v_mfma_f32_16x16x32_bf16 v[68:71], v[48:51], v[172:175], v[68:71]
  ds_read_b128 v[28:31], v20 offset:47104
  v_mfma_f32_16x16x32_bf16 v[72:75], v[52:55], v[172:175], v[72:75]
  ds_read_b128 v[32:35], v20 offset:48128
  v_mfma_f32_16x16x32_bf16 v[76:79], v[56:59], v[172:175], v[76:79]
  ds_read_b128 v[36:39], v20 offset:49152
  v_mfma_f32_16x16x32_bf16 v[80:83], v[60:63], v[172:175], v[80:83]
  ds_read_b128 v[40:43], v20 offset:50176
  v_mfma_f32_16x16x32_bf16 v[84:87], v[64:67], v[172:175], v[84:87]
  ds_read_b128 v[44:47], v20 offset:51200
  s_waitcnt lgkmcnt(0)
  v_mfma_f32_16x16x32_bf16 v[68:71], v[28:31], v[176:179], v[68:71]
  ds_read_b128 v[48:51], v20 offset:52224
  v_mfma_f32_16x16x32_bf16 v[72:75], v[32:35], v[176:179], v[72:75]
  ds_read_b128 v[52:55], v20 offset:53248
  v_mfma_f32_16x16x32_bf16 v[76:79], v[36:39], v[176:179], v[76:79]
  ds_read_b128 v[56:59], v20 offset:54272
  v_mfma_f32_16x16x32_bf16 v[80:83], v[40:43], v[176:179], v[80:83]
  ds_read_b128 v[60:63], v20 offset:55296
  v_mfma_f32_16x16x32_bf16 v[84:87], v[44:47], v[176:179], v[84:87]
  ds_read_b128 v[64:67], v20 offset:56320
  s_waitcnt lgkmcnt(0)
  v_mfma_f32_16x16x32_bf16 v[68:71], v[48:51], v[180:183], v[68:71]
  v_mfma_f32_16x16x32_bf16 v[72:75], v[52:55], v[180:183], v[72:75]
  v_mfma_f32_16x16x32_bf16 v[76:79], v[56:59], v[180:183], v[76:79]
  v_mfma_f32_16x16x32_bf16 v[80:83], v[60:63], v[180:183], v[80:83]
  v_mfma_f32_16x16x32_bf16 v[84:87], v[64:67], v[180:183], v[84:87]
  s_waitcnt vmcnt(0)
  v_mul_u32_u24 v12, 160, v3
  v_lshlrev_b32 v13, 3, v2
  v_add_u32 v12, v12, v13
  s_add_u32 s23, s44, 122880
  v_add_u32 v12, s23, v12
  v_lshlrev_b32 v13, 7, v2
  v_lshlrev_b32 v14, 3, v3
  v_add_u32 v13, v13, v14
  s_add_u32 s23, s44, 133120
  v_add_u32 v13, s23, v13
  ds_read_b64 v[184:185], v12 offset:0
  ds_read_b64_tr_b16 v[194:195], v13 offset:0
  ds_read_b64 v[186:187], v12 offset:32
  ds_read_b64_tr_b16 v[196:197], v13 offset:512
  ds_read_b64 v[188:189], v12 offset:64
  ds_read_b64_tr_b16 v[198:199], v13 offset:1024
  ds_read_b64 v[190:191], v12 offset:96
  ds_read_b64_tr_b16 v[200:201], v13 offset:1536
  ds_read_b64 v[192:193], v12 offset:128
  ds_read_b64_tr_b16 v[202:203], v13 offset:2048
  v_sub_f32 v14, 0, v24
  v_mov_b32 v16, v25
  s_mov_b32 s30, 1.0
  s_mov_b32 s31, 1.0
  s_mov_b32 s32, 0xbfb8aa3b
  v_mov_b32 v18, s32
  v_mov_b32 v19, s32
  s_waitcnt lgkmcnt(0)
  v_lshlrev_b32 v204, 16, v184
  v_and_b32 v205, s26, v184
  v_lshlrev_b32 v206, 16, v194
  v_and_b32 v207, s26, v194
  v_pk_mul_f32 v[208:209], v[68:69], v[18:19]
  v_exp_f32 v208, v208
  v_exp_f32 v209, v209
  v_pk_add_f32 v[210:211], v[204:205], v[14:15] op_sel_hi:[1,0]
  v_pk_add_f32 v[208:209], v[208:209], s[30:31]
  v_pk_mul_f32 v[210:211], v[210:211], v[16:17] op_sel_hi:[1,0]
  v_rcp_f32 v208, v208
  v_rcp_f32 v209, v209
  v_pk_mul_f32 v[210:211], v[210:211], v[206:207]
  v_pk_mul_f32 v[208:209], v[208:209], v[68:69]
  v_pk_fma_f32 v[210:211], v[210:211], v[208:209], v[204:205]
  v_cvt_pk_bf16_f32 v184, v210, v211
  v_lshlrev_b32 v212, 16, v185
  v_and_b32 v213, s26, v185
  v_lshlrev_b32 v214, 16, v195
  v_and_b32 v215, s26, v195
  v_pk_mul_f32 v[216:217], v[70:71], v[18:19]
  v_exp_f32 v216, v216
  v_exp_f32 v217, v217
  v_pk_add_f32 v[218:219], v[212:213], v[14:15] op_sel_hi:[1,0]
  v_pk_add_f32 v[216:217], v[216:217], s[30:31]
  v_pk_mul_f32 v[218:219], v[218:219], v[16:17] op_sel_hi:[1,0]
  v_rcp_f32 v216, v216
  v_rcp_f32 v217, v217
  v_pk_mul_f32 v[218:219], v[218:219], v[214:215]
  v_pk_mul_f32 v[216:217], v[216:217], v[70:71]
  v_pk_fma_f32 v[218:219], v[218:219], v[216:217], v[212:213]
  v_cvt_pk_bf16_f32 v185, v218, v219
  ds_write_b64 v12, v[184:185] offset:0
  v_lshlrev_b32 v204, 16, v186
  v_and_b32 v205, s26, v186
  v_lshlrev_b32 v206, 16, v196
  v_and_b32 v207, s26, v196
  v_pk_mul_f32 v[208:209], v[72:73], v[18:19]
  v_exp_f32 v208, v208
  v_exp_f32 v209, v209
  v_pk_add_f32 v[210:211], v[204:205], v[14:15] op_sel_hi:[1,0]
  v_pk_add_f32 v[208:209], v[208:209], s[30:31]
  v_pk_mul_f32 v[210:211], v[210:211], v[16:17] op_sel_hi:[1,0]
  v_rcp_f32 v208, v208
  v_rcp_f32 v209, v209
  v_pk_mul_f32 v[210:211], v[210:211], v[206:207]
  v_pk_mul_f32 v[208:209], v[208:209], v[72:73]
  v_pk_fma_f32 v[210:211], v[210:211], v[208:209], v[204:205]
  v_cvt_pk_bf16_f32 v186, v210, v211
  v_lshlrev_b32 v212, 16, v187
  v_and_b32 v213, s26, v187
  v_lshlrev_b32 v214, 16, v197
  v_and_b32 v215, s26, v197
  v_pk_mul_f32 v[216:217], v[74:75], v[18:19]
  v_exp_f32 v216, v216
  v_exp_f32 v217, v217
  v_pk_add_f32 v[218:219], v[212:213], v[14:15] op_sel_hi:[1,0]
  v_pk_add_f32 v[216:217], v[216:217], s[30:31]
  v_pk_mul_f32 v[218:219], v[218:219], v[16:17] op_sel_hi:[1,0]
  v_rcp_f32 v216, v216
  v_rcp_f32 v217, v217
  v_pk_mul_f32 v[218:219], v[218:219], v[214:215]
  v_pk_mul_f32 v[216:217], v[216:217], v[74:75]
  v_pk_fma_f32 v[218:219], v[218:219], v[216:217], v[212:213]
  v_cvt_pk_bf16_f32 v187, v218, v219
  ds_write_b64 v12, v[186:187] offset:32
  v_lshlrev_b32 v204, 16, v188
  v_and_b32 v205, s26, v188
  v_lshlrev_b32 v206, 16, v198
  v_and_b32 v207, s26, v198
  v_pk_mul_f32 v[208:209], v[76:77], v[18:19]
  v_exp_f32 v208, v208
  v_exp_f32 v209, v209
  v_pk_add_f32 v[210:211], v[204:205], v[14:15] op_sel_hi:[1,0]
  v_pk_add_f32 v[208:209], v[208:209], s[30:31]
  v_pk_mul_f32 v[210:211], v[210:211], v[16:17] op_sel_hi:[1,0]
  v_rcp_f32 v208, v208
  v_rcp_f32 v209, v209
  v_pk_mul_f32 v[210:211], v[210:211], v[206:207]
  v_pk_mul_f32 v[208:209], v[208:209], v[76:77]
  v_pk_fma_f32 v[210:211], v[210:211], v[208:209], v[204:205]
  v_cvt_pk_bf16_f32 v188, v210, v211
  v_lshlrev_b32 v212, 16, v189
  v_and_b32 v213, s26, v189
  v_lshlrev_b32 v214, 16, v199
  v_and_b32 v215, s26, v199
  v_pk_mul_f32 v[216:217], v[78:79], v[18:19]
  v_exp_f32 v216, v216
  v_exp_f32 v217, v217
  v_pk_add_f32 v[218:219], v[212:213], v[14:15] op_sel_hi:[1,0]
  v_pk_add_f32 v[216:217], v[216:217], s[30:31]
  v_pk_mul_f32 v[218:219], v[218:219], v[16:17] op_sel_hi:[1,0]
  v_rcp_f32 v216, v216
  v_rcp_f32 v217, v217
  v_pk_mul_f32 v[218:219], v[218:219], v[214:215]
  v_pk_mul_f32 v[216:217], v[216:217], v[78:79]
  v_pk_fma_f32 v[218:219], v[218:219], v[216:217], v[212:213]
  v_cvt_pk_bf16_f32 v189, v218, v219
  ds_write_b64 v12, v[188:189] offset:64
  v_lshlrev_b32 v204, 16, v190
  v_and_b32 v205, s26, v190
  v_lshlrev_b32 v206, 16, v200
  v_and_b32 v207, s26, v200
  v_pk_mul_f32 v[208:209], v[80:81], v[18:19]
  v_exp_f32 v208, v208
  v_exp_f32 v209, v209
  v_pk_add_f32 v[210:211], v[204:205], v[14:15] op_sel_hi:[1,0]
  v_pk_add_f32 v[208:209], v[208:209], s[30:31]
  v_pk_mul_f32 v[210:211], v[210:211], v[16:17] op_sel_hi:[1,0]
  v_rcp_f32 v208, v208
  v_rcp_f32 v209, v209
  v_pk_mul_f32 v[210:211], v[210:211], v[206:207]
  v_pk_mul_f32 v[208:209], v[208:209], v[80:81]
  v_pk_fma_f32 v[210:211], v[210:211], v[208:209], v[204:205]
  v_cvt_pk_bf16_f32 v190, v210, v211
  v_lshlrev_b32 v212, 16, v191
  v_and_b32 v213, s26, v191
  v_lshlrev_b32 v214, 16, v201
  v_and_b32 v215, s26, v201
  v_pk_mul_f32 v[216:217], v[82:83], v[18:19]
  v_exp_f32 v216, v216
  v_exp_f32 v217, v217
  v_pk_add_f32 v[218:219], v[212:213], v[14:15] op_sel_hi:[1,0]
  v_pk_add_f32 v[216:217], v[216:217], s[30:31]
  v_pk_mul_f32 v[218:219], v[218:219], v[16:17] op_sel_hi:[1,0]
  v_rcp_f32 v216, v216
  v_rcp_f32 v217, v217
  v_pk_mul_f32 v[218:219], v[218:219], v[214:215]
  v_pk_mul_f32 v[216:217], v[216:217], v[82:83]
  v_pk_fma_f32 v[218:219], v[218:219], v[216:217], v[212:213]
  v_cvt_pk_bf16_f32 v191, v218, v219
  ds_write_b64 v12, v[190:191] offset:96
  v_lshlrev_b32 v204, 16, v192
  v_and_b32 v205, s26, v192
  v_lshlrev_b32 v206, 16, v202
  v_and_b32 v207, s26, v202
  v_pk_mul_f32 v[208:209], v[84:85], v[18:19]
  v_exp_f32 v208, v208
  v_exp_f32 v209, v209
  v_pk_add_f32 v[210:211], v[204:205], v[14:15] op_sel_hi:[1,0]
  v_pk_add_f32 v[208:209], v[208:209], s[30:31]
  v_pk_mul_f32 v[210:211], v[210:211], v[16:17] op_sel_hi:[1,0]
  v_rcp_f32 v208, v208
  v_rcp_f32 v209, v209
  v_pk_mul_f32 v[210:211], v[210:211], v[206:207]
  v_pk_mul_f32 v[208:209], v[208:209], v[84:85]
  v_pk_fma_f32 v[210:211], v[210:211], v[208:209], v[204:205]
  v_cvt_pk_bf16_f32 v192, v210, v211
  v_lshlrev_b32 v212, 16, v193
  v_and_b32 v213, s26, v193
  v_lshlrev_b32 v214, 16, v203
  v_and_b32 v215, s26, v203
  v_pk_mul_f32 v[216:217], v[86:87], v[18:19]
  v_exp_f32 v216, v216
  v_exp_f32 v217, v217
  v_pk_add_f32 v[218:219], v[212:213], v[14:15] op_sel_hi:[1,0]
  v_pk_add_f32 v[216:217], v[216:217], s[30:31]
  v_pk_mul_f32 v[218:219], v[218:219], v[16:17] op_sel_hi:[1,0]
  v_rcp_f32 v216, v216
  v_rcp_f32 v217, v217
  v_pk_mul_f32 v[218:219], v[218:219], v[214:215]
  v_pk_mul_f32 v[216:217], v[216:217], v[86:87]
  v_pk_fma_f32 v[218:219], v[218:219], v[216:217], v[212:213]
  v_cvt_pk_bf16_f32 v193, v218, v219
  ds_write_b64 v12, v[192:193] offset:128
  s_waitcnt lgkmcnt(0)
  s_add_u32 s23, s44, 122880
  v_add_u32 v13, s23, v4
  ds_read_b128 v[220:223], v13 offset:0
  ds_read_b128 v[224:227], v13 offset:1024
  ds_read_b128 v[228:231], v13 offset:2048
  s_waitcnt lgkmcnt(0)
  buffer_store_dwordx4 v[220:223], v5, s[16:19], 0 offen
  buffer_store_dwordx4 v[224:227], v6, s[16:19], 0 offen
  s_mov_b32 exec_lo, 0xffffffff
  s_mov_b32 exec_hi, 0x0
  buffer_store_dwordx4 v[228:231], v7, s[16:19], 0 offen
  s_mov_b64 exec, s[28:29]
K3_END:
  s_endpgm

.section .rodata,"a"
.p2align 6
.amdhsa_kernel k3_kernel
  .amdhsa_next_free_vgpr 256
  .amdhsa_next_free_sgpr 96
  .amdhsa_accum_offset 256
  .amdhsa_group_segment_fixed_size 0
  .amdhsa_kernarg_size 112
  .amdhsa_user_sgpr_count 2
  .amdhsa_user_sgpr_kernarg_segment_ptr 1
  .amdhsa_system_sgpr_workgroup_id_x 1
  .amdhsa_float_denorm_mode_32 3
.end_amdhsa_kernel
.text
```

```asm
; @launch kernel=k1_kernel grid=(256,1,1) block=(768,1,1) lds=147456
; @launch kernel=k2_kernel grid=(470,1,1) block=(256,1,1) lds=65536
; @launch kernel=k3_kernel grid=(256,1,1) block=(256,1,1) lds=143360
.amdgcn_target "amdgcn-amd-amdhsa--gfx950"
.text
.globl k1_kernel
.p2align 8
.type k1_kernel,@function
k1_kernel:
  s_cmp_ge_u32 s2, 256
  s_cbranch_scc1 K1_END
  s_load_dwordx4 s[56:59], s[0:1], 0
  s_load_dwordx4 s[60:63], s[0:1], 16
  s_load_dwordx2 s[64:65], s[0:1], 56
  s_load_dwordx2 s[66:67], s[0:1], 80
  s_load_dwordx4 s[68:71], s[0:1], 96
  s_load_dwordx2 s[74:75], s[0:1], 64
  s_load_dwordx2 s[76:77], s[0:1], 32
  v_and_b32 v1, 63, v0
  v_lshrrev_b32 v14, 6, v0
  v_lshrrev_b32 v2, 4, v1
  v_readfirstlane_b32 s34, v14
  v_and_b32 v3, 15, v1
  s_and_b32 s40, s2, 7
  s_lshr_b32 s41, s2, 3
  s_lshr_b32 s32, s40, 1
  s_lshl_b32 s32, s32, 3
  s_lshr_b32 s42, s41, 2
  s_add_u32 s32, s32, s42
  s_and_b32 s33, s40, 1
  s_lshl_b32 s33, s33, 2
  s_and_b32 s42, s41, 3
  s_add_u32 s33, s33, s42
  s_and_b32 s55, s34, 3
  s_lshr_b32 s35, s55, 1
  s_and_b32 s36, s55, 1
  s_mov_b32 s47, 0xffff0000
  s_mov_b64 s[52:53], exec
  s_mul_i32 s44, s33, 192
  s_add_u32 s43, s44, 1536
  s_cmp_ge_u32 s34, 8
  s_cbranch_scc0 K1_AB
  s_lshl_b32 s40, s32, 6
  s_lshl_b32 s41, s55, 3
  s_add_u32 s40, s40, s41
  s_lshl_b32 s45, s55, 10
  v_lshrrev_b32 v30, 3, v1
  v_add_u32 v32, s41, v30
  v_lshrrev_b32 v31, 1, v32
  v_xor_b32 v31, v31, v1
  v_and_b32 v31, 7, v31
  v_lshlrev_b32 v31, 4, v31
  v_add_u32 v30, s40, v30
  v_mul_u32_u24 v30, 1280, v30
  v_add_u32 v8, v30, v31
  v_add_u32 v9, 40960, v8
  s_waitcnt lgkmcnt(0)
  s_mov_b32 s8, s56
  s_and_b32 s9, s57, 0xffff
  s_mov_b32 s10, 2621440
  s_mov_b32 s11, 0x20000
  s_mov_b32 s12, s64
  s_and_b32 s13, s65, 0xffff
  s_mov_b32 s14, 1966080
  s_mov_b32 s15, 0x20000
  s_and_b32 s40, s32, 7
  s_and_b32 s41, s33, 3
  s_mul_i32 s41, s41, 3
  s_add_u32 s37, s40, s41
  s_sub_u32 s40, s37, 10
  s_cmp_ge_u32 s37, 10
  s_cselect_b32 s37, s40, s37
  s_lshl_b32 s40, s55, 6
  s_add_u32 s40, s40, 0
  v_add_u32 v30, s40, v1
  v_mul_u32_u24 v31, 5462, v30
  v_lshrrev_b32 v31, 16, v31
  v_mul_u32_u24 v32, 12, v31
  v_sub_u32 v32, v30, v32
  v_lshrrev_b32 v33, 2, v31
  v_and_b32 v33, 2, v33
  v_xor_b32 v32, v32, v33
  v_lshlrev_b32 v32, 4, v32
  v_mul_u32_u24 v31, 3072, v31
  v_add_u32 v12, v31, v32
  s_lshl_b32 s40, s55, 6
  s_add_u32 s40, s40, 256
  v_add_u32 v30, s40, v1
  v_mul_u32_u24 v31, 5462, v30
  v_lshrrev_b32 v31, 16, v31
  v_mul_u32_u24 v32, 12, v31
  v_sub_u32 v32, v30, v32
  v_lshrrev_b32 v33, 2, v31
  v_and_b32 v33, 2, v33
  v_xor_b32 v32, v32, v33
  v_lshlrev_b32 v32, 4, v32
  v_mul_u32_u24 v31, 3072, v31
  v_add_u32 v13, v31, v32
  s_lshl_b32 s40, s55, 6
  s_add_u32 s40, s40, 512
  v_add_u32 v30, s40, v1
  v_mul_u32_u24 v31, 5462, v30
  v_lshrrev_b32 v31, 16, v31
  v_mul_u32_u24 v32, 12, v31
  v_sub_u32 v32, v30, v32
  v_lshrrev_b32 v33, 2, v31
  v_and_b32 v33, 2, v33
  v_xor_b32 v32, v32, v33
  v_lshlrev_b32 v32, 4, v32
  v_mul_u32_u24 v31, 3072, v31
  v_add_u32 v14, v31, v32
  s_add_u32 s38, s37, 0
  s_sub_u32 s40, s38, 10
  s_cmp_ge_u32 s38, 10
  s_cselect_b32 s38, s40, s38
  s_lshl_b32 s38, s38, 7
  s_add_u32 m0, s45, 61440
  s_nop 0
  buffer_load_dwordx4 v8, s[8:11], s38 offen lds
  s_add_u32 m0, s45, 65536
  s_nop 0
  buffer_load_dwordx4 v9, s[8:11], s38 offen lds
  s_add_u32 s39, s37, 0
  s_sub_u32 s40, s39, 10
  s_cmp_ge_u32 s39, 10
  s_cselect_b32 s39, s40, s39
  s_mul_i32 s39, s39, 196608
  s_add_u32 s39, s39, s43
  s_add_u32 m0, s45, 0
  s_nop 0
  buffer_load_dwordx4 v12, s[12:15], s39 offen lds
  s_add_u32 m0, s45, 4096
  s_nop 0
  buffer_load_dwordx4 v13, s[12:15], s39 offen lds
  s_add_u32 m0, s45, 8192
  s_nop 0
  buffer_load_dwordx4 v14, s[12:15], s39 offen lds
  s_waitcnt vmcnt(0)
  s_barrier
  s_add_u32 s38, s37, 1
  s_sub_u32 s40, s38, 10
  s_cmp_ge_u32 s38, 10
  s_cselect_b32 s38, s40, s38
  s_lshl_b32 s38, s38, 7
  s_add_u32 m0, s45, 69632
  s_nop 0
  buffer_load_dwordx4 v8, s[8:11], s38 offen lds
  s_add_u32 m0, s45, 73728
  s_nop 0
  buffer_load_dwordx4 v9, s[8:11], s38 offen lds
  s_add_u32 s39, s37, 1
  s_sub_u32 s40, s39, 10
  s_cmp_ge_u32 s39, 10
  s_cselect_b32 s39, s40, s39
  s_mul_i32 s39, s39, 196608
  s_add_u32 s39, s39, s43
  s_add_u32 m0, s45, 12288
  s_nop 0
  buffer_load_dwordx4 v12, s[12:15], s39 offen lds
  s_add_u32 m0, s45, 16384
  s_nop 0
  buffer_load_dwordx4 v13, s[12:15], s39 offen lds
  s_add_u32 m0, s45, 20480
  s_nop 0
  buffer_load_dwordx4 v14, s[12:15], s39 offen lds
  s_add_u32 s38, s37, 2
  s_sub_u32 s40, s38, 10
  s_cmp_ge_u32 s38, 10
  s_cselect_b32 s38, s40, s38
  s_lshl_b32 s38, s38, 7
  s_add_u32 m0, s45, 77824
  s_nop 0
  buffer_load_dwordx4 v8, s[8:11], s38 offen lds
  s_add_u32 m0, s45, 81920
  s_nop 0
  buffer_load_dwordx4 v9, s[8:11], s38 offen lds
  s_add_u32 s39, s37, 2
  s_sub_u32 s40, s39, 10
  s_cmp_ge_u32 s39, 10
  s_cselect_b32 s39, s40, s39
  s_mul_i32 s39, s39, 196608
  s_add_u32 s39, s39, s43
  s_add_u32 m0, s45, 24576
  s_nop 0
  buffer_load_dwordx4 v12, s[12:15], s39 offen lds
  s_add_u32 m0, s45, 28672
  s_nop 0
  buffer_load_dwordx4 v13, s[12:15], s39 offen lds
  s_add_u32 m0, s45, 32768
  s_nop 0
  buffer_load_dwordx4 v14, s[12:15], s39 offen lds
  s_waitcnt vmcnt(5)
  s_barrier
  s_add_u32 s38, s37, 3
  s_sub_u32 s40, s38, 10
  s_cmp_ge_u32 s38, 10
  s_cselect_b32 s38, s40, s38
  s_lshl_b32 s38, s38, 7
  s_add_u32 m0, s45, 86016
  s_nop 0
  buffer_load_dwordx4 v8, s[8:11], s38 offen lds
  s_add_u32 m0, s45, 90112
  s_nop 0
  buffer_load_dwordx4 v9, s[8:11], s38 offen lds
  s_add_u32 s39, s37, 3
  s_sub_u32 s40, s39, 10
  s_cmp_ge_u32 s39, 10
  s_cselect_b32 s39, s40, s39
  s_mul_i32 s39, s39, 196608
  s_add_u32 s39, s39, s43
  s_add_u32 m0, s45, 36864
  s_nop 0
  buffer_load_dwordx4 v12, s[12:15], s39 offen lds
  s_add_u32 m0, s45, 40960
  s_nop 0
  buffer_load_dwordx4 v13, s[12:15], s39 offen lds
  s_add_u32 m0, s45, 45056
  s_nop 0
  buffer_load_dwordx4 v14, s[12:15], s39 offen lds
  s_add_u32 s38, s37, 4
  s_sub_u32 s40, s38, 10
  s_cmp_ge_u32 s38, 10
  s_cselect_b32 s38, s40, s38
  s_lshl_b32 s38, s38, 7
  s_add_u32 m0, s45, 94208
  s_nop 0
  buffer_load_dwordx4 v8, s[8:11], s38 offen lds
  s_add_u32 m0, s45, 98304
  s_nop 0
  buffer_load_dwordx4 v9, s[8:11], s38 offen lds
  s_add_u32 s39, s37, 4
  s_sub_u32 s40, s39, 10
  s_cmp_ge_u32 s39, 10
  s_cselect_b32 s39, s40, s39
  s_mul_i32 s39, s39, 196608
  s_add_u32 s39, s39, s43
  s_add_u32 m0, s45, 49152
  s_nop 0
  buffer_load_dwordx4 v12, s[12:15], s39 offen lds
  s_add_u32 m0, s45, 53248
  s_nop 0
  buffer_load_dwordx4 v13, s[12:15], s39 offen lds
  s_add_u32 m0, s45, 57344
  s_nop 0
  buffer_load_dwordx4 v14, s[12:15], s39 offen lds
  s_waitcnt vmcnt(10)
  s_barrier
  s_add_u32 s38, s37, 5
  s_sub_u32 s40, s38, 10
  s_cmp_ge_u32 s38, 10
  s_cselect_b32 s38, s40, s38
  s_lshl_b32 s38, s38, 7
  s_add_u32 m0, s45, 102400
  s_nop 0
  buffer_load_dwordx4 v8, s[8:11], s38 offen lds
  s_add_u32 m0, s45, 106496
  s_nop 0
  buffer_load_dwordx4 v9, s[8:11], s38 offen lds
  s_add_u32 s39, s37, 5
  s_sub_u32 s40, s39, 10
  s_cmp_ge_u32 s39, 10
  s_cselect_b32 s39, s40, s39
  s_mul_i32 s39, s39, 196608
  s_add_u32 s39, s39, s43
  s_add_u32 m0, s45, 0
  s_nop 0
  buffer_load_dwordx4 v12, s[12:15], s39 offen lds
  s_add_u32 m0, s45, 4096
  s_nop 0
  buffer_load_dwordx4 v13, s[12:15], s39 offen lds
  s_add_u32 m0, s45, 8192
  s_nop 0
  buffer_load_dwordx4 v14, s[12:15], s39 offen lds
  s_add_u32 s38, s37, 6
  s_sub_u32 s40, s38, 10
  s_cmp_ge_u32 s38, 10
  s_cselect_b32 s38, s40, s38
  s_lshl_b32 s38, s38, 7
  s_add_u32 m0, s45, 110592
  s_nop 0
  buffer_load_dwordx4 v8, s[8:11], s38 offen lds
  s_add_u32 m0, s45, 114688
  s_nop 0
  buffer_load_dwordx4 v9, s[8:11], s38 offen lds
  s_waitcnt vmcnt(12)
  s_barrier
  s_add_u32 s38, s37, 7
  s_sub_u32 s40, s38, 10
  s_cmp_ge_u32 s38, 10
  s_cselect_b32 s38, s40, s38
  s_lshl_b32 s38, s38, 7
  s_add_u32 m0, s45, 118784
  s_nop 0
  buffer_load_dwordx4 v8, s[8:11], s38 offen lds
  s_add_u32 m0, s45, 122880
  s_nop 0
  buffer_load_dwordx4 v9, s[8:11], s38 offen lds
  s_add_u32 s39, s37, 6
  s_sub_u32 s40, s39, 10
  s_cmp_ge_u32 s39, 10
  s_cselect_b32 s39, s40, s39
  s_mul_i32 s39, s39, 196608
  s_add_u32 s39, s39, s43
  s_add_u32 m0, s45, 12288
  s_nop 0
  buffer_load_dwordx4 v12, s[12:15], s39 offen lds
  s_add_u32 m0, s45, 16384
  s_nop 0
  buffer_load_dwordx4 v13, s[12:15], s39 offen lds
  s_add_u32 m0, s45, 20480
  s_nop 0
  buffer_load_dwordx4 v14, s[12:15], s39 offen lds
  s_add_u32 s38, s37, 8
  s_sub_u32 s40, s38, 10
  s_cmp_ge_u32 s38, 10
  s_cselect_b32 s38, s40, s38
  s_lshl_b32 s38, s38, 7
  s_add_u32 m0, s45, 126976
  s_nop 0
  buffer_load_dwordx4 v8, s[8:11], s38 offen lds
  s_add_u32 m0, s45, 131072
  s_nop 0
  buffer_load_dwordx4 v9, s[8:11], s38 offen lds
  s_waitcnt vmcnt(14)
  s_barrier
  s_add_u32 s38, s37, 9
  s_sub_u32 s40, s38, 10
  s_cmp_ge_u32 s38, 10
  s_cselect_b32 s38, s40, s38
  s_lshl_b32 s38, s38, 7
  s_add_u32 m0, s45, 135168
  s_nop 0
  buffer_load_dwordx4 v8, s[8:11], s38 offen lds
  s_add_u32 m0, s45, 139264
  s_nop 0
  buffer_load_dwordx4 v9, s[8:11], s38 offen lds
  s_add_u32 s39, s37, 7
  s_sub_u32 s40, s39, 10
  s_cmp_ge_u32 s39, 10
  s_cselect_b32 s39, s40, s39
  s_mul_i32 s39, s39, 196608
  s_add_u32 s39, s39, s43
  s_add_u32 m0, s45, 24576
  s_nop 0
  buffer_load_dwordx4 v12, s[12:15], s39 offen lds
  s_add_u32 m0, s45, 28672
  s_nop 0
  buffer_load_dwordx4 v13, s[12:15], s39 offen lds
  s_add_u32 m0, s45, 32768
  s_nop 0
  buffer_load_dwordx4 v14, s[12:15], s39 offen lds
  s_waitcnt vmcnt(14)
  s_barrier
  s_add_u32 s39, s37, 8
  s_sub_u32 s40, s39, 10
  s_cmp_ge_u32 s39, 10
  s_cselect_b32 s39, s40, s39
  s_mul_i32 s39, s39, 196608
  s_add_u32 s39, s39, s43
  s_add_u32 m0, s45, 36864
  s_nop 0
  buffer_load_dwordx4 v12, s[12:15], s39 offen lds
  s_add_u32 m0, s45, 40960
  s_nop 0
  buffer_load_dwordx4 v13, s[12:15], s39 offen lds
  s_add_u32 m0, s45, 45056
  s_nop 0
  buffer_load_dwordx4 v14, s[12:15], s39 offen lds
  s_add_u32 s39, s37, 9
  s_sub_u32 s40, s39, 10
  s_cmp_ge_u32 s39, 10
  s_cselect_b32 s39, s40, s39
  s_mul_i32 s39, s39, 196608
  s_add_u32 s39, s39, s43
  s_add_u32 m0, s45, 49152
  s_nop 0
  buffer_load_dwordx4 v12, s[12:15], s39 offen lds
  s_add_u32 m0, s45, 53248
  s_nop 0
  buffer_load_dwordx4 v13, s[12:15], s39 offen lds
  s_add_u32 m0, s45, 57344
  s_nop 0
  buffer_load_dwordx4 v14, s[12:15], s39 offen lds
  s_waitcnt vmcnt(13)
  s_barrier
  s_add_u32 s39, s37, 0
  s_sub_u32 s40, s39, 10
  s_cmp_ge_u32 s39, 10
  s_cselect_b32 s39, s40, s39
  s_mul_i32 s39, s39, 196608
  s_add_u32 s39, s39, s44
  s_add_u32 m0, s45, 0
  s_nop 0
  buffer_load_dwordx4 v12, s[12:15], s39 offen lds
  s_add_u32 m0, s45, 4096
  s_nop 0
  buffer_load_dwordx4 v13, s[12:15], s39 offen lds
  s_add_u32 m0, s45, 8192
  s_nop 0
  buffer_load_dwordx4 v14, s[12:15], s39 offen lds
  s_waitcnt vmcnt(9)
  s_barrier
  s_add_u32 s39, s37, 1
  s_sub_u32 s40, s39, 10
  s_cmp_ge_u32 s39, 10
  s_cselect_b32 s39, s40, s39
  s_mul_i32 s39, s39, 196608
  s_add_u32 s39, s39, s44
  s_add_u32 m0, s45, 12288
  s_nop 0
  buffer_load_dwordx4 v12, s[12:15], s39 offen lds
  s_add_u32 m0, s45, 16384
  s_nop 0
  buffer_load_dwordx4 v13, s[12:15], s39 offen lds
  s_add_u32 m0, s45, 20480
  s_nop 0
  buffer_load_dwordx4 v14, s[12:15], s39 offen lds
  s_waitcnt vmcnt(9)
  s_barrier
  s_add_u32 s39, s37, 2
  s_sub_u32 s40, s39, 10
  s_cmp_ge_u32 s39, 10
  s_cselect_b32 s39, s40, s39
  s_mul_i32 s39, s39, 196608
  s_add_u32 s39, s39, s44
  s_add_u32 m0, s45, 24576
  s_nop 0
  buffer_load_dwordx4 v12, s[12:15], s39 offen lds
  s_add_u32 m0, s45, 28672
  s_nop 0
  buffer_load_dwordx4 v13, s[12:15], s39 offen lds
  s_add_u32 m0, s45, 32768
  s_nop 0
  buffer_load_dwordx4 v14, s[12:15], s39 offen lds
  s_waitcnt vmcnt(9)
  s_barrier
  s_add_u32 s39, s37, 3
  s_sub_u32 s40, s39, 10
  s_cmp_ge_u32 s39, 10
  s_cselect_b32 s39, s40, s39
  s_mul_i32 s39, s39, 196608
  s_add_u32 s39, s39, s44
  s_add_u32 m0, s45, 36864
  s_nop 0
  buffer_load_dwordx4 v12, s[12:15], s39 offen lds
  s_add_u32 m0, s45, 40960
  s_nop 0
  buffer_load_dwordx4 v13, s[12:15], s39 offen lds
  s_add_u32 m0, s45, 45056
  s_nop 0
  buffer_load_dwordx4 v14, s[12:15], s39 offen lds
  s_waitcnt vmcnt(9)
  s_barrier
  s_add_u32 s39, s37, 4
  s_sub_u32 s40, s39, 10
  s_cmp_ge_u32 s39, 10
  s_cselect_b32 s39, s40, s39
  s_mul_i32 s39, s39, 196608
  s_add_u32 s39, s39, s44
  s_add_u32 m0, s45, 49152
  s_nop 0
  buffer_load_dwordx4 v12, s[12:15], s39 offen lds
  s_add_u32 m0, s45, 53248
  s_nop 0
  buffer_load_dwordx4 v13, s[12:15], s39 offen lds
  s_add_u32 m0, s45, 57344
  s_nop 0
  buffer_load_dwordx4 v14, s[12:15], s39 offen lds
  s_waitcnt vmcnt(9)
  s_barrier
  s_add_u32 s39, s37, 5
  s_sub_u32 s40, s39, 10
  s_cmp_ge_u32 s39, 10
  s_cselect_b32 s39, s40, s39
  s_mul_i32 s39, s39, 196608
  s_add_u32 s39, s39, s44
  s_add_u32 m0, s45, 0
  s_nop 0
  buffer_load_dwordx4 v12, s[12:15], s39 offen lds
  s_add_u32 m0, s45, 4096
  s_nop 0
  buffer_load_dwordx4 v13, s[12:15], s39 offen lds
  s_add_u32 m0, s45, 8192
  s_nop 0
  buffer_load_dwordx4 v14, s[12:15], s39 offen lds
  s_waitcnt vmcnt(9)
  s_barrier
  s_add_u32 s39, s37, 6
  s_sub_u32 s40, s39, 10
  s_cmp_ge_u32 s39, 10
  s_cselect_b32 s39, s40, s39
  s_mul_i32 s39, s39, 196608
  s_add_u32 s39, s39, s44
  s_add_u32 m0, s45, 12288
  s_nop 0
  buffer_load_dwordx4 v12, s[12:15], s39 offen lds
  s_add_u32 m0, s45, 16384
  s_nop 0
  buffer_load_dwordx4 v13, s[12:15], s39 offen lds
  s_add_u32 m0, s45, 20480
  s_nop 0
  buffer_load_dwordx4 v14, s[12:15], s39 offen lds
  s_waitcnt vmcnt(9)
  s_barrier
  v_mul_u32_u24 v5, 6554, v1
  v_lshrrev_b32 v5, 16, v5
  v_mul_u32_u24 v4, 10, v5
  v_sub_u32 v4, v1, v4
  v_lshlrev_b32 v4, 4, v4
  v_mul_u32_u24 v30, 1280, v5
  v_add_u32 v4, v4, v30
  s_mov_b32 s20, s58
  s_and_b32 s21, s59, 0xffff
  s_mov_b32 s22, 2621440
  s_mov_b32 s23, 0x20000
  s_mov_b32 s24, s60
  s_and_b32 s25, s61, 0xffff
  s_mov_b32 s26, 2621440
  s_mov_b32 s27, 0x20000
  s_mov_b32 exec_lo, 0xffffffff
  s_mov_b32 exec_hi, 0xfffffff
  s_lshl_b32 s40, s32, 6
  s_mul_i32 s41, s55, 6
  s_add_u32 s40, s40, s41
  s_mul_i32 s46, s40, 1280
  s_mul_i32 s41, s33, 160
  s_add_u32 s46, s46, s41
  s_mul_i32 s78, s55, 960
  s_add_u32 s78, s78, 61440
  v_mov_b32 v30, v4
  s_sub_u32 s79, s46, 3840
  s_cmp_eq_u32 s40, 0
  s_cbranch_scc0 K1_NONNEG
  v_subrev_u32 v30, 3840, v4
  v_cmp_gt_u32 vcc, 3, v5
  v_mov_b32 v31, 0x80000000
  s_nop 0
  v_cndmask_b32 v30, v30, v31, vcc
  s_mov_b32 s79, s46
K1_NONNEG:
  s_add_u32 m0, s78, 0
  s_nop 0
  buffer_load_dwordx4 v30, s[20:23], s79 offen lds
  s_add_u32 m0, s78, 11520
  s_nop 0
  buffer_load_dwordx4 v4, s[24:27], s46 offen lds
  s_add_u32 s46, s46, 30720
  s_sub_u32 s79, s46, 3840
  s_add_u32 m0, s78, 3840
  s_nop 0
  buffer_load_dwordx4 v4, s[20:23], s79 offen lds
  s_add_u32 m0, s78, 15360
  s_nop 0
  buffer_load_dwordx4 v4, s[24:27], s46 offen lds
  s_add_u32 s46, s46, 30720
  s_sub_u32 s79, s46, 3840
  s_add_u32 m0, s78, 7680
  s_nop 0
  buffer_load_dwordx4 v4, s[20:23], s79 offen lds
  s_add_u32 m0, s78, 19200
  s_nop 0
  buffer_load_dwordx4 v4, s[24:27], s46 offen lds
  s_add_u32 s46, s46, 30720
  s_sub_u32 s79, s46, 3840
  s_mov_b64 exec, s[52:53]
  s_add_u32 s39, s37, 7
  s_sub_u32 s40, s39, 10
  s_cmp_ge_u32 s39, 10
  s_cselect_b32 s39, s40, s39
  s_mul_i32 s39, s39, 196608
  s_add_u32 s39, s39, s44
  s_add_u32 m0, s45, 24576
  s_nop 0
  buffer_load_dwordx4 v12, s[12:15], s39 offen lds
  s_add_u32 m0, s45, 28672
  s_nop 0
  buffer_load_dwordx4 v13, s[12:15], s39 offen lds
  s_add_u32 m0, s45, 32768
  s_nop 0
  buffer_load_dwordx4 v14, s[12:15], s39 offen lds
  s_waitcnt vmcnt(15)
  s_barrier
  s_add_u32 s39, s37, 8
  s_sub_u32 s40, s39, 10
  s_cmp_ge_u32 s39, 10
  s_cselect_b32 s39, s40, s39
  s_mul_i32 s39, s39, 196608
  s_add_u32 s39, s39, s44
  s_add_u32 m0, s45, 36864
  s_nop 0
  buffer_load_dwordx4 v12, s[12:15], s39 offen lds
  s_add_u32 m0, s45, 40960
  s_nop 0
  buffer_load_dwordx4 v13, s[12:15], s39 offen lds
  s_add_u32 m0, s45, 45056
  s_nop 0
  buffer_load_dwordx4 v14, s[12:15], s39 offen lds
  s_waitcnt vmcnt(15)
  s_barrier
  s_add_u32 s39, s37, 9
  s_sub_u32 s40, s39, 10
  s_cmp_ge_u32 s39, 10
  s_cselect_b32 s39, s40, s39
  s_mul_i32 s39, s39, 196608
  s_add_u32 s39, s39, s44
  s_add_u32 m0, s45, 49152
  s_nop 0
  buffer_load_dwordx4 v12, s[12:15], s39 offen lds
  s_add_u32 m0, s45, 53248
  s_nop 0
  buffer_load_dwordx4 v13, s[12:15], s39 offen lds
  s_add_u32 m0, s45, 57344
  s_nop 0
  buffer_load_dwordx4 v14, s[12:15], s39 offen lds
  v_lshlrev_b32 v30, 6, v1
  s_and_b32 s40, s2, 7
  s_lshl_b32 s40, s40, 8
  s_lshr_b32 s41, s2, 3
  s_lshl_b32 s41, s41, 3
  s_add_u32 s40, s40, s41
  s_lshl_b32 s41, s55, 1
  s_add_u32 s40, s40, s41
  s_lshl_b32 s40, s40, 12
  s_mov_b32 s20, s74
  s_and_b32 s21, s75, 0xffff
  s_mov_b32 s22, 8388608
  s_mov_b32 s23, 0x20000
  buffer_load_dword v31, v30, s[20:23], s40 offen
  s_add_u32 s40, s40, 4096
  buffer_load_dword v32, v30, s[20:23], s40 offen
  s_add_u32 s40, s40, 4096
  s_mov_b32 s24, s76
  s_and_b32 s25, s77, 0xffff
  s_mov_b32 s26, 2621440
  s_mov_b32 s27, 0x20000
  s_mul_i32 s40, s2, 3
  s_add_u32 s40, s40, s55
  s_lshl_b32 s40, s40, 12
  s_cmp_eq_u32 s55, 3
  s_cselect_b32 s40, 0x80000000, s40
  buffer_load_dword v35, v30, s[24:27], s40 offen
  s_waitcnt vmcnt(18)
  s_barrier
  s_waitcnt vmcnt(9)
  s_barrier
  s_waitcnt vmcnt(6)
  s_barrier
  s_waitcnt vmcnt(3)
  s_barrier
  s_barrier
  s_barrier
  s_endpgm
K1_AB:
  v_lshrrev_b32 v17, 1, v3
  v_xor_b32 v17, v17, v2
  v_lshlrev_b32 v17, 4, v17
  v_lshlrev_b32 v18, 7, v3
  v_add_u32 v17, v17, v18
  v_xor_b32 v18, 64, v17
  s_lshl_b32 s40, s35, 12
  s_lshl_b32 s41, s36, 11
  s_add_u32 s42, s40, s41
  s_add_u32 s42, s42, 61440
  v_add_u32 v4, s42, v17
  v_add_u32 v5, s42, v18
  s_xor_b32 s41, s41, 2048
  s_add_u32 s42, s40, s41
  s_add_u32 s42, s42, 61440
  v_add_u32 v6, s42, v17
  v_add_u32 v7, s42, v18
  v_lshrrev_b32 v17, 2, v1
  v_and_b32 v17, 3, v17
  v_lshlrev_b32 v18, 3, v2
  v_add_u32 v17, v17, v18
  v_mul_u32_u24 v17, 192, v17
  v_and_b32 v18, 3, v1
  v_lshlrev_b32 v18, 3, v18
  v_add_u32 v17, v17, v18
  v_and_b32 v19, 1, v2
  s_mul_i32 s40, s36, 3
  s_add_u32 s41, s40, 0
  v_xor_b32 v18, s41, v19
  v_lshlrev_b32 v18, 5, v18
  v_add_u32 v8, v17, v18
  s_add_u32 s41, s40, 1
  v_xor_b32 v18, s41, v19
  v_lshlrev_b32 v18, 5, v18
  v_add_u32 v9, v17, v18
  s_add_u32 s41, s40, 2
  v_xor_b32 v18, s41, v19
  v_lshlrev_b32 v18, 5, v18
  v_add_u32 v10, v17, v18
  s_mov_b32 s48, 0xbdd2d3e8
  s_mov_b32 s49, 0xbdd2d3e8
  s_mov_b32 s50, 1.0
  s_mov_b32 s51, 1.0
  s_waitcnt lgkmcnt(0)
  s_mov_b32 s16, s70
  s_and_b32 s17, s71, 0xffff
  s_mov_b32 s18, 18874368
  s_mov_b32 s19, 0x20000
  s_mov_b32 s4, s68
  s_and_b32 s5, s69, 0xffff
  s_mov_b32 s6, 256
  s_mov_b32 s7, 0x20000
  s_cmp_ge_u32 s34, 4
  s_cbranch_scc1 K1_B
  v_mov_b32 v102, 0x3f803f80
  v_mov_b32 v103, 0x3f803f80
  v_mov_b32 v104, 0x3f803f80
  v_mov_b32 v105, 0x3f803f80
  v_mov_b32 v66, 0
  v_mov_b32 v67, 0
  v_mov_b32 v68, 0
  v_mov_b32 v69, 0
  v_mov_b32 v70, 0
  v_mov_b32 v71, 0
  v_mov_b32 v72, 0
  v_mov_b32 v73, 0
  v_mov_b32 v74, 0
  v_mov_b32 v75, 0
  v_mov_b32 v76, 0
  v_mov_b32 v77, 0
  v_mov_b32 v78, 0
  v_mov_b32 v79, 0
  v_mov_b32 v80, 0
  v_mov_b32 v81, 0
  v_mov_b32 v82, 0
  v_mov_b32 v83, 0
  v_mov_b32 v84, 0
  v_mov_b32 v85, 0
  v_mov_b32 v86, 0
  v_mov_b32 v87, 0
  v_mov_b32 v88, 0
  v_mov_b32 v89, 0
  v_mov_b32 v90, 0
  v_mov_b32 v91, 0
  v_mov_b32 v92, 0
  v_mov_b32 v93, 0
  v_mov_b32 v94, 0
  v_mov_b32 v95, 0
  v_mov_b32 v96, 0
  v_mov_b32 v97, 0
  v_mov_b32 v98, 0
  v_mov_b32 v99, 0
  v_mov_b32 v100, 0
  v_mov_b32 v101, 0
  v_mov_b32 v106, 0
  v_mov_b32 v107, 0
  v_mov_b32 v108, 0
  v_mov_b32 v109, 0
  v_mov_b32 v110, 0
  v_mov_b32 v111, 0
  v_mov_b32 v112, 0
  v_mov_b32 v113, 0
  s_barrier
  s_mov_b32 s37, 0
  ds_read_b128 v[26:29], v4 offset:0
  ds_read_b64_tr_b16 v[42:43], v8 offset:0
  ds_read_b64_tr_b16 v[44:45], v8 offset:768
  ds_read_b128 v[30:33], v6 offset:0
  ds_read_b64_tr_b16 v[46:47], v9 offset:0
  ds_read_b64_tr_b16 v[48:49], v9 offset:768
  ds_read_b64_tr_b16 v[50:51], v10 offset:0
  ds_read_b64_tr_b16 v[52:53], v10 offset:768
K1_LOOP1:
  s_waitcnt lgkmcnt(0)
  v_mfma_f32_16x16x32_bf16 v[66:69], v[26:29], v[42:45], v[66:69]
  ds_read_b128 v[34:37], v5 offset:0
  ds_read_b64_tr_b16 v[54:55], v8 offset:6144
  v_mfma_f32_16x16x32_bf16 v[78:81], v[30:33], v[42:45], v[78:81]
  ds_read_b64_tr_b16 v[56:57], v8 offset:6912
  ds_read_b128 v[38:41], v7 offset:0
  v_mfma_f32_16x16x32_bf16 v[70:73], v[26:29], v[46:49], v[70:73]
  ds_read_b64_tr_b16 v[58:59], v9 offset:6144
  ds_read_b64_tr_b16 v[60:61], v9 offset:6912
  v_mfma_f32_16x16x32_bf16 v[82:85], v[30:33], v[46:49], v[82:85]
  ds_read_b64_tr_b16 v[62:63], v10 offset:6144
  ds_read_b64_tr_b16 v[64:65], v10 offset:6912
  v_mfma_f32_16x16x32_bf16 v[74:77], v[26:29], v[50:53], v[74:77]
  v_mfma_f32_16x16x32_bf16 v[86:89], v[30:33], v[50:53], v[86:89]
  v_mfma_f32_16x16x32_bf16 v[106:109], v[102:105], v[26:29], v[106:109]
  v_mfma_f32_16x16x32_bf16 v[110:113], v[26:29], v[26:29], v[110:113]
  s_cmp_eq_u32 s35, 0
  s_cbranch_scc0 K1_SK_1a0
  v_mfma_f32_16x16x32_bf16 v[90:93], v[102:105], v[42:45], v[90:93]
  v_mfma_f32_16x16x32_bf16 v[94:97], v[102:105], v[46:49], v[94:97]
  v_mfma_f32_16x16x32_bf16 v[98:101], v[102:105], v[50:53], v[98:101]
K1_SK_1a0:
  s_waitcnt lgkmcnt(0)
  s_barrier
  v_mfma_f32_16x16x32_bf16 v[66:69], v[34:37], v[54:57], v[66:69]
  ds_read_b128 v[26:29], v4 offset:8192
  ds_read_b64_tr_b16 v[42:43], v8 offset:12288
  v_mfma_f32_16x16x32_bf16 v[78:81], v[38:41], v[54:57], v[78:81]
  ds_read_b64_tr_b16 v[44:45], v8 offset:13056
  ds_read_b128 v[30:33], v6 offset:8192
  v_mfma_f32_16x16x32_bf16 v[70:73], v[34:37], v[58:61], v[70:73]
  ds_read_b64_tr_b16 v[46:47], v9 offset:12288
  ds_read_b64_tr_b16 v[48:49], v9 offset:13056
  v_mfma_f32_16x16x32_bf16 v[82:85], v[38:41], v[58:61], v[82:85]
  ds_read_b64_tr_b16 v[50:51], v10 offset:12288
  ds_read_b64_tr_b16 v[52:53], v10 offset:13056
  v_mfma_f32_16x16x32_bf16 v[74:77], v[34:37], v[62:65], v[74:77]
  v_mfma_f32_16x16x32_bf16 v[86:89], v[38:41], v[62:65], v[86:89]
  v_mfma_f32_16x16x32_bf16 v[106:109], v[102:105], v[34:37], v[106:109]
  v_mfma_f32_16x16x32_bf16 v[110:113], v[34:37], v[34:37], v[110:113]
  s_cmp_eq_u32 s35, 1
  s_cbranch_scc0 K1_SK_1b0
  v_mfma_f32_16x16x32_bf16 v[90:93], v[102:105], v[54:57], v[90:93]
  v_mfma_f32_16x16x32_bf16 v[94:97], v[102:105], v[58:61], v[94:97]
  v_mfma_f32_16x16x32_bf16 v[98:101], v[102:105], v[62:65], v[98:101]
K1_SK_1b0:
  s_waitcnt lgkmcnt(0)
  v_mfma_f32_16x16x32_bf16 v[66:69], v[26:29], v[42:45], v[66:69]
  ds_read_b128 v[34:37], v5 offset:8192
  ds_read_b64_tr_b16 v[54:55], v8 offset:18432
  v_mfma_f32_16x16x32_bf16 v[78:81], v[30:33], v[42:45], v[78:81]
  ds_read_b64_tr_b16 v[56:57], v8 offset:19200
  ds_read_b128 v[38:41], v7 offset:8192
  v_mfma_f32_16x16x32_bf16 v[70:73], v[26:29], v[46:49], v[70:73]
  ds_read_b64_tr_b16 v[58:59], v9 offset:18432
  ds_read_b64_tr_b16 v[60:61], v9 offset:19200
  v_mfma_f32_16x16x32_bf16 v[82:85], v[30:33], v[46:49], v[82:85]
  ds_read_b64_tr_b16 v[62:63], v10 offset:18432
  ds_read_b64_tr_b16 v[64:65], v10 offset:19200
  v_mfma_f32_16x16x32_bf16 v[74:77], v[26:29], v[50:53], v[74:77]
  v_mfma_f32_16x16x32_bf16 v[86:89], v[30:33], v[50:53], v[86:89]
  v_mfma_f32_16x16x32_bf16 v[106:109], v[102:105], v[26:29], v[106:109]
  v_mfma_f32_16x16x32_bf16 v[110:113], v[26:29], v[26:29], v[110:113]
  s_cmp_eq_u32 s35, 0
  s_cbranch_scc0 K1_SK_1a1
  v_mfma_f32_16x16x32_bf16 v[90:93], v[102:105], v[42:45], v[90:93]
  v_mfma_f32_16x16x32_bf16 v[94:97], v[102:105], v[46:49], v[94:97]
  v_mfma_f32_16x16x32_bf16 v[98:101], v[102:105], v[50:53], v[98:101]
K1_SK_1a1:
  s_waitcnt lgkmcnt(0)
  s_barrier
  v_mfma_f32_16x16x32_bf16 v[66:69], v[34:37], v[54:57], v[66:69]
  ds_read_b128 v[26:29], v4 offset:16384
  ds_read_b64_tr_b16 v[42:43], v8 offset:24576
  v_mfma_f32_16x16x32_bf16 v[78:81], v[38:41], v[54:57], v[78:81]
  ds_read_b64_tr_b16 v[44:45], v8 offset:25344
  ds_read_b128 v[30:33], v6 offset:16384
  v_mfma_f32_16x16x32_bf16 v[70:73], v[34:37], v[58:61], v[70:73]
  ds_read_b64_tr_b16 v[46:47], v9 offset:24576
  ds_read_b64_tr_b16 v[48:49], v9 offset:25344
  v_mfma_f32_16x16x32_bf16 v[82:85], v[38:41], v[58:61], v[82:85]
  ds_read_b64_tr_b16 v[50:51], v10 offset:24576
  ds_read_b64_tr_b16 v[52:53], v10 offset:25344
  v_mfma_f32_16x16x32_bf16 v[74:77], v[34:37], v[62:65], v[74:77]
  v_mfma_f32_16x16x32_bf16 v[86:89], v[38:41], v[62:65], v[86:89]
  v_mfma_f32_16x16x32_bf16 v[106:109], v[102:105], v[34:37], v[106:109]
  v_mfma_f32_16x16x32_bf16 v[110:113], v[34:37], v[34:37], v[110:113]
  s_cmp_eq_u32 s35, 1
  s_cbranch_scc0 K1_SK_1b1
  v_mfma_f32_16x16x32_bf16 v[90:93], v[102:105], v[54:57], v[90:93]
  v_mfma_f32_16x16x32_bf16 v[94:97], v[102:105], v[58:61], v[94:97]
  v_mfma_f32_16x16x32_bf16 v[98:101], v[102:105], v[62:65], v[98:101]
K1_SK_1b1:
  s_waitcnt lgkmcnt(0)
  v_mfma_f32_16x16x32_bf16 v[66:69], v[26:29], v[42:45], v[66:69]
  ds_read_b128 v[34:37], v5 offset:16384
  ds_read_b64_tr_b16 v[54:55], v8 offset:30720
  v_mfma_f32_16x16x32_bf16 v[78:81], v[30:33], v[42:45], v[78:81]
  ds_read_b64_tr_b16 v[56:57], v8 offset:31488
  ds_read_b128 v[38:41], v7 offset:16384
  v_mfma_f32_16x16x32_bf16 v[70:73], v[26:29], v[46:49], v[70:73]
  ds_read_b64_tr_b16 v[58:59], v9 offset:30720
  ds_read_b64_tr_b16 v[60:61], v9 offset:31488
  v_mfma_f32_16x16x32_bf16 v[82:85], v[30:33], v[46:49], v[82:85]
  ds_read_b64_tr_b16 v[62:63], v10 offset:30720
  ds_read_b64_tr_b16 v[64:65], v10 offset:31488
  v_mfma_f32_16x16x32_bf16 v[74:77], v[26:29], v[50:53], v[74:77]
  v_mfma_f32_16x16x32_bf16 v[86:89], v[30:33], v[50:53], v[86:89]
  v_mfma_f32_16x16x32_bf16 v[106:109], v[102:105], v[26:29], v[106:109]
  v_mfma_f32_16x16x32_bf16 v[110:113], v[26:29], v[26:29], v[110:113]
  s_cmp_eq_u32 s35, 0
  s_cbranch_scc0 K1_SK_1a2
  v_mfma_f32_16x16x32_bf16 v[90:93], v[102:105], v[42:45], v[90:93]
  v_mfma_f32_16x16x32_bf16 v[94:97], v[102:105], v[46:49], v[94:97]
  v_mfma_f32_16x16x32_bf16 v[98:101], v[102:105], v[50:53], v[98:101]
K1_SK_1a2:
  s_waitcnt lgkmcnt(0)
  s_barrier
  v_mfma_f32_16x16x32_bf16 v[66:69], v[34:37], v[54:57], v[66:69]
  ds_read_b128 v[26:29], v4 offset:24576
  ds_read_b64_tr_b16 v[42:43], v8 offset:36864
  v_mfma_f32_16x16x32_bf16 v[78:81], v[38:41], v[54:57], v[78:81]
  ds_read_b64_tr_b16 v[44:45], v8 offset:37632
  ds_read_b128 v[30:33], v6 offset:24576
  v_mfma_f32_16x16x32_bf16 v[70:73], v[34:37], v[58:61], v[70:73]
  ds_read_b64_tr_b16 v[46:47], v9 offset:36864
  ds_read_b64_tr_b16 v[48:49], v9 offset:37632
  v_mfma_f32_16x16x32_bf16 v[82:85], v[38:41], v[58:61], v[82:85]
  ds_read_b64_tr_b16 v[50:51], v10 offset:36864
  ds_read_b64_tr_b16 v[52:53], v10 offset:37632
  v_mfma_f32_16x16x32_bf16 v[74:77], v[34:37], v[62:65], v[74:77]
  v_mfma_f32_16x16x32_bf16 v[86:89], v[38:41], v[62:65], v[86:89]
  v_mfma_f32_16x16x32_bf16 v[106:109], v[102:105], v[34:37], v[106:109]
  v_mfma_f32_16x16x32_bf16 v[110:113], v[34:37], v[34:37], v[110:113]
  s_cmp_eq_u32 s35, 1
  s_cbranch_scc0 K1_SK_1b2
  v_mfma_f32_16x16x32_bf16 v[90:93], v[102:105], v[54:57], v[90:93]
  v_mfma_f32_16x16x32_bf16 v[94:97], v[102:105], v[58:61], v[94:97]
  v_mfma_f32_16x16x32_bf16 v[98:101], v[102:105], v[62:65], v[98:101]
K1_SK_1b2:
  s_waitcnt lgkmcnt(0)
  v_mfma_f32_16x16x32_bf16 v[66:69], v[26:29], v[42:45], v[66:69]
  ds_read_b128 v[34:37], v5 offset:24576
  ds_read_b64_tr_b16 v[54:55], v8 offset:43008
  v_mfma_f32_16x16x32_bf16 v[78:81], v[30:33], v[42:45], v[78:81]
  ds_read_b64_tr_b16 v[56:57], v8 offset:43776
  ds_read_b128 v[38:41], v7 offset:24576
  v_mfma_f32_16x16x32_bf16 v[70:73], v[26:29], v[46:49], v[70:73]
  ds_read_b64_tr_b16 v[58:59], v9 offset:43008
  ds_read_b64_tr_b16 v[60:61], v9 offset:43776
  v_mfma_f32_16x16x32_bf16 v[82:85], v[30:33], v[46:49], v[82:85]
  ds_read_b64_tr_b16 v[62:63], v10 offset:43008
  ds_read_b64_tr_b16 v[64:65], v10 offset:43776
  v_mfma_f32_16x16x32_bf16 v[74:77], v[26:29], v[50:53], v[74:77]
  v_mfma_f32_16x16x32_bf16 v[86:89], v[30:33], v[50:53], v[86:89]
  v_mfma_f32_16x16x32_bf16 v[106:109], v[102:105], v[26:29], v[106:109]
  v_mfma_f32_16x16x32_bf16 v[110:113], v[26:29], v[26:29], v[110:113]
  s_cmp_eq_u32 s35, 0
  s_cbranch_scc0 K1_SK_1a3
  v_mfma_f32_16x16x32_bf16 v[90:93], v[102:105], v[42:45], v[90:93]
  v_mfma_f32_16x16x32_bf16 v[94:97], v[102:105], v[46:49], v[94:97]
  v_mfma_f32_16x16x32_bf16 v[98:101], v[102:105], v[50:53], v[98:101]
K1_SK_1a3:
  s_waitcnt lgkmcnt(0)
  s_barrier
  v_mfma_f32_16x16x32_bf16 v[66:69], v[34:37], v[54:57], v[66:69]
  ds_read_b128 v[26:29], v4 offset:32768
  ds_read_b64_tr_b16 v[42:43], v8 offset:49152
  v_mfma_f32_16x16x32_bf16 v[78:81], v[38:41], v[54:57], v[78:81]
  ds_read_b64_tr_b16 v[44:45], v8 offset:49920
  ds_read_b128 v[30:33], v6 offset:32768
  v_mfma_f32_16x16x32_bf16 v[70:73], v[34:37], v[58:61], v[70:73]
  ds_read_b64_tr_b16 v[46:47], v9 offset:49152
  ds_read_b64_tr_b16 v[48:49], v9 offset:49920
  v_mfma_f32_16x16x32_bf16 v[82:85], v[38:41], v[58:61], v[82:85]
  ds_read_b64_tr_b16 v[50:51], v10 offset:49152
  ds_read_b64_tr_b16 v[52:53], v10 offset:49920
  v_mfma_f32_16x16x32_bf16 v[74:77], v[34:37], v[62:65], v[74:77]
  v_mfma_f32_16x16x32_bf16 v[86:89], v[38:41], v[62:65], v[86:89]
  v_mfma_f32_16x16x32_bf16 v[106:109], v[102:105], v[34:37], v[106:109]
  v_mfma_f32_16x16x32_bf16 v[110:113], v[34:37], v[34:37], v[110:113]
  s_cmp_eq_u32 s35, 1
  s_cbranch_scc0 K1_SK_1b3
  v_mfma_f32_16x16x32_bf16 v[90:93], v[102:105], v[54:57], v[90:93]
  v_mfma_f32_16x16x32_bf16 v[94:97], v[102:105], v[58:61], v[94:97]
  v_mfma_f32_16x16x32_bf16 v[98:101], v[102:105], v[62:65], v[98:101]
K1_SK_1b3:
  s_waitcnt lgkmcnt(0)
  v_mfma_f32_16x16x32_bf16 v[66:69], v[26:29], v[42:45], v[66:69]
  ds_read_b128 v[34:37], v5 offset:32768
  ds_read_b64_tr_b16 v[54:55], v8 offset:55296
  v_mfma_f32_16x16x32_bf16 v[78:81], v[30:33], v[42:45], v[78:81]
  ds_read_b64_tr_b16 v[56:57], v8 offset:56064
  ds_read_b128 v[38:41], v7 offset:32768
  v_mfma_f32_16x16x32_bf16 v[70:73], v[26:29], v[46:49], v[70:73]
  ds_read_b64_tr_b16 v[58:59], v9 offset:55296
  ds_read_b64_tr_b16 v[60:61], v9 offset:56064
  v_mfma_f32_16x16x32_bf16 v[82:85], v[30:33], v[46:49], v[82:85]
  ds_read_b64_tr_b16 v[62:63], v10 offset:55296
  ds_read_b64_tr_b16 v[64:65], v10 offset:56064
  v_mfma_f32_16x16x32_bf16 v[74:77], v[26:29], v[50:53], v[74:77]
  v_mfma_f32_16x16x32_bf16 v[86:89], v[30:33], v[50:53], v[86:89]
  v_mfma_f32_16x16x32_bf16 v[106:109], v[102:105], v[26:29], v[106:109]
  v_mfma_f32_16x16x32_bf16 v[110:113], v[26:29], v[26:29], v[110:113]
  s_cmp_eq_u32 s35, 0
  s_cbranch_scc0 K1_SK_1a4
  v_mfma_f32_16x16x32_bf16 v[90:93], v[102:105], v[42:45], v[90:93]
  v_mfma_f32_16x16x32_bf16 v[94:97], v[102:105], v[46:49], v[94:97]
  v_mfma_f32_16x16x32_bf16 v[98:101], v[102:105], v[50:53], v[98:101]
K1_SK_1a4:
  s_waitcnt lgkmcnt(0)
  s_barrier
  v_add_u32 v4, 40960, v4
  v_add_u32 v5, 40960, v5
  v_add_u32 v6, 40960, v6
  v_add_u32 v7, 40960, v7
  v_mfma_f32_16x16x32_bf16 v[66:69], v[34:37], v[54:57], v[66:69]
  ds_read_b128 v[26:29], v4 offset:0
  ds_read_b64_tr_b16 v[42:43], v8 offset:0
  v_mfma_f32_16x16x32_bf16 v[78:81], v[38:41], v[54:57], v[78:81]
  ds_read_b64_tr_b16 v[44:45], v8 offset:768
  ds_read_b128 v[30:33], v6 offset:0
  v_mfma_f32_16x16x32_bf16 v[70:73], v[34:37], v[58:61], v[70:73]
  ds_read_b64_tr_b16 v[46:47], v9 offset:0
  ds_read_b64_tr_b16 v[48:49], v9 offset:768
  v_mfma_f32_16x16x32_bf16 v[82:85], v[38:41], v[58:61], v[82:85]
  ds_read_b64_tr_b16 v[50:51], v10 offset:0
  ds_read_b64_tr_b16 v[52:53], v10 offset:768
  v_mfma_f32_16x16x32_bf16 v[74:77], v[34:37], v[62:65], v[74:77]
  v_mfma_f32_16x16x32_bf16 v[86:89], v[38:41], v[62:65], v[86:89]
  v_mfma_f32_16x16x32_bf16 v[106:109], v[102:105], v[34:37], v[106:109]
  v_mfma_f32_16x16x32_bf16 v[110:113], v[34:37], v[34:37], v[110:113]
  s_cmp_eq_u32 s35, 1
  s_cbranch_scc0 K1_SK_1b4
  v_mfma_f32_16x16x32_bf16 v[90:93], v[102:105], v[54:57], v[90:93]
  v_mfma_f32_16x16x32_bf16 v[94:97], v[102:105], v[58:61], v[94:97]
  v_mfma_f32_16x16x32_bf16 v[98:101], v[102:105], v[62:65], v[98:101]
K1_SK_1b4:
  s_add_u32 s37, s37, 1
  s_cmp_lt_u32 s37, 2
  s_cbranch_scc1 K1_LOOP1
  s_setprio 2
  s_lshl_b32 s40, s32, 2
  v_mov_b32 v22, s40
  buffer_load_dword v23, v22, s[4:7], 0 offen sc1
  s_mov_b32 s28, s62
  s_and_b32 s29, s63, 0xffff
  s_mov_b32 s30, 5120
  s_mov_b32 s31, 0x20000
  v_lshlrev_b32 v17, 4, v1
  s_mul_i32 s41, s33, 640
  buffer_load_dwordx4 v[160:163], v17, s[28:31], s41 offen
  v_and_b32 v14, 3, v3
  v_cmp_eq_u32 vcc, 1, v14
  s_nop 1
  v_cndmask_b32 v110, v110, v111, vcc
  v_cmp_eq_u32 vcc, 2, v14
  s_nop 1
  v_cndmask_b32 v110, v110, v112, vcc
  v_cmp_eq_u32 vcc, 3, v14
  s_nop 1
  v_cndmask_b32 v110, v110, v113, vcc
  v_mul_f32 v16, 0x3acccccd, v106
  v_mul_f32 v18, 0x3acccccd, v110
  v_fma_f32 v18, -v16, v16, v18
  v_max_f32 v18, 0, v18
  v_cvt_pk_bf16_f32 v16, v16, v16
  v_lshlrev_b32 v16, 16, v16
  v_cvt_pk_bf16_f32 v18, v18, v18
  v_lshlrev_b32 v18, 16, v18
  v_add_f32 v18, 0x3727c5ac, v18
  v_cvt_pk_bf16_f32 v18, v18, v18
  v_lshlrev_b32 v18, 16, v18
  v_sqrt_f32 v18, v18
  s_nop 0
  v_cvt_pk_bf16_f32 v18, v18, v18
  v_lshlrev_b32 v18, 16, v18
  v_rcp_f32 v17, v18
  s_lshl_b32 s40, s35, 5
  s_lshl_b32 s41, s36, 4
  s_add_u32 s40, s40, s41
  v_add_u32 v18, s40, v3
  v_lshlrev_b32 v19, 2, v18
  v_add_u32 v19, 143360, v19
  s_mov_b32 exec_lo, 0xf0000f
  s_mov_b32 exec_hi, 0xf0000f00
  ds_write_b32 v19, v16
  ds_write_b32 v19, v17 offset:256
  s_cmp_eq_u32 s33, 0
  s_cbranch_scc0 K1_NOST1X
  s_lshl_b32 s41, s32, 9
  s_add_u32 s41, s41, 16777216
  v_lshlrev_b32 v18, 3, v18
  buffer_store_dwordx2 v[16:17], v18, s[16:19], s41 offen
K1_NOST1X:
  s_mov_b64 exec, s[52:53]
  s_mul_i32 s40, s55, 192
  s_add_u32 s40, s40, 143872
  v_lshlrev_b32 v20, 2, v3
  v_add_u32 v20, s40, v20
  ds_write_b32 v20, v90 offset:0
  ds_write_b32 v20, v94 offset:64
  ds_write_b32 v20, v98 offset:128
  s_waitcnt lgkmcnt(0)
  s_barrier
  s_xor_b32 s41, s55, 2
  s_mul_i32 s41, s41, 192
  s_add_u32 s41, s41, 143872
  v_lshlrev_b32 v18, 2, v3
  v_add_u32 v18, s41, v18
  ds_read_b32 v136, v18 offset:0
  ds_read_b32 v138, v18 offset:64
  ds_read_b32 v140, v18 offset:128
  s_lshl_b32 s40, s35, 7
  s_lshl_b32 s41, s36, 6
  s_add_u32 s40, s40, s41
  s_add_u32 s40, s40, 143360
  v_lshlrev_b32 v19, 4, v2
  v_add_u32 v19, s40, v19
  v_xor_b32 v20, 64, v19
  ds_read_b128 v[26:29], v19
  ds_read_b128 v[30:33], v20
  ds_read_b128 v[34:37], v19 offset:256
  ds_read_b128 v[38:41], v20 offset:256
  v_mov_b32 v126, 0xc0135761
  v_mov_b32 v127, 0xc0135761
  v_mov_b32 v42, 0
  v_mov_b32 v43, 0
  v_mov_b32 v44, 0
  v_mov_b32 v45, 0
  v_mov_b32 v46, 0
  v_mov_b32 v47, 0
  v_mov_b32 v48, 0
  v_mov_b32 v49, 0
  v_mov_b32 v50, 0
  v_mov_b32 v51, 0
  v_mov_b32 v52, 0
  v_mov_b32 v53, 0
  v_mov_b32 v54, 0
  v_mov_b32 v55, 0
  v_mov_b32 v56, 0
  v_mov_b32 v57, 0
  s_waitcnt lgkmcnt(0)
  v_add_f32 v136, v136, v90
  v_sub_f32 v136, 0, v136
  v_add_f32 v138, v138, v94
  v_sub_f32 v138, 0, v138
  v_add_f32 v140, v140, v98
  v_sub_f32 v140, 0, v140
  v_fma_f32 v66, v26, v136, v66
  v_fma_f32 v67, v27, v136, v67
  v_mul_f32 v66, v66, v34
  v_mul_f32 v67, v67, v35
  v_mul_f32 v128, v66, v66
  v_mul_f32 v129, v67, v67
  v_fma_f32 v128, v128, s48, v126
  v_fma_f32 v129, v129, s48, v126
  v_mul_f32 v128, v128, v66
  v_mul_f32 v129, v129, v67
  v_exp_f32 v128, v128
  v_exp_f32 v129, v129
  v_add_f32 v128, 1.0, v128
  v_add_f32 v129, 1.0, v129
  v_rcp_f32 v128, v128
  v_rcp_f32 v129, v129
  v_mul_f32 v128, v128, v66
  v_mul_f32 v129, v129, v67
  v_cvt_pk_bf16_f32 v114, v128, v129
  v_add_f32 v42, v42, v128
  v_add_f32 v43, v43, v129
  v_fma_f32 v50, v128, v128, v50
  v_fma_f32 v51, v129, v129, v51
  v_fma_f32 v68, v28, v136, v68
  v_fma_f32 v69, v29, v136, v69
  v_mul_f32 v68, v68, v36
  v_mul_f32 v69, v69, v37
  v_mul_f32 v132, v68, v68
  v_mul_f32 v133, v69, v69
  v_fma_f32 v132, v132, s48, v126
  v_fma_f32 v133, v133, s48, v126
  v_mul_f32 v132, v132, v68
  v_mul_f32 v133, v133, v69
  v_exp_f32 v132, v132
  v_exp_f32 v133, v133
  v_add_f32 v132, 1.0, v132
  v_add_f32 v133, 1.0, v133
  v_rcp_f32 v132, v132
  v_rcp_f32 v133, v133
  v_mul_f32 v132, v132, v68
  v_mul_f32 v133, v133, v69
  v_cvt_pk_bf16_f32 v115, v132, v133
  v_add_f32 v44, v44, v132
  v_add_f32 v45, v45, v133
  v_fma_f32 v52, v132, v132, v52
  v_fma_f32 v53, v133, v133, v53
  s_barrier
  v_fma_f32 v78, v30, v136, v78
  v_fma_f32 v79, v31, v136, v79
  v_mul_f32 v78, v78, v38
  v_mul_f32 v79, v79, v39
  v_mul_f32 v128, v78, v78
  v_mul_f32 v129, v79, v79
  v_fma_f32 v128, v128, s48, v126
  v_fma_f32 v129, v129, s48, v126
  v_mul_f32 v128, v128, v78
  v_mul_f32 v129, v129, v79
  v_exp_f32 v128, v128
  v_exp_f32 v129, v129
  v_add_f32 v128, 1.0, v128
  v_add_f32 v129, 1.0, v129
  v_rcp_f32 v128, v128
  v_rcp_f32 v129, v129
  v_mul_f32 v128, v128, v78
  v_mul_f32 v129, v129, v79
  v_cvt_pk_bf16_f32 v116, v128, v129
  v_add_f32 v46, v46, v128
  v_add_f32 v47, v47, v129
  v_fma_f32 v54, v128, v128, v54
  v_fma_f32 v55, v129, v129, v55
  v_fma_f32 v80, v32, v136, v80
  v_fma_f32 v81, v33, v136, v81
  v_mul_f32 v80, v80, v40
  v_mul_f32 v81, v81, v41
  v_mul_f32 v132, v80, v80
  v_mul_f32 v133, v81, v81
  v_fma_f32 v132, v132, s48, v126
  v_fma_f32 v133, v133, s48, v126
  v_mul_f32 v132, v132, v80
  v_mul_f32 v133, v133, v81
  v_exp_f32 v132, v132
  v_exp_f32 v133, v133
  v_add_f32 v132, 1.0, v132
  v_add_f32 v133, 1.0, v133
  v_rcp_f32 v132, v132
  v_rcp_f32 v133, v133
  v_mul_f32 v132, v132, v80
  v_mul_f32 v133, v133, v81
  v_cvt_pk_bf16_f32 v117, v132, v133
  v_add_f32 v48, v48, v132
  v_add_f32 v49, v49, v133
  v_fma_f32 v56, v132, v132, v56
  v_fma_f32 v57, v133, v133, v57
  v_fma_f32 v70, v26, v138, v70
  v_fma_f32 v71, v27, v138, v71
  v_mul_f32 v70, v70, v34
  v_mul_f32 v71, v71, v35
  v_mul_f32 v128, v70, v70
  v_mul_f32 v129, v71, v71
  v_fma_f32 v128, v128, s48, v126
  v_fma_f32 v129, v129, s48, v126
  v_mul_f32 v128, v128, v70
  v_mul_f32 v129, v129, v71
  v_exp_f32 v128, v128
  v_exp_f32 v129, v129
  v_add_f32 v128, 1.0, v128
  v_add_f32 v129, 1.0, v129
  v_rcp_f32 v128, v128
  v_rcp_f32 v129, v129
  v_mul_f32 v128, v128, v70
  v_mul_f32 v129, v129, v71
  v_cvt_pk_bf16_f32 v118, v128, v129
  v_add_f32 v42, v42, v128
  v_add_f32 v43, v43, v129
  v_fma_f32 v50, v128, v128, v50
  v_fma_f32 v51, v129, v129, v51
  s_barrier
  v_fma_f32 v72, v28, v138, v72
  v_fma_f32 v73, v29, v138, v73
  v_mul_f32 v72, v72, v36
  v_mul_f32 v73, v73, v37
  v_mul_f32 v132, v72, v72
  v_mul_f32 v133, v73, v73
  v_fma_f32 v132, v132, s48, v126
  v_fma_f32 v133, v133, s48, v126
  v_mul_f32 v132, v132, v72
  v_mul_f32 v133, v133, v73
  v_exp_f32 v132, v132
  v_exp_f32 v133, v133
  v_add_f32 v132, 1.0, v132
  v_add_f32 v133, 1.0, v133
  v_rcp_f32 v132, v132
  v_rcp_f32 v133, v133
  v_mul_f32 v132, v132, v72
  v_mul_f32 v133, v133, v73
  v_cvt_pk_bf16_f32 v119, v132, v133
  v_add_f32 v44, v44, v132
  v_add_f32 v45, v45, v133
  v_fma_f32 v52, v132, v132, v52
  v_fma_f32 v53, v133, v133, v53
  v_fma_f32 v82, v30, v138, v82
  v_fma_f32 v83, v31, v138, v83
  v_mul_f32 v82, v82, v38
  v_mul_f32 v83, v83, v39
  v_mul_f32 v128, v82, v82
  v_mul_f32 v129, v83, v83
  v_fma_f32 v128, v128, s48, v126
  v_fma_f32 v129, v129, s48, v126
  v_mul_f32 v128, v128, v82
  v_mul_f32 v129, v129, v83
  v_exp_f32 v128, v128
  v_exp_f32 v129, v129
  v_add_f32 v128, 1.0, v128
  v_add_f32 v129, 1.0, v129
  v_rcp_f32 v128, v128
  v_rcp_f32 v129, v129
  v_mul_f32 v128, v128, v82
  v_mul_f32 v129, v129, v83
  v_cvt_pk_bf16_f32 v120, v128, v129
  v_add_f32 v46, v46, v128
  v_add_f32 v47, v47, v129
  v_fma_f32 v54, v128, v128, v54
  v_fma_f32 v55, v129, v129, v55
  v_fma_f32 v84, v32, v138, v84
  v_fma_f32 v85, v33, v138, v85
  v_mul_f32 v84, v84, v40
  v_mul_f32 v85, v85, v41
  v_mul_f32 v132, v84, v84
  v_mul_f32 v133, v85, v85
  v_fma_f32 v132, v132, s48, v126
  v_fma_f32 v133, v133, s48, v126
  v_mul_f32 v132, v132, v84
  v_mul_f32 v133, v133, v85
  v_exp_f32 v132, v132
  v_exp_f32 v133, v133
  v_add_f32 v132, 1.0, v132
  v_add_f32 v133, 1.0, v133
  v_rcp_f32 v132, v132
  v_rcp_f32 v133, v133
  v_mul_f32 v132, v132, v84
  v_mul_f32 v133, v133, v85
  v_cvt_pk_bf16_f32 v121, v132, v133
  v_add_f32 v48, v48, v132
  v_add_f32 v49, v49, v133
  v_fma_f32 v56, v132, v132, v56
  v_fma_f32 v57, v133, v133, v57
  s_barrier
  v_fma_f32 v74, v26, v140, v74
  v_fma_f32 v75, v27, v140, v75
  v_mul_f32 v74, v74, v34
  v_mul_f32 v75, v75, v35
  v_mul_f32 v128, v74, v74
  v_mul_f32 v129, v75, v75
  v_fma_f32 v128, v128, s48, v126
  v_fma_f32 v129, v129, s48, v126
  v_mul_f32 v128, v128, v74
  v_mul_f32 v129, v129, v75
  v_exp_f32 v128, v128
  v_exp_f32 v129, v129
  v_add_f32 v128, 1.0, v128
  v_add_f32 v129, 1.0, v129
  v_rcp_f32 v128, v128
  v_rcp_f32 v129, v129
  v_mul_f32 v128, v128, v74
  v_mul_f32 v129, v129, v75
  v_cvt_pk_bf16_f32 v122, v128, v129
  v_add_f32 v42, v42, v128
  v_add_f32 v43, v43, v129
  v_fma_f32 v50, v128, v128, v50
  v_fma_f32 v51, v129, v129, v51
  v_fma_f32 v76, v28, v140, v76
  v_fma_f32 v77, v29, v140, v77
  v_mul_f32 v76, v76, v36
  v_mul_f32 v77, v77, v37
  v_mul_f32 v132, v76, v76
  v_mul_f32 v133, v77, v77
  v_fma_f32 v132, v132, s48, v126
  v_fma_f32 v133, v133, s48, v126
  v_mul_f32 v132, v132, v76
  v_mul_f32 v133, v133, v77
  v_exp_f32 v132, v132
  v_exp_f32 v133, v133
  v_add_f32 v132, 1.0, v132
  v_add_f32 v133, 1.0, v133
  v_rcp_f32 v132, v132
  v_rcp_f32 v133, v133
  v_mul_f32 v132, v132, v76
  v_mul_f32 v133, v133, v77
  v_cvt_pk_bf16_f32 v123, v132, v133
  v_add_f32 v44, v44, v132
  v_add_f32 v45, v45, v133
  v_fma_f32 v52, v132, v132, v52
  v_fma_f32 v53, v133, v133, v53
  v_fma_f32 v86, v30, v140, v86
  v_fma_f32 v87, v31, v140, v87
  v_mul_f32 v86, v86, v38
  v_mul_f32 v87, v87, v39
  v_mul_f32 v128, v86, v86
  v_mul_f32 v129, v87, v87
  v_fma_f32 v128, v128, s48, v126
  v_fma_f32 v129, v129, s48, v126
  v_mul_f32 v128, v128, v86
  v_mul_f32 v129, v129, v87
  v_exp_f32 v128, v128
  v_exp_f32 v129, v129
  v_add_f32 v128, 1.0, v128
  v_add_f32 v129, 1.0, v129
  v_rcp_f32 v128, v128
  v_rcp_f32 v129, v129
  v_mul_f32 v128, v128, v86
  v_mul_f32 v129, v129, v87
  v_cvt_pk_bf16_f32 v124, v128, v129
  v_add_f32 v46, v46, v128
  v_add_f32 v47, v47, v129
  v_fma_f32 v54, v128, v128, v54
  v_fma_f32 v55, v129, v129, v55
  s_barrier
  v_fma_f32 v88, v32, v140, v88
  v_fma_f32 v89, v33, v140, v89
  v_mul_f32 v88, v88, v40
  v_mul_f32 v89, v89, v41
  v_mul_f32 v132, v88, v88
  v_mul_f32 v133, v89, v89
  v_fma_f32 v132, v132, s48, v126
  v_fma_f32 v133, v133, s48, v126
  v_mul_f32 v132, v132, v88
  v_mul_f32 v133, v133, v89
  v_exp_f32 v132, v132
  v_exp_f32 v133, v133
  v_add_f32 v132, 1.0, v132
  v_add_f32 v133, 1.0, v133
  v_rcp_f32 v132, v132
  v_rcp_f32 v133, v133
  v_mul_f32 v132, v132, v88
  v_mul_f32 v133, v133, v89
  v_cvt_pk_bf16_f32 v125, v132, v133
  v_add_f32 v48, v48, v132
  v_add_f32 v49, v49, v133
  v_fma_f32 v56, v132, v132, v56
  v_fma_f32 v57, v133, v133, v57
  v_add_f32_dpp v42, v42, v42 row_ror:8 row_mask:0xf bank_mask:0xf
  v_add_f32_dpp v43, v43, v43 row_ror:8 row_mask:0xf bank_mask:0xf
  v_add_f32_dpp v44, v44, v44 row_ror:8 row_mask:0xf bank_mask:0xf
  v_add_f32_dpp v45, v45, v45 row_ror:8 row_mask:0xf bank_mask:0xf
  v_add_f32_dpp v46, v46, v46 row_ror:8 row_mask:0xf bank_mask:0xf
  v_add_f32_dpp v47, v47, v47 row_ror:8 row_mask:0xf bank_mask:0xf
  v_add_f32_dpp v48, v48, v48 row_ror:8 row_mask:0xf bank_mask:0xf
  v_add_f32_dpp v49, v49, v49 row_ror:8 row_mask:0xf bank_mask:0xf
  v_add_f32_dpp v50, v50, v50 row_ror:8 row_mask:0xf bank_mask:0xf
  v_add_f32_dpp v51, v51, v51 row_ror:8 row_mask:0xf bank_mask:0xf
  v_add_f32_dpp v52, v52, v52 row_ror:8 row_mask:0xf bank_mask:0xf
  v_add_f32_dpp v53, v53, v53 row_ror:8 row_mask:0xf bank_mask:0xf
  v_add_f32_dpp v54, v54, v54 row_ror:8 row_mask:0xf bank_mask:0xf
  v_add_f32_dpp v55, v55, v55 row_ror:8 row_mask:0xf bank_mask:0xf
  v_add_f32_dpp v56, v56, v56 row_ror:8 row_mask:0xf bank_mask:0xf
  v_add_f32_dpp v57, v57, v57 row_ror:8 row_mask:0xf bank_mask:0xf
  v_add_f32_dpp v42, v42, v42 row_ror:4 row_mask:0xf bank_mask:0xf
  v_add_f32_dpp v43, v43, v43 row_ror:4 row_mask:0xf bank_mask:0xf
  v_add_f32_dpp v44, v44, v44 row_ror:4 row_mask:0xf bank_mask:0xf
  v_add_f32_dpp v45, v45, v45 row_ror:4 row_mask:0xf bank_mask:0xf
  v_add_f32_dpp v46, v46, v46 row_ror:4 row_mask:0xf bank_mask:0xf
  v_add_f32_dpp v47, v47, v47 row_ror:4 row_mask:0xf bank_mask:0xf
  v_add_f32_dpp v48, v48, v48 row_ror:4 row_mask:0xf bank_mask:0xf
  v_add_f32_dpp v49, v49, v49 row_ror:4 row_mask:0xf bank_mask:0xf
  v_add_f32_dpp v50, v50, v50 row_ror:4 row_mask:0xf bank_mask:0xf
  v_add_f32_dpp v51, v51, v51 row_ror:4 row_mask:0xf bank_mask:0xf
  v_add_f32_dpp v52, v52, v52 row_ror:4 row_mask:0xf bank_mask:0xf
  v_add_f32_dpp v53, v53, v53 row_ror:4 row_mask:0xf bank_mask:0xf
  v_add_f32_dpp v54, v54, v54 row_ror:4 row_mask:0xf bank_mask:0xf
  v_add_f32_dpp v55, v55, v55 row_ror:4 row_mask:0xf bank_mask:0xf
  v_add_f32_dpp v56, v56, v56 row_ror:4 row_mask:0xf bank_mask:0xf
  v_add_f32_dpp v57, v57, v57 row_ror:4 row_mask:0xf bank_mask:0xf
  s_barrier
  v_add_f32_dpp v42, v42, v42 row_ror:2 row_mask:0xf bank_mask:0xf
  v_add_f32_dpp v43, v43, v43 row_ror:2 row_mask:0xf bank_mask:0xf
  v_add_f32_dpp v44, v44, v44 row_ror:2 row_mask:0xf bank_mask:0xf
  v_add_f32_dpp v45, v45, v45 row_ror:2 row_mask:0xf bank_mask:0xf
  v_add_f32_dpp v46, v46, v46 row_ror:2 row_mask:0xf bank_mask:0xf
  v_add_f32_dpp v47, v47, v47 row_ror:2 row_mask:0xf bank_mask:0xf
  v_add_f32_dpp v48, v48, v48 row_ror:2 row_mask:0xf bank_mask:0xf
  v_add_f32_dpp v49, v49, v49 row_ror:2 row_mask:0xf bank_mask:0xf
  v_add_f32_dpp v50, v50, v50 row_ror:2 row_mask:0xf bank_mask:0xf
  v_add_f32_dpp v51, v51, v51 row_ror:2 row_mask:0xf bank_mask:0xf
  v_add_f32_dpp v52, v52, v52 row_ror:2 row_mask:0xf bank_mask:0xf
  v_add_f32_dpp v53, v53, v53 row_ror:2 row_mask:0xf bank_mask:0xf
  v_add_f32_dpp v54, v54, v54 row_ror:2 row_mask:0xf bank_mask:0xf
  v_add_f32_dpp v55, v55, v55 row_ror:2 row_mask:0xf bank_mask:0xf
  v_add_f32_dpp v56, v56, v56 row_ror:2 row_mask:0xf bank_mask:0xf
  v_add_f32_dpp v57, v57, v57 row_ror:2 row_mask:0xf bank_mask:0xf
  v_add_f32_dpp v42, v42, v42 row_ror:1 row_mask:0xf bank_mask:0xf
  v_add_f32_dpp v43, v43, v43 row_ror:1 row_mask:0xf bank_mask:0xf
  v_add_f32_dpp v44, v44, v44 row_ror:1 row_mask:0xf bank_mask:0xf
  v_add_f32_dpp v45, v45, v45 row_ror:1 row_mask:0xf bank_mask:0xf
  v_add_f32_dpp v46, v46, v46 row_ror:1 row_mask:0xf bank_mask:0xf
  v_add_f32_dpp v47, v47, v47 row_ror:1 row_mask:0xf bank_mask:0xf
  v_add_f32_dpp v48, v48, v48 row_ror:1 row_mask:0xf bank_mask:0xf
  v_add_f32_dpp v49, v49, v49 row_ror:1 row_mask:0xf bank_mask:0xf
  v_add_f32_dpp v50, v50, v50 row_ror:1 row_mask:0xf bank_mask:0xf
  v_add_f32_dpp v51, v51, v51 row_ror:1 row_mask:0xf bank_mask:0xf
  v_add_f32_dpp v52, v52, v52 row_ror:1 row_mask:0xf bank_mask:0xf
  v_add_f32_dpp v53, v53, v53 row_ror:1 row_mask:0xf bank_mask:0xf
  v_add_f32_dpp v54, v54, v54 row_ror:1 row_mask:0xf bank_mask:0xf
  v_add_f32_dpp v55, v55, v55 row_ror:1 row_mask:0xf bank_mask:0xf
  v_add_f32_dpp v56, v56, v56 row_ror:1 row_mask:0xf bank_mask:0xf
  v_add_f32_dpp v57, v57, v57 row_ror:1 row_mask:0xf bank_mask:0xf
  s_lshl_b32 s40, s36, 8
  s_add_u32 s40, s40, 2048
  v_add_u32 v19, s40, v19
  v_add_u32 v20, s40, v20
  s_mov_b32 exec_lo, 0x10001
  s_mov_b32 exec_hi, 0x10001
  ds_write_b128 v19, v[42:45]
  ds_write_b128 v20, v[46:49]
  ds_write_b128 v19, v[50:53] offset:512
  ds_write_b128 v20, v[54:57] offset:512
  s_mov_b64 exec, s[52:53]
  s_waitcnt lgkmcnt(0)
  s_barrier
  s_cmp_eq_u32 s34, 0
  s_cbranch_scc0 K1_NOPUB
  v_lshlrev_b32 v14, 2, v1
  v_add_u32 v14, 145408, v14
  ds_read_b32 v16, v14
  ds_read_b32 v18, v14 offset:256
  ds_read_b32 v17, v14 offset:512
  ds_read_b32 v19, v14 offset:768
  s_lshl_b32 s40, s32, 3
  s_add_u32 s40, s40, s33
  s_lshl_b32 s40, s40, 9
  s_add_u32 s40, s40, 16842752
  v_lshlrev_b32 v15, 3, v1
  s_waitcnt lgkmcnt(0)
  v_add_f32 v16, v16, v18
  v_add_f32 v17, v17, v19
  v_max_f32 v17, 0, v17
  buffer_store_dwordx2 v[16:17], v15, s[16:19], s40 offen sc1
K1_NOPUB:
  s_mul_i32 s40, s33, 6
  s_mul_i32 s41, s36, 3
  s_add_u32 s40, s40, s41
  s_lshl_b32 s40, s40, 6
  s_lshl_b32 s41, s32, 1
  s_add_u32 s40, s40, s41
  s_add_u32 s40, s40, s35
  s_lshl_b32 s40, s40, 10
  s_add_u32 s39, s40, 3145728
  v_and_b32 v21, 1, v2
  v_lshlrev_b32 v21, 1, v21
  v_lshrrev_b32 v24, 1, v2
  v_or_b32 v21, v21, v24
  s_lshl_b32 s41, s36, 1
  v_xor_b32 v21, s41, v21
  v_lshlrev_b32 v21, 4, v21
  v_add_u32 v21, v21, v3
  v_lshlrev_b32 v21, 4, v21
  v_and_b32 v24, 31, v1
  s_lshl_b32 s38, s35, 5
  v_add_u32 v24, s38, v24
  v_lshlrev_b32 v24, 3, v24
  s_lshl_b32 s38, s32, 12
  s_add_u32 s38, s38, 16842752
  s_barrier
  s_barrier
  s_barrier
  s_barrier
  s_setprio 0
  s_mul_i32 s40, s55, 2560
  s_add_u32 s40, s40, 61440
  v_lshlrev_b32 v17, 2, v1
  v_min_u32 v17, 156, v17
  v_add_u32 v17, s40, v17
  ds_read_b32 v26, v17 offset:0
  ds_read_b32 v27, v17 offset:160
  ds_read_b32 v28, v17 offset:320
  ds_read_b32 v29, v17 offset:480
  ds_read_b32 v30, v17 offset:640
  ds_read_b32 v31, v17 offset:800
  ds_read_b32 v32, v17 offset:960
  ds_read_b32 v33, v17 offset:1120
  ds_read_b32 v34, v17 offset:1280
  ds_read_b32 v35, v17 offset:1440
  ds_read_b32 v36, v17 offset:1600
  ds_read_b32 v37, v17 offset:1760
  ds_read_b32 v38, v17 offset:1920
  ds_read_b32 v39, v17 offset:2080
  s_waitcnt lgkmcnt(6)
  ds_read_b32 v40, v17 offset:2240
  ds_read_b32 v41, v17 offset:2400
  ds_read_b32 v42, v17 offset:2560
  ds_read_b32 v43, v17 offset:2720
  ds_read_b32 v44, v17 offset:2880
  ds_read_b32 v45, v17 offset:11520
  ds_read_b32 v46, v17 offset:11680
  s_waitcnt lgkmcnt(6)
  ds_read_b32 v47, v17 offset:11840
  ds_read_b32 v48, v17 offset:12000
  ds_read_b32 v49, v17 offset:12160
  ds_read_b32 v50, v17 offset:12320
  ds_read_b32 v51, v17 offset:12480
  ds_read_b32 v52, v17 offset:12640
  ds_read_b32 v53, v17 offset:12800
  ds_read_b32 v54, v17 offset:12960
  s_waitcnt lgkmcnt(6)
  ds_read_b32 v55, v17 offset:13120
  ds_read_b32 v56, v17 offset:13280
  ds_read_b32 v57, v17 offset:13440
  ds_read_b32 v58, v17 offset:13600
  ds_read_b32 v59, v17 offset:13760
  ds_read_b32 v60, v17 offset:13920
  s_waitcnt vmcnt(0)
  v_lshlrev_b32 v100, 16, v160
  v_lshlrev_b32 v101, 16, v162
  v_and_b32 v102, s47, v160
  v_and_b32 v103, s47, v162
  v_lshlrev_b32 v104, 16, v161
  v_lshlrev_b32 v105, 16, v163
  v_and_b32 v106, s47, v161
  v_and_b32 v107, s47, v163
  s_waitcnt lgkmcnt(12)
  v_lshlrev_b32 v62, 16, v26
  v_and_b32 v63, s47, v26
  v_lshlrev_b32 v64, 16, v27
  v_and_b32 v65, s47, v27
  v_lshlrev_b32 v66, 16, v28
  v_and_b32 v67, s47, v28
  v_lshlrev_b32 v68, 16, v29
  v_and_b32 v69, s47, v29
  v_lshlrev_b32 v70, 16, v30
  v_and_b32 v71, s47, v30
  v_lshlrev_b32 v72, 16, v31
  v_and_b32 v73, s47, v31
  v_lshlrev_b32 v74, 16, v32
  v_and_b32 v75, s47, v32
  v_lshlrev_b32 v76, 16, v33
  v_and_b32 v77, s47, v33
  v_lshlrev_b32 v78, 16, v34
  v_and_b32 v79, s47, v34
  v_lshlrev_b32 v80, 16, v35
  v_and_b32 v81, s47, v35
  v_lshlrev_b32 v82, 16, v36
  v_and_b32 v83, s47, v36
  v_lshlrev_b32 v84, 16, v37
  v_and_b32 v85, s47, v37
  s_waitcnt lgkmcnt(0)
  v_lshlrev_b32 v86, 16, v38
  v_and_b32 v87, s47, v38
  v_lshlrev_b32 v88, 16, v39
  v_and_b32 v89, s47, v39
  v_lshlrev_b32 v90, 16, v40
  v_and_b32 v91, s47, v40
  v_lshlrev_b32 v92, 16, v41
  v_and_b32 v93, s47, v41
  v_lshlrev_b32 v94, 16, v42
  v_and_b32 v95, s47, v42
  v_lshlrev_b32 v96, 16, v43
  v_and_b32 v97, s47, v43
  v_lshlrev_b32 v98, 16, v44
  v_and_b32 v99, s47, v44
  v_pk_mul_f32 v[126:127], v[106:107], v[62:63]
  v_lshlrev_b32 v18, 16, v45
  v_pk_fma_f32 v[126:127], v[104:105], v[64:65], v[126:127]
  v_and_b32 v19, s47, v45
  v_pk_fma_f32 v[126:127], v[102:103], v[66:67], v[126:127]
  v_pk_fma_f32 v[126:127], v[100:101], v[68:69], v[126:127]
  v_pk_mul_f32 v[126:127], v[126:127], v[18:19]
  v_pk_mul_f32 v[128:129], v[106:107], v[64:65]
  v_lshlrev_b32 v18, 16, v46
  v_pk_fma_f32 v[128:129], v[104:105], v[66:67], v[128:129]
  v_and_b32 v19, s47, v46
  v_pk_fma_f32 v[128:129], v[102:103], v[68:69], v[128:129]
  v_pk_fma_f32 v[128:129], v[100:101], v[70:71], v[128:129]
  v_pk_mul_f32 v[128:129], v[128:129], v[18:19]
  v_pk_mul_f32 v[130:131], v[106:107], v[66:67]
  v_lshlrev_b32 v18, 16, v47
  v_pk_fma_f32 v[130:131], v[104:105], v[68:69], v[130:131]
  v_and_b32 v19, s47, v47
  v_pk_fma_f32 v[130:131], v[102:103], v[70:71], v[130:131]
  v_pk_fma_f32 v[130:131], v[100:101], v[72:73], v[130:131]
  v_pk_mul_f32 v[130:131], v[130:131], v[18:19]
  v_pk_mul_f32 v[132:133], v[106:107], v[68:69]
  v_lshlrev_b32 v18, 16, v48
  v_pk_fma_f32 v[132:133], v[104:105], v[70:71], v[132:133]
  v_and_b32 v19, s47, v48
  v_pk_fma_f32 v[132:133], v[102:103], v[72:73], v[132:133]
  v_pk_fma_f32 v[132:133], v[100:101], v[74:75], v[132:133]
  v_pk_mul_f32 v[132:133], v[132:133], v[18:19]
  v_pk_mul_f32 v[134:135], v[106:107], v[70:71]
  v_lshlrev_b32 v18, 16, v49
  v_pk_fma_f32 v[134:135], v[104:105], v[72:73], v[134:135]
  v_and_b32 v19, s47, v49
  v_pk_fma_f32 v[134:135], v[102:103], v[74:75], v[134:135]
  v_pk_fma_f32 v[134:135], v[100:101], v[76:77], v[134:135]
  v_pk_mul_f32 v[134:135], v[134:135], v[18:19]
  v_pk_mul_f32 v[136:137], v[106:107], v[72:73]
  v_lshlrev_b32 v18, 16, v50
  v_pk_fma_f32 v[136:137], v[104:105], v[74:75], v[136:137]
  v_and_b32 v19, s47, v50
  v_pk_fma_f32 v[136:137], v[102:103], v[76:77], v[136:137]
  v_pk_fma_f32 v[136:137], v[100:101], v[78:79], v[136:137]
  v_pk_mul_f32 v[136:137], v[136:137], v[18:19]
  v_pk_mul_f32 v[138:139], v[106:107], v[74:75]
  v_lshlrev_b32 v18, 16, v51
  v_pk_fma_f32 v[138:139], v[104:105], v[76:77], v[138:139]
  v_and_b32 v19, s47, v51
  v_pk_fma_f32 v[138:139], v[102:103], v[78:79], v[138:139]
  v_pk_fma_f32 v[138:139], v[100:101], v[80:81], v[138:139]
  v_pk_mul_f32 v[138:139], v[138:139], v[18:19]
  v_pk_mul_f32 v[140:141], v[106:107], v[76:77]
  v_lshlrev_b32 v18, 16, v52
  v_pk_fma_f32 v[140:141], v[104:105], v[78:79], v[140:141]
  v_and_b32 v19, s47, v52
  v_pk_fma_f32 v[140:141], v[102:103], v[80:81], v[140:141]
  v_pk_fma_f32 v[140:141], v[100:101], v[82:83], v[140:141]
  v_pk_mul_f32 v[140:141], v[140:141], v[18:19]
  v_pk_mul_f32 v[142:143], v[106:107], v[78:79]
  v_lshlrev_b32 v18, 16, v53
  v_pk_fma_f32 v[142:143], v[104:105], v[80:81], v[142:143]
  v_and_b32 v19, s47, v53
  v_pk_fma_f32 v[142:143], v[102:103], v[82:83], v[142:143]
  v_pk_fma_f32 v[142:143], v[100:101], v[84:85], v[142:143]
  v_pk_mul_f32 v[142:143], v[142:143], v[18:19]
  v_pk_mul_f32 v[144:145], v[106:107], v[80:81]
  v_lshlrev_b32 v18, 16, v54
  v_pk_fma_f32 v[144:145], v[104:105], v[82:83], v[144:145]
  v_and_b32 v19, s47, v54
  v_pk_fma_f32 v[144:145], v[102:103], v[84:85], v[144:145]
  v_pk_fma_f32 v[144:145], v[100:101], v[86:87], v[144:145]
  v_pk_mul_f32 v[144:145], v[144:145], v[18:19]
  v_pk_mul_f32 v[146:147], v[106:107], v[82:83]
  v_lshlrev_b32 v18, 16, v55
  v_pk_fma_f32 v[146:147], v[104:105], v[84:85], v[146:147]
  v_and_b32 v19, s47, v55
  v_pk_fma_f32 v[146:147], v[102:103], v[86:87], v[146:147]
  v_pk_fma_f32 v[146:147], v[100:101], v[88:89], v[146:147]
  v_pk_mul_f32 v[146:147], v[146:147], v[18:19]
  v_pk_mul_f32 v[148:149], v[106:107], v[84:85]
  v_lshlrev_b32 v18, 16, v56
  v_pk_fma_f32 v[148:149], v[104:105], v[86:87], v[148:149]
  v_and_b32 v19, s47, v56
  v_pk_fma_f32 v[148:149], v[102:103], v[88:89], v[148:149]
  v_pk_fma_f32 v[148:149], v[100:101], v[90:91], v[148:149]
  v_pk_mul_f32 v[148:149], v[148:149], v[18:19]
  v_pk_mul_f32 v[150:151], v[106:107], v[86:87]
  v_lshlrev_b32 v18, 16, v57
  v_pk_fma_f32 v[150:151], v[104:105], v[88:89], v[150:151]
  v_and_b32 v19, s47, v57
  v_pk_fma_f32 v[150:151], v[102:103], v[90:91], v[150:151]
  v_pk_fma_f32 v[150:151], v[100:101], v[92:93], v[150:151]
  v_pk_mul_f32 v[150:151], v[150:151], v[18:19]
  v_pk_mul_f32 v[152:153], v[106:107], v[88:89]
  v_lshlrev_b32 v18, 16, v58
  v_pk_fma_f32 v[152:153], v[104:105], v[90:91], v[152:153]
  v_and_b32 v19, s47, v58
  v_pk_fma_f32 v[152:153], v[102:103], v[92:93], v[152:153]
  v_pk_fma_f32 v[152:153], v[100:101], v[94:95], v[152:153]
  v_pk_mul_f32 v[152:153], v[152:153], v[18:19]
  v_pk_mul_f32 v[154:155], v[106:107], v[90:91]
  v_lshlrev_b32 v18, 16, v59
  v_pk_fma_f32 v[154:155], v[104:105], v[92:93], v[154:155]
  v_and_b32 v19, s47, v59
  v_pk_fma_f32 v[154:155], v[102:103], v[94:95], v[154:155]
  v_pk_fma_f32 v[154:155], v[100:101], v[96:97], v[154:155]
  v_pk_mul_f32 v[154:155], v[154:155], v[18:19]
  v_pk_mul_f32 v[156:157], v[106:107], v[92:93]
  v_lshlrev_b32 v18, 16, v60
  v_pk_fma_f32 v[156:157], v[104:105], v[94:95], v[156:157]
  v_and_b32 v19, s47, v60
  v_pk_fma_f32 v[156:157], v[102:103], v[96:97], v[156:157]
  v_pk_fma_f32 v[156:157], v[100:101], v[98:99], v[156:157]
  v_pk_mul_f32 v[156:157], v[156:157], v[18:19]
  v_cvt_pk_bf16_f32 v26, v140, v138
  v_cvt_pk_bf16_f32 v27, v136, v134
  v_cvt_pk_bf16_f32 v28, v132, v130
  v_cvt_pk_bf16_f32 v29, v128, v126
  v_cvt_pk_bf16_f32 v30, v156, v154
  v_cvt_pk_bf16_f32 v31, v152, v150
  v_cvt_pk_bf16_f32 v32, v148, v146
  v_cvt_pk_bf16_f32 v33, v144, v142
  v_cvt_pk_bf16_f32 v34, v141, v139
  v_cvt_pk_bf16_f32 v35, v137, v135
  v_cvt_pk_bf16_f32 v36, v133, v131
  v_cvt_pk_bf16_f32 v37, v129, v127
  v_cvt_pk_bf16_f32 v38, v157, v155
  v_cvt_pk_bf16_f32 v39, v153, v151
  v_cvt_pk_bf16_f32 v40, v149, v147
  v_cvt_pk_bf16_f32 v41, v145, v143
  buffer_load_dwordx2 v[44:45], v24, s[16:19], s38 offen offset:0 sc1
  buffer_load_dwordx2 v[46:47], v24, s[16:19], s38 offen offset:512 sc1
  buffer_load_dwordx2 v[48:49], v24, s[16:19], s38 offen offset:1024 sc1
  buffer_load_dwordx2 v[50:51], v24, s[16:19], s38 offen offset:1536 sc1
  buffer_load_dwordx2 v[52:53], v24, s[16:19], s38 offen offset:2048 sc1
  buffer_load_dwordx2 v[54:55], v24, s[16:19], s38 offen offset:2560 sc1
  buffer_load_dwordx2 v[56:57], v24, s[16:19], s38 offen offset:3072 sc1
  buffer_load_dwordx2 v[58:59], v24, s[16:19], s38 offen offset:3584 sc1
  v_lshlrev_b32 v17, 13, v1
  s_mul_i32 s40, s33, 327680
  s_lshl_b32 s41, s32, 7
  s_add_u32 s40, s40, s41
  s_lshl_b32 s41, s55, 5
  s_add_u32 s40, s40, s41
  s_add_u32 s40, s40, 6291456
  s_add_u32 s41, s40, 4096
  s_mov_b32 exec_lo, 0xffffffff
  s_mov_b32 exec_hi, 0xff
  buffer_store_dwordx4 v[26:29], v17, s[16:19], s40 offen
  buffer_store_dwordx4 v[30:33], v17, s[16:19], s40 offen offset:16
  buffer_store_dwordx4 v[34:37], v17, s[16:19], s41 offen
  buffer_store_dwordx4 v[38:41], v17, s[16:19], s41 offen offset:16
  s_mov_b64 exec, s[52:53]
  v_readfirstlane_b32 s40, v23
  s_nop 0
  s_cmp_ge_u32 s40, 8
  s_cbranch_scc1 K1_CPOLLED
K1_CPOLL:
  s_sleep 4
  buffer_load_dword v23, v22, s[4:7], 0 offen sc1
  s_waitcnt vmcnt(0)
  v_readfirstlane_b32 s40, v23
  s_nop 0
  s_cmp_ge_u32 s40, 8
  s_cbranch_scc0 K1_CPOLL
  s_branch K1_POLL
K1_CPOLLED:
  s_waitcnt vmcnt(4)
  s_branch K1_CHECK
K1_POLL:
  buffer_load_dwordx2 v[44:45], v24, s[16:19], s38 offen offset:0 sc1
  buffer_load_dwordx2 v[46:47], v24, s[16:19], s38 offen offset:512 sc1
  buffer_load_dwordx2 v[48:49], v24, s[16:19], s38 offen offset:1024 sc1
  buffer_load_dwordx2 v[50:51], v24, s[16:19], s38 offen offset:1536 sc1
  buffer_load_dwordx2 v[52:53], v24, s[16:19], s38 offen offset:2048 sc1
  buffer_load_dwordx2 v[54:55], v24, s[16:19], s38 offen offset:2560 sc1
  buffer_load_dwordx2 v[56:57], v24, s[16:19], s38 offen offset:3072 sc1
  buffer_load_dwordx2 v[58:59], v24, s[16:19], s38 offen offset:3584 sc1
  s_waitcnt vmcnt(0)
K1_CHECK:
  s_mov_b32 s40, 0xbf800000
  v_cmp_eq_u32 vcc, s40, v45
  v_cmp_eq_u32 s[56:57], s40, v47
  s_nop 0
  s_or_b64 vcc, vcc, s[56:57]
  v_cmp_eq_u32 s[56:57], s40, v49
  s_nop 0
  s_or_b64 vcc, vcc, s[56:57]
  v_cmp_eq_u32 s[56:57], s40, v51
  s_nop 0
  s_or_b64 vcc, vcc, s[56:57]
  v_cmp_eq_u32 s[56:57], s40, v53
  s_nop 0
  s_or_b64 vcc, vcc, s[56:57]
  v_cmp_eq_u32 s[56:57], s40, v55
  s_nop 0
  s_or_b64 vcc, vcc, s[56:57]
  v_cmp_eq_u32 s[56:57], s40, v57
  s_nop 0
  s_or_b64 vcc, vcc, s[56:57]
  v_cmp_eq_u32 s[56:57], s40, v59
  s_nop 0
  s_or_b64 vcc, vcc, s[56:57]
  s_cmp_eq_u64 vcc, 0
  s_cbranch_scc1 K1_POLLED
  s_sleep 2
  s_branch K1_POLL
K1_POLLED:
  v_pk_add_f32 v[44:45], v[44:45], v[46:47]
  v_pk_add_f32 v[44:45], v[44:45], v[48:49]
  v_pk_add_f32 v[44:45], v[44:45], v[50:51]
  v_pk_add_f32 v[44:45], v[44:45], v[52:53]
  v_pk_add_f32 v[44:45], v[44:45], v[54:55]
  v_pk_add_f32 v[44:45], v[44:45], v[56:57]
  v_pk_add_f32 v[44:45], v[44:45], v[58:59]
  v_mul_f32 v16, 0x3aaaaaab, v44
  v_mul_f32 v18, 0x3aaaaaab, v45
  v_fma_f32 v18, -v16, v16, v18
  v_max_f32 v18, 0, v18
  v_cvt_pk_bf16_f32 v16, v16, v16
  v_lshlrev_b32 v16, 16, v16
  v_cvt_pk_bf16_f32 v18, v18, v18
  v_lshlrev_b32 v18, 16, v18
  v_add_f32 v18, 0x3727c5ac, v18
  v_cvt_pk_bf16_f32 v18, v18, v18
  v_lshlrev_b32 v18, 16, v18
  v_sqrt_f32 v18, v18
  s_nop 0
  v_cvt_pk_bf16_f32 v18, v18, v18
  v_lshlrev_b32 v18, 16, v18
  v_rcp_f32 v17, v18
  s_nop 0
  v_mul_f32 v16, v16, v17
  v_sub_f32 v16, 0, v16
  s_lshl_b32 s40, s55, 8
  s_add_u32 s40, s40, 146432
  v_and_b32 v18, 31, v1
  v_lshlrev_b32 v18, 2, v18
  v_add_u32 v18, s40, v18
  ds_write_b32 v18, v16
  ds_write_b32 v18, v17 offset:128
  s_lshl_b32 s41, s36, 6
  s_add_u32 s40, s40, s41
  v_lshlrev_b32 v19, 4, v2
  v_add_u32 v19, s40, v19
  v_xor_b32 v20, 64, v19
  s_waitcnt lgkmcnt(0)
  ds_read_b128 v[26:29], v19
  ds_read_b128 v[30:33], v20
  ds_read_b128 v[34:37], v19 offset:128
  ds_read_b128 v[38:41], v20 offset:128
  s_waitcnt lgkmcnt(0)
  v_lshlrev_b32 v128, 16, v114
  v_and_b32 v129, s47, v114
  v_pk_fma_f32 v[128:129], v[128:129], v[34:35], v[26:27]
  v_cvt_pk_bf16_f32 v114, v128, v129
  v_lshlrev_b32 v132, 16, v115
  v_and_b32 v133, s47, v115
  v_pk_fma_f32 v[132:133], v[132:133], v[36:37], v[28:29]
  v_cvt_pk_bf16_f32 v115, v132, v133
  v_lshlrev_b32 v128, 16, v116
  v_and_b32 v129, s47, v116
  v_pk_fma_f32 v[128:129], v[128:129], v[38:39], v[30:31]
  v_cvt_pk_bf16_f32 v116, v128, v129
  v_lshlrev_b32 v132, 16, v117
  v_and_b32 v133, s47, v117
  v_pk_fma_f32 v[132:133], v[132:133], v[40:41], v[32:33]
  v_cvt_pk_bf16_f32 v117, v132, v133
  v_permlane16_swap_b32 v114, v116
  s_nop 0
  v_permlane16_swap_b32 v115, v117
  s_add_u32 s41, s39, 0
  buffer_store_dwordx4 v[114:117], v21, s[16:19], s41 offen
  v_lshlrev_b32 v128, 16, v118
  v_and_b32 v129, s47, v118
  v_pk_fma_f32 v[128:129], v[128:129], v[34:35], v[26:27]
  v_cvt_pk_bf16_f32 v118, v128, v129
  v_lshlrev_b32 v132, 16, v119
  v_and_b32 v133, s47, v119
  v_pk_fma_f32 v[132:133], v[132:133], v[36:37], v[28:29]
  v_cvt_pk_bf16_f32 v119, v132, v133
  v_lshlrev_b32 v128, 16, v120
  v_and_b32 v129, s47, v120
  v_pk_fma_f32 v[128:129], v[128:129], v[38:39], v[30:31]
  v_cvt_pk_bf16_f32 v120, v128, v129
  v_lshlrev_b32 v132, 16, v121
  v_and_b32 v133, s47, v121
  v_pk_fma_f32 v[132:133], v[132:133], v[40:41], v[32:33]
  v_cvt_pk_bf16_f32 v121, v132, v133
  v_permlane16_swap_b32 v118, v120
  s_nop 0
  v_permlane16_swap_b32 v119, v121
  s_add_u32 s41, s39, 65536
  buffer_store_dwordx4 v[118:121], v21, s[16:19], s41 offen
  v_lshlrev_b32 v128, 16, v122
  v_and_b32 v129, s47, v122
  v_pk_fma_f32 v[128:129], v[128:129], v[34:35], v[26:27]
  v_cvt_pk_bf16_f32 v122, v128, v129
  v_lshlrev_b32 v132, 16, v123
  v_and_b32 v133, s47, v123
  v_pk_fma_f32 v[132:133], v[132:133], v[36:37], v[28:29]
  v_cvt_pk_bf16_f32 v123, v132, v133
  v_lshlrev_b32 v128, 16, v124
  v_and_b32 v129, s47, v124
  v_pk_fma_f32 v[128:129], v[128:129], v[38:39], v[30:31]
  v_cvt_pk_bf16_f32 v124, v128, v129
  v_lshlrev_b32 v132, 16, v125
  v_and_b32 v133, s47, v125
  v_pk_fma_f32 v[132:133], v[132:133], v[40:41], v[32:33]
  v_cvt_pk_bf16_f32 v125, v132, v133
  v_permlane16_swap_b32 v122, v124
  s_nop 0
  v_permlane16_swap_b32 v123, v125
  s_add_u32 s41, s39, 131072
  buffer_store_dwordx4 v[122:125], v21, s[16:19], s41 offen
  s_endpgm
K1_B:
  s_cmp_eq_u32 s34, 4
  s_cbranch_scc0 K1_NORST
  s_lshl_b32 s40, s32, 3
  s_add_u32 s40, s40, s33
  s_lshl_b32 s40, s40, 9
  s_add_u32 s40, s40, 16842752
  v_lshlrev_b32 v15, 3, v1
  v_mov_b32 v20, 0
  v_mov_b32 v21, 0xbf800000
  buffer_store_dwordx2 v[20:21], v15, s[16:19], s40 offen sc1
K1_NORST:
  s_lshl_b32 s40, s2, 2
  s_add_u32 s40, s40, s55
  s_mul_i32 s41, s40, 2731
  s_lshr_b32 s41, s41, 16
  s_mul_i32 s42, s41, 24
  s_sub_u32 s42, s40, s42
  s_mov_b32 s72, s40
  v_mul_u32_u24 v17, 5120, v2
  v_lshlrev_b32 v18, 1, v3
  v_add_u32 v17, v17, v18
  s_lshl_b32 s41, s41, 5
  s_mul_i32 s42, s42, 40960
  s_add_u32 s41, s41, s42
  s_add_u32 s42, s41, 20480
  s_barrier
  s_mov_b32 s28, s66
  s_and_b32 s29, s67, 0xffff
  s_mov_b32 s30, 983040
  s_mov_b32 s31, 0x20000
  buffer_load_ushort v152, v17, s[28:31], s41 offen offset:0
  buffer_load_ushort v153, v17, s[28:31], s41 offen offset:1280
  buffer_load_ushort v154, v17, s[28:31], s41 offen offset:2560
  buffer_load_ushort v155, v17, s[28:31], s41 offen offset:3840
  buffer_load_ushort v156, v17, s[28:31], s42 offen offset:0
  buffer_load_ushort v157, v17, s[28:31], s42 offen offset:1280
  buffer_load_ushort v158, v17, s[28:31], s42 offen offset:2560
  buffer_load_ushort v159, v17, s[28:31], s42 offen offset:3840
  s_barrier
  s_barrier
  s_barrier
  s_cmp_eq_u32 s34, 4
  s_cbranch_scc0 K1_NOCNT
  s_waitcnt vmcnt(0)
  s_lshl_b32 s39, s32, 2
  v_mov_b32 v20, s39
  v_mov_b32 v21, 1
  s_mov_b32 exec_lo, 0x1
  s_mov_b32 exec_hi, 0x0
  buffer_atomic_add v21, v20, s[4:7], 0 offen sc1
  s_mov_b64 exec, s[52:53]
K1_NOCNT:
  s_barrier
  s_cmp_ge_u32 s72, 960
  s_cbranch_scc1 K1_NOWOF
  s_waitcnt vmcnt(0)
  v_lshl_or_b32 v164, v153, 16, v152
  v_lshl_or_b32 v165, v155, 16, v154
  v_lshl_or_b32 v166, v157, 16, v156
  v_lshl_or_b32 v167, v159, 16, v158
  v_lshlrev_b32 v17, 4, v1
  s_lshl_b32 s40, s72, 10
  s_add_u32 s40, s40, 15728640
  buffer_store_dwordx4 v[164:167], v17, s[16:19], s40 offen
K1_NOWOF:
  s_barrier
  s_barrier
  s_barrier
  s_barrier
  s_barrier
  v_mov_b32 v102, 0x3f803f80
  v_mov_b32 v103, 0x3f803f80
  v_mov_b32 v104, 0x3f803f80
  v_mov_b32 v105, 0x3f803f80
  v_mov_b32 v66, 0
  v_mov_b32 v67, 0
  v_mov_b32 v68, 0
  v_mov_b32 v69, 0
  v_mov_b32 v70, 0
  v_mov_b32 v71, 0
  v_mov_b32 v72, 0
  v_mov_b32 v73, 0
  v_mov_b32 v74, 0
  v_mov_b32 v75, 0
  v_mov_b32 v76, 0
  v_mov_b32 v77, 0
  v_mov_b32 v78, 0
  v_mov_b32 v79, 0
  v_mov_b32 v80, 0
  v_mov_b32 v81, 0
  v_mov_b32 v82, 0
  v_mov_b32 v83, 0
  v_mov_b32 v84, 0
  v_mov_b32 v85, 0
  v_mov_b32 v86, 0
  v_mov_b32 v87, 0
  v_mov_b32 v88, 0
  v_mov_b32 v89, 0
  v_mov_b32 v90, 0
  v_mov_b32 v91, 0
  v_mov_b32 v92, 0
  v_mov_b32 v93, 0
  v_mov_b32 v94, 0
  v_mov_b32 v95, 0
  v_mov_b32 v96, 0
  v_mov_b32 v97, 0
  v_mov_b32 v98, 0
  v_mov_b32 v99, 0
  v_mov_b32 v100, 0
  v_mov_b32 v101, 0
  v_mov_b32 v106, 0
  v_mov_b32 v107, 0
  v_mov_b32 v108, 0
  v_mov_b32 v109, 0
  v_mov_b32 v110, 0
  v_mov_b32 v111, 0
  v_mov_b32 v112, 0
  v_mov_b32 v113, 0
  s_barrier
  s_mov_b32 s37, 0
  ds_read_b128 v[26:29], v4 offset:0
  ds_read_b64_tr_b16 v[42:43], v8 offset:0
  ds_read_b64_tr_b16 v[44:45], v8 offset:768
  ds_read_b128 v[30:33], v6 offset:0
  ds_read_b64_tr_b16 v[46:47], v9 offset:0
  ds_read_b64_tr_b16 v[48:49], v9 offset:768
  ds_read_b64_tr_b16 v[50:51], v10 offset:0
  ds_read_b64_tr_b16 v[52:53], v10 offset:768
K1_LOOP2:
  s_waitcnt lgkmcnt(0)
  v_mfma_f32_16x16x32_bf16 v[66:69], v[42:45], v[26:29], v[66:69]
  ds_read_b128 v[34:37], v5 offset:0
  ds_read_b64_tr_b16 v[54:55], v8 offset:6144
  v_mfma_f32_16x16x32_bf16 v[78:81], v[42:45], v[30:33], v[78:81]
  ds_read_b64_tr_b16 v[56:57], v8 offset:6912
  ds_read_b128 v[38:41], v7 offset:0
  v_mfma_f32_16x16x32_bf16 v[70:73], v[46:49], v[26:29], v[70:73]
  ds_read_b64_tr_b16 v[58:59], v9 offset:6144
  ds_read_b64_tr_b16 v[60:61], v9 offset:6912
  v_mfma_f32_16x16x32_bf16 v[82:85], v[46:49], v[30:33], v[82:85]
  ds_read_b64_tr_b16 v[62:63], v10 offset:6144
  ds_read_b64_tr_b16 v[64:65], v10 offset:6912
  v_mfma_f32_16x16x32_bf16 v[74:77], v[50:53], v[26:29], v[74:77]
  v_mfma_f32_16x16x32_bf16 v[86:89], v[50:53], v[30:33], v[86:89]
  s_cmp_eq_u32 s35, 0
  s_cbranch_scc0 K1_SK_2a0
  v_mfma_f32_16x16x32_bf16 v[90:93], v[42:45], v[102:105], v[90:93]
  v_mfma_f32_16x16x32_bf16 v[94:97], v[46:49], v[102:105], v[94:97]
  v_mfma_f32_16x16x32_bf16 v[98:101], v[50:53], v[102:105], v[98:101]
K1_SK_2a0:
  s_waitcnt lgkmcnt(0)
  s_barrier
  v_mfma_f32_16x16x32_bf16 v[66:69], v[54:57], v[34:37], v[66:69]
  ds_read_b128 v[26:29], v4 offset:8192
  ds_read_b64_tr_b16 v[42:43], v8 offset:12288
  v_mfma_f32_16x16x32_bf16 v[78:81], v[54:57], v[38:41], v[78:81]
  ds_read_b64_tr_b16 v[44:45], v8 offset:13056
  ds_read_b128 v[30:33], v6 offset:8192
  v_mfma_f32_16x16x32_bf16 v[70:73], v[58:61], v[34:37], v[70:73]
  ds_read_b64_tr_b16 v[46:47], v9 offset:12288
  ds_read_b64_tr_b16 v[48:49], v9 offset:13056
  v_mfma_f32_16x16x32_bf16 v[82:85], v[58:61], v[38:41], v[82:85]
  ds_read_b64_tr_b16 v[50:51], v10 offset:12288
  ds_read_b64_tr_b16 v[52:53], v10 offset:13056
  v_mfma_f32_16x16x32_bf16 v[74:77], v[62:65], v[34:37], v[74:77]
  v_mfma_f32_16x16x32_bf16 v[86:89], v[62:65], v[38:41], v[86:89]
  s_cmp_eq_u32 s35, 1
  s_cbranch_scc0 K1_SK_2b0
  v_mfma_f32_16x16x32_bf16 v[90:93], v[54:57], v[102:105], v[90:93]
  v_mfma_f32_16x16x32_bf16 v[94:97], v[58:61], v[102:105], v[94:97]
  v_mfma_f32_16x16x32_bf16 v[98:101], v[62:65], v[102:105], v[98:101]
K1_SK_2b0:
  s_waitcnt lgkmcnt(0)
  v_mfma_f32_16x16x32_bf16 v[66:69], v[42:45], v[26:29], v[66:69]
  ds_read_b128 v[34:37], v5 offset:8192
  ds_read_b64_tr_b16 v[54:55], v8 offset:18432
  v_mfma_f32_16x16x32_bf16 v[78:81], v[42:45], v[30:33], v[78:81]
  ds_read_b64_tr_b16 v[56:57], v8 offset:19200
  ds_read_b128 v[38:41], v7 offset:8192
  v_mfma_f32_16x16x32_bf16 v[70:73], v[46:49], v[26:29], v[70:73]
  ds_read_b64_tr_b16 v[58:59], v9 offset:18432
  ds_read_b64_tr_b16 v[60:61], v9 offset:19200
  v_mfma_f32_16x16x32_bf16 v[82:85], v[46:49], v[30:33], v[82:85]
  ds_read_b64_tr_b16 v[62:63], v10 offset:18432
  ds_read_b64_tr_b16 v[64:65], v10 offset:19200
  v_mfma_f32_16x16x32_bf16 v[74:77], v[50:53], v[26:29], v[74:77]
  v_mfma_f32_16x16x32_bf16 v[86:89], v[50:53], v[30:33], v[86:89]
  s_cmp_eq_u32 s35, 0
  s_cbranch_scc0 K1_SK_2a1
  v_mfma_f32_16x16x32_bf16 v[90:93], v[42:45], v[102:105], v[90:93]
  v_mfma_f32_16x16x32_bf16 v[94:97], v[46:49], v[102:105], v[94:97]
  v_mfma_f32_16x16x32_bf16 v[98:101], v[50:53], v[102:105], v[98:101]
K1_SK_2a1:
  s_waitcnt lgkmcnt(0)
  s_barrier
  v_mfma_f32_16x16x32_bf16 v[66:69], v[54:57], v[34:37], v[66:69]
  ds_read_b128 v[26:29], v4 offset:16384
  ds_read_b64_tr_b16 v[42:43], v8 offset:24576
  v_mfma_f32_16x16x32_bf16 v[78:81], v[54:57], v[38:41], v[78:81]
  ds_read_b64_tr_b16 v[44:45], v8 offset:25344
  ds_read_b128 v[30:33], v6 offset:16384
  v_mfma_f32_16x16x32_bf16 v[70:73], v[58:61], v[34:37], v[70:73]
  ds_read_b64_tr_b16 v[46:47], v9 offset:24576
  ds_read_b64_tr_b16 v[48:49], v9 offset:25344
  v_mfma_f32_16x16x32_bf16 v[82:85], v[58:61], v[38:41], v[82:85]
  ds_read_b64_tr_b16 v[50:51], v10 offset:24576
  ds_read_b64_tr_b16 v[52:53], v10 offset:25344
  v_mfma_f32_16x16x32_bf16 v[74:77], v[62:65], v[34:37], v[74:77]
  v_mfma_f32_16x16x32_bf16 v[86:89], v[62:65], v[38:41], v[86:89]
  s_cmp_eq_u32 s35, 1
  s_cbranch_scc0 K1_SK_2b1
  v_mfma_f32_16x16x32_bf16 v[90:93], v[54:57], v[102:105], v[90:93]
  v_mfma_f32_16x16x32_bf16 v[94:97], v[58:61], v[102:105], v[94:97]
  v_mfma_f32_16x16x32_bf16 v[98:101], v[62:65], v[102:105], v[98:101]
K1_SK_2b1:
  s_waitcnt lgkmcnt(0)
  v_mfma_f32_16x16x32_bf16 v[66:69], v[42:45], v[26:29], v[66:69]
  ds_read_b128 v[34:37], v5 offset:16384
  ds_read_b64_tr_b16 v[54:55], v8 offset:30720
  v_mfma_f32_16x16x32_bf16 v[78:81], v[42:45], v[30:33], v[78:81]
  ds_read_b64_tr_b16 v[56:57], v8 offset:31488
  ds_read_b128 v[38:41], v7 offset:16384
  v_mfma_f32_16x16x32_bf16 v[70:73], v[46:49], v[26:29], v[70:73]
  ds_read_b64_tr_b16 v[58:59], v9 offset:30720
  ds_read_b64_tr_b16 v[60:61], v9 offset:31488
  v_mfma_f32_16x16x32_bf16 v[82:85], v[46:49], v[30:33], v[82:85]
  ds_read_b64_tr_b16 v[62:63], v10 offset:30720
  ds_read_b64_tr_b16 v[64:65], v10 offset:31488
  v_mfma_f32_16x16x32_bf16 v[74:77], v[50:53], v[26:29], v[74:77]
  v_mfma_f32_16x16x32_bf16 v[86:89], v[50:53], v[30:33], v[86:89]
  s_cmp_eq_u32 s35, 0
  s_cbranch_scc0 K1_SK_2a2
  v_mfma_f32_16x16x32_bf16 v[90:93], v[42:45], v[102:105], v[90:93]
  v_mfma_f32_16x16x32_bf16 v[94:97], v[46:49], v[102:105], v[94:97]
  v_mfma_f32_16x16x32_bf16 v[98:101], v[50:53], v[102:105], v[98:101]
K1_SK_2a2:
  s_waitcnt lgkmcnt(0)
  s_barrier
  v_mfma_f32_16x16x32_bf16 v[66:69], v[54:57], v[34:37], v[66:69]
  ds_read_b128 v[26:29], v4 offset:24576
  ds_read_b64_tr_b16 v[42:43], v8 offset:36864
  v_mfma_f32_16x16x32_bf16 v[78:81], v[54:57], v[38:41], v[78:81]
  ds_read_b64_tr_b16 v[44:45], v8 offset:37632
  ds_read_b128 v[30:33], v6 offset:24576
  v_mfma_f32_16x16x32_bf16 v[70:73], v[58:61], v[34:37], v[70:73]
  ds_read_b64_tr_b16 v[46:47], v9 offset:36864
  ds_read_b64_tr_b16 v[48:49], v9 offset:37632
  v_mfma_f32_16x16x32_bf16 v[82:85], v[58:61], v[38:41], v[82:85]
  ds_read_b64_tr_b16 v[50:51], v10 offset:36864
  ds_read_b64_tr_b16 v[52:53], v10 offset:37632
  v_mfma_f32_16x16x32_bf16 v[74:77], v[62:65], v[34:37], v[74:77]
  v_mfma_f32_16x16x32_bf16 v[86:89], v[62:65], v[38:41], v[86:89]
  s_cmp_eq_u32 s35, 1
  s_cbranch_scc0 K1_SK_2b2
  v_mfma_f32_16x16x32_bf16 v[90:93], v[54:57], v[102:105], v[90:93]
  v_mfma_f32_16x16x32_bf16 v[94:97], v[58:61], v[102:105], v[94:97]
  v_mfma_f32_16x16x32_bf16 v[98:101], v[62:65], v[102:105], v[98:101]
K1_SK_2b2:
  s_waitcnt lgkmcnt(0)
  v_mfma_f32_16x16x32_bf16 v[66:69], v[42:45], v[26:29], v[66:69]
  ds_read_b128 v[34:37], v5 offset:24576
  ds_read_b64_tr_b16 v[54:55], v8 offset:43008
  v_mfma_f32_16x16x32_bf16 v[78:81], v[42:45], v[30:33], v[78:81]
  ds_read_b64_tr_b16 v[56:57], v8 offset:43776
  ds_read_b128 v[38:41], v7 offset:24576
  v_mfma_f32_16x16x32_bf16 v[70:73], v[46:49], v[26:29], v[70:73]
  ds_read_b64_tr_b16 v[58:59], v9 offset:43008
  ds_read_b64_tr_b16 v[60:61], v9 offset:43776
  v_mfma_f32_16x16x32_bf16 v[82:85], v[46:49], v[30:33], v[82:85]
  ds_read_b64_tr_b16 v[62:63], v10 offset:43008
  ds_read_b64_tr_b16 v[64:65], v10 offset:43776
  v_mfma_f32_16x16x32_bf16 v[74:77], v[50:53], v[26:29], v[74:77]
  v_mfma_f32_16x16x32_bf16 v[86:89], v[50:53], v[30:33], v[86:89]
  s_cmp_eq_u32 s35, 0
  s_cbranch_scc0 K1_SK_2a3
  v_mfma_f32_16x16x32_bf16 v[90:93], v[42:45], v[102:105], v[90:93]
  v_mfma_f32_16x16x32_bf16 v[94:97], v[46:49], v[102:105], v[94:97]
  v_mfma_f32_16x16x32_bf16 v[98:101], v[50:53], v[102:105], v[98:101]
K1_SK_2a3:
  s_waitcnt lgkmcnt(0)
  s_barrier
  v_mfma_f32_16x16x32_bf16 v[66:69], v[54:57], v[34:37], v[66:69]
  ds_read_b128 v[26:29], v4 offset:32768
  ds_read_b64_tr_b16 v[42:43], v8 offset:49152
  v_mfma_f32_16x16x32_bf16 v[78:81], v[54:57], v[38:41], v[78:81]
  ds_read_b64_tr_b16 v[44:45], v8 offset:49920
  ds_read_b128 v[30:33], v6 offset:32768
  v_mfma_f32_16x16x32_bf16 v[70:73], v[58:61], v[34:37], v[70:73]
  ds_read_b64_tr_b16 v[46:47], v9 offset:49152
  ds_read_b64_tr_b16 v[48:49], v9 offset:49920
  v_mfma_f32_16x16x32_bf16 v[82:85], v[58:61], v[38:41], v[82:85]
  ds_read_b64_tr_b16 v[50:51], v10 offset:49152
  ds_read_b64_tr_b16 v[52:53], v10 offset:49920
  v_mfma_f32_16x16x32_bf16 v[74:77], v[62:65], v[34:37], v[74:77]
  v_mfma_f32_16x16x32_bf16 v[86:89], v[62:65], v[38:41], v[86:89]
  s_cmp_eq_u32 s35, 1
  s_cbranch_scc0 K1_SK_2b3
  v_mfma_f32_16x16x32_bf16 v[90:93], v[54:57], v[102:105], v[90:93]
  v_mfma_f32_16x16x32_bf16 v[94:97], v[58:61], v[102:105], v[94:97]
  v_mfma_f32_16x16x32_bf16 v[98:101], v[62:65], v[102:105], v[98:101]
K1_SK_2b3:
  s_waitcnt lgkmcnt(0)
  v_mfma_f32_16x16x32_bf16 v[66:69], v[42:45], v[26:29], v[66:69]
  ds_read_b128 v[34:37], v5 offset:32768
  ds_read_b64_tr_b16 v[54:55], v8 offset:55296
  v_mfma_f32_16x16x32_bf16 v[78:81], v[42:45], v[30:33], v[78:81]
  ds_read_b64_tr_b16 v[56:57], v8 offset:56064
  ds_read_b128 v[38:41], v7 offset:32768
  v_mfma_f32_16x16x32_bf16 v[70:73], v[46:49], v[26:29], v[70:73]
  ds_read_b64_tr_b16 v[58:59], v9 offset:55296
  ds_read_b64_tr_b16 v[60:61], v9 offset:56064
  v_mfma_f32_16x16x32_bf16 v[82:85], v[46:49], v[30:33], v[82:85]
  ds_read_b64_tr_b16 v[62:63], v10 offset:55296
  ds_read_b64_tr_b16 v[64:65], v10 offset:56064
  v_mfma_f32_16x16x32_bf16 v[74:77], v[50:53], v[26:29], v[74:77]
  v_mfma_f32_16x16x32_bf16 v[86:89], v[50:53], v[30:33], v[86:89]
  s_cmp_eq_u32 s35, 0
  s_cbranch_scc0 K1_SK_2a4
  v_mfma_f32_16x16x32_bf16 v[90:93], v[42:45], v[102:105], v[90:93]
  v_mfma_f32_16x16x32_bf16 v[94:97], v[46:49], v[102:105], v[94:97]
  v_mfma_f32_16x16x32_bf16 v[98:101], v[50:53], v[102:105], v[98:101]
K1_SK_2a4:
  s_waitcnt lgkmcnt(0)
  s_barrier
  v_add_u32 v4, 40960, v4
  v_add_u32 v5, 40960, v5
  v_add_u32 v6, 40960, v6
  v_add_u32 v7, 40960, v7
  v_mfma_f32_16x16x32_bf16 v[66:69], v[54:57], v[34:37], v[66:69]
  ds_read_b128 v[26:29], v4 offset:0
  ds_read_b64_tr_b16 v[42:43], v8 offset:0
  v_mfma_f32_16x16x32_bf16 v[78:81], v[54:57], v[38:41], v[78:81]
  ds_read_b64_tr_b16 v[44:45], v8 offset:768
  ds_read_b128 v[30:33], v6 offset:0
  v_mfma_f32_16x16x32_bf16 v[70:73], v[58:61], v[34:37], v[70:73]
  ds_read_b64_tr_b16 v[46:47], v9 offset:0
  ds_read_b64_tr_b16 v[48:49], v9 offset:768
  v_mfma_f32_16x16x32_bf16 v[82:85], v[58:61], v[38:41], v[82:85]
  ds_read_b64_tr_b16 v[50:51], v10 offset:0
  ds_read_b64_tr_b16 v[52:53], v10 offset:768
  v_mfma_f32_16x16x32_bf16 v[74:77], v[62:65], v[34:37], v[74:77]
  v_mfma_f32_16x16x32_bf16 v[86:89], v[62:65], v[38:41], v[86:89]
  s_cmp_eq_u32 s35, 1
  s_cbranch_scc0 K1_SK_2b4
  v_mfma_f32_16x16x32_bf16 v[90:93], v[54:57], v[102:105], v[90:93]
  v_mfma_f32_16x16x32_bf16 v[94:97], v[58:61], v[102:105], v[94:97]
  v_mfma_f32_16x16x32_bf16 v[98:101], v[62:65], v[102:105], v[98:101]
K1_SK_2b4:
  s_add_u32 s37, s37, 1
  s_cmp_lt_u32 s37, 2
  s_cbranch_scc1 K1_LOOP2
  s_mul_i32 s40, s55, 192
  s_add_u32 s40, s40, 144640
  v_lshlrev_b32 v18, 4, v2
  v_add_u32 v19, s40, v18
  s_mov_b32 exec_lo, 0x10001
  s_mov_b32 exec_hi, 0x10001
  ds_write_b128 v19, v[90:93] offset:0
  ds_write_b128 v19, v[94:97] offset:64
  ds_write_b128 v19, v[98:101] offset:128
  s_mov_b64 exec, s[52:53]
  v_mov_b32 v126, 0xc0135761
  v_mov_b32 v127, 0xc0135761
  s_waitcnt lgkmcnt(0)
  s_barrier
  s_xor_b32 s41, s55, 2
  s_mul_i32 s41, s41, 192
  s_add_u32 s41, s41, 144640
  v_add_u32 v19, s41, v18
  ds_read_b128 v[26:29], v19 offset:0
  ds_read_b128 v[30:33], v19 offset:64
  ds_read_b128 v[34:37], v19 offset:128
  s_lshl_b32 s40, s35, 7
  s_lshl_b32 s41, s36, 6
  s_add_u32 s40, s40, s41
  s_add_u32 s40, s40, 143360
  v_lshlrev_b32 v20, 2, v3
  v_add_u32 v20, s40, v20
  v_xor_b32 v21, 64, v20
  ds_read_b32 v42, v20
  ds_read_b32 v44, v21
  ds_read_b32 v46, v20 offset:256
  ds_read_b32 v48, v21 offset:256
  s_lshl_b32 s40, s32, 2
  s_lshl_b32 s41, s35, 1
  s_add_u32 s40, s40, s41
  s_add_u32 s41, s40, s36
  s_xor_b32 s42, s41, 1
  s_mul_i32 s39, s33, 6
  s_mul_i32 s38, s36, 3
  s_add_u32 s39, s39, s38
  s_mul_i32 s41, s41, 48
  s_add_u32 s41, s41, s39
  s_lshl_b32 s41, s41, 9
  s_add_u32 s41, s41, 0
  s_mul_i32 s42, s42, 48
  s_add_u32 s42, s42, s39
  s_lshl_b32 s42, s42, 9
  s_add_u32 s42, s42, 0
  v_lshlrev_b32 v20, 3, v1
  s_waitcnt lgkmcnt(0)
  v_add_f32 v26, v26, v90
  v_sub_f32 v26, 0, v26
  v_add_f32 v27, v27, v91
  v_sub_f32 v27, 0, v27
  v_add_f32 v28, v28, v92
  v_sub_f32 v28, 0, v28
  v_add_f32 v29, v29, v93
  v_sub_f32 v29, 0, v29
  v_add_f32 v30, v30, v94
  v_sub_f32 v30, 0, v30
  v_add_f32 v31, v31, v95
  v_sub_f32 v31, 0, v31
  v_add_f32 v32, v32, v96
  v_sub_f32 v32, 0, v32
  v_add_f32 v33, v33, v97
  v_sub_f32 v33, 0, v33
  v_add_f32 v34, v34, v98
  v_sub_f32 v34, 0, v34
  v_add_f32 v35, v35, v99
  v_sub_f32 v35, 0, v35
  v_add_f32 v36, v36, v100
  v_sub_f32 v36, 0, v36
  v_add_f32 v37, v37, v101
  v_sub_f32 v37, 0, v37
  v_pk_fma_f32 v[66:67], v[26:27], v[42:43], v[66:67] op_sel_hi:[1,0,1]
  v_pk_mul_f32 v[66:67], v[66:67], v[46:47] op_sel_hi:[1,0]
  v_pk_mul_f32 v[128:129], v[66:67], v[66:67]
  v_pk_fma_f32 v[128:129], v[128:129], s[48:49], v[126:127]
  v_pk_mul_f32 v[128:129], v[128:129], v[66:67]
  v_exp_f32 v128, v128
  v_exp_f32 v129, v129
  s_nop 0
  v_pk_add_f32 v[128:129], v[128:129], s[50:51]
  v_rcp_f32 v128, v128
  v_rcp_f32 v129, v129
  s_nop 0
  v_pk_mul_f32 v[128:129], v[128:129], v[66:67]
  v_cvt_pk_bf16_f32 v114, v128, v129
  v_pk_fma_f32 v[68:69], v[28:29], v[42:43], v[68:69] op_sel_hi:[1,0,1]
  v_pk_mul_f32 v[68:69], v[68:69], v[46:47] op_sel_hi:[1,0]
  v_pk_mul_f32 v[132:133], v[68:69], v[68:69]
  v_pk_fma_f32 v[132:133], v[132:133], s[48:49], v[126:127]
  v_pk_mul_f32 v[132:133], v[132:133], v[68:69]
  v_exp_f32 v132, v132
  v_exp_f32 v133, v133
  s_nop 0
  v_pk_add_f32 v[132:133], v[132:133], s[50:51]
  v_rcp_f32 v132, v132
  v_rcp_f32 v133, v133
  s_nop 0
  v_pk_mul_f32 v[132:133], v[132:133], v[68:69]
  v_cvt_pk_bf16_f32 v115, v132, v133
  buffer_store_dwordx2 v[114:115], v20, s[16:19], s41 offen offset:0
  v_pk_fma_f32 v[70:71], v[30:31], v[42:43], v[70:71] op_sel_hi:[1,0,1]
  v_pk_mul_f32 v[70:71], v[70:71], v[46:47] op_sel_hi:[1,0]
  v_pk_mul_f32 v[128:129], v[70:71], v[70:71]
  v_pk_fma_f32 v[128:129], v[128:129], s[48:49], v[126:127]
  v_pk_mul_f32 v[128:129], v[128:129], v[70:71]
  v_exp_f32 v128, v128
  v_exp_f32 v129, v129
  s_nop 0
  v_pk_add_f32 v[128:129], v[128:129], s[50:51]
  v_rcp_f32 v128, v128
  v_rcp_f32 v129, v129
  s_nop 0
  v_pk_mul_f32 v[128:129], v[128:129], v[70:71]
  v_cvt_pk_bf16_f32 v116, v128, v129
  v_pk_fma_f32 v[72:73], v[32:33], v[42:43], v[72:73] op_sel_hi:[1,0,1]
  v_pk_mul_f32 v[72:73], v[72:73], v[46:47] op_sel_hi:[1,0]
  v_pk_mul_f32 v[132:133], v[72:73], v[72:73]
  v_pk_fma_f32 v[132:133], v[132:133], s[48:49], v[126:127]
  v_pk_mul_f32 v[132:133], v[132:133], v[72:73]
  v_exp_f32 v132, v132
  v_exp_f32 v133, v133
  s_nop 0
  v_pk_add_f32 v[132:133], v[132:133], s[50:51]
  v_rcp_f32 v132, v132
  v_rcp_f32 v133, v133
  s_nop 0
  v_pk_mul_f32 v[132:133], v[132:133], v[72:73]
  v_cvt_pk_bf16_f32 v117, v132, v133
  buffer_store_dwordx2 v[116:117], v20, s[16:19], s41 offen offset:512
  v_pk_fma_f32 v[74:75], v[34:35], v[42:43], v[74:75] op_sel_hi:[1,0,1]
  v_pk_mul_f32 v[74:75], v[74:75], v[46:47] op_sel_hi:[1,0]
  v_pk_mul_f32 v[128:129], v[74:75], v[74:75]
  v_pk_fma_f32 v[128:129], v[128:129], s[48:49], v[126:127]
  v_pk_mul_f32 v[128:129], v[128:129], v[74:75]
  v_exp_f32 v128, v128
  v_exp_f32 v129, v129
  s_nop 0
  v_pk_add_f32 v[128:129], v[128:129], s[50:51]
  v_rcp_f32 v128, v128
  v_rcp_f32 v129, v129
  s_nop 0
  v_pk_mul_f32 v[128:129], v[128:129], v[74:75]
  v_cvt_pk_bf16_f32 v118, v128, v129
  v_pk_fma_f32 v[76:77], v[36:37], v[42:43], v[76:77] op_sel_hi:[1,0,1]
  v_pk_mul_f32 v[76:77], v[76:77], v[46:47] op_sel_hi:[1,0]
  v_pk_mul_f32 v[132:133], v[76:77], v[76:77]
  v_pk_fma_f32 v[132:133], v[132:133], s[48:49], v[126:127]
  v_pk_mul_f32 v[132:133], v[132:133], v[76:77]
  v_exp_f32 v132, v132
  v_exp_f32 v133, v133
  s_nop 0
  v_pk_add_f32 v[132:133], v[132:133], s[50:51]
  v_rcp_f32 v132, v132
  v_rcp_f32 v133, v133
  s_nop 0
  v_pk_mul_f32 v[132:133], v[132:133], v[76:77]
  v_cvt_pk_bf16_f32 v119, v132, v133
  buffer_store_dwordx2 v[118:119], v20, s[16:19], s41 offen offset:1024
  v_pk_fma_f32 v[78:79], v[26:27], v[44:45], v[78:79] op_sel_hi:[1,0,1]
  v_pk_mul_f32 v[78:79], v[78:79], v[48:49] op_sel_hi:[1,0]
  v_pk_mul_f32 v[128:129], v[78:79], v[78:79]
  v_pk_fma_f32 v[128:129], v[128:129], s[48:49], v[126:127]
  v_pk_mul_f32 v[128:129], v[128:129], v[78:79]
  v_exp_f32 v128, v128
  v_exp_f32 v129, v129
  s_nop 0
  v_pk_add_f32 v[128:129], v[128:129], s[50:51]
  v_rcp_f32 v128, v128
  v_rcp_f32 v129, v129
  s_nop 0
  v_pk_mul_f32 v[128:129], v[128:129], v[78:79]
  v_cvt_pk_bf16_f32 v120, v128, v129
  v_pk_fma_f32 v[80:81], v[28:29], v[44:45], v[80:81] op_sel_hi:[1,0,1]
  v_pk_mul_f32 v[80:81], v[80:81], v[48:49] op_sel_hi:[1,0]
  v_pk_mul_f32 v[132:133], v[80:81], v[80:81]
  v_pk_fma_f32 v[132:133], v[132:133], s[48:49], v[126:127]
  v_pk_mul_f32 v[132:133], v[132:133], v[80:81]
  v_exp_f32 v132, v132
  v_exp_f32 v133, v133
  s_nop 0
  v_pk_add_f32 v[132:133], v[132:133], s[50:51]
  v_rcp_f32 v132, v132
  v_rcp_f32 v133, v133
  s_nop 0
  v_pk_mul_f32 v[132:133], v[132:133], v[80:81]
  v_cvt_pk_bf16_f32 v121, v132, v133
  buffer_store_dwordx2 v[120:121], v20, s[16:19], s42 offen offset:0
  v_pk_fma_f32 v[82:83], v[30:31], v[44:45], v[82:83] op_sel_hi:[1,0,1]
  v_pk_mul_f32 v[82:83], v[82:83], v[48:49] op_sel_hi:[1,0]
  v_pk_mul_f32 v[128:129], v[82:83], v[82:83]
  v_pk_fma_f32 v[128:129], v[128:129], s[48:49], v[126:127]
  v_pk_mul_f32 v[128:129], v[128:129], v[82:83]
  v_exp_f32 v128, v128
  v_exp_f32 v129, v129
  s_nop 0
  v_pk_add_f32 v[128:129], v[128:129], s[50:51]
  v_rcp_f32 v128, v128
  v_rcp_f32 v129, v129
  s_nop 0
  v_pk_mul_f32 v[128:129], v[128:129], v[82:83]
  v_cvt_pk_bf16_f32 v122, v128, v129
  v_pk_fma_f32 v[84:85], v[32:33], v[44:45], v[84:85] op_sel_hi:[1,0,1]
  v_pk_mul_f32 v[84:85], v[84:85], v[48:49] op_sel_hi:[1,0]
  v_pk_mul_f32 v[132:133], v[84:85], v[84:85]
  v_pk_fma_f32 v[132:133], v[132:133], s[48:49], v[126:127]
  v_pk_mul_f32 v[132:133], v[132:133], v[84:85]
  v_exp_f32 v132, v132
  v_exp_f32 v133, v133
  s_nop 0
  v_pk_add_f32 v[132:133], v[132:133], s[50:51]
  v_rcp_f32 v132, v132
  v_rcp_f32 v133, v133
  s_nop 0
  v_pk_mul_f32 v[132:133], v[132:133], v[84:85]
  v_cvt_pk_bf16_f32 v123, v132, v133
  buffer_store_dwordx2 v[122:123], v20, s[16:19], s42 offen offset:512
  v_pk_fma_f32 v[86:87], v[34:35], v[44:45], v[86:87] op_sel_hi:[1,0,1]
  v_pk_mul_f32 v[86:87], v[86:87], v[48:49] op_sel_hi:[1,0]
  v_pk_mul_f32 v[128:129], v[86:87], v[86:87]
  v_pk_fma_f32 v[128:129], v[128:129], s[48:49], v[126:127]
  v_pk_mul_f32 v[128:129], v[128:129], v[86:87]
  v_exp_f32 v128, v128
  v_exp_f32 v129, v129
  s_nop 0
  v_pk_add_f32 v[128:129], v[128:129], s[50:51]
  v_rcp_f32 v128, v128
  v_rcp_f32 v129, v129
  s_nop 0
  v_pk_mul_f32 v[128:129], v[128:129], v[86:87]
  v_cvt_pk_bf16_f32 v124, v128, v129
  v_pk_fma_f32 v[88:89], v[36:37], v[44:45], v[88:89] op_sel_hi:[1,0,1]
  v_pk_mul_f32 v[88:89], v[88:89], v[48:49] op_sel_hi:[1,0]
  v_pk_mul_f32 v[132:133], v[88:89], v[88:89]
  v_pk_fma_f32 v[132:133], v[132:133], s[48:49], v[126:127]
  v_pk_mul_f32 v[132:133], v[132:133], v[88:89]
  v_exp_f32 v132, v132
  v_exp_f32 v133, v133
  s_nop 0
  v_pk_add_f32 v[132:133], v[132:133], s[50:51]
  v_rcp_f32 v132, v132
  v_rcp_f32 v133, v133
  s_nop 0
  v_pk_mul_f32 v[132:133], v[132:133], v[88:89]
  v_cvt_pk_bf16_f32 v125, v132, v133
  buffer_store_dwordx2 v[124:125], v20, s[16:19], s42 offen offset:1024
K1_END:
  s_endpgm

.section .rodata,"a"
.p2align 6
.amdhsa_kernel k1_kernel
  .amdhsa_next_free_vgpr 168
  .amdhsa_next_free_sgpr 96
  .amdhsa_accum_offset 168
  .amdhsa_group_segment_fixed_size 0
  .amdhsa_kernarg_size 112
  .amdhsa_user_sgpr_count 2
  .amdhsa_user_sgpr_kernarg_segment_ptr 1
  .amdhsa_system_sgpr_workgroup_id_x 1
  .amdhsa_float_denorm_mode_32 3
.end_amdhsa_kernel
.text
.globl k2_kernel
.p2align 8
.type k2_kernel,@function
k2_kernel:
  s_cmp_ge_u32 s2, 470
  s_cbranch_scc1 K2_END
  s_cmp_ge_u32 s2, 256
  s_cbranch_scc1 K2_CONV
  s_load_dwordx4 s[36:39], s[0:1], 64
  s_load_dwordx2 s[40:41], s[0:1], 104
  v_and_b32 v1, 63, v0
  v_lshrrev_b32 v14, 6, v0
  v_lshrrev_b32 v2, 4, v1
  v_readfirstlane_b32 s22, v14
  v_and_b32 v3, 15, v1
  s_and_b32 s28, s2, 7
  s_lshr_b32 s29, s2, 3
  s_lshr_b32 s20, s28, 1
  s_lshl_b32 s20, s20, 3
  s_lshr_b32 s30, s29, 2
  s_add_u32 s20, s20, s30
  s_and_b32 s21, s28, 1
  s_lshl_b32 s21, s21, 2
  s_and_b32 s30, s29, 3
  s_add_u32 s21, s21, s30
  s_and_b32 s23, s22, 1
  s_lshr_b32 s24, s22, 1
  s_mov_b32 s32, 0xffff0000
  s_lshl_b32 s28, s20, 6
  s_lshl_b32 s29, s22, 4
  s_add_u32 s28, s28, s29
  v_add_u32 v14, 0, v2
  v_xor_b32 v15, v14, v3
  v_lshlrev_b32 v15, 4, v15
  v_add_u32 v14, s28, v14
  v_lshlrev_b32 v14, 12, v14
  v_add_u32 v4, v14, v15
  v_add_u32 v14, 4, v2
  v_xor_b32 v15, v14, v3
  v_lshlrev_b32 v15, 4, v15
  v_add_u32 v14, s28, v14
  v_lshlrev_b32 v14, 12, v14
  v_add_u32 v5, v14, v15
  v_add_u32 v14, 8, v2
  v_xor_b32 v15, v14, v3
  v_lshlrev_b32 v15, 4, v15
  v_add_u32 v14, s28, v14
  v_lshlrev_b32 v14, 12, v14
  v_add_u32 v6, v14, v15
  v_add_u32 v14, 12, v2
  v_xor_b32 v15, v14, v3
  v_lshlrev_b32 v15, 4, v15
  v_add_u32 v14, s28, v14
  v_lshlrev_b32 v14, 12, v14
  v_add_u32 v7, v14, v15
  v_xor_b32 v14, v2, v3
  v_lshlrev_b32 v14, 4, v14
  s_lshl_b32 s28, s24, 6
  v_xor_b32 v14, s28, v14
  v_lshlrev_b32 v15, 8, v3
  v_add_u32 v8, v14, v15
  v_xor_b32 v9, 128, v8
  s_mul_i32 s28, s21, 6
  s_mul_i32 s29, s23, 3
  s_add_u32 s28, s28, s29
  s_mov_b32 s31, s28
  s_mov_b32 s33, s28
  s_lshl_b32 s28, s28, 16
  s_add_u32 s28, s28, 3145728
  v_lshlrev_b32 v14, 4, v1
  s_add_u32 s29, s28, 0
  v_add_u32 v10, s29, v14
  s_add_u32 s29, s28, 65536
  v_add_u32 v11, s29, v14
  s_add_u32 s29, s28, 131072
  v_add_u32 v12, s29, v14
  s_waitcnt lgkmcnt(0)
  s_mov_b32 s8, s36
  s_and_b32 s9, s37, 0xffff
  s_mov_b32 s10, 8388608
  s_mov_b32 s11, 0x20000
  s_mov_b32 s16, s38
  s_and_b32 s17, s39, 0xffff
  s_mov_b32 s18, 4096
  s_mov_b32 s19, 0x20000
  s_mov_b32 s12, s40
  s_and_b32 s13, s41, 0xffff
  s_mov_b32 s14, 18874368
  s_mov_b32 s15, 0x20000
  s_and_b32 s28, s20, 7
  s_lshl_b32 s28, s28, 1
  s_and_b32 s29, s21, 3
  s_mul_i32 s29, s29, 5
  s_add_u32 s41, s28, s29
  s_mov_b32 s41, 0
  s_lshl_b32 s31, s22, 12
  s_lshl_b32 s40, s24, 10
  s_mov_b32 s25, 0
  s_add_u32 s29, s25, 0
  s_add_u32 s30, s29, s41
  s_and_b32 s30, s30, 15
  s_lshl_b32 s26, s30, 8
  s_lshl_b32 s27, s30, 12
  s_add_u32 s27, s27, s40
  s_cmp_lt_u32 s29, 16
  s_cselect_b32 s26, s26, 0x80000000
  s_cselect_b32 s27, s27, 0x80000000
  s_add_u32 s35, s27, 2048
  buffer_load_dwordx4 v[120:123], v10, s[12:15], s27 offen
  buffer_load_dwordx4 v[124:127], v11, s[12:15], s27 offen
  buffer_load_dwordx4 v[128:131], v12, s[12:15], s27 offen
  s_add_u32 m0, s31, 0
  s_nop 0
  buffer_load_dwordx4 v4, s[8:11], s26 offen lds
  s_add_u32 m0, s31, 1024
  s_nop 0
  buffer_load_dwordx4 v5, s[8:11], s26 offen lds
  buffer_load_dwordx4 v[132:135], v10, s[12:15], s35 offen
  buffer_load_dwordx4 v[136:139], v11, s[12:15], s35 offen
  buffer_load_dwordx4 v[140:143], v12, s[12:15], s35 offen
  s_add_u32 m0, s31, 2048
  s_nop 0
  buffer_load_dwordx4 v6, s[8:11], s26 offen lds
  s_add_u32 m0, s31, 3072
  s_nop 0
  buffer_load_dwordx4 v7, s[8:11], s26 offen lds
  s_add_u32 s29, s25, 1
  s_add_u32 s30, s29, s41
  s_and_b32 s30, s30, 15
  s_lshl_b32 s26, s30, 8
  s_lshl_b32 s27, s30, 12
  s_add_u32 s27, s27, s40
  s_cmp_lt_u32 s29, 16
  s_cselect_b32 s26, s26, 0x80000000
  s_cselect_b32 s27, s27, 0x80000000
  s_add_u32 s35, s27, 2048
  buffer_load_dwordx4 v[144:147], v10, s[12:15], s27 offen
  buffer_load_dwordx4 v[148:151], v11, s[12:15], s27 offen
  buffer_load_dwordx4 v[152:155], v12, s[12:15], s27 offen
  s_add_u32 m0, s31, 16384
  s_nop 0
  buffer_load_dwordx4 v4, s[8:11], s26 offen lds
  s_add_u32 m0, s31, 17408
  s_nop 0
  buffer_load_dwordx4 v5, s[8:11], s26 offen lds
  buffer_load_dwordx4 v[156:159], v10, s[12:15], s35 offen
  buffer_load_dwordx4 v[160:163], v11, s[12:15], s35 offen
  buffer_load_dwordx4 v[164:167], v12, s[12:15], s35 offen
  s_add_u32 m0, s31, 18432
  s_nop 0
  buffer_load_dwordx4 v6, s[8:11], s26 offen lds
  s_add_u32 m0, s31, 19456
  s_nop 0
  buffer_load_dwordx4 v7, s[8:11], s26 offen lds
  s_add_u32 s29, s25, 2
  s_add_u32 s30, s29, s41
  s_and_b32 s30, s30, 15
  s_lshl_b32 s26, s30, 8
  s_lshl_b32 s27, s30, 12
  s_add_u32 s27, s27, s40
  s_cmp_lt_u32 s29, 16
  s_cselect_b32 s26, s26, 0x80000000
  s_cselect_b32 s27, s27, 0x80000000
  s_add_u32 s35, s27, 2048
  buffer_load_dwordx4 v[168:171], v10, s[12:15], s27 offen
  buffer_load_dwordx4 v[172:175], v11, s[12:15], s27 offen
  buffer_load_dwordx4 v[176:179], v12, s[12:15], s27 offen
  s_add_u32 m0, s31, 32768
  s_nop 0
  buffer_load_dwordx4 v4, s[8:11], s26 offen lds
  s_add_u32 m0, s31, 33792
  s_nop 0
  buffer_load_dwordx4 v5, s[8:11], s26 offen lds
  buffer_load_dwordx4 v[180:183], v10, s[12:15], s35 offen
  buffer_load_dwordx4 v[184:187], v11, s[12:15], s35 offen
  buffer_load_dwordx4 v[188:191], v12, s[12:15], s35 offen
  s_add_u32 m0, s31, 34816
  s_nop 0
  buffer_load_dwordx4 v6, s[8:11], s26 offen lds
  s_add_u32 m0, s31, 35840
  s_nop 0
  buffer_load_dwordx4 v7, s[8:11], s26 offen lds
  s_lshl_b32 s28, s20, 2
  s_lshl_b32 s29, s24, 1
  s_add_u32 s28, s28, s29
  s_mov_b32 s34, s28
  s_mul_i32 s29, s28, 48
  s_add_u32 s29, s29, s33
  s_lshl_b32 s29, s29, 9
  s_add_u32 s29, s29, 0
  s_add_u32 s30, s29, 24576
  v_lshlrev_b32 v14, 3, v1
  buffer_load_dwordx2 v[24:25], v14, s[12:15], s29 offen offset:0
  buffer_load_dwordx2 v[26:27], v14, s[12:15], s29 offen offset:512
  buffer_load_dwordx2 v[28:29], v14, s[12:15], s29 offen offset:1024
  buffer_load_dwordx2 v[30:31], v14, s[12:15], s30 offen offset:0
  buffer_load_dwordx2 v[32:33], v14, s[12:15], s30 offen offset:512
  buffer_load_dwordx2 v[34:35], v14, s[12:15], s30 offen offset:1024
  v_lshlrev_b32 v15, 1, v3
  s_lshl_b32 s28, s28, 5
  buffer_load_ushort v36, v15, s[16:19], s28 offen
  buffer_load_ushort v37, v15, s[16:19], s28 offen offset:32
  v_mov_b32 v72, 0
  v_mov_b32 v73, 0
  v_mov_b32 v74, 0
  v_mov_b32 v75, 0
  v_mov_b32 v76, 0
  v_mov_b32 v77, 0
  v_mov_b32 v78, 0
  v_mov_b32 v79, 0
  v_mov_b32 v80, 0
  v_mov_b32 v81, 0
  v_mov_b32 v82, 0
  v_mov_b32 v83, 0
  v_mov_b32 v84, 0
  v_mov_b32 v85, 0
  v_mov_b32 v86, 0
  v_mov_b32 v87, 0
  v_mov_b32 v88, 0
  v_mov_b32 v89, 0
  v_mov_b32 v90, 0
  v_mov_b32 v91, 0
  v_mov_b32 v92, 0
  v_mov_b32 v93, 0
  v_mov_b32 v94, 0
  v_mov_b32 v95, 0
  v_mov_b32 v96, 0
  v_mov_b32 v97, 0
  v_mov_b32 v98, 0
  v_mov_b32 v99, 0
  v_mov_b32 v100, 0
  v_mov_b32 v101, 0
  v_mov_b32 v102, 0
  v_mov_b32 v103, 0
  v_mov_b32 v104, 0
  v_mov_b32 v105, 0
  v_mov_b32 v106, 0
  v_mov_b32 v107, 0
  v_mov_b32 v108, 0
  v_mov_b32 v109, 0
  v_mov_b32 v110, 0
  v_mov_b32 v111, 0
  v_mov_b32 v112, 0
  v_mov_b32 v113, 0
  v_mov_b32 v114, 0
  v_mov_b32 v115, 0
  v_mov_b32 v116, 0
  v_mov_b32 v117, 0
  v_mov_b32 v118, 0
  v_mov_b32 v119, 0
  s_waitcnt vmcnt(28)
  s_barrier
  ds_read_b128 v[40:43], v8 offset:0
  ds_read_b128 v[44:47], v8 offset:4096
  ds_read_b128 v[48:51], v8 offset:8192
  ds_read_b128 v[52:55], v8 offset:12288
K2_LOOP:
  s_add_u32 s29, s25, 3
  s_add_u32 s30, s29, s41
  s_and_b32 s30, s30, 15
  s_lshl_b32 s26, s30, 8
  s_lshl_b32 s27, s30, 12
  s_add_u32 s27, s27, s40
  s_cmp_lt_u32 s29, 16
  s_cselect_b32 s26, s26, 0x80000000
  s_cselect_b32 s27, s27, 0x80000000
  s_add_u32 s35, s27, 2048
  s_waitcnt lgkmcnt(0)
  v_mfma_f32_16x16x32_bf16 v[72:75], v[120:123], v[40:43], v[72:75]
  ds_read_b128 v[56:59], v9 offset:0
  v_mfma_f32_16x16x32_bf16 v[88:91], v[124:127], v[40:43], v[88:91]
  ds_read_b128 v[60:63], v9 offset:4096
  v_mfma_f32_16x16x32_bf16 v[104:107], v[128:131], v[40:43], v[104:107]
  ds_read_b128 v[64:67], v9 offset:8192
  buffer_load_dwordx4 v[192:195], v10, s[12:15], s27 offen
  v_mfma_f32_16x16x32_bf16 v[76:79], v[120:123], v[44:47], v[76:79]
  ds_read_b128 v[68:71], v9 offset:12288
  v_mfma_f32_16x16x32_bf16 v[92:95], v[124:127], v[44:47], v[92:95]
  buffer_load_dwordx4 v[196:199], v11, s[12:15], s27 offen
  v_mfma_f32_16x16x32_bf16 v[108:111], v[128:131], v[44:47], v[108:111]
  v_mfma_f32_16x16x32_bf16 v[80:83], v[120:123], v[48:51], v[80:83]
  buffer_load_dwordx4 v[200:203], v12, s[12:15], s27 offen
  v_mfma_f32_16x16x32_bf16 v[96:99], v[124:127], v[48:51], v[96:99]
  v_mfma_f32_16x16x32_bf16 v[112:115], v[128:131], v[48:51], v[112:115]
  s_add_u32 m0, s31, 49152
  s_nop 0
  buffer_load_dwordx4 v4, s[8:11], s26 offen lds
  v_mfma_f32_16x16x32_bf16 v[84:87], v[120:123], v[52:55], v[84:87]
  v_mfma_f32_16x16x32_bf16 v[100:103], v[124:127], v[52:55], v[100:103]
  s_add_u32 m0, s31, 50176
  s_nop 0
  buffer_load_dwordx4 v5, s[8:11], s26 offen lds
  v_mfma_f32_16x16x32_bf16 v[116:119], v[128:131], v[52:55], v[116:119]
  s_waitcnt vmcnt(15) lgkmcnt(0)
  s_barrier
  v_mfma_f32_16x16x32_bf16 v[72:75], v[132:135], v[56:59], v[72:75]
  ds_read_b128 v[40:43], v8 offset:16384
  v_mfma_f32_16x16x32_bf16 v[88:91], v[136:139], v[56:59], v[88:91]
  ds_read_b128 v[44:47], v8 offset:20480
  v_mfma_f32_16x16x32_bf16 v[104:107], v[140:143], v[56:59], v[104:107]
  ds_read_b128 v[48:51], v8 offset:24576
  buffer_load_dwordx4 v[204:207], v10, s[12:15], s35 offen
  v_mfma_f32_16x16x32_bf16 v[76:79], v[132:135], v[60:63], v[76:79]
  ds_read_b128 v[52:55], v8 offset:28672
  v_mfma_f32_16x16x32_bf16 v[92:95], v[136:139], v[60:63], v[92:95]
  buffer_load_dwordx4 v[208:211], v11, s[12:15], s35 offen
  v_mfma_f32_16x16x32_bf16 v[108:111], v[140:143], v[60:63], v[108:111]
  v_mfma_f32_16x16x32_bf16 v[80:83], v[132:135], v[64:67], v[80:83]
  buffer_load_dwordx4 v[212:215], v12, s[12:15], s35 offen
  v_mfma_f32_16x16x32_bf16 v[96:99], v[136:139], v[64:67], v[96:99]
  v_mfma_f32_16x16x32_bf16 v[112:115], v[140:143], v[64:67], v[112:115]
  s_add_u32 m0, s31, 51200
  s_nop 0
  buffer_load_dwordx4 v6, s[8:11], s26 offen lds
  v_mfma_f32_16x16x32_bf16 v[84:87], v[132:135], v[68:71], v[84:87]
  v_mfma_f32_16x16x32_bf16 v[100:103], v[136:139], v[68:71], v[100:103]
  s_add_u32 m0, s31, 52224
  s_nop 0
  buffer_load_dwordx4 v7, s[8:11], s26 offen lds
  v_mfma_f32_16x16x32_bf16 v[116:119], v[140:143], v[68:71], v[116:119]
  s_add_u32 s29, s25, 4
  s_add_u32 s30, s29, s41
  s_and_b32 s30, s30, 15
  s_lshl_b32 s26, s30, 8
  s_lshl_b32 s27, s30, 12
  s_add_u32 s27, s27, s40
  s_cmp_lt_u32 s29, 16
  s_cselect_b32 s26, s26, 0x80000000
  s_cselect_b32 s27, s27, 0x80000000
  s_add_u32 s35, s27, 2048
  s_waitcnt lgkmcnt(0)
  v_mfma_f32_16x16x32_bf16 v[72:75], v[144:147], v[40:43], v[72:75]
  ds_read_b128 v[56:59], v9 offset:16384
  v_mfma_f32_16x16x32_bf16 v[88:91], v[148:151], v[40:43], v[88:91]
  ds_read_b128 v[60:63], v9 offset:20480
  v_mfma_f32_16x16x32_bf16 v[104:107], v[152:155], v[40:43], v[104:107]
  ds_read_b128 v[64:67], v9 offset:24576
  buffer_load_dwordx4 v[120:123], v10, s[12:15], s27 offen
  v_mfma_f32_16x16x32_bf16 v[76:79], v[144:147], v[44:47], v[76:79]
  ds_read_b128 v[68:71], v9 offset:28672
  v_mfma_f32_16x16x32_bf16 v[92:95], v[148:151], v[44:47], v[92:95]
  buffer_load_dwordx4 v[124:127], v11, s[12:15], s27 offen
  v_mfma_f32_16x16x32_bf16 v[108:111], v[152:155], v[44:47], v[108:111]
  v_mfma_f32_16x16x32_bf16 v[80:83], v[144:147], v[48:51], v[80:83]
  buffer_load_dwordx4 v[128:131], v12, s[12:15], s27 offen
  v_mfma_f32_16x16x32_bf16 v[96:99], v[148:151], v[48:51], v[96:99]
  v_mfma_f32_16x16x32_bf16 v[112:115], v[152:155], v[48:51], v[112:115]
  s_add_u32 m0, s31, 0
  s_nop 0
  buffer_load_dwordx4 v4, s[8:11], s26 offen lds
  v_mfma_f32_16x16x32_bf16 v[84:87], v[144:147], v[52:55], v[84:87]
  v_mfma_f32_16x16x32_bf16 v[100:103], v[148:151], v[52:55], v[100:103]
  s_add_u32 m0, s31, 1024
  s_nop 0
  buffer_load_dwordx4 v5, s[8:11], s26 offen lds
  v_mfma_f32_16x16x32_bf16 v[116:119], v[152:155], v[52:55], v[116:119]
  s_waitcnt vmcnt(15) lgkmcnt(0)
  s_barrier
  v_mfma_f32_16x16x32_bf16 v[72:75], v[156:159], v[56:59], v[72:75]
  ds_read_b128 v[40:43], v8 offset:32768
  v_mfma_f32_16x16x32_bf16 v[88:91], v[160:163], v[56:59], v[88:91]
  ds_read_b128 v[44:47], v8 offset:36864
  v_mfma_f32_16x16x32_bf16 v[104:107], v[164:167], v[56:59], v[104:107]
  ds_read_b128 v[48:51], v8 offset:40960
  buffer_load_dwordx4 v[132:135], v10, s[12:15], s35 offen
  v_mfma_f32_16x16x32_bf16 v[76:79], v[156:159], v[60:63], v[76:79]
  ds_read_b128 v[52:55], v8 offset:45056
  v_mfma_f32_16x16x32_bf16 v[92:95], v[160:163], v[60:63], v[92:95]
  buffer_load_dwordx4 v[136:139], v11, s[12:15], s35 offen
  v_mfma_f32_16x16x32_bf16 v[108:111], v[164:167], v[60:63], v[108:111]
  v_mfma_f32_16x16x32_bf16 v[80:83], v[156:159], v[64:67], v[80:83]
  buffer_load_dwordx4 v[140:143], v12, s[12:15], s35 offen
  v_mfma_f32_16x16x32_bf16 v[96:99], v[160:163], v[64:67], v[96:99]
  v_mfma_f32_16x16x32_bf16 v[112:115], v[164:167], v[64:67], v[112:115]
  s_add_u32 m0, s31, 2048
  s_nop 0
  buffer_load_dwordx4 v6, s[8:11], s26 offen lds
  v_mfma_f32_16x16x32_bf16 v[84:87], v[156:159], v[68:71], v[84:87]
  v_mfma_f32_16x16x32_bf16 v[100:103], v[160:163], v[68:71], v[100:103]
  s_add_u32 m0, s31, 3072
  s_nop 0
  buffer_load_dwordx4 v7, s[8:11], s26 offen lds
  v_mfma_f32_16x16x32_bf16 v[116:119], v[164:167], v[68:71], v[116:119]
  s_add_u32 s29, s25, 5
  s_add_u32 s30, s29, s41
  s_and_b32 s30, s30, 15
  s_lshl_b32 s26, s30, 8
  s_lshl_b32 s27, s30, 12
  s_add_u32 s27, s27, s40
  s_cmp_lt_u32 s29, 16
  s_cselect_b32 s26, s26, 0x80000000
  s_cselect_b32 s27, s27, 0x80000000
  s_add_u32 s35, s27, 2048
  s_waitcnt lgkmcnt(0)
  v_mfma_f32_16x16x32_bf16 v[72:75], v[168:171], v[40:43], v[72:75]
  ds_read_b128 v[56:59], v9 offset:32768
  v_mfma_f32_16x16x32_bf16 v[88:91], v[172:175], v[40:43], v[88:91]
  ds_read_b128 v[60:63], v9 offset:36864
  v_mfma_f32_16x16x32_bf16 v[104:107], v[176:179], v[40:43], v[104:107]
  ds_read_b128 v[64:67], v9 offset:40960
  buffer_load_dwordx4 v[144:147], v10, s[12:15], s27 offen
  v_mfma_f32_16x16x32_bf16 v[76:79], v[168:171], v[44:47], v[76:79]
  ds_read_b128 v[68:71], v9 offset:45056
  v_mfma_f32_16x16x32_bf16 v[92:95], v[172:175], v[44:47], v[92:95]
  buffer_load_dwordx4 v[148:151], v11, s[12:15], s27 offen
  v_mfma_f32_16x16x32_bf16 v[108:111], v[176:179], v[44:47], v[108:111]
  v_mfma_f32_16x16x32_bf16 v[80:83], v[168:171], v[48:51], v[80:83]
  buffer_load_dwordx4 v[152:155], v12, s[12:15], s27 offen
  v_mfma_f32_16x16x32_bf16 v[96:99], v[172:175], v[48:51], v[96:99]
  v_mfma_f32_16x16x32_bf16 v[112:115], v[176:179], v[48:51], v[112:115]
  s_add_u32 m0, s31, 16384
  s_nop 0
  buffer_load_dwordx4 v4, s[8:11], s26 offen lds
  v_mfma_f32_16x16x32_bf16 v[84:87], v[168:171], v[52:55], v[84:87]
  v_mfma_f32_16x16x32_bf16 v[100:103], v[172:175], v[52:55], v[100:103]
  s_add_u32 m0, s31, 17408
  s_nop 0
  buffer_load_dwordx4 v5, s[8:11], s26 offen lds
  v_mfma_f32_16x16x32_bf16 v[116:119], v[176:179], v[52:55], v[116:119]
  s_waitcnt vmcnt(15) lgkmcnt(0)
  s_barrier
  v_mfma_f32_16x16x32_bf16 v[72:75], v[180:183], v[56:59], v[72:75]
  ds_read_b128 v[40:43], v8 offset:49152
  v_mfma_f32_16x16x32_bf16 v[88:91], v[184:187], v[56:59], v[88:91]
  ds_read_b128 v[44:47], v8 offset:53248
  v_mfma_f32_16x16x32_bf16 v[104:107], v[188:191], v[56:59], v[104:107]
  ds_read_b128 v[48:51], v8 offset:57344
  buffer_load_dwordx4 v[156:159], v10, s[12:15], s35 offen
  v_mfma_f32_16x16x32_bf16 v[76:79], v[180:183], v[60:63], v[76:79]
  ds_read_b128 v[52:55], v8 offset:61440
  v_mfma_f32_16x16x32_bf16 v[92:95], v[184:187], v[60:63], v[92:95]
  buffer_load_dwordx4 v[160:163], v11, s[12:15], s35 offen
  v_mfma_f32_16x16x32_bf16 v[108:111], v[188:191], v[60:63], v[108:111]
  v_mfma_f32_16x16x32_bf16 v[80:83], v[180:183], v[64:67], v[80:83]
  buffer_load_dwordx4 v[164:167], v12, s[12:15], s35 offen
  v_mfma_f32_16x16x32_bf16 v[96:99], v[184:187], v[64:67], v[96:99]
  v_mfma_f32_16x16x32_bf16 v[112:115], v[188:191], v[64:67], v[112:115]
  s_add_u32 m0, s31, 18432
  s_nop 0
  buffer_load_dwordx4 v6, s[8:11], s26 offen lds
  v_mfma_f32_16x16x32_bf16 v[84:87], v[180:183], v[68:71], v[84:87]
  v_mfma_f32_16x16x32_bf16 v[100:103], v[184:187], v[68:71], v[100:103]
  s_add_u32 m0, s31, 19456
  s_nop 0
  buffer_load_dwordx4 v7, s[8:11], s26 offen lds
  v_mfma_f32_16x16x32_bf16 v[116:119], v[188:191], v[68:71], v[116:119]
  s_add_u32 s29, s25, 6
  s_add_u32 s30, s29, s41
  s_and_b32 s30, s30, 15
  s_lshl_b32 s26, s30, 8
  s_lshl_b32 s27, s30, 12
  s_add_u32 s27, s27, s40
  s_cmp_lt_u32 s29, 16
  s_cselect_b32 s26, s26, 0x80000000
  s_cselect_b32 s27, s27, 0x80000000
  s_add_u32 s35, s27, 2048
  s_waitcnt lgkmcnt(0)
  v_mfma_f32_16x16x32_bf16 v[72:75], v[192:195], v[40:43], v[72:75]
  ds_read_b128 v[56:59], v9 offset:49152
  v_mfma_f32_16x16x32_bf16 v[88:91], v[196:199], v[40:43], v[88:91]
  ds_read_b128 v[60:63], v9 offset:53248
  v_mfma_f32_16x16x32_bf16 v[104:107], v[200:203], v[40:43], v[104:107]
  ds_read_b128 v[64:67], v9 offset:57344
  buffer_load_dwordx4 v[168:171], v10, s[12:15], s27 offen
  v_mfma_f32_16x16x32_bf16 v[76:79], v[192:195], v[44:47], v[76:79]
  ds_read_b128 v[68:71], v9 offset:61440
  v_mfma_f32_16x16x32_bf16 v[92:95], v[196:199], v[44:47], v[92:95]
  buffer_load_dwordx4 v[172:175], v11, s[12:15], s27 offen
  v_mfma_f32_16x16x32_bf16 v[108:111], v[200:203], v[44:47], v[108:111]
  v_mfma_f32_16x16x32_bf16 v[80:83], v[192:195], v[48:51], v[80:83]
  buffer_load_dwordx4 v[176:179], v12, s[12:15], s27 offen
  v_mfma_f32_16x16x32_bf16 v[96:99], v[196:199], v[48:51], v[96:99]
  v_mfma_f32_16x16x32_bf16 v[112:115], v[200:203], v[48:51], v[112:115]
  s_add_u32 m0, s31, 32768
  s_nop 0
  buffer_load_dwordx4 v4, s[8:11], s26 offen lds
  v_mfma_f32_16x16x32_bf16 v[84:87], v[192:195], v[52:55], v[84:87]
  v_mfma_f32_16x16x32_bf16 v[100:103], v[196:199], v[52:55], v[100:103]
  s_add_u32 m0, s31, 33792
  s_nop 0
  buffer_load_dwordx4 v5, s[8:11], s26 offen lds
  v_mfma_f32_16x16x32_bf16 v[116:119], v[200:203], v[52:55], v[116:119]
  s_waitcnt vmcnt(15) lgkmcnt(0)
  s_barrier
  v_mfma_f32_16x16x32_bf16 v[72:75], v[204:207], v[56:59], v[72:75]
  ds_read_b128 v[40:43], v8 offset:0
  v_mfma_f32_16x16x32_bf16 v[88:91], v[208:211], v[56:59], v[88:91]
  ds_read_b128 v[44:47], v8 offset:4096
  v_mfma_f32_16x16x32_bf16 v[104:107], v[212:215], v[56:59], v[104:107]
  ds_read_b128 v[48:51], v8 offset:8192
  buffer_load_dwordx4 v[180:183], v10, s[12:15], s35 offen
  v_mfma_f32_16x16x32_bf16 v[76:79], v[204:207], v[60:63], v[76:79]
  ds_read_b128 v[52:55], v8 offset:12288
  v_mfma_f32_16x16x32_bf16 v[92:95], v[208:211], v[60:63], v[92:95]
  buffer_load_dwordx4 v[184:187], v11, s[12:15], s35 offen
  v_mfma_f32_16x16x32_bf16 v[108:111], v[212:215], v[60:63], v[108:111]
  v_mfma_f32_16x16x32_bf16 v[80:83], v[204:207], v[64:67], v[80:83]
  buffer_load_dwordx4 v[188:191], v12, s[12:15], s35 offen
  v_mfma_f32_16x16x32_bf16 v[96:99], v[208:211], v[64:67], v[96:99]
  v_mfma_f32_16x16x32_bf16 v[112:115], v[212:215], v[64:67], v[112:115]
  s_add_u32 m0, s31, 34816
  s_nop 0
  buffer_load_dwordx4 v6, s[8:11], s26 offen lds
  v_mfma_f32_16x16x32_bf16 v[84:87], v[204:207], v[68:71], v[84:87]
  v_mfma_f32_16x16x32_bf16 v[100:103], v[208:211], v[68:71], v[100:103]
  s_add_u32 m0, s31, 35840
  s_nop 0
  buffer_load_dwordx4 v7, s[8:11], s26 offen lds
  v_mfma_f32_16x16x32_bf16 v[116:119], v[212:215], v[68:71], v[116:119]
  s_add_u32 s25, s25, 4
  s_cmp_lt_u32 s25, 16
  s_cbranch_scc1 K2_LOOP
  s_waitcnt vmcnt(0) lgkmcnt(0)
  s_barrier
  s_mul_i32 s28, s22, 6144
  v_lshlrev_b32 v14, 4, v1
  v_add_u32 v15, s28, v14
  s_xor_b32 s29, s22, 2
  s_mul_i32 s29, s29, 6144
  v_add_u32 v16, s29, v14
  s_cmp_eq_u32 s24, 0
  s_cbranch_scc0 K2_KH1
  ds_write_b128 v15, v[80:83] offset:0
  ds_write_b128 v15, v[84:87] offset:1024
  ds_write_b128 v15, v[96:99] offset:2048
  ds_write_b128 v15, v[100:103] offset:3072
  ds_write_b128 v15, v[112:115] offset:4096
  ds_write_b128 v15, v[116:119] offset:5120
  v_mov_b32 v120, v72
  v_mov_b32 v121, v73
  v_mov_b32 v122, v74
  v_mov_b32 v123, v75
  v_mov_b32 v124, v76
  v_mov_b32 v125, v77
  v_mov_b32 v126, v78
  v_mov_b32 v127, v79
  v_mov_b32 v128, v88
  v_mov_b32 v129, v89
  v_mov_b32 v130, v90
  v_mov_b32 v131, v91
  v_mov_b32 v132, v92
  v_mov_b32 v133, v93
  v_mov_b32 v134, v94
  v_mov_b32 v135, v95
  v_mov_b32 v136, v104
  v_mov_b32 v137, v105
  v_mov_b32 v138, v106
  v_mov_b32 v139, v107
  v_mov_b32 v140, v108
  v_mov_b32 v141, v109
  v_mov_b32 v142, v110
  v_mov_b32 v143, v111
  s_branch K2_KHD
K2_KH1:
  ds_write_b128 v15, v[72:75] offset:0
  ds_write_b128 v15, v[76:79] offset:1024
  ds_write_b128 v15, v[88:91] offset:2048
  ds_write_b128 v15, v[92:95] offset:3072
  ds_write_b128 v15, v[104:107] offset:4096
  ds_write_b128 v15, v[108:111] offset:5120
  v_mov_b32 v120, v80
  v_mov_b32 v121, v81
  v_mov_b32 v122, v82
  v_mov_b32 v123, v83
  v_mov_b32 v124, v84
  v_mov_b32 v125, v85
  v_mov_b32 v126, v86
  v_mov_b32 v127, v87
  v_mov_b32 v128, v96
  v_mov_b32 v129, v97
  v_mov_b32 v130, v98
  v_mov_b32 v131, v99
  v_mov_b32 v132, v100
  v_mov_b32 v133, v101
  v_mov_b32 v134, v102
  v_mov_b32 v135, v103
  v_mov_b32 v136, v112
  v_mov_b32 v137, v113
  v_mov_b32 v138, v114
  v_mov_b32 v139, v115
  v_mov_b32 v140, v116
  v_mov_b32 v141, v117
  v_mov_b32 v142, v118
  v_mov_b32 v143, v119
K2_KHD:
  s_waitcnt lgkmcnt(0)
  s_barrier
  ds_read_b128 v[40:43], v16 offset:0
  ds_read_b128 v[44:47], v16 offset:1024
  ds_read_b128 v[48:51], v16 offset:2048
  ds_read_b128 v[52:55], v16 offset:3072
  ds_read_b128 v[56:59], v16 offset:4096
  ds_read_b128 v[60:63], v16 offset:5120
  v_lshlrev_b32 v18, 16, v36
  v_lshlrev_b32 v20, 16, v37
  v_lshlrev_b32 v22, 4, v1
  s_waitcnt lgkmcnt(0)
  s_add_u32 s28, s33, 0
  s_lshr_b32 s29, s28, 1
  s_and_b32 s28, s28, 1
  s_lshl_b32 s28, s28, 3
  s_lshl_b32 s29, s29, 10
  s_add_u32 s28, s28, s29
  s_mul_i32 s29, s34, 24576
  s_add_u32 s28, s28, s29
  s_add_u32 s28, s28, 12582912
  s_add_u32 s29, s28, 24576
  v_add_f32 v120, v120, v40
  v_add_f32 v121, v121, v41
  v_add_f32 v120, v120, v18
  v_add_f32 v121, v121, v18
  v_lshlrev_b32 v40, 16, v24
  v_and_b32 v41, s32, v24
  v_mul_f32 v120, v120, v40
  v_mul_f32 v121, v121, v41
  v_cvt_pk_bf16_f32 v24, v120, v121
  v_add_f32 v122, v122, v42
  v_add_f32 v123, v123, v43
  v_add_f32 v122, v122, v18
  v_add_f32 v123, v123, v18
  v_lshlrev_b32 v42, 16, v25
  v_and_b32 v43, s32, v25
  v_mul_f32 v122, v122, v42
  v_mul_f32 v123, v123, v43
  v_cvt_pk_bf16_f32 v25, v122, v123
  buffer_store_dwordx2 v[24:25], v22, s[12:15], s28 offen
  v_add_f32 v124, v124, v44
  v_add_f32 v125, v125, v45
  v_add_f32 v124, v124, v20
  v_add_f32 v125, v125, v20
  v_lshlrev_b32 v44, 16, v30
  v_and_b32 v45, s32, v30
  v_mul_f32 v124, v124, v44
  v_mul_f32 v125, v125, v45
  v_cvt_pk_bf16_f32 v30, v124, v125
  v_add_f32 v126, v126, v46
  v_add_f32 v127, v127, v47
  v_add_f32 v126, v126, v20
  v_add_f32 v127, v127, v20
  v_lshlrev_b32 v46, 16, v31
  v_and_b32 v47, s32, v31
  v_mul_f32 v126, v126, v46
  v_mul_f32 v127, v127, v47
  v_cvt_pk_bf16_f32 v31, v126, v127
  buffer_store_dwordx2 v[30:31], v22, s[12:15], s29 offen
  s_add_u32 s28, s33, 1
  s_lshr_b32 s29, s28, 1
  s_and_b32 s28, s28, 1
  s_lshl_b32 s28, s28, 3
  s_lshl_b32 s29, s29, 10
  s_add_u32 s28, s28, s29
  s_mul_i32 s29, s34, 24576
  s_add_u32 s28, s28, s29
  s_add_u32 s28, s28, 12582912
  s_add_u32 s29, s28, 24576
  v_add_f32 v128, v128, v48
  v_add_f32 v129, v129, v49
  v_add_f32 v128, v128, v18
  v_add_f32 v129, v129, v18
  v_lshlrev_b32 v48, 16, v26
  v_and_b32 v49, s32, v26
  v_mul_f32 v128, v128, v48
  v_mul_f32 v129, v129, v49
  v_cvt_pk_bf16_f32 v26, v128, v129
  v_add_f32 v130, v130, v50
  v_add_f32 v131, v131, v51
  v_add_f32 v130, v130, v18
  v_add_f32 v131, v131, v18
  v_lshlrev_b32 v50, 16, v27
  v_and_b32 v51, s32, v27
  v_mul_f32 v130, v130, v50
  v_mul_f32 v131, v131, v51
  v_cvt_pk_bf16_f32 v27, v130, v131
  buffer_store_dwordx2 v[26:27], v22, s[12:15], s28 offen
  v_add_f32 v132, v132, v52
  v_add_f32 v133, v133, v53
  v_add_f32 v132, v132, v20
  v_add_f32 v133, v133, v20
  v_lshlrev_b32 v52, 16, v32
  v_and_b32 v53, s32, v32
  v_mul_f32 v132, v132, v52
  v_mul_f32 v133, v133, v53
  v_cvt_pk_bf16_f32 v32, v132, v133
  v_add_f32 v134, v134, v54
  v_add_f32 v135, v135, v55
  v_add_f32 v134, v134, v20
  v_add_f32 v135, v135, v20
  v_lshlrev_b32 v54, 16, v33
  v_and_b32 v55, s32, v33
  v_mul_f32 v134, v134, v54
  v_mul_f32 v135, v135, v55
  v_cvt_pk_bf16_f32 v33, v134, v135
  buffer_store_dwordx2 v[32:33], v22, s[12:15], s29 offen
  s_add_u32 s28, s33, 2
  s_lshr_b32 s29, s28, 1
  s_and_b32 s28, s28, 1
  s_lshl_b32 s28, s28, 3
  s_lshl_b32 s29, s29, 10
  s_add_u32 s28, s28, s29
  s_mul_i32 s29, s34, 24576
  s_add_u32 s28, s28, s29
  s_add_u32 s28, s28, 12582912
  s_add_u32 s29, s28, 24576
  v_add_f32 v136, v136, v56
  v_add_f32 v137, v137, v57
  v_add_f32 v136, v136, v18
  v_add_f32 v137, v137, v18
  v_lshlrev_b32 v56, 16, v28
  v_and_b32 v57, s32, v28
  v_mul_f32 v136, v136, v56
  v_mul_f32 v137, v137, v57
  v_cvt_pk_bf16_f32 v28, v136, v137
  v_add_f32 v138, v138, v58
  v_add_f32 v139, v139, v59
  v_add_f32 v138, v138, v18
  v_add_f32 v139, v139, v18
  v_lshlrev_b32 v58, 16, v29
  v_and_b32 v59, s32, v29
  v_mul_f32 v138, v138, v58
  v_mul_f32 v139, v139, v59
  v_cvt_pk_bf16_f32 v29, v138, v139
  buffer_store_dwordx2 v[28:29], v22, s[12:15], s28 offen
  v_add_f32 v140, v140, v60
  v_add_f32 v141, v141, v61
  v_add_f32 v140, v140, v20
  v_add_f32 v141, v141, v20
  v_lshlrev_b32 v60, 16, v34
  v_and_b32 v61, s32, v34
  v_mul_f32 v140, v140, v60
  v_mul_f32 v141, v141, v61
  v_cvt_pk_bf16_f32 v34, v140, v141
  v_add_f32 v142, v142, v62
  v_add_f32 v143, v143, v63
  v_add_f32 v142, v142, v20
  v_add_f32 v143, v143, v20
  v_lshlrev_b32 v62, 16, v35
  v_and_b32 v63, s32, v35
  v_mul_f32 v142, v142, v62
  v_mul_f32 v143, v143, v63
  v_cvt_pk_bf16_f32 v35, v142, v143
  buffer_store_dwordx2 v[34:35], v22, s[12:15], s29 offen
  s_endpgm
K2_CONV:
  v_lshrrev_b32 v6, 6, v0
  v_and_b32 v1, 63, v0
  v_readfirstlane_b32 s20, v6
  s_sub_u32 s23, s2, 256
  s_mul_i32 s21, s23, 3
  s_add_u32 s21, s21, s20
  s_cmp_ge_u32 s20, 3
  s_cbranch_scc1 K2_END
  s_cmp_ge_u32 s21, 640
  s_cbranch_scc1 K2_END
  s_load_dwordx4 s[36:39], s[0:1], 32
  s_load_dwordx2 s[40:41], s[0:1], 104
  v_lshrrev_b32 v2, 4, v1
  v_and_b32 v3, 15, v1
  s_mul_i32 s22, s20, 21248
  s_mov_b32 s26, 0xffff0000
  s_mov_b64 s[28:29], exec
  s_waitcnt lgkmcnt(0)
  s_lshl_b32 s23, s21, 12
  s_add_u32 s8, s36, s23
  s_addc_u32 s9, s37, 0
  s_and_b32 s9, s9, 0xffff
  s_mov_b32 s10, 4096
  s_mov_b32 s11, 0x20000
  s_mov_b32 s12, s40
  s_and_b32 s13, s41, 0xffff
  s_mov_b32 s14, 18874368
  s_mov_b32 s15, 0x20000
  s_mov_b32 s16, s38
  s_and_b32 s17, s39, 0xffff
  s_mov_b32 s18, 1280
  s_mov_b32 s19, 0x20000
  v_lshlrev_b32 v6, 4, v1
  s_lshl_b32 s23, s21, 12
  s_add_u32 s23, s23, 6291456
  s_add_u32 m0, s22, 17152
  s_add_u32 s24, s23, 0
  buffer_load_dwordx4 v6, s[12:15], s24 offen lds
  s_add_u32 m0, s22, 18176
  s_add_u32 s24, s23, 1024
  buffer_load_dwordx4 v6, s[12:15], s24 offen lds
  s_add_u32 m0, s22, 19200
  s_add_u32 s24, s23, 2048
  buffer_load_dwordx4 v6, s[12:15], s24 offen lds
  s_add_u32 m0, s22, 20224
  s_add_u32 s24, s23, 3072
  buffer_load_dwordx4 v6, s[12:15], s24 offen lds
  buffer_load_dwordx4 v[16:19], v6, s[8:11], 0 offen offset:0
  buffer_load_dwordx2 v[20:21], v6, s[8:11], 0 offen offset:16
  buffer_load_dwordx4 v[22:25], v6, s[8:11], 0 offen offset:1024
  buffer_load_dwordx2 v[26:27], v6, s[8:11], 0 offen offset:1040
  buffer_load_dwordx4 v[28:31], v6, s[8:11], 0 offen offset:2048
  buffer_load_dwordx2 v[32:33], v6, s[8:11], 0 offen offset:2064
  buffer_load_dwordx4 v[34:37], v6, s[8:11], 0 offen offset:3072
  buffer_load_dwordx2 v[38:39], v6, s[8:11], 0 offen offset:3088
  v_mov_b32 v7, 0
  buffer_load_dwordx2 v[44:45], v7, s[8:11], 0 offen
  s_lshl_b32 s23, s21, 1
  buffer_load_ushort v46, v7, s[16:19], s23 offen
  v_mov_b32 v8, 0
  v_mov_b32 v9, 0
  v_lshlrev_b32 v10, 3, v1
  v_add_u32 v10, s22, v10
  ds_write_b64 v10, v[8:9] offset:16640
  v_add_u32 v10, 1, v3
  v_and_b32 v10, 3, v10
  v_lshrrev_b32 v11, 1, v2
  v_and_b32 v12, 1, v2
  v_lshlrev_b32 v13, 4, v11
  v_add_u32 v13, v13, v3
  v_lshlrev_b32 v14, 3, v12
  v_sub_u32 v13, v13, v14
  v_add_u32 v13, 9, v13
  v_sub_u32 v13, v13, v10
  v_lshlrev_b32 v13, 1, v13
  v_mul_u32_u24 v10, 4160, v10
  v_add_u32 v13, v13, v10
  v_add_u32 v4, s22, v13
  v_sub_u32 v13, v3, v11
  v_lshlrev_b32 v13, 1, v13
  v_add_u32 v13, v13, v12
  v_lshlrev_b32 v13, 4, v13
  s_add_u32 s23, s22, 17152
  v_add_u32 v5, s23, v13
  v_lshlrev_b32 v10, 4, v1
  v_add_u32 v10, s22, v10
  s_waitcnt vmcnt(0)
  v_alignbit_b32 v80, v17, v16, 16
  v_alignbit_b32 v81, v18, v17, 16
  v_alignbit_b32 v82, v19, v18, 16
  v_alignbit_b32 v83, v20, v19, 16
  v_mov_b32 v84, v17
  v_mov_b32 v85, v18
  v_mov_b32 v86, v19
  v_mov_b32 v87, v20
  v_mov_b32 v88, v81
  v_mov_b32 v89, v82
  v_mov_b32 v90, v83
  v_alignbit_b32 v91, v21, v20, 16
  ds_write_b128 v10, v[16:19] offset:32
  ds_write_b128 v10, v[80:83] offset:4192
  ds_write_b128 v10, v[84:87] offset:8352
  ds_write_b128 v10, v[88:91] offset:12512
  s_waitcnt lgkmcnt(4)
  v_alignbit_b32 v92, v23, v22, 16
  v_alignbit_b32 v93, v24, v23, 16
  v_alignbit_b32 v94, v25, v24, 16
  v_alignbit_b32 v95, v26, v25, 16
  v_mov_b32 v96, v23
  v_mov_b32 v97, v24
  v_mov_b32 v98, v25
  v_mov_b32 v99, v26
  v_mov_b32 v100, v93
  v_mov_b32 v101, v94
  v_mov_b32 v102, v95
  v_alignbit_b32 v103, v27, v26, 16
  ds_write_b128 v10, v[22:25] offset:1056
  ds_write_b128 v10, v[92:95] offset:5216
  ds_write_b128 v10, v[96:99] offset:9376
  ds_write_b128 v10, v[100:103] offset:13536
  s_waitcnt lgkmcnt(4)
  v_alignbit_b32 v104, v29, v28, 16
  v_alignbit_b32 v105, v30, v29, 16
  v_alignbit_b32 v106, v31, v30, 16
  v_alignbit_b32 v107, v32, v31, 16
  v_mov_b32 v108, v29
  v_mov_b32 v109, v30
  v_mov_b32 v110, v31
  v_mov_b32 v111, v32
  v_mov_b32 v112, v105
  v_mov_b32 v113, v106
  v_mov_b32 v114, v107
  v_alignbit_b32 v115, v33, v32, 16
  ds_write_b128 v10, v[28:31] offset:2080
  ds_write_b128 v10, v[104:107] offset:6240
  ds_write_b128 v10, v[108:111] offset:10400
  ds_write_b128 v10, v[112:115] offset:14560
  s_waitcnt lgkmcnt(4)
  v_alignbit_b32 v116, v35, v34, 16
  v_alignbit_b32 v117, v36, v35, 16
  v_alignbit_b32 v118, v37, v36, 16
  v_alignbit_b32 v119, v38, v37, 16
  v_mov_b32 v120, v35
  v_mov_b32 v121, v36
  v_mov_b32 v122, v37
  v_mov_b32 v123, v38
  v_mov_b32 v124, v117
  v_mov_b32 v125, v118
  v_mov_b32 v126, v119
  v_alignbit_b32 v127, v39, v38, 16
  ds_write_b128 v10, v[34:37] offset:3104
  ds_write_b128 v10, v[116:119] offset:7264
  ds_write_b128 v10, v[120:123] offset:11424
  ds_write_b128 v10, v[124:127] offset:15584
  s_waitcnt lgkmcnt(4)
  v_mov_b32 v40, 0
  v_mov_b32 v41, 0
  v_mov_b32 v42, 0
  v_mov_b32 v43, 0
  v_cmp_eq_u32 vcc, 1, v1
  s_nop 1
  v_cndmask_b32 v44, 0, v44, vcc
  v_cndmask_b32 v45, 0, v45, vcc
  s_mov_b32 exec_lo, 0x3
  s_mov_b32 exec_hi, 0x0
  v_alignbit_b32 v128, v41, v40, 16
  v_alignbit_b32 v129, v42, v41, 16
  v_alignbit_b32 v130, v43, v42, 16
  v_alignbit_b32 v131, v44, v43, 16
  v_mov_b32 v132, v41
  v_mov_b32 v133, v42
  v_mov_b32 v134, v43
  v_mov_b32 v135, v44
  v_mov_b32 v136, v129
  v_mov_b32 v137, v130
  v_mov_b32 v138, v131
  v_alignbit_b32 v139, v45, v44, 16
  ds_write_b128 v10, v[40:43] offset:0
  ds_write_b128 v10, v[128:131] offset:4160
  ds_write_b128 v10, v[132:135] offset:8320
  ds_write_b128 v10, v[136:139] offset:12480
  s_mov_b64 exec, s[28:29]
  v_lshlrev_b32 v46, 16, v46
  v_mov_b32 v48, 0
  v_mov_b32 v49, 0
  v_mov_b32 v50, 0
  v_mov_b32 v51, 0
  v_mov_b32 v52, 0
  v_mov_b32 v53, 0
  v_mov_b32 v54, 0
  v_mov_b32 v55, 0
  v_mov_b32 v56, 0
  v_mov_b32 v57, 0
  v_mov_b32 v58, 0
  v_mov_b32 v59, 0
  v_mov_b32 v60, 0
  v_mov_b32 v61, 0
  v_mov_b32 v62, 0
  v_mov_b32 v63, 0
  v_mov_b32 v64, 0
  v_mov_b32 v65, 0
  v_mov_b32 v66, 0
  v_mov_b32 v67, 0
  v_mov_b32 v68, 0
  v_mov_b32 v69, 0
  v_mov_b32 v70, 0
  v_mov_b32 v71, 0
  v_mov_b32 v72, 0
  v_mov_b32 v73, 0
  v_mov_b32 v74, 0
  v_mov_b32 v75, 0
  v_mov_b32 v76, 0
  v_mov_b32 v77, 0
  v_mov_b32 v78, 0
  v_mov_b32 v79, 0
  s_waitcnt lgkmcnt(0)
  ds_read_b64 v[80:81], v4 offset:0
  ds_read_b64 v[82:83], v4 offset:8
  ds_read_b128 v[144:147], v5 offset:0
  ds_read_b64 v[84:85], v4 offset:512
  ds_read_b64 v[86:87], v4 offset:520
  ds_read_b128 v[148:151], v5 offset:512
  ds_read_b64 v[88:89], v4 offset:1024
  ds_read_b64 v[90:91], v4 offset:1032
  s_waitcnt lgkmcnt(7)
  ds_read_b128 v[152:155], v5 offset:1024
  ds_read_b64 v[92:93], v4 offset:1536
  ds_read_b64 v[94:95], v4 offset:1544
  ds_read_b128 v[156:159], v5 offset:1536
  ds_read_b64 v[96:97], v4 offset:2048
  ds_read_b64 v[98:99], v4 offset:2056
  ds_read_b128 v[160:163], v5 offset:2048
  ds_read_b64 v[100:101], v4 offset:2560
  s_waitcnt lgkmcnt(7)
  ds_read_b64 v[102:103], v4 offset:2568
  ds_read_b128 v[164:167], v5 offset:2560
  ds_read_b64 v[104:105], v4 offset:3072
  ds_read_b64 v[106:107], v4 offset:3080
  ds_read_b128 v[168:171], v5 offset:3072
  ds_read_b64 v[108:109], v4 offset:3584
  ds_read_b64 v[110:111], v4 offset:3592
  ds_read_b128 v[172:175], v5 offset:3584
  s_waitcnt lgkmcnt(7)
  s_mov_b32 s25, 0
K2_CLOOP:
  v_add_u32 v4, 64, v4
  v_subrev_u32 v5, 64, v5
  s_waitcnt lgkmcnt(0)
  v_mfma_f32_16x16x32_bf16 v[48:51], v[80:83], v[144:147], v[48:51]
  ds_read_b64 v[112:113], v4 offset:0
  v_mfma_f32_16x16x32_bf16 v[52:55], v[80:83], v[148:151], v[52:55]
  ds_read_b64 v[114:115], v4 offset:8
  v_mfma_f32_16x16x32_bf16 v[56:59], v[80:83], v[152:155], v[56:59]
  ds_read_b128 v[176:179], v5 offset:0
  v_mfma_f32_16x16x32_bf16 v[60:63], v[80:83], v[156:159], v[60:63]
  ds_read_b64 v[116:117], v4 offset:512
  v_mfma_f32_16x16x32_bf16 v[64:67], v[80:83], v[160:163], v[64:67]
  ds_read_b64 v[118:119], v4 offset:520
  v_mfma_f32_16x16x32_bf16 v[68:71], v[80:83], v[164:167], v[68:71]
  ds_read_b128 v[180:183], v5 offset:512
  s_waitcnt lgkmcnt(9)
  v_mfma_f32_16x16x32_bf16 v[72:75], v[80:83], v[168:171], v[72:75]
  ds_read_b64 v[120:121], v4 offset:1024
  v_mfma_f32_16x16x32_bf16 v[76:79], v[80:83], v[172:175], v[76:79]
  ds_read_b64 v[122:123], v4 offset:1032
  v_mfma_f32_16x16x32_bf16 v[52:55], v[84:87], v[144:147], v[52:55]
  ds_read_b128 v[184:187], v5 offset:1024
  v_mfma_f32_16x16x32_bf16 v[56:59], v[84:87], v[148:151], v[56:59]
  ds_read_b64 v[124:125], v4 offset:1536
  v_mfma_f32_16x16x32_bf16 v[60:63], v[84:87], v[152:155], v[60:63]
  ds_read_b64 v[126:127], v4 offset:1544
  v_mfma_f32_16x16x32_bf16 v[64:67], v[84:87], v[156:159], v[64:67]
  ds_read_b128 v[188:191], v5 offset:1536
  s_waitcnt lgkmcnt(9)
  v_mfma_f32_16x16x32_bf16 v[68:71], v[84:87], v[160:163], v[68:71]
  ds_read_b64 v[128:129], v4 offset:2048
  v_mfma_f32_16x16x32_bf16 v[72:75], v[84:87], v[164:167], v[72:75]
  ds_read_b64 v[130:131], v4 offset:2056
  v_mfma_f32_16x16x32_bf16 v[76:79], v[84:87], v[168:171], v[76:79]
  ds_read_b128 v[192:195], v5 offset:2048
  v_mfma_f32_16x16x32_bf16 v[56:59], v[88:91], v[144:147], v[56:59]
  ds_read_b64 v[132:133], v4 offset:2560
  v_mfma_f32_16x16x32_bf16 v[60:63], v[88:91], v[148:151], v[60:63]
  ds_read_b64 v[134:135], v4 offset:2568
  v_mfma_f32_16x16x32_bf16 v[64:67], v[88:91], v[152:155], v[64:67]
  ds_read_b128 v[196:199], v5 offset:2560
  s_waitcnt lgkmcnt(9)
  v_mfma_f32_16x16x32_bf16 v[68:71], v[88:91], v[156:159], v[68:71]
  ds_read_b64 v[136:137], v4 offset:3072
  v_mfma_f32_16x16x32_bf16 v[72:75], v[88:91], v[160:163], v[72:75]
  ds_read_b64 v[138:139], v4 offset:3080
  v_mfma_f32_16x16x32_bf16 v[76:79], v[88:91], v[164:167], v[76:79]
  ds_read_b128 v[200:203], v5 offset:3072
  v_mfma_f32_16x16x32_bf16 v[60:63], v[92:95], v[144:147], v[60:63]
  ds_read_b64 v[140:141], v4 offset:3584
  v_mfma_f32_16x16x32_bf16 v[64:67], v[92:95], v[148:151], v[64:67]
  ds_read_b64 v[142:143], v4 offset:3592
  v_mfma_f32_16x16x32_bf16 v[68:71], v[92:95], v[152:155], v[68:71]
  ds_read_b128 v[204:207], v5 offset:3584
  s_waitcnt lgkmcnt(9)
  v_mfma_f32_16x16x32_bf16 v[72:75], v[92:95], v[156:159], v[72:75]
  v_mfma_f32_16x16x32_bf16 v[76:79], v[92:95], v[160:163], v[76:79]
  v_mfma_f32_16x16x32_bf16 v[64:67], v[96:99], v[144:147], v[64:67]
  v_mfma_f32_16x16x32_bf16 v[68:71], v[96:99], v[148:151], v[68:71]
  v_mfma_f32_16x16x32_bf16 v[72:75], v[96:99], v[152:155], v[72:75]
  v_mfma_f32_16x16x32_bf16 v[76:79], v[96:99], v[156:159], v[76:79]
  v_mfma_f32_16x16x32_bf16 v[68:71], v[100:103], v[144:147], v[68:71]
  v_mfma_f32_16x16x32_bf16 v[72:75], v[100:103], v[148:151], v[72:75]
  v_mfma_f32_16x16x32_bf16 v[76:79], v[100:103], v[152:155], v[76:79]
  v_mfma_f32_16x16x32_bf16 v[72:75], v[104:107], v[144:147], v[72:75]
  v_mfma_f32_16x16x32_bf16 v[76:79], v[104:107], v[148:151], v[76:79]
  v_mfma_f32_16x16x32_bf16 v[76:79], v[108:111], v[144:147], v[76:79]
  v_add_u32 v4, 64, v4
  v_subrev_u32 v5, 64, v5
  s_waitcnt lgkmcnt(0)
  v_mfma_f32_16x16x32_bf16 v[48:51], v[112:115], v[176:179], v[48:51]
  ds_read_b64 v[80:81], v4 offset:0
  v_mfma_f32_16x16x32_bf16 v[52:55], v[112:115], v[180:183], v[52:55]
  ds_read_b64 v[82:83], v4 offset:8
  v_mfma_f32_16x16x32_bf16 v[56:59], v[112:115], v[184:187], v[56:59]
  ds_read_b128 v[144:147], v5 offset:0
  v_mfma_f32_16x16x32_bf16 v[60:63], v[112:115], v[188:191], v[60:63]
  ds_read_b64 v[84:85], v4 offset:512
  v_mfma_f32_16x16x32_bf16 v[64:67], v[112:115], v[192:195], v[64:67]
  ds_read_b64 v[86:87], v4 offset:520
  v_mfma_f32_16x16x32_bf16 v[68:71], v[112:115], v[196:199], v[68:71]
  ds_read_b128 v[148:151], v5 offset:512
  s_waitcnt lgkmcnt(9)
  v_mfma_f32_16x16x32_bf16 v[72:75], v[112:115], v[200:203], v[72:75]
  ds_read_b64 v[88:89], v4 offset:1024
  v_mfma_f32_16x16x32_bf16 v[76:79], v[112:115], v[204:207], v[76:79]
  ds_read_b64 v[90:91], v4 offset:1032
  v_mfma_f32_16x16x32_bf16 v[52:55], v[116:119], v[176:179], v[52:55]
  ds_read_b128 v[152:155], v5 offset:1024
  v_mfma_f32_16x16x32_bf16 v[56:59], v[116:119], v[180:183], v[56:59]
  ds_read_b64 v[92:93], v4 offset:1536
  v_mfma_f32_16x16x32_bf16 v[60:63], v[116:119], v[184:187], v[60:63]
  ds_read_b64 v[94:95], v4 offset:1544
  v_mfma_f32_16x16x32_bf16 v[64:67], v[116:119], v[188:191], v[64:67]
  ds_read_b128 v[156:159], v5 offset:1536
  s_waitcnt lgkmcnt(9)
  v_mfma_f32_16x16x32_bf16 v[68:71], v[116:119], v[192:195], v[68:71]
  ds_read_b64 v[96:97], v4 offset:2048
  v_mfma_f32_16x16x32_bf16 v[72:75], v[116:119], v[196:199], v[72:75]
  ds_read_b64 v[98:99], v4 offset:2056
  v_mfma_f32_16x16x32_bf16 v[76:79], v[116:119], v[200:203], v[76:79]
  ds_read_b128 v[160:163], v5 offset:2048
  v_mfma_f32_16x16x32_bf16 v[56:59], v[120:123], v[176:179], v[56:59]
  ds_read_b64 v[100:101], v4 offset:2560
  v_mfma_f32_16x16x32_bf16 v[60:63], v[120:123], v[180:183], v[60:63]
  ds_read_b64 v[102:103], v4 offset:2568
  v_mfma_f32_16x16x32_bf16 v[64:67], v[120:123], v[184:187], v[64:67]
  ds_read_b128 v[164:167], v5 offset:2560
  s_waitcnt lgkmcnt(9)
  v_mfma_f32_16x16x32_bf16 v[68:71], v[120:123], v[188:191], v[68:71]
  ds_read_b64 v[104:105], v4 offset:3072
  v_mfma_f32_16x16x32_bf16 v[72:75], v[120:123], v[192:195], v[72:75]
  ds_read_b64 v[106:107], v4 offset:3080
  v_mfma_f32_16x16x32_bf16 v[76:79], v[120:123], v[196:199], v[76:79]
  ds_read_b128 v[168:171], v5 offset:3072
  v_mfma_f32_16x16x32_bf16 v[60:63], v[124:127], v[176:179], v[60:63]
  ds_read_b64 v[108:109], v4 offset:3584
  v_mfma_f32_16x16x32_bf16 v[64:67], v[124:127], v[180:183], v[64:67]
  ds_read_b64 v[110:111], v4 offset:3592
  v_mfma_f32_16x16x32_bf16 v[68:71], v[124:127], v[184:187], v[68:71]
  ds_read_b128 v[172:175], v5 offset:3584
  s_waitcnt lgkmcnt(9)
  v_mfma_f32_16x16x32_bf16 v[72:75], v[124:127], v[188:191], v[72:75]
  v_mfma_f32_16x16x32_bf16 v[76:79], v[124:127], v[192:195], v[76:79]
  v_mfma_f32_16x16x32_bf16 v[64:67], v[128:131], v[176:179], v[64:67]
  v_mfma_f32_16x16x32_bf16 v[68:71], v[128:131], v[180:183], v[68:71]
  v_mfma_f32_16x16x32_bf16 v[72:75], v[128:131], v[184:187], v[72:75]
  v_mfma_f32_16x16x32_bf16 v[76:79], v[128:131], v[188:191], v[76:79]
  v_mfma_f32_16x16x32_bf16 v[68:71], v[132:135], v[176:179], v[68:71]
  v_mfma_f32_16x16x32_bf16 v[72:75], v[132:135], v[180:183], v[72:75]
  v_mfma_f32_16x16x32_bf16 v[76:79], v[132:135], v[184:187], v[76:79]
  v_mfma_f32_16x16x32_bf16 v[72:75], v[136:139], v[176:179], v[72:75]
  v_mfma_f32_16x16x32_bf16 v[76:79], v[136:139], v[180:183], v[76:79]
  v_mfma_f32_16x16x32_bf16 v[76:79], v[140:143], v[176:179], v[76:79]
  s_add_u32 s25, s25, 2
  s_cmp_lt_u32 s25, 8
  s_cbranch_scc1 K2_CLOOP
  s_waitcnt lgkmcnt(0)
  v_lshlrev_b32 v6, 5, v3
  v_lshrrev_b32 v7, 1, v2
  v_lshlrev_b32 v7, 4, v7
  v_add_u32 v6, v6, v7
  v_and_b32 v7, 1, v2
  v_xor_b32 v7, 1, v7
  v_lshlrev_b32 v7, 3, v7
  v_add_u32 v6, v6, v7
  s_add_u32 s23, s22, 17152
  v_add_u32 v6, s23, v6
  ds_read_b64 v[80:81], v6 offset:0
  ds_read_b64 v[82:83], v6 offset:512
  ds_read_b64 v[84:85], v6 offset:1024
  ds_read_b64 v[86:87], v6 offset:1536
  ds_read_b64 v[88:89], v6 offset:2048
  ds_read_b64 v[90:91], v6 offset:2560
  ds_read_b64 v[92:93], v6 offset:3072
  ds_read_b64 v[94:95], v6 offset:3584
  v_lshlrev_b32 v8, 5, v3
  v_lshlrev_b32 v9, 3, v2
  v_add_u32 v8, v8, v9
  s_lshl_b32 s23, s21, 12
  s_add_u32 s23, s23, 9437184
  s_waitcnt lgkmcnt(0)
  v_and_b32 v144, s26, v81
  v_lshlrev_b32 v145, 16, v81
  v_and_b32 v146, s26, v80
  v_lshlrev_b32 v147, 16, v80
  v_fmac_f32 v48, v144, v46
  v_fmac_f32 v49, v145, v46
  v_fmac_f32 v50, v146, v46
  v_fmac_f32 v51, v147, v46
  v_cvt_pk_bf16_f32 v148, v48, v49
  v_cvt_pk_bf16_f32 v149, v50, v51
  buffer_store_dwordx2 v[148:149], v8, s[12:15], s23 offen offset:0
  v_and_b32 v152, s26, v83
  v_lshlrev_b32 v153, 16, v83
  v_and_b32 v154, s26, v82
  v_lshlrev_b32 v155, 16, v82
  v_fmac_f32 v52, v152, v46
  v_fmac_f32 v53, v153, v46
  v_fmac_f32 v54, v154, v46
  v_fmac_f32 v55, v155, v46
  v_cvt_pk_bf16_f32 v156, v52, v53
  v_cvt_pk_bf16_f32 v157, v54, v55
  buffer_store_dwordx2 v[156:157], v8, s[12:15], s23 offen offset:512
  v_and_b32 v160, s26, v85
  v_lshlrev_b32 v161, 16, v85
  v_and_b32 v162, s26, v84
  v_lshlrev_b32 v163, 16, v84
  v_fmac_f32 v56, v160, v46
  v_fmac_f32 v57, v161, v46
  v_fmac_f32 v58, v162, v46
  v_fmac_f32 v59, v163, v46
  v_cvt_pk_bf16_f32 v164, v56, v57
  v_cvt_pk_bf16_f32 v165, v58, v59
  buffer_store_dwordx2 v[164:165], v8, s[12:15], s23 offen offset:1024
  v_and_b32 v168, s26, v87
  v_lshlrev_b32 v169, 16, v87
  v_and_b32 v170, s26, v86
  v_lshlrev_b32 v171, 16, v86
  v_fmac_f32 v60, v168, v46
  v_fmac_f32 v61, v169, v46
  v_fmac_f32 v62, v170, v46
  v_fmac_f32 v63, v171, v46
  v_cvt_pk_bf16_f32 v172, v60, v61
  v_cvt_pk_bf16_f32 v173, v62, v63
  buffer_store_dwordx2 v[172:173], v8, s[12:15], s23 offen offset:1536
  v_and_b32 v176, s26, v89
  v_lshlrev_b32 v177, 16, v89
  v_and_b32 v178, s26, v88
  v_lshlrev_b32 v179, 16, v88
  v_fmac_f32 v64, v176, v46
  v_fmac_f32 v65, v177, v46
  v_fmac_f32 v66, v178, v46
  v_fmac_f32 v67, v179, v46
  v_cvt_pk_bf16_f32 v180, v64, v65
  v_cvt_pk_bf16_f32 v181, v66, v67
  buffer_store_dwordx2 v[180:181], v8, s[12:15], s23 offen offset:2048
  v_and_b32 v184, s26, v91
  v_lshlrev_b32 v185, 16, v91
  v_and_b32 v186, s26, v90
  v_lshlrev_b32 v187, 16, v90
  v_fmac_f32 v68, v184, v46
  v_fmac_f32 v69, v185, v46
  v_fmac_f32 v70, v186, v46
  v_fmac_f32 v71, v187, v46
  v_cvt_pk_bf16_f32 v188, v68, v69
  v_cvt_pk_bf16_f32 v189, v70, v71
  buffer_store_dwordx2 v[188:189], v8, s[12:15], s23 offen offset:2560
  v_and_b32 v192, s26, v93
  v_lshlrev_b32 v193, 16, v93
  v_and_b32 v194, s26, v92
  v_lshlrev_b32 v195, 16, v92
  v_fmac_f32 v72, v192, v46
  v_fmac_f32 v73, v193, v46
  v_fmac_f32 v74, v194, v46
  v_fmac_f32 v75, v195, v46
  v_cvt_pk_bf16_f32 v196, v72, v73
  v_cvt_pk_bf16_f32 v197, v74, v75
  buffer_store_dwordx2 v[196:197], v8, s[12:15], s23 offen offset:3072
  v_and_b32 v200, s26, v95
  v_lshlrev_b32 v201, 16, v95
  v_and_b32 v202, s26, v94
  v_lshlrev_b32 v203, 16, v94
  v_fmac_f32 v76, v200, v46
  v_fmac_f32 v77, v201, v46
  v_fmac_f32 v78, v202, v46
  v_fmac_f32 v79, v203, v46
  v_cvt_pk_bf16_f32 v204, v76, v77
  v_cvt_pk_bf16_f32 v205, v78, v79
  buffer_store_dwordx2 v[204:205], v8, s[12:15], s23 offen offset:3584
K2_END:
  s_endpgm

.section .rodata,"a"
.p2align 6
.amdhsa_kernel k2_kernel
  .amdhsa_next_free_vgpr 256
  .amdhsa_next_free_sgpr 96
  .amdhsa_accum_offset 256
  .amdhsa_group_segment_fixed_size 0
  .amdhsa_kernarg_size 112
  .amdhsa_user_sgpr_count 2
  .amdhsa_user_sgpr_kernarg_segment_ptr 1
  .amdhsa_system_sgpr_workgroup_id_x 1
  .amdhsa_float_denorm_mode_32 3
.end_amdhsa_kernel
.text
.globl k3_kernel
.p2align 8
.type k3_kernel,@function
k3_kernel:
  s_cmp_ge_u32 s2, 256
  s_cbranch_scc1 K3_END
  s_load_dwordx2 s[36:37], s[0:1], 0
  s_load_dwordx2 s[38:39], s[0:1], 88
  s_load_dwordx2 s[40:41], s[0:1], 104
  v_and_b32 v1, 63, v0
  v_lshrrev_b32 v12, 6, v0
  v_lshrrev_b32 v2, 4, v1
  v_readfirstlane_b32 s22, v12
  v_and_b32 v3, 15, v1
  v_lshlrev_b32 v4, 4, v1
  s_and_b32 s23, s2, 7
  s_lshr_b32 s24, s2, 3
  s_lshr_b32 s20, s23, 1
  s_lshl_b32 s20, s20, 3
  s_lshr_b32 s25, s24, 2
  s_add_u32 s20, s20, s25
  s_and_b32 s21, s23, 1
  s_lshl_b32 s21, s21, 2
  s_and_b32 s25, s24, 3
  s_add_u32 s21, s21, s25
  s_mov_b32 s26, 0xffff0000
  s_mov_b64 s[28:29], exec
  s_waitcnt lgkmcnt(0)
  s_mov_b32 s8, s36
  s_and_b32 s9, s37, 0xffff
  s_mov_b32 s10, 2621440
  s_mov_b32 s11, 0x20000
  s_mov_b32 s16, s38
  s_and_b32 s17, s39, 0xffff
  s_mov_b32 s18, 2621440
  s_mov_b32 s19, 0x20000
  s_mov_b32 s12, s40
  s_and_b32 s13, s41, 0xffff
  s_mov_b32 s14, 18874368
  s_mov_b32 s15, 0x20000
  s_lshl_b32 s34, s20, 2
  s_add_u32 s34, s34, s22
  s_mul_i32 s35, s34, 24576
  s_add_u32 s35, s35, 12582912
  s_mul_i32 s33, s21, 122880
  s_lshl_b32 s23, s22, 10
  s_add_u32 s33, s33, s23
  s_add_u32 s33, s33, 15728640
  s_mul_i32 s37, s22, 5120
  s_and_b32 s23, s20, 7
  s_and_b32 s24, s21, 3
  s_lshl_b32 s24, s24, 1
  s_add_u32 s38, s23, s24
  s_sub_u32 s23, s38, 6
  s_cmp_ge_u32 s38, 6
  s_cselect_b32 s38, s23, s38
  s_sub_u32 s23, s38, 6
  s_cmp_ge_u32 s38, 6
  s_cselect_b32 s38, s23, s38
  s_mov_b32 s38, 0
  s_add_u32 s39, s38, 0
  s_sub_u32 s23, s39, 6
  s_cmp_ge_u32 s39, 6
  s_cselect_b32 s39, s23, s39
  s_lshl_b32 s39, s39, 12
  s_add_u32 m0, s37, 0
  s_add_u32 s23, s33, 0
  s_add_u32 s23, s23, s39
  buffer_load_dwordx4 v4, s[12:15], s23 offen lds
  s_add_u32 m0, s37, 1024
  s_add_u32 s23, s33, 24576
  s_add_u32 s23, s23, s39
  buffer_load_dwordx4 v4, s[12:15], s23 offen lds
  s_add_u32 m0, s37, 2048
  s_add_u32 s23, s33, 49152
  s_add_u32 s23, s23, s39
  buffer_load_dwordx4 v4, s[12:15], s23 offen lds
  s_add_u32 m0, s37, 3072
  s_add_u32 s23, s33, 73728
  s_add_u32 s23, s23, s39
  buffer_load_dwordx4 v4, s[12:15], s23 offen lds
  s_add_u32 m0, s37, 4096
  s_add_u32 s23, s33, 98304
  s_add_u32 s23, s23, s39
  buffer_load_dwordx4 v4, s[12:15], s23 offen lds
  s_add_u32 s23, s35, s39
  buffer_load_dwordx4 v[88:91], v4, s[12:15], s23 offen offset:0
  s_add_u32 s23, s35, s39
  buffer_load_dwordx4 v[92:95], v4, s[12:15], s23 offen offset:1024
  s_add_u32 s23, s35, s39
  buffer_load_dwordx4 v[96:99], v4, s[12:15], s23 offen offset:2048
  s_add_u32 s23, s35, s39
  buffer_load_dwordx4 v[100:103], v4, s[12:15], s23 offen offset:3072
  s_add_u32 s39, s38, 1
  s_sub_u32 s23, s39, 6
  s_cmp_ge_u32 s39, 6
  s_cselect_b32 s39, s23, s39
  s_lshl_b32 s39, s39, 12
  s_add_u32 m0, s37, 20480
  s_add_u32 s23, s33, 0
  s_add_u32 s23, s23, s39
  buffer_load_dwordx4 v4, s[12:15], s23 offen lds
  s_add_u32 m0, s37, 21504
  s_add_u32 s23, s33, 24576
  s_add_u32 s23, s23, s39
  buffer_load_dwordx4 v4, s[12:15], s23 offen lds
  s_add_u32 m0, s37, 22528
  s_add_u32 s23, s33, 49152
  s_add_u32 s23, s23, s39
  buffer_load_dwordx4 v4, s[12:15], s23 offen lds
  s_add_u32 m0, s37, 23552
  s_add_u32 s23, s33, 73728
  s_add_u32 s23, s23, s39
  buffer_load_dwordx4 v4, s[12:15], s23 offen lds
  s_add_u32 m0, s37, 24576
  s_add_u32 s23, s33, 98304
  s_add_u32 s23, s23, s39
  buffer_load_dwordx4 v4, s[12:15], s23 offen lds
  s_add_u32 s23, s35, s39
  buffer_load_dwordx4 v[104:107], v4, s[12:15], s23 offen offset:0
  s_add_u32 s23, s35, s39
  buffer_load_dwordx4 v[108:111], v4, s[12:15], s23 offen offset:1024
  s_add_u32 s23, s35, s39
  buffer_load_dwordx4 v[112:115], v4, s[12:15], s23 offen offset:2048
  s_add_u32 s23, s35, s39
  buffer_load_dwordx4 v[116:119], v4, s[12:15], s23 offen offset:3072
  s_lshl_b32 s23, s34, 4
  s_mul_i32 s23, s23, 1280
  s_mul_i32 s24, s21, 160
  s_add_u32 s23, s23, s24
  v_add_u32 v12, 0, v1
  v_mul_u32_u24 v13, 6554, v12
  v_lshrrev_b32 v13, 16, v13
  v_mul_u32_u24 v14, 10, v13
  v_sub_u32 v14, v12, v14
  v_lshlrev_b32 v14, 4, v14
  v_mul_u32_u24 v13, 1280, v13
  v_add_u32 v13, v13, v14
  v_add_u32 v5, s23, v13
  v_lshrrev_b32 v13, 1, v12
  v_lshlrev_b32 v13, 12, v13
  v_and_b32 v14, 1, v12
  v_lshlrev_b32 v14, 4, v14
  v_add_u32 v8, v13, v14
  v_add_u32 v12, 64, v1
  v_mul_u32_u24 v13, 6554, v12
  v_lshrrev_b32 v13, 16, v13
  v_mul_u32_u24 v14, 10, v13
  v_sub_u32 v14, v12, v14
  v_lshlrev_b32 v14, 4, v14
  v_mul_u32_u24 v13, 1280, v13
  v_add_u32 v13, v13, v14
  v_add_u32 v6, s23, v13
  v_lshrrev_b32 v13, 1, v12
  v_lshlrev_b32 v13, 12, v13
  v_and_b32 v14, 1, v12
  v_lshlrev_b32 v14, 4, v14
  v_add_u32 v9, v13, v14
  v_add_u32 v12, 128, v1
  v_mul_u32_u24 v13, 6554, v12
  v_lshrrev_b32 v13, 16, v13
  v_mul_u32_u24 v14, 10, v13
  v_sub_u32 v14, v12, v14
  v_lshlrev_b32 v14, 4, v14
  v_mul_u32_u24 v13, 1280, v13
  v_add_u32 v13, v13, v14
  v_add_u32 v7, s23, v13
  v_lshrrev_b32 v13, 1, v12
  v_lshlrev_b32 v13, 12, v13
  v_and_b32 v14, 1, v12
  v_lshlrev_b32 v14, 4, v14
  v_add_u32 v10, v13, v14
  s_mul_i32 s44, s22, 2560
  s_mul_i32 s45, s21, 327680
  s_lshl_b32 s24, s34, 5
  s_add_u32 s45, s45, s24
  s_add_u32 s45, s45, 9437184
  v_lshlrev_b32 v21, 3, v3
  s_lshl_b32 s46, s34, 7
  s_add_u32 s46, s46, 16777216
  v_mov_b32 v68, 0
  v_mov_b32 v69, 0
  v_mov_b32 v70, 0
  v_mov_b32 v71, 0
  v_mov_b32 v72, 0
  v_mov_b32 v73, 0
  v_mov_b32 v74, 0
  v_mov_b32 v75, 0
  v_mov_b32 v76, 0
  v_mov_b32 v77, 0
  v_mov_b32 v78, 0
  v_mov_b32 v79, 0
  v_mov_b32 v80, 0
  v_mov_b32 v81, 0
  v_mov_b32 v82, 0
  v_mov_b32 v83, 0
  v_mov_b32 v84, 0
  v_mov_b32 v85, 0
  v_mov_b32 v86, 0
  v_mov_b32 v87, 0
  v_add_u32 v20, 65536, v4
  s_waitcnt vmcnt(9)
  s_barrier
  ds_read_b128 v[28:31], v4 offset:0
  ds_read_b128 v[32:35], v4 offset:1024
  ds_read_b128 v[36:39], v4 offset:2048
  ds_read_b128 v[40:43], v4 offset:3072
  ds_read_b128 v[44:47], v4 offset:4096
  s_waitcnt lgkmcnt(0)
  v_mfma_f32_16x16x32_bf16 v[68:71], v[28:31], v[88:91], v[68:71]
  ds_read_b128 v[48:51], v4 offset:5120
  v_mfma_f32_16x16x32_bf16 v[72:75], v[32:35], v[88:91], v[72:75]
  ds_read_b128 v[52:55], v4 offset:6144
  s_add_u32 s39, s38, 2
  s_sub_u32 s23, s39, 6
  s_cmp_ge_u32 s39, 6
  s_cselect_b32 s39, s23, s39
  s_lshl_b32 s39, s39, 12
  s_add_u32 m0, s37, 40960
  s_add_u32 s23, s33, 0
  s_add_u32 s23, s23, s39
  buffer_load_dwordx4 v4, s[12:15], s23 offen lds
  v_mfma_f32_16x16x32_bf16 v[76:79], v[36:39], v[88:91], v[76:79]
  ds_read_b128 v[56:59], v4 offset:7168
  s_add_u32 m0, s37, 41984
  s_add_u32 s23, s33, 24576
  s_add_u32 s23, s23, s39
  buffer_load_dwordx4 v4, s[12:15], s23 offen lds
  v_mfma_f32_16x16x32_bf16 v[80:83], v[40:43], v[88:91], v[80:83]
  ds_read_b128 v[60:63], v4 offset:8192
  v_mfma_f32_16x16x32_bf16 v[84:87], v[44:47], v[88:91], v[84:87]
  ds_read_b128 v[64:67], v4 offset:9216
  s_waitcnt lgkmcnt(0)
  v_mfma_f32_16x16x32_bf16 v[68:71], v[48:51], v[92:95], v[68:71]
  ds_read_b128 v[28:31], v4 offset:10240
  v_mfma_f32_16x16x32_bf16 v[72:75], v[52:55], v[92:95], v[72:75]
  ds_read_b128 v[32:35], v4 offset:11264
  s_add_u32 m0, s37, 43008
  s_add_u32 s23, s33, 49152
  s_add_u32 s23, s23, s39
  buffer_load_dwordx4 v4, s[12:15], s23 offen lds
  v_mfma_f32_16x16x32_bf16 v[76:79], v[56:59], v[92:95], v[76:79]
  ds_read_b128 v[36:39], v4 offset:12288
  s_add_u32 m0, s37, 44032
  s_add_u32 s23, s33, 73728
  s_add_u32 s23, s23, s39
  buffer_load_dwordx4 v4, s[12:15], s23 offen lds
  v_mfma_f32_16x16x32_bf16 v[80:83], v[60:63], v[92:95], v[80:83]
  ds_read_b128 v[40:43], v4 offset:13312
  v_mfma_f32_16x16x32_bf16 v[84:87], v[64:67], v[92:95], v[84:87]
  ds_read_b128 v[44:47], v4 offset:14336
  s_waitcnt lgkmcnt(0)
  v_mfma_f32_16x16x32_bf16 v[68:71], v[28:31], v[96:99], v[68:71]
  ds_read_b128 v[48:51], v4 offset:15360
  v_mfma_f32_16x16x32_bf16 v[72:75], v[32:35], v[96:99], v[72:75]
  ds_read_b128 v[52:55], v4 offset:16384
  s_add_u32 m0, s37, 45056
  s_add_u32 s23, s33, 98304
  s_add_u32 s23, s23, s39
  buffer_load_dwordx4 v4, s[12:15], s23 offen lds
  v_mfma_f32_16x16x32_bf16 v[76:79], v[36:39], v[96:99], v[76:79]
  ds_read_b128 v[56:59], v4 offset:17408
  s_add_u32 s23, s35, s39
  buffer_load_dwordx4 v[120:123], v4, s[12:15], s23 offen offset:0
  v_mfma_f32_16x16x32_bf16 v[80:83], v[40:43], v[96:99], v[80:83]
  ds_read_b128 v[60:63], v4 offset:18432
  v_mfma_f32_16x16x32_bf16 v[84:87], v[44:47], v[96:99], v[84:87]
  ds_read_b128 v[64:67], v4 offset:19456
  s_waitcnt vmcnt(6) lgkmcnt(0)
  s_barrier
  v_mfma_f32_16x16x32_bf16 v[68:71], v[48:51], v[100:103], v[68:71]
  ds_read_b128 v[28:31], v4 offset:20480
  v_mfma_f32_16x16x32_bf16 v[72:75], v[52:55], v[100:103], v[72:75]
  ds_read_b128 v[32:35], v4 offset:21504
  s_add_u32 s23, s35, s39
  buffer_load_dwordx4 v[124:127], v4, s[12:15], s23 offen offset:1024
  v_mfma_f32_16x16x32_bf16 v[76:79], v[56:59], v[100:103], v[76:79]
  ds_read_b128 v[36:39], v4 offset:22528
  s_add_u32 s23, s35, s39
  buffer_load_dwordx4 v[128:131], v4, s[12:15], s23 offen offset:2048
  v_mfma_f32_16x16x32_bf16 v[80:83], v[60:63], v[100:103], v[80:83]
  ds_read_b128 v[40:43], v4 offset:23552
  s_add_u32 s23, s35, s39
  buffer_load_dwordx4 v[132:135], v4, s[12:15], s23 offen offset:3072
  v_mfma_f32_16x16x32_bf16 v[84:87], v[64:67], v[100:103], v[84:87]
  ds_read_b128 v[44:47], v4 offset:24576
  s_waitcnt lgkmcnt(0)
  v_mfma_f32_16x16x32_bf16 v[68:71], v[28:31], v[104:107], v[68:71]
  ds_read_b128 v[48:51], v4 offset:25600
  v_mfma_f32_16x16x32_bf16 v[72:75], v[32:35], v[104:107], v[72:75]
  ds_read_b128 v[52:55], v4 offset:26624
  s_add_u32 s39, s38, 3
  s_sub_u32 s23, s39, 6
  s_cmp_ge_u32 s39, 6
  s_cselect_b32 s39, s23, s39
  s_lshl_b32 s39, s39, 12
  s_add_u32 m0, s37, 61440
  s_add_u32 s23, s33, 0
  s_add_u32 s23, s23, s39
  buffer_load_dwordx4 v4, s[12:15], s23 offen lds
  v_mfma_f32_16x16x32_bf16 v[76:79], v[36:39], v[104:107], v[76:79]
  ds_read_b128 v[56:59], v4 offset:27648
  s_add_u32 m0, s37, 62464
  s_add_u32 s23, s33, 24576
  s_add_u32 s23, s23, s39
  buffer_load_dwordx4 v4, s[12:15], s23 offen lds
  v_mfma_f32_16x16x32_bf16 v[80:83], v[40:43], v[104:107], v[80:83]
  ds_read_b128 v[60:63], v4 offset:28672
  v_mfma_f32_16x16x32_bf16 v[84:87], v[44:47], v[104:107], v[84:87]
  ds_read_b128 v[64:67], v4 offset:29696
  s_waitcnt lgkmcnt(0)
  v_mfma_f32_16x16x32_bf16 v[68:71], v[48:51], v[108:111], v[68:71]
  ds_read_b128 v[28:31], v4 offset:30720
  v_mfma_f32_16x16x32_bf16 v[72:75], v[52:55], v[108:111], v[72:75]
  ds_read_b128 v[32:35], v4 offset:31744
  s_add_u32 m0, s37, 63488
  s_add_u32 s23, s33, 49152
  s_add_u32 s23, s23, s39
  buffer_load_dwordx4 v4, s[12:15], s23 offen lds
  v_mfma_f32_16x16x32_bf16 v[76:79], v[56:59], v[108:111], v[76:79]
  ds_read_b128 v[36:39], v4 offset:32768
  s_add_u32 m0, s37, 64512
  s_add_u32 s23, s33, 73728
  s_add_u32 s23, s23, s39
  buffer_load_dwordx4 v4, s[12:15], s23 offen lds
  v_mfma_f32_16x16x32_bf16 v[80:83], v[60:63], v[108:111], v[80:83]
  ds_read_b128 v[40:43], v4 offset:33792
  v_mfma_f32_16x16x32_bf16 v[84:87], v[64:67], v[108:111], v[84:87]
  ds_read_b128 v[44:47], v4 offset:34816
  s_waitcnt lgkmcnt(0)
  v_mfma_f32_16x16x32_bf16 v[68:71], v[28:31], v[112:115], v[68:71]
  ds_read_b128 v[48:51], v4 offset:35840
  v_mfma_f32_16x16x32_bf16 v[72:75], v[32:35], v[112:115], v[72:75]
  ds_read_b128 v[52:55], v4 offset:36864
  s_add_u32 m0, s37, 65536
  s_add_u32 s23, s33, 98304
  s_add_u32 s23, s23, s39
  buffer_load_dwordx4 v4, s[12:15], s23 offen lds
  v_mfma_f32_16x16x32_bf16 v[76:79], v[36:39], v[112:115], v[76:79]
  ds_read_b128 v[56:59], v4 offset:37888
  s_add_u32 s23, s35, s39
  buffer_load_dwordx4 v[136:139], v4, s[12:15], s23 offen offset:0
  v_mfma_f32_16x16x32_bf16 v[80:83], v[40:43], v[112:115], v[80:83]
  ds_read_b128 v[60:63], v4 offset:38912
  v_mfma_f32_16x16x32_bf16 v[84:87], v[44:47], v[112:115], v[84:87]
  ds_read_b128 v[64:67], v4 offset:39936
  s_waitcnt vmcnt(6) lgkmcnt(0)
  s_barrier
  v_mfma_f32_16x16x32_bf16 v[68:71], v[48:51], v[116:119], v[68:71]
  ds_read_b128 v[28:31], v4 offset:40960
  v_mfma_f32_16x16x32_bf16 v[72:75], v[52:55], v[116:119], v[72:75]
  ds_read_b128 v[32:35], v4 offset:41984
  s_add_u32 s23, s35, s39
  buffer_load_dwordx4 v[140:143], v4, s[12:15], s23 offen offset:1024
  v_mfma_f32_16x16x32_bf16 v[76:79], v[56:59], v[116:119], v[76:79]
  ds_read_b128 v[36:39], v4 offset:43008
  s_add_u32 s23, s35, s39
  buffer_load_dwordx4 v[144:147], v4, s[12:15], s23 offen offset:2048
  v_mfma_f32_16x16x32_bf16 v[80:83], v[60:63], v[116:119], v[80:83]
  ds_read_b128 v[40:43], v4 offset:44032
  s_add_u32 s23, s35, s39
  buffer_load_dwordx4 v[148:151], v4, s[12:15], s23 offen offset:3072
  v_mfma_f32_16x16x32_bf16 v[84:87], v[64:67], v[116:119], v[84:87]
  ds_read_b128 v[44:47], v4 offset:45056
  s_waitcnt lgkmcnt(0)
  v_mfma_f32_16x16x32_bf16 v[68:71], v[28:31], v[120:123], v[68:71]
  ds_read_b128 v[48:51], v4 offset:46080
  v_mfma_f32_16x16x32_bf16 v[72:75], v[32:35], v[120:123], v[72:75]
  ds_read_b128 v[52:55], v4 offset:47104
  s_add_u32 s39, s38, 4
  s_sub_u32 s23, s39, 6
  s_cmp_ge_u32 s39, 6
  s_cselect_b32 s39, s23, s39
  s_lshl_b32 s39, s39, 12
  s_add_u32 m0, s37, 81920
  s_add_u32 s23, s33, 0
  s_add_u32 s23, s23, s39
  buffer_load_dwordx4 v4, s[12:15], s23 offen lds
  v_mfma_f32_16x16x32_bf16 v[76:79], v[36:39], v[120:123], v[76:79]
  ds_read_b128 v[56:59], v4 offset:48128
  s_add_u32 m0, s37, 82944
  s_add_u32 s23, s33, 24576
  s_add_u32 s23, s23, s39
  buffer_load_dwordx4 v4, s[12:15], s23 offen lds
  v_mfma_f32_16x16x32_bf16 v[80:83], v[40:43], v[120:123], v[80:83]
  ds_read_b128 v[60:63], v4 offset:49152
  v_mfma_f32_16x16x32_bf16 v[84:87], v[44:47], v[120:123], v[84:87]
  ds_read_b128 v[64:67], v4 offset:50176
  s_waitcnt lgkmcnt(0)
  v_mfma_f32_16x16x32_bf16 v[68:71], v[48:51], v[124:127], v[68:71]
  ds_read_b128 v[28:31], v4 offset:51200
  v_mfma_f32_16x16x32_bf16 v[72:75], v[52:55], v[124:127], v[72:75]
  ds_read_b128 v[32:35], v4 offset:52224
  s_add_u32 m0, s37, 83968
  s_add_u32 s23, s33, 49152
  s_add_u32 s23, s23, s39
  buffer_load_dwordx4 v4, s[12:15], s23 offen lds
  v_mfma_f32_16x16x32_bf16 v[76:79], v[56:59], v[124:127], v[76:79]
  ds_read_b128 v[36:39], v4 offset:53248
  s_add_u32 m0, s37, 84992
  s_add_u32 s23, s33, 73728
  s_add_u32 s23, s23, s39
  buffer_load_dwordx4 v4, s[12:15], s23 offen lds
  v_mfma_f32_16x16x32_bf16 v[80:83], v[60:63], v[124:127], v[80:83]
  ds_read_b128 v[40:43], v4 offset:54272
  v_mfma_f32_16x16x32_bf16 v[84:87], v[64:67], v[124:127], v[84:87]
  ds_read_b128 v[44:47], v4 offset:55296
  s_waitcnt lgkmcnt(0)
  v_mfma_f32_16x16x32_bf16 v[68:71], v[28:31], v[128:131], v[68:71]
  ds_read_b128 v[48:51], v4 offset:56320
  v_mfma_f32_16x16x32_bf16 v[72:75], v[32:35], v[128:131], v[72:75]
  ds_read_b128 v[52:55], v4 offset:57344
  s_add_u32 m0, s37, 86016
  s_add_u32 s23, s33, 98304
  s_add_u32 s23, s23, s39
  buffer_load_dwordx4 v4, s[12:15], s23 offen lds
  v_mfma_f32_16x16x32_bf16 v[76:79], v[36:39], v[128:131], v[76:79]
  ds_read_b128 v[56:59], v4 offset:58368
  s_add_u32 s23, s35, s39
  buffer_load_dwordx4 v[152:155], v4, s[12:15], s23 offen offset:0
  v_mfma_f32_16x16x32_bf16 v[80:83], v[40:43], v[128:131], v[80:83]
  ds_read_b128 v[60:63], v4 offset:59392
  v_mfma_f32_16x16x32_bf16 v[84:87], v[44:47], v[128:131], v[84:87]
  ds_read_b128 v[64:67], v4 offset:60416
  s_waitcnt vmcnt(6) lgkmcnt(0)
  s_barrier
  v_mfma_f32_16x16x32_bf16 v[68:71], v[48:51], v[132:135], v[68:71]
  ds_read_b128 v[28:31], v4 offset:61440
  v_mfma_f32_16x16x32_bf16 v[72:75], v[52:55], v[132:135], v[72:75]
  ds_read_b128 v[32:35], v4 offset:62464
  s_add_u32 s23, s35, s39
  buffer_load_dwordx4 v[156:159], v4, s[12:15], s23 offen offset:1024
  v_mfma_f32_16x16x32_bf16 v[76:79], v[56:59], v[132:135], v[76:79]
  ds_read_b128 v[36:39], v4 offset:63488
  s_add_u32 s23, s35, s39
  buffer_load_dwordx4 v[160:163], v4, s[12:15], s23 offen offset:2048
  v_mfma_f32_16x16x32_bf16 v[80:83], v[60:63], v[132:135], v[80:83]
  ds_read_b128 v[40:43], v4 offset:64512
  s_add_u32 s23, s35, s39
  buffer_load_dwordx4 v[164:167], v4, s[12:15], s23 offen offset:3072
  v_mfma_f32_16x16x32_bf16 v[84:87], v[64:67], v[132:135], v[84:87]
  ds_read_b128 v[44:47], v20 offset:0
  s_waitcnt lgkmcnt(0)
  v_mfma_f32_16x16x32_bf16 v[68:71], v[28:31], v[136:139], v[68:71]
  ds_read_b128 v[48:51], v20 offset:1024
  v_mfma_f32_16x16x32_bf16 v[72:75], v[32:35], v[136:139], v[72:75]
  ds_read_b128 v[52:55], v20 offset:2048
  s_add_u32 s39, s38, 5
  s_sub_u32 s23, s39, 6
  s_cmp_ge_u32 s39, 6
  s_cselect_b32 s39, s23, s39
  s_lshl_b32 s39, s39, 12
  s_add_u32 m0, s37, 102400
  s_add_u32 s23, s33, 0
  s_add_u32 s23, s23, s39
  buffer_load_dwordx4 v4, s[12:15], s23 offen lds
  v_mfma_f32_16x16x32_bf16 v[76:79], v[36:39], v[136:139], v[76:79]
  ds_read_b128 v[56:59], v20 offset:3072
  s_add_u32 m0, s37, 103424
  s_add_u32 s23, s33, 24576
  s_add_u32 s23, s23, s39
  buffer_load_dwordx4 v4, s[12:15], s23 offen lds
  v_mfma_f32_16x16x32_bf16 v[80:83], v[40:43], v[136:139], v[80:83]
  ds_read_b128 v[60:63], v20 offset:4096
  v_mfma_f32_16x16x32_bf16 v[84:87], v[44:47], v[136:139], v[84:87]
  ds_read_b128 v[64:67], v20 offset:5120
  s_waitcnt lgkmcnt(0)
  v_mfma_f32_16x16x32_bf16 v[68:71], v[48:51], v[140:143], v[68:71]
  ds_read_b128 v[28:31], v20 offset:6144
  v_mfma_f32_16x16x32_bf16 v[72:75], v[52:55], v[140:143], v[72:75]
  ds_read_b128 v[32:35], v20 offset:7168
  s_add_u32 m0, s37, 104448
  s_add_u32 s23, s33, 49152
  s_add_u32 s23, s23, s39
  buffer_load_dwordx4 v4, s[12:15], s23 offen lds
  v_mfma_f32_16x16x32_bf16 v[76:79], v[56:59], v[140:143], v[76:79]
  ds_read_b128 v[36:39], v20 offset:8192
  s_add_u32 m0, s37, 105472
  s_add_u32 s23, s33, 73728
  s_add_u32 s23, s23, s39
  buffer_load_dwordx4 v4, s[12:15], s23 offen lds
  v_mfma_f32_16x16x32_bf16 v[80:83], v[60:63], v[140:143], v[80:83]
  ds_read_b128 v[40:43], v20 offset:9216
  v_mfma_f32_16x16x32_bf16 v[84:87], v[64:67], v[140:143], v[84:87]
  ds_read_b128 v[44:47], v20 offset:10240
  s_waitcnt lgkmcnt(0)
  v_mfma_f32_16x16x32_bf16 v[68:71], v[28:31], v[144:147], v[68:71]
  ds_read_b128 v[48:51], v20 offset:11264
  v_mfma_f32_16x16x32_bf16 v[72:75], v[32:35], v[144:147], v[72:75]
  ds_read_b128 v[52:55], v20 offset:12288
  s_add_u32 m0, s37, 106496
  s_add_u32 s23, s33, 98304
  s_add_u32 s23, s23, s39
  buffer_load_dwordx4 v4, s[12:15], s23 offen lds
  v_mfma_f32_16x16x32_bf16 v[76:79], v[36:39], v[144:147], v[76:79]
  ds_read_b128 v[56:59], v20 offset:13312
  s_add_u32 s23, s35, s39
  buffer_load_dwordx4 v[168:171], v4, s[12:15], s23 offen offset:0
  v_mfma_f32_16x16x32_bf16 v[80:83], v[40:43], v[144:147], v[80:83]
  ds_read_b128 v[60:63], v20 offset:14336
  v_mfma_f32_16x16x32_bf16 v[84:87], v[44:47], v[144:147], v[84:87]
  ds_read_b128 v[64:67], v20 offset:15360
  s_waitcnt vmcnt(6) lgkmcnt(0)
  s_barrier
  v_mfma_f32_16x16x32_bf16 v[68:71], v[48:51], v[148:151], v[68:71]
  ds_read_b128 v[28:31], v20 offset:16384
  v_mfma_f32_16x16x32_bf16 v[72:75], v[52:55], v[148:151], v[72:75]
  ds_read_b128 v[32:35], v20 offset:17408
  s_add_u32 s23, s35, s39
  buffer_load_dwordx4 v[172:175], v4, s[12:15], s23 offen offset:1024
  v_mfma_f32_16x16x32_bf16 v[76:79], v[56:59], v[148:151], v[76:79]
  ds_read_b128 v[36:39], v20 offset:18432
  s_add_u32 s23, s35, s39
  buffer_load_dwordx4 v[176:179], v4, s[12:15], s23 offen offset:2048
  v_mfma_f32_16x16x32_bf16 v[80:83], v[60:63], v[148:151], v[80:83]
  ds_read_b128 v[40:43], v20 offset:19456
  s_add_u32 s23, s35, s39
  buffer_load_dwordx4 v[180:183], v4, s[12:15], s23 offen offset:3072
  v_mfma_f32_16x16x32_bf16 v[84:87], v[64:67], v[148:151], v[84:87]
  ds_read_b128 v[44:47], v20 offset:20480
  s_waitcnt lgkmcnt(0)
  v_mfma_f32_16x16x32_bf16 v[68:71], v[28:31], v[152:155], v[68:71]
  ds_read_b128 v[48:51], v20 offset:21504
  v_mfma_f32_16x16x32_bf16 v[72:75], v[32:35], v[152:155], v[72:75]
  ds_read_b128 v[52:55], v20 offset:22528
  s_add_u32 m0, s44, 122880
  s_nop 0
  buffer_load_dwordx4 v5, s[8:11], 0 offen lds
  v_mfma_f32_16x16x32_bf16 v[76:79], v[36:39], v[152:155], v[76:79]
  ds_read_b128 v[56:59], v20 offset:23552
  v_mfma_f32_16x16x32_bf16 v[80:83], v[40:43], v[152:155], v[80:83]
  ds_read_b128 v[60:63], v20 offset:24576
  v_mfma_f32_16x16x32_bf16 v[84:87], v[44:47], v[152:155], v[84:87]
  ds_read_b128 v[64:67], v20 offset:25600
  s_waitcnt lgkmcnt(0)
  v_mfma_f32_16x16x32_bf16 v[68:71], v[48:51], v[156:159], v[68:71]
  ds_read_b128 v[28:31], v20 offset:26624
  v_mfma_f32_16x16x32_bf16 v[72:75], v[52:55], v[156:159], v[72:75]
  ds_read_b128 v[32:35], v20 offset:27648
  s_add_u32 m0, s44, 133120
  s_nop 0
  buffer_load_dwordx4 v8, s[12:15], s45 offen lds
  v_mfma_f32_16x16x32_bf16 v[76:79], v[56:59], v[156:159], v[76:79]
  ds_read_b128 v[36:39], v20 offset:28672
  s_add_u32 m0, s44, 123904
  s_nop 0
  buffer_load_dwordx4 v6, s[8:11], 0 offen lds
  v_mfma_f32_16x16x32_bf16 v[80:83], v[60:63], v[156:159], v[80:83]
  ds_read_b128 v[40:43], v20 offset:29696
  v_mfma_f32_16x16x32_bf16 v[84:87], v[64:67], v[156:159], v[84:87]
  ds_read_b128 v[44:47], v20 offset:30720
  s_waitcnt lgkmcnt(0)
  v_mfma_f32_16x16x32_bf16 v[68:71], v[28:31], v[160:163], v[68:71]
  ds_read_b128 v[48:51], v20 offset:31744
  v_mfma_f32_16x16x32_bf16 v[72:75], v[32:35], v[160:163], v[72:75]
  ds_read_b128 v[52:55], v20 offset:32768
  s_add_u32 m0, s44, 134144
  s_nop 0
  buffer_load_dwordx4 v9, s[12:15], s45 offen lds
  v_mfma_f32_16x16x32_bf16 v[76:79], v[36:39], v[160:163], v[76:79]
  ds_read_b128 v[56:59], v20 offset:33792
  s_mov_b32 exec_hi, 0
  s_add_u32 m0, s44, 124928
  s_nop 0
  buffer_load_dwordx4 v7, s[8:11], 0 offen lds
  s_mov_b32 exec_hi, -1
  v_mfma_f32_16x16x32_bf16 v[80:83], v[40:43], v[160:163], v[80:83]
  ds_read_b128 v[60:63], v20 offset:34816
  v_mfma_f32_16x16x32_bf16 v[84:87], v[44:47], v[160:163], v[84:87]
  ds_read_b128 v[64:67], v20 offset:35840
  s_waitcnt vmcnt(5) lgkmcnt(0)
  s_barrier
  v_mfma_f32_16x16x32_bf16 v[68:71], v[48:51], v[164:167], v[68:71]
  ds_read_b128 v[28:31], v20 offset:36864
  v_mfma_f32_16x16x32_bf16 v[72:75], v[52:55], v[164:167], v[72:75]
  ds_read_b128 v[32:35], v20 offset:37888
  s_mov_b32 exec_hi, 0
  s_add_u32 m0, s44, 135168
  s_nop 0
  buffer_load_dwordx4 v10, s[12:15], s45 offen lds
  s_mov_b32 exec_hi, -1
  v_mfma_f32_16x16x32_bf16 v[76:79], v[56:59], v[164:167], v[76:79]
  ds_read_b128 v[36:39], v20 offset:38912
  buffer_load_dwordx2 v[24:25], v21, s[12:15], s46 offen
  v_mfma_f32_16x16x32_bf16 v[80:83], v[60:63], v[164:167], v[80:83]
  ds_read_b128 v[40:43], v20 offset:39936
  v_mfma_f32_16x16x32_bf16 v[84:87], v[64:67], v[164:167], v[84:87]
  ds_read_b128 v[44:47], v20 offset:40960
  s_waitcnt lgkmcnt(0)
  v_mfma_f32_16x16x32_bf16 v[68:71], v[28:31], v[168:171], v[68:71]
  ds_read_b128 v[48:51], v20 offset:41984
  v_mfma_f32_16x16x32_bf16 v[72:75], v[32:35], v[168:171], v[72:75]
  ds_read_b128 v[52:55], v20 offset:43008
  v_mfma_f32_16x16x32_bf16 v[76:79], v[36:39], v[168:171], v[76:79]
  ds_read_b128 v[56:59], v20 offset:44032
  v_mfma_f32_16x16x32_bf16 v[80:83], v[40:43], v[168:171], v[80:83]
  ds_read_b128 v[60:63], v20 offset:45056
  v_mfma_f32_16x16x32_bf16 v[84:87], v[44:47], v[168:171], v[84:87]
  ds_read_b128 v[64:67], v20 offset:46080
  s_waitcnt lgkmcnt(0)
  v_mfma_f32_16x16x32_bf16 v[68:71], v[48:51], v[172:175], v[68:71]
  ds_read_b128 v[28:31], v20 offset:47104
  v_mfma_f32_16x16x32_bf16 v[72:75], v[52:55], v[172:175], v[72:75]
  ds_read_b128 v[32:35], v20 offset:48128
  v_mfma_f32_16x16x32_bf16 v[76:79], v[56:59], v[172:175], v[76:79]
  ds_read_b128 v[36:39], v20 offset:49152
  v_mfma_f32_16x16x32_bf16 v[80:83], v[60:63], v[172:175], v[80:83]
  ds_read_b128 v[40:43], v20 offset:50176
  v_mfma_f32_16x16x32_bf16 v[84:87], v[64:67], v[172:175], v[84:87]
  ds_read_b128 v[44:47], v20 offset:51200
  s_waitcnt lgkmcnt(0)
  v_mfma_f32_16x16x32_bf16 v[68:71], v[28:31], v[176:179], v[68:71]
  ds_read_b128 v[48:51], v20 offset:52224
  v_mfma_f32_16x16x32_bf16 v[72:75], v[32:35], v[176:179], v[72:75]
  ds_read_b128 v[52:55], v20 offset:53248
  v_mfma_f32_16x16x32_bf16 v[76:79], v[36:39], v[176:179], v[76:79]
  ds_read_b128 v[56:59], v20 offset:54272
  v_mfma_f32_16x16x32_bf16 v[80:83], v[40:43], v[176:179], v[80:83]
  ds_read_b128 v[60:63], v20 offset:55296
  v_mfma_f32_16x16x32_bf16 v[84:87], v[44:47], v[176:179], v[84:87]
  ds_read_b128 v[64:67], v20 offset:56320
  s_waitcnt lgkmcnt(0)
  v_mfma_f32_16x16x32_bf16 v[68:71], v[48:51], v[180:183], v[68:71]
  v_mfma_f32_16x16x32_bf16 v[72:75], v[52:55], v[180:183], v[72:75]
  v_mfma_f32_16x16x32_bf16 v[76:79], v[56:59], v[180:183], v[76:79]
  v_mfma_f32_16x16x32_bf16 v[80:83], v[60:63], v[180:183], v[80:83]
  v_mfma_f32_16x16x32_bf16 v[84:87], v[64:67], v[180:183], v[84:87]
  s_waitcnt vmcnt(0)
  v_mul_u32_u24 v12, 160, v3
  v_lshlrev_b32 v13, 3, v2
  v_add_u32 v12, v12, v13
  s_add_u32 s23, s44, 122880
  v_add_u32 v12, s23, v12
  v_lshlrev_b32 v13, 7, v2
  v_lshlrev_b32 v14, 3, v3
  v_add_u32 v13, v13, v14
  s_add_u32 s23, s44, 133120
  v_add_u32 v13, s23, v13
  ds_read_b64 v[184:185], v12 offset:0
  ds_read_b64_tr_b16 v[194:195], v13 offset:0
  ds_read_b64 v[186:187], v12 offset:32
  ds_read_b64_tr_b16 v[196:197], v13 offset:512
  ds_read_b64 v[188:189], v12 offset:64
  ds_read_b64_tr_b16 v[198:199], v13 offset:1024
  ds_read_b64 v[190:191], v12 offset:96
  ds_read_b64_tr_b16 v[200:201], v13 offset:1536
  ds_read_b64 v[192:193], v12 offset:128
  ds_read_b64_tr_b16 v[202:203], v13 offset:2048
  v_sub_f32 v14, 0, v24
  v_mov_b32 v16, v25
  s_mov_b32 s30, 1.0
  s_mov_b32 s31, 1.0
  s_mov_b32 s32, 0xbfb8aa3b
  v_mov_b32 v18, s32
  v_mov_b32 v19, s32
  s_waitcnt lgkmcnt(0)
  v_lshlrev_b32 v204, 16, v184
  v_and_b32 v205, s26, v184
  v_lshlrev_b32 v206, 16, v194
  v_and_b32 v207, s26, v194
  v_pk_mul_f32 v[208:209], v[68:69], v[18:19]
  v_exp_f32 v208, v208
  v_exp_f32 v209, v209
  v_pk_add_f32 v[210:211], v[204:205], v[14:15] op_sel_hi:[1,0]
  v_pk_add_f32 v[208:209], v[208:209], s[30:31]
  v_pk_mul_f32 v[210:211], v[210:211], v[16:17] op_sel_hi:[1,0]
  v_rcp_f32 v208, v208
  v_rcp_f32 v209, v209
  v_pk_mul_f32 v[210:211], v[210:211], v[206:207]
  v_pk_mul_f32 v[208:209], v[208:209], v[68:69]
  v_pk_fma_f32 v[210:211], v[210:211], v[208:209], v[204:205]
  v_cvt_pk_bf16_f32 v184, v210, v211
  v_lshlrev_b32 v212, 16, v185
  v_and_b32 v213, s26, v185
  v_lshlrev_b32 v214, 16, v195
  v_and_b32 v215, s26, v195
  v_pk_mul_f32 v[216:217], v[70:71], v[18:19]
  v_exp_f32 v216, v216
  v_exp_f32 v217, v217
  v_pk_add_f32 v[218:219], v[212:213], v[14:15] op_sel_hi:[1,0]
  v_pk_add_f32 v[216:217], v[216:217], s[30:31]
  v_pk_mul_f32 v[218:219], v[218:219], v[16:17] op_sel_hi:[1,0]
  v_rcp_f32 v216, v216
  v_rcp_f32 v217, v217
  v_pk_mul_f32 v[218:219], v[218:219], v[214:215]
  v_pk_mul_f32 v[216:217], v[216:217], v[70:71]
  v_pk_fma_f32 v[218:219], v[218:219], v[216:217], v[212:213]
  v_cvt_pk_bf16_f32 v185, v218, v219
  ds_write_b64 v12, v[184:185] offset:0
  v_lshlrev_b32 v204, 16, v186
  v_and_b32 v205, s26, v186
  v_lshlrev_b32 v206, 16, v196
  v_and_b32 v207, s26, v196
  v_pk_mul_f32 v[208:209], v[72:73], v[18:19]
  v_exp_f32 v208, v208
  v_exp_f32 v209, v209
  v_pk_add_f32 v[210:211], v[204:205], v[14:15] op_sel_hi:[1,0]
  v_pk_add_f32 v[208:209], v[208:209], s[30:31]
  v_pk_mul_f32 v[210:211], v[210:211], v[16:17] op_sel_hi:[1,0]
  v_rcp_f32 v208, v208
  v_rcp_f32 v209, v209
  v_pk_mul_f32 v[210:211], v[210:211], v[206:207]
  v_pk_mul_f32 v[208:209], v[208:209], v[72:73]
  v_pk_fma_f32 v[210:211], v[210:211], v[208:209], v[204:205]
  v_cvt_pk_bf16_f32 v186, v210, v211
  v_lshlrev_b32 v212, 16, v187
  v_and_b32 v213, s26, v187
  v_lshlrev_b32 v214, 16, v197
  v_and_b32 v215, s26, v197
  v_pk_mul_f32 v[216:217], v[74:75], v[18:19]
  v_exp_f32 v216, v216
  v_exp_f32 v217, v217
  v_pk_add_f32 v[218:219], v[212:213], v[14:15] op_sel_hi:[1,0]
  v_pk_add_f32 v[216:217], v[216:217], s[30:31]
  v_pk_mul_f32 v[218:219], v[218:219], v[16:17] op_sel_hi:[1,0]
  v_rcp_f32 v216, v216
  v_rcp_f32 v217, v217
  v_pk_mul_f32 v[218:219], v[218:219], v[214:215]
  v_pk_mul_f32 v[216:217], v[216:217], v[74:75]
  v_pk_fma_f32 v[218:219], v[218:219], v[216:217], v[212:213]
  v_cvt_pk_bf16_f32 v187, v218, v219
  ds_write_b64 v12, v[186:187] offset:32
  v_lshlrev_b32 v204, 16, v188
  v_and_b32 v205, s26, v188
  v_lshlrev_b32 v206, 16, v198
  v_and_b32 v207, s26, v198
  v_pk_mul_f32 v[208:209], v[76:77], v[18:19]
  v_exp_f32 v208, v208
  v_exp_f32 v209, v209
  v_pk_add_f32 v[210:211], v[204:205], v[14:15] op_sel_hi:[1,0]
  v_pk_add_f32 v[208:209], v[208:209], s[30:31]
  v_pk_mul_f32 v[210:211], v[210:211], v[16:17] op_sel_hi:[1,0]
  v_rcp_f32 v208, v208
  v_rcp_f32 v209, v209
  v_pk_mul_f32 v[210:211], v[210:211], v[206:207]
  v_pk_mul_f32 v[208:209], v[208:209], v[76:77]
  v_pk_fma_f32 v[210:211], v[210:211], v[208:209], v[204:205]
  v_cvt_pk_bf16_f32 v188, v210, v211
  v_lshlrev_b32 v212, 16, v189
  v_and_b32 v213, s26, v189
  v_lshlrev_b32 v214, 16, v199
  v_and_b32 v215, s26, v199
  v_pk_mul_f32 v[216:217], v[78:79], v[18:19]
  v_exp_f32 v216, v216
  v_exp_f32 v217, v217
  v_pk_add_f32 v[218:219], v[212:213], v[14:15] op_sel_hi:[1,0]
  v_pk_add_f32 v[216:217], v[216:217], s[30:31]
  v_pk_mul_f32 v[218:219], v[218:219], v[16:17] op_sel_hi:[1,0]
  v_rcp_f32 v216, v216
  v_rcp_f32 v217, v217
  v_pk_mul_f32 v[218:219], v[218:219], v[214:215]
  v_pk_mul_f32 v[216:217], v[216:217], v[78:79]
  v_pk_fma_f32 v[218:219], v[218:219], v[216:217], v[212:213]
  v_cvt_pk_bf16_f32 v189, v218, v219
  ds_write_b64 v12, v[188:189] offset:64
  v_lshlrev_b32 v204, 16, v190
  v_and_b32 v205, s26, v190
  v_lshlrev_b32 v206, 16, v200
  v_and_b32 v207, s26, v200
  v_pk_mul_f32 v[208:209], v[80:81], v[18:19]
  v_exp_f32 v208, v208
  v_exp_f32 v209, v209
  v_pk_add_f32 v[210:211], v[204:205], v[14:15] op_sel_hi:[1,0]
  v_pk_add_f32 v[208:209], v[208:209], s[30:31]
  v_pk_mul_f32 v[210:211], v[210:211], v[16:17] op_sel_hi:[1,0]
  v_rcp_f32 v208, v208
  v_rcp_f32 v209, v209
  v_pk_mul_f32 v[210:211], v[210:211], v[206:207]
  v_pk_mul_f32 v[208:209], v[208:209], v[80:81]
  v_pk_fma_f32 v[210:211], v[210:211], v[208:209], v[204:205]
  v_cvt_pk_bf16_f32 v190, v210, v211
  v_lshlrev_b32 v212, 16, v191
  v_and_b32 v213, s26, v191
  v_lshlrev_b32 v214, 16, v201
  v_and_b32 v215, s26, v201
  v_pk_mul_f32 v[216:217], v[82:83], v[18:19]
  v_exp_f32 v216, v216
  v_exp_f32 v217, v217
  v_pk_add_f32 v[218:219], v[212:213], v[14:15] op_sel_hi:[1,0]
  v_pk_add_f32 v[216:217], v[216:217], s[30:31]
  v_pk_mul_f32 v[218:219], v[218:219], v[16:17] op_sel_hi:[1,0]
  v_rcp_f32 v216, v216
  v_rcp_f32 v217, v217
  v_pk_mul_f32 v[218:219], v[218:219], v[214:215]
  v_pk_mul_f32 v[216:217], v[216:217], v[82:83]
  v_pk_fma_f32 v[218:219], v[218:219], v[216:217], v[212:213]
  v_cvt_pk_bf16_f32 v191, v218, v219
  ds_write_b64 v12, v[190:191] offset:96
  v_lshlrev_b32 v204, 16, v192
  v_and_b32 v205, s26, v192
  v_lshlrev_b32 v206, 16, v202
  v_and_b32 v207, s26, v202
  v_pk_mul_f32 v[208:209], v[84:85], v[18:19]
  v_exp_f32 v208, v208
  v_exp_f32 v209, v209
  v_pk_add_f32 v[210:211], v[204:205], v[14:15] op_sel_hi:[1,0]
  v_pk_add_f32 v[208:209], v[208:209], s[30:31]
  v_pk_mul_f32 v[210:211], v[210:211], v[16:17] op_sel_hi:[1,0]
  v_rcp_f32 v208, v208
  v_rcp_f32 v209, v209
  v_pk_mul_f32 v[210:211], v[210:211], v[206:207]
  v_pk_mul_f32 v[208:209], v[208:209], v[84:85]
  v_pk_fma_f32 v[210:211], v[210:211], v[208:209], v[204:205]
  v_cvt_pk_bf16_f32 v192, v210, v211
  v_lshlrev_b32 v212, 16, v193
  v_and_b32 v213, s26, v193
  v_lshlrev_b32 v214, 16, v203
  v_and_b32 v215, s26, v203
  v_pk_mul_f32 v[216:217], v[86:87], v[18:19]
  v_exp_f32 v216, v216
  v_exp_f32 v217, v217
  v_pk_add_f32 v[218:219], v[212:213], v[14:15] op_sel_hi:[1,0]
  v_pk_add_f32 v[216:217], v[216:217], s[30:31]
  v_pk_mul_f32 v[218:219], v[218:219], v[16:17] op_sel_hi:[1,0]
  v_rcp_f32 v216, v216
  v_rcp_f32 v217, v217
  v_pk_mul_f32 v[218:219], v[218:219], v[214:215]
  v_pk_mul_f32 v[216:217], v[216:217], v[86:87]
  v_pk_fma_f32 v[218:219], v[218:219], v[216:217], v[212:213]
  v_cvt_pk_bf16_f32 v193, v218, v219
  ds_write_b64 v12, v[192:193] offset:128
  s_waitcnt lgkmcnt(0)
  s_add_u32 s23, s44, 122880
  v_add_u32 v13, s23, v4
  ds_read_b128 v[220:223], v13 offset:0
  ds_read_b128 v[224:227], v13 offset:1024
  ds_read_b128 v[228:231], v13 offset:2048
  s_waitcnt lgkmcnt(0)
  buffer_store_dwordx4 v[220:223], v5, s[16:19], 0 offen
  buffer_store_dwordx4 v[224:227], v6, s[16:19], 0 offen
  s_mov_b32 exec_lo, 0xffffffff
  s_mov_b32 exec_hi, 0x0
  buffer_store_dwordx4 v[228:231], v7, s[16:19], 0 offen
  s_mov_b64 exec, s[28:29]
K3_END:
  s_endpgm

.section .rodata,"a"
.p2align 6
.amdhsa_kernel k3_kernel
  .amdhsa_next_free_vgpr 256
  .amdhsa_next_free_sgpr 96
  .amdhsa_accum_offset 256
  .amdhsa_group_segment_fixed_size 0
  .amdhsa_kernarg_size 112
  .amdhsa_user_sgpr_count 2
  .amdhsa_user_sgpr_kernarg_segment_ptr 1
  .amdhsa_system_sgpr_workgroup_id_x 1
  .amdhsa_float_denorm_mode_32 3
.end_amdhsa_kernel
.text
```

```asm
; @launch grid=(256,1,1) block=(768,1,1) lds=159744
.amdgcn_target "amdgcn-amd-amdhsa--gfx950"
.text
.globl recurrent_scan__ssm_conv_h3__mixer_gmlp__prompt_kernel
.p2align 8
.type recurrent_scan__ssm_conv_h3__mixer_gmlp__prompt_kernel,@function
recurrent_scan__ssm_conv_h3__mixer_gmlp__prompt_kernel:
  s_cmp_ge_u32 s2, 256
  s_cbranch_scc1 K1_END
  s_load_dwordx4 s[56:59], s[0:1], 0
  s_load_dwordx4 s[60:63], s[0:1], 16
  s_load_dwordx2 s[64:65], s[0:1], 56
  s_load_dwordx2 s[66:67], s[0:1], 80
  s_load_dwordx4 s[68:71], s[0:1], 96
  s_load_dwordx2 s[74:75], s[0:1], 64
  s_load_dwordx2 s[76:77], s[0:1], 32
  v_and_b32 v1, 63, v0
  v_lshrrev_b32 v14, 6, v0
  v_lshrrev_b32 v2, 4, v1
  v_readfirstlane_b32 s34, v14
  v_and_b32 v3, 15, v1
  s_and_b32 s40, s2, 7
  s_lshr_b32 s41, s2, 3
  s_lshr_b32 s32, s40, 1
  s_lshl_b32 s32, s32, 3
  s_lshr_b32 s42, s41, 2
  s_add_u32 s32, s32, s42
  s_and_b32 s33, s40, 1
  s_lshl_b32 s33, s33, 2
  s_and_b32 s42, s41, 3
  s_add_u32 s33, s33, s42
  s_and_b32 s55, s34, 3
  s_lshr_b32 s35, s55, 1
  s_and_b32 s36, s55, 1
  s_mov_b32 s47, 0xffff0000
  s_mov_b64 s[52:53], exec
  s_mul_i32 s44, s33, 192
  s_add_u32 s43, s44, 1536
  s_cmp_ge_u32 s34, 8
  s_cbranch_scc0 K1_AB
  s_lshl_b32 s40, s32, 6
  s_lshl_b32 s41, s55, 3
  s_add_u32 s40, s40, s41
  s_lshl_b32 s45, s55, 10
  v_lshrrev_b32 v30, 3, v1
  v_add_u32 v32, s41, v30
  v_lshrrev_b32 v31, 1, v32
  v_xor_b32 v31, v31, v1
  v_and_b32 v31, 7, v31
  v_lshlrev_b32 v31, 4, v31
  v_add_u32 v30, s40, v30
  v_mul_u32_u24 v30, 1280, v30
  v_add_u32 v8, v30, v31
  v_add_u32 v9, 40960, v8
  s_waitcnt lgkmcnt(0)
  s_mov_b32 s8, s56
  s_and_b32 s9, s57, 0xffff
  s_mov_b32 s10, 2621440
  s_mov_b32 s11, 0x20000
  s_mov_b32 s12, s64
  s_and_b32 s13, s65, 0xffff
  s_mov_b32 s14, 1966080
  s_mov_b32 s15, 0x20000
  s_and_b32 s40, s32, 7
  s_and_b32 s41, s33, 3
  s_mul_i32 s41, s41, 3
  s_add_u32 s37, s40, s41
  s_sub_u32 s40, s37, 10
  s_cmp_ge_u32 s37, 10
  s_cselect_b32 s37, s40, s37
  s_lshl_b32 s40, s55, 6
  s_add_u32 s40, s40, 0
  v_add_u32 v30, s40, v1
  v_mul_u32_u24 v31, 5462, v30
  v_lshrrev_b32 v31, 16, v31
  v_mul_u32_u24 v32, 12, v31
  v_sub_u32 v32, v30, v32
  v_lshrrev_b32 v33, 2, v31
  v_and_b32 v33, 2, v33
  v_xor_b32 v32, v32, v33
  v_lshlrev_b32 v32, 4, v32
  v_mul_u32_u24 v31, 3072, v31
  v_add_u32 v12, v31, v32
  s_lshl_b32 s40, s55, 6
  s_add_u32 s40, s40, 256
  v_add_u32 v30, s40, v1
  v_mul_u32_u24 v31, 5462, v30
  v_lshrrev_b32 v31, 16, v31
  v_mul_u32_u24 v32, 12, v31
  v_sub_u32 v32, v30, v32
  v_lshrrev_b32 v33, 2, v31
  v_and_b32 v33, 2, v33
  v_xor_b32 v32, v32, v33
  v_lshlrev_b32 v32, 4, v32
  v_mul_u32_u24 v31, 3072, v31
  v_add_u32 v13, v31, v32
  s_lshl_b32 s40, s55, 6
  s_add_u32 s40, s40, 512
  v_add_u32 v30, s40, v1
  v_mul_u32_u24 v31, 5462, v30
  v_lshrrev_b32 v31, 16, v31
  v_mul_u32_u24 v32, 12, v31
  v_sub_u32 v32, v30, v32
  v_lshrrev_b32 v33, 2, v31
  v_and_b32 v33, 2, v33
  v_xor_b32 v32, v32, v33
  v_lshlrev_b32 v32, 4, v32
  v_mul_u32_u24 v31, 3072, v31
  v_add_u32 v14, v31, v32
  s_add_u32 s38, s37, 0
  s_sub_u32 s40, s38, 10
  s_cmp_ge_u32 s38, 10
  s_cselect_b32 s38, s40, s38
  s_lshl_b32 s38, s38, 7
  s_add_u32 m0, s45, 61440
  s_nop 0
  buffer_load_dwordx4 v8, s[8:11], s38 offen lds
  s_add_u32 m0, s45, 65536
  s_nop 0
  buffer_load_dwordx4 v9, s[8:11], s38 offen lds
  s_add_u32 s39, s37, 0
  s_sub_u32 s40, s39, 10
  s_cmp_ge_u32 s39, 10
  s_cselect_b32 s39, s40, s39
  s_mul_i32 s39, s39, 196608
  s_add_u32 s39, s39, s43
  s_add_u32 m0, s45, 0
  s_nop 0
  buffer_load_dwordx4 v12, s[12:15], s39 offen lds
  s_add_u32 m0, s45, 4096
  s_nop 0
  buffer_load_dwordx4 v13, s[12:15], s39 offen lds
  s_add_u32 m0, s45, 8192
  s_nop 0
  buffer_load_dwordx4 v14, s[12:15], s39 offen lds
  s_waitcnt vmcnt(0)
  s_barrier
  s_add_u32 s38, s37, 1
  s_sub_u32 s40, s38, 10
  s_cmp_ge_u32 s38, 10
  s_cselect_b32 s38, s40, s38
  s_lshl_b32 s38, s38, 7
  s_add_u32 m0, s45, 69632
  s_nop 0
  buffer_load_dwordx4 v8, s[8:11], s38 offen lds
  s_add_u32 m0, s45, 73728
  s_nop 0
  buffer_load_dwordx4 v9, s[8:11], s38 offen lds
  s_add_u32 s39, s37, 1
  s_sub_u32 s40, s39, 10
  s_cmp_ge_u32 s39, 10
  s_cselect_b32 s39, s40, s39
  s_mul_i32 s39, s39, 196608
  s_add_u32 s39, s39, s43
  s_add_u32 m0, s45, 12288
  s_nop 0
  buffer_load_dwordx4 v12, s[12:15], s39 offen lds
  s_add_u32 m0, s45, 16384
  s_nop 0
  buffer_load_dwordx4 v13, s[12:15], s39 offen lds
  s_add_u32 m0, s45, 20480
  s_nop 0
  buffer_load_dwordx4 v14, s[12:15], s39 offen lds
  s_add_u32 s38, s37, 2
  s_sub_u32 s40, s38, 10
  s_cmp_ge_u32 s38, 10
  s_cselect_b32 s38, s40, s38
  s_lshl_b32 s38, s38, 7
  s_add_u32 m0, s45, 77824
  s_nop 0
  buffer_load_dwordx4 v8, s[8:11], s38 offen lds
  s_add_u32 m0, s45, 81920
  s_nop 0
  buffer_load_dwordx4 v9, s[8:11], s38 offen lds
  s_add_u32 s39, s37, 2
  s_sub_u32 s40, s39, 10
  s_cmp_ge_u32 s39, 10
  s_cselect_b32 s39, s40, s39
  s_mul_i32 s39, s39, 196608
  s_add_u32 s39, s39, s43
  s_add_u32 m0, s45, 24576
  s_nop 0
  buffer_load_dwordx4 v12, s[12:15], s39 offen lds
  s_add_u32 m0, s45, 28672
  s_nop 0
  buffer_load_dwordx4 v13, s[12:15], s39 offen lds
  s_add_u32 m0, s45, 32768
  s_nop 0
  buffer_load_dwordx4 v14, s[12:15], s39 offen lds
  s_waitcnt vmcnt(5)
  s_barrier
  s_add_u32 s38, s37, 3
  s_sub_u32 s40, s38, 10
  s_cmp_ge_u32 s38, 10
  s_cselect_b32 s38, s40, s38
  s_lshl_b32 s38, s38, 7
  s_add_u32 m0, s45, 86016
  s_nop 0
  buffer_load_dwordx4 v8, s[8:11], s38 offen lds
  s_add_u32 m0, s45, 90112
  s_nop 0
  buffer_load_dwordx4 v9, s[8:11], s38 offen lds
  s_add_u32 s39, s37, 3
  s_sub_u32 s40, s39, 10
  s_cmp_ge_u32 s39, 10
  s_cselect_b32 s39, s40, s39
  s_mul_i32 s39, s39, 196608
  s_add_u32 s39, s39, s43
  s_add_u32 m0, s45, 36864
  s_nop 0
  buffer_load_dwordx4 v12, s[12:15], s39 offen lds
  s_add_u32 m0, s45, 40960
  s_nop 0
  buffer_load_dwordx4 v13, s[12:15], s39 offen lds
  s_add_u32 m0, s45, 45056
  s_nop 0
  buffer_load_dwordx4 v14, s[12:15], s39 offen lds
  s_add_u32 s38, s37, 4
  s_sub_u32 s40, s38, 10
  s_cmp_ge_u32 s38, 10
  s_cselect_b32 s38, s40, s38
  s_lshl_b32 s38, s38, 7
  s_add_u32 m0, s45, 94208
  s_nop 0
  buffer_load_dwordx4 v8, s[8:11], s38 offen lds
  s_add_u32 m0, s45, 98304
  s_nop 0
  buffer_load_dwordx4 v9, s[8:11], s38 offen lds
  s_add_u32 s39, s37, 4
  s_sub_u32 s40, s39, 10
  s_cmp_ge_u32 s39, 10
  s_cselect_b32 s39, s40, s39
  s_mul_i32 s39, s39, 196608
  s_add_u32 s39, s39, s43
  s_add_u32 m0, s45, 49152
  s_nop 0
  buffer_load_dwordx4 v12, s[12:15], s39 offen lds
  s_add_u32 m0, s45, 53248
  s_nop 0
  buffer_load_dwordx4 v13, s[12:15], s39 offen lds
  s_add_u32 m0, s45, 57344
  s_nop 0
  buffer_load_dwordx4 v14, s[12:15], s39 offen lds
  s_waitcnt vmcnt(10)
  s_barrier
  s_add_u32 s38, s37, 5
  s_sub_u32 s40, s38, 10
  s_cmp_ge_u32 s38, 10
  s_cselect_b32 s38, s40, s38
  s_lshl_b32 s38, s38, 7
  s_add_u32 m0, s45, 102400
  s_nop 0
  buffer_load_dwordx4 v8, s[8:11], s38 offen lds
  s_add_u32 m0, s45, 106496
  s_nop 0
  buffer_load_dwordx4 v9, s[8:11], s38 offen lds
  s_add_u32 s39, s37, 5
  s_sub_u32 s40, s39, 10
  s_cmp_ge_u32 s39, 10
  s_cselect_b32 s39, s40, s39
  s_mul_i32 s39, s39, 196608
  s_add_u32 s39, s39, s43
  s_add_u32 m0, s45, 0
  s_nop 0
  buffer_load_dwordx4 v12, s[12:15], s39 offen lds
  s_add_u32 m0, s45, 4096
  s_nop 0
  buffer_load_dwordx4 v13, s[12:15], s39 offen lds
  s_add_u32 m0, s45, 8192
  s_nop 0
  buffer_load_dwordx4 v14, s[12:15], s39 offen lds
  s_add_u32 s38, s37, 6
  s_sub_u32 s40, s38, 10
  s_cmp_ge_u32 s38, 10
  s_cselect_b32 s38, s40, s38
  s_lshl_b32 s38, s38, 7
  s_add_u32 m0, s45, 110592
  s_nop 0
  buffer_load_dwordx4 v8, s[8:11], s38 offen lds
  s_add_u32 m0, s45, 114688
  s_nop 0
  buffer_load_dwordx4 v9, s[8:11], s38 offen lds
  s_waitcnt vmcnt(12)
  s_barrier
  s_add_u32 s38, s37, 7
  s_sub_u32 s40, s38, 10
  s_cmp_ge_u32 s38, 10
  s_cselect_b32 s38, s40, s38
  s_lshl_b32 s38, s38, 7
  s_add_u32 m0, s45, 118784
  s_nop 0
  buffer_load_dwordx4 v8, s[8:11], s38 offen lds
  s_add_u32 m0, s45, 122880
  s_nop 0
  buffer_load_dwordx4 v9, s[8:11], s38 offen lds
  s_add_u32 s39, s37, 6
  s_sub_u32 s40, s39, 10
  s_cmp_ge_u32 s39, 10
  s_cselect_b32 s39, s40, s39
  s_mul_i32 s39, s39, 196608
  s_add_u32 s39, s39, s43
  s_add_u32 m0, s45, 12288
  s_nop 0
  buffer_load_dwordx4 v12, s[12:15], s39 offen lds
  s_add_u32 m0, s45, 16384
  s_nop 0
  buffer_load_dwordx4 v13, s[12:15], s39 offen lds
  s_add_u32 m0, s45, 20480
  s_nop 0
  buffer_load_dwordx4 v14, s[12:15], s39 offen lds
  s_add_u32 s38, s37, 8
  s_sub_u32 s40, s38, 10
  s_cmp_ge_u32 s38, 10
  s_cselect_b32 s38, s40, s38
  s_lshl_b32 s38, s38, 7
  s_add_u32 m0, s45, 126976
  s_nop 0
  buffer_load_dwordx4 v8, s[8:11], s38 offen lds
  s_add_u32 m0, s45, 131072
  s_nop 0
  buffer_load_dwordx4 v9, s[8:11], s38 offen lds
  s_waitcnt vmcnt(14)
  s_barrier
  s_add_u32 s38, s37, 9
  s_sub_u32 s40, s38, 10
  s_cmp_ge_u32 s38, 10
  s_cselect_b32 s38, s40, s38
  s_lshl_b32 s38, s38, 7
  s_add_u32 m0, s45, 135168
  s_nop 0
  buffer_load_dwordx4 v8, s[8:11], s38 offen lds
  s_add_u32 m0, s45, 139264
  s_nop 0
  buffer_load_dwordx4 v9, s[8:11], s38 offen lds
  s_add_u32 s39, s37, 7
  s_sub_u32 s40, s39, 10
  s_cmp_ge_u32 s39, 10
  s_cselect_b32 s39, s40, s39
  s_mul_i32 s39, s39, 196608
  s_add_u32 s39, s39, s43
  s_add_u32 m0, s45, 24576
  s_nop 0
  buffer_load_dwordx4 v12, s[12:15], s39 offen lds
  s_add_u32 m0, s45, 28672
  s_nop 0
  buffer_load_dwordx4 v13, s[12:15], s39 offen lds
  s_add_u32 m0, s45, 32768
  s_nop 0
  buffer_load_dwordx4 v14, s[12:15], s39 offen lds
  s_waitcnt vmcnt(14)
  s_barrier
  s_add_u32 s39, s37, 8
  s_sub_u32 s40, s39, 10
  s_cmp_ge_u32 s39, 10
  s_cselect_b32 s39, s40, s39
  s_mul_i32 s39, s39, 196608
  s_add_u32 s39, s39, s43
  s_add_u32 m0, s45, 36864
  s_nop 0
  buffer_load_dwordx4 v12, s[12:15], s39 offen lds
  s_add_u32 m0, s45, 40960
  s_nop 0
  buffer_load_dwordx4 v13, s[12:15], s39 offen lds
  s_add_u32 m0, s45, 45056
  s_nop 0
  buffer_load_dwordx4 v14, s[12:15], s39 offen lds
  s_add_u32 s39, s37, 9
  s_sub_u32 s40, s39, 10
  s_cmp_ge_u32 s39, 10
  s_cselect_b32 s39, s40, s39
  s_mul_i32 s39, s39, 196608
  s_add_u32 s39, s39, s43
  s_add_u32 m0, s45, 49152
  s_nop 0
  buffer_load_dwordx4 v12, s[12:15], s39 offen lds
  s_add_u32 m0, s45, 53248
  s_nop 0
  buffer_load_dwordx4 v13, s[12:15], s39 offen lds
  s_add_u32 m0, s45, 57344
  s_nop 0
  buffer_load_dwordx4 v14, s[12:15], s39 offen lds
  s_waitcnt vmcnt(13)
  s_barrier
  s_add_u32 s39, s37, 0
  s_sub_u32 s40, s39, 10
  s_cmp_ge_u32 s39, 10
  s_cselect_b32 s39, s40, s39
  s_mul_i32 s39, s39, 196608
  s_add_u32 s39, s39, s44
  s_add_u32 m0, s45, 0
  s_nop 0
  buffer_load_dwordx4 v12, s[12:15], s39 offen lds
  s_add_u32 m0, s45, 4096
  s_nop 0
  buffer_load_dwordx4 v13, s[12:15], s39 offen lds
  s_add_u32 m0, s45, 8192
  s_nop 0
  buffer_load_dwordx4 v14, s[12:15], s39 offen lds
  s_waitcnt vmcnt(9)
  s_barrier
  s_add_u32 s39, s37, 1
  s_sub_u32 s40, s39, 10
  s_cmp_ge_u32 s39, 10
  s_cselect_b32 s39, s40, s39
  s_mul_i32 s39, s39, 196608
  s_add_u32 s39, s39, s44
  s_add_u32 m0, s45, 12288
  s_nop 0
  buffer_load_dwordx4 v12, s[12:15], s39 offen lds
  s_add_u32 m0, s45, 16384
  s_nop 0
  buffer_load_dwordx4 v13, s[12:15], s39 offen lds
  s_add_u32 m0, s45, 20480
  s_nop 0
  buffer_load_dwordx4 v14, s[12:15], s39 offen lds
  s_waitcnt vmcnt(9)
  s_barrier
  s_add_u32 s39, s37, 2
  s_sub_u32 s40, s39, 10
  s_cmp_ge_u32 s39, 10
  s_cselect_b32 s39, s40, s39
  s_mul_i32 s39, s39, 196608
  s_add_u32 s39, s39, s44
  s_add_u32 m0, s45, 24576
  s_nop 0
  buffer_load_dwordx4 v12, s[12:15], s39 offen lds
  s_add_u32 m0, s45, 28672
  s_nop 0
  buffer_load_dwordx4 v13, s[12:15], s39 offen lds
  s_add_u32 m0, s45, 32768
  s_nop 0
  buffer_load_dwordx4 v14, s[12:15], s39 offen lds
  s_waitcnt vmcnt(9)
  s_barrier
  s_add_u32 s39, s37, 3
  s_sub_u32 s40, s39, 10
  s_cmp_ge_u32 s39, 10
  s_cselect_b32 s39, s40, s39
  s_mul_i32 s39, s39, 196608
  s_add_u32 s39, s39, s44
  s_add_u32 m0, s45, 36864
  s_nop 0
  buffer_load_dwordx4 v12, s[12:15], s39 offen lds
  s_add_u32 m0, s45, 40960
  s_nop 0
  buffer_load_dwordx4 v13, s[12:15], s39 offen lds
  s_add_u32 m0, s45, 45056
  s_nop 0
  buffer_load_dwordx4 v14, s[12:15], s39 offen lds
  s_waitcnt vmcnt(9)
  s_barrier
  s_add_u32 s39, s37, 4
  s_sub_u32 s40, s39, 10
  s_cmp_ge_u32 s39, 10
  s_cselect_b32 s39, s40, s39
  s_mul_i32 s39, s39, 196608
  s_add_u32 s39, s39, s44
  s_add_u32 m0, s45, 49152
  s_nop 0
  buffer_load_dwordx4 v12, s[12:15], s39 offen lds
  s_add_u32 m0, s45, 53248
  s_nop 0
  buffer_load_dwordx4 v13, s[12:15], s39 offen lds
  s_add_u32 m0, s45, 57344
  s_nop 0
  buffer_load_dwordx4 v14, s[12:15], s39 offen lds
  s_waitcnt vmcnt(9)
  s_barrier
  s_add_u32 s39, s37, 5
  s_sub_u32 s40, s39, 10
  s_cmp_ge_u32 s39, 10
  s_cselect_b32 s39, s40, s39
  s_mul_i32 s39, s39, 196608
  s_add_u32 s39, s39, s44
  s_add_u32 m0, s45, 0
  s_nop 0
  buffer_load_dwordx4 v12, s[12:15], s39 offen lds
  s_add_u32 m0, s45, 4096
  s_nop 0
  buffer_load_dwordx4 v13, s[12:15], s39 offen lds
  s_add_u32 m0, s45, 8192
  s_nop 0
  buffer_load_dwordx4 v14, s[12:15], s39 offen lds
  s_waitcnt vmcnt(9)
  s_barrier
  s_add_u32 s39, s37, 6
  s_sub_u32 s40, s39, 10
  s_cmp_ge_u32 s39, 10
  s_cselect_b32 s39, s40, s39
  s_mul_i32 s39, s39, 196608
  s_add_u32 s39, s39, s44
  s_add_u32 m0, s45, 12288
  s_nop 0
  buffer_load_dwordx4 v12, s[12:15], s39 offen lds
  s_add_u32 m0, s45, 16384
  s_nop 0
  buffer_load_dwordx4 v13, s[12:15], s39 offen lds
  s_add_u32 m0, s45, 20480
  s_nop 0
  buffer_load_dwordx4 v14, s[12:15], s39 offen lds
  s_waitcnt vmcnt(9)
  s_barrier
  v_mul_u32_u24 v5, 6554, v1
  v_lshrrev_b32 v5, 16, v5
  v_mul_u32_u24 v4, 10, v5
  v_sub_u32 v4, v1, v4
  v_lshlrev_b32 v4, 4, v4
  v_mul_u32_u24 v30, 1280, v5
  v_add_u32 v4, v4, v30
  s_mov_b32 s20, s58
  s_and_b32 s21, s59, 0xffff
  s_mov_b32 s22, 2621440
  s_mov_b32 s23, 0x20000
  s_mov_b32 s24, s60
  s_and_b32 s25, s61, 0xffff
  s_mov_b32 s26, 2621440
  s_mov_b32 s27, 0x20000
  s_mov_b32 exec_lo, 0xffffffff
  s_mov_b32 exec_hi, 0xfffffff
  s_lshl_b32 s40, s32, 6
  s_mul_i32 s41, s55, 6
  s_add_u32 s40, s40, s41
  s_mul_i32 s46, s40, 1280
  s_mul_i32 s41, s33, 160
  s_add_u32 s46, s46, s41
  s_mul_i32 s78, s55, 960
  s_add_u32 s78, s78, 61440
  v_mov_b32 v30, v4
  s_sub_u32 s79, s46, 3840
  s_cmp_eq_u32 s40, 0
  s_cbranch_scc0 K1_NONNEG
  v_subrev_u32 v30, 3840, v4
  v_cmp_gt_u32 vcc, 3, v5
  v_mov_b32 v31, 0x80000000
  s_nop 0
  v_cndmask_b32 v30, v30, v31, vcc
  s_mov_b32 s79, s46
K1_NONNEG:
  s_add_u32 m0, s78, 0
  s_nop 0
  buffer_load_dwordx4 v30, s[20:23], s79 offen lds
  s_add_u32 m0, s78, 11520
  s_nop 0
  buffer_load_dwordx4 v4, s[24:27], s46 offen lds
  s_add_u32 s46, s46, 30720
  s_sub_u32 s79, s46, 3840
  s_add_u32 m0, s78, 3840
  s_nop 0
  buffer_load_dwordx4 v4, s[20:23], s79 offen lds
  s_add_u32 m0, s78, 15360
  s_nop 0
  buffer_load_dwordx4 v4, s[24:27], s46 offen lds
  s_add_u32 s46, s46, 30720
  s_sub_u32 s79, s46, 3840
  s_add_u32 m0, s78, 7680
  s_nop 0
  buffer_load_dwordx4 v4, s[20:23], s79 offen lds
  s_add_u32 m0, s78, 19200
  s_nop 0
  buffer_load_dwordx4 v4, s[24:27], s46 offen lds
  s_add_u32 s46, s46, 30720
  s_sub_u32 s79, s46, 3840
  s_mov_b64 exec, s[52:53]
  s_add_u32 s39, s37, 7
  s_sub_u32 s40, s39, 10
  s_cmp_ge_u32 s39, 10
  s_cselect_b32 s39, s40, s39
  s_mul_i32 s39, s39, 196608
  s_add_u32 s39, s39, s44
  s_add_u32 m0, s45, 24576
  s_nop 0
  buffer_load_dwordx4 v12, s[12:15], s39 offen lds
  s_add_u32 m0, s45, 28672
  s_nop 0
  buffer_load_dwordx4 v13, s[12:15], s39 offen lds
  s_add_u32 m0, s45, 32768
  s_nop 0
  buffer_load_dwordx4 v14, s[12:15], s39 offen lds
  s_waitcnt vmcnt(15)
  s_barrier
  s_add_u32 s39, s37, 8
  s_sub_u32 s40, s39, 10
  s_cmp_ge_u32 s39, 10
  s_cselect_b32 s39, s40, s39
  s_mul_i32 s39, s39, 196608
  s_add_u32 s39, s39, s44
  s_add_u32 m0, s45, 36864
  s_nop 0
  buffer_load_dwordx4 v12, s[12:15], s39 offen lds
  s_add_u32 m0, s45, 40960
  s_nop 0
  buffer_load_dwordx4 v13, s[12:15], s39 offen lds
  s_add_u32 m0, s45, 45056
  s_nop 0
  buffer_load_dwordx4 v14, s[12:15], s39 offen lds
  s_waitcnt vmcnt(15)
  s_barrier
  s_add_u32 s39, s37, 9
  s_sub_u32 s40, s39, 10
  s_cmp_ge_u32 s39, 10
  s_cselect_b32 s39, s40, s39
  s_mul_i32 s39, s39, 196608
  s_add_u32 s39, s39, s44
  s_add_u32 m0, s45, 49152
  s_nop 0
  buffer_load_dwordx4 v12, s[12:15], s39 offen lds
  s_add_u32 m0, s45, 53248
  s_nop 0
  buffer_load_dwordx4 v13, s[12:15], s39 offen lds
  s_add_u32 m0, s45, 57344
  s_nop 0
  buffer_load_dwordx4 v14, s[12:15], s39 offen lds
  s_waitcnt vmcnt(15)
  s_barrier
  s_waitcnt vmcnt(6)
  s_barrier
  s_waitcnt vmcnt(3)
  s_barrier
  s_waitcnt vmcnt(0)
  s_barrier
  s_barrier
  s_barrier
  s_load_dwordx2 s[56:57], s[0:1], 64
  s_load_dwordx2 s[60:61], s[0:1], 104
  s_lshl_b32 s40, s32, 6
  s_lshl_b32 s41, s55, 4
  s_add_u32 s40, s40, s41
  v_add_u32 v10, 0, v2
  v_xor_b32 v11, v10, v3
  v_lshlrev_b32 v11, 4, v11
  v_add_u32 v10, s40, v10
  v_lshlrev_b32 v10, 12, v10
  v_add_u32 v4, v10, v11
  v_add_u32 v10, 4, v2
  v_xor_b32 v11, v10, v3
  v_lshlrev_b32 v11, 4, v11
  v_add_u32 v10, s40, v10
  v_lshlrev_b32 v10, 12, v10
  v_add_u32 v5, v10, v11
  v_add_u32 v10, 8, v2
  v_xor_b32 v11, v10, v3
  v_lshlrev_b32 v11, 4, v11
  v_add_u32 v10, s40, v10
  v_lshlrev_b32 v10, 12, v10
  v_add_u32 v6, v10, v11
  v_add_u32 v10, 12, v2
  v_xor_b32 v11, v10, v3
  v_lshlrev_b32 v11, 4, v11
  v_add_u32 v10, s40, v10
  v_lshlrev_b32 v10, 12, v10
  v_add_u32 v7, v10, v11
  s_lshl_b32 s39, s55, 12
  s_waitcnt lgkmcnt(0)
  s_mov_b32 s8, s56
  s_and_b32 s9, s57, 0xffff
  s_mov_b32 s10, 8388608
  s_mov_b32 s11, 0x20000
  s_mov_b32 s16, s60
  s_and_b32 s17, s61, 0xffff
  s_mov_b32 s18, 18874368
  s_mov_b32 s19, 0x20000
  s_movk_i32 s38, 0
  s_add_u32 m0, s39, 0
  s_nop 0
  buffer_load_dwordx4 v4, s[8:11], s38 offen lds
  s_add_u32 m0, s39, 1024
  s_nop 0
  buffer_load_dwordx4 v5, s[8:11], s38 offen lds
  s_add_u32 m0, s39, 2048
  s_nop 0
  buffer_load_dwordx4 v6, s[8:11], s38 offen lds
  s_add_u32 m0, s39, 3072
  s_nop 0
  buffer_load_dwordx4 v7, s[8:11], s38 offen lds
  s_movk_i32 s38, 256
  s_add_u32 m0, s39, 16384
  s_nop 0
  buffer_load_dwordx4 v4, s[8:11], s38 offen lds
  s_add_u32 m0, s39, 17408
  s_nop 0
  buffer_load_dwordx4 v5, s[8:11], s38 offen lds
  s_add_u32 m0, s39, 18432
  s_nop 0
  buffer_load_dwordx4 v6, s[8:11], s38 offen lds
  s_add_u32 m0, s39, 19456
  s_nop 0
  buffer_load_dwordx4 v7, s[8:11], s38 offen lds
  s_movk_i32 s38, 512
  s_add_u32 m0, s39, 32768
  s_nop 0
  buffer_load_dwordx4 v4, s[8:11], s38 offen lds
  s_add_u32 m0, s39, 33792
  s_nop 0
  buffer_load_dwordx4 v5, s[8:11], s38 offen lds
  s_add_u32 m0, s39, 34816
  s_nop 0
  buffer_load_dwordx4 v6, s[8:11], s38 offen lds
  s_add_u32 m0, s39, 35840
  s_nop 0
  buffer_load_dwordx4 v7, s[8:11], s38 offen lds
  s_movk_i32 s38, 768
  s_add_u32 m0, s39, 49152
  s_nop 0
  buffer_load_dwordx4 v4, s[8:11], s38 offen lds
  s_add_u32 m0, s39, 50176
  s_nop 0
  buffer_load_dwordx4 v5, s[8:11], s38 offen lds
  s_add_u32 m0, s39, 51200
  s_nop 0
  buffer_load_dwordx4 v6, s[8:11], s38 offen lds
  s_add_u32 m0, s39, 52224
  s_nop 0
  buffer_load_dwordx4 v7, s[8:11], s38 offen lds
  s_barrier
  s_barrier
  s_waitcnt vmcnt(12)
  s_barrier
  s_waitcnt vmcnt(8)
  s_barrier
  s_movk_i32 s38, 1024
  s_add_u32 m0, s39, 0
  s_nop 0
  buffer_load_dwordx4 v4, s[8:11], s38 offen lds
  s_add_u32 m0, s39, 1024
  s_nop 0
  buffer_load_dwordx4 v5, s[8:11], s38 offen lds
  s_add_u32 m0, s39, 2048
  s_nop 0
  buffer_load_dwordx4 v6, s[8:11], s38 offen lds
  s_add_u32 m0, s39, 3072
  s_nop 0
  buffer_load_dwordx4 v7, s[8:11], s38 offen lds
  s_waitcnt vmcnt(8)
  s_barrier
  s_movk_i32 s38, 1280
  s_add_u32 m0, s39, 16384
  s_nop 0
  buffer_load_dwordx4 v4, s[8:11], s38 offen lds
  s_add_u32 m0, s39, 17408
  s_nop 0
  buffer_load_dwordx4 v5, s[8:11], s38 offen lds
  s_add_u32 m0, s39, 18432
  s_nop 0
  buffer_load_dwordx4 v6, s[8:11], s38 offen lds
  s_add_u32 m0, s39, 19456
  s_nop 0
  buffer_load_dwordx4 v7, s[8:11], s38 offen lds
  s_waitcnt vmcnt(8)
  s_barrier
  s_movk_i32 s38, 1536
  s_add_u32 m0, s39, 32768
  s_nop 0
  buffer_load_dwordx4 v4, s[8:11], s38 offen lds
  s_add_u32 m0, s39, 33792
  s_nop 0
  buffer_load_dwordx4 v5, s[8:11], s38 offen lds
  s_add_u32 m0, s39, 34816
  s_nop 0
  buffer_load_dwordx4 v6, s[8:11], s38 offen lds
  s_add_u32 m0, s39, 35840
  s_nop 0
  buffer_load_dwordx4 v7, s[8:11], s38 offen lds
  s_waitcnt vmcnt(8)
  s_barrier
  s_movk_i32 s38, 1792
  s_add_u32 m0, s39, 49152
  s_nop 0
  buffer_load_dwordx4 v4, s[8:11], s38 offen lds
  s_add_u32 m0, s39, 50176
  s_nop 0
  buffer_load_dwordx4 v5, s[8:11], s38 offen lds
  s_add_u32 m0, s39, 51200
  s_nop 0
  buffer_load_dwordx4 v6, s[8:11], s38 offen lds
  s_add_u32 m0, s39, 52224
  s_nop 0
  buffer_load_dwordx4 v7, s[8:11], s38 offen lds
  s_waitcnt vmcnt(8)
  s_barrier
  s_movk_i32 s38, 2048
  s_add_u32 m0, s39, 0
  s_nop 0
  buffer_load_dwordx4 v4, s[8:11], s38 offen lds
  s_add_u32 m0, s39, 1024
  s_nop 0
  buffer_load_dwordx4 v5, s[8:11], s38 offen lds
  s_add_u32 m0, s39, 2048
  s_nop 0
  buffer_load_dwordx4 v6, s[8:11], s38 offen lds
  s_add_u32 m0, s39, 3072
  s_nop 0
  buffer_load_dwordx4 v7, s[8:11], s38 offen lds
  s_waitcnt vmcnt(8)
  s_barrier
  s_movk_i32 s38, 2304
  s_add_u32 m0, s39, 16384
  s_nop 0
  buffer_load_dwordx4 v4, s[8:11], s38 offen lds
  s_add_u32 m0, s39, 17408
  s_nop 0
  buffer_load_dwordx4 v5, s[8:11], s38 offen lds
  s_add_u32 m0, s39, 18432
  s_nop 0
  buffer_load_dwordx4 v6, s[8:11], s38 offen lds
  s_add_u32 m0, s39, 19456
  s_nop 0
  buffer_load_dwordx4 v7, s[8:11], s38 offen lds
  s_waitcnt vmcnt(8)
  s_barrier
  s_movk_i32 s38, 2560
  s_add_u32 m0, s39, 32768
  s_nop 0
  buffer_load_dwordx4 v4, s[8:11], s38 offen lds
  s_add_u32 m0, s39, 33792
  s_nop 0
  buffer_load_dwordx4 v5, s[8:11], s38 offen lds
  s_add_u32 m0, s39, 34816
  s_nop 0
  buffer_load_dwordx4 v6, s[8:11], s38 offen lds
  s_add_u32 m0, s39, 35840
  s_nop 0
  buffer_load_dwordx4 v7, s[8:11], s38 offen lds
  s_waitcnt vmcnt(8)
  s_barrier
  s_movk_i32 s38, 2816
  s_add_u32 m0, s39, 49152
  s_nop 0
  buffer_load_dwordx4 v4, s[8:11], s38 offen lds
  s_add_u32 m0, s39, 50176
  s_nop 0
  buffer_load_dwordx4 v5, s[8:11], s38 offen lds
  s_add_u32 m0, s39, 51200
  s_nop 0
  buffer_load_dwordx4 v6, s[8:11], s38 offen lds
  s_add_u32 m0, s39, 52224
  s_nop 0
  buffer_load_dwordx4 v7, s[8:11], s38 offen lds
  s_waitcnt vmcnt(8)
  s_barrier
  s_movk_i32 s38, 3072
  s_add_u32 m0, s39, 0
  s_nop 0
  buffer_load_dwordx4 v4, s[8:11], s38 offen lds
  s_add_u32 m0, s39, 1024
  s_nop 0
  buffer_load_dwordx4 v5, s[8:11], s38 offen lds
  s_add_u32 m0, s39, 2048
  s_nop 0
  buffer_load_dwordx4 v6, s[8:11], s38 offen lds
  s_add_u32 m0, s39, 3072
  s_nop 0
  buffer_load_dwordx4 v7, s[8:11], s38 offen lds
  s_waitcnt vmcnt(8)
  s_barrier
  s_movk_i32 s38, 3328
  s_add_u32 m0, s39, 16384
  s_nop 0
  buffer_load_dwordx4 v4, s[8:11], s38 offen lds
  s_add_u32 m0, s39, 17408
  s_nop 0
  buffer_load_dwordx4 v5, s[8:11], s38 offen lds
  s_add_u32 m0, s39, 18432
  s_nop 0
  buffer_load_dwordx4 v6, s[8:11], s38 offen lds
  s_add_u32 m0, s39, 19456
  s_nop 0
  buffer_load_dwordx4 v7, s[8:11], s38 offen lds
  s_waitcnt vmcnt(8)
  s_barrier
  s_movk_i32 s38, 3584
  s_add_u32 m0, s39, 32768
  s_nop 0
  buffer_load_dwordx4 v4, s[8:11], s38 offen lds
  s_add_u32 m0, s39, 33792
  s_nop 0
  buffer_load_dwordx4 v5, s[8:11], s38 offen lds
  s_add_u32 m0, s39, 34816
  s_nop 0
  buffer_load_dwordx4 v6, s[8:11], s38 offen lds
  s_add_u32 m0, s39, 35840
  s_nop 0
  buffer_load_dwordx4 v7, s[8:11], s38 offen lds
  s_waitcnt vmcnt(8)
  s_barrier
  s_movk_i32 s38, 3840
  s_add_u32 m0, s39, 49152
  s_nop 0
  buffer_load_dwordx4 v4, s[8:11], s38 offen lds
  s_add_u32 m0, s39, 50176
  s_nop 0
  buffer_load_dwordx4 v5, s[8:11], s38 offen lds
  s_add_u32 m0, s39, 51200
  s_nop 0
  buffer_load_dwordx4 v6, s[8:11], s38 offen lds
  s_add_u32 m0, s39, 52224
  s_nop 0
  buffer_load_dwordx4 v7, s[8:11], s38 offen lds
  s_waitcnt vmcnt(8)
  s_barrier
  s_waitcnt vmcnt(4)
  s_barrier
  s_waitcnt vmcnt(0)
  s_barrier
  s_barrier
  s_barrier
  s_barrier
  s_barrier
  v_lshlrev_b32 v4, 4, v1
  s_mul_i32 s35, s33, 122880
  s_lshl_b32 s40, s55, 10
  s_add_u32 s35, s35, s40
  s_add_u32 s35, s35, 15728640
  s_mul_i32 s36, s55, 5120
  s_add_u32 m0, s36, 0
  s_add_u32 s40, s35, 0
  buffer_load_dwordx4 v4, s[16:19], s40 offen sc1 lds
  s_add_u32 m0, s36, 1024
  s_add_u32 s40, s35, 24576
  buffer_load_dwordx4 v4, s[16:19], s40 offen sc1 lds
  s_add_u32 m0, s36, 2048
  s_add_u32 s40, s35, 49152
  buffer_load_dwordx4 v4, s[16:19], s40 offen sc1 lds
  s_add_u32 m0, s36, 3072
  s_add_u32 s40, s35, 73728
  buffer_load_dwordx4 v4, s[16:19], s40 offen sc1 lds
  s_add_u32 m0, s36, 4096
  s_add_u32 s40, s35, 98304
  buffer_load_dwordx4 v4, s[16:19], s40 offen sc1 lds
  s_add_u32 m0, s36, 20480
  s_add_u32 s40, s35, 4096
  buffer_load_dwordx4 v4, s[16:19], s40 offen sc1 lds
  s_add_u32 m0, s36, 21504
  s_add_u32 s40, s35, 28672
  buffer_load_dwordx4 v4, s[16:19], s40 offen sc1 lds
  s_add_u32 m0, s36, 22528
  s_add_u32 s40, s35, 53248
  buffer_load_dwordx4 v4, s[16:19], s40 offen sc1 lds
  s_add_u32 m0, s36, 23552
  s_add_u32 s40, s35, 77824
  buffer_load_dwordx4 v4, s[16:19], s40 offen sc1 lds
  s_add_u32 m0, s36, 24576
  s_add_u32 s40, s35, 102400
  buffer_load_dwordx4 v4, s[16:19], s40 offen sc1 lds
  s_add_u32 m0, s36, 40960
  s_add_u32 s40, s35, 8192
  buffer_load_dwordx4 v4, s[16:19], s40 offen sc1 lds
  s_add_u32 m0, s36, 41984
  s_add_u32 s40, s35, 32768
  buffer_load_dwordx4 v4, s[16:19], s40 offen sc1 lds
  s_add_u32 m0, s36, 43008
  s_add_u32 s40, s35, 57344
  buffer_load_dwordx4 v4, s[16:19], s40 offen sc1 lds
  s_add_u32 m0, s36, 44032
  s_add_u32 s40, s35, 81920
  buffer_load_dwordx4 v4, s[16:19], s40 offen sc1 lds
  s_add_u32 m0, s36, 45056
  s_add_u32 s40, s35, 106496
  buffer_load_dwordx4 v4, s[16:19], s40 offen sc1 lds
  s_add_u32 m0, s36, 61440
  s_add_u32 s40, s35, 12288
  buffer_load_dwordx4 v4, s[16:19], s40 offen sc1 lds
  s_add_u32 m0, s36, 62464
  s_add_u32 s40, s35, 36864
  buffer_load_dwordx4 v4, s[16:19], s40 offen sc1 lds
  s_add_u32 m0, s36, 63488
  s_add_u32 s40, s35, 61440
  buffer_load_dwordx4 v4, s[16:19], s40 offen sc1 lds
  s_add_u32 m0, s36, 64512
  s_add_u32 s40, s35, 86016
  buffer_load_dwordx4 v4, s[16:19], s40 offen sc1 lds
  s_add_u32 m0, s36, 65536
  s_add_u32 s40, s35, 110592
  buffer_load_dwordx4 v4, s[16:19], s40 offen sc1 lds
  s_add_u32 m0, s36, 81920
  s_add_u32 s40, s35, 16384
  buffer_load_dwordx4 v4, s[16:19], s40 offen sc1 lds
  s_add_u32 m0, s36, 82944
  s_add_u32 s40, s35, 40960
  buffer_load_dwordx4 v4, s[16:19], s40 offen sc1 lds
  s_add_u32 m0, s36, 83968
  s_add_u32 s40, s35, 65536
  buffer_load_dwordx4 v4, s[16:19], s40 offen sc1 lds
  s_add_u32 m0, s36, 84992
  s_add_u32 s40, s35, 90112
  buffer_load_dwordx4 v4, s[16:19], s40 offen sc1 lds
  s_add_u32 m0, s36, 86016
  s_add_u32 s40, s35, 114688
  buffer_load_dwordx4 v4, s[16:19], s40 offen sc1 lds
  s_add_u32 m0, s36, 102400
  s_add_u32 s40, s35, 20480
  buffer_load_dwordx4 v4, s[16:19], s40 offen sc1 lds
  s_add_u32 m0, s36, 103424
  s_add_u32 s40, s35, 45056
  buffer_load_dwordx4 v4, s[16:19], s40 offen sc1 lds
  s_add_u32 m0, s36, 104448
  s_add_u32 s40, s35, 69632
  buffer_load_dwordx4 v4, s[16:19], s40 offen sc1 lds
  s_add_u32 m0, s36, 105472
  s_add_u32 s40, s35, 94208
  buffer_load_dwordx4 v4, s[16:19], s40 offen sc1 lds
  s_add_u32 m0, s36, 106496
  s_add_u32 s40, s35, 118784
  buffer_load_dwordx4 v4, s[16:19], s40 offen sc1 lds
  s_barrier
  s_waitcnt vmcnt(25)
  s_barrier
  s_waitcnt vmcnt(20)
  s_barrier
  s_waitcnt vmcnt(15)
  s_barrier
  s_waitcnt vmcnt(10)
  s_barrier
  s_waitcnt vmcnt(5)
  s_barrier
  s_waitcnt vmcnt(0)
  s_barrier
  s_endpgm
K1_AB:
  v_lshrrev_b32 v17, 1, v3
  v_xor_b32 v17, v17, v2
  v_lshlrev_b32 v17, 4, v17
  v_lshlrev_b32 v18, 7, v3
  v_add_u32 v17, v17, v18
  v_xor_b32 v18, 64, v17
  s_lshl_b32 s40, s35, 12
  s_lshl_b32 s41, s36, 11
  s_add_u32 s42, s40, s41
  s_add_u32 s42, s42, 61440
  v_add_u32 v4, s42, v17
  v_add_u32 v5, s42, v18
  s_xor_b32 s41, s41, 2048
  s_add_u32 s42, s40, s41
  s_add_u32 s42, s42, 61440
  v_add_u32 v6, s42, v17
  v_add_u32 v7, s42, v18
  v_lshrrev_b32 v17, 2, v1
  v_and_b32 v17, 3, v17
  v_lshlrev_b32 v18, 3, v2
  v_add_u32 v17, v17, v18
  v_mul_u32_u24 v17, 192, v17
  v_and_b32 v18, 3, v1
  v_lshlrev_b32 v18, 3, v18
  v_add_u32 v17, v17, v18
  v_and_b32 v19, 1, v2
  s_mul_i32 s40, s36, 3
  s_add_u32 s41, s40, 0
  v_xor_b32 v18, s41, v19
  v_lshlrev_b32 v18, 5, v18
  v_add_u32 v8, v17, v18
  s_add_u32 s41, s40, 1
  v_xor_b32 v18, s41, v19
  v_lshlrev_b32 v18, 5, v18
  v_add_u32 v9, v17, v18
  s_add_u32 s41, s40, 2
  v_xor_b32 v18, s41, v19
  v_lshlrev_b32 v18, 5, v18
  v_add_u32 v10, v17, v18
  s_mov_b32 s48, 0xbdd2d3e8
  s_mov_b32 s49, 0xbdd2d3e8
  s_mov_b32 s50, 1.0
  s_mov_b32 s51, 1.0
  s_waitcnt lgkmcnt(0)
  s_mov_b32 s16, s70
  s_and_b32 s17, s71, 0xffff
  s_mov_b32 s18, 18874368
  s_mov_b32 s19, 0x20000
  s_mov_b32 s4, s68
  s_and_b32 s5, s69, 0xffff
  s_mov_b32 s6, 256
  s_mov_b32 s7, 0x20000
  s_cmp_ge_u32 s34, 4
  s_cbranch_scc1 K1_B
  v_mov_b32 v102, 0x3f803f80
  v_mov_b32 v103, 0x3f803f80
  v_mov_b32 v104, 0x3f803f80
  v_mov_b32 v105, 0x3f803f80
  v_mov_b32 v66, 0
  v_mov_b32 v67, 0
  v_mov_b32 v68, 0
  v_mov_b32 v69, 0
  v_mov_b32 v70, 0
  v_mov_b32 v71, 0
  v_mov_b32 v72, 0
  v_mov_b32 v73, 0
  v_mov_b32 v74, 0
  v_mov_b32 v75, 0
  v_mov_b32 v76, 0
  v_mov_b32 v77, 0
  v_mov_b32 v78, 0
  v_mov_b32 v79, 0
  v_mov_b32 v80, 0
  v_mov_b32 v81, 0
  v_mov_b32 v82, 0
  v_mov_b32 v83, 0
  v_mov_b32 v84, 0
  v_mov_b32 v85, 0
  v_mov_b32 v86, 0
  v_mov_b32 v87, 0
  v_mov_b32 v88, 0
  v_mov_b32 v89, 0
  v_mov_b32 v90, 0
  v_mov_b32 v91, 0
  v_mov_b32 v92, 0
  v_mov_b32 v93, 0
  v_mov_b32 v94, 0
  v_mov_b32 v95, 0
  v_mov_b32 v96, 0
  v_mov_b32 v97, 0
  v_mov_b32 v98, 0
  v_mov_b32 v99, 0
  v_mov_b32 v100, 0
  v_mov_b32 v101, 0
  v_mov_b32 v106, 0
  v_mov_b32 v107, 0
  v_mov_b32 v108, 0
  v_mov_b32 v109, 0
  v_mov_b32 v110, 0
  v_mov_b32 v111, 0
  v_mov_b32 v112, 0
  v_mov_b32 v113, 0
  s_barrier
  s_mov_b32 s37, 0
  ds_read_b128 v[26:29], v4 offset:0
  ds_read_b64_tr_b16 v[42:43], v8 offset:0
  ds_read_b64_tr_b16 v[44:45], v8 offset:768
  ds_read_b128 v[30:33], v6 offset:0
  ds_read_b64_tr_b16 v[46:47], v9 offset:0
  ds_read_b64_tr_b16 v[48:49], v9 offset:768
  ds_read_b64_tr_b16 v[50:51], v10 offset:0
  ds_read_b64_tr_b16 v[52:53], v10 offset:768
K1_LOOP1:
  s_waitcnt lgkmcnt(0)
  v_mfma_f32_16x16x32_bf16 v[66:69], v[26:29], v[42:45], v[66:69]
  ds_read_b128 v[34:37], v5 offset:0
  ds_read_b64_tr_b16 v[54:55], v8 offset:6144
  v_mfma_f32_16x16x32_bf16 v[78:81], v[30:33], v[42:45], v[78:81]
  ds_read_b64_tr_b16 v[56:57], v8 offset:6912
  ds_read_b128 v[38:41], v7 offset:0
  v_mfma_f32_16x16x32_bf16 v[70:73], v[26:29], v[46:49], v[70:73]
  ds_read_b64_tr_b16 v[58:59], v9 offset:6144
  ds_read_b64_tr_b16 v[60:61], v9 offset:6912
  v_mfma_f32_16x16x32_bf16 v[82:85], v[30:33], v[46:49], v[82:85]
  ds_read_b64_tr_b16 v[62:63], v10 offset:6144
  ds_read_b64_tr_b16 v[64:65], v10 offset:6912
  v_mfma_f32_16x16x32_bf16 v[74:77], v[26:29], v[50:53], v[74:77]
  v_mfma_f32_16x16x32_bf16 v[86:89], v[30:33], v[50:53], v[86:89]
  v_mfma_f32_16x16x32_bf16 v[106:109], v[102:105], v[26:29], v[106:109]
  v_mfma_f32_16x16x32_bf16 v[110:113], v[26:29], v[26:29], v[110:113]
  s_cmp_eq_u32 s35, 0
  s_cbranch_scc0 K1_SK_1a0
  v_mfma_f32_16x16x32_bf16 v[90:93], v[102:105], v[42:45], v[90:93]
  v_mfma_f32_16x16x32_bf16 v[94:97], v[102:105], v[46:49], v[94:97]
  v_mfma_f32_16x16x32_bf16 v[98:101], v[102:105], v[50:53], v[98:101]
K1_SK_1a0:
  s_waitcnt lgkmcnt(0)
  s_barrier
  v_mfma_f32_16x16x32_bf16 v[66:69], v[34:37], v[54:57], v[66:69]
  ds_read_b128 v[26:29], v4 offset:8192
  ds_read_b64_tr_b16 v[42:43], v8 offset:12288
  v_mfma_f32_16x16x32_bf16 v[78:81], v[38:41], v[54:57], v[78:81]
  ds_read_b64_tr_b16 v[44:45], v8 offset:13056
  ds_read_b128 v[30:33], v6 offset:8192
  v_mfma_f32_16x16x32_bf16 v[70:73], v[34:37], v[58:61], v[70:73]
  ds_read_b64_tr_b16 v[46:47], v9 offset:12288
  ds_read_b64_tr_b16 v[48:49], v9 offset:13056
  v_mfma_f32_16x16x32_bf16 v[82:85], v[38:41], v[58:61], v[82:85]
  ds_read_b64_tr_b16 v[50:51], v10 offset:12288
  ds_read_b64_tr_b16 v[52:53], v10 offset:13056
  v_mfma_f32_16x16x32_bf16 v[74:77], v[34:37], v[62:65], v[74:77]
  v_mfma_f32_16x16x32_bf16 v[86:89], v[38:41], v[62:65], v[86:89]
  v_mfma_f32_16x16x32_bf16 v[106:109], v[102:105], v[34:37], v[106:109]
  v_mfma_f32_16x16x32_bf16 v[110:113], v[34:37], v[34:37], v[110:113]
  s_cmp_eq_u32 s35, 1
  s_cbranch_scc0 K1_SK_1b0
  v_mfma_f32_16x16x32_bf16 v[90:93], v[102:105], v[54:57], v[90:93]
  v_mfma_f32_16x16x32_bf16 v[94:97], v[102:105], v[58:61], v[94:97]
  v_mfma_f32_16x16x32_bf16 v[98:101], v[102:105], v[62:65], v[98:101]
K1_SK_1b0:
  s_waitcnt lgkmcnt(0)
  v_mfma_f32_16x16x32_bf16 v[66:69], v[26:29], v[42:45], v[66:69]
  ds_read_b128 v[34:37], v5 offset:8192
  ds_read_b64_tr_b16 v[54:55], v8 offset:18432
  v_mfma_f32_16x16x32_bf16 v[78:81], v[30:33], v[42:45], v[78:81]
  ds_read_b64_tr_b16 v[56:57], v8 offset:19200
  ds_read_b128 v[38:41], v7 offset:8192
  v_mfma_f32_16x16x32_bf16 v[70:73], v[26:29], v[46:49], v[70:73]
  ds_read_b64_tr_b16 v[58:59], v9 offset:18432
  ds_read_b64_tr_b16 v[60:61], v9 offset:19200
  v_mfma_f32_16x16x32_bf16 v[82:85], v[30:33], v[46:49], v[82:85]
  ds_read_b64_tr_b16 v[62:63], v10 offset:18432
  ds_read_b64_tr_b16 v[64:65], v10 offset:19200
  v_mfma_f32_16x16x32_bf16 v[74:77], v[26:29], v[50:53], v[74:77]
  v_mfma_f32_16x16x32_bf16 v[86:89], v[30:33], v[50:53], v[86:89]
  v_mfma_f32_16x16x32_bf16 v[106:109], v[102:105], v[26:29], v[106:109]
  v_mfma_f32_16x16x32_bf16 v[110:113], v[26:29], v[26:29], v[110:113]
  s_cmp_eq_u32 s35, 0
  s_cbranch_scc0 K1_SK_1a1
  v_mfma_f32_16x16x32_bf16 v[90:93], v[102:105], v[42:45], v[90:93]
  v_mfma_f32_16x16x32_bf16 v[94:97], v[102:105], v[46:49], v[94:97]
  v_mfma_f32_16x16x32_bf16 v[98:101], v[102:105], v[50:53], v[98:101]
K1_SK_1a1:
  s_waitcnt lgkmcnt(0)
  s_barrier
  v_mfma_f32_16x16x32_bf16 v[66:69], v[34:37], v[54:57], v[66:69]
  ds_read_b128 v[26:29], v4 offset:16384
  ds_read_b64_tr_b16 v[42:43], v8 offset:24576
  v_mfma_f32_16x16x32_bf16 v[78:81], v[38:41], v[54:57], v[78:81]
  ds_read_b64_tr_b16 v[44:45], v8 offset:25344
  ds_read_b128 v[30:33], v6 offset:16384
  v_mfma_f32_16x16x32_bf16 v[70:73], v[34:37], v[58:61], v[70:73]
  ds_read_b64_tr_b16 v[46:47], v9 offset:24576
  ds_read_b64_tr_b16 v[48:49], v9 offset:25344
  v_mfma_f32_16x16x32_bf16 v[82:85], v[38:41], v[58:61], v[82:85]
  ds_read_b64_tr_b16 v[50:51], v10 offset:24576
  ds_read_b64_tr_b16 v[52:53], v10 offset:25344
  v_mfma_f32_16x16x32_bf16 v[74:77], v[34:37], v[62:65], v[74:77]
  v_mfma_f32_16x16x32_bf16 v[86:89], v[38:41], v[62:65], v[86:89]
  v_mfma_f32_16x16x32_bf16 v[106:109], v[102:105], v[34:37], v[106:109]
  v_mfma_f32_16x16x32_bf16 v[110:113], v[34:37], v[34:37], v[110:113]
  s_cmp_eq_u32 s35, 1
  s_cbranch_scc0 K1_SK_1b1
  v_mfma_f32_16x16x32_bf16 v[90:93], v[102:105], v[54:57], v[90:93]
  v_mfma_f32_16x16x32_bf16 v[94:97], v[102:105], v[58:61], v[94:97]
  v_mfma_f32_16x16x32_bf16 v[98:101], v[102:105], v[62:65], v[98:101]
K1_SK_1b1:
  s_waitcnt lgkmcnt(0)
  v_mfma_f32_16x16x32_bf16 v[66:69], v[26:29], v[42:45], v[66:69]
  ds_read_b128 v[34:37], v5 offset:16384
  ds_read_b64_tr_b16 v[54:55], v8 offset:30720
  v_mfma_f32_16x16x32_bf16 v[78:81], v[30:33], v[42:45], v[78:81]
  ds_read_b64_tr_b16 v[56:57], v8 offset:31488
  ds_read_b128 v[38:41], v7 offset:16384
  v_mfma_f32_16x16x32_bf16 v[70:73], v[26:29], v[46:49], v[70:73]
  ds_read_b64_tr_b16 v[58:59], v9 offset:30720
  ds_read_b64_tr_b16 v[60:61], v9 offset:31488
  v_mfma_f32_16x16x32_bf16 v[82:85], v[30:33], v[46:49], v[82:85]
  ds_read_b64_tr_b16 v[62:63], v10 offset:30720
  ds_read_b64_tr_b16 v[64:65], v10 offset:31488
  v_mfma_f32_16x16x32_bf16 v[74:77], v[26:29], v[50:53], v[74:77]
  v_mfma_f32_16x16x32_bf16 v[86:89], v[30:33], v[50:53], v[86:89]
  v_mfma_f32_16x16x32_bf16 v[106:109], v[102:105], v[26:29], v[106:109]
  v_mfma_f32_16x16x32_bf16 v[110:113], v[26:29], v[26:29], v[110:113]
  s_cmp_eq_u32 s35, 0
  s_cbranch_scc0 K1_SK_1a2
  v_mfma_f32_16x16x32_bf16 v[90:93], v[102:105], v[42:45], v[90:93]
  v_mfma_f32_16x16x32_bf16 v[94:97], v[102:105], v[46:49], v[94:97]
  v_mfma_f32_16x16x32_bf16 v[98:101], v[102:105], v[50:53], v[98:101]
K1_SK_1a2:
  s_waitcnt lgkmcnt(0)
  s_barrier
  v_mfma_f32_16x16x32_bf16 v[66:69], v[34:37], v[54:57], v[66:69]
  ds_read_b128 v[26:29], v4 offset:24576
  ds_read_b64_tr_b16 v[42:43], v8 offset:36864
  v_mfma_f32_16x16x32_bf16 v[78:81], v[38:41], v[54:57], v[78:81]
  ds_read_b64_tr_b16 v[44:45], v8 offset:37632
  ds_read_b128 v[30:33], v6 offset:24576
  v_mfma_f32_16x16x32_bf16 v[70:73], v[34:37], v[58:61], v[70:73]
  ds_read_b64_tr_b16 v[46:47], v9 offset:36864
  ds_read_b64_tr_b16 v[48:49], v9 offset:37632
  v_mfma_f32_16x16x32_bf16 v[82:85], v[38:41], v[58:61], v[82:85]
  ds_read_b64_tr_b16 v[50:51], v10 offset:36864
  ds_read_b64_tr_b16 v[52:53], v10 offset:37632
  v_mfma_f32_16x16x32_bf16 v[74:77], v[34:37], v[62:65], v[74:77]
  v_mfma_f32_16x16x32_bf16 v[86:89], v[38:41], v[62:65], v[86:89]
  v_mfma_f32_16x16x32_bf16 v[106:109], v[102:105], v[34:37], v[106:109]
  v_mfma_f32_16x16x32_bf16 v[110:113], v[34:37], v[34:37], v[110:113]
  s_cmp_eq_u32 s35, 1
  s_cbranch_scc0 K1_SK_1b2
  v_mfma_f32_16x16x32_bf16 v[90:93], v[102:105], v[54:57], v[90:93]
  v_mfma_f32_16x16x32_bf16 v[94:97], v[102:105], v[58:61], v[94:97]
  v_mfma_f32_16x16x32_bf16 v[98:101], v[102:105], v[62:65], v[98:101]
K1_SK_1b2:
  s_waitcnt lgkmcnt(0)
  v_mfma_f32_16x16x32_bf16 v[66:69], v[26:29], v[42:45], v[66:69]
  ds_read_b128 v[34:37], v5 offset:24576
  ds_read_b64_tr_b16 v[54:55], v8 offset:43008
  v_mfma_f32_16x16x32_bf16 v[78:81], v[30:33], v[42:45], v[78:81]
  ds_read_b64_tr_b16 v[56:57], v8 offset:43776
  ds_read_b128 v[38:41], v7 offset:24576
  v_mfma_f32_16x16x32_bf16 v[70:73], v[26:29], v[46:49], v[70:73]
  ds_read_b64_tr_b16 v[58:59], v9 offset:43008
  ds_read_b64_tr_b16 v[60:61], v9 offset:43776
  v_mfma_f32_16x16x32_bf16 v[82:85], v[30:33], v[46:49], v[82:85]
  ds_read_b64_tr_b16 v[62:63], v10 offset:43008
  ds_read_b64_tr_b16 v[64:65], v10 offset:43776
  v_mfma_f32_16x16x32_bf16 v[74:77], v[26:29], v[50:53], v[74:77]
  v_mfma_f32_16x16x32_bf16 v[86:89], v[30:33], v[50:53], v[86:89]
  v_mfma_f32_16x16x32_bf16 v[106:109], v[102:105], v[26:29], v[106:109]
  v_mfma_f32_16x16x32_bf16 v[110:113], v[26:29], v[26:29], v[110:113]
  s_cmp_eq_u32 s35, 0
  s_cbranch_scc0 K1_SK_1a3
  v_mfma_f32_16x16x32_bf16 v[90:93], v[102:105], v[42:45], v[90:93]
  v_mfma_f32_16x16x32_bf16 v[94:97], v[102:105], v[46:49], v[94:97]
  v_mfma_f32_16x16x32_bf16 v[98:101], v[102:105], v[50:53], v[98:101]
K1_SK_1a3:
  s_waitcnt lgkmcnt(0)
  s_barrier
  v_mfma_f32_16x16x32_bf16 v[66:69], v[34:37], v[54:57], v[66:69]
  ds_read_b128 v[26:29], v4 offset:32768
  ds_read_b64_tr_b16 v[42:43], v8 offset:49152
  v_mfma_f32_16x16x32_bf16 v[78:81], v[38:41], v[54:57], v[78:81]
  ds_read_b64_tr_b16 v[44:45], v8 offset:49920
  ds_read_b128 v[30:33], v6 offset:32768
  v_mfma_f32_16x16x32_bf16 v[70:73], v[34:37], v[58:61], v[70:73]
  ds_read_b64_tr_b16 v[46:47], v9 offset:49152
  ds_read_b64_tr_b16 v[48:49], v9 offset:49920
  v_mfma_f32_16x16x32_bf16 v[82:85], v[38:41], v[58:61], v[82:85]
  ds_read_b64_tr_b16 v[50:51], v10 offset:49152
  ds_read_b64_tr_b16 v[52:53], v10 offset:49920
  v_mfma_f32_16x16x32_bf16 v[74:77], v[34:37], v[62:65], v[74:77]
  v_mfma_f32_16x16x32_bf16 v[86:89], v[38:41], v[62:65], v[86:89]
  v_mfma_f32_16x16x32_bf16 v[106:109], v[102:105], v[34:37], v[106:109]
  v_mfma_f32_16x16x32_bf16 v[110:113], v[34:37], v[34:37], v[110:113]
  s_cmp_eq_u32 s35, 1
  s_cbranch_scc0 K1_SK_1b3
  v_mfma_f32_16x16x32_bf16 v[90:93], v[102:105], v[54:57], v[90:93]
  v_mfma_f32_16x16x32_bf16 v[94:97], v[102:105], v[58:61], v[94:97]
  v_mfma_f32_16x16x32_bf16 v[98:101], v[102:105], v[62:65], v[98:101]
K1_SK_1b3:
  s_waitcnt lgkmcnt(0)
  v_mfma_f32_16x16x32_bf16 v[66:69], v[26:29], v[42:45], v[66:69]
  ds_read_b128 v[34:37], v5 offset:32768
  ds_read_b64_tr_b16 v[54:55], v8 offset:55296
  v_mfma_f32_16x16x32_bf16 v[78:81], v[30:33], v[42:45], v[78:81]
  ds_read_b64_tr_b16 v[56:57], v8 offset:56064
  ds_read_b128 v[38:41], v7 offset:32768
  v_mfma_f32_16x16x32_bf16 v[70:73], v[26:29], v[46:49], v[70:73]
  ds_read_b64_tr_b16 v[58:59], v9 offset:55296
  ds_read_b64_tr_b16 v[60:61], v9 offset:56064
  v_mfma_f32_16x16x32_bf16 v[82:85], v[30:33], v[46:49], v[82:85]
  ds_read_b64_tr_b16 v[62:63], v10 offset:55296
  ds_read_b64_tr_b16 v[64:65], v10 offset:56064
  v_mfma_f32_16x16x32_bf16 v[74:77], v[26:29], v[50:53], v[74:77]
  v_mfma_f32_16x16x32_bf16 v[86:89], v[30:33], v[50:53], v[86:89]
  v_mfma_f32_16x16x32_bf16 v[106:109], v[102:105], v[26:29], v[106:109]
  v_mfma_f32_16x16x32_bf16 v[110:113], v[26:29], v[26:29], v[110:113]
  s_cmp_eq_u32 s35, 0
  s_cbranch_scc0 K1_SK_1a4
  v_mfma_f32_16x16x32_bf16 v[90:93], v[102:105], v[42:45], v[90:93]
  v_mfma_f32_16x16x32_bf16 v[94:97], v[102:105], v[46:49], v[94:97]
  v_mfma_f32_16x16x32_bf16 v[98:101], v[102:105], v[50:53], v[98:101]
K1_SK_1a4:
  s_waitcnt lgkmcnt(0)
  s_barrier
  v_add_u32 v4, 40960, v4
  v_add_u32 v5, 40960, v5
  v_add_u32 v6, 40960, v6
  v_add_u32 v7, 40960, v7
  v_mfma_f32_16x16x32_bf16 v[66:69], v[34:37], v[54:57], v[66:69]
  ds_read_b128 v[26:29], v4 offset:0
  ds_read_b64_tr_b16 v[42:43], v8 offset:0
  v_mfma_f32_16x16x32_bf16 v[78:81], v[38:41], v[54:57], v[78:81]
  ds_read_b64_tr_b16 v[44:45], v8 offset:768
  ds_read_b128 v[30:33], v6 offset:0
  v_mfma_f32_16x16x32_bf16 v[70:73], v[34:37], v[58:61], v[70:73]
  ds_read_b64_tr_b16 v[46:47], v9 offset:0
  ds_read_b64_tr_b16 v[48:49], v9 offset:768
  v_mfma_f32_16x16x32_bf16 v[82:85], v[38:41], v[58:61], v[82:85]
  ds_read_b64_tr_b16 v[50:51], v10 offset:0
  ds_read_b64_tr_b16 v[52:53], v10 offset:768
  v_mfma_f32_16x16x32_bf16 v[74:77], v[34:37], v[62:65], v[74:77]
  v_mfma_f32_16x16x32_bf16 v[86:89], v[38:41], v[62:65], v[86:89]
  v_mfma_f32_16x16x32_bf16 v[106:109], v[102:105], v[34:37], v[106:109]
  v_mfma_f32_16x16x32_bf16 v[110:113], v[34:37], v[34:37], v[110:113]
  s_cmp_eq_u32 s35, 1
  s_cbranch_scc0 K1_SK_1b4
  v_mfma_f32_16x16x32_bf16 v[90:93], v[102:105], v[54:57], v[90:93]
  v_mfma_f32_16x16x32_bf16 v[94:97], v[102:105], v[58:61], v[94:97]
  v_mfma_f32_16x16x32_bf16 v[98:101], v[102:105], v[62:65], v[98:101]
K1_SK_1b4:
  s_add_u32 s37, s37, 1
  s_cmp_lt_u32 s37, 2
  s_cbranch_scc1 K1_LOOP1
  s_setprio 2
  s_lshl_b32 s40, s32, 2
  v_mov_b32 v22, s40
  buffer_load_dword v23, v22, s[4:7], 0 offen sc1
  s_mov_b32 s28, s62
  s_and_b32 s29, s63, 0xffff
  s_mov_b32 s30, 5120
  s_mov_b32 s31, 0x20000
  v_lshlrev_b32 v17, 4, v1
  s_mul_i32 s41, s33, 640
  buffer_load_dwordx4 v[160:163], v17, s[28:31], s41 offen
  v_and_b32 v14, 3, v3
  v_cmp_eq_u32 vcc, 1, v14
  s_nop 1
  v_cndmask_b32 v110, v110, v111, vcc
  v_cmp_eq_u32 vcc, 2, v14
  s_nop 1
  v_cndmask_b32 v110, v110, v112, vcc
  v_cmp_eq_u32 vcc, 3, v14
  s_nop 1
  v_cndmask_b32 v110, v110, v113, vcc
  v_mul_f32 v16, 0x3acccccd, v106
  v_mul_f32 v18, 0x3acccccd, v110
  v_fma_f32 v18, -v16, v16, v18
  v_max_f32 v18, 0, v18
  v_cvt_pk_bf16_f32 v16, v16, v16
  v_lshlrev_b32 v16, 16, v16
  v_cvt_pk_bf16_f32 v18, v18, v18
  v_lshlrev_b32 v18, 16, v18
  v_add_f32 v18, 0x3727c5ac, v18
  v_cvt_pk_bf16_f32 v18, v18, v18
  v_lshlrev_b32 v18, 16, v18
  v_sqrt_f32 v18, v18
  s_nop 0
  v_cvt_pk_bf16_f32 v18, v18, v18
  v_lshlrev_b32 v18, 16, v18
  v_rcp_f32 v17, v18
  s_lshl_b32 s40, s35, 5
  s_lshl_b32 s41, s36, 4
  s_add_u32 s40, s40, s41
  v_add_u32 v18, s40, v3
  v_lshlrev_b32 v19, 2, v18
  v_add_u32 v19, 143360, v19
  s_mov_b32 exec_lo, 0xf0000f
  s_mov_b32 exec_hi, 0xf0000f00
  ds_write_b32 v19, v16
  ds_write_b32 v19, v17 offset:256
  s_cmp_eq_u32 s33, 0
  s_cbranch_scc0 K1_NOST1X
  s_lshl_b32 s41, s32, 9
  s_add_u32 s41, s41, 16777216
  v_lshlrev_b32 v18, 3, v18
  buffer_store_dwordx2 v[16:17], v18, s[16:19], s41 offen sc1
K1_NOST1X:
  s_mov_b64 exec, s[52:53]
  s_mul_i32 s40, s55, 192
  s_add_u32 s40, s40, 143872
  v_lshlrev_b32 v20, 2, v3
  v_add_u32 v20, s40, v20
  ds_write_b32 v20, v90 offset:0
  ds_write_b32 v20, v94 offset:64
  ds_write_b32 v20, v98 offset:128
  s_waitcnt lgkmcnt(0)
  s_barrier
  s_xor_b32 s41, s55, 2
  s_mul_i32 s41, s41, 192
  s_add_u32 s41, s41, 143872
  v_lshlrev_b32 v18, 2, v3
  v_add_u32 v18, s41, v18
  ds_read_b32 v136, v18 offset:0
  ds_read_b32 v138, v18 offset:64
  ds_read_b32 v140, v18 offset:128
  s_lshl_b32 s40, s35, 7
  s_lshl_b32 s41, s36, 6
  s_add_u32 s40, s40, s41
  s_add_u32 s40, s40, 143360
  v_lshlrev_b32 v19, 4, v2
  v_add_u32 v19, s40, v19
  v_xor_b32 v20, 64, v19
  ds_read_b128 v[26:29], v19
  ds_read_b128 v[30:33], v20
  ds_read_b128 v[34:37], v19 offset:256
  ds_read_b128 v[38:41], v20 offset:256
  v_mov_b32 v126, 0xc0135761
  v_mov_b32 v127, 0xc0135761
  v_mov_b32 v42, 0
  v_mov_b32 v43, 0
  v_mov_b32 v44, 0
  v_mov_b32 v45, 0
  v_mov_b32 v46, 0
  v_mov_b32 v47, 0
  v_mov_b32 v48, 0
  v_mov_b32 v49, 0
  v_mov_b32 v50, 0
  v_mov_b32 v51, 0
  v_mov_b32 v52, 0
  v_mov_b32 v53, 0
  v_mov_b32 v54, 0
  v_mov_b32 v55, 0
  v_mov_b32 v56, 0
  v_mov_b32 v57, 0
  s_waitcnt lgkmcnt(0)
  v_add_f32 v136, v136, v90
  v_sub_f32 v136, 0, v136
  v_add_f32 v138, v138, v94
  v_sub_f32 v138, 0, v138
  v_add_f32 v140, v140, v98
  v_sub_f32 v140, 0, v140
  v_fma_f32 v66, v26, v136, v66
  v_fma_f32 v67, v27, v136, v67
  v_mul_f32 v66, v66, v34
  v_mul_f32 v67, v67, v35
  v_mul_f32 v128, v66, v66
  v_mul_f32 v129, v67, v67
  v_fma_f32 v128, v128, s48, v126
  v_fma_f32 v129, v129, s48, v126
  v_mul_f32 v128, v128, v66
  v_mul_f32 v129, v129, v67
  v_exp_f32 v128, v128
  v_exp_f32 v129, v129
  v_add_f32 v128, 1.0, v128
  v_add_f32 v129, 1.0, v129
  v_rcp_f32 v128, v128
  v_rcp_f32 v129, v129
  v_mul_f32 v128, v128, v66
  v_mul_f32 v129, v129, v67
  v_cvt_pk_bf16_f32 v114, v128, v129
  v_add_f32 v42, v42, v128
  v_add_f32 v43, v43, v129
  v_fma_f32 v50, v128, v128, v50
  v_fma_f32 v51, v129, v129, v51
  v_fma_f32 v68, v28, v136, v68
  v_fma_f32 v69, v29, v136, v69
  v_mul_f32 v68, v68, v36
  v_mul_f32 v69, v69, v37
  v_mul_f32 v132, v68, v68
  v_mul_f32 v133, v69, v69
  v_fma_f32 v132, v132, s48, v126
  v_fma_f32 v133, v133, s48, v126
  v_mul_f32 v132, v132, v68
  v_mul_f32 v133, v133, v69
  v_exp_f32 v132, v132
  v_exp_f32 v133, v133
  v_add_f32 v132, 1.0, v132
  v_add_f32 v133, 1.0, v133
  v_rcp_f32 v132, v132
  v_rcp_f32 v133, v133
  v_mul_f32 v132, v132, v68
  v_mul_f32 v133, v133, v69
  v_cvt_pk_bf16_f32 v115, v132, v133
  v_add_f32 v44, v44, v132
  v_add_f32 v45, v45, v133
  v_fma_f32 v52, v132, v132, v52
  v_fma_f32 v53, v133, v133, v53
  v_fma_f32 v78, v30, v136, v78
  v_fma_f32 v79, v31, v136, v79
  v_mul_f32 v78, v78, v38
  v_mul_f32 v79, v79, v39
  v_mul_f32 v128, v78, v78
  v_mul_f32 v129, v79, v79
  v_fma_f32 v128, v128, s48, v126
  v_fma_f32 v129, v129, s48, v126
  v_mul_f32 v128, v128, v78
  v_mul_f32 v129, v129, v79
  v_exp_f32 v128, v128
  v_exp_f32 v129, v129
  v_add_f32 v128, 1.0, v128
  v_add_f32 v129, 1.0, v129
  v_rcp_f32 v128, v128
  v_rcp_f32 v129, v129
  v_mul_f32 v128, v128, v78
  v_mul_f32 v129, v129, v79
  v_cvt_pk_bf16_f32 v116, v128, v129
  v_add_f32 v46, v46, v128
  v_add_f32 v47, v47, v129
  v_fma_f32 v54, v128, v128, v54
  v_fma_f32 v55, v129, v129, v55
  v_fma_f32 v80, v32, v136, v80
  v_fma_f32 v81, v33, v136, v81
  v_mul_f32 v80, v80, v40
  v_mul_f32 v81, v81, v41
  v_mul_f32 v132, v80, v80
  v_mul_f32 v133, v81, v81
  v_fma_f32 v132, v132, s48, v126
  v_fma_f32 v133, v133, s48, v126
  v_mul_f32 v132, v132, v80
  v_mul_f32 v133, v133, v81
  v_exp_f32 v132, v132
  v_exp_f32 v133, v133
  v_add_f32 v132, 1.0, v132
  v_add_f32 v133, 1.0, v133
  v_rcp_f32 v132, v132
  v_rcp_f32 v133, v133
  v_mul_f32 v132, v132, v80
  v_mul_f32 v133, v133, v81
  v_cvt_pk_bf16_f32 v117, v132, v133
  v_add_f32 v48, v48, v132
  v_add_f32 v49, v49, v133
  v_fma_f32 v56, v132, v132, v56
  v_fma_f32 v57, v133, v133, v57
  s_barrier
  v_fma_f32 v70, v26, v138, v70
  v_fma_f32 v71, v27, v138, v71
  v_mul_f32 v70, v70, v34
  v_mul_f32 v71, v71, v35
  v_mul_f32 v128, v70, v70
  v_mul_f32 v129, v71, v71
  v_fma_f32 v128, v128, s48, v126
  v_fma_f32 v129, v129, s48, v126
  v_mul_f32 v128, v128, v70
  v_mul_f32 v129, v129, v71
  v_exp_f32 v128, v128
  v_exp_f32 v129, v129
  v_add_f32 v128, 1.0, v128
  v_add_f32 v129, 1.0, v129
  v_rcp_f32 v128, v128
  v_rcp_f32 v129, v129
  v_mul_f32 v128, v128, v70
  v_mul_f32 v129, v129, v71
  v_cvt_pk_bf16_f32 v118, v128, v129
  v_add_f32 v42, v42, v128
  v_add_f32 v43, v43, v129
  v_fma_f32 v50, v128, v128, v50
  v_fma_f32 v51, v129, v129, v51
  v_fma_f32 v72, v28, v138, v72
  v_fma_f32 v73, v29, v138, v73
  v_mul_f32 v72, v72, v36
  v_mul_f32 v73, v73, v37
  v_mul_f32 v132, v72, v72
  v_mul_f32 v133, v73, v73
  v_fma_f32 v132, v132, s48, v126
  v_fma_f32 v133, v133, s48, v126
  v_mul_f32 v132, v132, v72
  v_mul_f32 v133, v133, v73
  v_exp_f32 v132, v132
  v_exp_f32 v133, v133
  v_add_f32 v132, 1.0, v132
  v_add_f32 v133, 1.0, v133
  v_rcp_f32 v132, v132
  v_rcp_f32 v133, v133
  v_mul_f32 v132, v132, v72
  v_mul_f32 v133, v133, v73
  v_cvt_pk_bf16_f32 v119, v132, v133
  v_add_f32 v44, v44, v132
  v_add_f32 v45, v45, v133
  v_fma_f32 v52, v132, v132, v52
  v_fma_f32 v53, v133, v133, v53
  v_fma_f32 v82, v30, v138, v82
  v_fma_f32 v83, v31, v138, v83
  v_mul_f32 v82, v82, v38
  v_mul_f32 v83, v83, v39
  v_mul_f32 v128, v82, v82
  v_mul_f32 v129, v83, v83
  v_fma_f32 v128, v128, s48, v126
  v_fma_f32 v129, v129, s48, v126
  v_mul_f32 v128, v128, v82
  v_mul_f32 v129, v129, v83
  v_exp_f32 v128, v128
  v_exp_f32 v129, v129
  v_add_f32 v128, 1.0, v128
  v_add_f32 v129, 1.0, v129
  v_rcp_f32 v128, v128
  v_rcp_f32 v129, v129
  v_mul_f32 v128, v128, v82
  v_mul_f32 v129, v129, v83
  v_cvt_pk_bf16_f32 v120, v128, v129
  v_add_f32 v46, v46, v128
  v_add_f32 v47, v47, v129
  v_fma_f32 v54, v128, v128, v54
  v_fma_f32 v55, v129, v129, v55
  v_fma_f32 v84, v32, v138, v84
  v_fma_f32 v85, v33, v138, v85
  v_mul_f32 v84, v84, v40
  v_mul_f32 v85, v85, v41
  v_mul_f32 v132, v84, v84
  v_mul_f32 v133, v85, v85
  v_fma_f32 v132, v132, s48, v126
  v_fma_f32 v133, v133, s48, v126
  v_mul_f32 v132, v132, v84
  v_mul_f32 v133, v133, v85
  v_exp_f32 v132, v132
  v_exp_f32 v133, v133
  v_add_f32 v132, 1.0, v132
  v_add_f32 v133, 1.0, v133
  v_rcp_f32 v132, v132
  v_rcp_f32 v133, v133
  v_mul_f32 v132, v132, v84
  v_mul_f32 v133, v133, v85
  v_cvt_pk_bf16_f32 v121, v132, v133
  v_add_f32 v48, v48, v132
  v_add_f32 v49, v49, v133
  v_fma_f32 v56, v132, v132, v56
  v_fma_f32 v57, v133, v133, v57
  v_fma_f32 v74, v26, v140, v74
  v_fma_f32 v75, v27, v140, v75
  v_mul_f32 v74, v74, v34
  v_mul_f32 v75, v75, v35
  v_mul_f32 v128, v74, v74
  v_mul_f32 v129, v75, v75
  v_fma_f32 v128, v128, s48, v126
  v_fma_f32 v129, v129, s48, v126
  v_mul_f32 v128, v128, v74
  v_mul_f32 v129, v129, v75
  v_exp_f32 v128, v128
  v_exp_f32 v129, v129
  v_add_f32 v128, 1.0, v128
  v_add_f32 v129, 1.0, v129
  v_rcp_f32 v128, v128
  v_rcp_f32 v129, v129
  v_mul_f32 v128, v128, v74
  v_mul_f32 v129, v129, v75
  v_cvt_pk_bf16_f32 v122, v128, v129
  v_add_f32 v42, v42, v128
  v_add_f32 v43, v43, v129
  v_fma_f32 v50, v128, v128, v50
  v_fma_f32 v51, v129, v129, v51
  s_barrier
  v_fma_f32 v76, v28, v140, v76
  v_fma_f32 v77, v29, v140, v77
  v_mul_f32 v76, v76, v36
  v_mul_f32 v77, v77, v37
  v_mul_f32 v132, v76, v76
  v_mul_f32 v133, v77, v77
  v_fma_f32 v132, v132, s48, v126
  v_fma_f32 v133, v133, s48, v126
  v_mul_f32 v132, v132, v76
  v_mul_f32 v133, v133, v77
  v_exp_f32 v132, v132
  v_exp_f32 v133, v133
  v_add_f32 v132, 1.0, v132
  v_add_f32 v133, 1.0, v133
  v_rcp_f32 v132, v132
  v_rcp_f32 v133, v133
  v_mul_f32 v132, v132, v76
  v_mul_f32 v133, v133, v77
  v_cvt_pk_bf16_f32 v123, v132, v133
  v_add_f32 v44, v44, v132
  v_add_f32 v45, v45, v133
  v_fma_f32 v52, v132, v132, v52
  v_fma_f32 v53, v133, v133, v53
  v_fma_f32 v86, v30, v140, v86
  v_fma_f32 v87, v31, v140, v87
  v_mul_f32 v86, v86, v38
  v_mul_f32 v87, v87, v39
  v_mul_f32 v128, v86, v86
  v_mul_f32 v129, v87, v87
  v_fma_f32 v128, v128, s48, v126
  v_fma_f32 v129, v129, s48, v126
  v_mul_f32 v128, v128, v86
  v_mul_f32 v129, v129, v87
  v_exp_f32 v128, v128
  v_exp_f32 v129, v129
  v_add_f32 v128, 1.0, v128
  v_add_f32 v129, 1.0, v129
  v_rcp_f32 v128, v128
  v_rcp_f32 v129, v129
  v_mul_f32 v128, v128, v86
  v_mul_f32 v129, v129, v87
  v_cvt_pk_bf16_f32 v124, v128, v129
  v_add_f32 v46, v46, v128
  v_add_f32 v47, v47, v129
  v_fma_f32 v54, v128, v128, v54
  v_fma_f32 v55, v129, v129, v55
  v_fma_f32 v88, v32, v140, v88
  v_fma_f32 v89, v33, v140, v89
  v_mul_f32 v88, v88, v40
  v_mul_f32 v89, v89, v41
  v_mul_f32 v132, v88, v88
  v_mul_f32 v133, v89, v89
  v_fma_f32 v132, v132, s48, v126
  v_fma_f32 v133, v133, s48, v126
  v_mul_f32 v132, v132, v88
  v_mul_f32 v133, v133, v89
  v_exp_f32 v132, v132
  v_exp_f32 v133, v133
  v_add_f32 v132, 1.0, v132
  v_add_f32 v133, 1.0, v133
  v_rcp_f32 v132, v132
  v_rcp_f32 v133, v133
  v_mul_f32 v132, v132, v88
  v_mul_f32 v133, v133, v89
  v_cvt_pk_bf16_f32 v125, v132, v133
  v_add_f32 v48, v48, v132
  v_add_f32 v49, v49, v133
  v_fma_f32 v56, v132, v132, v56
  v_fma_f32 v57, v133, v133, v57
  v_add_f32_dpp v42, v42, v42 row_ror:8 row_mask:0xf bank_mask:0xf
  v_add_f32_dpp v43, v43, v43 row_ror:8 row_mask:0xf bank_mask:0xf
  v_add_f32_dpp v44, v44, v44 row_ror:8 row_mask:0xf bank_mask:0xf
  v_add_f32_dpp v45, v45, v45 row_ror:8 row_mask:0xf bank_mask:0xf
  v_add_f32_dpp v46, v46, v46 row_ror:8 row_mask:0xf bank_mask:0xf
  v_add_f32_dpp v47, v47, v47 row_ror:8 row_mask:0xf bank_mask:0xf
  v_add_f32_dpp v48, v48, v48 row_ror:8 row_mask:0xf bank_mask:0xf
  v_add_f32_dpp v49, v49, v49 row_ror:8 row_mask:0xf bank_mask:0xf
  v_add_f32_dpp v50, v50, v50 row_ror:8 row_mask:0xf bank_mask:0xf
  v_add_f32_dpp v51, v51, v51 row_ror:8 row_mask:0xf bank_mask:0xf
  v_add_f32_dpp v52, v52, v52 row_ror:8 row_mask:0xf bank_mask:0xf
  v_add_f32_dpp v53, v53, v53 row_ror:8 row_mask:0xf bank_mask:0xf
  v_add_f32_dpp v54, v54, v54 row_ror:8 row_mask:0xf bank_mask:0xf
  v_add_f32_dpp v55, v55, v55 row_ror:8 row_mask:0xf bank_mask:0xf
  v_add_f32_dpp v56, v56, v56 row_ror:8 row_mask:0xf bank_mask:0xf
  v_add_f32_dpp v57, v57, v57 row_ror:8 row_mask:0xf bank_mask:0xf
  v_add_f32_dpp v42, v42, v42 row_ror:4 row_mask:0xf bank_mask:0xf
  v_add_f32_dpp v43, v43, v43 row_ror:4 row_mask:0xf bank_mask:0xf
  v_add_f32_dpp v44, v44, v44 row_ror:4 row_mask:0xf bank_mask:0xf
  v_add_f32_dpp v45, v45, v45 row_ror:4 row_mask:0xf bank_mask:0xf
  v_add_f32_dpp v46, v46, v46 row_ror:4 row_mask:0xf bank_mask:0xf
  v_add_f32_dpp v47, v47, v47 row_ror:4 row_mask:0xf bank_mask:0xf
  v_add_f32_dpp v48, v48, v48 row_ror:4 row_mask:0xf bank_mask:0xf
  v_add_f32_dpp v49, v49, v49 row_ror:4 row_mask:0xf bank_mask:0xf
  v_add_f32_dpp v50, v50, v50 row_ror:4 row_mask:0xf bank_mask:0xf
  v_add_f32_dpp v51, v51, v51 row_ror:4 row_mask:0xf bank_mask:0xf
  v_add_f32_dpp v52, v52, v52 row_ror:4 row_mask:0xf bank_mask:0xf
  v_add_f32_dpp v53, v53, v53 row_ror:4 row_mask:0xf bank_mask:0xf
  v_add_f32_dpp v54, v54, v54 row_ror:4 row_mask:0xf bank_mask:0xf
  v_add_f32_dpp v55, v55, v55 row_ror:4 row_mask:0xf bank_mask:0xf
  v_add_f32_dpp v56, v56, v56 row_ror:4 row_mask:0xf bank_mask:0xf
  v_add_f32_dpp v57, v57, v57 row_ror:4 row_mask:0xf bank_mask:0xf
  v_add_f32_dpp v42, v42, v42 row_ror:2 row_mask:0xf bank_mask:0xf
  v_add_f32_dpp v43, v43, v43 row_ror:2 row_mask:0xf bank_mask:0xf
  v_add_f32_dpp v44, v44, v44 row_ror:2 row_mask:0xf bank_mask:0xf
  v_add_f32_dpp v45, v45, v45 row_ror:2 row_mask:0xf bank_mask:0xf
  v_add_f32_dpp v46, v46, v46 row_ror:2 row_mask:0xf bank_mask:0xf
  v_add_f32_dpp v47, v47, v47 row_ror:2 row_mask:0xf bank_mask:0xf
  v_add_f32_dpp v48, v48, v48 row_ror:2 row_mask:0xf bank_mask:0xf
  v_add_f32_dpp v49, v49, v49 row_ror:2 row_mask:0xf bank_mask:0xf
  v_add_f32_dpp v50, v50, v50 row_ror:2 row_mask:0xf bank_mask:0xf
  v_add_f32_dpp v51, v51, v51 row_ror:2 row_mask:0xf bank_mask:0xf
  v_add_f32_dpp v52, v52, v52 row_ror:2 row_mask:0xf bank_mask:0xf
  v_add_f32_dpp v53, v53, v53 row_ror:2 row_mask:0xf bank_mask:0xf
  v_add_f32_dpp v54, v54, v54 row_ror:2 row_mask:0xf bank_mask:0xf
  v_add_f32_dpp v55, v55, v55 row_ror:2 row_mask:0xf bank_mask:0xf
  v_add_f32_dpp v56, v56, v56 row_ror:2 row_mask:0xf bank_mask:0xf
  v_add_f32_dpp v57, v57, v57 row_ror:2 row_mask:0xf bank_mask:0xf
  v_add_f32_dpp v42, v42, v42 row_ror:1 row_mask:0xf bank_mask:0xf
  v_add_f32_dpp v43, v43, v43 row_ror:1 row_mask:0xf bank_mask:0xf
  v_add_f32_dpp v44, v44, v44 row_ror:1 row_mask:0xf bank_mask:0xf
  v_add_f32_dpp v45, v45, v45 row_ror:1 row_mask:0xf bank_mask:0xf
  v_add_f32_dpp v46, v46, v46 row_ror:1 row_mask:0xf bank_mask:0xf
  v_add_f32_dpp v47, v47, v47 row_ror:1 row_mask:0xf bank_mask:0xf
  v_add_f32_dpp v48, v48, v48 row_ror:1 row_mask:0xf bank_mask:0xf
  v_add_f32_dpp v49, v49, v49 row_ror:1 row_mask:0xf bank_mask:0xf
  v_add_f32_dpp v50, v50, v50 row_ror:1 row_mask:0xf bank_mask:0xf
  v_add_f32_dpp v51, v51, v51 row_ror:1 row_mask:0xf bank_mask:0xf
  v_add_f32_dpp v52, v52, v52 row_ror:1 row_mask:0xf bank_mask:0xf
  v_add_f32_dpp v53, v53, v53 row_ror:1 row_mask:0xf bank_mask:0xf
  v_add_f32_dpp v54, v54, v54 row_ror:1 row_mask:0xf bank_mask:0xf
  v_add_f32_dpp v55, v55, v55 row_ror:1 row_mask:0xf bank_mask:0xf
  v_add_f32_dpp v56, v56, v56 row_ror:1 row_mask:0xf bank_mask:0xf
  v_add_f32_dpp v57, v57, v57 row_ror:1 row_mask:0xf bank_mask:0xf
  s_lshl_b32 s40, s36, 8
  s_add_u32 s40, s40, 2048
  v_add_u32 v19, s40, v19
  v_add_u32 v20, s40, v20
  s_mov_b32 exec_lo, 0x10001
  s_mov_b32 exec_hi, 0x10001
  ds_write_b128 v19, v[42:45]
  ds_write_b128 v20, v[46:49]
  ds_write_b128 v19, v[50:53] offset:512
  ds_write_b128 v20, v[54:57] offset:512
  s_mov_b64 exec, s[52:53]
  s_waitcnt lgkmcnt(0)
  s_barrier
  s_cmp_eq_u32 s34, 0
  s_cbranch_scc0 K1_NOPUB
  v_lshlrev_b32 v14, 2, v1
  v_add_u32 v14, 145408, v14
  ds_read_b32 v16, v14
  ds_read_b32 v18, v14 offset:256
  ds_read_b32 v17, v14 offset:512
  ds_read_b32 v19, v14 offset:768
  s_lshl_b32 s40, s32, 3
  s_add_u32 s40, s40, s33
  s_lshl_b32 s40, s40, 9
  s_add_u32 s40, s40, 16842752
  v_lshlrev_b32 v15, 3, v1
  s_waitcnt lgkmcnt(0)
  v_add_f32 v16, v16, v18
  v_add_f32 v17, v17, v19
  v_max_f32 v17, 0, v17
  buffer_store_dwordx2 v[16:17], v15, s[16:19], s40 offen sc1
K1_NOPUB:
  s_mul_i32 s40, s33, 6
  s_mul_i32 s41, s36, 3
  s_add_u32 s40, s40, s41
  s_lshl_b32 s40, s40, 6
  s_lshl_b32 s41, s32, 1
  s_add_u32 s40, s40, s41
  s_add_u32 s40, s40, s35
  s_lshl_b32 s40, s40, 10
  s_add_u32 s39, s40, 3145728
  v_and_b32 v21, 1, v2
  v_lshlrev_b32 v21, 1, v21
  v_lshrrev_b32 v24, 1, v2
  v_or_b32 v21, v21, v24
  s_lshl_b32 s41, s36, 1
  v_xor_b32 v21, s41, v21
  v_lshlrev_b32 v21, 4, v21
  v_add_u32 v21, v21, v3
  v_lshlrev_b32 v21, 4, v21
  v_and_b32 v24, 31, v1
  s_lshl_b32 s38, s35, 5
  v_add_u32 v24, s38, v24
  v_lshlrev_b32 v24, 3, v24
  s_lshl_b32 s38, s32, 12
  s_add_u32 s38, s38, 16842752
  s_barrier
  s_barrier
  s_barrier
  s_mul_i32 s40, s55, 2560
  s_add_u32 s40, s40, 61440
  v_lshlrev_b32 v17, 2, v1
  v_min_u32 v17, 156, v17
  v_add_u32 v17, s40, v17
  ds_read_b32 v26, v17 offset:0
  ds_read_b32 v27, v17 offset:160
  ds_read_b32 v28, v17 offset:320
  ds_read_b32 v29, v17 offset:480
  ds_read_b32 v30, v17 offset:640
  ds_read_b32 v31, v17 offset:800
  ds_read_b32 v32, v17 offset:960
  ds_read_b32 v33, v17 offset:1120
  ds_read_b32 v34, v17 offset:1280
  ds_read_b32 v35, v17 offset:1440
  ds_read_b32 v36, v17 offset:1600
  ds_read_b32 v37, v17 offset:1760
  ds_read_b32 v38, v17 offset:1920
  ds_read_b32 v39, v17 offset:2080
  s_waitcnt lgkmcnt(6)
  ds_read_b32 v40, v17 offset:2240
  ds_read_b32 v41, v17 offset:2400
  ds_read_b32 v42, v17 offset:2560
  ds_read_b32 v43, v17 offset:2720
  ds_read_b32 v44, v17 offset:2880
  ds_read_b32 v45, v17 offset:11520
  ds_read_b32 v46, v17 offset:11680
  s_waitcnt lgkmcnt(6)
  ds_read_b32 v47, v17 offset:11840
  ds_read_b32 v48, v17 offset:12000
  ds_read_b32 v49, v17 offset:12160
  ds_read_b32 v50, v17 offset:12320
  ds_read_b32 v51, v17 offset:12480
  ds_read_b32 v52, v17 offset:12640
  ds_read_b32 v53, v17 offset:12800
  ds_read_b32 v54, v17 offset:12960
  s_waitcnt lgkmcnt(6)
  ds_read_b32 v55, v17 offset:13120
  ds_read_b32 v56, v17 offset:13280
  ds_read_b32 v57, v17 offset:13440
  ds_read_b32 v58, v17 offset:13600
  ds_read_b32 v59, v17 offset:13760
  ds_read_b32 v60, v17 offset:13920
  s_waitcnt vmcnt(0)
  v_lshlrev_b32 v100, 16, v160
  v_lshlrev_b32 v101, 16, v162
  v_and_b32 v102, s47, v160
  v_and_b32 v103, s47, v162
  v_lshlrev_b32 v104, 16, v161
  v_lshlrev_b32 v105, 16, v163
  v_and_b32 v106, s47, v161
  v_and_b32 v107, s47, v163
  s_waitcnt lgkmcnt(12)
  v_lshlrev_b32 v62, 16, v26
  v_and_b32 v63, s47, v26
  v_lshlrev_b32 v64, 16, v27
  v_and_b32 v65, s47, v27
  v_lshlrev_b32 v66, 16, v28
  v_and_b32 v67, s47, v28
  v_lshlrev_b32 v68, 16, v29
  v_and_b32 v69, s47, v29
  v_lshlrev_b32 v70, 16, v30
  v_and_b32 v71, s47, v30
  v_lshlrev_b32 v72, 16, v31
  v_and_b32 v73, s47, v31
  v_lshlrev_b32 v74, 16, v32
  v_and_b32 v75, s47, v32
  v_lshlrev_b32 v76, 16, v33
  v_and_b32 v77, s47, v33
  v_lshlrev_b32 v78, 16, v34
  v_and_b32 v79, s47, v34
  v_lshlrev_b32 v80, 16, v35
  v_and_b32 v81, s47, v35
  v_lshlrev_b32 v82, 16, v36
  v_and_b32 v83, s47, v36
  v_lshlrev_b32 v84, 16, v37
  v_and_b32 v85, s47, v37
  s_waitcnt lgkmcnt(0)
  v_lshlrev_b32 v86, 16, v38
  v_and_b32 v87, s47, v38
  v_lshlrev_b32 v88, 16, v39
  v_and_b32 v89, s47, v39
  v_lshlrev_b32 v90, 16, v40
  v_and_b32 v91, s47, v40
  v_lshlrev_b32 v92, 16, v41
  v_and_b32 v93, s47, v41
  v_lshlrev_b32 v94, 16, v42
  v_and_b32 v95, s47, v42
  v_lshlrev_b32 v96, 16, v43
  v_and_b32 v97, s47, v43
  v_lshlrev_b32 v98, 16, v44
  v_and_b32 v99, s47, v44
  s_barrier
  v_mul_f32 v126, v106, v62
  v_mul_f32 v127, v107, v63
  v_fmac_f32 v126, v104, v64
  v_fmac_f32 v127, v105, v65
  v_fmac_f32 v126, v102, v66
  v_fmac_f32 v127, v103, v67
  v_fmac_f32 v126, v100, v68
  v_fmac_f32 v127, v101, v69
  v_lshlrev_b32 v18, 16, v45
  v_and_b32 v19, s47, v45
  v_mul_f32 v126, v126, v18
  v_mul_f32 v127, v127, v19
  v_mul_f32 v128, v106, v64
  v_mul_f32 v129, v107, v65
  v_fmac_f32 v128, v104, v66
  v_fmac_f32 v129, v105, v67
  v_fmac_f32 v128, v102, v68
  v_fmac_f32 v129, v103, v69
  v_fmac_f32 v128, v100, v70
  v_fmac_f32 v129, v101, v71
  v_lshlrev_b32 v18, 16, v46
  v_and_b32 v19, s47, v46
  v_mul_f32 v128, v128, v18
  v_mul_f32 v129, v129, v19
  v_mul_f32 v130, v106, v66
  v_mul_f32 v131, v107, v67
  v_fmac_f32 v130, v104, v68
  v_fmac_f32 v131, v105, v69
  v_fmac_f32 v130, v102, v70
  v_fmac_f32 v131, v103, v71
  v_fmac_f32 v130, v100, v72
  v_fmac_f32 v131, v101, v73
  v_lshlrev_b32 v18, 16, v47
  v_and_b32 v19, s47, v47
  v_mul_f32 v130, v130, v18
  v_mul_f32 v131, v131, v19
  v_mul_f32 v132, v106, v68
  v_mul_f32 v133, v107, v69
  v_fmac_f32 v132, v104, v70
  v_fmac_f32 v133, v105, v71
  v_fmac_f32 v132, v102, v72
  v_fmac_f32 v133, v103, v73
  v_fmac_f32 v132, v100, v74
  v_fmac_f32 v133, v101, v75
  v_lshlrev_b32 v18, 16, v48
  v_and_b32 v19, s47, v48
  v_mul_f32 v132, v132, v18
  v_mul_f32 v133, v133, v19
  v_mul_f32 v134, v106, v70
  v_mul_f32 v135, v107, v71
  v_fmac_f32 v134, v104, v72
  v_fmac_f32 v135, v105, v73
  v_fmac_f32 v134, v102, v74
  v_fmac_f32 v135, v103, v75
  v_fmac_f32 v134, v100, v76
  v_fmac_f32 v135, v101, v77
  v_lshlrev_b32 v18, 16, v49
  v_and_b32 v19, s47, v49
  v_mul_f32 v134, v134, v18
  v_mul_f32 v135, v135, v19
  s_barrier
  v_mul_f32 v136, v106, v72
  v_mul_f32 v137, v107, v73
  v_fmac_f32 v136, v104, v74
  v_fmac_f32 v137, v105, v75
  v_fmac_f32 v136, v102, v76
  v_fmac_f32 v137, v103, v77
  v_fmac_f32 v136, v100, v78
  v_fmac_f32 v137, v101, v79
  v_lshlrev_b32 v18, 16, v50
  v_and_b32 v19, s47, v50
  v_mul_f32 v136, v136, v18
  v_mul_f32 v137, v137, v19
  v_mul_f32 v138, v106, v74
  v_mul_f32 v139, v107, v75
  v_fmac_f32 v138, v104, v76
  v_fmac_f32 v139, v105, v77
  v_fmac_f32 v138, v102, v78
  v_fmac_f32 v139, v103, v79
  v_fmac_f32 v138, v100, v80
  v_fmac_f32 v139, v101, v81
  v_lshlrev_b32 v18, 16, v51
  v_and_b32 v19, s47, v51
  v_mul_f32 v138, v138, v18
  v_mul_f32 v139, v139, v19
  v_mul_f32 v140, v106, v76
  v_mul_f32 v141, v107, v77
  v_fmac_f32 v140, v104, v78
  v_fmac_f32 v141, v105, v79
  v_fmac_f32 v140, v102, v80
  v_fmac_f32 v141, v103, v81
  v_fmac_f32 v140, v100, v82
  v_fmac_f32 v141, v101, v83
  v_lshlrev_b32 v18, 16, v52
  v_and_b32 v19, s47, v52
  v_mul_f32 v140, v140, v18
  v_mul_f32 v141, v141, v19
  v_mul_f32 v142, v106, v78
  v_mul_f32 v143, v107, v79
  v_fmac_f32 v142, v104, v80
  v_fmac_f32 v143, v105, v81
  v_fmac_f32 v142, v102, v82
  v_fmac_f32 v143, v103, v83
  v_fmac_f32 v142, v100, v84
  v_fmac_f32 v143, v101, v85
  v_lshlrev_b32 v18, 16, v53
  v_and_b32 v19, s47, v53
  v_mul_f32 v142, v142, v18
  v_mul_f32 v143, v143, v19
  v_mul_f32 v144, v106, v80
  v_mul_f32 v145, v107, v81
  v_fmac_f32 v144, v104, v82
  v_fmac_f32 v145, v105, v83
  v_fmac_f32 v144, v102, v84
  v_fmac_f32 v145, v103, v85
  v_fmac_f32 v144, v100, v86
  v_fmac_f32 v145, v101, v87
  v_lshlrev_b32 v18, 16, v54
  v_and_b32 v19, s47, v54
  v_mul_f32 v144, v144, v18
  v_mul_f32 v145, v145, v19
  s_barrier
  v_mul_f32 v146, v106, v82
  v_mul_f32 v147, v107, v83
  v_fmac_f32 v146, v104, v84
  v_fmac_f32 v147, v105, v85
  v_fmac_f32 v146, v102, v86
  v_fmac_f32 v147, v103, v87
  v_fmac_f32 v146, v100, v88
  v_fmac_f32 v147, v101, v89
  v_lshlrev_b32 v18, 16, v55
  v_and_b32 v19, s47, v55
  v_mul_f32 v146, v146, v18
  v_mul_f32 v147, v147, v19
  v_mul_f32 v148, v106, v84
  v_mul_f32 v149, v107, v85
  v_fmac_f32 v148, v104, v86
  v_fmac_f32 v149, v105, v87
  v_fmac_f32 v148, v102, v88
  v_fmac_f32 v149, v103, v89
  v_fmac_f32 v148, v100, v90
  v_fmac_f32 v149, v101, v91
  v_lshlrev_b32 v18, 16, v56
  v_and_b32 v19, s47, v56
  v_mul_f32 v148, v148, v18
  v_mul_f32 v149, v149, v19
  v_mul_f32 v150, v106, v86
  v_mul_f32 v151, v107, v87
  v_fmac_f32 v150, v104, v88
  v_fmac_f32 v151, v105, v89
  v_fmac_f32 v150, v102, v90
  v_fmac_f32 v151, v103, v91
  v_fmac_f32 v150, v100, v92
  v_fmac_f32 v151, v101, v93
  v_lshlrev_b32 v18, 16, v57
  v_and_b32 v19, s47, v57
  v_mul_f32 v150, v150, v18
  v_mul_f32 v151, v151, v19
  v_mul_f32 v152, v106, v88
  v_mul_f32 v153, v107, v89
  v_fmac_f32 v152, v104, v90
  v_fmac_f32 v153, v105, v91
  v_fmac_f32 v152, v102, v92
  v_fmac_f32 v153, v103, v93
  v_fmac_f32 v152, v100, v94
  v_fmac_f32 v153, v101, v95
  v_lshlrev_b32 v18, 16, v58
  v_and_b32 v19, s47, v58
  v_mul_f32 v152, v152, v18
  v_mul_f32 v153, v153, v19
  v_mul_f32 v154, v106, v90
  v_mul_f32 v155, v107, v91
  v_fmac_f32 v154, v104, v92
  v_fmac_f32 v155, v105, v93
  v_fmac_f32 v154, v102, v94
  v_fmac_f32 v155, v103, v95
  v_fmac_f32 v154, v100, v96
  v_fmac_f32 v155, v101, v97
  v_lshlrev_b32 v18, 16, v59
  v_and_b32 v19, s47, v59
  v_mul_f32 v154, v154, v18
  v_mul_f32 v155, v155, v19
  v_mul_f32 v156, v106, v92
  v_mul_f32 v157, v107, v93
  v_fmac_f32 v156, v104, v94
  v_fmac_f32 v157, v105, v95
  v_fmac_f32 v156, v102, v96
  v_fmac_f32 v157, v103, v97
  v_fmac_f32 v156, v100, v98
  v_fmac_f32 v157, v101, v99
  v_lshlrev_b32 v18, 16, v60
  v_and_b32 v19, s47, v60
  v_mul_f32 v156, v156, v18
  v_mul_f32 v157, v157, v19
  s_barrier
  s_setprio 0
  v_cvt_pk_bf16_f32 v26, v140, v138
  v_cvt_pk_bf16_f32 v27, v136, v134
  v_cvt_pk_bf16_f32 v28, v132, v130
  v_cvt_pk_bf16_f32 v29, v128, v126
  v_cvt_pk_bf16_f32 v30, v156, v154
  v_cvt_pk_bf16_f32 v31, v152, v150
  v_cvt_pk_bf16_f32 v32, v148, v146
  v_cvt_pk_bf16_f32 v33, v144, v142
  v_cvt_pk_bf16_f32 v34, v141, v139
  v_cvt_pk_bf16_f32 v35, v137, v135
  v_cvt_pk_bf16_f32 v36, v133, v131
  v_cvt_pk_bf16_f32 v37, v129, v127
  v_cvt_pk_bf16_f32 v38, v157, v155
  v_cvt_pk_bf16_f32 v39, v153, v151
  v_cvt_pk_bf16_f32 v40, v149, v147
  v_cvt_pk_bf16_f32 v41, v145, v143
  v_mul_u32_u24 v17, 288, v1
  s_lshl_b32 s40, s55, 5
  s_add_u32 s40, s40, 86016
  v_add_u32 v17, s40, v17
  s_mov_b32 exec_lo, 0xffffffff
  s_mov_b32 exec_hi, 0xff
  ds_write_b128 v17, v[26:29] offset:0
  ds_write_b128 v17, v[30:33] offset:16
  ds_write_b128 v17, v[34:37] offset:144
  ds_write_b128 v17, v[38:41] offset:160
  s_mov_b64 exec, s[52:53]
  s_waitcnt lgkmcnt(0)
  s_barrier
  buffer_load_dwordx2 v[44:45], v24, s[16:19], s38 offen offset:0 sc1
  buffer_load_dwordx2 v[46:47], v24, s[16:19], s38 offen offset:512 sc1
  buffer_load_dwordx2 v[48:49], v24, s[16:19], s38 offen offset:1024 sc1
  buffer_load_dwordx2 v[50:51], v24, s[16:19], s38 offen offset:1536 sc1
  buffer_load_dwordx2 v[52:53], v24, s[16:19], s38 offen offset:2048 sc1
  buffer_load_dwordx2 v[54:55], v24, s[16:19], s38 offen offset:2560 sc1
  buffer_load_dwordx2 v[56:57], v24, s[16:19], s38 offen offset:3072 sc1
  buffer_load_dwordx2 v[58:59], v24, s[16:19], s38 offen offset:3584 sc1
  v_lshrrev_b32 v17, 3, v1
  s_lshl_b32 s40, s55, 3
  v_add_u32 v17, s40, v17
  v_and_b32 v18, 7, v1
  v_lshlrev_b32 v18, 4, v18
  v_mul_u32_u24 v19, 144, v17
  v_add_u32 v19, v19, v18
  v_add_u32 v19, 86016, v19
  v_lshlrev_b32 v17, 12, v17
  v_add_u32 v17, v17, v18
  ds_read_b128 v[62:65], v19 offset:0
  ds_read_b128 v[66:69], v19 offset:4608
  ds_read_b128 v[70:73], v19 offset:9216
  s_mul_i32 s40, s33, 327680
  s_lshl_b32 s41, s32, 7
  s_add_u32 s40, s40, s41
  s_add_u32 s40, s40, 6291456
  s_waitcnt lgkmcnt(0)
  buffer_store_dwordx4 v[62:65], v17, s[16:19], s40 offen sc1
  s_add_u32 s40, s40, 131072
  buffer_store_dwordx4 v[66:69], v17, s[16:19], s40 offen sc1
  s_add_u32 s40, s40, 131072
  s_cmp_lt_u32 s55, 2
  s_cselect_b32 s40, s40, 0x80000000
  buffer_store_dwordx4 v[70:73], v17, s[16:19], s40 offen sc1
  s_add_u32 s40, s40, 131072
  v_readfirstlane_b32 s40, v23
  s_nop 0
  s_cmp_ge_u32 s40, 8
  s_cbranch_scc1 K1_CPOLLED
  s_mov_b32 s54, 0
K1_CPOLL:
  s_add_u32 s54, s54, 1
  s_cmp_lt_u32 s54, 0x200000
  s_cbranch_scc0 K1_POLLED
  s_sleep 4
  buffer_load_dword v23, v22, s[4:7], 0 offen sc1
  s_waitcnt vmcnt(0)
  v_readfirstlane_b32 s40, v23
  s_nop 0
  s_cmp_ge_u32 s40, 8
  s_cbranch_scc0 K1_CPOLL
  s_branch K1_POLL
K1_CPOLLED:
  s_mov_b32 s54, 0
  s_waitcnt vmcnt(3)
  s_branch K1_CHECK
K1_POLL:
  buffer_load_dwordx2 v[44:45], v24, s[16:19], s38 offen offset:0 sc1
  buffer_load_dwordx2 v[46:47], v24, s[16:19], s38 offen offset:512 sc1
  buffer_load_dwordx2 v[48:49], v24, s[16:19], s38 offen offset:1024 sc1
  buffer_load_dwordx2 v[50:51], v24, s[16:19], s38 offen offset:1536 sc1
  buffer_load_dwordx2 v[52:53], v24, s[16:19], s38 offen offset:2048 sc1
  buffer_load_dwordx2 v[54:55], v24, s[16:19], s38 offen offset:2560 sc1
  buffer_load_dwordx2 v[56:57], v24, s[16:19], s38 offen offset:3072 sc1
  buffer_load_dwordx2 v[58:59], v24, s[16:19], s38 offen offset:3584 sc1
  s_waitcnt vmcnt(0)
K1_CHECK:
  s_mov_b32 s40, 0xbf800000
  v_cmp_eq_u32 vcc, s40, v45
  v_cmp_eq_u32 s[56:57], s40, v47
  s_nop 0
  s_or_b64 vcc, vcc, s[56:57]
  v_cmp_eq_u32 s[56:57], s40, v49
  s_nop 0
  s_or_b64 vcc, vcc, s[56:57]
  v_cmp_eq_u32 s[56:57], s40, v51
  s_nop 0
  s_or_b64 vcc, vcc, s[56:57]
  v_cmp_eq_u32 s[56:57], s40, v53
  s_nop 0
  s_or_b64 vcc, vcc, s[56:57]
  v_cmp_eq_u32 s[56:57], s40, v55
  s_nop 0
  s_or_b64 vcc, vcc, s[56:57]
  v_cmp_eq_u32 s[56:57], s40, v57
  s_nop 0
  s_or_b64 vcc, vcc, s[56:57]
  v_cmp_eq_u32 s[56:57], s40, v59
  s_nop 0
  s_or_b64 vcc, vcc, s[56:57]
  s_cmp_eq_u64 vcc, 0
  s_cbranch_scc1 K1_POLLED
  s_add_u32 s54, s54, 1
  s_cmp_lt_u32 s54, 0x200000
  s_cbranch_scc0 K1_POLLED
  s_sleep 2
  s_branch K1_POLL
K1_POLLED:
  v_pk_add_f32 v[44:45], v[44:45], v[46:47]
  v_pk_add_f32 v[44:45], v[44:45], v[48:49]
  v_pk_add_f32 v[44:45], v[44:45], v[50:51]
  v_pk_add_f32 v[44:45], v[44:45], v[52:53]
  v_pk_add_f32 v[44:45], v[44:45], v[54:55]
  v_pk_add_f32 v[44:45], v[44:45], v[56:57]
  v_pk_add_f32 v[44:45], v[44:45], v[58:59]
  v_mul_f32 v16, 0x3aaaaaab, v44
  v_mul_f32 v18, 0x3aaaaaab, v45
  v_fma_f32 v18, -v16, v16, v18
  v_max_f32 v18, 0, v18
  v_cvt_pk_bf16_f32 v16, v16, v16
  v_lshlrev_b32 v16, 16, v16
  v_cvt_pk_bf16_f32 v18, v18, v18
  v_lshlrev_b32 v18, 16, v18
  v_add_f32 v18, 0x3727c5ac, v18
  v_cvt_pk_bf16_f32 v18, v18, v18
  v_lshlrev_b32 v18, 16, v18
  v_sqrt_f32 v18, v18
  s_nop 0
  v_cvt_pk_bf16_f32 v18, v18, v18
  v_lshlrev_b32 v18, 16, v18
  v_rcp_f32 v17, v18
  s_nop 0
  v_mul_f32 v16, v16, v17
  v_sub_f32 v16, 0, v16
  s_lshl_b32 s40, s55, 8
  s_add_u32 s40, s40, 146432
  v_and_b32 v18, 31, v1
  v_lshlrev_b32 v18, 2, v18
  v_add_u32 v18, s40, v18
  ds_write_b32 v18, v16
  ds_write_b32 v18, v17 offset:128
  s_lshl_b32 s41, s36, 6
  s_add_u32 s40, s40, s41
  v_lshlrev_b32 v19, 4, v2
  v_add_u32 v19, s40, v19
  v_xor_b32 v20, 64, v19
  s_waitcnt lgkmcnt(0)
  ds_read_b128 v[26:29], v19
  ds_read_b128 v[30:33], v20
  ds_read_b128 v[34:37], v19 offset:128
  ds_read_b128 v[38:41], v20 offset:128
  s_waitcnt lgkmcnt(0)
  v_lshlrev_b32 v128, 16, v114
  v_and_b32 v129, s47, v114
  v_pk_fma_f32 v[128:129], v[128:129], v[34:35], v[26:27]
  v_cvt_pk_bf16_f32 v114, v128, v129
  v_lshlrev_b32 v132, 16, v115
  v_and_b32 v133, s47, v115
  v_pk_fma_f32 v[132:133], v[132:133], v[36:37], v[28:29]
  v_cvt_pk_bf16_f32 v115, v132, v133
  v_lshlrev_b32 v128, 16, v116
  v_and_b32 v129, s47, v116
  v_pk_fma_f32 v[128:129], v[128:129], v[38:39], v[30:31]
  v_cvt_pk_bf16_f32 v116, v128, v129
  v_lshlrev_b32 v132, 16, v117
  v_and_b32 v133, s47, v117
  v_pk_fma_f32 v[132:133], v[132:133], v[40:41], v[32:33]
  v_cvt_pk_bf16_f32 v117, v132, v133
  v_permlane16_swap_b32 v114, v116
  s_nop 0
  v_permlane16_swap_b32 v115, v117
  s_add_u32 s41, s39, 0
  buffer_store_dwordx4 v[114:117], v21, s[16:19], s41 offen sc1
  v_lshlrev_b32 v128, 16, v118
  v_and_b32 v129, s47, v118
  v_pk_fma_f32 v[128:129], v[128:129], v[34:35], v[26:27]
  v_cvt_pk_bf16_f32 v118, v128, v129
  v_lshlrev_b32 v132, 16, v119
  v_and_b32 v133, s47, v119
  v_pk_fma_f32 v[132:133], v[132:133], v[36:37], v[28:29]
  v_cvt_pk_bf16_f32 v119, v132, v133
  v_lshlrev_b32 v128, 16, v120
  v_and_b32 v129, s47, v120
  v_pk_fma_f32 v[128:129], v[128:129], v[38:39], v[30:31]
  v_cvt_pk_bf16_f32 v120, v128, v129
  v_lshlrev_b32 v132, 16, v121
  v_and_b32 v133, s47, v121
  v_pk_fma_f32 v[132:133], v[132:133], v[40:41], v[32:33]
  v_cvt_pk_bf16_f32 v121, v132, v133
  v_permlane16_swap_b32 v118, v120
  s_nop 0
  v_permlane16_swap_b32 v119, v121
  s_add_u32 s41, s39, 65536
  buffer_store_dwordx4 v[118:121], v21, s[16:19], s41 offen sc1
  v_lshlrev_b32 v128, 16, v122
  v_and_b32 v129, s47, v122
  v_pk_fma_f32 v[128:129], v[128:129], v[34:35], v[26:27]
  v_cvt_pk_bf16_f32 v122, v128, v129
  v_lshlrev_b32 v132, 16, v123
  v_and_b32 v133, s47, v123
  v_pk_fma_f32 v[132:133], v[132:133], v[36:37], v[28:29]
  v_cvt_pk_bf16_f32 v123, v132, v133
  v_lshlrev_b32 v128, 16, v124
  v_and_b32 v129, s47, v124
  v_pk_fma_f32 v[128:129], v[128:129], v[38:39], v[30:31]
  v_cvt_pk_bf16_f32 v124, v128, v129
  v_lshlrev_b32 v132, 16, v125
  v_and_b32 v133, s47, v125
  v_pk_fma_f32 v[132:133], v[132:133], v[40:41], v[32:33]
  v_cvt_pk_bf16_f32 v125, v132, v133
  v_permlane16_swap_b32 v122, v124
  s_nop 0
  v_permlane16_swap_b32 v123, v125
  s_add_u32 s41, s39, 131072
  buffer_store_dwordx4 v[122:125], v21, s[16:19], s41 offen sc1
  s_waitcnt vmcnt(0)
  s_barrier
  s_load_dwordx2 s[56:57], s[0:1], 72
  s_and_b32 s35, s34, 1
  s_lshr_b32 s36, s34, 1
  v_xor_b32 v9, v2, v3
  v_lshlrev_b32 v9, 4, v9
  s_lshl_b32 s40, s36, 6
  v_xor_b32 v9, s40, v9
  v_lshlrev_b32 v10, 8, v3
  v_add_u32 v4, v9, v10
  v_xor_b32 v5, 128, v4
  s_mul_i32 s40, s33, 6
  s_mul_i32 s41, s35, 3
  s_add_u32 s40, s40, s41
  s_lshl_b32 s40, s40, 16
  s_add_u32 s40, s40, 3145728
  v_lshlrev_b32 v9, 4, v1
  s_add_u32 s41, s40, 0
  v_add_u32 v6, s41, v9
  s_add_u32 s41, s40, 65536
  v_add_u32 v7, s41, v9
  s_add_u32 s41, s40, 131072
  v_add_u32 v8, s41, v9
  s_lshl_b32 s39, s36, 10
  v_mov_b32 v48, 0
  v_mov_b32 v49, 0
  v_mov_b32 v50, 0
  v_mov_b32 v51, 0
  v_mov_b32 v52, 0
  v_mov_b32 v53, 0
  v_mov_b32 v54, 0
  v_mov_b32 v55, 0
  v_mov_b32 v56, 0
  v_mov_b32 v57, 0
  v_mov_b32 v58, 0
  v_mov_b32 v59, 0
  v_mov_b32 v60, 0
  v_mov_b32 v61, 0
  v_mov_b32 v62, 0
  v_mov_b32 v63, 0
  v_mov_b32 v64, 0
  v_mov_b32 v65, 0
  v_mov_b32 v66, 0
  v_mov_b32 v67, 0
  v_mov_b32 v68, 0
  v_mov_b32 v69, 0
  v_mov_b32 v70, 0
  v_mov_b32 v71, 0
  v_mov_b32 v72, 0
  v_mov_b32 v73, 0
  v_mov_b32 v74, 0
  v_mov_b32 v75, 0
  v_mov_b32 v76, 0
  v_mov_b32 v77, 0
  v_mov_b32 v78, 0
  v_mov_b32 v79, 0
  v_mov_b32 v80, 0
  v_mov_b32 v81, 0
  v_mov_b32 v82, 0
  v_mov_b32 v83, 0
  v_mov_b32 v84, 0
  v_mov_b32 v85, 0
  v_mov_b32 v86, 0
  v_mov_b32 v87, 0
  v_mov_b32 v88, 0
  v_mov_b32 v89, 0
  v_mov_b32 v90, 0
  v_mov_b32 v91, 0
  v_mov_b32 v92, 0
  v_mov_b32 v93, 0
  v_mov_b32 v94, 0
  v_mov_b32 v95, 0
  s_waitcnt lgkmcnt(0)
  s_mov_b32 s12, s56
  s_and_b32 s13, s57, 0xffff
  s_mov_b32 s14, 4096
  s_mov_b32 s15, 0x20000
  s_barrier
  s_add_u32 s38, s39, 0
  buffer_load_dwordx4 v[96:99], v6, s[16:19], s38 offen sc1
  buffer_load_dwordx4 v[100:103], v7, s[16:19], s38 offen sc1
  buffer_load_dwordx4 v[104:107], v8, s[16:19], s38 offen sc1
  s_add_u32 s38, s39, 2048
  buffer_load_dwordx4 v[108:111], v6, s[16:19], s38 offen sc1
  buffer_load_dwordx4 v[112:115], v7, s[16:19], s38 offen sc1
  buffer_load_dwordx4 v[116:119], v8, s[16:19], s38 offen sc1
  s_add_u32 s38, s39, 4096
  buffer_load_dwordx4 v[120:123], v6, s[16:19], s38 offen sc1
  buffer_load_dwordx4 v[124:127], v7, s[16:19], s38 offen sc1
  buffer_load_dwordx4 v[128:131], v8, s[16:19], s38 offen sc1
  s_add_u32 s38, s39, 6144
  buffer_load_dwordx4 v[132:135], v6, s[16:19], s38 offen sc1
  buffer_load_dwordx4 v[136:139], v7, s[16:19], s38 offen sc1
  buffer_load_dwordx4 v[140:143], v8, s[16:19], s38 offen sc1
  s_add_u32 s38, s39, 8192
  buffer_load_dwordx4 v[144:147], v6, s[16:19], s38 offen sc1
  buffer_load_dwordx4 v[148:151], v7, s[16:19], s38 offen sc1
  buffer_load_dwordx4 v[152:155], v8, s[16:19], s38 offen sc1
  s_mov_b32 s37, 0
  ds_read_b128 v[16:19], v4 offset:0
  ds_read_b128 v[20:23], v4 offset:4096
  ds_read_b128 v[24:27], v4 offset:8192
  ds_read_b128 v[28:31], v4 offset:12288
F2_GLOOP:
  s_lshl_b32 s40, s37, 1
  s_add_u32 s40, s40, 5
  s_lshl_b32 s38, s40, 11
  s_add_u32 s38, s38, s39
  s_cmp_lt_u32 s40, 32
  s_cselect_b32 s38, s38, 0x80000000
  s_waitcnt vmcnt(12) lgkmcnt(0)
  v_mfma_f32_16x16x32_bf16 v[48:51], v[96:99], v[16:19], v[48:51]
  ds_read_b128 v[32:35], v5 offset:0
  v_mfma_f32_16x16x32_bf16 v[64:67], v[100:103], v[16:19], v[64:67]
  ds_read_b128 v[36:39], v5 offset:4096
  v_mfma_f32_16x16x32_bf16 v[80:83], v[104:107], v[16:19], v[80:83]
  ds_read_b128 v[40:43], v5 offset:8192
  v_mfma_f32_16x16x32_bf16 v[52:55], v[96:99], v[20:23], v[52:55]
  ds_read_b128 v[44:47], v5 offset:12288
  v_mfma_f32_16x16x32_bf16 v[68:71], v[100:103], v[20:23], v[68:71]
  buffer_load_dwordx4 v[156:159], v6, s[16:19], s38 offen sc1
  v_mfma_f32_16x16x32_bf16 v[84:87], v[104:107], v[20:23], v[84:87]
  v_mfma_f32_16x16x32_bf16 v[56:59], v[96:99], v[24:27], v[56:59]
  buffer_load_dwordx4 v[160:163], v7, s[16:19], s38 offen sc1
  v_mfma_f32_16x16x32_bf16 v[72:75], v[100:103], v[24:27], v[72:75]
  v_mfma_f32_16x16x32_bf16 v[88:91], v[104:107], v[24:27], v[88:91]
  buffer_load_dwordx4 v[164:167], v8, s[16:19], s38 offen sc1
  v_mfma_f32_16x16x32_bf16 v[60:63], v[96:99], v[28:31], v[60:63]
  v_mfma_f32_16x16x32_bf16 v[76:79], v[100:103], v[28:31], v[76:79]
  v_mfma_f32_16x16x32_bf16 v[92:95], v[104:107], v[28:31], v[92:95]
  s_and_b32 s40, s37, 3
  s_movk_i32 s43, 16384
  s_cmp_eq_u32 s40, 3
  s_cselect_b32 s43, 4294918144, s43
  s_lshl_b32 s40, s37, 1
  s_add_u32 s40, s40, 6
  s_lshl_b32 s38, s40, 11
  s_add_u32 s38, s38, s39
  s_cmp_lt_u32 s40, 32
  s_cselect_b32 s38, s38, 0x80000000
  s_waitcnt lgkmcnt(0)
  s_barrier
  v_add_u32 v4, s43, v4
  s_waitcnt vmcnt(12)
  v_mfma_f32_16x16x32_bf16 v[48:51], v[108:111], v[32:35], v[48:51]
  ds_read_b128 v[16:19], v4 offset:0
  v_mfma_f32_16x16x32_bf16 v[64:67], v[112:115], v[32:35], v[64:67]
  ds_read_b128 v[20:23], v4 offset:4096
  v_mfma_f32_16x16x32_bf16 v[80:83], v[116:119], v[32:35], v[80:83]
  ds_read_b128 v[24:27], v4 offset:8192
  v_mfma_f32_16x16x32_bf16 v[52:55], v[108:111], v[36:39], v[52:55]
  ds_read_b128 v[28:31], v4 offset:12288
  v_mfma_f32_16x16x32_bf16 v[68:71], v[112:115], v[36:39], v[68:71]
  buffer_load_dwordx4 v[96:99], v6, s[16:19], s38 offen sc1
  v_mfma_f32_16x16x32_bf16 v[84:87], v[116:119], v[36:39], v[84:87]
  v_mfma_f32_16x16x32_bf16 v[56:59], v[108:111], v[40:43], v[56:59]
  buffer_load_dwordx4 v[100:103], v7, s[16:19], s38 offen sc1
  v_mfma_f32_16x16x32_bf16 v[72:75], v[112:115], v[40:43], v[72:75]
  v_mfma_f32_16x16x32_bf16 v[88:91], v[116:119], v[40:43], v[88:91]
  buffer_load_dwordx4 v[104:107], v8, s[16:19], s38 offen sc1
  v_mfma_f32_16x16x32_bf16 v[60:63], v[108:111], v[44:47], v[60:63]
  v_mfma_f32_16x16x32_bf16 v[76:79], v[112:115], v[44:47], v[76:79]
  v_mfma_f32_16x16x32_bf16 v[92:95], v[116:119], v[44:47], v[92:95]
  v_add_u32 v5, s43, v5
  s_add_u32 s37, s37, 1
  s_cmp_eq_u32 s37, 16
  s_cbranch_scc1 F2_GDONE
  s_lshl_b32 s40, s37, 1
  s_add_u32 s40, s40, 5
  s_lshl_b32 s38, s40, 11
  s_add_u32 s38, s38, s39
  s_cmp_lt_u32 s40, 32
  s_cselect_b32 s38, s38, 0x80000000
  s_waitcnt vmcnt(12) lgkmcnt(0)
  v_mfma_f32_16x16x32_bf16 v[48:51], v[120:123], v[16:19], v[48:51]
  ds_read_b128 v[32:35], v5 offset:0
  v_mfma_f32_16x16x32_bf16 v[64:67], v[124:127], v[16:19], v[64:67]
  ds_read_b128 v[36:39], v5 offset:4096
  v_mfma_f32_16x16x32_bf16 v[80:83], v[128:131], v[16:19], v[80:83]
  ds_read_b128 v[40:43], v5 offset:8192
  v_mfma_f32_16x16x32_bf16 v[52:55], v[120:123], v[20:23], v[52:55]
  ds_read_b128 v[44:47], v5 offset:12288
  v_mfma_f32_16x16x32_bf16 v[68:71], v[124:127], v[20:23], v[68:71]
  buffer_load_dwordx4 v[108:111], v6, s[16:19], s38 offen sc1
  v_mfma_f32_16x16x32_bf16 v[84:87], v[128:131], v[20:23], v[84:87]
  v_mfma_f32_16x16x32_bf16 v[56:59], v[120:123], v[24:27], v[56:59]
  buffer_load_dwordx4 v[112:115], v7, s[16:19], s38 offen sc1
  v_mfma_f32_16x16x32_bf16 v[72:75], v[124:127], v[24:27], v[72:75]
  v_mfma_f32_16x16x32_bf16 v[88:91], v[128:131], v[24:27], v[88:91]
  buffer_load_dwordx4 v[116:119], v8, s[16:19], s38 offen sc1
  v_mfma_f32_16x16x32_bf16 v[60:63], v[120:123], v[28:31], v[60:63]
  v_mfma_f32_16x16x32_bf16 v[76:79], v[124:127], v[28:31], v[76:79]
  v_mfma_f32_16x16x32_bf16 v[92:95], v[128:131], v[28:31], v[92:95]
  s_and_b32 s40, s37, 3
  s_movk_i32 s43, 16384
  s_cmp_eq_u32 s40, 3
  s_cselect_b32 s43, 4294918144, s43
  s_lshl_b32 s40, s37, 1
  s_add_u32 s40, s40, 6
  s_lshl_b32 s38, s40, 11
  s_add_u32 s38, s38, s39
  s_cmp_lt_u32 s40, 32
  s_cselect_b32 s38, s38, 0x80000000
  s_waitcnt lgkmcnt(0)
  s_barrier
  v_add_u32 v4, s43, v4
  s_waitcnt vmcnt(12)
  v_mfma_f32_16x16x32_bf16 v[48:51], v[132:135], v[32:35], v[48:51]
  ds_read_b128 v[16:19], v4 offset:0
  v_mfma_f32_16x16x32_bf16 v[64:67], v[136:139], v[32:35], v[64:67]
  ds_read_b128 v[20:23], v4 offset:4096
  v_mfma_f32_16x16x32_bf16 v[80:83], v[140:143], v[32:35], v[80:83]
  ds_read_b128 v[24:27], v4 offset:8192
  v_mfma_f32_16x16x32_bf16 v[52:55], v[132:135], v[36:39], v[52:55]
  ds_read_b128 v[28:31], v4 offset:12288
  v_mfma_f32_16x16x32_bf16 v[68:71], v[136:139], v[36:39], v[68:71]
  buffer_load_dwordx4 v[120:123], v6, s[16:19], s38 offen sc1
  v_mfma_f32_16x16x32_bf16 v[84:87], v[140:143], v[36:39], v[84:87]
  v_mfma_f32_16x16x32_bf16 v[56:59], v[132:135], v[40:43], v[56:59]
  buffer_load_dwordx4 v[124:127], v7, s[16:19], s38 offen sc1
  v_mfma_f32_16x16x32_bf16 v[72:75], v[136:139], v[40:43], v[72:75]
  v_mfma_f32_16x16x32_bf16 v[88:91], v[140:143], v[40:43], v[88:91]
  buffer_load_dwordx4 v[128:131], v8, s[16:19], s38 offen sc1
  v_mfma_f32_16x16x32_bf16 v[60:63], v[132:135], v[44:47], v[60:63]
  v_mfma_f32_16x16x32_bf16 v[76:79], v[136:139], v[44:47], v[76:79]
  v_mfma_f32_16x16x32_bf16 v[92:95], v[140:143], v[44:47], v[92:95]
  v_add_u32 v5, s43, v5
  s_add_u32 s37, s37, 1
  s_cmp_eq_u32 s37, 16
  s_cbranch_scc1 F2_GDONE
  s_lshl_b32 s40, s37, 1
  s_add_u32 s40, s40, 5
  s_lshl_b32 s38, s40, 11
  s_add_u32 s38, s38, s39
  s_cmp_lt_u32 s40, 32
  s_cselect_b32 s38, s38, 0x80000000
  s_waitcnt vmcnt(12) lgkmcnt(0)
  v_mfma_f32_16x16x32_bf16 v[48:51], v[144:147], v[16:19], v[48:51]
  ds_read_b128 v[32:35], v5 offset:0
  v_mfma_f32_16x16x32_bf16 v[64:67], v[148:151], v[16:19], v[64:67]
  ds_read_b128 v[36:39], v5 offset:4096
  v_mfma_f32_16x16x32_bf16 v[80:83], v[152:155], v[16:19], v[80:83]
  ds_read_b128 v[40:43], v5 offset:8192
  v_mfma_f32_16x16x32_bf16 v[52:55], v[144:147], v[20:23], v[52:55]
  ds_read_b128 v[44:47], v5 offset:12288
  v_mfma_f32_16x16x32_bf16 v[68:71], v[148:151], v[20:23], v[68:71]
  buffer_load_dwordx4 v[132:135], v6, s[16:19], s38 offen sc1
  v_mfma_f32_16x16x32_bf16 v[84:87], v[152:155], v[20:23], v[84:87]
  v_mfma_f32_16x16x32_bf16 v[56:59], v[144:147], v[24:27], v[56:59]
  buffer_load_dwordx4 v[136:139], v7, s[16:19], s38 offen sc1
  v_mfma_f32_16x16x32_bf16 v[72:75], v[148:151], v[24:27], v[72:75]
  v_mfma_f32_16x16x32_bf16 v[88:91], v[152:155], v[24:27], v[88:91]
  buffer_load_dwordx4 v[140:143], v8, s[16:19], s38 offen sc1
  v_mfma_f32_16x16x32_bf16 v[60:63], v[144:147], v[28:31], v[60:63]
  v_mfma_f32_16x16x32_bf16 v[76:79], v[148:151], v[28:31], v[76:79]
  v_mfma_f32_16x16x32_bf16 v[92:95], v[152:155], v[28:31], v[92:95]
  s_and_b32 s40, s37, 3
  s_movk_i32 s43, 16384
  s_cmp_eq_u32 s40, 3
  s_cselect_b32 s43, 4294918144, s43
  s_lshl_b32 s40, s37, 1
  s_add_u32 s40, s40, 6
  s_lshl_b32 s38, s40, 11
  s_add_u32 s38, s38, s39
  s_cmp_lt_u32 s40, 32
  s_cselect_b32 s38, s38, 0x80000000
  s_waitcnt lgkmcnt(0)
  s_barrier
  v_add_u32 v4, s43, v4
  s_waitcnt vmcnt(12)
  v_mfma_f32_16x16x32_bf16 v[48:51], v[156:159], v[32:35], v[48:51]
  ds_read_b128 v[16:19], v4 offset:0
  v_mfma_f32_16x16x32_bf16 v[64:67], v[160:163], v[32:35], v[64:67]
  ds_read_b128 v[20:23], v4 offset:4096
  v_mfma_f32_16x16x32_bf16 v[80:83], v[164:167], v[32:35], v[80:83]
  ds_read_b128 v[24:27], v4 offset:8192
  v_mfma_f32_16x16x32_bf16 v[52:55], v[156:159], v[36:39], v[52:55]
  ds_read_b128 v[28:31], v4 offset:12288
  v_mfma_f32_16x16x32_bf16 v[68:71], v[160:163], v[36:39], v[68:71]
  buffer_load_dwordx4 v[144:147], v6, s[16:19], s38 offen sc1
  v_mfma_f32_16x16x32_bf16 v[84:87], v[164:167], v[36:39], v[84:87]
  v_mfma_f32_16x16x32_bf16 v[56:59], v[156:159], v[40:43], v[56:59]
  buffer_load_dwordx4 v[148:151], v7, s[16:19], s38 offen sc1
  v_mfma_f32_16x16x32_bf16 v[72:75], v[160:163], v[40:43], v[72:75]
  v_mfma_f32_16x16x32_bf16 v[88:91], v[164:167], v[40:43], v[88:91]
  buffer_load_dwordx4 v[152:155], v8, s[16:19], s38 offen sc1
  v_mfma_f32_16x16x32_bf16 v[60:63], v[156:159], v[44:47], v[60:63]
  v_mfma_f32_16x16x32_bf16 v[76:79], v[160:163], v[44:47], v[76:79]
  v_mfma_f32_16x16x32_bf16 v[92:95], v[164:167], v[44:47], v[92:95]
  v_add_u32 v5, s43, v5
  s_add_u32 s37, s37, 1
  s_cmp_eq_u32 s37, 16
  s_cbranch_scc0 F2_GLOOP
F2_GDONE:
  s_lshl_b32 s40, s32, 2
  s_add_u32 s45, s40, s34
  v_lshlrev_b32 v10, 1, v3
  s_lshl_b32 s40, s45, 5
  buffer_load_ushort v15, v10, s[12:15], s40 offen
  s_waitcnt lgkmcnt(0)
  s_barrier
  s_mul_i32 s40, s34, 3072
  v_lshlrev_b32 v9, 4, v1
  v_add_u32 v10, s40, v9
  ds_write_b128 v10, v[48:51] offset:0
  ds_write_b128 v10, v[64:67] offset:1024
  ds_write_b128 v10, v[80:83] offset:2048
  ds_write_b128 v10, v[52:55] offset:12288
  ds_write_b128 v10, v[68:71] offset:13312
  ds_write_b128 v10, v[84:87] offset:14336
  s_waitcnt lgkmcnt(6)
  ds_write_b128 v10, v[56:59] offset:24576
  ds_write_b128 v10, v[72:75] offset:25600
  ds_write_b128 v10, v[88:91] offset:26624
  ds_write_b128 v10, v[60:63] offset:36864
  ds_write_b128 v10, v[76:79] offset:37888
  ds_write_b128 v10, v[92:95] offset:38912
  s_waitcnt lgkmcnt(6)
  s_waitcnt lgkmcnt(0)
  s_barrier
  s_mul_i32 s40, s34, 12288
  v_add_u32 v10, s40, v9
  ds_read_b128 v[16:19], v10 offset:0
  ds_read_b128 v[20:23], v10 offset:1024
  ds_read_b128 v[24:27], v10 offset:2048
  ds_read_b128 v[28:31], v10 offset:3072
  ds_read_b128 v[32:35], v10 offset:4096
  ds_read_b128 v[36:39], v10 offset:5120
  ds_read_b128 v[40:43], v10 offset:6144
  ds_read_b128 v[44:47], v10 offset:7168
  ds_read_b128 v[48:51], v10 offset:8192
  s_waitcnt lgkmcnt(6)
  ds_read_b128 v[52:55], v10 offset:9216
  ds_read_b128 v[56:59], v10 offset:10240
  ds_read_b128 v[60:63], v10 offset:11264
  s_mul_i32 s40, s34, 3072
  s_add_u32 s40, s40, 147456
  v_lshlrev_b32 v11, 3, v1
  v_add_u32 v11, s40, v11
  s_waitcnt lgkmcnt(6)
  ds_read_b64 v[64:65], v11 offset:0
  ds_read_b64 v[66:67], v11 offset:512
  ds_read_b64 v[68:69], v11 offset:1024
  ds_read_b64 v[70:71], v11 offset:1536
  ds_read_b64 v[72:73], v11 offset:2048
  ds_read_b64 v[74:75], v11 offset:2560
  s_waitcnt vmcnt(0)
  v_lshlrev_b32 v15, 16, v15
  s_mul_i32 s40, s45, 24576
  s_mul_i32 s41, s33, 3072
  s_add_u32 s40, s40, s41
  s_add_u32 s40, s40, 12582912
  s_waitcnt lgkmcnt(0)
  v_add_f32 v16, v16, v40
  v_add_f32 v17, v17, v41
  v_add_f32 v18, v18, v42
  v_add_f32 v19, v19, v43
  v_add_f32 v16, v16, v15
  v_add_f32 v17, v17, v15
  v_add_f32 v18, v18, v15
  v_add_f32 v19, v19, v15
  v_lshlrev_b32 v88, 16, v64
  v_and_b32 v89, s47, v64
  v_lshlrev_b32 v90, 16, v65
  v_and_b32 v91, s47, v65
  v_mul_f32 v16, v16, v88
  v_mul_f32 v17, v17, v89
  v_mul_f32 v18, v18, v90
  v_mul_f32 v19, v19, v91
  v_cvt_pk_bf16_f32 v76, v16, v17
  v_cvt_pk_bf16_f32 v77, v18, v19
  v_add_f32 v20, v20, v44
  v_add_f32 v21, v21, v45
  v_add_f32 v22, v22, v46
  v_add_f32 v23, v23, v47
  v_add_f32 v20, v20, v15
  v_add_f32 v21, v21, v15
  v_add_f32 v22, v22, v15
  v_add_f32 v23, v23, v15
  v_lshlrev_b32 v88, 16, v66
  v_and_b32 v89, s47, v66
  v_lshlrev_b32 v90, 16, v67
  v_and_b32 v91, s47, v67
  v_mul_f32 v20, v20, v88
  v_mul_f32 v21, v21, v89
  v_mul_f32 v22, v22, v90
  v_mul_f32 v23, v23, v91
  v_cvt_pk_bf16_f32 v78, v20, v21
  v_cvt_pk_bf16_f32 v79, v22, v23
  buffer_store_dwordx4 v[76:79], v9, s[16:19], s40 offen offset:0 sc1
  v_add_f32 v24, v24, v48
  v_add_f32 v25, v25, v49
  v_add_f32 v26, v26, v50
  v_add_f32 v27, v27, v51
  v_add_f32 v24, v24, v15
  v_add_f32 v25, v25, v15
  v_add_f32 v26, v26, v15
  v_add_f32 v27, v27, v15
  v_lshlrev_b32 v88, 16, v68
  v_and_b32 v89, s47, v68
  v_lshlrev_b32 v90, 16, v69
  v_and_b32 v91, s47, v69
  v_mul_f32 v24, v24, v88
  v_mul_f32 v25, v25, v89
  v_mul_f32 v26, v26, v90
  v_mul_f32 v27, v27, v91
  v_cvt_pk_bf16_f32 v80, v24, v25
  v_cvt_pk_bf16_f32 v81, v26, v27
  v_add_f32 v28, v28, v52
  v_add_f32 v29, v29, v53
  v_add_f32 v30, v30, v54
  v_add_f32 v31, v31, v55
  v_add_f32 v28, v28, v15
  v_add_f32 v29, v29, v15
  v_add_f32 v30, v30, v15
  v_add_f32 v31, v31, v15
  v_lshlrev_b32 v88, 16, v70
  v_and_b32 v89, s47, v70
  v_lshlrev_b32 v90, 16, v71
  v_and_b32 v91, s47, v71
  v_mul_f32 v28, v28, v88
  v_mul_f32 v29, v29, v89
  v_mul_f32 v30, v30, v90
  v_mul_f32 v31, v31, v91
  v_cvt_pk_bf16_f32 v82, v28, v29
  v_cvt_pk_bf16_f32 v83, v30, v31
  buffer_store_dwordx4 v[80:83], v9, s[16:19], s40 offen offset:1024 sc1
  v_add_f32 v32, v32, v56
  v_add_f32 v33, v33, v57
  v_add_f32 v34, v34, v58
  v_add_f32 v35, v35, v59
  v_add_f32 v32, v32, v15
  v_add_f32 v33, v33, v15
  v_add_f32 v34, v34, v15
  v_add_f32 v35, v35, v15
  v_lshlrev_b32 v88, 16, v72
  v_and_b32 v89, s47, v72
  v_lshlrev_b32 v90, 16, v73
  v_and_b32 v91, s47, v73
  v_mul_f32 v32, v32, v88
  v_mul_f32 v33, v33, v89
  v_mul_f32 v34, v34, v90
  v_mul_f32 v35, v35, v91
  v_cvt_pk_bf16_f32 v84, v32, v33
  v_cvt_pk_bf16_f32 v85, v34, v35
  v_add_f32 v36, v36, v60
  v_add_f32 v37, v37, v61
  v_add_f32 v38, v38, v62
  v_add_f32 v39, v39, v63
  v_add_f32 v36, v36, v15
  v_add_f32 v37, v37, v15
  v_add_f32 v38, v38, v15
  v_add_f32 v39, v39, v15
  v_lshlrev_b32 v88, 16, v74
  v_and_b32 v89, s47, v74
  v_lshlrev_b32 v90, 16, v75
  v_and_b32 v91, s47, v75
  v_mul_f32 v36, v36, v88
  v_mul_f32 v37, v37, v89
  v_mul_f32 v38, v38, v90
  v_mul_f32 v39, v39, v91
  v_cvt_pk_bf16_f32 v86, v36, v37
  v_cvt_pk_bf16_f32 v87, v38, v39
  buffer_store_dwordx4 v[84:87], v9, s[16:19], s40 offen offset:2048 sc1
  s_waitcnt vmcnt(0)
  s_barrier
  s_load_dwordx2 s[56:57], s[0:1], 0
  s_load_dwordx2 s[58:59], s[0:1], 88
  v_lshlrev_b32 v4, 4, v1
  s_lshl_b32 s35, s32, 2
  s_add_u32 s35, s35, s34
  s_mul_i32 s36, s35, 24576
  s_add_u32 s36, s36, 12582912
  s_lshl_b32 s40, s35, 4
  s_mul_i32 s40, s40, 1280
  s_mul_i32 s41, s33, 160
  s_add_u32 s40, s40, s41
  v_add_u32 v12, 0, v1
  v_mul_u32_u24 v13, 6554, v12
  v_lshrrev_b32 v13, 16, v13
  v_mul_u32_u24 v14, 10, v13
  v_sub_u32 v14, v12, v14
  v_lshlrev_b32 v14, 4, v14
  v_mul_u32_u24 v13, 1280, v13
  v_add_u32 v13, v13, v14
  v_add_u32 v5, s40, v13
  v_lshrrev_b32 v13, 1, v12
  v_lshlrev_b32 v13, 12, v13
  v_and_b32 v14, 1, v12
  v_lshlrev_b32 v14, 4, v14
  v_add_u32 v8, v13, v14
  v_add_u32 v12, 64, v1
  v_mul_u32_u24 v13, 6554, v12
  v_lshrrev_b32 v13, 16, v13
  v_mul_u32_u24 v14, 10, v13
  v_sub_u32 v14, v12, v14
  v_lshlrev_b32 v14, 4, v14
  v_mul_u32_u24 v13, 1280, v13
  v_add_u32 v13, v13, v14
  v_add_u32 v6, s40, v13
  v_lshrrev_b32 v13, 1, v12
  v_lshlrev_b32 v13, 12, v13
  v_and_b32 v14, 1, v12
  v_lshlrev_b32 v14, 4, v14
  v_add_u32 v9, v13, v14
  v_add_u32 v12, 128, v1
  v_mul_u32_u24 v13, 6554, v12
  v_lshrrev_b32 v13, 16, v13
  v_mul_u32_u24 v14, 10, v13
  v_sub_u32 v14, v12, v14
  v_lshlrev_b32 v14, 4, v14
  v_mul_u32_u24 v13, 1280, v13
  v_add_u32 v13, v13, v14
  v_add_u32 v7, s40, v13
  v_lshrrev_b32 v13, 1, v12
  v_lshlrev_b32 v13, 12, v13
  v_and_b32 v14, 1, v12
  v_lshlrev_b32 v14, 4, v14
  v_add_u32 v10, v13, v14
  s_mul_i32 s37, s34, 2560
  s_mul_i32 s38, s33, 327680
  s_lshl_b32 s41, s35, 5
  s_add_u32 s38, s38, s41
  s_add_u32 s38, s38, 9437184
  v_lshlrev_b32 v21, 3, v3
  s_lshl_b32 s39, s35, 7
  s_add_u32 s39, s39, 16777216
  v_add_u32 v20, 65536, v4
  s_waitcnt lgkmcnt(0)
  s_mov_b32 s8, s56
  s_and_b32 s9, s57, 0xffff
  s_mov_b32 s10, 2621440
  s_mov_b32 s11, 0x20000
  s_mov_b32 s12, s58
  s_and_b32 s13, s59, 0xffff
  s_mov_b32 s14, 2621440
  s_mov_b32 s15, 0x20000
  s_barrier
  s_add_u32 s40, s36, 0
  buffer_load_dwordx4 v[88:91], v4, s[16:19], s40 offen offset:0 sc1
  s_add_u32 s40, s36, 0
  buffer_load_dwordx4 v[92:95], v4, s[16:19], s40 offen offset:1024 sc1
  s_add_u32 s40, s36, 0
  buffer_load_dwordx4 v[96:99], v4, s[16:19], s40 offen offset:2048 sc1
  s_add_u32 s40, s36, 0
  buffer_load_dwordx4 v[100:103], v4, s[16:19], s40 offen offset:3072 sc1
  s_add_u32 s40, s36, 4096
  buffer_load_dwordx4 v[104:107], v4, s[16:19], s40 offen offset:0 sc1
  s_add_u32 s40, s36, 4096
  buffer_load_dwordx4 v[108:111], v4, s[16:19], s40 offen offset:1024 sc1
  s_add_u32 s40, s36, 4096
  buffer_load_dwordx4 v[112:115], v4, s[16:19], s40 offen offset:2048 sc1
  s_add_u32 s40, s36, 4096
  buffer_load_dwordx4 v[116:119], v4, s[16:19], s40 offen offset:3072 sc1
  s_add_u32 s40, s36, 8192
  buffer_load_dwordx4 v[120:123], v4, s[16:19], s40 offen offset:0 sc1
  s_add_u32 s40, s36, 8192
  buffer_load_dwordx4 v[124:127], v4, s[16:19], s40 offen offset:1024 sc1
  s_add_u32 s40, s36, 8192
  buffer_load_dwordx4 v[128:131], v4, s[16:19], s40 offen offset:2048 sc1
  s_add_u32 s40, s36, 8192
  buffer_load_dwordx4 v[132:135], v4, s[16:19], s40 offen offset:3072 sc1
  v_mov_b32 v68, 0
  v_mov_b32 v69, 0
  v_mov_b32 v70, 0
  v_mov_b32 v71, 0
  v_mov_b32 v72, 0
  v_mov_b32 v73, 0
  v_mov_b32 v74, 0
  v_mov_b32 v75, 0
  v_mov_b32 v76, 0
  v_mov_b32 v77, 0
  v_mov_b32 v78, 0
  v_mov_b32 v79, 0
  v_mov_b32 v80, 0
  v_mov_b32 v81, 0
  v_mov_b32 v82, 0
  v_mov_b32 v83, 0
  v_mov_b32 v84, 0
  v_mov_b32 v85, 0
  v_mov_b32 v86, 0
  v_mov_b32 v87, 0
  s_barrier
  ds_read_b128 v[28:31], v4 offset:0
  ds_read_b128 v[32:35], v4 offset:1024
  ds_read_b128 v[36:39], v4 offset:2048
  ds_read_b128 v[40:43], v4 offset:3072
  ds_read_b128 v[44:47], v4 offset:4096
  s_waitcnt vmcnt(11) lgkmcnt(0)
  v_mfma_f32_16x16x32_bf16 v[68:71], v[28:31], v[88:91], v[68:71]
  ds_read_b128 v[48:51], v4 offset:5120
  v_mfma_f32_16x16x32_bf16 v[72:75], v[32:35], v[88:91], v[72:75]
  ds_read_b128 v[52:55], v4 offset:6144
  v_mfma_f32_16x16x32_bf16 v[76:79], v[36:39], v[88:91], v[76:79]
  ds_read_b128 v[56:59], v4 offset:7168
  v_mfma_f32_16x16x32_bf16 v[80:83], v[40:43], v[88:91], v[80:83]
  ds_read_b128 v[60:63], v4 offset:8192
  v_mfma_f32_16x16x32_bf16 v[84:87], v[44:47], v[88:91], v[84:87]
  ds_read_b128 v[64:67], v4 offset:9216
  s_add_u32 s40, s36, 12288
  buffer_load_dwordx4 v[88:91], v4, s[16:19], s40 offen offset:0 sc1
  s_waitcnt vmcnt(11) lgkmcnt(0)
  v_mfma_f32_16x16x32_bf16 v[68:71], v[48:51], v[92:95], v[68:71]
  ds_read_b128 v[28:31], v4 offset:10240
  v_mfma_f32_16x16x32_bf16 v[72:75], v[52:55], v[92:95], v[72:75]
  ds_read_b128 v[32:35], v4 offset:11264
  v_mfma_f32_16x16x32_bf16 v[76:79], v[56:59], v[92:95], v[76:79]
  ds_read_b128 v[36:39], v4 offset:12288
  v_mfma_f32_16x16x32_bf16 v[80:83], v[60:63], v[92:95], v[80:83]
  ds_read_b128 v[40:43], v4 offset:13312
  v_mfma_f32_16x16x32_bf16 v[84:87], v[64:67], v[92:95], v[84:87]
  ds_read_b128 v[44:47], v4 offset:14336
  s_add_u32 s40, s36, 12288
  buffer_load_dwordx4 v[92:95], v4, s[16:19], s40 offen offset:1024 sc1
  s_waitcnt vmcnt(11) lgkmcnt(0)
  v_mfma_f32_16x16x32_bf16 v[68:71], v[28:31], v[96:99], v[68:71]
  ds_read_b128 v[48:51], v4 offset:15360
  v_mfma_f32_16x16x32_bf16 v[72:75], v[32:35], v[96:99], v[72:75]
  ds_read_b128 v[52:55], v4 offset:16384
  v_mfma_f32_16x16x32_bf16 v[76:79], v[36:39], v[96:99], v[76:79]
  ds_read_b128 v[56:59], v4 offset:17408
  v_mfma_f32_16x16x32_bf16 v[80:83], v[40:43], v[96:99], v[80:83]
  ds_read_b128 v[60:63], v4 offset:18432
  v_mfma_f32_16x16x32_bf16 v[84:87], v[44:47], v[96:99], v[84:87]
  ds_read_b128 v[64:67], v4 offset:19456
  s_add_u32 s40, s36, 12288
  buffer_load_dwordx4 v[96:99], v4, s[16:19], s40 offen offset:2048 sc1
  s_waitcnt vmcnt(11) lgkmcnt(0)
  s_barrier
  v_mfma_f32_16x16x32_bf16 v[68:71], v[48:51], v[100:103], v[68:71]
  ds_read_b128 v[28:31], v4 offset:20480
  v_mfma_f32_16x16x32_bf16 v[72:75], v[52:55], v[100:103], v[72:75]
  ds_read_b128 v[32:35], v4 offset:21504
  v_mfma_f32_16x16x32_bf16 v[76:79], v[56:59], v[100:103], v[76:79]
  ds_read_b128 v[36:39], v4 offset:22528
  v_mfma_f32_16x16x32_bf16 v[80:83], v[60:63], v[100:103], v[80:83]
  ds_read_b128 v[40:43], v4 offset:23552
  v_mfma_f32_16x16x32_bf16 v[84:87], v[64:67], v[100:103], v[84:87]
  ds_read_b128 v[44:47], v4 offset:24576
  s_add_u32 s40, s36, 12288
  buffer_load_dwordx4 v[100:103], v4, s[16:19], s40 offen offset:3072 sc1
  s_waitcnt vmcnt(11) lgkmcnt(0)
  v_mfma_f32_16x16x32_bf16 v[68:71], v[28:31], v[104:107], v[68:71]
  ds_read_b128 v[48:51], v4 offset:25600
  v_mfma_f32_16x16x32_bf16 v[72:75], v[32:35], v[104:107], v[72:75]
  ds_read_b128 v[52:55], v4 offset:26624
  v_mfma_f32_16x16x32_bf16 v[76:79], v[36:39], v[104:107], v[76:79]
  ds_read_b128 v[56:59], v4 offset:27648
  v_mfma_f32_16x16x32_bf16 v[80:83], v[40:43], v[104:107], v[80:83]
  ds_read_b128 v[60:63], v4 offset:28672
  v_mfma_f32_16x16x32_bf16 v[84:87], v[44:47], v[104:107], v[84:87]
  ds_read_b128 v[64:67], v4 offset:29696
  s_add_u32 s40, s36, 16384
  buffer_load_dwordx4 v[104:107], v4, s[16:19], s40 offen offset:0 sc1
  s_waitcnt vmcnt(11) lgkmcnt(0)
  v_mfma_f32_16x16x32_bf16 v[68:71], v[48:51], v[108:111], v[68:71]
  ds_read_b128 v[28:31], v4 offset:30720
  v_mfma_f32_16x16x32_bf16 v[72:75], v[52:55], v[108:111], v[72:75]
  ds_read_b128 v[32:35], v4 offset:31744
  v_mfma_f32_16x16x32_bf16 v[76:79], v[56:59], v[108:111], v[76:79]
  ds_read_b128 v[36:39], v4 offset:32768
  v_mfma_f32_16x16x32_bf16 v[80:83], v[60:63], v[108:111], v[80:83]
  ds_read_b128 v[40:43], v4 offset:33792
  v_mfma_f32_16x16x32_bf16 v[84:87], v[64:67], v[108:111], v[84:87]
  ds_read_b128 v[44:47], v4 offset:34816
  s_add_u32 s40, s36, 16384
  buffer_load_dwordx4 v[108:111], v4, s[16:19], s40 offen offset:1024 sc1
  s_waitcnt vmcnt(11) lgkmcnt(0)
  v_mfma_f32_16x16x32_bf16 v[68:71], v[28:31], v[112:115], v[68:71]
  ds_read_b128 v[48:51], v4 offset:35840
  v_mfma_f32_16x16x32_bf16 v[72:75], v[32:35], v[112:115], v[72:75]
  ds_read_b128 v[52:55], v4 offset:36864
  v_mfma_f32_16x16x32_bf16 v[76:79], v[36:39], v[112:115], v[76:79]
  ds_read_b128 v[56:59], v4 offset:37888
  v_mfma_f32_16x16x32_bf16 v[80:83], v[40:43], v[112:115], v[80:83]
  ds_read_b128 v[60:63], v4 offset:38912
  v_mfma_f32_16x16x32_bf16 v[84:87], v[44:47], v[112:115], v[84:87]
  ds_read_b128 v[64:67], v4 offset:39936
  s_add_u32 s40, s36, 16384
  buffer_load_dwordx4 v[112:115], v4, s[16:19], s40 offen offset:2048 sc1
  s_waitcnt vmcnt(11) lgkmcnt(0)
  s_barrier
  v_mfma_f32_16x16x32_bf16 v[68:71], v[48:51], v[116:119], v[68:71]
  ds_read_b128 v[28:31], v4 offset:40960
  v_mfma_f32_16x16x32_bf16 v[72:75], v[52:55], v[116:119], v[72:75]
  ds_read_b128 v[32:35], v4 offset:41984
  v_mfma_f32_16x16x32_bf16 v[76:79], v[56:59], v[116:119], v[76:79]
  ds_read_b128 v[36:39], v4 offset:43008
  v_mfma_f32_16x16x32_bf16 v[80:83], v[60:63], v[116:119], v[80:83]
  ds_read_b128 v[40:43], v4 offset:44032
  v_mfma_f32_16x16x32_bf16 v[84:87], v[64:67], v[116:119], v[84:87]
  ds_read_b128 v[44:47], v4 offset:45056
  s_add_u32 s40, s36, 16384
  buffer_load_dwordx4 v[116:119], v4, s[16:19], s40 offen offset:3072 sc1
  s_waitcnt vmcnt(11) lgkmcnt(0)
  v_mfma_f32_16x16x32_bf16 v[68:71], v[28:31], v[120:123], v[68:71]
  ds_read_b128 v[48:51], v4 offset:46080
  v_mfma_f32_16x16x32_bf16 v[72:75], v[32:35], v[120:123], v[72:75]
  ds_read_b128 v[52:55], v4 offset:47104
  v_mfma_f32_16x16x32_bf16 v[76:79], v[36:39], v[120:123], v[76:79]
  ds_read_b128 v[56:59], v4 offset:48128
  v_mfma_f32_16x16x32_bf16 v[80:83], v[40:43], v[120:123], v[80:83]
  ds_read_b128 v[60:63], v4 offset:49152
  v_mfma_f32_16x16x32_bf16 v[84:87], v[44:47], v[120:123], v[84:87]
  ds_read_b128 v[64:67], v4 offset:50176
  s_add_u32 s40, s36, 20480
  buffer_load_dwordx4 v[120:123], v4, s[16:19], s40 offen offset:0 sc1
  s_waitcnt vmcnt(11) lgkmcnt(0)
  v_mfma_f32_16x16x32_bf16 v[68:71], v[48:51], v[124:127], v[68:71]
  ds_read_b128 v[28:31], v4 offset:51200
  v_mfma_f32_16x16x32_bf16 v[72:75], v[52:55], v[124:127], v[72:75]
  ds_read_b128 v[32:35], v4 offset:52224
  v_mfma_f32_16x16x32_bf16 v[76:79], v[56:59], v[124:127], v[76:79]
  ds_read_b128 v[36:39], v4 offset:53248
  v_mfma_f32_16x16x32_bf16 v[80:83], v[60:63], v[124:127], v[80:83]
  ds_read_b128 v[40:43], v4 offset:54272
  v_mfma_f32_16x16x32_bf16 v[84:87], v[64:67], v[124:127], v[84:87]
  ds_read_b128 v[44:47], v4 offset:55296
  s_add_u32 s40, s36, 20480
  buffer_load_dwordx4 v[124:127], v4, s[16:19], s40 offen offset:1024 sc1
  s_waitcnt vmcnt(11) lgkmcnt(0)
  v_mfma_f32_16x16x32_bf16 v[68:71], v[28:31], v[128:131], v[68:71]
  ds_read_b128 v[48:51], v4 offset:56320
  v_mfma_f32_16x16x32_bf16 v[72:75], v[32:35], v[128:131], v[72:75]
  ds_read_b128 v[52:55], v4 offset:57344
  v_mfma_f32_16x16x32_bf16 v[76:79], v[36:39], v[128:131], v[76:79]
  ds_read_b128 v[56:59], v4 offset:58368
  v_mfma_f32_16x16x32_bf16 v[80:83], v[40:43], v[128:131], v[80:83]
  ds_read_b128 v[60:63], v4 offset:59392
  v_mfma_f32_16x16x32_bf16 v[84:87], v[44:47], v[128:131], v[84:87]
  ds_read_b128 v[64:67], v4 offset:60416
  s_add_u32 s40, s36, 20480
  buffer_load_dwordx4 v[128:131], v4, s[16:19], s40 offen offset:2048 sc1
  s_waitcnt vmcnt(11) lgkmcnt(0)
  s_barrier
  v_mfma_f32_16x16x32_bf16 v[68:71], v[48:51], v[132:135], v[68:71]
  ds_read_b128 v[28:31], v4 offset:61440
  v_mfma_f32_16x16x32_bf16 v[72:75], v[52:55], v[132:135], v[72:75]
  ds_read_b128 v[32:35], v4 offset:62464
  v_mfma_f32_16x16x32_bf16 v[76:79], v[56:59], v[132:135], v[76:79]
  ds_read_b128 v[36:39], v4 offset:63488
  v_mfma_f32_16x16x32_bf16 v[80:83], v[60:63], v[132:135], v[80:83]
  ds_read_b128 v[40:43], v4 offset:64512
  v_mfma_f32_16x16x32_bf16 v[84:87], v[64:67], v[132:135], v[84:87]
  ds_read_b128 v[44:47], v20 offset:0
  s_add_u32 s40, s36, 20480
  buffer_load_dwordx4 v[132:135], v4, s[16:19], s40 offen offset:3072 sc1
  s_waitcnt vmcnt(11) lgkmcnt(0)
  v_mfma_f32_16x16x32_bf16 v[68:71], v[28:31], v[88:91], v[68:71]
  ds_read_b128 v[48:51], v20 offset:1024
  v_mfma_f32_16x16x32_bf16 v[72:75], v[32:35], v[88:91], v[72:75]
  ds_read_b128 v[52:55], v20 offset:2048
  v_mfma_f32_16x16x32_bf16 v[76:79], v[36:39], v[88:91], v[76:79]
  ds_read_b128 v[56:59], v20 offset:3072
  v_mfma_f32_16x16x32_bf16 v[80:83], v[40:43], v[88:91], v[80:83]
  ds_read_b128 v[60:63], v20 offset:4096
  v_mfma_f32_16x16x32_bf16 v[84:87], v[44:47], v[88:91], v[84:87]
  ds_read_b128 v[64:67], v20 offset:5120
  s_add_u32 m0, s37, 122880
  s_nop 0
  buffer_load_dwordx4 v5, s[8:11], 0 offen lds
  s_waitcnt vmcnt(11) lgkmcnt(0)
  v_mfma_f32_16x16x32_bf16 v[68:71], v[48:51], v[92:95], v[68:71]
  ds_read_b128 v[28:31], v20 offset:6144
  v_mfma_f32_16x16x32_bf16 v[72:75], v[52:55], v[92:95], v[72:75]
  ds_read_b128 v[32:35], v20 offset:7168
  v_mfma_f32_16x16x32_bf16 v[76:79], v[56:59], v[92:95], v[76:79]
  ds_read_b128 v[36:39], v20 offset:8192
  v_mfma_f32_16x16x32_bf16 v[80:83], v[60:63], v[92:95], v[80:83]
  ds_read_b128 v[40:43], v20 offset:9216
  v_mfma_f32_16x16x32_bf16 v[84:87], v[64:67], v[92:95], v[84:87]
  ds_read_b128 v[44:47], v20 offset:10240
  s_add_u32 m0, s37, 133120
  s_nop 0
  buffer_load_dwordx4 v8, s[16:19], s38 offen sc1 lds
  s_waitcnt vmcnt(11) lgkmcnt(0)
  v_mfma_f32_16x16x32_bf16 v[68:71], v[28:31], v[96:99], v[68:71]
  ds_read_b128 v[48:51], v20 offset:11264
  v_mfma_f32_16x16x32_bf16 v[72:75], v[32:35], v[96:99], v[72:75]
  ds_read_b128 v[52:55], v20 offset:12288
  v_mfma_f32_16x16x32_bf16 v[76:79], v[36:39], v[96:99], v[76:79]
  ds_read_b128 v[56:59], v20 offset:13312
  v_mfma_f32_16x16x32_bf16 v[80:83], v[40:43], v[96:99], v[80:83]
  ds_read_b128 v[60:63], v20 offset:14336
  v_mfma_f32_16x16x32_bf16 v[84:87], v[44:47], v[96:99], v[84:87]
  ds_read_b128 v[64:67], v20 offset:15360
  s_add_u32 m0, s37, 123904
  s_nop 0
  buffer_load_dwordx4 v6, s[8:11], 0 offen lds
  s_waitcnt vmcnt(11) lgkmcnt(0)
  s_barrier
  v_mfma_f32_16x16x32_bf16 v[68:71], v[48:51], v[100:103], v[68:71]
  ds_read_b128 v[28:31], v20 offset:16384
  v_mfma_f32_16x16x32_bf16 v[72:75], v[52:55], v[100:103], v[72:75]
  ds_read_b128 v[32:35], v20 offset:17408
  v_mfma_f32_16x16x32_bf16 v[76:79], v[56:59], v[100:103], v[76:79]
  ds_read_b128 v[36:39], v20 offset:18432
  v_mfma_f32_16x16x32_bf16 v[80:83], v[60:63], v[100:103], v[80:83]
  ds_read_b128 v[40:43], v20 offset:19456
  v_mfma_f32_16x16x32_bf16 v[84:87], v[64:67], v[100:103], v[84:87]
  ds_read_b128 v[44:47], v20 offset:20480
  s_add_u32 m0, s37, 134144
  s_nop 0
  buffer_load_dwordx4 v9, s[16:19], s38 offen sc1 lds
  s_waitcnt vmcnt(11) lgkmcnt(0)
  v_mfma_f32_16x16x32_bf16 v[68:71], v[28:31], v[104:107], v[68:71]
  ds_read_b128 v[48:51], v20 offset:21504
  v_mfma_f32_16x16x32_bf16 v[72:75], v[32:35], v[104:107], v[72:75]
  ds_read_b128 v[52:55], v20 offset:22528
  v_mfma_f32_16x16x32_bf16 v[76:79], v[36:39], v[104:107], v[76:79]
  ds_read_b128 v[56:59], v20 offset:23552
  v_mfma_f32_16x16x32_bf16 v[80:83], v[40:43], v[104:107], v[80:83]
  ds_read_b128 v[60:63], v20 offset:24576
  v_mfma_f32_16x16x32_bf16 v[84:87], v[44:47], v[104:107], v[84:87]
  ds_read_b128 v[64:67], v20 offset:25600
  s_mov_b32 exec_hi, 0
  s_add_u32 m0, s37, 124928
  s_nop 0
  buffer_load_dwordx4 v7, s[8:11], 0 offen lds
  s_mov_b32 exec_hi, -1
  s_waitcnt vmcnt(11) lgkmcnt(0)
  v_mfma_f32_16x16x32_bf16 v[68:71], v[48:51], v[108:111], v[68:71]
  ds_read_b128 v[28:31], v20 offset:26624
  v_mfma_f32_16x16x32_bf16 v[72:75], v[52:55], v[108:111], v[72:75]
  ds_read_b128 v[32:35], v20 offset:27648
  v_mfma_f32_16x16x32_bf16 v[76:79], v[56:59], v[108:111], v[76:79]
  ds_read_b128 v[36:39], v20 offset:28672
  v_mfma_f32_16x16x32_bf16 v[80:83], v[60:63], v[108:111], v[80:83]
  ds_read_b128 v[40:43], v20 offset:29696
  v_mfma_f32_16x16x32_bf16 v[84:87], v[64:67], v[108:111], v[84:87]
  ds_read_b128 v[44:47], v20 offset:30720
  s_mov_b32 exec_hi, 0
  s_add_u32 m0, s37, 135168
  s_nop 0
  buffer_load_dwordx4 v10, s[16:19], s38 offen sc1 lds
  s_mov_b32 exec_hi, -1
  s_waitcnt vmcnt(11) lgkmcnt(0)
  v_mfma_f32_16x16x32_bf16 v[68:71], v[28:31], v[112:115], v[68:71]
  ds_read_b128 v[48:51], v20 offset:31744
  v_mfma_f32_16x16x32_bf16 v[72:75], v[32:35], v[112:115], v[72:75]
  ds_read_b128 v[52:55], v20 offset:32768
  v_mfma_f32_16x16x32_bf16 v[76:79], v[36:39], v[112:115], v[76:79]
  ds_read_b128 v[56:59], v20 offset:33792
  v_mfma_f32_16x16x32_bf16 v[80:83], v[40:43], v[112:115], v[80:83]
  ds_read_b128 v[60:63], v20 offset:34816
  v_mfma_f32_16x16x32_bf16 v[84:87], v[44:47], v[112:115], v[84:87]
  ds_read_b128 v[64:67], v20 offset:35840
  buffer_load_dwordx2 v[24:25], v21, s[16:19], s39 offen sc1
  s_waitcnt vmcnt(11) lgkmcnt(0)
  s_barrier
  v_mfma_f32_16x16x32_bf16 v[68:71], v[48:51], v[116:119], v[68:71]
  ds_read_b128 v[28:31], v20 offset:36864
  v_mfma_f32_16x16x32_bf16 v[72:75], v[52:55], v[116:119], v[72:75]
  ds_read_b128 v[32:35], v20 offset:37888
  v_mfma_f32_16x16x32_bf16 v[76:79], v[56:59], v[116:119], v[76:79]
  ds_read_b128 v[36:39], v20 offset:38912
  v_mfma_f32_16x16x32_bf16 v[80:83], v[60:63], v[116:119], v[80:83]
  ds_read_b128 v[40:43], v20 offset:39936
  v_mfma_f32_16x16x32_bf16 v[84:87], v[64:67], v[116:119], v[84:87]
  ds_read_b128 v[44:47], v20 offset:40960
  s_waitcnt vmcnt(10) lgkmcnt(0)
  v_mfma_f32_16x16x32_bf16 v[68:71], v[28:31], v[120:123], v[68:71]
  ds_read_b128 v[48:51], v20 offset:41984
  v_mfma_f32_16x16x32_bf16 v[72:75], v[32:35], v[120:123], v[72:75]
  ds_read_b128 v[52:55], v20 offset:43008
  v_mfma_f32_16x16x32_bf16 v[76:79], v[36:39], v[120:123], v[76:79]
  ds_read_b128 v[56:59], v20 offset:44032
  v_mfma_f32_16x16x32_bf16 v[80:83], v[40:43], v[120:123], v[80:83]
  ds_read_b128 v[60:63], v20 offset:45056
  v_mfma_f32_16x16x32_bf16 v[84:87], v[44:47], v[120:123], v[84:87]
  ds_read_b128 v[64:67], v20 offset:46080
  s_waitcnt vmcnt(9) lgkmcnt(0)
  v_mfma_f32_16x16x32_bf16 v[68:71], v[48:51], v[124:127], v[68:71]
  ds_read_b128 v[28:31], v20 offset:47104
  v_mfma_f32_16x16x32_bf16 v[72:75], v[52:55], v[124:127], v[72:75]
  ds_read_b128 v[32:35], v20 offset:48128
  v_mfma_f32_16x16x32_bf16 v[76:79], v[56:59], v[124:127], v[76:79]
  ds_read_b128 v[36:39], v20 offset:49152
  v_mfma_f32_16x16x32_bf16 v[80:83], v[60:63], v[124:127], v[80:83]
  ds_read_b128 v[40:43], v20 offset:50176
  v_mfma_f32_16x16x32_bf16 v[84:87], v[64:67], v[124:127], v[84:87]
  ds_read_b128 v[44:47], v20 offset:51200
  s_waitcnt vmcnt(8) lgkmcnt(0)
  v_mfma_f32_16x16x32_bf16 v[68:71], v[28:31], v[128:131], v[68:71]
  ds_read_b128 v[48:51], v20 offset:52224
  v_mfma_f32_16x16x32_bf16 v[72:75], v[32:35], v[128:131], v[72:75]
  ds_read_b128 v[52:55], v20 offset:53248
  v_mfma_f32_16x16x32_bf16 v[76:79], v[36:39], v[128:131], v[76:79]
  ds_read_b128 v[56:59], v20 offset:54272
  v_mfma_f32_16x16x32_bf16 v[80:83], v[40:43], v[128:131], v[80:83]
  ds_read_b128 v[60:63], v20 offset:55296
  v_mfma_f32_16x16x32_bf16 v[84:87], v[44:47], v[128:131], v[84:87]
  ds_read_b128 v[64:67], v20 offset:56320
  s_waitcnt vmcnt(7) lgkmcnt(0)
  v_mfma_f32_16x16x32_bf16 v[68:71], v[48:51], v[132:135], v[68:71]
  v_mfma_f32_16x16x32_bf16 v[72:75], v[52:55], v[132:135], v[72:75]
  v_mfma_f32_16x16x32_bf16 v[76:79], v[56:59], v[132:135], v[76:79]
  v_mfma_f32_16x16x32_bf16 v[80:83], v[60:63], v[132:135], v[80:83]
  v_mfma_f32_16x16x32_bf16 v[84:87], v[64:67], v[132:135], v[84:87]
  s_waitcnt vmcnt(0)
  v_mul_u32_u24 v12, 160, v3
  v_lshlrev_b32 v13, 3, v2
  v_add_u32 v12, v12, v13
  s_add_u32 s40, s37, 122880
  v_add_u32 v12, s40, v12
  v_lshlrev_b32 v13, 7, v2
  v_lshlrev_b32 v14, 3, v3
  v_add_u32 v13, v13, v14
  s_add_u32 s40, s37, 133120
  v_add_u32 v13, s40, v13
  ds_read_b64 v[88:89], v12 offset:0
  ds_read_b64_tr_b16 v[98:99], v13 offset:0
  ds_read_b64 v[90:91], v12 offset:32
  ds_read_b64_tr_b16 v[100:101], v13 offset:512
  ds_read_b64 v[92:93], v12 offset:64
  ds_read_b64_tr_b16 v[102:103], v13 offset:1024
  ds_read_b64 v[94:95], v12 offset:96
  ds_read_b64_tr_b16 v[104:105], v13 offset:1536
  ds_read_b64 v[96:97], v12 offset:128
  ds_read_b64_tr_b16 v[106:107], v13 offset:2048
  v_sub_f32 v14, 0, v24
  v_mov_b32 v16, v25
  s_mov_b32 s48, 1.0
  s_mov_b32 s49, 1.0
  v_mov_b32 v18, 0xbfb8aa3b
  v_mov_b32 v19, 0xbfb8aa3b
  s_waitcnt lgkmcnt(0)
  v_lshlrev_b32 v108, 16, v88
  v_and_b32 v109, s47, v88
  v_lshlrev_b32 v110, 16, v98
  v_and_b32 v111, s47, v98
  v_pk_mul_f32 v[112:113], v[68:69], v[18:19]
  v_exp_f32 v112, v112
  v_exp_f32 v113, v113
  v_pk_add_f32 v[114:115], v[108:109], v[14:15] op_sel_hi:[1,0]
  v_pk_add_f32 v[112:113], v[112:113], s[48:49]
  v_pk_mul_f32 v[114:115], v[114:115], v[16:17] op_sel_hi:[1,0]
  v_rcp_f32 v112, v112
  v_rcp_f32 v113, v113
  v_pk_mul_f32 v[114:115], v[114:115], v[110:111]
  v_pk_mul_f32 v[112:113], v[112:113], v[68:69]
  v_pk_fma_f32 v[114:115], v[114:115], v[112:113], v[108:109]
  v_cvt_pk_bf16_f32 v88, v114, v115
  v_lshlrev_b32 v116, 16, v89
  v_and_b32 v117, s47, v89
  v_lshlrev_b32 v118, 16, v99
  v_and_b32 v119, s47, v99
  v_pk_mul_f32 v[120:121], v[70:71], v[18:19]
  v_exp_f32 v120, v120
  v_exp_f32 v121, v121
  v_pk_add_f32 v[122:123], v[116:117], v[14:15] op_sel_hi:[1,0]
  v_pk_add_f32 v[120:121], v[120:121], s[48:49]
  v_pk_mul_f32 v[122:123], v[122:123], v[16:17] op_sel_hi:[1,0]
  v_rcp_f32 v120, v120
  v_rcp_f32 v121, v121
  v_pk_mul_f32 v[122:123], v[122:123], v[118:119]
  v_pk_mul_f32 v[120:121], v[120:121], v[70:71]
  v_pk_fma_f32 v[122:123], v[122:123], v[120:121], v[116:117]
  v_cvt_pk_bf16_f32 v89, v122, v123
  ds_write_b64 v12, v[88:89] offset:0
  v_lshlrev_b32 v108, 16, v90
  v_and_b32 v109, s47, v90
  v_lshlrev_b32 v110, 16, v100
  v_and_b32 v111, s47, v100
  v_pk_mul_f32 v[112:113], v[72:73], v[18:19]
  v_exp_f32 v112, v112
  v_exp_f32 v113, v113
  v_pk_add_f32 v[114:115], v[108:109], v[14:15] op_sel_hi:[1,0]
  v_pk_add_f32 v[112:113], v[112:113], s[48:49]
  v_pk_mul_f32 v[114:115], v[114:115], v[16:17] op_sel_hi:[1,0]
  v_rcp_f32 v112, v112
  v_rcp_f32 v113, v113
  v_pk_mul_f32 v[114:115], v[114:115], v[110:111]
  v_pk_mul_f32 v[112:113], v[112:113], v[72:73]
  v_pk_fma_f32 v[114:115], v[114:115], v[112:113], v[108:109]
  v_cvt_pk_bf16_f32 v90, v114, v115
  v_lshlrev_b32 v116, 16, v91
  v_and_b32 v117, s47, v91
  v_lshlrev_b32 v118, 16, v101
  v_and_b32 v119, s47, v101
  v_pk_mul_f32 v[120:121], v[74:75], v[18:19]
  v_exp_f32 v120, v120
  v_exp_f32 v121, v121
  v_pk_add_f32 v[122:123], v[116:117], v[14:15] op_sel_hi:[1,0]
  v_pk_add_f32 v[120:121], v[120:121], s[48:49]
  v_pk_mul_f32 v[122:123], v[122:123], v[16:17] op_sel_hi:[1,0]
  v_rcp_f32 v120, v120
  v_rcp_f32 v121, v121
  v_pk_mul_f32 v[122:123], v[122:123], v[118:119]
  v_pk_mul_f32 v[120:121], v[120:121], v[74:75]
  v_pk_fma_f32 v[122:123], v[122:123], v[120:121], v[116:117]
  v_cvt_pk_bf16_f32 v91, v122, v123
  ds_write_b64 v12, v[90:91] offset:32
  v_lshlrev_b32 v108, 16, v92
  v_and_b32 v109, s47, v92
  v_lshlrev_b32 v110, 16, v102
  v_and_b32 v111, s47, v102
  v_pk_mul_f32 v[112:113], v[76:77], v[18:19]
  v_exp_f32 v112, v112
  v_exp_f32 v113, v113
  v_pk_add_f32 v[114:115], v[108:109], v[14:15] op_sel_hi:[1,0]
  v_pk_add_f32 v[112:113], v[112:113], s[48:49]
  v_pk_mul_f32 v[114:115], v[114:115], v[16:17] op_sel_hi:[1,0]
  v_rcp_f32 v112, v112
  v_rcp_f32 v113, v113
  v_pk_mul_f32 v[114:115], v[114:115], v[110:111]
  v_pk_mul_f32 v[112:113], v[112:113], v[76:77]
  v_pk_fma_f32 v[114:115], v[114:115], v[112:113], v[108:109]
  v_cvt_pk_bf16_f32 v92, v114, v115
  v_lshlrev_b32 v116, 16, v93
  v_and_b32 v117, s47, v93
  v_lshlrev_b32 v118, 16, v103
  v_and_b32 v119, s47, v103
  v_pk_mul_f32 v[120:121], v[78:79], v[18:19]
  v_exp_f32 v120, v120
  v_exp_f32 v121, v121
  v_pk_add_f32 v[122:123], v[116:117], v[14:15] op_sel_hi:[1,0]
  v_pk_add_f32 v[120:121], v[120:121], s[48:49]
  v_pk_mul_f32 v[122:123], v[122:123], v[16:17] op_sel_hi:[1,0]
  v_rcp_f32 v120, v120
  v_rcp_f32 v121, v121
  v_pk_mul_f32 v[122:123], v[122:123], v[118:119]
  v_pk_mul_f32 v[120:121], v[120:121], v[78:79]
  v_pk_fma_f32 v[122:123], v[122:123], v[120:121], v[116:117]
  v_cvt_pk_bf16_f32 v93, v122, v123
  ds_write_b64 v12, v[92:93] offset:64
  v_lshlrev_b32 v108, 16, v94
  v_and_b32 v109, s47, v94
  v_lshlrev_b32 v110, 16, v104
  v_and_b32 v111, s47, v104
  v_pk_mul_f32 v[112:113], v[80:81], v[18:19]
  v_exp_f32 v112, v112
  v_exp_f32 v113, v113
  v_pk_add_f32 v[114:115], v[108:109], v[14:15] op_sel_hi:[1,0]
  v_pk_add_f32 v[112:113], v[112:113], s[48:49]
  v_pk_mul_f32 v[114:115], v[114:115], v[16:17] op_sel_hi:[1,0]
  v_rcp_f32 v112, v112
  v_rcp_f32 v113, v113
  v_pk_mul_f32 v[114:115], v[114:115], v[110:111]
  v_pk_mul_f32 v[112:113], v[112:113], v[80:81]
  v_pk_fma_f32 v[114:115], v[114:115], v[112:113], v[108:109]
  v_cvt_pk_bf16_f32 v94, v114, v115
  v_lshlrev_b32 v116, 16, v95
  v_and_b32 v117, s47, v95
  v_lshlrev_b32 v118, 16, v105
  v_and_b32 v119, s47, v105
  v_pk_mul_f32 v[120:121], v[82:83], v[18:19]
  v_exp_f32 v120, v120
  v_exp_f32 v121, v121
  v_pk_add_f32 v[122:123], v[116:117], v[14:15] op_sel_hi:[1,0]
  v_pk_add_f32 v[120:121], v[120:121], s[48:49]
  v_pk_mul_f32 v[122:123], v[122:123], v[16:17] op_sel_hi:[1,0]
  v_rcp_f32 v120, v120
  v_rcp_f32 v121, v121
  v_pk_mul_f32 v[122:123], v[122:123], v[118:119]
  v_pk_mul_f32 v[120:121], v[120:121], v[82:83]
  v_pk_fma_f32 v[122:123], v[122:123], v[120:121], v[116:117]
  v_cvt_pk_bf16_f32 v95, v122, v123
  ds_write_b64 v12, v[94:95] offset:96
  v_lshlrev_b32 v108, 16, v96
  v_and_b32 v109, s47, v96
  v_lshlrev_b32 v110, 16, v106
  v_and_b32 v111, s47, v106
  v_pk_mul_f32 v[112:113], v[84:85], v[18:19]
  v_exp_f32 v112, v112
  v_exp_f32 v113, v113
  v_pk_add_f32 v[114:115], v[108:109], v[14:15] op_sel_hi:[1,0]
  v_pk_add_f32 v[112:113], v[112:113], s[48:49]
  v_pk_mul_f32 v[114:115], v[114:115], v[16:17] op_sel_hi:[1,0]
  v_rcp_f32 v112, v112
  v_rcp_f32 v113, v113
  v_pk_mul_f32 v[114:115], v[114:115], v[110:111]
  v_pk_mul_f32 v[112:113], v[112:113], v[84:85]
  v_pk_fma_f32 v[114:115], v[114:115], v[112:113], v[108:109]
  v_cvt_pk_bf16_f32 v96, v114, v115
  v_lshlrev_b32 v116, 16, v97
  v_and_b32 v117, s47, v97
  v_lshlrev_b32 v118, 16, v107
  v_and_b32 v119, s47, v107
  v_pk_mul_f32 v[120:121], v[86:87], v[18:19]
  v_exp_f32 v120, v120
  v_exp_f32 v121, v121
  v_pk_add_f32 v[122:123], v[116:117], v[14:15] op_sel_hi:[1,0]
  v_pk_add_f32 v[120:121], v[120:121], s[48:49]
  v_pk_mul_f32 v[122:123], v[122:123], v[16:17] op_sel_hi:[1,0]
  v_rcp_f32 v120, v120
  v_rcp_f32 v121, v121
  v_pk_mul_f32 v[122:123], v[122:123], v[118:119]
  v_pk_mul_f32 v[120:121], v[120:121], v[86:87]
  v_pk_fma_f32 v[122:123], v[122:123], v[120:121], v[116:117]
  v_cvt_pk_bf16_f32 v97, v122, v123
  ds_write_b64 v12, v[96:97] offset:128
  s_waitcnt lgkmcnt(0)
  s_add_u32 s40, s37, 122880
  v_add_u32 v13, s40, v4
  ds_read_b128 v[124:127], v13 offset:0
  ds_read_b128 v[128:131], v13 offset:1024
  ds_read_b128 v[132:135], v13 offset:2048
  s_waitcnt lgkmcnt(0)
  buffer_store_dwordx4 v[124:127], v5, s[12:15], 0 offen
  buffer_store_dwordx4 v[128:131], v6, s[12:15], 0 offen
  s_mov_b32 exec_lo, 0xffffffff
  s_mov_b32 exec_hi, 0x0
  buffer_store_dwordx4 v[132:135], v7, s[12:15], 0 offen
  s_mov_b64 exec, s[52:53]
  s_endpgm
K1_B:
  s_cmp_eq_u32 s34, 4
  s_cbranch_scc0 K1_NORST
  s_lshl_b32 s40, s32, 3
  s_add_u32 s40, s40, s33
  s_lshl_b32 s40, s40, 9
  s_add_u32 s40, s40, 16842752
  v_lshlrev_b32 v15, 3, v1
  v_mov_b32 v20, 0
  v_mov_b32 v21, 0xbf800000
  buffer_store_dwordx2 v[20:21], v15, s[16:19], s40 offen sc1
  s_lshl_b32 s40, s33, 7
  s_lshl_b32 s41, s32, 2
  s_add_u32 s40, s40, s41
  s_add_u32 s41, s40, 17040384
  s_add_u32 s40, s40, 17039360
  v_mov_b32 v15, s40
  v_mov_b32 v16, s41
  v_cmp_eq_u32 vcc, 1, v1
  s_nop 1
  v_cndmask_b32 v15, v15, v16, vcc
  s_lshl_b32 s40, s32, 5
  s_lshl_b32 s41, s33, 2
  s_add_u32 s40, s40, s41
  s_add_u32 s40, s40, 17041408
  v_mov_b32 v16, s40
  v_cmp_eq_u32 vcc, 2, v1
  s_nop 1
  v_cndmask_b32 v15, v15, v16, vcc
  s_mov_b32 exec_lo, 0x7
  s_mov_b32 exec_hi, 0x0
  buffer_store_dword v20, v15, s[16:19], 0 offen sc1
  s_mov_b64 exec, s[52:53]
K1_NORST:
  s_lshl_b32 s40, s2, 2
  s_add_u32 s40, s40, s55
  s_mul_i32 s41, s40, 2731
  s_lshr_b32 s41, s41, 16
  s_mul_i32 s42, s41, 24
  s_sub_u32 s42, s40, s42
  s_mov_b32 s72, s40
  v_mul_u32_u24 v17, 5120, v2
  v_lshlrev_b32 v18, 1, v3
  v_add_u32 v17, v17, v18
  s_lshl_b32 s41, s41, 5
  s_mul_i32 s42, s42, 40960
  s_add_u32 s41, s41, s42
  s_add_u32 s42, s41, 20480
  s_barrier
  s_mov_b32 s28, s66
  s_and_b32 s29, s67, 0xffff
  s_mov_b32 s30, 983040
  s_mov_b32 s31, 0x20000
  buffer_load_ushort v152, v17, s[28:31], s41 offen offset:0
  buffer_load_ushort v153, v17, s[28:31], s41 offen offset:1280
  buffer_load_ushort v154, v17, s[28:31], s41 offen offset:2560
  buffer_load_ushort v155, v17, s[28:31], s41 offen offset:3840
  buffer_load_ushort v156, v17, s[28:31], s42 offen offset:0
  buffer_load_ushort v157, v17, s[28:31], s42 offen offset:1280
  buffer_load_ushort v158, v17, s[28:31], s42 offen offset:2560
  buffer_load_ushort v159, v17, s[28:31], s42 offen offset:3840
  s_barrier
  s_barrier
  s_barrier
  s_cmp_eq_u32 s34, 4
  s_cbranch_scc0 K1_NOCNT
  s_waitcnt vmcnt(0)
  s_lshl_b32 s39, s32, 2
  v_mov_b32 v20, s39
  v_mov_b32 v21, 1
  s_mov_b32 exec_lo, 0x1
  s_mov_b32 exec_hi, 0x0
  buffer_atomic_add v21, v20, s[4:7], 0 offen sc1
  s_mov_b64 exec, s[52:53]
K1_NOCNT:
  s_barrier
  s_cmp_ge_u32 s72, 960
  s_cbranch_scc1 K1_NOWOF
  s_waitcnt vmcnt(0)
  v_lshl_or_b32 v164, v153, 16, v152
  v_lshl_or_b32 v165, v155, 16, v154
  v_lshl_or_b32 v166, v157, 16, v156
  v_lshl_or_b32 v167, v159, 16, v158
  v_lshlrev_b32 v17, 4, v1
  s_lshl_b32 s40, s72, 10
  s_add_u32 s40, s40, 15728640
  buffer_store_dwordx4 v[164:167], v17, s[16:19], s40 offen sc1
K1_NOWOF:
  s_barrier
  s_barrier
  s_barrier
  v_lshrrev_b32 v145, 2, v1
  v_mul_u32_u24 v145, 1280, v145
  v_and_b32 v23, 3, v1
  v_lshlrev_b32 v23, 6, v23
  v_add_u32 v145, v145, v23
  s_lshl_b32 s78, s32, 6
  s_lshl_b32 s39, s36, 5
  s_add_u32 s78, s78, s39
  s_mul_i32 s78, s78, 1280
  s_mul_i32 s39, s33, 160
  s_andn2_b32 s39, s39, 63
  s_add_u32 s78, s78, s39
  s_cmp_eq_u32 s35, 0
  s_cselect_b32 s56, s58, s60
  s_cselect_b32 s57, s59, s61
  s_mov_b32 s28, s56
  s_and_b32 s29, s57, 0xffff
  s_mov_b32 s30, 2621440
  s_mov_b32 s31, 0x20000
  s_barrier
  v_lshlrev_b32 v144, 6, v1
  s_and_b32 s54, s2, 7
  s_lshl_b32 s54, s54, 8
  s_lshr_b32 s39, s2, 3
  s_lshl_b32 s39, s39, 3
  s_add_u32 s54, s54, s39
  s_lshl_b32 s39, s55, 1
  s_add_u32 s54, s54, s39
  s_lshl_b32 s54, s54, 12
  s_mov_b32 s20, s74
  s_and_b32 s21, s75, 0xffff
  s_mov_b32 s22, 8388608
  s_mov_b32 s23, 0x20000
  s_mov_b32 s24, s76
  s_and_b32 s25, s77, 0xffff
  s_mov_b32 s26, 2621440
  s_mov_b32 s27, 0x20000
  s_mul_i32 s46, s2, 3
  s_add_u32 s46, s46, s55
  s_lshl_b32 s46, s46, 12
  s_cmp_eq_u32 s55, 3
  s_cselect_b32 s46, 0x80000000, s46
  s_barrier
  v_mov_b32 v102, 0x3f803f80
  v_mov_b32 v103, 0x3f803f80
  v_mov_b32 v104, 0x3f803f80
  v_mov_b32 v105, 0x3f803f80
  v_mov_b32 v66, 0
  v_mov_b32 v67, 0
  v_mov_b32 v68, 0
  v_mov_b32 v69, 0
  v_mov_b32 v70, 0
  v_mov_b32 v71, 0
  v_mov_b32 v72, 0
  v_mov_b32 v73, 0
  v_mov_b32 v74, 0
  v_mov_b32 v75, 0
  v_mov_b32 v76, 0
  v_mov_b32 v77, 0
  v_mov_b32 v78, 0
  v_mov_b32 v79, 0
  v_mov_b32 v80, 0
  v_mov_b32 v81, 0
  v_mov_b32 v82, 0
  v_mov_b32 v83, 0
  v_mov_b32 v84, 0
  v_mov_b32 v85, 0
  v_mov_b32 v86, 0
  v_mov_b32 v87, 0
  v_mov_b32 v88, 0
  v_mov_b32 v89, 0
  v_mov_b32 v90, 0
  v_mov_b32 v91, 0
  v_mov_b32 v92, 0
  v_mov_b32 v93, 0
  v_mov_b32 v94, 0
  v_mov_b32 v95, 0
  v_mov_b32 v96, 0
  v_mov_b32 v97, 0
  v_mov_b32 v98, 0
  v_mov_b32 v99, 0
  v_mov_b32 v100, 0
  v_mov_b32 v101, 0
  v_mov_b32 v106, 0
  v_mov_b32 v107, 0
  v_mov_b32 v108, 0
  v_mov_b32 v109, 0
  v_mov_b32 v110, 0
  v_mov_b32 v111, 0
  v_mov_b32 v112, 0
  v_mov_b32 v113, 0
  s_barrier
  s_mov_b32 s37, 0
  ds_read_b128 v[26:29], v4 offset:0
  ds_read_b64_tr_b16 v[42:43], v8 offset:0
  ds_read_b64_tr_b16 v[44:45], v8 offset:768
  ds_read_b128 v[30:33], v6 offset:0
  ds_read_b64_tr_b16 v[46:47], v9 offset:0
  ds_read_b64_tr_b16 v[48:49], v9 offset:768
  ds_read_b64_tr_b16 v[50:51], v10 offset:0
  ds_read_b64_tr_b16 v[52:53], v10 offset:768
K1_LOOP2:
  s_waitcnt lgkmcnt(0)
  v_mfma_f32_16x16x32_bf16 v[66:69], v[42:45], v[26:29], v[66:69]
  ds_read_b128 v[34:37], v5 offset:0
  ds_read_b64_tr_b16 v[54:55], v8 offset:6144
  v_mfma_f32_16x16x32_bf16 v[78:81], v[42:45], v[30:33], v[78:81]
  ds_read_b64_tr_b16 v[56:57], v8 offset:6912
  ds_read_b128 v[38:41], v7 offset:0
  v_mfma_f32_16x16x32_bf16 v[70:73], v[46:49], v[26:29], v[70:73]
  ds_read_b64_tr_b16 v[58:59], v9 offset:6144
  ds_read_b64_tr_b16 v[60:61], v9 offset:6912
  v_mfma_f32_16x16x32_bf16 v[82:85], v[46:49], v[30:33], v[82:85]
  ds_read_b64_tr_b16 v[62:63], v10 offset:6144
  ds_read_b64_tr_b16 v[64:65], v10 offset:6912
  v_mfma_f32_16x16x32_bf16 v[74:77], v[50:53], v[26:29], v[74:77]
  v_mfma_f32_16x16x32_bf16 v[86:89], v[50:53], v[30:33], v[86:89]
  s_cmp_eq_u32 s35, 0
  s_cbranch_scc0 K1_SK_2a0
  v_mfma_f32_16x16x32_bf16 v[90:93], v[42:45], v[102:105], v[90:93]
  v_mfma_f32_16x16x32_bf16 v[94:97], v[46:49], v[102:105], v[94:97]
  v_mfma_f32_16x16x32_bf16 v[98:101], v[50:53], v[102:105], v[98:101]
K1_SK_2a0:
  s_waitcnt lgkmcnt(0)
  s_barrier
  v_mfma_f32_16x16x32_bf16 v[66:69], v[54:57], v[34:37], v[66:69]
  ds_read_b128 v[26:29], v4 offset:8192
  ds_read_b64_tr_b16 v[42:43], v8 offset:12288
  v_mfma_f32_16x16x32_bf16 v[78:81], v[54:57], v[38:41], v[78:81]
  ds_read_b64_tr_b16 v[44:45], v8 offset:13056
  ds_read_b128 v[30:33], v6 offset:8192
  v_mfma_f32_16x16x32_bf16 v[70:73], v[58:61], v[34:37], v[70:73]
  ds_read_b64_tr_b16 v[46:47], v9 offset:12288
  ds_read_b64_tr_b16 v[48:49], v9 offset:13056
  v_mfma_f32_16x16x32_bf16 v[82:85], v[58:61], v[38:41], v[82:85]
  ds_read_b64_tr_b16 v[50:51], v10 offset:12288
  ds_read_b64_tr_b16 v[52:53], v10 offset:13056
  v_mfma_f32_16x16x32_bf16 v[74:77], v[62:65], v[34:37], v[74:77]
  v_mfma_f32_16x16x32_bf16 v[86:89], v[62:65], v[38:41], v[86:89]
  s_cmp_eq_u32 s35, 1
  s_cbranch_scc0 K1_SK_2b0
  v_mfma_f32_16x16x32_bf16 v[90:93], v[54:57], v[102:105], v[90:93]
  v_mfma_f32_16x16x32_bf16 v[94:97], v[58:61], v[102:105], v[94:97]
  v_mfma_f32_16x16x32_bf16 v[98:101], v[62:65], v[102:105], v[98:101]
K1_SK_2b0:
  buffer_load_dword v146, v145, s[28:31], s78 offen
  s_add_u32 s78, s78, 20480
  s_waitcnt lgkmcnt(0)
  v_mfma_f32_16x16x32_bf16 v[66:69], v[42:45], v[26:29], v[66:69]
  ds_read_b128 v[34:37], v5 offset:8192
  ds_read_b64_tr_b16 v[54:55], v8 offset:18432
  v_mfma_f32_16x16x32_bf16 v[78:81], v[42:45], v[30:33], v[78:81]
  ds_read_b64_tr_b16 v[56:57], v8 offset:19200
  ds_read_b128 v[38:41], v7 offset:8192
  v_mfma_f32_16x16x32_bf16 v[70:73], v[46:49], v[26:29], v[70:73]
  ds_read_b64_tr_b16 v[58:59], v9 offset:18432
  ds_read_b64_tr_b16 v[60:61], v9 offset:19200
  v_mfma_f32_16x16x32_bf16 v[82:85], v[46:49], v[30:33], v[82:85]
  ds_read_b64_tr_b16 v[62:63], v10 offset:18432
  ds_read_b64_tr_b16 v[64:65], v10 offset:19200
  v_mfma_f32_16x16x32_bf16 v[74:77], v[50:53], v[26:29], v[74:77]
  v_mfma_f32_16x16x32_bf16 v[86:89], v[50:53], v[30:33], v[86:89]
  s_cmp_eq_u32 s35, 0
  s_cbranch_scc0 K1_SK_2a1
  v_mfma_f32_16x16x32_bf16 v[90:93], v[42:45], v[102:105], v[90:93]
  v_mfma_f32_16x16x32_bf16 v[94:97], v[46:49], v[102:105], v[94:97]
  v_mfma_f32_16x16x32_bf16 v[98:101], v[50:53], v[102:105], v[98:101]
K1_SK_2a1:
  s_waitcnt lgkmcnt(0)
  s_barrier
  v_mfma_f32_16x16x32_bf16 v[66:69], v[54:57], v[34:37], v[66:69]
  ds_read_b128 v[26:29], v4 offset:16384
  ds_read_b64_tr_b16 v[42:43], v8 offset:24576
  v_mfma_f32_16x16x32_bf16 v[78:81], v[54:57], v[38:41], v[78:81]
  ds_read_b64_tr_b16 v[44:45], v8 offset:25344
  ds_read_b128 v[30:33], v6 offset:16384
  v_mfma_f32_16x16x32_bf16 v[70:73], v[58:61], v[34:37], v[70:73]
  ds_read_b64_tr_b16 v[46:47], v9 offset:24576
  ds_read_b64_tr_b16 v[48:49], v9 offset:25344
  v_mfma_f32_16x16x32_bf16 v[82:85], v[58:61], v[38:41], v[82:85]
  ds_read_b64_tr_b16 v[50:51], v10 offset:24576
  ds_read_b64_tr_b16 v[52:53], v10 offset:25344
  v_mfma_f32_16x16x32_bf16 v[74:77], v[62:65], v[34:37], v[74:77]
  v_mfma_f32_16x16x32_bf16 v[86:89], v[62:65], v[38:41], v[86:89]
  s_cmp_eq_u32 s35, 1
  s_cbranch_scc0 K1_SK_2b1
  v_mfma_f32_16x16x32_bf16 v[90:93], v[54:57], v[102:105], v[90:93]
  v_mfma_f32_16x16x32_bf16 v[94:97], v[58:61], v[102:105], v[94:97]
  v_mfma_f32_16x16x32_bf16 v[98:101], v[62:65], v[102:105], v[98:101]
K1_SK_2b1:
  buffer_load_dword v147, v145, s[28:31], s78 offen
  s_mov_b32 s78, 0x80000000
  s_waitcnt lgkmcnt(0)
  v_mfma_f32_16x16x32_bf16 v[66:69], v[42:45], v[26:29], v[66:69]
  ds_read_b128 v[34:37], v5 offset:16384
  ds_read_b64_tr_b16 v[54:55], v8 offset:30720
  v_mfma_f32_16x16x32_bf16 v[78:81], v[42:45], v[30:33], v[78:81]
  ds_read_b64_tr_b16 v[56:57], v8 offset:31488
  ds_read_b128 v[38:41], v7 offset:16384
  v_mfma_f32_16x16x32_bf16 v[70:73], v[46:49], v[26:29], v[70:73]
  ds_read_b64_tr_b16 v[58:59], v9 offset:30720
  ds_read_b64_tr_b16 v[60:61], v9 offset:31488
  v_mfma_f32_16x16x32_bf16 v[82:85], v[46:49], v[30:33], v[82:85]
  ds_read_b64_tr_b16 v[62:63], v10 offset:30720
  ds_read_b64_tr_b16 v[64:65], v10 offset:31488
  v_mfma_f32_16x16x32_bf16 v[74:77], v[50:53], v[26:29], v[74:77]
  v_mfma_f32_16x16x32_bf16 v[86:89], v[50:53], v[30:33], v[86:89]
  s_cmp_eq_u32 s35, 0
  s_cbranch_scc0 K1_SK_2a2
  v_mfma_f32_16x16x32_bf16 v[90:93], v[42:45], v[102:105], v[90:93]
  v_mfma_f32_16x16x32_bf16 v[94:97], v[46:49], v[102:105], v[94:97]
  v_mfma_f32_16x16x32_bf16 v[98:101], v[50:53], v[102:105], v[98:101]
K1_SK_2a2:
  s_waitcnt lgkmcnt(0)
  s_barrier
  v_mfma_f32_16x16x32_bf16 v[66:69], v[54:57], v[34:37], v[66:69]
  ds_read_b128 v[26:29], v4 offset:24576
  ds_read_b64_tr_b16 v[42:43], v8 offset:36864
  v_mfma_f32_16x16x32_bf16 v[78:81], v[54:57], v[38:41], v[78:81]
  ds_read_b64_tr_b16 v[44:45], v8 offset:37632
  ds_read_b128 v[30:33], v6 offset:24576
  v_mfma_f32_16x16x32_bf16 v[70:73], v[58:61], v[34:37], v[70:73]
  ds_read_b64_tr_b16 v[46:47], v9 offset:36864
  ds_read_b64_tr_b16 v[48:49], v9 offset:37632
  v_mfma_f32_16x16x32_bf16 v[82:85], v[58:61], v[38:41], v[82:85]
  ds_read_b64_tr_b16 v[50:51], v10 offset:36864
  ds_read_b64_tr_b16 v[52:53], v10 offset:37632
  v_mfma_f32_16x16x32_bf16 v[74:77], v[62:65], v[34:37], v[74:77]
  v_mfma_f32_16x16x32_bf16 v[86:89], v[62:65], v[38:41], v[86:89]
  s_cmp_eq_u32 s35, 1
  s_cbranch_scc0 K1_SK_2b2
  v_mfma_f32_16x16x32_bf16 v[90:93], v[54:57], v[102:105], v[90:93]
  v_mfma_f32_16x16x32_bf16 v[94:97], v[58:61], v[102:105], v[94:97]
  v_mfma_f32_16x16x32_bf16 v[98:101], v[62:65], v[102:105], v[98:101]
K1_SK_2b2:
  buffer_load_dword v148, v144, s[20:23], s54 offen
  s_add_u32 s54, s54, 4096
  s_waitcnt lgkmcnt(0)
  v_mfma_f32_16x16x32_bf16 v[66:69], v[42:45], v[26:29], v[66:69]
  ds_read_b128 v[34:37], v5 offset:24576
  ds_read_b64_tr_b16 v[54:55], v8 offset:43008
  v_mfma_f32_16x16x32_bf16 v[78:81], v[42:45], v[30:33], v[78:81]
  ds_read_b64_tr_b16 v[56:57], v8 offset:43776
  ds_read_b128 v[38:41], v7 offset:24576
  v_mfma_f32_16x16x32_bf16 v[70:73], v[46:49], v[26:29], v[70:73]
  ds_read_b64_tr_b16 v[58:59], v9 offset:43008
  ds_read_b64_tr_b16 v[60:61], v9 offset:43776
  v_mfma_f32_16x16x32_bf16 v[82:85], v[46:49], v[30:33], v[82:85]
  ds_read_b64_tr_b16 v[62:63], v10 offset:43008
  ds_read_b64_tr_b16 v[64:65], v10 offset:43776
  v_mfma_f32_16x16x32_bf16 v[74:77], v[50:53], v[26:29], v[74:77]
  v_mfma_f32_16x16x32_bf16 v[86:89], v[50:53], v[30:33], v[86:89]
  s_cmp_eq_u32 s35, 0
  s_cbranch_scc0 K1_SK_2a3
  v_mfma_f32_16x16x32_bf16 v[90:93], v[42:45], v[102:105], v[90:93]
  v_mfma_f32_16x16x32_bf16 v[94:97], v[46:49], v[102:105], v[94:97]
  v_mfma_f32_16x16x32_bf16 v[98:101], v[50:53], v[102:105], v[98:101]
K1_SK_2a3:
  s_waitcnt lgkmcnt(0)
  s_barrier
  v_mfma_f32_16x16x32_bf16 v[66:69], v[54:57], v[34:37], v[66:69]
  ds_read_b128 v[26:29], v4 offset:32768
  ds_read_b64_tr_b16 v[42:43], v8 offset:49152
  v_mfma_f32_16x16x32_bf16 v[78:81], v[54:57], v[38:41], v[78:81]
  ds_read_b64_tr_b16 v[44:45], v8 offset:49920
  ds_read_b128 v[30:33], v6 offset:32768
  v_mfma_f32_16x16x32_bf16 v[70:73], v[58:61], v[34:37], v[70:73]
  ds_read_b64_tr_b16 v[46:47], v9 offset:49152
  ds_read_b64_tr_b16 v[48:49], v9 offset:49920
  v_mfma_f32_16x16x32_bf16 v[82:85], v[58:61], v[38:41], v[82:85]
  ds_read_b64_tr_b16 v[50:51], v10 offset:49152
  ds_read_b64_tr_b16 v[52:53], v10 offset:49920
  v_mfma_f32_16x16x32_bf16 v[74:77], v[62:65], v[34:37], v[74:77]
  v_mfma_f32_16x16x32_bf16 v[86:89], v[62:65], v[38:41], v[86:89]
  s_cmp_eq_u32 s35, 1
  s_cbranch_scc0 K1_SK_2b3
  v_mfma_f32_16x16x32_bf16 v[90:93], v[54:57], v[102:105], v[90:93]
  v_mfma_f32_16x16x32_bf16 v[94:97], v[58:61], v[102:105], v[94:97]
  v_mfma_f32_16x16x32_bf16 v[98:101], v[62:65], v[102:105], v[98:101]
K1_SK_2b3:
  buffer_load_dword v149, v144, s[24:27], s46 offen
  s_mov_b32 s46, 0x80000000
  s_waitcnt lgkmcnt(0)
  v_mfma_f32_16x16x32_bf16 v[66:69], v[42:45], v[26:29], v[66:69]
  ds_read_b128 v[34:37], v5 offset:32768
  ds_read_b64_tr_b16 v[54:55], v8 offset:55296
  v_mfma_f32_16x16x32_bf16 v[78:81], v[42:45], v[30:33], v[78:81]
  ds_read_b64_tr_b16 v[56:57], v8 offset:56064
  ds_read_b128 v[38:41], v7 offset:32768
  v_mfma_f32_16x16x32_bf16 v[70:73], v[46:49], v[26:29], v[70:73]
  ds_read_b64_tr_b16 v[58:59], v9 offset:55296
  ds_read_b64_tr_b16 v[60:61], v9 offset:56064
  v_mfma_f32_16x16x32_bf16 v[82:85], v[46:49], v[30:33], v[82:85]
  ds_read_b64_tr_b16 v[62:63], v10 offset:55296
  ds_read_b64_tr_b16 v[64:65], v10 offset:56064
  v_mfma_f32_16x16x32_bf16 v[74:77], v[50:53], v[26:29], v[74:77]
  v_mfma_f32_16x16x32_bf16 v[86:89], v[50:53], v[30:33], v[86:89]
  s_cmp_eq_u32 s35, 0
  s_cbranch_scc0 K1_SK_2a4
  v_mfma_f32_16x16x32_bf16 v[90:93], v[42:45], v[102:105], v[90:93]
  v_mfma_f32_16x16x32_bf16 v[94:97], v[46:49], v[102:105], v[94:97]
  v_mfma_f32_16x16x32_bf16 v[98:101], v[50:53], v[102:105], v[98:101]
K1_SK_2a4:
  s_waitcnt lgkmcnt(0)
  s_barrier
  v_add_u32 v4, 40960, v4
  v_add_u32 v5, 40960, v5
  v_add_u32 v6, 40960, v6
  v_add_u32 v7, 40960, v7
  v_mfma_f32_16x16x32_bf16 v[66:69], v[54:57], v[34:37], v[66:69]
  ds_read_b128 v[26:29], v4 offset:0
  ds_read_b64_tr_b16 v[42:43], v8 offset:0
  v_mfma_f32_16x16x32_bf16 v[78:81], v[54:57], v[38:41], v[78:81]
  ds_read_b64_tr_b16 v[44:45], v8 offset:768
  ds_read_b128 v[30:33], v6 offset:0
  v_mfma_f32_16x16x32_bf16 v[70:73], v[58:61], v[34:37], v[70:73]
  ds_read_b64_tr_b16 v[46:47], v9 offset:0
  ds_read_b64_tr_b16 v[48:49], v9 offset:768
  v_mfma_f32_16x16x32_bf16 v[82:85], v[58:61], v[38:41], v[82:85]
  ds_read_b64_tr_b16 v[50:51], v10 offset:0
  ds_read_b64_tr_b16 v[52:53], v10 offset:768
  v_mfma_f32_16x16x32_bf16 v[74:77], v[62:65], v[34:37], v[74:77]
  v_mfma_f32_16x16x32_bf16 v[86:89], v[62:65], v[38:41], v[86:89]
  s_cmp_eq_u32 s35, 1
  s_cbranch_scc0 K1_SK_2b4
  v_mfma_f32_16x16x32_bf16 v[90:93], v[54:57], v[102:105], v[90:93]
  v_mfma_f32_16x16x32_bf16 v[94:97], v[58:61], v[102:105], v[94:97]
  v_mfma_f32_16x16x32_bf16 v[98:101], v[62:65], v[102:105], v[98:101]
K1_SK_2b4:
  s_add_u32 s37, s37, 1
  s_cmp_lt_u32 s37, 2
  s_cbranch_scc1 K1_LOOP2
  s_mul_i32 s40, s55, 192
  s_add_u32 s40, s40, 144640
  v_lshlrev_b32 v18, 4, v2
  v_add_u32 v19, s40, v18
  s_mov_b32 exec_lo, 0x10001
  s_mov_b32 exec_hi, 0x10001
  ds_write_b128 v19, v[90:93] offset:0
  ds_write_b128 v19, v[94:97] offset:64
  ds_write_b128 v19, v[98:101] offset:128
  s_mov_b64 exec, s[52:53]
  v_mov_b32 v126, 0xc0135761
  v_mov_b32 v127, 0xc0135761
  s_waitcnt lgkmcnt(0)
  s_barrier
  s_xor_b32 s41, s55, 2
  s_mul_i32 s41, s41, 192
  s_add_u32 s41, s41, 144640
  v_add_u32 v19, s41, v18
  ds_read_b128 v[26:29], v19 offset:0
  ds_read_b128 v[30:33], v19 offset:64
  ds_read_b128 v[34:37], v19 offset:128
  s_lshl_b32 s40, s35, 7
  s_lshl_b32 s41, s36, 6
  s_add_u32 s40, s40, s41
  s_add_u32 s40, s40, 143360
  v_lshlrev_b32 v20, 2, v3
  v_add_u32 v20, s40, v20
  v_xor_b32 v21, 64, v20
  ds_read_b32 v42, v20
  ds_read_b32 v44, v21
  ds_read_b32 v46, v20 offset:256
  ds_read_b32 v48, v21 offset:256
  s_lshl_b32 s40, s32, 2
  s_lshl_b32 s41, s35, 1
  s_add_u32 s40, s40, s41
  s_add_u32 s41, s40, s36
  s_xor_b32 s42, s41, 1
  s_mul_i32 s39, s33, 6
  s_mul_i32 s38, s36, 3
  s_add_u32 s39, s39, s38
  s_mul_i32 s41, s41, 48
  s_add_u32 s41, s41, s39
  s_lshl_b32 s41, s41, 9
  s_add_u32 s41, s41, 0
  s_mul_i32 s42, s42, 48
  s_add_u32 s42, s42, s39
  s_lshl_b32 s42, s42, 9
  s_add_u32 s42, s42, 0
  v_lshlrev_b32 v20, 3, v1
  s_lshl_b32 s38, s35, 1
  s_add_u32 s38, s38, s36
  s_mul_i32 s39, s38, 3072
  s_mul_i32 s40, s36, 1536
  s_add_u32 s39, s39, s40
  s_add_u32 s39, s39, 147456
  v_add_u32 v22, s39, v20
  s_xor_b32 s38, s38, 1
  s_mul_i32 s39, s38, 3072
  s_add_u32 s39, s39, s40
  s_add_u32 s39, s39, 147456
  v_add_u32 v23, s39, v20
  s_waitcnt lgkmcnt(0)
  v_add_f32 v26, v26, v90
  v_sub_f32 v26, 0, v26
  v_add_f32 v27, v27, v91
  v_sub_f32 v27, 0, v27
  v_add_f32 v28, v28, v92
  v_sub_f32 v28, 0, v28
  v_add_f32 v29, v29, v93
  v_sub_f32 v29, 0, v29
  v_add_f32 v30, v30, v94
  v_sub_f32 v30, 0, v30
  v_add_f32 v31, v31, v95
  v_sub_f32 v31, 0, v31
  v_add_f32 v32, v32, v96
  v_sub_f32 v32, 0, v32
  v_add_f32 v33, v33, v97
  v_sub_f32 v33, 0, v33
  v_add_f32 v34, v34, v98
  v_sub_f32 v34, 0, v34
  v_add_f32 v35, v35, v99
  v_sub_f32 v35, 0, v35
  v_add_f32 v36, v36, v100
  v_sub_f32 v36, 0, v36
  v_add_f32 v37, v37, v101
  v_sub_f32 v37, 0, v37
  v_pk_fma_f32 v[66:67], v[26:27], v[42:43], v[66:67] op_sel_hi:[1,0,1]
  v_pk_mul_f32 v[66:67], v[66:67], v[46:47] op_sel_hi:[1,0]
  v_pk_mul_f32 v[128:129], v[66:67], v[66:67]
  v_pk_fma_f32 v[128:129], v[128:129], s[48:49], v[126:127]
  v_pk_mul_f32 v[128:129], v[128:129], v[66:67]
  v_exp_f32 v128, v128
  v_exp_f32 v129, v129
  s_nop 0
  v_pk_add_f32 v[128:129], v[128:129], s[50:51]
  v_rcp_f32 v128, v128
  v_rcp_f32 v129, v129
  s_nop 0
  v_pk_mul_f32 v[128:129], v[128:129], v[66:67]
  v_cvt_pk_bf16_f32 v114, v128, v129
  v_pk_fma_f32 v[68:69], v[28:29], v[42:43], v[68:69] op_sel_hi:[1,0,1]
  v_pk_mul_f32 v[68:69], v[68:69], v[46:47] op_sel_hi:[1,0]
  v_pk_mul_f32 v[132:133], v[68:69], v[68:69]
  v_pk_fma_f32 v[132:133], v[132:133], s[48:49], v[126:127]
  v_pk_mul_f32 v[132:133], v[132:133], v[68:69]
  v_exp_f32 v132, v132
  v_exp_f32 v133, v133
  s_nop 0
  v_pk_add_f32 v[132:133], v[132:133], s[50:51]
  v_rcp_f32 v132, v132
  v_rcp_f32 v133, v133
  s_nop 0
  v_pk_mul_f32 v[132:133], v[132:133], v[68:69]
  v_cvt_pk_bf16_f32 v115, v132, v133
  ds_write_b64 v22, v[114:115] offset:0
  v_pk_fma_f32 v[70:71], v[30:31], v[42:43], v[70:71] op_sel_hi:[1,0,1]
  v_pk_mul_f32 v[70:71], v[70:71], v[46:47] op_sel_hi:[1,0]
  v_pk_mul_f32 v[128:129], v[70:71], v[70:71]
  v_pk_fma_f32 v[128:129], v[128:129], s[48:49], v[126:127]
  v_pk_mul_f32 v[128:129], v[128:129], v[70:71]
  v_exp_f32 v128, v128
  v_exp_f32 v129, v129
  s_nop 0
  v_pk_add_f32 v[128:129], v[128:129], s[50:51]
  v_rcp_f32 v128, v128
  v_rcp_f32 v129, v129
  s_nop 0
  v_pk_mul_f32 v[128:129], v[128:129], v[70:71]
  v_cvt_pk_bf16_f32 v116, v128, v129
  v_pk_fma_f32 v[72:73], v[32:33], v[42:43], v[72:73] op_sel_hi:[1,0,1]
  v_pk_mul_f32 v[72:73], v[72:73], v[46:47] op_sel_hi:[1,0]
  v_pk_mul_f32 v[132:133], v[72:73], v[72:73]
  v_pk_fma_f32 v[132:133], v[132:133], s[48:49], v[126:127]
  v_pk_mul_f32 v[132:133], v[132:133], v[72:73]
  v_exp_f32 v132, v132
  v_exp_f32 v133, v133
  s_nop 0
  v_pk_add_f32 v[132:133], v[132:133], s[50:51]
  v_rcp_f32 v132, v132
  v_rcp_f32 v133, v133
  s_nop 0
  v_pk_mul_f32 v[132:133], v[132:133], v[72:73]
  v_cvt_pk_bf16_f32 v117, v132, v133
  ds_write_b64 v22, v[116:117] offset:512
  v_pk_fma_f32 v[74:75], v[34:35], v[42:43], v[74:75] op_sel_hi:[1,0,1]
  v_pk_mul_f32 v[74:75], v[74:75], v[46:47] op_sel_hi:[1,0]
  v_pk_mul_f32 v[128:129], v[74:75], v[74:75]
  v_pk_fma_f32 v[128:129], v[128:129], s[48:49], v[126:127]
  v_pk_mul_f32 v[128:129], v[128:129], v[74:75]
  v_exp_f32 v128, v128
  v_exp_f32 v129, v129
  s_nop 0
  v_pk_add_f32 v[128:129], v[128:129], s[50:51]
  v_rcp_f32 v128, v128
  v_rcp_f32 v129, v129
  s_nop 0
  v_pk_mul_f32 v[128:129], v[128:129], v[74:75]
  v_cvt_pk_bf16_f32 v118, v128, v129
  v_pk_fma_f32 v[76:77], v[36:37], v[42:43], v[76:77] op_sel_hi:[1,0,1]
  v_pk_mul_f32 v[76:77], v[76:77], v[46:47] op_sel_hi:[1,0]
  v_pk_mul_f32 v[132:133], v[76:77], v[76:77]
  v_pk_fma_f32 v[132:133], v[132:133], s[48:49], v[126:127]
  v_pk_mul_f32 v[132:133], v[132:133], v[76:77]
  v_exp_f32 v132, v132
  v_exp_f32 v133, v133
  s_nop 0
  v_pk_add_f32 v[132:133], v[132:133], s[50:51]
  v_rcp_f32 v132, v132
  v_rcp_f32 v133, v133
  s_nop 0
  v_pk_mul_f32 v[132:133], v[132:133], v[76:77]
  v_cvt_pk_bf16_f32 v119, v132, v133
  ds_write_b64 v22, v[118:119] offset:1024
  v_pk_fma_f32 v[78:79], v[26:27], v[44:45], v[78:79] op_sel_hi:[1,0,1]
  v_pk_mul_f32 v[78:79], v[78:79], v[48:49] op_sel_hi:[1,0]
  v_pk_mul_f32 v[128:129], v[78:79], v[78:79]
  v_pk_fma_f32 v[128:129], v[128:129], s[48:49], v[126:127]
  v_pk_mul_f32 v[128:129], v[128:129], v[78:79]
  v_exp_f32 v128, v128
  v_exp_f32 v129, v129
  s_nop 0
  v_pk_add_f32 v[128:129], v[128:129], s[50:51]
  v_rcp_f32 v128, v128
  v_rcp_f32 v129, v129
  s_nop 0
  v_pk_mul_f32 v[128:129], v[128:129], v[78:79]
  v_cvt_pk_bf16_f32 v120, v128, v129
  v_pk_fma_f32 v[80:81], v[28:29], v[44:45], v[80:81] op_sel_hi:[1,0,1]
  v_pk_mul_f32 v[80:81], v[80:81], v[48:49] op_sel_hi:[1,0]
  v_pk_mul_f32 v[132:133], v[80:81], v[80:81]
  v_pk_fma_f32 v[132:133], v[132:133], s[48:49], v[126:127]
  v_pk_mul_f32 v[132:133], v[132:133], v[80:81]
  v_exp_f32 v132, v132
  v_exp_f32 v133, v133
  s_nop 0
  v_pk_add_f32 v[132:133], v[132:133], s[50:51]
  v_rcp_f32 v132, v132
  v_rcp_f32 v133, v133
  s_nop 0
  v_pk_mul_f32 v[132:133], v[132:133], v[80:81]
  v_cvt_pk_bf16_f32 v121, v132, v133
  ds_write_b64 v23, v[120:121] offset:0
  v_pk_fma_f32 v[82:83], v[30:31], v[44:45], v[82:83] op_sel_hi:[1,0,1]
  v_pk_mul_f32 v[82:83], v[82:83], v[48:49] op_sel_hi:[1,0]
  v_pk_mul_f32 v[128:129], v[82:83], v[82:83]
  v_pk_fma_f32 v[128:129], v[128:129], s[48:49], v[126:127]
  v_pk_mul_f32 v[128:129], v[128:129], v[82:83]
  v_exp_f32 v128, v128
  v_exp_f32 v129, v129
  s_nop 0
  v_pk_add_f32 v[128:129], v[128:129], s[50:51]
  v_rcp_f32 v128, v128
  v_rcp_f32 v129, v129
  s_nop 0
  v_pk_mul_f32 v[128:129], v[128:129], v[82:83]
  v_cvt_pk_bf16_f32 v122, v128, v129
  v_pk_fma_f32 v[84:85], v[32:33], v[44:45], v[84:85] op_sel_hi:[1,0,1]
  v_pk_mul_f32 v[84:85], v[84:85], v[48:49] op_sel_hi:[1,0]
  v_pk_mul_f32 v[132:133], v[84:85], v[84:85]
  v_pk_fma_f32 v[132:133], v[132:133], s[48:49], v[126:127]
  v_pk_mul_f32 v[132:133], v[132:133], v[84:85]
  v_exp_f32 v132, v132
  v_exp_f32 v133, v133
  s_nop 0
  v_pk_add_f32 v[132:133], v[132:133], s[50:51]
  v_rcp_f32 v132, v132
  v_rcp_f32 v133, v133
  s_nop 0
  v_pk_mul_f32 v[132:133], v[132:133], v[84:85]
  v_cvt_pk_bf16_f32 v123, v132, v133
  ds_write_b64 v23, v[122:123] offset:512
  v_pk_fma_f32 v[86:87], v[34:35], v[44:45], v[86:87] op_sel_hi:[1,0,1]
  v_pk_mul_f32 v[86:87], v[86:87], v[48:49] op_sel_hi:[1,0]
  v_pk_mul_f32 v[128:129], v[86:87], v[86:87]
  v_pk_fma_f32 v[128:129], v[128:129], s[48:49], v[126:127]
  v_pk_mul_f32 v[128:129], v[128:129], v[86:87]
  v_exp_f32 v128, v128
  v_exp_f32 v129, v129
  s_nop 0
  v_pk_add_f32 v[128:129], v[128:129], s[50:51]
  v_rcp_f32 v128, v128
  v_rcp_f32 v129, v129
  s_nop 0
  v_pk_mul_f32 v[128:129], v[128:129], v[86:87]
  v_cvt_pk_bf16_f32 v124, v128, v129
  v_pk_fma_f32 v[88:89], v[36:37], v[44:45], v[88:89] op_sel_hi:[1,0,1]
  v_pk_mul_f32 v[88:89], v[88:89], v[48:49] op_sel_hi:[1,0]
  v_pk_mul_f32 v[132:133], v[88:89], v[88:89]
  v_pk_fma_f32 v[132:133], v[132:133], s[48:49], v[126:127]
  v_pk_mul_f32 v[132:133], v[132:133], v[88:89]
  v_exp_f32 v132, v132
  v_exp_f32 v133, v133
  s_nop 0
  v_pk_add_f32 v[132:133], v[132:133], s[50:51]
  v_rcp_f32 v132, v132
  v_rcp_f32 v133, v133
  s_nop 0
  v_pk_mul_f32 v[132:133], v[132:133], v[88:89]
  v_cvt_pk_bf16_f32 v125, v132, v133
  ds_write_b64 v23, v[124:125] offset:1024
  s_waitcnt lgkmcnt(0)
  s_barrier
  s_cmp_eq_u32 s34, 7
  s_cbranch_scc1 F2_SYNC
  s_load_dwordx4 s[64:67], s[0:1], 32
  s_sub_u32 s42, s34, 4
  s_mul_i32 s35, s33, 80
  s_mul_i32 s40, s32, 3
  s_lshl_b32 s41, s32, 1
  s_add_u32 s41, s41, 16
  s_cmp_lt_u32 s32, 16
  s_cselect_b32 s40, s40, s41
  s_cselect_b32 s41, 3, 2
  s_add_u32 s35, s35, s40
  s_add_u32 s35, s35, s42
  s_cmp_lt_u32 s42, s41
  s_cbranch_scc0 F2_IDLE
  s_mul_i32 s36, s42, 21248
  s_add_u32 s36, s36, 65536
  s_waitcnt lgkmcnt(0)
  s_lshl_b32 s40, s35, 12
  s_add_u32 s20, s64, s40
  s_addc_u32 s21, s65, 0
  s_and_b32 s21, s21, 0xffff
  s_mov_b32 s22, 4096
  s_mov_b32 s23, 0x20000
  s_mov_b32 s24, s66
  s_and_b32 s25, s67, 0xffff
  s_mov_b32 s26, 1280
  s_mov_b32 s27, 0x20000
  v_lshlrev_b32 v6, 4, v1
  buffer_load_dwordx4 v[16:19], v6, s[20:23], 0 offen offset:0
  buffer_load_dwordx2 v[20:21], v6, s[20:23], 0 offen offset:16
  buffer_load_dwordx4 v[22:25], v6, s[20:23], 0 offen offset:1024
  buffer_load_dwordx2 v[26:27], v6, s[20:23], 0 offen offset:1040
  buffer_load_dwordx4 v[28:31], v6, s[20:23], 0 offen offset:2048
  buffer_load_dwordx2 v[32:33], v6, s[20:23], 0 offen offset:2064
  buffer_load_dwordx4 v[34:37], v6, s[20:23], 0 offen offset:3072
  buffer_load_dwordx2 v[38:39], v6, s[20:23], 0 offen offset:3088
  v_mov_b32 v7, 0
  buffer_load_dwordx2 v[44:45], v7, s[20:23], 0 offen
  s_lshl_b32 s40, s35, 1
  buffer_load_ushort v46, v7, s[24:27], s40 offen
  v_add_u32 v10, 1, v3
  v_and_b32 v10, 3, v10
  v_lshrrev_b32 v11, 1, v2
  v_and_b32 v12, 1, v2
  v_lshlrev_b32 v13, 4, v11
  v_add_u32 v13, v13, v3
  v_lshlrev_b32 v14, 3, v12
  v_sub_u32 v13, v13, v14
  v_add_u32 v13, 9, v13
  v_sub_u32 v13, v13, v10
  v_lshlrev_b32 v13, 1, v13
  v_mul_u32_u24 v10, 4160, v10
  v_add_u32 v13, v13, v10
  v_add_u32 v4, s36, v13
  v_sub_u32 v13, v3, v11
  v_lshlrev_b32 v13, 1, v13
  v_add_u32 v13, v13, v12
  v_lshlrev_b32 v13, 4, v13
  s_add_u32 s40, s36, 17152
  v_add_u32 v5, s40, v13
  s_waitcnt vmcnt(0)
  s_barrier
  v_mov_b32 v8, 0
  v_mov_b32 v9, 0
  v_lshlrev_b32 v10, 3, v1
  v_add_u32 v10, s36, v10
  ds_write_b64 v10, v[8:9] offset:16640
  v_lshlrev_b32 v10, 4, v1
  v_add_u32 v10, s36, v10
  v_alignbit_b32 v112, v17, v16, 16
  v_alignbit_b32 v113, v18, v17, 16
  v_alignbit_b32 v114, v19, v18, 16
  v_alignbit_b32 v115, v20, v19, 16
  v_mov_b32 v116, v17
  v_mov_b32 v117, v18
  v_mov_b32 v118, v19
  v_mov_b32 v119, v20
  v_mov_b32 v120, v113
  v_mov_b32 v121, v114
  v_mov_b32 v122, v115
  v_alignbit_b32 v123, v21, v20, 16
  ds_write_b128 v10, v[16:19] offset:32
  ds_write_b128 v10, v[112:115] offset:4192
  ds_write_b128 v10, v[116:119] offset:8352
  ds_write_b128 v10, v[120:123] offset:12512
  s_waitcnt lgkmcnt(4)
  v_alignbit_b32 v124, v23, v22, 16
  v_alignbit_b32 v125, v24, v23, 16
  v_alignbit_b32 v126, v25, v24, 16
  v_alignbit_b32 v127, v26, v25, 16
  v_mov_b32 v128, v23
  v_mov_b32 v129, v24
  v_mov_b32 v130, v25
  v_mov_b32 v131, v26
  v_mov_b32 v132, v125
  v_mov_b32 v133, v126
  v_mov_b32 v134, v127
  v_alignbit_b32 v135, v27, v26, 16
  ds_write_b128 v10, v[22:25] offset:1056
  ds_write_b128 v10, v[124:127] offset:5216
  ds_write_b128 v10, v[128:131] offset:9376
  ds_write_b128 v10, v[132:135] offset:13536
  s_waitcnt lgkmcnt(4)
  v_alignbit_b32 v136, v29, v28, 16
  v_alignbit_b32 v137, v30, v29, 16
  v_alignbit_b32 v138, v31, v30, 16
  v_alignbit_b32 v139, v32, v31, 16
  v_mov_b32 v140, v29
  v_mov_b32 v141, v30
  v_mov_b32 v142, v31
  v_mov_b32 v143, v32
  v_mov_b32 v144, v137
  v_mov_b32 v145, v138
  v_mov_b32 v146, v139
  v_alignbit_b32 v147, v33, v32, 16
  ds_write_b128 v10, v[28:31] offset:2080
  ds_write_b128 v10, v[136:139] offset:6240
  ds_write_b128 v10, v[140:143] offset:10400
  ds_write_b128 v10, v[144:147] offset:14560
  s_waitcnt lgkmcnt(4)
  v_alignbit_b32 v148, v35, v34, 16
  v_alignbit_b32 v149, v36, v35, 16
  v_alignbit_b32 v150, v37, v36, 16
  v_alignbit_b32 v151, v38, v37, 16
  v_mov_b32 v152, v35
  v_mov_b32 v153, v36
  v_mov_b32 v154, v37
  v_mov_b32 v155, v38
  v_mov_b32 v156, v149
  v_mov_b32 v157, v150
  v_mov_b32 v158, v151
  v_alignbit_b32 v159, v39, v38, 16
  ds_write_b128 v10, v[34:37] offset:3104
  ds_write_b128 v10, v[148:151] offset:7264
  ds_write_b128 v10, v[152:155] offset:11424
  ds_write_b128 v10, v[156:159] offset:15584
  s_waitcnt lgkmcnt(4)
  v_mov_b32 v40, 0
  v_mov_b32 v41, 0
  v_mov_b32 v42, 0
  v_mov_b32 v43, 0
  v_cmp_eq_u32 vcc, 1, v1
  s_nop 1
  v_cndmask_b32 v44, 0, v44, vcc
  v_cndmask_b32 v45, 0, v45, vcc
  s_waitcnt lgkmcnt(0)
  s_mov_b32 exec_lo, 0x3
  s_mov_b32 exec_hi, 0x0
  v_alignbit_b32 v112, v41, v40, 16
  v_alignbit_b32 v113, v42, v41, 16
  v_alignbit_b32 v114, v43, v42, 16
  v_alignbit_b32 v115, v44, v43, 16
  v_mov_b32 v116, v41
  v_mov_b32 v117, v42
  v_mov_b32 v118, v43
  v_mov_b32 v119, v44
  v_mov_b32 v120, v113
  v_mov_b32 v121, v114
  v_mov_b32 v122, v115
  v_alignbit_b32 v123, v45, v44, 16
  ds_write_b128 v10, v[40:43] offset:0
  ds_write_b128 v10, v[112:115] offset:4160
  ds_write_b128 v10, v[116:119] offset:8320
  ds_write_b128 v10, v[120:123] offset:12480
  s_mov_b64 exec, s[52:53]
  v_lshlrev_b32 v46, 16, v46
  v_mov_b32 v48, 0
  v_mov_b32 v49, 0
  v_mov_b32 v50, 0
  v_mov_b32 v51, 0
  v_mov_b32 v52, 0
  v_mov_b32 v53, 0
  v_mov_b32 v54, 0
  v_mov_b32 v55, 0
  v_mov_b32 v56, 0
  v_mov_b32 v57, 0
  v_mov_b32 v58, 0
  v_mov_b32 v59, 0
  v_mov_b32 v60, 0
  v_mov_b32 v61, 0
  v_mov_b32 v62, 0
  v_mov_b32 v63, 0
  v_mov_b32 v64, 0
  v_mov_b32 v65, 0
  v_mov_b32 v66, 0
  v_mov_b32 v67, 0
  v_mov_b32 v68, 0
  v_mov_b32 v69, 0
  v_mov_b32 v70, 0
  v_mov_b32 v71, 0
  v_mov_b32 v72, 0
  v_mov_b32 v73, 0
  v_mov_b32 v74, 0
  v_mov_b32 v75, 0
  v_mov_b32 v76, 0
  v_mov_b32 v77, 0
  v_mov_b32 v78, 0
  v_mov_b32 v79, 0
  v_lshlrev_b32 v6, 4, v1
  s_lshl_b32 s40, s35, 12
  s_add_u32 s40, s40, 6291456
  s_waitcnt lgkmcnt(0)
  s_barrier
  s_add_u32 m0, s36, 17152
  s_add_u32 s41, s40, 0
  buffer_load_dwordx4 v6, s[16:19], s41 offen sc1 lds
  s_add_u32 m0, s36, 18176
  s_add_u32 s41, s40, 1024
  buffer_load_dwordx4 v6, s[16:19], s41 offen sc1 lds
  s_add_u32 m0, s36, 19200
  s_add_u32 s41, s40, 2048
  buffer_load_dwordx4 v6, s[16:19], s41 offen sc1 lds
  s_add_u32 m0, s36, 20224
  s_add_u32 s41, s40, 3072
  buffer_load_dwordx4 v6, s[16:19], s41 offen sc1 lds
  ds_read_b64 v[80:81], v4 offset:0
  ds_read_b64 v[82:83], v4 offset:8
  ds_read_b64 v[84:85], v4 offset:512
  ds_read_b64 v[86:87], v4 offset:520
  ds_read_b64 v[88:89], v4 offset:1024
  ds_read_b64 v[90:91], v4 offset:1032
  ds_read_b64 v[92:93], v4 offset:1536
  ds_read_b64 v[94:95], v4 offset:1544
  s_waitcnt lgkmcnt(6)
  ds_read_b64 v[96:97], v4 offset:2048
  ds_read_b64 v[98:99], v4 offset:2056
  ds_read_b64 v[100:101], v4 offset:2560
  ds_read_b64 v[102:103], v4 offset:2568
  ds_read_b64 v[104:105], v4 offset:3072
  ds_read_b64 v[106:107], v4 offset:3080
  ds_read_b64 v[108:109], v4 offset:3584
  ds_read_b64 v[110:111], v4 offset:3592
  s_waitcnt lgkmcnt(6)
  s_waitcnt vmcnt(0)
  ds_read_b128 v[112:115], v5 offset:0
  ds_read_b128 v[116:119], v5 offset:512
  ds_read_b128 v[120:123], v5 offset:1024
  ds_read_b128 v[124:127], v5 offset:1536
  ds_read_b128 v[128:131], v5 offset:2048
  ds_read_b128 v[132:135], v5 offset:2560
  ds_read_b128 v[136:139], v5 offset:3072
  ds_read_b128 v[140:143], v5 offset:3584
  s_barrier
  s_mov_b32 s37, 0
F2_CLOOP:
  v_add_u32 v4, 64, v4
  v_subrev_u32 v5, 64, v5
  s_waitcnt lgkmcnt(0)
  v_mfma_f32_16x16x32_bf16 v[48:51], v[80:83], v[112:115], v[48:51]
  v_mfma_f32_16x16x32_bf16 v[52:55], v[80:83], v[116:119], v[52:55]
  v_mfma_f32_16x16x32_bf16 v[56:59], v[80:83], v[120:123], v[56:59]
  v_mfma_f32_16x16x32_bf16 v[60:63], v[80:83], v[124:127], v[60:63]
  v_mfma_f32_16x16x32_bf16 v[64:67], v[80:83], v[128:131], v[64:67]
  v_mfma_f32_16x16x32_bf16 v[68:71], v[80:83], v[132:135], v[68:71]
  v_mfma_f32_16x16x32_bf16 v[72:75], v[80:83], v[136:139], v[72:75]
  v_mfma_f32_16x16x32_bf16 v[76:79], v[80:83], v[140:143], v[76:79]
  ds_read_b64 v[80:81], v4 offset:0
  ds_read_b64 v[82:83], v4 offset:8
  ds_read_b128 v[140:143], v5 offset:3584
  v_mfma_f32_16x16x32_bf16 v[52:55], v[84:87], v[112:115], v[52:55]
  v_mfma_f32_16x16x32_bf16 v[56:59], v[84:87], v[116:119], v[56:59]
  v_mfma_f32_16x16x32_bf16 v[60:63], v[84:87], v[120:123], v[60:63]
  v_mfma_f32_16x16x32_bf16 v[64:67], v[84:87], v[124:127], v[64:67]
  v_mfma_f32_16x16x32_bf16 v[68:71], v[84:87], v[128:131], v[68:71]
  v_mfma_f32_16x16x32_bf16 v[72:75], v[84:87], v[132:135], v[72:75]
  v_mfma_f32_16x16x32_bf16 v[76:79], v[84:87], v[136:139], v[76:79]
  ds_read_b64 v[84:85], v4 offset:512
  ds_read_b64 v[86:87], v4 offset:520
  ds_read_b128 v[136:139], v5 offset:3072
  v_mfma_f32_16x16x32_bf16 v[56:59], v[88:91], v[112:115], v[56:59]
  v_mfma_f32_16x16x32_bf16 v[60:63], v[88:91], v[116:119], v[60:63]
  v_mfma_f32_16x16x32_bf16 v[64:67], v[88:91], v[120:123], v[64:67]
  v_mfma_f32_16x16x32_bf16 v[68:71], v[88:91], v[124:127], v[68:71]
  v_mfma_f32_16x16x32_bf16 v[72:75], v[88:91], v[128:131], v[72:75]
  v_mfma_f32_16x16x32_bf16 v[76:79], v[88:91], v[132:135], v[76:79]
  ds_read_b64 v[88:89], v4 offset:1024
  ds_read_b64 v[90:91], v4 offset:1032
  ds_read_b128 v[132:135], v5 offset:2560
  s_barrier
  v_mfma_f32_16x16x32_bf16 v[60:63], v[92:95], v[112:115], v[60:63]
  v_mfma_f32_16x16x32_bf16 v[64:67], v[92:95], v[116:119], v[64:67]
  v_mfma_f32_16x16x32_bf16 v[68:71], v[92:95], v[120:123], v[68:71]
  v_mfma_f32_16x16x32_bf16 v[72:75], v[92:95], v[124:127], v[72:75]
  v_mfma_f32_16x16x32_bf16 v[76:79], v[92:95], v[128:131], v[76:79]
  ds_read_b64 v[92:93], v4 offset:1536
  ds_read_b64 v[94:95], v4 offset:1544
  ds_read_b128 v[128:131], v5 offset:2048
  s_waitcnt lgkmcnt(6)
  v_mfma_f32_16x16x32_bf16 v[64:67], v[96:99], v[112:115], v[64:67]
  v_mfma_f32_16x16x32_bf16 v[68:71], v[96:99], v[116:119], v[68:71]
  v_mfma_f32_16x16x32_bf16 v[72:75], v[96:99], v[120:123], v[72:75]
  v_mfma_f32_16x16x32_bf16 v[76:79], v[96:99], v[124:127], v[76:79]
  ds_read_b64 v[96:97], v4 offset:2048
  ds_read_b64 v[98:99], v4 offset:2056
  ds_read_b128 v[124:127], v5 offset:1536
  v_mfma_f32_16x16x32_bf16 v[68:71], v[100:103], v[112:115], v[68:71]
  v_mfma_f32_16x16x32_bf16 v[72:75], v[100:103], v[116:119], v[72:75]
  v_mfma_f32_16x16x32_bf16 v[76:79], v[100:103], v[120:123], v[76:79]
  ds_read_b64 v[100:101], v4 offset:2560
  ds_read_b64 v[102:103], v4 offset:2568
  ds_read_b128 v[120:123], v5 offset:1024
  v_mfma_f32_16x16x32_bf16 v[72:75], v[104:107], v[112:115], v[72:75]
  v_mfma_f32_16x16x32_bf16 v[76:79], v[104:107], v[116:119], v[76:79]
  ds_read_b64 v[104:105], v4 offset:3072
  ds_read_b64 v[106:107], v4 offset:3080
  ds_read_b128 v[116:119], v5 offset:512
  s_waitcnt lgkmcnt(6)
  v_mfma_f32_16x16x32_bf16 v[76:79], v[108:111], v[112:115], v[76:79]
  ds_read_b64 v[108:109], v4 offset:3584
  ds_read_b64 v[110:111], v4 offset:3592
  ds_read_b128 v[112:115], v5 offset:0
  s_barrier
  s_add_u32 s37, s37, 1
  s_cmp_lt_u32 s37, 8
  s_cbranch_scc1 F2_CLOOP
  s_waitcnt lgkmcnt(0)
  v_lshlrev_b32 v6, 5, v3
  v_lshrrev_b32 v7, 1, v2
  v_lshlrev_b32 v7, 4, v7
  v_add_u32 v6, v6, v7
  v_and_b32 v7, 1, v2
  v_xor_b32 v7, 1, v7
  v_lshlrev_b32 v7, 3, v7
  v_add_u32 v6, v6, v7
  s_add_u32 s40, s36, 17152
  v_add_u32 v6, s40, v6
  ds_read_b64 v[80:81], v6 offset:0
  ds_read_b64 v[82:83], v6 offset:512
  ds_read_b64 v[84:85], v6 offset:1024
  ds_read_b64 v[86:87], v6 offset:1536
  ds_read_b64 v[88:89], v6 offset:2048
  ds_read_b64 v[90:91], v6 offset:2560
  ds_read_b64 v[92:93], v6 offset:3072
  ds_read_b64 v[94:95], v6 offset:3584
  v_lshlrev_b32 v8, 5, v3
  v_lshlrev_b32 v9, 3, v2
  v_add_u32 v8, v8, v9
  s_lshl_b32 s40, s35, 12
  s_add_u32 s40, s40, 9437184
  s_barrier
  s_waitcnt lgkmcnt(0)
  v_and_b32 v112, s47, v81
  v_lshlrev_b32 v113, 16, v81
  v_and_b32 v114, s47, v80
  v_lshlrev_b32 v115, 16, v80
  v_fmac_f32 v48, v112, v46
  v_fmac_f32 v49, v113, v46
  v_fmac_f32 v50, v114, v46
  v_fmac_f32 v51, v115, v46
  v_cvt_pk_bf16_f32 v116, v48, v49
  v_cvt_pk_bf16_f32 v117, v50, v51
  buffer_store_dwordx2 v[116:117], v8, s[16:19], s40 offen offset:0 sc1
  v_and_b32 v120, s47, v83
  v_lshlrev_b32 v121, 16, v83
  v_and_b32 v122, s47, v82
  v_lshlrev_b32 v123, 16, v82
  v_fmac_f32 v52, v120, v46
  v_fmac_f32 v53, v121, v46
  v_fmac_f32 v54, v122, v46
  v_fmac_f32 v55, v123, v46
  v_cvt_pk_bf16_f32 v124, v52, v53
  v_cvt_pk_bf16_f32 v125, v54, v55
  buffer_store_dwordx2 v[124:125], v8, s[16:19], s40 offen offset:512 sc1
  v_and_b32 v128, s47, v85
  v_lshlrev_b32 v129, 16, v85
  v_and_b32 v130, s47, v84
  v_lshlrev_b32 v131, 16, v84
  v_fmac_f32 v56, v128, v46
  v_fmac_f32 v57, v129, v46
  v_fmac_f32 v58, v130, v46
  v_fmac_f32 v59, v131, v46
  v_cvt_pk_bf16_f32 v132, v56, v57
  v_cvt_pk_bf16_f32 v133, v58, v59
  buffer_store_dwordx2 v[132:133], v8, s[16:19], s40 offen offset:1024 sc1
  v_and_b32 v136, s47, v87
  v_lshlrev_b32 v137, 16, v87
  v_and_b32 v138, s47, v86
  v_lshlrev_b32 v139, 16, v86
  v_fmac_f32 v60, v136, v46
  v_fmac_f32 v61, v137, v46
  v_fmac_f32 v62, v138, v46
  v_fmac_f32 v63, v139, v46
  v_cvt_pk_bf16_f32 v140, v60, v61
  v_cvt_pk_bf16_f32 v141, v62, v63
  buffer_store_dwordx2 v[140:141], v8, s[16:19], s40 offen offset:1536 sc1
  v_and_b32 v112, s47, v89
  v_lshlrev_b32 v113, 16, v89
  v_and_b32 v114, s47, v88
  v_lshlrev_b32 v115, 16, v88
  v_fmac_f32 v64, v112, v46
  v_fmac_f32 v65, v113, v46
  v_fmac_f32 v66, v114, v46
  v_fmac_f32 v67, v115, v46
  v_cvt_pk_bf16_f32 v116, v64, v65
  v_cvt_pk_bf16_f32 v117, v66, v67
  buffer_store_dwordx2 v[116:117], v8, s[16:19], s40 offen offset:2048 sc1
  v_and_b32 v120, s47, v91
  v_lshlrev_b32 v121, 16, v91
  v_and_b32 v122, s47, v90
  v_lshlrev_b32 v123, 16, v90
  v_fmac_f32 v68, v120, v46
  v_fmac_f32 v69, v121, v46
  v_fmac_f32 v70, v122, v46
  v_fmac_f32 v71, v123, v46
  v_cvt_pk_bf16_f32 v124, v68, v69
  v_cvt_pk_bf16_f32 v125, v70, v71
  buffer_store_dwordx2 v[124:125], v8, s[16:19], s40 offen offset:2560 sc1
  v_and_b32 v128, s47, v93
  v_lshlrev_b32 v129, 16, v93
  v_and_b32 v130, s47, v92
  v_lshlrev_b32 v131, 16, v92
  v_fmac_f32 v72, v128, v46
  v_fmac_f32 v73, v129, v46
  v_fmac_f32 v74, v130, v46
  v_fmac_f32 v75, v131, v46
  v_cvt_pk_bf16_f32 v132, v72, v73
  v_cvt_pk_bf16_f32 v133, v74, v75
  buffer_store_dwordx2 v[132:133], v8, s[16:19], s40 offen offset:3072 sc1
  v_and_b32 v136, s47, v95
  v_lshlrev_b32 v137, 16, v95
  v_and_b32 v138, s47, v94
  v_lshlrev_b32 v139, 16, v94
  v_fmac_f32 v76, v136, v46
  v_fmac_f32 v77, v137, v46
  v_fmac_f32 v78, v138, v46
  v_fmac_f32 v79, v139, v46
  v_cvt_pk_bf16_f32 v140, v76, v77
  v_cvt_pk_bf16_f32 v141, v78, v79
  buffer_store_dwordx2 v[140:141], v8, s[16:19], s40 offen offset:3584 sc1
  s_waitcnt vmcnt(0)
  s_barrier
F3_IDLE:
  s_barrier
  s_barrier
  s_barrier
  s_barrier
  s_barrier
  s_barrier
  s_barrier
  s_endpgm
F2_IDLE:
  s_waitcnt vmcnt(0)
  s_barrier
  s_barrier
  s_barrier
  s_barrier
  s_barrier
  s_barrier
  s_barrier
  s_barrier
  s_barrier
  s_barrier
  s_barrier
  s_barrier
  s_barrier
  s_barrier
  s_barrier
  s_barrier
  s_barrier
  s_barrier
  s_barrier
  s_barrier
  s_barrier
  s_branch F3_IDLE
F2_SYNC:
  v_lshlrev_b32 v6, 2, v1
  s_mov_b32 s42, 0
  s_mov_b32 exec_lo, 0xffffffff
  s_mov_b32 exec_hi, 0x0
FP_CNT:
  buffer_load_dword v7, v6, s[4:7], 0 offen sc1
  s_waitcnt vmcnt(0)
  v_cmp_gt_u32 vcc, 8, v7
  s_add_u32 s42, s42, 1
  s_cmp_eq_u64 vcc, 0
  s_cbranch_scc1 FP_CNT_OK
  s_cmp_lt_u32 s42, 2097152
  s_cbranch_scc0 FP_CNT_OK
  s_sleep 1
  s_branch FP_CNT
FP_CNT_OK:
  s_mov_b64 exec, s[52:53]
  s_lshl_b32 s40, s33, 7
  s_lshl_b32 s41, s32, 2
  s_add_u32 s40, s40, s41
  s_add_u32 s41, s40, 17040384
  s_add_u32 s40, s40, 17039360
  v_mov_b32 v8, s40
  v_mov_b32 v9, s41
  v_cmp_eq_u32 vcc, 1, v1
  s_nop 1
  v_cndmask_b32 v8, v8, v9, vcc
  s_lshl_b32 s40, s32, 5
  s_lshl_b32 s41, s33, 2
  s_add_u32 s40, s40, s41
  s_add_u32 s40, s40, 17041408
  v_mov_b32 v9, s40
  v_cmp_eq_u32 vcc, 2, v1
  s_nop 1
  v_cndmask_b32 v8, v8, v9, vcc
  v_mov_b32 v10, 1
  s_waitcnt vmcnt(0)
  s_barrier
  s_mov_b32 exec_lo, 0x1
  s_mov_b32 exec_hi, 0x0
  buffer_store_dword v10, v8, s[16:19], 0 offen sc1
  s_mov_b64 exec, s[52:53]
  s_lshl_b32 s40, s33, 7
  s_add_u32 s40, s40, 17039360
  v_lshlrev_b32 v6, 2, v1
  v_add_u32 v6, s40, v6
  s_mov_b32 s42, 0
  s_mov_b32 exec_lo, 0xffffffff
  s_mov_b32 exec_hi, 0x0
FP_F1:
  buffer_load_dword v7, v6, s[16:19], 0 offen sc1
  s_waitcnt vmcnt(0)
  v_cmp_ne_u32 vcc, 1, v7
  s_add_u32 s42, s42, 1
  s_cmp_eq_u64 vcc, 0
  s_cbranch_scc1 FP_F1_OK
  s_cmp_lt_u32 s42, 2097152
  s_cbranch_scc0 FP_F1_OK
  s_sleep 1
  s_branch FP_F1
FP_F1_OK:
  s_mov_b64 exec, s[52:53]
  s_barrier
  s_barrier
  s_barrier
  s_barrier
  s_barrier
  s_barrier
  s_barrier
  s_barrier
  s_barrier
  s_barrier
  s_barrier
  s_barrier
  s_barrier
  s_barrier
  s_barrier
  s_barrier
  s_barrier
  s_barrier
  s_barrier
  s_barrier
  s_mov_b32 exec_lo, 0x6
  s_mov_b32 exec_hi, 0x0
  buffer_store_dword v10, v8, s[16:19], 0 offen sc1
  s_mov_b64 exec, s[52:53]
  s_lshl_b32 s40, s33, 7
  s_add_u32 s40, s40, 17040384
  v_lshlrev_b32 v6, 2, v1
  v_add_u32 v11, s40, v6
  s_lshl_b32 s40, s32, 5
  s_add_u32 s40, s40, 17041280
  v_add_u32 v12, s40, v6
  v_cmp_gt_u32 vcc, 32, v1
  s_nop 1
  v_cndmask_b32 v6, v12, v11, vcc
  s_mov_b32 s42, 0
  s_mov_b32 exec_lo, 0xffffffff
  s_mov_b32 exec_hi, 0xff
FP_F2:
  buffer_load_dword v7, v6, s[16:19], 0 offen sc1
  s_waitcnt vmcnt(0)
  v_cmp_ne_u32 vcc, 1, v7
  s_add_u32 s42, s42, 1
  s_cmp_eq_u64 vcc, 0
  s_cbranch_scc1 FP_F2_OK
  s_cmp_lt_u32 s42, 2097152
  s_cbranch_scc0 FP_F2_OK
  s_sleep 1
  s_branch FP_F2
FP_F2_OK:
  s_mov_b64 exec, s[52:53]
  s_branch F3_IDLE
K1_END:
  s_endpgm

.section .rodata,"a"
.p2align 6
.amdhsa_kernel recurrent_scan__ssm_conv_h3__mixer_gmlp__prompt_kernel
  .amdhsa_next_free_vgpr 168
  .amdhsa_next_free_sgpr 96
  .amdhsa_accum_offset 168
  .amdhsa_group_segment_fixed_size 0
  .amdhsa_kernarg_size 112
  .amdhsa_user_sgpr_count 2
  .amdhsa_user_sgpr_kernarg_segment_ptr 1
  .amdhsa_system_sgpr_workgroup_id_x 1
  .amdhsa_float_denorm_mode_32 3
.end_amdhsa_kernel
.text
```

```asm
; @launch grid=(256,1,1) block=(768,1,1) lds=159744
.amdgcn_target "amdgcn-amd-amdhsa--gfx950"
.text
.globl recurrent_scan__ssm_conv_h3__mixer_gmlp__prompt_kernel
.p2align 8
.type recurrent_scan__ssm_conv_h3__mixer_gmlp__prompt_kernel,@function
recurrent_scan__ssm_conv_h3__mixer_gmlp__prompt_kernel:
  s_cmp_ge_u32 s2, 256
  s_cbranch_scc1 K1_END
  s_load_dwordx4 s[56:59], s[0:1], 0
  s_load_dwordx4 s[60:63], s[0:1], 16
  s_load_dwordx2 s[64:65], s[0:1], 56
  s_load_dwordx2 s[66:67], s[0:1], 80
  s_load_dwordx4 s[68:71], s[0:1], 96
  s_load_dwordx2 s[74:75], s[0:1], 64
  s_load_dwordx2 s[76:77], s[0:1], 32
  v_and_b32 v1, 63, v0
  v_lshrrev_b32 v14, 6, v0
  v_lshrrev_b32 v2, 4, v1
  v_readfirstlane_b32 s34, v14
  v_and_b32 v3, 15, v1
  s_and_b32 s40, s2, 7
  s_lshr_b32 s41, s2, 3
  s_lshr_b32 s32, s40, 1
  s_lshl_b32 s32, s32, 3
  s_lshr_b32 s42, s41, 2
  s_add_u32 s32, s32, s42
  s_and_b32 s33, s40, 1
  s_lshl_b32 s33, s33, 2
  s_and_b32 s42, s41, 3
  s_add_u32 s33, s33, s42
  s_and_b32 s55, s34, 3
  s_lshr_b32 s35, s55, 1
  s_and_b32 s36, s55, 1
  s_mov_b32 s47, 0xffff0000
  s_mov_b64 s[52:53], exec
  s_mul_i32 s44, s33, 192
  s_add_u32 s43, s44, 1536
  s_cmp_ge_u32 s34, 8
  s_cbranch_scc0 K1_AB
  s_lshl_b32 s40, s32, 6
  s_lshl_b32 s41, s55, 3
  s_add_u32 s40, s40, s41
  s_lshl_b32 s45, s55, 10
  v_lshrrev_b32 v30, 3, v1
  v_add_u32 v32, s41, v30
  v_lshrrev_b32 v31, 1, v32
  v_xor_b32 v31, v31, v1
  v_and_b32 v31, 7, v31
  v_lshlrev_b32 v31, 4, v31
  v_add_u32 v30, s40, v30
  v_mul_u32_u24 v30, 1280, v30
  v_add_u32 v8, v30, v31
  v_add_u32 v9, 40960, v8
  s_waitcnt lgkmcnt(0)
  s_mov_b32 s8, s56
  s_and_b32 s9, s57, 0xffff
  s_mov_b32 s10, 2621440
  s_mov_b32 s11, 0x20000
  s_mov_b32 s12, s64
  s_and_b32 s13, s65, 0xffff
  s_mov_b32 s14, 1966080
  s_mov_b32 s15, 0x20000
  s_and_b32 s40, s32, 7
  s_and_b32 s41, s33, 3
  s_mul_i32 s41, s41, 3
  s_add_u32 s37, s40, s41
  s_sub_u32 s40, s37, 10
  s_cmp_ge_u32 s37, 10
  s_cselect_b32 s37, s40, s37
  s_lshl_b32 s40, s55, 6
  s_add_u32 s40, s40, 0
  v_add_u32 v30, s40, v1
  v_mul_u32_u24 v31, 5462, v30
  v_lshrrev_b32 v31, 16, v31
  v_mul_u32_u24 v32, 12, v31
  v_sub_u32 v32, v30, v32
  v_lshrrev_b32 v33, 2, v31
  v_and_b32 v33, 2, v33
  v_xor_b32 v32, v32, v33
  v_lshlrev_b32 v32, 4, v32
  v_mul_u32_u24 v31, 3072, v31
  v_add_u32 v12, v31, v32
  s_lshl_b32 s40, s55, 6
  s_add_u32 s40, s40, 256
  v_add_u32 v30, s40, v1
  v_mul_u32_u24 v31, 5462, v30
  v_lshrrev_b32 v31, 16, v31
  v_mul_u32_u24 v32, 12, v31
  v_sub_u32 v32, v30, v32
  v_lshrrev_b32 v33, 2, v31
  v_and_b32 v33, 2, v33
  v_xor_b32 v32, v32, v33
  v_lshlrev_b32 v32, 4, v32
  v_mul_u32_u24 v31, 3072, v31
  v_add_u32 v13, v31, v32
  s_lshl_b32 s40, s55, 6
  s_add_u32 s40, s40, 512
  v_add_u32 v30, s40, v1
  v_mul_u32_u24 v31, 5462, v30
  v_lshrrev_b32 v31, 16, v31
  v_mul_u32_u24 v32, 12, v31
  v_sub_u32 v32, v30, v32
  v_lshrrev_b32 v33, 2, v31
  v_and_b32 v33, 2, v33
  v_xor_b32 v32, v32, v33
  v_lshlrev_b32 v32, 4, v32
  v_mul_u32_u24 v31, 3072, v31
  v_add_u32 v14, v31, v32
  s_add_u32 s38, s37, 0
  s_sub_u32 s40, s38, 10
  s_cmp_ge_u32 s38, 10
  s_cselect_b32 s38, s40, s38
  s_lshl_b32 s38, s38, 7
  s_add_u32 m0, s45, 61440
  s_nop 0
  buffer_load_dwordx4 v8, s[8:11], s38 offen  lds
  s_add_u32 m0, s45, 65536
  s_nop 0
  buffer_load_dwordx4 v9, s[8:11], s38 offen  lds
  s_add_u32 s39, s37, 0
  s_sub_u32 s40, s39, 10
  s_cmp_ge_u32 s39, 10
  s_cselect_b32 s39, s40, s39
  s_mul_i32 s39, s39, 196608
  s_add_u32 s39, s39, s43
  s_add_u32 m0, s45, 0
  s_nop 0
  buffer_load_dwordx4 v12, s[12:15], s39 offen  lds
  s_add_u32 m0, s45, 4096
  s_nop 0
  buffer_load_dwordx4 v13, s[12:15], s39 offen  lds
  s_add_u32 m0, s45, 8192
  s_nop 0
  buffer_load_dwordx4 v14, s[12:15], s39 offen  lds
  s_add_u32 s38, s37, 1
  s_sub_u32 s40, s38, 10
  s_cmp_ge_u32 s38, 10
  s_cselect_b32 s38, s40, s38
  s_lshl_b32 s38, s38, 7
  s_add_u32 m0, s45, 69632
  s_nop 0
  buffer_load_dwordx4 v8, s[8:11], s38 offen  lds
  s_add_u32 m0, s45, 73728
  s_nop 0
  buffer_load_dwordx4 v9, s[8:11], s38 offen  lds
  s_add_u32 s39, s37, 1
  s_sub_u32 s40, s39, 10
  s_cmp_ge_u32 s39, 10
  s_cselect_b32 s39, s40, s39
  s_mul_i32 s39, s39, 196608
  s_add_u32 s39, s39, s43
  s_add_u32 m0, s45, 12288
  s_nop 0
  buffer_load_dwordx4 v12, s[12:15], s39 offen  lds
  s_add_u32 m0, s45, 16384
  s_nop 0
  buffer_load_dwordx4 v13, s[12:15], s39 offen  lds
  s_add_u32 m0, s45, 20480
  s_nop 0
  buffer_load_dwordx4 v14, s[12:15], s39 offen  lds
  s_waitcnt vmcnt(5)
  s_barrier
  s_add_u32 s38, s37, 2
  s_sub_u32 s40, s38, 10
  s_cmp_ge_u32 s38, 10
  s_cselect_b32 s38, s40, s38
  s_lshl_b32 s38, s38, 7
  s_add_u32 m0, s45, 77824
  s_nop 0
  buffer_load_dwordx4 v8, s[8:11], s38 offen  lds
  s_add_u32 m0, s45, 81920
  s_nop 0
  buffer_load_dwordx4 v9, s[8:11], s38 offen  lds
  s_add_u32 s39, s37, 2
  s_sub_u32 s40, s39, 10
  s_cmp_ge_u32 s39, 10
  s_cselect_b32 s39, s40, s39
  s_mul_i32 s39, s39, 196608
  s_add_u32 s39, s39, s43
  s_add_u32 m0, s45, 24576
  s_nop 0
  buffer_load_dwordx4 v12, s[12:15], s39 offen  lds
  s_add_u32 m0, s45, 28672
  s_nop 0
  buffer_load_dwordx4 v13, s[12:15], s39 offen  lds
  s_add_u32 m0, s45, 32768
  s_nop 0
  buffer_load_dwordx4 v14, s[12:15], s39 offen  lds
  s_add_u32 s38, s37, 3
  s_sub_u32 s40, s38, 10
  s_cmp_ge_u32 s38, 10
  s_cselect_b32 s38, s40, s38
  s_lshl_b32 s38, s38, 7
  s_add_u32 m0, s45, 86016
  s_nop 0
  buffer_load_dwordx4 v8, s[8:11], s38 offen  lds
  s_add_u32 m0, s45, 90112
  s_nop 0
  buffer_load_dwordx4 v9, s[8:11], s38 offen  lds
  s_add_u32 s39, s37, 3
  s_sub_u32 s40, s39, 10
  s_cmp_ge_u32 s39, 10
  s_cselect_b32 s39, s40, s39
  s_mul_i32 s39, s39, 196608
  s_add_u32 s39, s39, s43
  s_add_u32 m0, s45, 36864
  s_nop 0
  buffer_load_dwordx4 v12, s[12:15], s39 offen  lds
  s_add_u32 m0, s45, 40960
  s_nop 0
  buffer_load_dwordx4 v13, s[12:15], s39 offen  lds
  s_add_u32 m0, s45, 45056
  s_nop 0
  buffer_load_dwordx4 v14, s[12:15], s39 offen  lds
  s_waitcnt vmcnt(10)
  s_barrier
  s_add_u32 s38, s37, 4
  s_sub_u32 s40, s38, 10
  s_cmp_ge_u32 s38, 10
  s_cselect_b32 s38, s40, s38
  s_lshl_b32 s38, s38, 7
  s_add_u32 m0, s45, 94208
  s_nop 0
  buffer_load_dwordx4 v8, s[8:11], s38 offen  lds
  s_add_u32 m0, s45, 98304
  s_nop 0
  buffer_load_dwordx4 v9, s[8:11], s38 offen  lds
  s_add_u32 s39, s37, 4
  s_sub_u32 s40, s39, 10
  s_cmp_ge_u32 s39, 10
  s_cselect_b32 s39, s40, s39
  s_mul_i32 s39, s39, 196608
  s_add_u32 s39, s39, s43
  s_add_u32 m0, s45, 49152
  s_nop 0
  buffer_load_dwordx4 v12, s[12:15], s39 offen  lds
  s_add_u32 m0, s45, 53248
  s_nop 0
  buffer_load_dwordx4 v13, s[12:15], s39 offen  lds
  s_add_u32 m0, s45, 57344
  s_nop 0
  buffer_load_dwordx4 v14, s[12:15], s39 offen  lds
  s_add_u32 s38, s37, 5
  s_sub_u32 s40, s38, 10
  s_cmp_ge_u32 s38, 10
  s_cselect_b32 s38, s40, s38
  s_lshl_b32 s38, s38, 7
  s_add_u32 m0, s45, 102400
  s_nop 0
  buffer_load_dwordx4 v8, s[8:11], s38 offen  lds
  s_add_u32 m0, s45, 106496
  s_nop 0
  buffer_load_dwordx4 v9, s[8:11], s38 offen  lds
  s_waitcnt vmcnt(12)
  s_barrier
  s_add_u32 s38, s37, 6
  s_sub_u32 s40, s38, 10
  s_cmp_ge_u32 s38, 10
  s_cselect_b32 s38, s40, s38
  s_lshl_b32 s38, s38, 7
  s_add_u32 m0, s45, 110592
  s_nop 0
  buffer_load_dwordx4 v8, s[8:11], s38 offen  lds
  s_add_u32 m0, s45, 114688
  s_nop 0
  buffer_load_dwordx4 v9, s[8:11], s38 offen  lds
  s_add_u32 s39, s37, 5
  s_sub_u32 s40, s39, 10
  s_cmp_ge_u32 s39, 10
  s_cselect_b32 s39, s40, s39
  s_mul_i32 s39, s39, 196608
  s_add_u32 s39, s39, s43
  s_add_u32 m0, s45, 0
  s_nop 0
  buffer_load_dwordx4 v12, s[12:15], s39 offen  lds
  s_add_u32 m0, s45, 4096
  s_nop 0
  buffer_load_dwordx4 v13, s[12:15], s39 offen  lds
  s_add_u32 m0, s45, 8192
  s_nop 0
  buffer_load_dwordx4 v14, s[12:15], s39 offen  lds
  s_add_u32 s38, s37, 7
  s_sub_u32 s40, s38, 10
  s_cmp_ge_u32 s38, 10
  s_cselect_b32 s38, s40, s38
  s_lshl_b32 s38, s38, 7
  s_add_u32 m0, s45, 118784
  s_nop 0
  buffer_load_dwordx4 v8, s[8:11], s38 offen  lds
  s_add_u32 m0, s45, 122880
  s_nop 0
  buffer_load_dwordx4 v9, s[8:11], s38 offen  lds
  s_waitcnt vmcnt(14)
  s_barrier
  s_add_u32 s38, s37, 8
  s_sub_u32 s40, s38, 10
  s_cmp_ge_u32 s38, 10
  s_cselect_b32 s38, s40, s38
  s_lshl_b32 s38, s38, 7
  s_add_u32 m0, s45, 126976
  s_nop 0
  buffer_load_dwordx4 v8, s[8:11], s38 offen  lds
  s_add_u32 m0, s45, 131072
  s_nop 0
  buffer_load_dwordx4 v9, s[8:11], s38 offen  lds
  s_add_u32 s39, s37, 6
  s_sub_u32 s40, s39, 10
  s_cmp_ge_u32 s39, 10
  s_cselect_b32 s39, s40, s39
  s_mul_i32 s39, s39, 196608
  s_add_u32 s39, s39, s43
  s_add_u32 m0, s45, 12288
  s_nop 0
  buffer_load_dwordx4 v12, s[12:15], s39 offen  lds
  s_add_u32 m0, s45, 16384
  s_nop 0
  buffer_load_dwordx4 v13, s[12:15], s39 offen  lds
  s_add_u32 m0, s45, 20480
  s_nop 0
  buffer_load_dwordx4 v14, s[12:15], s39 offen  lds
  s_add_u32 s38, s37, 9
  s_sub_u32 s40, s38, 10
  s_cmp_ge_u32 s38, 10
  s_cselect_b32 s38, s40, s38
  s_lshl_b32 s38, s38, 7
  s_add_u32 m0, s45, 135168
  s_nop 0
  buffer_load_dwordx4 v8, s[8:11], s38 offen  lds
  s_add_u32 m0, s45, 139264
  s_nop 0
  buffer_load_dwordx4 v9, s[8:11], s38 offen  lds
  s_waitcnt vmcnt(16)
  s_barrier
  s_add_u32 s39, s37, 7
  s_sub_u32 s40, s39, 10
  s_cmp_ge_u32 s39, 10
  s_cselect_b32 s39, s40, s39
  s_mul_i32 s39, s39, 196608
  s_add_u32 s39, s39, s43
  s_add_u32 m0, s45, 24576
  s_nop 0
  buffer_load_dwordx4 v12, s[12:15], s39 offen  lds
  s_add_u32 m0, s45, 28672
  s_nop 0
  buffer_load_dwordx4 v13, s[12:15], s39 offen  lds
  s_add_u32 m0, s45, 32768
  s_nop 0
  buffer_load_dwordx4 v14, s[12:15], s39 offen  lds
  s_waitcnt vmcnt(12)
  s_barrier
  s_add_u32 s39, s37, 8
  s_sub_u32 s40, s39, 10
  s_cmp_ge_u32 s39, 10
  s_cselect_b32 s39, s40, s39
  s_mul_i32 s39, s39, 196608
  s_add_u32 s39, s39, s43
  s_add_u32 m0, s45, 36864
  s_nop 0
  buffer_load_dwordx4 v12, s[12:15], s39 offen  lds
  s_add_u32 m0, s45, 40960
  s_nop 0
  buffer_load_dwordx4 v13, s[12:15], s39 offen  lds
  s_add_u32 m0, s45, 45056
  s_nop 0
  buffer_load_dwordx4 v14, s[12:15], s39 offen  lds
  s_add_u32 s39, s37, 9
  s_sub_u32 s40, s39, 10
  s_cmp_ge_u32 s39, 10
  s_cselect_b32 s39, s40, s39
  s_mul_i32 s39, s39, 196608
  s_add_u32 s39, s39, s43
  s_add_u32 m0, s45, 49152
  s_nop 0
  buffer_load_dwordx4 v12, s[12:15], s39 offen  lds
  s_add_u32 m0, s45, 53248
  s_nop 0
  buffer_load_dwordx4 v13, s[12:15], s39 offen  lds
  s_add_u32 m0, s45, 57344
  s_nop 0
  buffer_load_dwordx4 v14, s[12:15], s39 offen  lds
  s_waitcnt vmcnt(11)
  s_barrier
  s_add_u32 s39, s37, 0
  s_sub_u32 s40, s39, 10
  s_cmp_ge_u32 s39, 10
  s_cselect_b32 s39, s40, s39
  s_mul_i32 s39, s39, 196608
  s_add_u32 s39, s39, s44
  s_add_u32 m0, s45, 0
  s_nop 0
  buffer_load_dwordx4 v12, s[12:15], s39 offen  lds
  s_add_u32 m0, s45, 4096
  s_nop 0
  buffer_load_dwordx4 v13, s[12:15], s39 offen  lds
  s_add_u32 m0, s45, 8192
  s_nop 0
  buffer_load_dwordx4 v14, s[12:15], s39 offen  lds
  s_waitcnt vmcnt(9)
  s_barrier
  s_add_u32 s39, s37, 1
  s_sub_u32 s40, s39, 10
  s_cmp_ge_u32 s39, 10
  s_cselect_b32 s39, s40, s39
  s_mul_i32 s39, s39, 196608
  s_add_u32 s39, s39, s44
  s_add_u32 m0, s45, 12288
  s_nop 0
  buffer_load_dwordx4 v12, s[12:15], s39 offen  lds
  s_add_u32 m0, s45, 16384
  s_nop 0
  buffer_load_dwordx4 v13, s[12:15], s39 offen  lds
  s_add_u32 m0, s45, 20480
  s_nop 0
  buffer_load_dwordx4 v14, s[12:15], s39 offen  lds
  s_waitcnt vmcnt(9)
  s_barrier
  s_add_u32 s39, s37, 2
  s_sub_u32 s40, s39, 10
  s_cmp_ge_u32 s39, 10
  s_cselect_b32 s39, s40, s39
  s_mul_i32 s39, s39, 196608
  s_add_u32 s39, s39, s44
  s_add_u32 m0, s45, 24576
  s_nop 0
  buffer_load_dwordx4 v12, s[12:15], s39 offen  lds
  s_add_u32 m0, s45, 28672
  s_nop 0
  buffer_load_dwordx4 v13, s[12:15], s39 offen  lds
  s_add_u32 m0, s45, 32768
  s_nop 0
  buffer_load_dwordx4 v14, s[12:15], s39 offen  lds
  s_waitcnt vmcnt(9)
  s_barrier
  s_add_u32 s39, s37, 3
  s_sub_u32 s40, s39, 10
  s_cmp_ge_u32 s39, 10
  s_cselect_b32 s39, s40, s39
  s_mul_i32 s39, s39, 196608
  s_add_u32 s39, s39, s44
  s_add_u32 m0, s45, 36864
  s_nop 0
  buffer_load_dwordx4 v12, s[12:15], s39 offen  lds
  s_add_u32 m0, s45, 40960
  s_nop 0
  buffer_load_dwordx4 v13, s[12:15], s39 offen  lds
  s_add_u32 m0, s45, 45056
  s_nop 0
  buffer_load_dwordx4 v14, s[12:15], s39 offen  lds
  s_waitcnt vmcnt(9)
  s_barrier
  s_add_u32 s39, s37, 4
  s_sub_u32 s40, s39, 10
  s_cmp_ge_u32 s39, 10
  s_cselect_b32 s39, s40, s39
  s_mul_i32 s39, s39, 196608
  s_add_u32 s39, s39, s44
  s_add_u32 m0, s45, 49152
  s_nop 0
  buffer_load_dwordx4 v12, s[12:15], s39 offen  lds
  s_add_u32 m0, s45, 53248
  s_nop 0
  buffer_load_dwordx4 v13, s[12:15], s39 offen  lds
  s_add_u32 m0, s45, 57344
  s_nop 0
  buffer_load_dwordx4 v14, s[12:15], s39 offen  lds
  v_mul_u32_u24 v5, 6554, v1
  v_lshrrev_b32 v5, 16, v5
  v_mul_u32_u24 v4, 10, v5
  v_sub_u32 v4, v1, v4
  v_lshlrev_b32 v4, 4, v4
  v_mul_u32_u24 v30, 1280, v5
  v_add_u32 v4, v4, v30
  s_mov_b32 s20, s58
  s_and_b32 s21, s59, 0xffff
  s_mov_b32 s22, 2621440
  s_mov_b32 s23, 0x20000
  s_mov_b32 s24, s60
  s_and_b32 s25, s61, 0xffff
  s_mov_b32 s26, 2621440
  s_mov_b32 s27, 0x20000
  s_lshl_b32 s40, s32, 6
  s_lshl_b32 s41, s55, 4
  s_add_u32 s40, s40, s41
  s_mul_i32 s46, s40, 1280
  s_mul_i32 s41, s33, 160
  s_add_u32 s46, s46, s41
  s_mul_i32 s78, s55, 6720
  s_add_u32 s78, s78, 61440
  v_mov_b32 v20, v4
  s_sub_u32 s79, s46, 3840
  s_cmp_eq_u32 s40, 0
  s_cbranch_scc0 K1_NONNEG
  v_subrev_u32 v20, 3840, v4
  v_cmp_gt_u32 vcc, 3, v5
  v_mov_b32 v31, 0x80000000
  s_nop 0
  v_cndmask_b32 v20, v20, v31, vcc
  s_mov_b32 s79, s46
K1_NONNEG:
  s_mov_b32 s28, s62
  s_and_b32 s29, s63, 0xffff
  s_mov_b32 s30, 5120
  s_mov_b32 s31, 0x20000
  v_lshlrev_b32 v21, 4, v1
  s_mul_i32 s54, s33, 640
  s_waitcnt vmcnt(9)
  s_barrier
  s_add_u32 s39, s37, 5
  s_sub_u32 s40, s39, 10
  s_cmp_ge_u32 s39, 10
  s_cselect_b32 s39, s40, s39
  s_mul_i32 s39, s39, 196608
  s_add_u32 s39, s39, s44
  s_add_u32 m0, s45, 0
  s_nop 0
  buffer_load_dwordx4 v12, s[12:15], s39 offen  lds
  s_add_u32 m0, s45, 4096
  s_nop 0
  buffer_load_dwordx4 v13, s[12:15], s39 offen  lds
  s_add_u32 m0, s45, 8192
  s_nop 0
  buffer_load_dwordx4 v14, s[12:15], s39 offen  lds
  s_waitcnt vmcnt(9)
  s_barrier
  s_add_u32 s39, s37, 6
  s_sub_u32 s40, s39, 10
  s_cmp_ge_u32 s39, 10
  s_cselect_b32 s39, s40, s39
  s_mul_i32 s39, s39, 196608
  s_add_u32 s39, s39, s44
  s_add_u32 m0, s45, 12288
  s_nop 0
  buffer_load_dwordx4 v12, s[12:15], s39 offen  lds
  s_add_u32 m0, s45, 16384
  s_nop 0
  buffer_load_dwordx4 v13, s[12:15], s39 offen  lds
  s_add_u32 m0, s45, 20480
  s_nop 0
  buffer_load_dwordx4 v14, s[12:15], s39 offen  lds
  s_waitcnt vmcnt(9)
  s_barrier
  s_add_u32 s39, s37, 7
  s_sub_u32 s40, s39, 10
  s_cmp_ge_u32 s39, 10
  s_cselect_b32 s39, s40, s39
  s_mul_i32 s39, s39, 196608
  s_add_u32 s39, s39, s44
  s_add_u32 m0, s45, 24576
  s_nop 0
  buffer_load_dwordx4 v12, s[12:15], s39 offen  lds
  s_add_u32 m0, s45, 28672
  s_nop 0
  buffer_load_dwordx4 v13, s[12:15], s39 offen  lds
  s_add_u32 m0, s45, 32768
  s_nop 0
  buffer_load_dwordx4 v14, s[12:15], s39 offen  lds
  s_waitcnt vmcnt(9)
  s_barrier
  s_add_u32 s39, s37, 8
  s_sub_u32 s40, s39, 10
  s_cmp_ge_u32 s39, 10
  s_cselect_b32 s39, s40, s39
  s_mul_i32 s39, s39, 196608
  s_add_u32 s39, s39, s44
  s_add_u32 m0, s45, 36864
  s_nop 0
  buffer_load_dwordx4 v12, s[12:15], s39 offen  lds
  s_add_u32 m0, s45, 40960
  s_nop 0
  buffer_load_dwordx4 v13, s[12:15], s39 offen  lds
  s_add_u32 m0, s45, 45056
  s_nop 0
  buffer_load_dwordx4 v14, s[12:15], s39 offen  lds
  s_waitcnt vmcnt(9)
  s_barrier
  s_add_u32 s39, s37, 9
  s_sub_u32 s40, s39, 10
  s_cmp_ge_u32 s39, 10
  s_cselect_b32 s39, s40, s39
  s_mul_i32 s39, s39, 196608
  s_add_u32 s39, s39, s44
  s_add_u32 m0, s45, 49152
  s_nop 0
  buffer_load_dwordx4 v12, s[12:15], s39 offen  lds
  s_add_u32 m0, s45, 53248
  s_nop 0
  buffer_load_dwordx4 v13, s[12:15], s39 offen  lds
  s_add_u32 m0, s45, 57344
  s_nop 0
  buffer_load_dwordx4 v14, s[12:15], s39 offen  lds
  s_mov_b32 exec_lo, 0xffffffff
  s_mov_b32 exec_hi, 0xfffffff
  s_add_u32 m0, s78, 0
  s_nop 0
  buffer_load_dwordx4 v20, s[20:23], s79 offen  lds
  s_add_u32 m0, s78, 960
  s_add_u32 s79, s46, 3840
  buffer_load_dwordx4 v4, s[20:23], s79 offen  lds
  s_add_u32 m0, s78, 1920
  s_add_u32 s79, s46, 11520
  buffer_load_dwordx4 v4, s[20:23], s79 offen  lds
  s_add_u32 m0, s78, 2880
  s_add_u32 s79, s46, 19200
  buffer_load_dwordx4 v4, s[20:23], s79 offen  lds
  s_add_u32 m0, s78, 3840
  s_add_u32 s79, s46, 0
  buffer_load_dwordx4 v4, s[24:27], s79 offen  lds
  s_add_u32 m0, s78, 4800
  s_add_u32 s79, s46, 7680
  buffer_load_dwordx4 v4, s[24:27], s79 offen  lds
  s_add_u32 m0, s78, 5760
  s_add_u32 s79, s46, 15360
  buffer_load_dwordx4 v4, s[24:27], s79 offen  lds
  s_mov_b64 exec, s[52:53]
  buffer_load_dwordx4 v[156:159], v21, s[28:31], s54 offen
  s_waitcnt vmcnt(17)
  s_barrier
  s_waitcnt vmcnt(14)
  s_barrier
  s_waitcnt vmcnt(11)
  s_barrier
  s_waitcnt vmcnt(8)
  s_barrier
  s_waitcnt vmcnt(0)
  v_lshlrev_b32 v30, 2, v1
  v_min_u32 v30, 156, v30
  v_add_u32 v30, s78, v30
  ds_read_b32 v40, v30 offset:0
  ds_read_b32 v41, v30 offset:160
  ds_read_b32 v42, v30 offset:320
  ds_read_b32 v43, v30 offset:480
  ds_read_b32 v44, v30 offset:640
  ds_read_b32 v45, v30 offset:800
  ds_read_b32 v46, v30 offset:960
  ds_read_b32 v47, v30 offset:1120
  ds_read_b32 v48, v30 offset:1280
  ds_read_b32 v49, v30 offset:1440
  ds_read_b32 v50, v30 offset:1600
  ds_read_b32 v51, v30 offset:1760
  ds_read_b32 v52, v30 offset:1920
  ds_read_b32 v53, v30 offset:2080
  s_waitcnt lgkmcnt(6)
  ds_read_b32 v54, v30 offset:2240
  ds_read_b32 v55, v30 offset:2400
  ds_read_b32 v56, v30 offset:2560
  ds_read_b32 v57, v30 offset:2720
  ds_read_b32 v58, v30 offset:2880
  s_barrier
  ds_read_b32 v59, v30 offset:3840
  ds_read_b32 v60, v30 offset:4000
  s_waitcnt lgkmcnt(6)
  ds_read_b32 v61, v30 offset:4160
  ds_read_b32 v62, v30 offset:4320
  ds_read_b32 v63, v30 offset:4480
  ds_read_b32 v64, v30 offset:4640
  ds_read_b32 v65, v30 offset:4800
  ds_read_b32 v66, v30 offset:4960
  ds_read_b32 v67, v30 offset:5120
  ds_read_b32 v68, v30 offset:5280
  s_waitcnt lgkmcnt(6)
  ds_read_b32 v69, v30 offset:5440
  ds_read_b32 v70, v30 offset:5600
  ds_read_b32 v71, v30 offset:5760
  ds_read_b32 v72, v30 offset:5920
  ds_read_b32 v73, v30 offset:6080
  ds_read_b32 v74, v30 offset:6240
  v_lshlrev_b32 v114, 16, v156
  v_lshlrev_b32 v115, 16, v158
  v_and_b32 v116, s47, v156
  v_and_b32 v117, s47, v158
  v_lshlrev_b32 v118, 16, v157
  v_lshlrev_b32 v119, 16, v159
  v_and_b32 v120, s47, v157
  v_and_b32 v121, s47, v159
  s_waitcnt lgkmcnt(0)
  s_barrier
  v_lshlrev_b32 v76, 16, v40
  v_and_b32 v77, s47, v40
  v_lshlrev_b32 v78, 16, v41
  v_and_b32 v79, s47, v41
  v_lshlrev_b32 v80, 16, v42
  v_and_b32 v81, s47, v42
  v_lshlrev_b32 v82, 16, v43
  v_and_b32 v83, s47, v43
  v_lshlrev_b32 v84, 16, v44
  v_and_b32 v85, s47, v44
  v_lshlrev_b32 v86, 16, v45
  v_and_b32 v87, s47, v45
  v_lshlrev_b32 v88, 16, v46
  v_and_b32 v89, s47, v46
  v_lshlrev_b32 v90, 16, v47
  v_and_b32 v91, s47, v47
  v_lshlrev_b32 v92, 16, v48
  v_and_b32 v93, s47, v48
  v_lshlrev_b32 v94, 16, v49
  v_and_b32 v95, s47, v49
  v_lshlrev_b32 v96, 16, v50
  v_and_b32 v97, s47, v50
  v_lshlrev_b32 v98, 16, v51
  v_and_b32 v99, s47, v51
  v_lshlrev_b32 v100, 16, v52
  v_and_b32 v101, s47, v52
  v_lshlrev_b32 v102, 16, v53
  v_and_b32 v103, s47, v53
  v_lshlrev_b32 v104, 16, v54
  v_and_b32 v105, s47, v54
  v_lshlrev_b32 v106, 16, v55
  v_and_b32 v107, s47, v55
  v_lshlrev_b32 v108, 16, v56
  v_and_b32 v109, s47, v56
  v_lshlrev_b32 v110, 16, v57
  v_and_b32 v111, s47, v57
  v_lshlrev_b32 v112, 16, v58
  v_and_b32 v113, s47, v58
  v_pk_mul_f32 v[122:123], v[120:121], v[76:77]
  v_lshlrev_b32 v32, 16, v59
  v_pk_fma_f32 v[122:123], v[118:119], v[78:79], v[122:123]
  v_and_b32 v33, s47, v59
  v_pk_fma_f32 v[122:123], v[116:117], v[80:81], v[122:123]
  v_pk_fma_f32 v[122:123], v[114:115], v[82:83], v[122:123]
  v_pk_mul_f32 v[122:123], v[122:123], v[32:33]
  v_pk_mul_f32 v[124:125], v[120:121], v[78:79]
  v_lshlrev_b32 v32, 16, v60
  v_pk_fma_f32 v[124:125], v[118:119], v[80:81], v[124:125]
  v_and_b32 v33, s47, v60
  v_pk_fma_f32 v[124:125], v[116:117], v[82:83], v[124:125]
  v_pk_fma_f32 v[124:125], v[114:115], v[84:85], v[124:125]
  v_pk_mul_f32 v[124:125], v[124:125], v[32:33]
  v_pk_mul_f32 v[126:127], v[120:121], v[80:81]
  v_lshlrev_b32 v32, 16, v61
  v_pk_fma_f32 v[126:127], v[118:119], v[82:83], v[126:127]
  v_and_b32 v33, s47, v61
  v_pk_fma_f32 v[126:127], v[116:117], v[84:85], v[126:127]
  v_pk_fma_f32 v[126:127], v[114:115], v[86:87], v[126:127]
  v_pk_mul_f32 v[126:127], v[126:127], v[32:33]
  v_pk_mul_f32 v[128:129], v[120:121], v[82:83]
  v_lshlrev_b32 v32, 16, v62
  v_pk_fma_f32 v[128:129], v[118:119], v[84:85], v[128:129]
  v_and_b32 v33, s47, v62
  v_pk_fma_f32 v[128:129], v[116:117], v[86:87], v[128:129]
  v_pk_fma_f32 v[128:129], v[114:115], v[88:89], v[128:129]
  v_pk_mul_f32 v[128:129], v[128:129], v[32:33]
  v_pk_mul_f32 v[130:131], v[120:121], v[84:85]
  v_lshlrev_b32 v32, 16, v63
  v_pk_fma_f32 v[130:131], v[118:119], v[86:87], v[130:131]
  v_and_b32 v33, s47, v63
  v_pk_fma_f32 v[130:131], v[116:117], v[88:89], v[130:131]
  v_pk_fma_f32 v[130:131], v[114:115], v[90:91], v[130:131]
  v_pk_mul_f32 v[130:131], v[130:131], v[32:33]
  v_pk_mul_f32 v[132:133], v[120:121], v[86:87]
  v_lshlrev_b32 v32, 16, v64
  v_pk_fma_f32 v[132:133], v[118:119], v[88:89], v[132:133]
  v_and_b32 v33, s47, v64
  v_pk_fma_f32 v[132:133], v[116:117], v[90:91], v[132:133]
  v_pk_fma_f32 v[132:133], v[114:115], v[92:93], v[132:133]
  v_pk_mul_f32 v[132:133], v[132:133], v[32:33]
  v_pk_mul_f32 v[134:135], v[120:121], v[88:89]
  v_lshlrev_b32 v32, 16, v65
  v_pk_fma_f32 v[134:135], v[118:119], v[90:91], v[134:135]
  v_and_b32 v33, s47, v65
  v_pk_fma_f32 v[134:135], v[116:117], v[92:93], v[134:135]
  v_pk_fma_f32 v[134:135], v[114:115], v[94:95], v[134:135]
  v_pk_mul_f32 v[134:135], v[134:135], v[32:33]
  v_pk_mul_f32 v[136:137], v[120:121], v[90:91]
  v_lshlrev_b32 v32, 16, v66
  v_pk_fma_f32 v[136:137], v[118:119], v[92:93], v[136:137]
  v_and_b32 v33, s47, v66
  v_pk_fma_f32 v[136:137], v[116:117], v[94:95], v[136:137]
  v_pk_fma_f32 v[136:137], v[114:115], v[96:97], v[136:137]
  v_pk_mul_f32 v[136:137], v[136:137], v[32:33]
  v_pk_mul_f32 v[138:139], v[120:121], v[92:93]
  v_lshlrev_b32 v32, 16, v67
  v_pk_fma_f32 v[138:139], v[118:119], v[94:95], v[138:139]
  v_and_b32 v33, s47, v67
  v_pk_fma_f32 v[138:139], v[116:117], v[96:97], v[138:139]
  v_pk_fma_f32 v[138:139], v[114:115], v[98:99], v[138:139]
  v_pk_mul_f32 v[138:139], v[138:139], v[32:33]
  v_pk_mul_f32 v[140:141], v[120:121], v[94:95]
  v_lshlrev_b32 v32, 16, v68
  v_pk_fma_f32 v[140:141], v[118:119], v[96:97], v[140:141]
  v_and_b32 v33, s47, v68
  v_pk_fma_f32 v[140:141], v[116:117], v[98:99], v[140:141]
  v_pk_fma_f32 v[140:141], v[114:115], v[100:101], v[140:141]
  v_pk_mul_f32 v[140:141], v[140:141], v[32:33]
  v_pk_mul_f32 v[142:143], v[120:121], v[96:97]
  v_lshlrev_b32 v32, 16, v69
  v_pk_fma_f32 v[142:143], v[118:119], v[98:99], v[142:143]
  v_and_b32 v33, s47, v69
  v_pk_fma_f32 v[142:143], v[116:117], v[100:101], v[142:143]
  v_pk_fma_f32 v[142:143], v[114:115], v[102:103], v[142:143]
  v_pk_mul_f32 v[142:143], v[142:143], v[32:33]
  v_pk_mul_f32 v[144:145], v[120:121], v[98:99]
  v_lshlrev_b32 v32, 16, v70
  v_pk_fma_f32 v[144:145], v[118:119], v[100:101], v[144:145]
  v_and_b32 v33, s47, v70
  v_pk_fma_f32 v[144:145], v[116:117], v[102:103], v[144:145]
  v_pk_fma_f32 v[144:145], v[114:115], v[104:105], v[144:145]
  v_pk_mul_f32 v[144:145], v[144:145], v[32:33]
  v_pk_mul_f32 v[146:147], v[120:121], v[100:101]
  v_lshlrev_b32 v32, 16, v71
  v_pk_fma_f32 v[146:147], v[118:119], v[102:103], v[146:147]
  v_and_b32 v33, s47, v71
  v_pk_fma_f32 v[146:147], v[116:117], v[104:105], v[146:147]
  v_pk_fma_f32 v[146:147], v[114:115], v[106:107], v[146:147]
  v_pk_mul_f32 v[146:147], v[146:147], v[32:33]
  v_pk_mul_f32 v[148:149], v[120:121], v[102:103]
  v_lshlrev_b32 v32, 16, v72
  v_pk_fma_f32 v[148:149], v[118:119], v[104:105], v[148:149]
  v_and_b32 v33, s47, v72
  v_pk_fma_f32 v[148:149], v[116:117], v[106:107], v[148:149]
  v_pk_fma_f32 v[148:149], v[114:115], v[108:109], v[148:149]
  v_pk_mul_f32 v[148:149], v[148:149], v[32:33]
  v_pk_mul_f32 v[150:151], v[120:121], v[104:105]
  v_lshlrev_b32 v32, 16, v73
  v_pk_fma_f32 v[150:151], v[118:119], v[106:107], v[150:151]
  v_and_b32 v33, s47, v73
  v_pk_fma_f32 v[150:151], v[116:117], v[108:109], v[150:151]
  v_pk_fma_f32 v[150:151], v[114:115], v[110:111], v[150:151]
  v_pk_mul_f32 v[150:151], v[150:151], v[32:33]
  v_pk_mul_f32 v[152:153], v[120:121], v[106:107]
  v_lshlrev_b32 v32, 16, v74
  v_pk_fma_f32 v[152:153], v[118:119], v[108:109], v[152:153]
  v_and_b32 v33, s47, v74
  v_pk_fma_f32 v[152:153], v[116:117], v[110:111], v[152:153]
  v_pk_fma_f32 v[152:153], v[114:115], v[112:113], v[152:153]
  v_pk_mul_f32 v[152:153], v[152:153], v[32:33]
  v_cvt_pk_bf16_f32 v40, v136, v134
  v_cvt_pk_bf16_f32 v41, v132, v130
  v_cvt_pk_bf16_f32 v42, v128, v126
  v_cvt_pk_bf16_f32 v43, v124, v122
  v_cvt_pk_bf16_f32 v44, v152, v150
  v_cvt_pk_bf16_f32 v45, v148, v146
  v_cvt_pk_bf16_f32 v46, v144, v142
  v_cvt_pk_bf16_f32 v47, v140, v138
  v_cvt_pk_bf16_f32 v48, v137, v135
  v_cvt_pk_bf16_f32 v49, v133, v131
  v_cvt_pk_bf16_f32 v50, v129, v127
  v_cvt_pk_bf16_f32 v51, v125, v123
  v_cvt_pk_bf16_f32 v52, v153, v151
  v_cvt_pk_bf16_f32 v53, v149, v147
  v_cvt_pk_bf16_f32 v54, v145, v143
  v_cvt_pk_bf16_f32 v55, v141, v139
  v_mul_u32_u24 v30, 288, v1
  s_lshl_b32 s40, s55, 5
  s_add_u32 s40, s40, 49152
  v_add_u32 v30, s40, v30
  s_mov_b32 exec_lo, 0xffffffff
  s_mov_b32 exec_hi, 0xff
  ds_write_b128 v30, v[40:43] offset:0
  ds_write_b128 v30, v[44:47] offset:16
  ds_write_b128 v30, v[48:51] offset:144
  ds_write_b128 v30, v[52:55] offset:160
  s_mov_b64 exec, s[52:53]
  s_load_dwordx2 s[56:57], s[0:1], 64
  s_load_dwordx2 s[60:61], s[0:1], 104
  s_lshl_b32 s40, s32, 6
  s_lshl_b32 s41, s55, 4
  s_add_u32 s40, s40, s41
  v_add_u32 v10, 0, v2
  v_xor_b32 v11, v10, v3
  v_lshlrev_b32 v11, 4, v11
  v_add_u32 v10, s40, v10
  v_lshlrev_b32 v10, 12, v10
  v_add_u32 v4, v10, v11
  v_add_u32 v10, 4, v2
  v_xor_b32 v11, v10, v3
  v_lshlrev_b32 v11, 4, v11
  v_add_u32 v10, s40, v10
  v_lshlrev_b32 v10, 12, v10
  v_add_u32 v5, v10, v11
  v_add_u32 v10, 8, v2
  v_xor_b32 v11, v10, v3
  v_lshlrev_b32 v11, 4, v11
  v_add_u32 v10, s40, v10
  v_lshlrev_b32 v10, 12, v10
  v_add_u32 v6, v10, v11
  v_add_u32 v10, 12, v2
  v_xor_b32 v11, v10, v3
  v_lshlrev_b32 v11, 4, v11
  v_add_u32 v10, s40, v10
  v_lshlrev_b32 v10, 12, v10
  v_add_u32 v7, v10, v11
  s_lshl_b32 s39, s55, 12
  s_waitcnt lgkmcnt(0)
  s_mov_b32 s8, s56
  s_and_b32 s9, s57, 0xffff
  s_mov_b32 s10, 8388608
  s_mov_b32 s11, 0x20000
  s_mov_b32 s16, s60
  s_and_b32 s17, s61, 0xffff
  s_mov_b32 s18, 18874368
  s_mov_b32 s19, 0x20000
  s_waitcnt lgkmcnt(0)
  s_barrier
  s_sleep 5
  s_movk_i32 s38, 0
  s_add_u32 m0, s39, 0
  s_nop 0
  buffer_load_dwordx4 v4, s[8:11], s38 offen  lds
  s_add_u32 m0, s39, 1024
  s_nop 0
  buffer_load_dwordx4 v5, s[8:11], s38 offen  lds
  s_add_u32 m0, s39, 2048
  s_nop 0
  buffer_load_dwordx4 v6, s[8:11], s38 offen  lds
  s_add_u32 m0, s39, 3072
  s_nop 0
  buffer_load_dwordx4 v7, s[8:11], s38 offen  lds
  s_movk_i32 s38, 256
  s_add_u32 m0, s39, 16384
  s_nop 0
  buffer_load_dwordx4 v4, s[8:11], s38 offen  lds
  s_add_u32 m0, s39, 17408
  s_nop 0
  buffer_load_dwordx4 v5, s[8:11], s38 offen  lds
  s_add_u32 m0, s39, 18432
  s_nop 0
  buffer_load_dwordx4 v6, s[8:11], s38 offen  lds
  s_add_u32 m0, s39, 19456
  s_nop 0
  buffer_load_dwordx4 v7, s[8:11], s38 offen  lds
  s_waitcnt vmcnt(4)
  s_barrier
  s_movk_i32 s38, 512
  s_add_u32 m0, s39, 32768
  s_nop 0
  buffer_load_dwordx4 v4, s[8:11], s38 offen  lds
  s_add_u32 m0, s39, 33792
  s_nop 0
  buffer_load_dwordx4 v5, s[8:11], s38 offen  lds
  s_add_u32 m0, s39, 34816
  s_nop 0
  buffer_load_dwordx4 v6, s[8:11], s38 offen  lds
  s_add_u32 m0, s39, 35840
  s_nop 0
  buffer_load_dwordx4 v7, s[8:11], s38 offen  lds
  s_movk_i32 s38, 768
  s_add_u32 m0, s39, 49152
  s_nop 0
  buffer_load_dwordx4 v4, s[8:11], s38 offen  lds
  s_add_u32 m0, s39, 50176
  s_nop 0
  buffer_load_dwordx4 v5, s[8:11], s38 offen  lds
  s_add_u32 m0, s39, 51200
  s_nop 0
  buffer_load_dwordx4 v6, s[8:11], s38 offen  lds
  s_add_u32 m0, s39, 52224
  s_nop 0
  buffer_load_dwordx4 v7, s[8:11], s38 offen  lds
  s_waitcnt vmcnt(8)
  s_barrier
  s_movk_i32 s38, 1024
  s_add_u32 m0, s39, 0
  s_nop 0
  buffer_load_dwordx4 v4, s[8:11], s38 offen  lds
  s_add_u32 m0, s39, 1024
  s_nop 0
  buffer_load_dwordx4 v5, s[8:11], s38 offen  lds
  s_add_u32 m0, s39, 2048
  s_nop 0
  buffer_load_dwordx4 v6, s[8:11], s38 offen  lds
  s_add_u32 m0, s39, 3072
  s_nop 0
  buffer_load_dwordx4 v7, s[8:11], s38 offen  lds
  s_waitcnt vmcnt(8)
  s_barrier
  s_movk_i32 s38, 1280
  s_add_u32 m0, s39, 16384
  s_nop 0
  buffer_load_dwordx4 v4, s[8:11], s38 offen  lds
  s_add_u32 m0, s39, 17408
  s_nop 0
  buffer_load_dwordx4 v5, s[8:11], s38 offen  lds
  s_add_u32 m0, s39, 18432
  s_nop 0
  buffer_load_dwordx4 v6, s[8:11], s38 offen  lds
  s_add_u32 m0, s39, 19456
  s_nop 0
  buffer_load_dwordx4 v7, s[8:11], s38 offen  lds
  s_waitcnt vmcnt(8)
  s_barrier
  s_movk_i32 s38, 1536
  s_add_u32 m0, s39, 32768
  s_nop 0
  buffer_load_dwordx4 v4, s[8:11], s38 offen  lds
  s_add_u32 m0, s39, 33792
  s_nop 0
  buffer_load_dwordx4 v5, s[8:11], s38 offen  lds
  s_add_u32 m0, s39, 34816
  s_nop 0
  buffer_load_dwordx4 v6, s[8:11], s38 offen  lds
  s_add_u32 m0, s39, 35840
  s_nop 0
  buffer_load_dwordx4 v7, s[8:11], s38 offen  lds
  s_waitcnt vmcnt(8)
  s_barrier
  s_movk_i32 s38, 1792
  s_add_u32 m0, s39, 49152
  s_nop 0
  buffer_load_dwordx4 v4, s[8:11], s38 offen  lds
  s_add_u32 m0, s39, 50176
  s_nop 0
  buffer_load_dwordx4 v5, s[8:11], s38 offen  lds
  s_add_u32 m0, s39, 51200
  s_nop 0
  buffer_load_dwordx4 v6, s[8:11], s38 offen  lds
  s_add_u32 m0, s39, 52224
  s_nop 0
  buffer_load_dwordx4 v7, s[8:11], s38 offen  lds
  s_waitcnt vmcnt(8)
  s_barrier
  s_movk_i32 s38, 2048
  s_add_u32 m0, s39, 0
  s_nop 0
  buffer_load_dwordx4 v4, s[8:11], s38 offen  lds
  s_add_u32 m0, s39, 1024
  s_nop 0
  buffer_load_dwordx4 v5, s[8:11], s38 offen  lds
  s_add_u32 m0, s39, 2048
  s_nop 0
  buffer_load_dwordx4 v6, s[8:11], s38 offen  lds
  s_add_u32 m0, s39, 3072
  s_nop 0
  buffer_load_dwordx4 v7, s[8:11], s38 offen  lds
  s_waitcnt vmcnt(8)
  s_barrier
  s_movk_i32 s38, 2304
  s_add_u32 m0, s39, 16384
  s_nop 0
  buffer_load_dwordx4 v4, s[8:11], s38 offen  lds
  s_add_u32 m0, s39, 17408
  s_nop 0
  buffer_load_dwordx4 v5, s[8:11], s38 offen  lds
  s_add_u32 m0, s39, 18432
  s_nop 0
  buffer_load_dwordx4 v6, s[8:11], s38 offen  lds
  s_add_u32 m0, s39, 19456
  s_nop 0
  buffer_load_dwordx4 v7, s[8:11], s38 offen  lds
  s_waitcnt vmcnt(8)
  s_barrier
  s_movk_i32 s38, 2560
  s_add_u32 m0, s39, 32768
  s_nop 0
  buffer_load_dwordx4 v4, s[8:11], s38 offen  lds
  s_add_u32 m0, s39, 33792
  s_nop 0
  buffer_load_dwordx4 v5, s[8:11], s38 offen  lds
  s_add_u32 m0, s39, 34816
  s_nop 0
  buffer_load_dwordx4 v6, s[8:11], s38 offen  lds
  s_add_u32 m0, s39, 35840
  s_nop 0
  buffer_load_dwordx4 v7, s[8:11], s38 offen  lds
  s_waitcnt vmcnt(8)
  s_barrier
  s_movk_i32 s38, 2816
  s_add_u32 m0, s39, 49152
  s_nop 0
  buffer_load_dwordx4 v4, s[8:11], s38 offen  lds
  s_add_u32 m0, s39, 50176
  s_nop 0
  buffer_load_dwordx4 v5, s[8:11], s38 offen  lds
  s_add_u32 m0, s39, 51200
  s_nop 0
  buffer_load_dwordx4 v6, s[8:11], s38 offen  lds
  s_add_u32 m0, s39, 52224
  s_nop 0
  buffer_load_dwordx4 v7, s[8:11], s38 offen  lds
  s_waitcnt vmcnt(8)
  s_barrier
  s_movk_i32 s38, 3072
  s_add_u32 m0, s39, 0
  s_nop 0
  buffer_load_dwordx4 v4, s[8:11], s38 offen  lds
  s_add_u32 m0, s39, 1024
  s_nop 0
  buffer_load_dwordx4 v5, s[8:11], s38 offen  lds
  s_add_u32 m0, s39, 2048
  s_nop 0
  buffer_load_dwordx4 v6, s[8:11], s38 offen  lds
  s_add_u32 m0, s39, 3072
  s_nop 0
  buffer_load_dwordx4 v7, s[8:11], s38 offen  lds
  s_waitcnt vmcnt(8)
  s_barrier
  s_movk_i32 s38, 3328
  s_add_u32 m0, s39, 16384
  s_nop 0
  buffer_load_dwordx4 v4, s[8:11], s38 offen  lds
  s_add_u32 m0, s39, 17408
  s_nop 0
  buffer_load_dwordx4 v5, s[8:11], s38 offen  lds
  s_add_u32 m0, s39, 18432
  s_nop 0
  buffer_load_dwordx4 v6, s[8:11], s38 offen  lds
  s_add_u32 m0, s39, 19456
  s_nop 0
  buffer_load_dwordx4 v7, s[8:11], s38 offen  lds
  s_waitcnt vmcnt(8)
  s_barrier
  s_movk_i32 s38, 3584
  s_add_u32 m0, s39, 32768
  s_nop 0
  buffer_load_dwordx4 v4, s[8:11], s38 offen  lds
  s_add_u32 m0, s39, 33792
  s_nop 0
  buffer_load_dwordx4 v5, s[8:11], s38 offen  lds
  s_add_u32 m0, s39, 34816
  s_nop 0
  buffer_load_dwordx4 v6, s[8:11], s38 offen  lds
  s_add_u32 m0, s39, 35840
  s_nop 0
  buffer_load_dwordx4 v7, s[8:11], s38 offen  lds
  s_waitcnt vmcnt(8)
  s_barrier
  s_movk_i32 s38, 3840
  s_add_u32 m0, s39, 49152
  s_nop 0
  buffer_load_dwordx4 v4, s[8:11], s38 offen  lds
  s_add_u32 m0, s39, 50176
  s_nop 0
  buffer_load_dwordx4 v5, s[8:11], s38 offen  lds
  s_add_u32 m0, s39, 51200
  s_nop 0
  buffer_load_dwordx4 v6, s[8:11], s38 offen  lds
  s_add_u32 m0, s39, 52224
  s_nop 0
  buffer_load_dwordx4 v7, s[8:11], s38 offen  lds
  s_waitcnt vmcnt(8)
  s_barrier
  s_waitcnt vmcnt(4)
  s_barrier
  s_waitcnt vmcnt(0)
  s_barrier
  s_barrier
  s_barrier
  s_barrier
  s_barrier
  v_lshlrev_b32 v4, 4, v1
  s_mul_i32 s35, s33, 122880
  s_lshl_b32 s40, s55, 10
  s_add_u32 s35, s35, s40
  s_add_u32 s35, s35, 15728640
  s_mul_i32 s36, s55, 5120
  s_sleep 4
  s_add_u32 m0, s36, 0
  s_add_u32 s40, s35, 0
  buffer_load_dwordx4 v4, s[16:19], s40 offen sc1 lds
  s_add_u32 m0, s36, 1024
  s_add_u32 s40, s35, 24576
  buffer_load_dwordx4 v4, s[16:19], s40 offen sc1 lds
  s_add_u32 m0, s36, 2048
  s_add_u32 s40, s35, 49152
  buffer_load_dwordx4 v4, s[16:19], s40 offen sc1 lds
  s_add_u32 m0, s36, 3072
  s_add_u32 s40, s35, 73728
  buffer_load_dwordx4 v4, s[16:19], s40 offen sc1 lds
  s_add_u32 m0, s36, 4096
  s_add_u32 s40, s35, 98304
  buffer_load_dwordx4 v4, s[16:19], s40 offen sc1 lds
  s_add_u32 m0, s36, 20480
  s_add_u32 s40, s35, 4096
  buffer_load_dwordx4 v4, s[16:19], s40 offen sc1 lds
  s_add_u32 m0, s36, 21504
  s_add_u32 s40, s35, 28672
  buffer_load_dwordx4 v4, s[16:19], s40 offen sc1 lds
  s_add_u32 m0, s36, 22528
  s_add_u32 s40, s35, 53248
  buffer_load_dwordx4 v4, s[16:19], s40 offen sc1 lds
  s_add_u32 m0, s36, 23552
  s_add_u32 s40, s35, 77824
  buffer_load_dwordx4 v4, s[16:19], s40 offen sc1 lds
  s_add_u32 m0, s36, 24576
  s_add_u32 s40, s35, 102400
  buffer_load_dwordx4 v4, s[16:19], s40 offen sc1 lds
  s_barrier
  s_add_u32 m0, s36, 40960
  s_add_u32 s40, s35, 8192
  buffer_load_dwordx4 v4, s[16:19], s40 offen sc1 lds
  s_add_u32 m0, s36, 41984
  s_add_u32 s40, s35, 32768
  buffer_load_dwordx4 v4, s[16:19], s40 offen sc1 lds
  s_add_u32 m0, s36, 43008
  s_add_u32 s40, s35, 57344
  buffer_load_dwordx4 v4, s[16:19], s40 offen sc1 lds
  s_add_u32 m0, s36, 44032
  s_add_u32 s40, s35, 81920
  buffer_load_dwordx4 v4, s[16:19], s40 offen sc1 lds
  s_add_u32 m0, s36, 45056
  s_add_u32 s40, s35, 106496
  buffer_load_dwordx4 v4, s[16:19], s40 offen sc1 lds
  s_waitcnt vmcnt(10)
  s_barrier
  s_add_u32 m0, s36, 61440
  s_add_u32 s40, s35, 12288
  buffer_load_dwordx4 v4, s[16:19], s40 offen sc1 lds
  s_add_u32 m0, s36, 62464
  s_add_u32 s40, s35, 36864
  buffer_load_dwordx4 v4, s[16:19], s40 offen sc1 lds
  s_add_u32 m0, s36, 63488
  s_add_u32 s40, s35, 61440
  buffer_load_dwordx4 v4, s[16:19], s40 offen sc1 lds
  s_add_u32 m0, s36, 64512
  s_add_u32 s40, s35, 86016
  buffer_load_dwordx4 v4, s[16:19], s40 offen sc1 lds
  s_add_u32 m0, s36, 65536
  s_add_u32 s40, s35, 110592
  buffer_load_dwordx4 v4, s[16:19], s40 offen sc1 lds
  s_waitcnt vmcnt(10)
  s_barrier
  s_add_u32 m0, s36, 81920
  s_add_u32 s40, s35, 16384
  buffer_load_dwordx4 v4, s[16:19], s40 offen sc1 lds
  s_add_u32 m0, s36, 82944
  s_add_u32 s40, s35, 40960
  buffer_load_dwordx4 v4, s[16:19], s40 offen sc1 lds
  s_add_u32 m0, s36, 83968
  s_add_u32 s40, s35, 65536
  buffer_load_dwordx4 v4, s[16:19], s40 offen sc1 lds
  s_add_u32 m0, s36, 84992
  s_add_u32 s40, s35, 90112
  buffer_load_dwordx4 v4, s[16:19], s40 offen sc1 lds
  s_add_u32 m0, s36, 86016
  s_add_u32 s40, s35, 114688
  buffer_load_dwordx4 v4, s[16:19], s40 offen sc1 lds
  s_waitcnt vmcnt(10)
  s_barrier
  s_add_u32 m0, s36, 102400
  s_add_u32 s40, s35, 20480
  buffer_load_dwordx4 v4, s[16:19], s40 offen sc1 lds
  s_add_u32 m0, s36, 103424
  s_add_u32 s40, s35, 45056
  buffer_load_dwordx4 v4, s[16:19], s40 offen sc1 lds
  s_add_u32 m0, s36, 104448
  s_add_u32 s40, s35, 69632
  buffer_load_dwordx4 v4, s[16:19], s40 offen sc1 lds
  s_add_u32 m0, s36, 105472
  s_add_u32 s40, s35, 94208
  buffer_load_dwordx4 v4, s[16:19], s40 offen sc1 lds
  s_add_u32 m0, s36, 106496
  s_add_u32 s40, s35, 118784
  buffer_load_dwordx4 v4, s[16:19], s40 offen sc1 lds
  s_waitcnt vmcnt(10)
  s_barrier
  s_waitcnt vmcnt(5)
  s_barrier
  s_waitcnt vmcnt(0)
  s_barrier
  s_endpgm
K1_AB:
  v_lshrrev_b32 v17, 1, v3
  v_xor_b32 v17, v17, v2
  v_lshlrev_b32 v17, 4, v17
  v_lshlrev_b32 v18, 7, v3
  v_add_u32 v17, v17, v18
  v_xor_b32 v18, 64, v17
  s_lshl_b32 s40, s35, 12
  s_lshl_b32 s41, s36, 11
  s_add_u32 s42, s40, s41
  s_add_u32 s42, s42, 61440
  v_add_u32 v4, s42, v17
  v_add_u32 v5, s42, v18
  s_xor_b32 s41, s41, 2048
  s_add_u32 s42, s40, s41
  s_add_u32 s42, s42, 61440
  v_add_u32 v6, s42, v17
  v_add_u32 v7, s42, v18
  v_lshrrev_b32 v17, 2, v1
  v_and_b32 v17, 3, v17
  v_lshlrev_b32 v18, 3, v2
  v_add_u32 v17, v17, v18
  v_mul_u32_u24 v17, 192, v17
  v_and_b32 v18, 3, v1
  v_lshlrev_b32 v18, 3, v18
  v_add_u32 v17, v17, v18
  v_and_b32 v19, 1, v2
  s_mul_i32 s40, s36, 3
  s_add_u32 s41, s40, 0
  v_xor_b32 v18, s41, v19
  v_lshlrev_b32 v18, 5, v18
  v_add_u32 v8, v17, v18
  s_add_u32 s41, s40, 1
  v_xor_b32 v18, s41, v19
  v_lshlrev_b32 v18, 5, v18
  v_add_u32 v9, v17, v18
  s_add_u32 s41, s40, 2
  v_xor_b32 v18, s41, v19
  v_lshlrev_b32 v18, 5, v18
  v_add_u32 v10, v17, v18
  s_mov_b32 s48, 0xbdd2d3e8
  s_mov_b32 s49, 0xbdd2d3e8
  s_mov_b32 s50, 1.0
  s_mov_b32 s51, 1.0
  s_waitcnt lgkmcnt(0)
  s_mov_b32 s16, s70
  s_and_b32 s17, s71, 0xffff
  s_mov_b32 s18, 18874368
  s_mov_b32 s19, 0x20000
  s_mov_b32 s4, s68
  s_and_b32 s5, s69, 0xffff
  s_mov_b32 s6, 256
  s_mov_b32 s7, 0x20000
  s_cmp_ge_u32 s34, 4
  s_cbranch_scc1 K1_B
  v_mov_b32 v102, 0x3f803f80
  v_mov_b32 v103, 0x3f803f80
  v_mov_b32 v104, 0x3f803f80
  v_mov_b32 v105, 0x3f803f80
  v_mov_b32 v66, 0
  v_mov_b32 v67, 0
  v_mov_b32 v68, 0
  v_mov_b32 v69, 0
  v_mov_b32 v70, 0
  v_mov_b32 v71, 0
  v_mov_b32 v72, 0
  v_mov_b32 v73, 0
  v_mov_b32 v74, 0
  v_mov_b32 v75, 0
  v_mov_b32 v76, 0
  v_mov_b32 v77, 0
  v_mov_b32 v78, 0
  v_mov_b32 v79, 0
  v_mov_b32 v80, 0
  v_mov_b32 v81, 0
  v_mov_b32 v82, 0
  v_mov_b32 v83, 0
  v_mov_b32 v84, 0
  v_mov_b32 v85, 0
  v_mov_b32 v86, 0
  v_mov_b32 v87, 0
  v_mov_b32 v88, 0
  v_mov_b32 v89, 0
  v_mov_b32 v90, 0
  v_mov_b32 v91, 0
  v_mov_b32 v92, 0
  v_mov_b32 v93, 0
  v_mov_b32 v94, 0
  v_mov_b32 v95, 0
  v_mov_b32 v96, 0
  v_mov_b32 v97, 0
  v_mov_b32 v98, 0
  v_mov_b32 v99, 0
  v_mov_b32 v100, 0
  v_mov_b32 v101, 0
  v_mov_b32 v106, 0
  v_mov_b32 v107, 0
  v_mov_b32 v108, 0
  v_mov_b32 v109, 0
  v_mov_b32 v110, 0
  v_mov_b32 v111, 0
  v_mov_b32 v112, 0
  v_mov_b32 v113, 0
  s_barrier
  s_mov_b32 s37, 0
  ds_read_b128 v[26:29], v4 offset:0
  ds_read_b64_tr_b16 v[42:43], v8 offset:0
  ds_read_b64_tr_b16 v[44:45], v8 offset:768
  ds_read_b128 v[30:33], v6 offset:0
  ds_read_b64_tr_b16 v[46:47], v9 offset:0
  ds_read_b64_tr_b16 v[48:49], v9 offset:768
  ds_read_b64_tr_b16 v[50:51], v10 offset:0
  ds_read_b64_tr_b16 v[52:53], v10 offset:768
K1_LOOP1:
  s_waitcnt lgkmcnt(0)
  v_mfma_f32_16x16x32_bf16 v[66:69], v[26:29], v[42:45], v[66:69]
  ds_read_b128 v[34:37], v5 offset:0
  ds_read_b64_tr_b16 v[54:55], v8 offset:6144
  v_mfma_f32_16x16x32_bf16 v[78:81], v[30:33], v[42:45], v[78:81]
  ds_read_b64_tr_b16 v[56:57], v8 offset:6912
  ds_read_b128 v[38:41], v7 offset:0
  v_mfma_f32_16x16x32_bf16 v[70:73], v[26:29], v[46:49], v[70:73]
  ds_read_b64_tr_b16 v[58:59], v9 offset:6144
  ds_read_b64_tr_b16 v[60:61], v9 offset:6912
  v_mfma_f32_16x16x32_bf16 v[82:85], v[30:33], v[46:49], v[82:85]
  ds_read_b64_tr_b16 v[62:63], v10 offset:6144
  ds_read_b64_tr_b16 v[64:65], v10 offset:6912
  v_mfma_f32_16x16x32_bf16 v[74:77], v[26:29], v[50:53], v[74:77]
  v_mfma_f32_16x16x32_bf16 v[86:89], v[30:33], v[50:53], v[86:89]
  v_mfma_f32_16x16x32_bf16 v[106:109], v[102:105], v[26:29], v[106:109]
  v_mfma_f32_16x16x32_bf16 v[110:113], v[26:29], v[26:29], v[110:113]
  s_cmp_eq_u32 s35, 0
  s_cbranch_scc0 K1_SK_1a0
  v_mfma_f32_16x16x32_bf16 v[90:93], v[102:105], v[42:45], v[90:93]
  v_mfma_f32_16x16x32_bf16 v[94:97], v[102:105], v[46:49], v[94:97]
  v_mfma_f32_16x16x32_bf16 v[98:101], v[102:105], v[50:53], v[98:101]
K1_SK_1a0:
  s_waitcnt lgkmcnt(0)
  s_barrier
  v_mfma_f32_16x16x32_bf16 v[66:69], v[34:37], v[54:57], v[66:69]
  ds_read_b128 v[26:29], v4 offset:8192
  ds_read_b64_tr_b16 v[42:43], v8 offset:12288
  v_mfma_f32_16x16x32_bf16 v[78:81], v[38:41], v[54:57], v[78:81]
  ds_read_b64_tr_b16 v[44:45], v8 offset:13056
  ds_read_b128 v[30:33], v6 offset:8192
  v_mfma_f32_16x16x32_bf16 v[70:73], v[34:37], v[58:61], v[70:73]
  ds_read_b64_tr_b16 v[46:47], v9 offset:12288
  ds_read_b64_tr_b16 v[48:49], v9 offset:13056
  v_mfma_f32_16x16x32_bf16 v[82:85], v[38:41], v[58:61], v[82:85]
  ds_read_b64_tr_b16 v[50:51], v10 offset:12288
  ds_read_b64_tr_b16 v[52:53], v10 offset:13056
  v_mfma_f32_16x16x32_bf16 v[74:77], v[34:37], v[62:65], v[74:77]
  v_mfma_f32_16x16x32_bf16 v[86:89], v[38:41], v[62:65], v[86:89]
  v_mfma_f32_16x16x32_bf16 v[106:109], v[102:105], v[34:37], v[106:109]
  v_mfma_f32_16x16x32_bf16 v[110:113], v[34:37], v[34:37], v[110:113]
  s_cmp_eq_u32 s35, 1
  s_cbranch_scc0 K1_SK_1b0
  v_mfma_f32_16x16x32_bf16 v[90:93], v[102:105], v[54:57], v[90:93]
  v_mfma_f32_16x16x32_bf16 v[94:97], v[102:105], v[58:61], v[94:97]
  v_mfma_f32_16x16x32_bf16 v[98:101], v[102:105], v[62:65], v[98:101]
K1_SK_1b0:
  s_waitcnt lgkmcnt(0)
  v_mfma_f32_16x16x32_bf16 v[66:69], v[26:29], v[42:45], v[66:69]
  ds_read_b128 v[34:37], v5 offset:8192
  ds_read_b64_tr_b16 v[54:55], v8 offset:18432
  v_mfma_f32_16x16x32_bf16 v[78:81], v[30:33], v[42:45], v[78:81]
  ds_read_b64_tr_b16 v[56:57], v8 offset:19200
  ds_read_b128 v[38:41], v7 offset:8192
  v_mfma_f32_16x16x32_bf16 v[70:73], v[26:29], v[46:49], v[70:73]
  ds_read_b64_tr_b16 v[58:59], v9 offset:18432
  ds_read_b64_tr_b16 v[60:61], v9 offset:19200
  v_mfma_f32_16x16x32_bf16 v[82:85], v[30:33], v[46:49], v[82:85]
  ds_read_b64_tr_b16 v[62:63], v10 offset:18432
  ds_read_b64_tr_b16 v[64:65], v10 offset:19200
  v_mfma_f32_16x16x32_bf16 v[74:77], v[26:29], v[50:53], v[74:77]
  v_mfma_f32_16x16x32_bf16 v[86:89], v[30:33], v[50:53], v[86:89]
  v_mfma_f32_16x16x32_bf16 v[106:109], v[102:105], v[26:29], v[106:109]
  v_mfma_f32_16x16x32_bf16 v[110:113], v[26:29], v[26:29], v[110:113]
  s_cmp_eq_u32 s35, 0
  s_cbranch_scc0 K1_SK_1a1
  v_mfma_f32_16x16x32_bf16 v[90:93], v[102:105], v[42:45], v[90:93]
  v_mfma_f32_16x16x32_bf16 v[94:97], v[102:105], v[46:49], v[94:97]
  v_mfma_f32_16x16x32_bf16 v[98:101], v[102:105], v[50:53], v[98:101]
K1_SK_1a1:
  s_waitcnt lgkmcnt(0)
  s_barrier
  v_mfma_f32_16x16x32_bf16 v[66:69], v[34:37], v[54:57], v[66:69]
  ds_read_b128 v[26:29], v4 offset:16384
  ds_read_b64_tr_b16 v[42:43], v8 offset:24576
  v_mfma_f32_16x16x32_bf16 v[78:81], v[38:41], v[54:57], v[78:81]
  ds_read_b64_tr_b16 v[44:45], v8 offset:25344
  ds_read_b128 v[30:33], v6 offset:16384
  v_mfma_f32_16x16x32_bf16 v[70:73], v[34:37], v[58:61], v[70:73]
  ds_read_b64_tr_b16 v[46:47], v9 offset:24576
  ds_read_b64_tr_b16 v[48:49], v9 offset:25344
  v_mfma_f32_16x16x32_bf16 v[82:85], v[38:41], v[58:61], v[82:85]
  ds_read_b64_tr_b16 v[50:51], v10 offset:24576
  ds_read_b64_tr_b16 v[52:53], v10 offset:25344
  v_mfma_f32_16x16x32_bf16 v[74:77], v[34:37], v[62:65], v[74:77]
  v_mfma_f32_16x16x32_bf16 v[86:89], v[38:41], v[62:65], v[86:89]
  v_mfma_f32_16x16x32_bf16 v[106:109], v[102:105], v[34:37], v[106:109]
  v_mfma_f32_16x16x32_bf16 v[110:113], v[34:37], v[34:37], v[110:113]
  s_cmp_eq_u32 s35, 1
  s_cbranch_scc0 K1_SK_1b1
  v_mfma_f32_16x16x32_bf16 v[90:93], v[102:105], v[54:57], v[90:93]
  v_mfma_f32_16x16x32_bf16 v[94:97], v[102:105], v[58:61], v[94:97]
  v_mfma_f32_16x16x32_bf16 v[98:101], v[102:105], v[62:65], v[98:101]
K1_SK_1b1:
  s_waitcnt lgkmcnt(0)
  v_mfma_f32_16x16x32_bf16 v[66:69], v[26:29], v[42:45], v[66:69]
  ds_read_b128 v[34:37], v5 offset:16384
  ds_read_b64_tr_b16 v[54:55], v8 offset:30720
  v_mfma_f32_16x16x32_bf16 v[78:81], v[30:33], v[42:45], v[78:81]
  ds_read_b64_tr_b16 v[56:57], v8 offset:31488
  ds_read_b128 v[38:41], v7 offset:16384
  v_mfma_f32_16x16x32_bf16 v[70:73], v[26:29], v[46:49], v[70:73]
  ds_read_b64_tr_b16 v[58:59], v9 offset:30720
  ds_read_b64_tr_b16 v[60:61], v9 offset:31488
  v_mfma_f32_16x16x32_bf16 v[82:85], v[30:33], v[46:49], v[82:85]
  ds_read_b64_tr_b16 v[62:63], v10 offset:30720
  ds_read_b64_tr_b16 v[64:65], v10 offset:31488
  v_mfma_f32_16x16x32_bf16 v[74:77], v[26:29], v[50:53], v[74:77]
  v_mfma_f32_16x16x32_bf16 v[86:89], v[30:33], v[50:53], v[86:89]
  v_mfma_f32_16x16x32_bf16 v[106:109], v[102:105], v[26:29], v[106:109]
  v_mfma_f32_16x16x32_bf16 v[110:113], v[26:29], v[26:29], v[110:113]
  s_cmp_eq_u32 s35, 0
  s_cbranch_scc0 K1_SK_1a2
  v_mfma_f32_16x16x32_bf16 v[90:93], v[102:105], v[42:45], v[90:93]
  v_mfma_f32_16x16x32_bf16 v[94:97], v[102:105], v[46:49], v[94:97]
  v_mfma_f32_16x16x32_bf16 v[98:101], v[102:105], v[50:53], v[98:101]
K1_SK_1a2:
  s_waitcnt lgkmcnt(0)
  s_barrier
  v_mfma_f32_16x16x32_bf16 v[66:69], v[34:37], v[54:57], v[66:69]
  ds_read_b128 v[26:29], v4 offset:24576
  ds_read_b64_tr_b16 v[42:43], v8 offset:36864
  v_mfma_f32_16x16x32_bf16 v[78:81], v[38:41], v[54:57], v[78:81]
  ds_read_b64_tr_b16 v[44:45], v8 offset:37632
  ds_read_b128 v[30:33], v6 offset:24576
  v_mfma_f32_16x16x32_bf16 v[70:73], v[34:37], v[58:61], v[70:73]
  ds_read_b64_tr_b16 v[46:47], v9 offset:36864
  ds_read_b64_tr_b16 v[48:49], v9 offset:37632
  v_mfma_f32_16x16x32_bf16 v[82:85], v[38:41], v[58:61], v[82:85]
  ds_read_b64_tr_b16 v[50:51], v10 offset:36864
  ds_read_b64_tr_b16 v[52:53], v10 offset:37632
  v_mfma_f32_16x16x32_bf16 v[74:77], v[34:37], v[62:65], v[74:77]
  v_mfma_f32_16x16x32_bf16 v[86:89], v[38:41], v[62:65], v[86:89]
  v_mfma_f32_16x16x32_bf16 v[106:109], v[102:105], v[34:37], v[106:109]
  v_mfma_f32_16x16x32_bf16 v[110:113], v[34:37], v[34:37], v[110:113]
  s_cmp_eq_u32 s35, 1
  s_cbranch_scc0 K1_SK_1b2
  v_mfma_f32_16x16x32_bf16 v[90:93], v[102:105], v[54:57], v[90:93]
  v_mfma_f32_16x16x32_bf16 v[94:97], v[102:105], v[58:61], v[94:97]
  v_mfma_f32_16x16x32_bf16 v[98:101], v[102:105], v[62:65], v[98:101]
K1_SK_1b2:
  s_waitcnt lgkmcnt(0)
  v_mfma_f32_16x16x32_bf16 v[66:69], v[26:29], v[42:45], v[66:69]
  ds_read_b128 v[34:37], v5 offset:24576
  ds_read_b64_tr_b16 v[54:55], v8 offset:43008
  v_mfma_f32_16x16x32_bf16 v[78:81], v[30:33], v[42:45], v[78:81]
  ds_read_b64_tr_b16 v[56:57], v8 offset:43776
  ds_read_b128 v[38:41], v7 offset:24576
  v_mfma_f32_16x16x32_bf16 v[70:73], v[26:29], v[46:49], v[70:73]
  ds_read_b64_tr_b16 v[58:59], v9 offset:43008
  ds_read_b64_tr_b16 v[60:61], v9 offset:43776
  v_mfma_f32_16x16x32_bf16 v[82:85], v[30:33], v[46:49], v[82:85]
  ds_read_b64_tr_b16 v[62:63], v10 offset:43008
  ds_read_b64_tr_b16 v[64:65], v10 offset:43776
  v_mfma_f32_16x16x32_bf16 v[74:77], v[26:29], v[50:53], v[74:77]
  v_mfma_f32_16x16x32_bf16 v[86:89], v[30:33], v[50:53], v[86:89]
  v_mfma_f32_16x16x32_bf16 v[106:109], v[102:105], v[26:29], v[106:109]
  v_mfma_f32_16x16x32_bf16 v[110:113], v[26:29], v[26:29], v[110:113]
  s_cmp_eq_u32 s35, 0
  s_cbranch_scc0 K1_SK_1a3
  v_mfma_f32_16x16x32_bf16 v[90:93], v[102:105], v[42:45], v[90:93]
  v_mfma_f32_16x16x32_bf16 v[94:97], v[102:105], v[46:49], v[94:97]
  v_mfma_f32_16x16x32_bf16 v[98:101], v[102:105], v[50:53], v[98:101]
K1_SK_1a3:
  s_waitcnt lgkmcnt(0)
  s_barrier
  v_mfma_f32_16x16x32_bf16 v[66:69], v[34:37], v[54:57], v[66:69]
  ds_read_b128 v[26:29], v4 offset:32768
  ds_read_b64_tr_b16 v[42:43], v8 offset:49152
  v_mfma_f32_16x16x32_bf16 v[78:81], v[38:41], v[54:57], v[78:81]
  ds_read_b64_tr_b16 v[44:45], v8 offset:49920
  ds_read_b128 v[30:33], v6 offset:32768
  v_mfma_f32_16x16x32_bf16 v[70:73], v[34:37], v[58:61], v[70:73]
  ds_read_b64_tr_b16 v[46:47], v9 offset:49152
  ds_read_b64_tr_b16 v[48:49], v9 offset:49920
  v_mfma_f32_16x16x32_bf16 v[82:85], v[38:41], v[58:61], v[82:85]
  ds_read_b64_tr_b16 v[50:51], v10 offset:49152
  ds_read_b64_tr_b16 v[52:53], v10 offset:49920
  v_mfma_f32_16x16x32_bf16 v[74:77], v[34:37], v[62:65], v[74:77]
  v_mfma_f32_16x16x32_bf16 v[86:89], v[38:41], v[62:65], v[86:89]
  v_mfma_f32_16x16x32_bf16 v[106:109], v[102:105], v[34:37], v[106:109]
  v_mfma_f32_16x16x32_bf16 v[110:113], v[34:37], v[34:37], v[110:113]
  s_cmp_eq_u32 s35, 1
  s_cbranch_scc0 K1_SK_1b3
  v_mfma_f32_16x16x32_bf16 v[90:93], v[102:105], v[54:57], v[90:93]
  v_mfma_f32_16x16x32_bf16 v[94:97], v[102:105], v[58:61], v[94:97]
  v_mfma_f32_16x16x32_bf16 v[98:101], v[102:105], v[62:65], v[98:101]
K1_SK_1b3:
  s_waitcnt lgkmcnt(0)
  v_mfma_f32_16x16x32_bf16 v[66:69], v[26:29], v[42:45], v[66:69]
  ds_read_b128 v[34:37], v5 offset:32768
  ds_read_b64_tr_b16 v[54:55], v8 offset:55296
  v_mfma_f32_16x16x32_bf16 v[78:81], v[30:33], v[42:45], v[78:81]
  ds_read_b64_tr_b16 v[56:57], v8 offset:56064
  ds_read_b128 v[38:41], v7 offset:32768
  v_mfma_f32_16x16x32_bf16 v[70:73], v[26:29], v[46:49], v[70:73]
  ds_read_b64_tr_b16 v[58:59], v9 offset:55296
  ds_read_b64_tr_b16 v[60:61], v9 offset:56064
  v_mfma_f32_16x16x32_bf16 v[82:85], v[30:33], v[46:49], v[82:85]
  ds_read_b64_tr_b16 v[62:63], v10 offset:55296
  ds_read_b64_tr_b16 v[64:65], v10 offset:56064
  v_mfma_f32_16x16x32_bf16 v[74:77], v[26:29], v[50:53], v[74:77]
  v_mfma_f32_16x16x32_bf16 v[86:89], v[30:33], v[50:53], v[86:89]
  v_mfma_f32_16x16x32_bf16 v[106:109], v[102:105], v[26:29], v[106:109]
  v_mfma_f32_16x16x32_bf16 v[110:113], v[26:29], v[26:29], v[110:113]
  s_cmp_eq_u32 s35, 0
  s_cbranch_scc0 K1_SK_1a4
  v_mfma_f32_16x16x32_bf16 v[90:93], v[102:105], v[42:45], v[90:93]
  v_mfma_f32_16x16x32_bf16 v[94:97], v[102:105], v[46:49], v[94:97]
  v_mfma_f32_16x16x32_bf16 v[98:101], v[102:105], v[50:53], v[98:101]
K1_SK_1a4:
  s_waitcnt lgkmcnt(0)
  s_barrier
  v_add_u32 v4, 40960, v4
  v_add_u32 v5, 40960, v5
  v_add_u32 v6, 40960, v6
  v_add_u32 v7, 40960, v7
  v_mfma_f32_16x16x32_bf16 v[66:69], v[34:37], v[54:57], v[66:69]
  ds_read_b128 v[26:29], v4 offset:0
  ds_read_b64_tr_b16 v[42:43], v8 offset:0
  v_mfma_f32_16x16x32_bf16 v[78:81], v[38:41], v[54:57], v[78:81]
  ds_read_b64_tr_b16 v[44:45], v8 offset:768
  ds_read_b128 v[30:33], v6 offset:0
  v_mfma_f32_16x16x32_bf16 v[70:73], v[34:37], v[58:61], v[70:73]
  ds_read_b64_tr_b16 v[46:47], v9 offset:0
  ds_read_b64_tr_b16 v[48:49], v9 offset:768
  v_mfma_f32_16x16x32_bf16 v[82:85], v[38:41], v[58:61], v[82:85]
  ds_read_b64_tr_b16 v[50:51], v10 offset:0
  ds_read_b64_tr_b16 v[52:53], v10 offset:768
  v_mfma_f32_16x16x32_bf16 v[74:77], v[34:37], v[62:65], v[74:77]
  v_mfma_f32_16x16x32_bf16 v[86:89], v[38:41], v[62:65], v[86:89]
  v_mfma_f32_16x16x32_bf16 v[106:109], v[102:105], v[34:37], v[106:109]
  v_mfma_f32_16x16x32_bf16 v[110:113], v[34:37], v[34:37], v[110:113]
  s_cmp_eq_u32 s35, 1
  s_cbranch_scc0 K1_SK_1b4
  v_mfma_f32_16x16x32_bf16 v[90:93], v[102:105], v[54:57], v[90:93]
  v_mfma_f32_16x16x32_bf16 v[94:97], v[102:105], v[58:61], v[94:97]
  v_mfma_f32_16x16x32_bf16 v[98:101], v[102:105], v[62:65], v[98:101]
K1_SK_1b4:
  s_add_u32 s37, s37, 1
  s_cmp_lt_u32 s37, 2
  s_cbranch_scc1 K1_LOOP1
  s_setprio 2
  s_lshl_b32 s40, s32, 2
  v_mov_b32 v22, s40
  v_and_b32 v14, 3, v3
  v_cmp_eq_u32 vcc, 1, v14
  s_nop 1
  v_cndmask_b32 v110, v110, v111, vcc
  v_cmp_eq_u32 vcc, 2, v14
  s_nop 1
  v_cndmask_b32 v110, v110, v112, vcc
  v_cmp_eq_u32 vcc, 3, v14
  s_nop 1
  v_cndmask_b32 v110, v110, v113, vcc
  v_mul_f32 v16, 0x3acccccd, v106
  v_mul_f32 v18, 0x3acccccd, v110
  v_fma_f32 v18, -v16, v16, v18
  v_max_f32 v18, 0, v18
  v_cvt_pk_bf16_f32 v16, v16, v16
  v_lshlrev_b32 v16, 16, v16
  v_cvt_pk_bf16_f32 v18, v18, v18
  v_lshlrev_b32 v18, 16, v18
  v_add_f32 v18, 0x3727c5ac, v18
  v_cvt_pk_bf16_f32 v18, v18, v18
  v_lshlrev_b32 v18, 16, v18
  v_sqrt_f32 v18, v18
  s_nop 0
  v_cvt_pk_bf16_f32 v18, v18, v18
  v_lshlrev_b32 v18, 16, v18
  v_rcp_f32 v17, v18
  s_lshl_b32 s40, s35, 5
  s_lshl_b32 s41, s36, 4
  s_add_u32 s40, s40, s41
  v_add_u32 v18, s40, v3
  v_lshlrev_b32 v19, 2, v18
  v_add_u32 v19, 143360, v19
  s_mov_b32 exec_lo, 0xf0000f
  s_mov_b32 exec_hi, 0xf0000f00
  ds_write_b32 v19, v16
  ds_write_b32 v19, v17 offset:256
  s_branch K1_NOST1X
  s_cmp_eq_u32 s33, 0
  s_cbranch_scc0 K1_NOST1X
  s_lshl_b32 s41, s32, 9
  s_add_u32 s41, s41, 16777216
  v_lshlrev_b32 v18, 3, v18
  buffer_store_dwordx2 v[16:17], v18, s[16:19], s41 offen sc1
K1_NOST1X:
  s_mov_b64 exec, s[52:53]
  s_mul_i32 s40, s55, 192
  s_add_u32 s40, s40, 143872
  v_lshlrev_b32 v20, 2, v3
  v_add_u32 v20, s40, v20
  ds_write_b32 v20, v90 offset:0
  ds_write_b32 v20, v94 offset:64
  ds_write_b32 v20, v98 offset:128
  s_waitcnt lgkmcnt(0)
  s_barrier
  s_xor_b32 s41, s55, 2
  s_mul_i32 s41, s41, 192
  s_add_u32 s41, s41, 143872
  v_lshlrev_b32 v18, 2, v3
  v_add_u32 v18, s41, v18
  ds_read_b32 v136, v18 offset:0
  ds_read_b32 v138, v18 offset:64
  ds_read_b32 v140, v18 offset:128
  s_lshl_b32 s40, s35, 7
  s_lshl_b32 s41, s36, 6
  s_add_u32 s40, s40, s41
  s_add_u32 s40, s40, 143360
  v_lshlrev_b32 v19, 4, v2
  v_add_u32 v19, s40, v19
  v_xor_b32 v20, 64, v19
  ds_read_b128 v[26:29], v19
  ds_read_b128 v[30:33], v20
  ds_read_b128 v[34:37], v19 offset:256
  ds_read_b128 v[38:41], v20 offset:256
  v_mov_b32 v126, 0xc0135761
  v_mov_b32 v127, 0xc0135761
  v_mov_b32 v42, 0
  v_mov_b32 v43, 0
  v_mov_b32 v44, 0
  v_mov_b32 v45, 0
  v_mov_b32 v46, 0
  v_mov_b32 v47, 0
  v_mov_b32 v48, 0
  v_mov_b32 v49, 0
  v_mov_b32 v50, 0
  v_mov_b32 v51, 0
  v_mov_b32 v52, 0
  v_mov_b32 v53, 0
  v_mov_b32 v54, 0
  v_mov_b32 v55, 0
  v_mov_b32 v56, 0
  v_mov_b32 v57, 0
  s_waitcnt lgkmcnt(0)
  v_add_f32 v136, v136, v90
  v_sub_f32 v136, 0, v136
  v_add_f32 v138, v138, v94
  v_sub_f32 v138, 0, v138
  v_add_f32 v140, v140, v98
  v_sub_f32 v140, 0, v140
  v_fma_f32 v66, v26, v136, v66
  v_fma_f32 v67, v27, v136, v67
  v_mul_f32 v66, v66, v34
  v_mul_f32 v67, v67, v35
  v_mul_f32 v128, v66, v66
  v_mul_f32 v129, v67, v67
  v_fma_f32 v128, v128, s48, v126
  v_fma_f32 v129, v129, s48, v126
  v_mul_f32 v128, v128, v66
  v_mul_f32 v129, v129, v67
  v_exp_f32 v128, v128
  v_exp_f32 v129, v129
  v_add_f32 v128, 1.0, v128
  v_add_f32 v129, 1.0, v129
  v_rcp_f32 v128, v128
  v_rcp_f32 v129, v129
  v_mul_f32 v128, v128, v66
  v_mul_f32 v129, v129, v67
  v_cvt_pk_bf16_f32 v114, v128, v129
  v_add_f32 v42, v42, v128
  v_add_f32 v43, v43, v129
  v_fma_f32 v50, v128, v128, v50
  v_fma_f32 v51, v129, v129, v51
  v_fma_f32 v68, v28, v136, v68
  v_fma_f32 v69, v29, v136, v69
  v_mul_f32 v68, v68, v36
  v_mul_f32 v69, v69, v37
  v_mul_f32 v132, v68, v68
  v_mul_f32 v133, v69, v69
  v_fma_f32 v132, v132, s48, v126
  v_fma_f32 v133, v133, s48, v126
  v_mul_f32 v132, v132, v68
  v_mul_f32 v133, v133, v69
  v_exp_f32 v132, v132
  v_exp_f32 v133, v133
  v_add_f32 v132, 1.0, v132
  v_add_f32 v133, 1.0, v133
  v_rcp_f32 v132, v132
  v_rcp_f32 v133, v133
  v_mul_f32 v132, v132, v68
  v_mul_f32 v133, v133, v69
  v_cvt_pk_bf16_f32 v115, v132, v133
  v_add_f32 v44, v44, v132
  v_add_f32 v45, v45, v133
  v_fma_f32 v52, v132, v132, v52
  v_fma_f32 v53, v133, v133, v53
  s_barrier
  v_fma_f32 v78, v30, v136, v78
  v_fma_f32 v79, v31, v136, v79
  v_mul_f32 v78, v78, v38
  v_mul_f32 v79, v79, v39
  v_mul_f32 v128, v78, v78
  v_mul_f32 v129, v79, v79
  v_fma_f32 v128, v128, s48, v126
  v_fma_f32 v129, v129, s48, v126
  v_mul_f32 v128, v128, v78
  v_mul_f32 v129, v129, v79
  v_exp_f32 v128, v128
  v_exp_f32 v129, v129
  v_add_f32 v128, 1.0, v128
  v_add_f32 v129, 1.0, v129
  v_rcp_f32 v128, v128
  v_rcp_f32 v129, v129
  v_mul_f32 v128, v128, v78
  v_mul_f32 v129, v129, v79
  v_cvt_pk_bf16_f32 v116, v128, v129
  v_add_f32 v46, v46, v128
  v_add_f32 v47, v47, v129
  v_fma_f32 v54, v128, v128, v54
  v_fma_f32 v55, v129, v129, v55
  v_fma_f32 v80, v32, v136, v80
  v_fma_f32 v81, v33, v136, v81
  v_mul_f32 v80, v80, v40
  v_mul_f32 v81, v81, v41
  v_mul_f32 v132, v80, v80
  v_mul_f32 v133, v81, v81
  v_fma_f32 v132, v132, s48, v126
  v_fma_f32 v133, v133, s48, v126
  v_mul_f32 v132, v132, v80
  v_mul_f32 v133, v133, v81
  v_exp_f32 v132, v132
  v_exp_f32 v133, v133
  v_add_f32 v132, 1.0, v132
  v_add_f32 v133, 1.0, v133
  v_rcp_f32 v132, v132
  v_rcp_f32 v133, v133
  v_mul_f32 v132, v132, v80
  v_mul_f32 v133, v133, v81
  v_cvt_pk_bf16_f32 v117, v132, v133
  v_add_f32 v48, v48, v132
  v_add_f32 v49, v49, v133
  v_fma_f32 v56, v132, v132, v56
  v_fma_f32 v57, v133, v133, v57
  v_fma_f32 v70, v26, v138, v70
  v_fma_f32 v71, v27, v138, v71
  v_mul_f32 v70, v70, v34
  v_mul_f32 v71, v71, v35
  v_mul_f32 v128, v70, v70
  v_mul_f32 v129, v71, v71
  v_fma_f32 v128, v128, s48, v126
  v_fma_f32 v129, v129, s48, v126
  v_mul_f32 v128, v128, v70
  v_mul_f32 v129, v129, v71
  v_exp_f32 v128, v128
  v_exp_f32 v129, v129
  v_add_f32 v128, 1.0, v128
  v_add_f32 v129, 1.0, v129
  v_rcp_f32 v128, v128
  v_rcp_f32 v129, v129
  v_mul_f32 v128, v128, v70
  v_mul_f32 v129, v129, v71
  v_cvt_pk_bf16_f32 v118, v128, v129
  v_add_f32 v42, v42, v128
  v_add_f32 v43, v43, v129
  v_fma_f32 v50, v128, v128, v50
  v_fma_f32 v51, v129, v129, v51
  s_barrier
  v_fma_f32 v72, v28, v138, v72
  v_fma_f32 v73, v29, v138, v73
  v_mul_f32 v72, v72, v36
  v_mul_f32 v73, v73, v37
  v_mul_f32 v132, v72, v72
  v_mul_f32 v133, v73, v73
  v_fma_f32 v132, v132, s48, v126
  v_fma_f32 v133, v133, s48, v126
  v_mul_f32 v132, v132, v72
  v_mul_f32 v133, v133, v73
  v_exp_f32 v132, v132
  v_exp_f32 v133, v133
  v_add_f32 v132, 1.0, v132
  v_add_f32 v133, 1.0, v133
  v_rcp_f32 v132, v132
  v_rcp_f32 v133, v133
  v_mul_f32 v132, v132, v72
  v_mul_f32 v133, v133, v73
  v_cvt_pk_bf16_f32 v119, v132, v133
  v_add_f32 v44, v44, v132
  v_add_f32 v45, v45, v133
  v_fma_f32 v52, v132, v132, v52
  v_fma_f32 v53, v133, v133, v53
  v_fma_f32 v82, v30, v138, v82
  v_fma_f32 v83, v31, v138, v83
  v_mul_f32 v82, v82, v38
  v_mul_f32 v83, v83, v39
  v_mul_f32 v128, v82, v82
  v_mul_f32 v129, v83, v83
  v_fma_f32 v128, v128, s48, v126
  v_fma_f32 v129, v129, s48, v126
  v_mul_f32 v128, v128, v82
  v_mul_f32 v129, v129, v83
  v_exp_f32 v128, v128
  v_exp_f32 v129, v129
  v_add_f32 v128, 1.0, v128
  v_add_f32 v129, 1.0, v129
  v_rcp_f32 v128, v128
  v_rcp_f32 v129, v129
  v_mul_f32 v128, v128, v82
  v_mul_f32 v129, v129, v83
  v_cvt_pk_bf16_f32 v120, v128, v129
  v_add_f32 v46, v46, v128
  v_add_f32 v47, v47, v129
  v_fma_f32 v54, v128, v128, v54
  v_fma_f32 v55, v129, v129, v55
  s_barrier
  v_fma_f32 v84, v32, v138, v84
  v_fma_f32 v85, v33, v138, v85
  v_mul_f32 v84, v84, v40
  v_mul_f32 v85, v85, v41
  v_mul_f32 v132, v84, v84
  v_mul_f32 v133, v85, v85
  v_fma_f32 v132, v132, s48, v126
  v_fma_f32 v133, v133, s48, v126
  v_mul_f32 v132, v132, v84
  v_mul_f32 v133, v133, v85
  v_exp_f32 v132, v132
  v_exp_f32 v133, v133
  v_add_f32 v132, 1.0, v132
  v_add_f32 v133, 1.0, v133
  v_rcp_f32 v132, v132
  v_rcp_f32 v133, v133
  v_mul_f32 v132, v132, v84
  v_mul_f32 v133, v133, v85
  v_cvt_pk_bf16_f32 v121, v132, v133
  v_add_f32 v48, v48, v132
  v_add_f32 v49, v49, v133
  v_fma_f32 v56, v132, v132, v56
  v_fma_f32 v57, v133, v133, v57
  v_fma_f32 v74, v26, v140, v74
  v_fma_f32 v75, v27, v140, v75
  v_mul_f32 v74, v74, v34
  v_mul_f32 v75, v75, v35
  v_mul_f32 v128, v74, v74
  v_mul_f32 v129, v75, v75
  v_fma_f32 v128, v128, s48, v126
  v_fma_f32 v129, v129, s48, v126
  v_mul_f32 v128, v128, v74
  v_mul_f32 v129, v129, v75
  v_exp_f32 v128, v128
  v_exp_f32 v129, v129
  v_add_f32 v128, 1.0, v128
  v_add_f32 v129, 1.0, v129
  v_rcp_f32 v128, v128
  v_rcp_f32 v129, v129
  v_mul_f32 v128, v128, v74
  v_mul_f32 v129, v129, v75
  v_cvt_pk_bf16_f32 v122, v128, v129
  v_add_f32 v42, v42, v128
  v_add_f32 v43, v43, v129
  v_fma_f32 v50, v128, v128, v50
  v_fma_f32 v51, v129, v129, v51
  v_fma_f32 v76, v28, v140, v76
  v_fma_f32 v77, v29, v140, v77
  v_mul_f32 v76, v76, v36
  v_mul_f32 v77, v77, v37
  v_mul_f32 v132, v76, v76
  v_mul_f32 v133, v77, v77
  v_fma_f32 v132, v132, s48, v126
  v_fma_f32 v133, v133, s48, v126
  v_mul_f32 v132, v132, v76
  v_mul_f32 v133, v133, v77
  v_exp_f32 v132, v132
  v_exp_f32 v133, v133
  v_add_f32 v132, 1.0, v132
  v_add_f32 v133, 1.0, v133
  v_rcp_f32 v132, v132
  v_rcp_f32 v133, v133
  v_mul_f32 v132, v132, v76
  v_mul_f32 v133, v133, v77
  v_cvt_pk_bf16_f32 v123, v132, v133
  v_add_f32 v44, v44, v132
  v_add_f32 v45, v45, v133
  v_fma_f32 v52, v132, v132, v52
  v_fma_f32 v53, v133, v133, v53
  s_barrier
  v_fma_f32 v86, v30, v140, v86
  v_fma_f32 v87, v31, v140, v87
  v_mul_f32 v86, v86, v38
  v_mul_f32 v87, v87, v39
  v_mul_f32 v128, v86, v86
  v_mul_f32 v129, v87, v87
  v_fma_f32 v128, v128, s48, v126
  v_fma_f32 v129, v129, s48, v126
  v_mul_f32 v128, v128, v86
  v_mul_f32 v129, v129, v87
  v_exp_f32 v128, v128
  v_exp_f32 v129, v129
  v_add_f32 v128, 1.0, v128
  v_add_f32 v129, 1.0, v129
  v_rcp_f32 v128, v128
  v_rcp_f32 v129, v129
  v_mul_f32 v128, v128, v86
  v_mul_f32 v129, v129, v87
  v_cvt_pk_bf16_f32 v124, v128, v129
  v_add_f32 v46, v46, v128
  v_add_f32 v47, v47, v129
  v_fma_f32 v54, v128, v128, v54
  v_fma_f32 v55, v129, v129, v55
  v_fma_f32 v88, v32, v140, v88
  v_fma_f32 v89, v33, v140, v89
  v_mul_f32 v88, v88, v40
  v_mul_f32 v89, v89, v41
  v_mul_f32 v132, v88, v88
  v_mul_f32 v133, v89, v89
  v_fma_f32 v132, v132, s48, v126
  v_fma_f32 v133, v133, s48, v126
  v_mul_f32 v132, v132, v88
  v_mul_f32 v133, v133, v89
  v_exp_f32 v132, v132
  v_exp_f32 v133, v133
  v_add_f32 v132, 1.0, v132
  v_add_f32 v133, 1.0, v133
  v_rcp_f32 v132, v132
  v_rcp_f32 v133, v133
  v_mul_f32 v132, v132, v88
  v_mul_f32 v133, v133, v89
  v_cvt_pk_bf16_f32 v125, v132, v133
  v_add_f32 v48, v48, v132
  v_add_f32 v49, v49, v133
  v_fma_f32 v56, v132, v132, v56
  v_fma_f32 v57, v133, v133, v57
  s_barrier
  v_add_f32_dpp v42, v42, v42 row_ror:8 row_mask:0xf bank_mask:0xf
  v_add_f32_dpp v43, v43, v43 row_ror:8 row_mask:0xf bank_mask:0xf
  v_add_f32_dpp v44, v44, v44 row_ror:8 row_mask:0xf bank_mask:0xf
  v_add_f32_dpp v45, v45, v45 row_ror:8 row_mask:0xf bank_mask:0xf
  v_add_f32_dpp v46, v46, v46 row_ror:8 row_mask:0xf bank_mask:0xf
  v_add_f32_dpp v47, v47, v47 row_ror:8 row_mask:0xf bank_mask:0xf
  v_add_f32_dpp v48, v48, v48 row_ror:8 row_mask:0xf bank_mask:0xf
  v_add_f32_dpp v49, v49, v49 row_ror:8 row_mask:0xf bank_mask:0xf
  v_add_f32_dpp v50, v50, v50 row_ror:8 row_mask:0xf bank_mask:0xf
  v_add_f32_dpp v51, v51, v51 row_ror:8 row_mask:0xf bank_mask:0xf
  v_add_f32_dpp v52, v52, v52 row_ror:8 row_mask:0xf bank_mask:0xf
  v_add_f32_dpp v53, v53, v53 row_ror:8 row_mask:0xf bank_mask:0xf
  v_add_f32_dpp v54, v54, v54 row_ror:8 row_mask:0xf bank_mask:0xf
  v_add_f32_dpp v55, v55, v55 row_ror:8 row_mask:0xf bank_mask:0xf
  v_add_f32_dpp v56, v56, v56 row_ror:8 row_mask:0xf bank_mask:0xf
  v_add_f32_dpp v57, v57, v57 row_ror:8 row_mask:0xf bank_mask:0xf
  v_add_f32_dpp v42, v42, v42 row_ror:4 row_mask:0xf bank_mask:0xf
  v_add_f32_dpp v43, v43, v43 row_ror:4 row_mask:0xf bank_mask:0xf
  v_add_f32_dpp v44, v44, v44 row_ror:4 row_mask:0xf bank_mask:0xf
  v_add_f32_dpp v45, v45, v45 row_ror:4 row_mask:0xf bank_mask:0xf
  v_add_f32_dpp v46, v46, v46 row_ror:4 row_mask:0xf bank_mask:0xf
  v_add_f32_dpp v47, v47, v47 row_ror:4 row_mask:0xf bank_mask:0xf
  v_add_f32_dpp v48, v48, v48 row_ror:4 row_mask:0xf bank_mask:0xf
  v_add_f32_dpp v49, v49, v49 row_ror:4 row_mask:0xf bank_mask:0xf
  v_add_f32_dpp v50, v50, v50 row_ror:4 row_mask:0xf bank_mask:0xf
  v_add_f32_dpp v51, v51, v51 row_ror:4 row_mask:0xf bank_mask:0xf
  v_add_f32_dpp v52, v52, v52 row_ror:4 row_mask:0xf bank_mask:0xf
  v_add_f32_dpp v53, v53, v53 row_ror:4 row_mask:0xf bank_mask:0xf
  v_add_f32_dpp v54, v54, v54 row_ror:4 row_mask:0xf bank_mask:0xf
  v_add_f32_dpp v55, v55, v55 row_ror:4 row_mask:0xf bank_mask:0xf
  v_add_f32_dpp v56, v56, v56 row_ror:4 row_mask:0xf bank_mask:0xf
  v_add_f32_dpp v57, v57, v57 row_ror:4 row_mask:0xf bank_mask:0xf
  v_add_f32_dpp v42, v42, v42 row_ror:2 row_mask:0xf bank_mask:0xf
  v_add_f32_dpp v43, v43, v43 row_ror:2 row_mask:0xf bank_mask:0xf
  v_add_f32_dpp v44, v44, v44 row_ror:2 row_mask:0xf bank_mask:0xf
  v_add_f32_dpp v45, v45, v45 row_ror:2 row_mask:0xf bank_mask:0xf
  v_add_f32_dpp v46, v46, v46 row_ror:2 row_mask:0xf bank_mask:0xf
  v_add_f32_dpp v47, v47, v47 row_ror:2 row_mask:0xf bank_mask:0xf
  v_add_f32_dpp v48, v48, v48 row_ror:2 row_mask:0xf bank_mask:0xf
  v_add_f32_dpp v49, v49, v49 row_ror:2 row_mask:0xf bank_mask:0xf
  v_add_f32_dpp v50, v50, v50 row_ror:2 row_mask:0xf bank_mask:0xf
  v_add_f32_dpp v51, v51, v51 row_ror:2 row_mask:0xf bank_mask:0xf
  v_add_f32_dpp v52, v52, v52 row_ror:2 row_mask:0xf bank_mask:0xf
  v_add_f32_dpp v53, v53, v53 row_ror:2 row_mask:0xf bank_mask:0xf
  v_add_f32_dpp v54, v54, v54 row_ror:2 row_mask:0xf bank_mask:0xf
  v_add_f32_dpp v55, v55, v55 row_ror:2 row_mask:0xf bank_mask:0xf
  v_add_f32_dpp v56, v56, v56 row_ror:2 row_mask:0xf bank_mask:0xf
  v_add_f32_dpp v57, v57, v57 row_ror:2 row_mask:0xf bank_mask:0xf
  v_add_f32_dpp v42, v42, v42 row_ror:1 row_mask:0xf bank_mask:0xf
  v_add_f32_dpp v43, v43, v43 row_ror:1 row_mask:0xf bank_mask:0xf
  v_add_f32_dpp v44, v44, v44 row_ror:1 row_mask:0xf bank_mask:0xf
  v_add_f32_dpp v45, v45, v45 row_ror:1 row_mask:0xf bank_mask:0xf
  v_add_f32_dpp v46, v46, v46 row_ror:1 row_mask:0xf bank_mask:0xf
  v_add_f32_dpp v47, v47, v47 row_ror:1 row_mask:0xf bank_mask:0xf
  v_add_f32_dpp v48, v48, v48 row_ror:1 row_mask:0xf bank_mask:0xf
  v_add_f32_dpp v49, v49, v49 row_ror:1 row_mask:0xf bank_mask:0xf
  v_add_f32_dpp v50, v50, v50 row_ror:1 row_mask:0xf bank_mask:0xf
  v_add_f32_dpp v51, v51, v51 row_ror:1 row_mask:0xf bank_mask:0xf
  v_add_f32_dpp v52, v52, v52 row_ror:1 row_mask:0xf bank_mask:0xf
  v_add_f32_dpp v53, v53, v53 row_ror:1 row_mask:0xf bank_mask:0xf
  v_add_f32_dpp v54, v54, v54 row_ror:1 row_mask:0xf bank_mask:0xf
  v_add_f32_dpp v55, v55, v55 row_ror:1 row_mask:0xf bank_mask:0xf
  v_add_f32_dpp v56, v56, v56 row_ror:1 row_mask:0xf bank_mask:0xf
  v_add_f32_dpp v57, v57, v57 row_ror:1 row_mask:0xf bank_mask:0xf
  s_lshl_b32 s40, s36, 8
  s_add_u32 s40, s40, 2048
  v_add_u32 v19, s40, v19
  v_add_u32 v20, s40, v20
  s_mov_b32 exec_lo, 0x10001
  s_mov_b32 exec_hi, 0x10001
  ds_write_b128 v19, v[42:45]
  ds_write_b128 v20, v[46:49]
  ds_write_b128 v19, v[50:53] offset:512
  ds_write_b128 v20, v[54:57] offset:512
  s_mov_b64 exec, s[52:53]
  s_waitcnt lgkmcnt(0)
  s_barrier
  s_cmp_eq_u32 s34, 0
  s_cbranch_scc0 K1_NOPUB
  v_lshlrev_b32 v14, 2, v1
  v_add_u32 v14, 145408, v14
  ds_read_b32 v16, v14
  ds_read_b32 v18, v14 offset:256
  ds_read_b32 v17, v14 offset:512
  ds_read_b32 v19, v14 offset:768
  s_lshl_b32 s40, s32, 3
  s_add_u32 s40, s40, s33
  s_lshl_b32 s40, s40, 9
  s_add_u32 s40, s40, 16842752
  v_lshlrev_b32 v15, 3, v1
  s_waitcnt lgkmcnt(0)
  v_add_f32 v16, v16, v18
  v_add_f32 v17, v17, v19
  v_max_f32 v17, 0, v17
  buffer_store_dwordx2 v[16:17], v15, s[16:19], s40 offen sc1
K1_NOPUB:
  s_mul_i32 s40, s33, 6
  s_mul_i32 s41, s36, 3
  s_add_u32 s40, s40, s41
  s_lshl_b32 s40, s40, 6
  s_lshl_b32 s41, s32, 1
  s_add_u32 s40, s40, s41
  s_add_u32 s40, s40, s35
  s_lshl_b32 s40, s40, 10
  s_add_u32 s39, s40, 3145728
  v_and_b32 v21, 1, v2
  v_lshlrev_b32 v21, 1, v21
  v_lshrrev_b32 v24, 1, v2
  v_or_b32 v21, v21, v24
  s_lshl_b32 s41, s36, 1
  v_xor_b32 v21, s41, v21
  v_lshlrev_b32 v21, 4, v21
  v_add_u32 v21, v21, v3
  v_lshlrev_b32 v21, 4, v21
  v_and_b32 v24, 31, v1
  s_lshl_b32 s38, s35, 5
  v_add_u32 v24, s38, v24
  v_lshlrev_b32 v24, 3, v24
  s_lshl_b32 s38, s32, 12
  s_add_u32 s38, s38, 16842752
  buffer_load_dword v23, v22, s[4:7], 0 offen offset:0 sc1
  s_barrier
  s_barrier
  s_barrier
  s_waitcnt vmcnt(0)
  s_mov_b32 s54, 0
K1_CCHK:
  v_readfirstlane_b32 s40, v23
  s_nop 0
  s_cmp_ge_u32 s40, 8
  s_cbranch_scc1 K1_COK
  s_add_u32 s54, s54, 1
  s_cmp_lt_u32 s54, 0x200000
  s_cbranch_scc0 K1_COK
  s_sleep 4
  buffer_load_dword v23, v22, s[4:7], 0 offen offset:0 sc1
  s_waitcnt vmcnt(0)
  s_branch K1_CCHK
K1_COK:
  buffer_load_dwordx2 v[44:45], v24, s[16:19], s38 offen offset:0 sc1
  buffer_load_dwordx2 v[46:47], v24, s[16:19], s38 offen offset:512 sc1
  buffer_load_dwordx2 v[48:49], v24, s[16:19], s38 offen offset:1024 sc1
  buffer_load_dwordx2 v[50:51], v24, s[16:19], s38 offen offset:1536 sc1
  buffer_load_dwordx2 v[52:53], v24, s[16:19], s38 offen offset:2048 sc1
  buffer_load_dwordx2 v[54:55], v24, s[16:19], s38 offen offset:2560 sc1
  buffer_load_dwordx2 v[56:57], v24, s[16:19], s38 offen offset:3072 sc1
  buffer_load_dwordx2 v[58:59], v24, s[16:19], s38 offen offset:3584 sc1
  s_barrier
  s_setprio 0
  s_waitcnt vmcnt(0)
  s_mov_b32 s54, 0
K1_CHECK:
  s_mov_b32 s40, 0xbf800000
  v_cmp_eq_u32 vcc, s40, v45
  v_cmp_eq_u32 s[56:57], s40, v47
  s_nop 0
  s_or_b64 vcc, vcc, s[56:57]
  v_cmp_eq_u32 s[56:57], s40, v49
  s_nop 0
  s_or_b64 vcc, vcc, s[56:57]
  v_cmp_eq_u32 s[56:57], s40, v51
  s_nop 0
  s_or_b64 vcc, vcc, s[56:57]
  v_cmp_eq_u32 s[56:57], s40, v53
  s_nop 0
  s_or_b64 vcc, vcc, s[56:57]
  v_cmp_eq_u32 s[56:57], s40, v55
  s_nop 0
  s_or_b64 vcc, vcc, s[56:57]
  v_cmp_eq_u32 s[56:57], s40, v57
  s_nop 0
  s_or_b64 vcc, vcc, s[56:57]
  v_cmp_eq_u32 s[56:57], s40, v59
  s_nop 0
  s_or_b64 vcc, vcc, s[56:57]
  s_cmp_eq_u64 vcc, 0
  s_cbranch_scc1 K1_POLLED
  s_add_u32 s54, s54, 1
  s_cmp_lt_u32 s54, 0x200000
  s_cbranch_scc0 K1_POLLED
  buffer_load_dwordx2 v[44:45], v24, s[16:19], s38 offen offset:0 sc1
  buffer_load_dwordx2 v[46:47], v24, s[16:19], s38 offen offset:512 sc1
  buffer_load_dwordx2 v[48:49], v24, s[16:19], s38 offen offset:1024 sc1
  buffer_load_dwordx2 v[50:51], v24, s[16:19], s38 offen offset:1536 sc1
  buffer_load_dwordx2 v[52:53], v24, s[16:19], s38 offen offset:2048 sc1
  buffer_load_dwordx2 v[54:55], v24, s[16:19], s38 offen offset:2560 sc1
  buffer_load_dwordx2 v[56:57], v24, s[16:19], s38 offen offset:3072 sc1
  buffer_load_dwordx2 v[58:59], v24, s[16:19], s38 offen offset:3584 sc1
  s_waitcnt vmcnt(0)
  s_branch K1_CHECK
K1_POLLED:
  v_pk_add_f32 v[44:45], v[44:45], v[46:47]
  v_pk_add_f32 v[44:45], v[44:45], v[48:49]
  v_pk_add_f32 v[44:45], v[44:45], v[50:51]
  v_pk_add_f32 v[44:45], v[44:45], v[52:53]
  v_pk_add_f32 v[44:45], v[44:45], v[54:55]
  v_pk_add_f32 v[44:45], v[44:45], v[56:57]
  v_pk_add_f32 v[44:45], v[44:45], v[58:59]
  v_mul_f32 v16, 0x3aaaaaab, v44
  v_mul_f32 v18, 0x3aaaaaab, v45
  v_fma_f32 v18, -v16, v16, v18
  v_max_f32 v18, 0, v18
  v_cvt_pk_bf16_f32 v16, v16, v16
  v_lshlrev_b32 v16, 16, v16
  v_cvt_pk_bf16_f32 v18, v18, v18
  v_lshlrev_b32 v18, 16, v18
  v_add_f32 v18, 0x3727c5ac, v18
  v_cvt_pk_bf16_f32 v18, v18, v18
  v_lshlrev_b32 v18, 16, v18
  v_sqrt_f32 v18, v18
  s_nop 0
  v_cvt_pk_bf16_f32 v18, v18, v18
  v_lshlrev_b32 v18, 16, v18
  v_rcp_f32 v17, v18
  s_nop 0
  v_mul_f32 v16, v16, v17
  v_sub_f32 v16, 0, v16
  s_lshl_b32 s40, s55, 8
  s_add_u32 s40, s40, 146432
  v_and_b32 v18, 31, v1
  v_lshlrev_b32 v18, 2, v18
  v_add_u32 v18, s40, v18
  ds_write_b32 v18, v16
  ds_write_b32 v18, v17 offset:128
  s_lshl_b32 s41, s36, 6
  s_add_u32 s40, s40, s41
  v_lshlrev_b32 v19, 4, v2
  v_add_u32 v19, s40, v19
  v_xor_b32 v20, 64, v19
  s_waitcnt lgkmcnt(0)
  ds_read_b128 v[26:29], v19
  ds_read_b128 v[30:33], v20
  ds_read_b128 v[34:37], v19 offset:128
  ds_read_b128 v[38:41], v20 offset:128
  s_waitcnt lgkmcnt(0)
  v_lshlrev_b32 v128, 16, v114
  v_and_b32 v129, s47, v114
  v_pk_fma_f32 v[128:129], v[128:129], v[34:35], v[26:27]
  v_cvt_pk_bf16_f32 v114, v128, v129
  v_lshlrev_b32 v132, 16, v115
  v_and_b32 v133, s47, v115
  v_pk_fma_f32 v[132:133], v[132:133], v[36:37], v[28:29]
  v_cvt_pk_bf16_f32 v115, v132, v133
  v_lshlrev_b32 v128, 16, v116
  v_and_b32 v129, s47, v116
  v_pk_fma_f32 v[128:129], v[128:129], v[38:39], v[30:31]
  v_cvt_pk_bf16_f32 v116, v128, v129
  v_lshlrev_b32 v132, 16, v117
  v_and_b32 v133, s47, v117
  v_pk_fma_f32 v[132:133], v[132:133], v[40:41], v[32:33]
  v_cvt_pk_bf16_f32 v117, v132, v133
  v_permlane16_swap_b32 v114, v116
  s_nop 0
  v_permlane16_swap_b32 v115, v117
  s_add_u32 s41, s39, 0
  buffer_store_dwordx4 v[114:117], v21, s[16:19], s41 offen sc1
  v_lshlrev_b32 v128, 16, v118
  v_and_b32 v129, s47, v118
  v_pk_fma_f32 v[128:129], v[128:129], v[34:35], v[26:27]
  v_cvt_pk_bf16_f32 v118, v128, v129
  v_lshlrev_b32 v132, 16, v119
  v_and_b32 v133, s47, v119
  v_pk_fma_f32 v[132:133], v[132:133], v[36:37], v[28:29]
  v_cvt_pk_bf16_f32 v119, v132, v133
  v_lshlrev_b32 v128, 16, v120
  v_and_b32 v129, s47, v120
  v_pk_fma_f32 v[128:129], v[128:129], v[38:39], v[30:31]
  v_cvt_pk_bf16_f32 v120, v128, v129
  v_lshlrev_b32 v132, 16, v121
  v_and_b32 v133, s47, v121
  v_pk_fma_f32 v[132:133], v[132:133], v[40:41], v[32:33]
  v_cvt_pk_bf16_f32 v121, v132, v133
  v_permlane16_swap_b32 v118, v120
  s_nop 0
  v_permlane16_swap_b32 v119, v121
  s_add_u32 s41, s39, 65536
  buffer_store_dwordx4 v[118:121], v21, s[16:19], s41 offen sc1
  v_lshlrev_b32 v128, 16, v122
  v_and_b32 v129, s47, v122
  v_pk_fma_f32 v[128:129], v[128:129], v[34:35], v[26:27]
  v_cvt_pk_bf16_f32 v122, v128, v129
  v_lshlrev_b32 v132, 16, v123
  v_and_b32 v133, s47, v123
  v_pk_fma_f32 v[132:133], v[132:133], v[36:37], v[28:29]
  v_cvt_pk_bf16_f32 v123, v132, v133
  v_lshlrev_b32 v128, 16, v124
  v_and_b32 v129, s47, v124
  v_pk_fma_f32 v[128:129], v[128:129], v[38:39], v[30:31]
  v_cvt_pk_bf16_f32 v124, v128, v129
  v_lshlrev_b32 v132, 16, v125
  v_and_b32 v133, s47, v125
  v_pk_fma_f32 v[132:133], v[132:133], v[40:41], v[32:33]
  v_cvt_pk_bf16_f32 v125, v132, v133
  v_permlane16_swap_b32 v122, v124
  s_nop 0
  v_permlane16_swap_b32 v123, v125
  s_add_u32 s41, s39, 131072
  buffer_store_dwordx4 v[122:125], v21, s[16:19], s41 offen sc1
  s_waitcnt vmcnt(0)
  s_barrier
  s_load_dwordx2 s[56:57], s[0:1], 72
  s_and_b32 s35, s34, 1
  s_lshr_b32 s36, s34, 1
  v_xor_b32 v9, v2, v3
  v_lshlrev_b32 v9, 4, v9
  s_lshl_b32 s40, s36, 6
  v_xor_b32 v9, s40, v9
  v_lshlrev_b32 v10, 8, v3
  v_add_u32 v4, v9, v10
  v_xor_b32 v5, 128, v4
  s_mul_i32 s40, s33, 6
  s_mul_i32 s41, s35, 3
  s_add_u32 s40, s40, s41
  s_lshl_b32 s40, s40, 16
  s_add_u32 s40, s40, 3145728
  v_lshlrev_b32 v9, 4, v1
  s_add_u32 s41, s40, 0
  v_add_u32 v6, s41, v9
  s_add_u32 s41, s40, 65536
  v_add_u32 v7, s41, v9
  s_add_u32 s41, s40, 131072
  v_add_u32 v8, s41, v9
  s_lshl_b32 s39, s36, 10
  v_mov_b32 v48, 0
  v_mov_b32 v49, 0
  v_mov_b32 v50, 0
  v_mov_b32 v51, 0
  v_mov_b32 v52, 0
  v_mov_b32 v53, 0
  v_mov_b32 v54, 0
  v_mov_b32 v55, 0
  v_mov_b32 v56, 0
  v_mov_b32 v57, 0
  v_mov_b32 v58, 0
  v_mov_b32 v59, 0
  v_mov_b32 v60, 0
  v_mov_b32 v61, 0
  v_mov_b32 v62, 0
  v_mov_b32 v63, 0
  v_mov_b32 v64, 0
  v_mov_b32 v65, 0
  v_mov_b32 v66, 0
  v_mov_b32 v67, 0
  v_mov_b32 v68, 0
  v_mov_b32 v69, 0
  v_mov_b32 v70, 0
  v_mov_b32 v71, 0
  v_mov_b32 v72, 0
  v_mov_b32 v73, 0
  v_mov_b32 v74, 0
  v_mov_b32 v75, 0
  v_mov_b32 v76, 0
  v_mov_b32 v77, 0
  v_mov_b32 v78, 0
  v_mov_b32 v79, 0
  v_mov_b32 v80, 0
  v_mov_b32 v81, 0
  v_mov_b32 v82, 0
  v_mov_b32 v83, 0
  v_mov_b32 v84, 0
  v_mov_b32 v85, 0
  v_mov_b32 v86, 0
  v_mov_b32 v87, 0
  v_mov_b32 v88, 0
  v_mov_b32 v89, 0
  v_mov_b32 v90, 0
  v_mov_b32 v91, 0
  v_mov_b32 v92, 0
  v_mov_b32 v93, 0
  v_mov_b32 v94, 0
  v_mov_b32 v95, 0
  s_waitcnt lgkmcnt(0)
  s_mov_b32 s12, s56
  s_and_b32 s13, s57, 0xffff
  s_mov_b32 s14, 4096
  s_mov_b32 s15, 0x20000
  s_barrier
  s_add_u32 s38, s39, 0
  buffer_load_dwordx4 v[96:99], v6, s[16:19], s38 offen sc1
  buffer_load_dwordx4 v[100:103], v7, s[16:19], s38 offen sc1
  buffer_load_dwordx4 v[104:107], v8, s[16:19], s38 offen sc1
  s_add_u32 s38, s39, 2048
  buffer_load_dwordx4 v[108:111], v6, s[16:19], s38 offen sc1
  buffer_load_dwordx4 v[112:115], v7, s[16:19], s38 offen sc1
  buffer_load_dwordx4 v[116:119], v8, s[16:19], s38 offen sc1
  s_add_u32 s38, s39, 4096
  buffer_load_dwordx4 v[120:123], v6, s[16:19], s38 offen sc1
  buffer_load_dwordx4 v[124:127], v7, s[16:19], s38 offen sc1
  buffer_load_dwordx4 v[128:131], v8, s[16:19], s38 offen sc1
  s_add_u32 s38, s39, 6144
  buffer_load_dwordx4 v[132:135], v6, s[16:19], s38 offen sc1
  buffer_load_dwordx4 v[136:139], v7, s[16:19], s38 offen sc1
  buffer_load_dwordx4 v[140:143], v8, s[16:19], s38 offen sc1
  s_add_u32 s38, s39, 8192
  buffer_load_dwordx4 v[144:147], v6, s[16:19], s38 offen sc1
  buffer_load_dwordx4 v[148:151], v7, s[16:19], s38 offen sc1
  buffer_load_dwordx4 v[152:155], v8, s[16:19], s38 offen sc1
  s_mov_b32 s37, 0
  ds_read_b128 v[16:19], v4 offset:0
  ds_read_b128 v[20:23], v4 offset:4096
  ds_read_b128 v[24:27], v4 offset:8192
  ds_read_b128 v[28:31], v4 offset:12288
F2_GLOOP:
  s_lshl_b32 s40, s37, 1
  s_add_u32 s40, s40, 5
  s_lshl_b32 s38, s40, 11
  s_add_u32 s38, s38, s39
  s_cmp_lt_u32 s40, 32
  s_cselect_b32 s38, s38, 0x80000000
  s_waitcnt vmcnt(12) lgkmcnt(0)
  v_mfma_f32_16x16x32_bf16 v[48:51], v[96:99], v[16:19], v[48:51]
  ds_read_b128 v[32:35], v5 offset:0
  v_mfma_f32_16x16x32_bf16 v[64:67], v[100:103], v[16:19], v[64:67]
  ds_read_b128 v[36:39], v5 offset:4096
  v_mfma_f32_16x16x32_bf16 v[80:83], v[104:107], v[16:19], v[80:83]
  ds_read_b128 v[40:43], v5 offset:8192
  v_mfma_f32_16x16x32_bf16 v[52:55], v[96:99], v[20:23], v[52:55]
  ds_read_b128 v[44:47], v5 offset:12288
  v_mfma_f32_16x16x32_bf16 v[68:71], v[100:103], v[20:23], v[68:71]
  buffer_load_dwordx4 v[156:159], v6, s[16:19], s38 offen sc1
  v_mfma_f32_16x16x32_bf16 v[84:87], v[104:107], v[20:23], v[84:87]
  v_mfma_f32_16x16x32_bf16 v[56:59], v[96:99], v[24:27], v[56:59]
  buffer_load_dwordx4 v[160:163], v7, s[16:19], s38 offen sc1
  v_mfma_f32_16x16x32_bf16 v[72:75], v[100:103], v[24:27], v[72:75]
  v_mfma_f32_16x16x32_bf16 v[88:91], v[104:107], v[24:27], v[88:91]
  buffer_load_dwordx4 v[164:167], v8, s[16:19], s38 offen sc1
  v_mfma_f32_16x16x32_bf16 v[60:63], v[96:99], v[28:31], v[60:63]
  v_mfma_f32_16x16x32_bf16 v[76:79], v[100:103], v[28:31], v[76:79]
  v_mfma_f32_16x16x32_bf16 v[92:95], v[104:107], v[28:31], v[92:95]
  s_and_b32 s40, s37, 3
  s_movk_i32 s43, 16384
  s_cmp_eq_u32 s40, 3
  s_cselect_b32 s43, 4294918144, s43
  s_lshl_b32 s40, s37, 1
  s_add_u32 s40, s40, 6
  s_lshl_b32 s38, s40, 11
  s_add_u32 s38, s38, s39
  s_cmp_lt_u32 s40, 32
  s_cselect_b32 s38, s38, 0x80000000
  s_waitcnt lgkmcnt(0)
  s_barrier
  v_add_u32 v4, s43, v4
  s_waitcnt vmcnt(12)
  v_mfma_f32_16x16x32_bf16 v[48:51], v[108:111], v[32:35], v[48:51]
  ds_read_b128 v[16:19], v4 offset:0
  v_mfma_f32_16x16x32_bf16 v[64:67], v[112:115], v[32:35], v[64:67]
  ds_read_b128 v[20:23], v4 offset:4096
  v_mfma_f32_16x16x32_bf16 v[80:83], v[116:119], v[32:35], v[80:83]
  ds_read_b128 v[24:27], v4 offset:8192
  v_mfma_f32_16x16x32_bf16 v[52:55], v[108:111], v[36:39], v[52:55]
  ds_read_b128 v[28:31], v4 offset:12288
  v_mfma_f32_16x16x32_bf16 v[68:71], v[112:115], v[36:39], v[68:71]
  buffer_load_dwordx4 v[96:99], v6, s[16:19], s38 offen sc1
  v_mfma_f32_16x16x32_bf16 v[84:87], v[116:119], v[36:39], v[84:87]
  v_mfma_f32_16x16x32_bf16 v[56:59], v[108:111], v[40:43], v[56:59]
  buffer_load_dwordx4 v[100:103], v7, s[16:19], s38 offen sc1
  v_mfma_f32_16x16x32_bf16 v[72:75], v[112:115], v[40:43], v[72:75]
  v_mfma_f32_16x16x32_bf16 v[88:91], v[116:119], v[40:43], v[88:91]
  buffer_load_dwordx4 v[104:107], v8, s[16:19], s38 offen sc1
  v_mfma_f32_16x16x32_bf16 v[60:63], v[108:111], v[44:47], v[60:63]
  v_mfma_f32_16x16x32_bf16 v[76:79], v[112:115], v[44:47], v[76:79]
  v_mfma_f32_16x16x32_bf16 v[92:95], v[116:119], v[44:47], v[92:95]
  v_add_u32 v5, s43, v5
  s_add_u32 s37, s37, 1
  s_cmp_eq_u32 s37, 16
  s_cbranch_scc1 F2_GDONE
  s_lshl_b32 s40, s37, 1
  s_add_u32 s40, s40, 5
  s_lshl_b32 s38, s40, 11
  s_add_u32 s38, s38, s39
  s_cmp_lt_u32 s40, 32
  s_cselect_b32 s38, s38, 0x80000000
  s_waitcnt vmcnt(12) lgkmcnt(0)
  v_mfma_f32_16x16x32_bf16 v[48:51], v[120:123], v[16:19], v[48:51]
  ds_read_b128 v[32:35], v5 offset:0
  v_mfma_f32_16x16x32_bf16 v[64:67], v[124:127], v[16:19], v[64:67]
  ds_read_b128 v[36:39], v5 offset:4096
  v_mfma_f32_16x16x32_bf16 v[80:83], v[128:131], v[16:19], v[80:83]
  ds_read_b128 v[40:43], v5 offset:8192
  v_mfma_f32_16x16x32_bf16 v[52:55], v[120:123], v[20:23], v[52:55]
  ds_read_b128 v[44:47], v5 offset:12288
  v_mfma_f32_16x16x32_bf16 v[68:71], v[124:127], v[20:23], v[68:71]
  buffer_load_dwordx4 v[108:111], v6, s[16:19], s38 offen sc1
  v_mfma_f32_16x16x32_bf16 v[84:87], v[128:131], v[20:23], v[84:87]
  v_mfma_f32_16x16x32_bf16 v[56:59], v[120:123], v[24:27], v[56:59]
  buffer_load_dwordx4 v[112:115], v7, s[16:19], s38 offen sc1
  v_mfma_f32_16x16x32_bf16 v[72:75], v[124:127], v[24:27], v[72:75]
  v_mfma_f32_16x16x32_bf16 v[88:91], v[128:131], v[24:27], v[88:91]
  buffer_load_dwordx4 v[116:119], v8, s[16:19], s38 offen sc1
  v_mfma_f32_16x16x32_bf16 v[60:63], v[120:123], v[28:31], v[60:63]
  v_mfma_f32_16x16x32_bf16 v[76:79], v[124:127], v[28:31], v[76:79]
  v_mfma_f32_16x16x32_bf16 v[92:95], v[128:131], v[28:31], v[92:95]
  s_and_b32 s40, s37, 3
  s_movk_i32 s43, 16384
  s_cmp_eq_u32 s40, 3
  s_cselect_b32 s43, 4294918144, s43
  s_lshl_b32 s40, s37, 1
  s_add_u32 s40, s40, 6
  s_lshl_b32 s38, s40, 11
  s_add_u32 s38, s38, s39
  s_cmp_lt_u32 s40, 32
  s_cselect_b32 s38, s38, 0x80000000
  s_waitcnt lgkmcnt(0)
  s_barrier
  v_add_u32 v4, s43, v4
  s_waitcnt vmcnt(12)
  v_mfma_f32_16x16x32_bf16 v[48:51], v[132:135], v[32:35], v[48:51]
  ds_read_b128 v[16:19], v4 offset:0
  v_mfma_f32_16x16x32_bf16 v[64:67], v[136:139], v[32:35], v[64:67]
  ds_read_b128 v[20:23], v4 offset:4096
  v_mfma_f32_16x16x32_bf16 v[80:83], v[140:143], v[32:35], v[80:83]
  ds_read_b128 v[24:27], v4 offset:8192
  v_mfma_f32_16x16x32_bf16 v[52:55], v[132:135], v[36:39], v[52:55]
  ds_read_b128 v[28:31], v4 offset:12288
  v_mfma_f32_16x16x32_bf16 v[68:71], v[136:139], v[36:39], v[68:71]
  buffer_load_dwordx4 v[120:123], v6, s[16:19], s38 offen sc1
  v_mfma_f32_16x16x32_bf16 v[84:87], v[140:143], v[36:39], v[84:87]
  v_mfma_f32_16x16x32_bf16 v[56:59], v[132:135], v[40:43], v[56:59]
  buffer_load_dwordx4 v[124:127], v7, s[16:19], s38 offen sc1
  v_mfma_f32_16x16x32_bf16 v[72:75], v[136:139], v[40:43], v[72:75]
  v_mfma_f32_16x16x32_bf16 v[88:91], v[140:143], v[40:43], v[88:91]
  buffer_load_dwordx4 v[128:131], v8, s[16:19], s38 offen sc1
  v_mfma_f32_16x16x32_bf16 v[60:63], v[132:135], v[44:47], v[60:63]
  v_mfma_f32_16x16x32_bf16 v[76:79], v[136:139], v[44:47], v[76:79]
  v_mfma_f32_16x16x32_bf16 v[92:95], v[140:143], v[44:47], v[92:95]
  v_add_u32 v5, s43, v5
  s_add_u32 s37, s37, 1
  s_cmp_eq_u32 s37, 16
  s_cbranch_scc1 F2_GDONE
  s_lshl_b32 s40, s37, 1
  s_add_u32 s40, s40, 5
  s_lshl_b32 s38, s40, 11
  s_add_u32 s38, s38, s39
  s_cmp_lt_u32 s40, 32
  s_cselect_b32 s38, s38, 0x80000000
  s_waitcnt vmcnt(12) lgkmcnt(0)
  v_mfma_f32_16x16x32_bf16 v[48:51], v[144:147], v[16:19], v[48:51]
  ds_read_b128 v[32:35], v5 offset:0
  v_mfma_f32_16x16x32_bf16 v[64:67], v[148:151], v[16:19], v[64:67]
  ds_read_b128 v[36:39], v5 offset:4096
  v_mfma_f32_16x16x32_bf16 v[80:83], v[152:155], v[16:19], v[80:83]
  ds_read_b128 v[40:43], v5 offset:8192
  v_mfma_f32_16x16x32_bf16 v[52:55], v[144:147], v[20:23], v[52:55]
  ds_read_b128 v[44:47], v5 offset:12288
  v_mfma_f32_16x16x32_bf16 v[68:71], v[148:151], v[20:23], v[68:71]
  buffer_load_dwordx4 v[132:135], v6, s[16:19], s38 offen sc1
  v_mfma_f32_16x16x32_bf16 v[84:87], v[152:155], v[20:23], v[84:87]
  v_mfma_f32_16x16x32_bf16 v[56:59], v[144:147], v[24:27], v[56:59]
  buffer_load_dwordx4 v[136:139], v7, s[16:19], s38 offen sc1
  v_mfma_f32_16x16x32_bf16 v[72:75], v[148:151], v[24:27], v[72:75]
  v_mfma_f32_16x16x32_bf16 v[88:91], v[152:155], v[24:27], v[88:91]
  buffer_load_dwordx4 v[140:143], v8, s[16:19], s38 offen sc1
  v_mfma_f32_16x16x32_bf16 v[60:63], v[144:147], v[28:31], v[60:63]
  v_mfma_f32_16x16x32_bf16 v[76:79], v[148:151], v[28:31], v[76:79]
  v_mfma_f32_16x16x32_bf16 v[92:95], v[152:155], v[28:31], v[92:95]
  s_and_b32 s40, s37, 3
  s_movk_i32 s43, 16384
  s_cmp_eq_u32 s40, 3
  s_cselect_b32 s43, 4294918144, s43
  s_lshl_b32 s40, s37, 1
  s_add_u32 s40, s40, 6
  s_lshl_b32 s38, s40, 11
  s_add_u32 s38, s38, s39
  s_cmp_lt_u32 s40, 32
  s_cselect_b32 s38, s38, 0x80000000
  s_waitcnt lgkmcnt(0)
  s_barrier
  v_add_u32 v4, s43, v4
  s_waitcnt vmcnt(12)
  v_mfma_f32_16x16x32_bf16 v[48:51], v[156:159], v[32:35], v[48:51]
  ds_read_b128 v[16:19], v4 offset:0
  v_mfma_f32_16x16x32_bf16 v[64:67], v[160:163], v[32:35], v[64:67]
  ds_read_b128 v[20:23], v4 offset:4096
  v_mfma_f32_16x16x32_bf16 v[80:83], v[164:167], v[32:35], v[80:83]
  ds_read_b128 v[24:27], v4 offset:8192
  v_mfma_f32_16x16x32_bf16 v[52:55], v[156:159], v[36:39], v[52:55]
  ds_read_b128 v[28:31], v4 offset:12288
  v_mfma_f32_16x16x32_bf16 v[68:71], v[160:163], v[36:39], v[68:71]
  buffer_load_dwordx4 v[144:147], v6, s[16:19], s38 offen sc1
  v_mfma_f32_16x16x32_bf16 v[84:87], v[164:167], v[36:39], v[84:87]
  v_mfma_f32_16x16x32_bf16 v[56:59], v[156:159], v[40:43], v[56:59]
  buffer_load_dwordx4 v[148:151], v7, s[16:19], s38 offen sc1
  v_mfma_f32_16x16x32_bf16 v[72:75], v[160:163], v[40:43], v[72:75]
  v_mfma_f32_16x16x32_bf16 v[88:91], v[164:167], v[40:43], v[88:91]
  buffer_load_dwordx4 v[152:155], v8, s[16:19], s38 offen sc1
  v_mfma_f32_16x16x32_bf16 v[60:63], v[156:159], v[44:47], v[60:63]
  v_mfma_f32_16x16x32_bf16 v[76:79], v[160:163], v[44:47], v[76:79]
  v_mfma_f32_16x16x32_bf16 v[92:95], v[164:167], v[44:47], v[92:95]
  v_add_u32 v5, s43, v5
  s_add_u32 s37, s37, 1
  s_cmp_eq_u32 s37, 16
  s_cbranch_scc0 F2_GLOOP
F2_GDONE:
  s_lshl_b32 s40, s32, 2
  s_add_u32 s45, s40, s34
  v_lshlrev_b32 v10, 1, v3
  s_lshl_b32 s40, s45, 5
  buffer_load_ushort v15, v10, s[12:15], s40 offen
  s_waitcnt lgkmcnt(0)
  s_barrier
  s_mul_i32 s40, s34, 3072
  v_lshlrev_b32 v9, 4, v1
  v_add_u32 v10, s40, v9
  ds_write_b128 v10, v[48:51] offset:0
  ds_write_b128 v10, v[64:67] offset:1024
  ds_write_b128 v10, v[80:83] offset:2048
  ds_write_b128 v10, v[52:55] offset:12288
  ds_write_b128 v10, v[68:71] offset:13312
  ds_write_b128 v10, v[84:87] offset:14336
  s_waitcnt lgkmcnt(6)
  ds_write_b128 v10, v[56:59] offset:24576
  ds_write_b128 v10, v[72:75] offset:25600
  ds_write_b128 v10, v[88:91] offset:26624
  ds_write_b128 v10, v[60:63] offset:36864
  ds_write_b128 v10, v[76:79] offset:37888
  ds_write_b128 v10, v[92:95] offset:38912
  s_waitcnt lgkmcnt(6)
  s_waitcnt lgkmcnt(0)
  s_barrier
  s_mul_i32 s40, s34, 12288
  v_add_u32 v10, s40, v9
  ds_read_b128 v[16:19], v10 offset:0
  ds_read_b128 v[20:23], v10 offset:1024
  ds_read_b128 v[24:27], v10 offset:2048
  ds_read_b128 v[28:31], v10 offset:3072
  ds_read_b128 v[32:35], v10 offset:4096
  ds_read_b128 v[36:39], v10 offset:5120
  ds_read_b128 v[40:43], v10 offset:6144
  ds_read_b128 v[44:47], v10 offset:7168
  ds_read_b128 v[48:51], v10 offset:8192
  s_waitcnt lgkmcnt(6)
  ds_read_b128 v[52:55], v10 offset:9216
  ds_read_b128 v[56:59], v10 offset:10240
  ds_read_b128 v[60:63], v10 offset:11264
  s_mul_i32 s40, s34, 3072
  s_add_u32 s40, s40, 147456
  v_lshlrev_b32 v11, 3, v1
  v_add_u32 v11, s40, v11
  s_waitcnt lgkmcnt(6)
  ds_read_b64 v[64:65], v11 offset:0
  ds_read_b64 v[66:67], v11 offset:512
  ds_read_b64 v[68:69], v11 offset:1024
  ds_read_b64 v[70:71], v11 offset:1536
  ds_read_b64 v[72:73], v11 offset:2048
  ds_read_b64 v[74:75], v11 offset:2560
  s_waitcnt vmcnt(0)
  v_lshlrev_b32 v92, 16, v15
  s_mul_i32 s40, s45, 24576
  s_mul_i32 s41, s33, 3072
  s_add_u32 s40, s40, s41
  s_add_u32 s40, s40, 12582912
  s_waitcnt lgkmcnt(0)
  v_pk_add_f32 v[16:17], v[16:17], v[40:41]
  v_pk_add_f32 v[18:19], v[18:19], v[42:43]
  v_lshlrev_b32 v88, 16, v64
  v_and_b32 v89, s47, v64
  v_lshlrev_b32 v90, 16, v65
  v_and_b32 v91, s47, v65
  v_pk_add_f32 v[16:17], v[16:17], v[92:93] op_sel_hi:[1,0]
  v_pk_add_f32 v[18:19], v[18:19], v[92:93] op_sel_hi:[1,0]
  v_pk_mul_f32 v[16:17], v[16:17], v[88:89]
  v_pk_mul_f32 v[18:19], v[18:19], v[90:91]
  v_cvt_pk_bf16_f32 v76, v16, v17
  v_cvt_pk_bf16_f32 v77, v18, v19
  v_pk_add_f32 v[20:21], v[20:21], v[44:45]
  v_pk_add_f32 v[22:23], v[22:23], v[46:47]
  v_lshlrev_b32 v88, 16, v66
  v_and_b32 v89, s47, v66
  v_lshlrev_b32 v90, 16, v67
  v_and_b32 v91, s47, v67
  v_pk_add_f32 v[20:21], v[20:21], v[92:93] op_sel_hi:[1,0]
  v_pk_add_f32 v[22:23], v[22:23], v[92:93] op_sel_hi:[1,0]
  v_pk_mul_f32 v[20:21], v[20:21], v[88:89]
  v_pk_mul_f32 v[22:23], v[22:23], v[90:91]
  v_cvt_pk_bf16_f32 v78, v20, v21
  v_cvt_pk_bf16_f32 v79, v22, v23
  buffer_store_dwordx4 v[76:79], v9, s[16:19], s40 offen offset:0 sc1
  v_pk_add_f32 v[24:25], v[24:25], v[48:49]
  v_pk_add_f32 v[26:27], v[26:27], v[50:51]
  v_lshlrev_b32 v88, 16, v68
  v_and_b32 v89, s47, v68
  v_lshlrev_b32 v90, 16, v69
  v_and_b32 v91, s47, v69
  v_pk_add_f32 v[24:25], v[24:25], v[92:93] op_sel_hi:[1,0]
  v_pk_add_f32 v[26:27], v[26:27], v[92:93] op_sel_hi:[1,0]
  v_pk_mul_f32 v[24:25], v[24:25], v[88:89]
  v_pk_mul_f32 v[26:27], v[26:27], v[90:91]
  v_cvt_pk_bf16_f32 v80, v24, v25
  v_cvt_pk_bf16_f32 v81, v26, v27
  v_pk_add_f32 v[28:29], v[28:29], v[52:53]
  v_pk_add_f32 v[30:31], v[30:31], v[54:55]
  v_lshlrev_b32 v88, 16, v70
  v_and_b32 v89, s47, v70
  v_lshlrev_b32 v90, 16, v71
  v_and_b32 v91, s47, v71
  v_pk_add_f32 v[28:29], v[28:29], v[92:93] op_sel_hi:[1,0]
  v_pk_add_f32 v[30:31], v[30:31], v[92:93] op_sel_hi:[1,0]
  v_pk_mul_f32 v[28:29], v[28:29], v[88:89]
  v_pk_mul_f32 v[30:31], v[30:31], v[90:91]
  v_cvt_pk_bf16_f32 v82, v28, v29
  v_cvt_pk_bf16_f32 v83, v30, v31
  buffer_store_dwordx4 v[80:83], v9, s[16:19], s40 offen offset:1024 sc1
  v_pk_add_f32 v[32:33], v[32:33], v[56:57]
  v_pk_add_f32 v[34:35], v[34:35], v[58:59]
  v_lshlrev_b32 v88, 16, v72
  v_and_b32 v89, s47, v72
  v_lshlrev_b32 v90, 16, v73
  v_and_b32 v91, s47, v73
  v_pk_add_f32 v[32:33], v[32:33], v[92:93] op_sel_hi:[1,0]
  v_pk_add_f32 v[34:35], v[34:35], v[92:93] op_sel_hi:[1,0]
  v_pk_mul_f32 v[32:33], v[32:33], v[88:89]
  v_pk_mul_f32 v[34:35], v[34:35], v[90:91]
  v_cvt_pk_bf16_f32 v84, v32, v33
  v_cvt_pk_bf16_f32 v85, v34, v35
  v_pk_add_f32 v[36:37], v[36:37], v[60:61]
  v_pk_add_f32 v[38:39], v[38:39], v[62:63]
  v_lshlrev_b32 v88, 16, v74
  v_and_b32 v89, s47, v74
  v_lshlrev_b32 v90, 16, v75
  v_and_b32 v91, s47, v75
  v_pk_add_f32 v[36:37], v[36:37], v[92:93] op_sel_hi:[1,0]
  v_pk_add_f32 v[38:39], v[38:39], v[92:93] op_sel_hi:[1,0]
  v_pk_mul_f32 v[36:37], v[36:37], v[88:89]
  v_pk_mul_f32 v[38:39], v[38:39], v[90:91]
  v_cvt_pk_bf16_f32 v86, v36, v37
  v_cvt_pk_bf16_f32 v87, v38, v39
  buffer_store_dwordx4 v[84:87], v9, s[16:19], s40 offen offset:2048 sc1
  s_waitcnt vmcnt(0)
  s_barrier
  s_load_dwordx2 s[56:57], s[0:1], 0
  s_load_dwordx2 s[58:59], s[0:1], 88
  v_lshlrev_b32 v4, 4, v1
  s_lshl_b32 s35, s32, 2
  s_add_u32 s35, s35, s34
  s_mul_i32 s36, s35, 24576
  s_add_u32 s36, s36, 12582912
  s_lshl_b32 s40, s35, 4
  s_mul_i32 s40, s40, 1280
  s_mul_i32 s41, s33, 160
  s_add_u32 s40, s40, s41
  v_add_u32 v12, 0, v1
  v_mul_u32_u24 v13, 6554, v12
  v_lshrrev_b32 v13, 16, v13
  v_mul_u32_u24 v14, 10, v13
  v_sub_u32 v14, v12, v14
  v_lshlrev_b32 v14, 4, v14
  v_mul_u32_u24 v13, 1280, v13
  v_add_u32 v13, v13, v14
  v_add_u32 v5, s40, v13
  v_lshrrev_b32 v13, 1, v12
  v_lshlrev_b32 v13, 12, v13
  v_and_b32 v14, 1, v12
  v_lshlrev_b32 v14, 4, v14
  v_add_u32 v8, v13, v14
  v_add_u32 v12, 64, v1
  v_mul_u32_u24 v13, 6554, v12
  v_lshrrev_b32 v13, 16, v13
  v_mul_u32_u24 v14, 10, v13
  v_sub_u32 v14, v12, v14
  v_lshlrev_b32 v14, 4, v14
  v_mul_u32_u24 v13, 1280, v13
  v_add_u32 v13, v13, v14
  v_add_u32 v6, s40, v13
  v_lshrrev_b32 v13, 1, v12
  v_lshlrev_b32 v13, 12, v13
  v_and_b32 v14, 1, v12
  v_lshlrev_b32 v14, 4, v14
  v_add_u32 v9, v13, v14
  v_add_u32 v12, 128, v1
  v_mul_u32_u24 v13, 6554, v12
  v_lshrrev_b32 v13, 16, v13
  v_mul_u32_u24 v14, 10, v13
  v_sub_u32 v14, v12, v14
  v_lshlrev_b32 v14, 4, v14
  v_mul_u32_u24 v13, 1280, v13
  v_add_u32 v13, v13, v14
  v_add_u32 v7, s40, v13
  v_lshrrev_b32 v13, 1, v12
  v_lshlrev_b32 v13, 12, v13
  v_and_b32 v14, 1, v12
  v_lshlrev_b32 v14, 4, v14
  v_add_u32 v10, v13, v14
  s_mul_i32 s37, s34, 2560
  s_mul_i32 s38, s33, 327680
  s_lshl_b32 s41, s35, 5
  s_add_u32 s38, s38, s41
  s_add_u32 s38, s38, 9437184
  v_lshlrev_b32 v21, 3, v3
  s_lshl_b32 s39, s35, 7
  s_add_u32 s39, s39, 16777216
  v_add_u32 v20, 65536, v4
  s_waitcnt lgkmcnt(0)
  s_mov_b32 s8, s56
  s_and_b32 s9, s57, 0xffff
  s_mov_b32 s10, 2621440
  s_mov_b32 s11, 0x20000
  s_mov_b32 s12, s58
  s_and_b32 s13, s59, 0xffff
  s_mov_b32 s14, 2621440
  s_mov_b32 s15, 0x20000
  s_add_u32 m0, s37, 122880
  s_nop 0
  buffer_load_dwordx4 v5, s[8:11], 0 offen lds
  s_add_u32 m0, s37, 123904
  s_nop 0
  buffer_load_dwordx4 v6, s[8:11], 0 offen lds
  s_mov_b32 exec_hi, 0
  s_add_u32 m0, s37, 124928
  s_nop 0
  buffer_load_dwordx4 v7, s[8:11], 0 offen lds
  s_mov_b32 exec_hi, -1
  s_lshl_b32 s40, s34, 6
  s_add_u32 s40, s40, 143360
  v_lshlrev_b32 v21, 2, v3
  v_add_u32 v21, s40, v21
  ds_read_b32 v24, v21
  ds_read_b32 v25, v21 offset:256
  s_barrier
  s_add_u32 s40, s36, 0
  buffer_load_dwordx4 v[88:91], v4, s[16:19], s40 offen offset:0 sc1
  s_add_u32 s40, s36, 0
  buffer_load_dwordx4 v[92:95], v4, s[16:19], s40 offen offset:1024 sc1
  s_add_u32 s40, s36, 0
  buffer_load_dwordx4 v[96:99], v4, s[16:19], s40 offen offset:2048 sc1
  s_add_u32 s40, s36, 0
  buffer_load_dwordx4 v[100:103], v4, s[16:19], s40 offen offset:3072 sc1
  s_add_u32 s40, s36, 4096
  buffer_load_dwordx4 v[104:107], v4, s[16:19], s40 offen offset:0 sc1
  s_add_u32 s40, s36, 4096
  buffer_load_dwordx4 v[108:111], v4, s[16:19], s40 offen offset:1024 sc1
  s_add_u32 s40, s36, 4096
  buffer_load_dwordx4 v[112:115], v4, s[16:19], s40 offen offset:2048 sc1
  s_add_u32 s40, s36, 4096
  buffer_load_dwordx4 v[116:119], v4, s[16:19], s40 offen offset:3072 sc1
  s_add_u32 s40, s36, 8192
  buffer_load_dwordx4 v[120:123], v4, s[16:19], s40 offen offset:0 sc1
  s_add_u32 s40, s36, 8192
  buffer_load_dwordx4 v[124:127], v4, s[16:19], s40 offen offset:1024 sc1
  s_add_u32 s40, s36, 8192
  buffer_load_dwordx4 v[128:131], v4, s[16:19], s40 offen offset:2048 sc1
  s_add_u32 s40, s36, 8192
  buffer_load_dwordx4 v[132:135], v4, s[16:19], s40 offen offset:3072 sc1
  v_mov_b32 v68, 0
  v_mov_b32 v69, 0
  v_mov_b32 v70, 0
  v_mov_b32 v71, 0
  v_mov_b32 v72, 0
  v_mov_b32 v73, 0
  v_mov_b32 v74, 0
  v_mov_b32 v75, 0
  v_mov_b32 v76, 0
  v_mov_b32 v77, 0
  v_mov_b32 v78, 0
  v_mov_b32 v79, 0
  v_mov_b32 v80, 0
  v_mov_b32 v81, 0
  v_mov_b32 v82, 0
  v_mov_b32 v83, 0
  v_mov_b32 v84, 0
  v_mov_b32 v85, 0
  v_mov_b32 v86, 0
  v_mov_b32 v87, 0
  s_barrier
  ds_read_b128 v[28:31], v4 offset:0
  ds_read_b128 v[32:35], v4 offset:1024
  ds_read_b128 v[36:39], v4 offset:2048
  ds_read_b128 v[40:43], v4 offset:3072
  ds_read_b128 v[44:47], v4 offset:4096
  s_waitcnt vmcnt(11) lgkmcnt(0)
  v_mfma_f32_16x16x32_bf16 v[68:71], v[28:31], v[88:91], v[68:71]
  ds_read_b128 v[48:51], v4 offset:5120
  v_mfma_f32_16x16x32_bf16 v[72:75], v[32:35], v[88:91], v[72:75]
  ds_read_b128 v[52:55], v4 offset:6144
  v_mfma_f32_16x16x32_bf16 v[76:79], v[36:39], v[88:91], v[76:79]
  ds_read_b128 v[56:59], v4 offset:7168
  v_mfma_f32_16x16x32_bf16 v[80:83], v[40:43], v[88:91], v[80:83]
  ds_read_b128 v[60:63], v4 offset:8192
  v_mfma_f32_16x16x32_bf16 v[84:87], v[44:47], v[88:91], v[84:87]
  ds_read_b128 v[64:67], v4 offset:9216
  s_add_u32 s40, s36, 12288
  buffer_load_dwordx4 v[88:91], v4, s[16:19], s40 offen offset:0 sc1
  s_waitcnt vmcnt(11) lgkmcnt(0)
  v_mfma_f32_16x16x32_bf16 v[68:71], v[48:51], v[92:95], v[68:71]
  ds_read_b128 v[28:31], v4 offset:10240
  v_mfma_f32_16x16x32_bf16 v[72:75], v[52:55], v[92:95], v[72:75]
  ds_read_b128 v[32:35], v4 offset:11264
  v_mfma_f32_16x16x32_bf16 v[76:79], v[56:59], v[92:95], v[76:79]
  ds_read_b128 v[36:39], v4 offset:12288
  v_mfma_f32_16x16x32_bf16 v[80:83], v[60:63], v[92:95], v[80:83]
  ds_read_b128 v[40:43], v4 offset:13312
  v_mfma_f32_16x16x32_bf16 v[84:87], v[64:67], v[92:95], v[84:87]
  ds_read_b128 v[44:47], v4 offset:14336
  s_add_u32 s40, s36, 12288
  buffer_load_dwordx4 v[92:95], v4, s[16:19], s40 offen offset:1024 sc1
  s_waitcnt vmcnt(11) lgkmcnt(0)
  v_mfma_f32_16x16x32_bf16 v[68:71], v[28:31], v[96:99], v[68:71]
  ds_read_b128 v[48:51], v4 offset:15360
  v_mfma_f32_16x16x32_bf16 v[72:75], v[32:35], v[96:99], v[72:75]
  ds_read_b128 v[52:55], v4 offset:16384
  v_mfma_f32_16x16x32_bf16 v[76:79], v[36:39], v[96:99], v[76:79]
  ds_read_b128 v[56:59], v4 offset:17408
  v_mfma_f32_16x16x32_bf16 v[80:83], v[40:43], v[96:99], v[80:83]
  ds_read_b128 v[60:63], v4 offset:18432
  v_mfma_f32_16x16x32_bf16 v[84:87], v[44:47], v[96:99], v[84:87]
  ds_read_b128 v[64:67], v4 offset:19456
  s_add_u32 s40, s36, 12288
  buffer_load_dwordx4 v[96:99], v4, s[16:19], s40 offen offset:2048 sc1
  s_waitcnt vmcnt(11) lgkmcnt(0)
  s_barrier
  v_mfma_f32_16x16x32_bf16 v[68:71], v[48:51], v[100:103], v[68:71]
  ds_read_b128 v[28:31], v4 offset:20480
  v_mfma_f32_16x16x32_bf16 v[72:75], v[52:55], v[100:103], v[72:75]
  ds_read_b128 v[32:35], v4 offset:21504
  v_mfma_f32_16x16x32_bf16 v[76:79], v[56:59], v[100:103], v[76:79]
  ds_read_b128 v[36:39], v4 offset:22528
  v_mfma_f32_16x16x32_bf16 v[80:83], v[60:63], v[100:103], v[80:83]
  ds_read_b128 v[40:43], v4 offset:23552
  v_mfma_f32_16x16x32_bf16 v[84:87], v[64:67], v[100:103], v[84:87]
  ds_read_b128 v[44:47], v4 offset:24576
  s_add_u32 s40, s36, 12288
  buffer_load_dwordx4 v[100:103], v4, s[16:19], s40 offen offset:3072 sc1
  s_waitcnt vmcnt(11) lgkmcnt(0)
  v_mfma_f32_16x16x32_bf16 v[68:71], v[28:31], v[104:107], v[68:71]
  ds_read_b128 v[48:51], v4 offset:25600
  v_mfma_f32_16x16x32_bf16 v[72:75], v[32:35], v[104:107], v[72:75]
  ds_read_b128 v[52:55], v4 offset:26624
  v_mfma_f32_16x16x32_bf16 v[76:79], v[36:39], v[104:107], v[76:79]
  ds_read_b128 v[56:59], v4 offset:27648
  v_mfma_f32_16x16x32_bf16 v[80:83], v[40:43], v[104:107], v[80:83]
  ds_read_b128 v[60:63], v4 offset:28672
  v_mfma_f32_16x16x32_bf16 v[84:87], v[44:47], v[104:107], v[84:87]
  ds_read_b128 v[64:67], v4 offset:29696
  s_add_u32 s40, s36, 16384
  buffer_load_dwordx4 v[104:107], v4, s[16:19], s40 offen offset:0 sc1
  s_waitcnt vmcnt(11) lgkmcnt(0)
  v_mfma_f32_16x16x32_bf16 v[68:71], v[48:51], v[108:111], v[68:71]
  ds_read_b128 v[28:31], v4 offset:30720
  v_mfma_f32_16x16x32_bf16 v[72:75], v[52:55], v[108:111], v[72:75]
  ds_read_b128 v[32:35], v4 offset:31744
  v_mfma_f32_16x16x32_bf16 v[76:79], v[56:59], v[108:111], v[76:79]
  ds_read_b128 v[36:39], v4 offset:32768
  v_mfma_f32_16x16x32_bf16 v[80:83], v[60:63], v[108:111], v[80:83]
  ds_read_b128 v[40:43], v4 offset:33792
  v_mfma_f32_16x16x32_bf16 v[84:87], v[64:67], v[108:111], v[84:87]
  ds_read_b128 v[44:47], v4 offset:34816
  s_add_u32 s40, s36, 16384
  buffer_load_dwordx4 v[108:111], v4, s[16:19], s40 offen offset:1024 sc1
  s_waitcnt vmcnt(11) lgkmcnt(0)
  v_mfma_f32_16x16x32_bf16 v[68:71], v[28:31], v[112:115], v[68:71]
  ds_read_b128 v[48:51], v4 offset:35840
  v_mfma_f32_16x16x32_bf16 v[72:75], v[32:35], v[112:115], v[72:75]
  ds_read_b128 v[52:55], v4 offset:36864
  v_mfma_f32_16x16x32_bf16 v[76:79], v[36:39], v[112:115], v[76:79]
  ds_read_b128 v[56:59], v4 offset:37888
  v_mfma_f32_16x16x32_bf16 v[80:83], v[40:43], v[112:115], v[80:83]
  ds_read_b128 v[60:63], v4 offset:38912
  v_mfma_f32_16x16x32_bf16 v[84:87], v[44:47], v[112:115], v[84:87]
  ds_read_b128 v[64:67], v4 offset:39936
  s_add_u32 s40, s36, 16384
  buffer_load_dwordx4 v[112:115], v4, s[16:19], s40 offen offset:2048 sc1
  s_waitcnt vmcnt(11) lgkmcnt(0)
  s_barrier
  v_mfma_f32_16x16x32_bf16 v[68:71], v[48:51], v[116:119], v[68:71]
  ds_read_b128 v[28:31], v4 offset:40960
  v_mfma_f32_16x16x32_bf16 v[72:75], v[52:55], v[116:119], v[72:75]
  ds_read_b128 v[32:35], v4 offset:41984
  v_mfma_f32_16x16x32_bf16 v[76:79], v[56:59], v[116:119], v[76:79]
  ds_read_b128 v[36:39], v4 offset:43008
  v_mfma_f32_16x16x32_bf16 v[80:83], v[60:63], v[116:119], v[80:83]
  ds_read_b128 v[40:43], v4 offset:44032
  v_mfma_f32_16x16x32_bf16 v[84:87], v[64:67], v[116:119], v[84:87]
  ds_read_b128 v[44:47], v4 offset:45056
  s_add_u32 s40, s36, 16384
  buffer_load_dwordx4 v[116:119], v4, s[16:19], s40 offen offset:3072 sc1
  s_waitcnt vmcnt(11) lgkmcnt(0)
  v_mfma_f32_16x16x32_bf16 v[68:71], v[28:31], v[120:123], v[68:71]
  ds_read_b128 v[48:51], v4 offset:46080
  v_mfma_f32_16x16x32_bf16 v[72:75], v[32:35], v[120:123], v[72:75]
  ds_read_b128 v[52:55], v4 offset:47104
  v_mfma_f32_16x16x32_bf16 v[76:79], v[36:39], v[120:123], v[76:79]
  ds_read_b128 v[56:59], v4 offset:48128
  v_mfma_f32_16x16x32_bf16 v[80:83], v[40:43], v[120:123], v[80:83]
  ds_read_b128 v[60:63], v4 offset:49152
  v_mfma_f32_16x16x32_bf16 v[84:87], v[44:47], v[120:123], v[84:87]
  ds_read_b128 v[64:67], v4 offset:50176
  s_add_u32 s40, s36, 20480
  buffer_load_dwordx4 v[120:123], v4, s[16:19], s40 offen offset:0 sc1
  s_waitcnt vmcnt(11) lgkmcnt(0)
  v_mfma_f32_16x16x32_bf16 v[68:71], v[48:51], v[124:127], v[68:71]
  ds_read_b128 v[28:31], v4 offset:51200
  v_mfma_f32_16x16x32_bf16 v[72:75], v[52:55], v[124:127], v[72:75]
  ds_read_b128 v[32:35], v4 offset:52224
  v_mfma_f32_16x16x32_bf16 v[76:79], v[56:59], v[124:127], v[76:79]
  ds_read_b128 v[36:39], v4 offset:53248
  v_mfma_f32_16x16x32_bf16 v[80:83], v[60:63], v[124:127], v[80:83]
  ds_read_b128 v[40:43], v4 offset:54272
  v_mfma_f32_16x16x32_bf16 v[84:87], v[64:67], v[124:127], v[84:87]
  ds_read_b128 v[44:47], v4 offset:55296
  s_add_u32 s40, s36, 20480
  buffer_load_dwordx4 v[124:127], v4, s[16:19], s40 offen offset:1024 sc1
  s_waitcnt vmcnt(11) lgkmcnt(0)
  v_mfma_f32_16x16x32_bf16 v[68:71], v[28:31], v[128:131], v[68:71]
  ds_read_b128 v[48:51], v4 offset:56320
  v_mfma_f32_16x16x32_bf16 v[72:75], v[32:35], v[128:131], v[72:75]
  ds_read_b128 v[52:55], v4 offset:57344
  v_mfma_f32_16x16x32_bf16 v[76:79], v[36:39], v[128:131], v[76:79]
  ds_read_b128 v[56:59], v4 offset:58368
  v_mfma_f32_16x16x32_bf16 v[80:83], v[40:43], v[128:131], v[80:83]
  ds_read_b128 v[60:63], v4 offset:59392
  v_mfma_f32_16x16x32_bf16 v[84:87], v[44:47], v[128:131], v[84:87]
  ds_read_b128 v[64:67], v4 offset:60416
  s_add_u32 s40, s36, 20480
  buffer_load_dwordx4 v[128:131], v4, s[16:19], s40 offen offset:2048 sc1
  s_waitcnt vmcnt(11) lgkmcnt(0)
  s_barrier
  v_mfma_f32_16x16x32_bf16 v[68:71], v[48:51], v[132:135], v[68:71]
  ds_read_b128 v[28:31], v4 offset:61440
  v_mfma_f32_16x16x32_bf16 v[72:75], v[52:55], v[132:135], v[72:75]
  ds_read_b128 v[32:35], v4 offset:62464
  v_mfma_f32_16x16x32_bf16 v[76:79], v[56:59], v[132:135], v[76:79]
  ds_read_b128 v[36:39], v4 offset:63488
  v_mfma_f32_16x16x32_bf16 v[80:83], v[60:63], v[132:135], v[80:83]
  ds_read_b128 v[40:43], v4 offset:64512
  v_mfma_f32_16x16x32_bf16 v[84:87], v[64:67], v[132:135], v[84:87]
  ds_read_b128 v[44:47], v20 offset:0
  s_add_u32 s40, s36, 20480
  buffer_load_dwordx4 v[132:135], v4, s[16:19], s40 offen offset:3072 sc1
  s_waitcnt vmcnt(11) lgkmcnt(0)
  v_mfma_f32_16x16x32_bf16 v[68:71], v[28:31], v[88:91], v[68:71]
  ds_read_b128 v[48:51], v20 offset:1024
  v_mfma_f32_16x16x32_bf16 v[72:75], v[32:35], v[88:91], v[72:75]
  ds_read_b128 v[52:55], v20 offset:2048
  v_mfma_f32_16x16x32_bf16 v[76:79], v[36:39], v[88:91], v[76:79]
  ds_read_b128 v[56:59], v20 offset:3072
  v_mfma_f32_16x16x32_bf16 v[80:83], v[40:43], v[88:91], v[80:83]
  ds_read_b128 v[60:63], v20 offset:4096
  v_mfma_f32_16x16x32_bf16 v[84:87], v[44:47], v[88:91], v[84:87]
  ds_read_b128 v[64:67], v20 offset:5120
  s_add_u32 m0, s37, 133120
  s_nop 0
  buffer_load_dwordx4 v8, s[16:19], s38 offen sc1 lds
  s_waitcnt vmcnt(11) lgkmcnt(0)
  v_mfma_f32_16x16x32_bf16 v[68:71], v[48:51], v[92:95], v[68:71]
  ds_read_b128 v[28:31], v20 offset:6144
  v_mfma_f32_16x16x32_bf16 v[72:75], v[52:55], v[92:95], v[72:75]
  ds_read_b128 v[32:35], v20 offset:7168
  v_mfma_f32_16x16x32_bf16 v[76:79], v[56:59], v[92:95], v[76:79]
  ds_read_b128 v[36:39], v20 offset:8192
  v_mfma_f32_16x16x32_bf16 v[80:83], v[60:63], v[92:95], v[80:83]
  ds_read_b128 v[40:43], v20 offset:9216
  v_mfma_f32_16x16x32_bf16 v[84:87], v[64:67], v[92:95], v[84:87]
  ds_read_b128 v[44:47], v20 offset:10240
  s_add_u32 m0, s37, 134144
  s_nop 0
  buffer_load_dwordx4 v9, s[16:19], s38 offen sc1 lds
  s_waitcnt vmcnt(11) lgkmcnt(0)
  v_mfma_f32_16x16x32_bf16 v[68:71], v[28:31], v[96:99], v[68:71]
  ds_read_b128 v[48:51], v20 offset:11264
  v_mfma_f32_16x16x32_bf16 v[72:75], v[32:35], v[96:99], v[72:75]
  ds_read_b128 v[52:55], v20 offset:12288
  v_mfma_f32_16x16x32_bf16 v[76:79], v[36:39], v[96:99], v[76:79]
  ds_read_b128 v[56:59], v20 offset:13312
  v_mfma_f32_16x16x32_bf16 v[80:83], v[40:43], v[96:99], v[80:83]
  ds_read_b128 v[60:63], v20 offset:14336
  v_mfma_f32_16x16x32_bf16 v[84:87], v[44:47], v[96:99], v[84:87]
  ds_read_b128 v[64:67], v20 offset:15360
  s_mov_b32 exec_hi, 0
  s_add_u32 m0, s37, 135168
  s_nop 0
  buffer_load_dwordx4 v10, s[16:19], s38 offen sc1 lds
  s_mov_b32 exec_hi, -1
  s_waitcnt vmcnt(11) lgkmcnt(0)
  s_barrier
  v_mfma_f32_16x16x32_bf16 v[68:71], v[48:51], v[100:103], v[68:71]
  ds_read_b128 v[28:31], v20 offset:16384
  v_mfma_f32_16x16x32_bf16 v[72:75], v[52:55], v[100:103], v[72:75]
  ds_read_b128 v[32:35], v20 offset:17408
  v_mfma_f32_16x16x32_bf16 v[76:79], v[56:59], v[100:103], v[76:79]
  ds_read_b128 v[36:39], v20 offset:18432
  v_mfma_f32_16x16x32_bf16 v[80:83], v[60:63], v[100:103], v[80:83]
  ds_read_b128 v[40:43], v20 offset:19456
  v_mfma_f32_16x16x32_bf16 v[84:87], v[64:67], v[100:103], v[84:87]
  ds_read_b128 v[44:47], v20 offset:20480
  s_waitcnt vmcnt(10) lgkmcnt(0)
  v_mfma_f32_16x16x32_bf16 v[68:71], v[28:31], v[104:107], v[68:71]
  ds_read_b128 v[48:51], v20 offset:21504
  v_mfma_f32_16x16x32_bf16 v[72:75], v[32:35], v[104:107], v[72:75]
  ds_read_b128 v[52:55], v20 offset:22528
  v_mfma_f32_16x16x32_bf16 v[76:79], v[36:39], v[104:107], v[76:79]
  ds_read_b128 v[56:59], v20 offset:23552
  v_mfma_f32_16x16x32_bf16 v[80:83], v[40:43], v[104:107], v[80:83]
  ds_read_b128 v[60:63], v20 offset:24576
  v_mfma_f32_16x16x32_bf16 v[84:87], v[44:47], v[104:107], v[84:87]
  ds_read_b128 v[64:67], v20 offset:25600
  s_waitcnt vmcnt(9) lgkmcnt(0)
  v_mfma_f32_16x16x32_bf16 v[68:71], v[48:51], v[108:111], v[68:71]
  ds_read_b128 v[28:31], v20 offset:26624
  v_mfma_f32_16x16x32_bf16 v[72:75], v[52:55], v[108:111], v[72:75]
  ds_read_b128 v[32:35], v20 offset:27648
  v_mfma_f32_16x16x32_bf16 v[76:79], v[56:59], v[108:111], v[76:79]
  ds_read_b128 v[36:39], v20 offset:28672
  v_mfma_f32_16x16x32_bf16 v[80:83], v[60:63], v[108:111], v[80:83]
  ds_read_b128 v[40:43], v20 offset:29696
  v_mfma_f32_16x16x32_bf16 v[84:87], v[64:67], v[108:111], v[84:87]
  ds_read_b128 v[44:47], v20 offset:30720
  s_waitcnt vmcnt(8) lgkmcnt(0)
  v_mfma_f32_16x16x32_bf16 v[68:71], v[28:31], v[112:115], v[68:71]
  ds_read_b128 v[48:51], v20 offset:31744
  v_mfma_f32_16x16x32_bf16 v[72:75], v[32:35], v[112:115], v[72:75]
  ds_read_b128 v[52:55], v20 offset:32768
  v_mfma_f32_16x16x32_bf16 v[76:79], v[36:39], v[112:115], v[76:79]
  ds_read_b128 v[56:59], v20 offset:33792
  v_mfma_f32_16x16x32_bf16 v[80:83], v[40:43], v[112:115], v[80:83]
  ds_read_b128 v[60:63], v20 offset:34816
  v_mfma_f32_16x16x32_bf16 v[84:87], v[44:47], v[112:115], v[84:87]
  ds_read_b128 v[64:67], v20 offset:35840
  s_waitcnt vmcnt(7) lgkmcnt(0)
  s_barrier
  v_mfma_f32_16x16x32_bf16 v[68:71], v[48:51], v[116:119], v[68:71]
  ds_read_b128 v[28:31], v20 offset:36864
  v_mfma_f32_16x16x32_bf16 v[72:75], v[52:55], v[116:119], v[72:75]
  ds_read_b128 v[32:35], v20 offset:37888
  v_mfma_f32_16x16x32_bf16 v[76:79], v[56:59], v[116:119], v[76:79]
  ds_read_b128 v[36:39], v20 offset:38912
  v_mfma_f32_16x16x32_bf16 v[80:83], v[60:63], v[116:119], v[80:83]
  ds_read_b128 v[40:43], v20 offset:39936
  v_mfma_f32_16x16x32_bf16 v[84:87], v[64:67], v[116:119], v[84:87]
  ds_read_b128 v[44:47], v20 offset:40960
  s_waitcnt vmcnt(6) lgkmcnt(0)
  v_mfma_f32_16x16x32_bf16 v[68:71], v[28:31], v[120:123], v[68:71]
  ds_read_b128 v[48:51], v20 offset:41984
  v_mfma_f32_16x16x32_bf16 v[72:75], v[32:35], v[120:123], v[72:75]
  ds_read_b128 v[52:55], v20 offset:43008
  v_mfma_f32_16x16x32_bf16 v[76:79], v[36:39], v[120:123], v[76:79]
  ds_read_b128 v[56:59], v20 offset:44032
  v_mfma_f32_16x16x32_bf16 v[80:83], v[40:43], v[120:123], v[80:83]
  ds_read_b128 v[60:63], v20 offset:45056
  v_mfma_f32_16x16x32_bf16 v[84:87], v[44:47], v[120:123], v[84:87]
  ds_read_b128 v[64:67], v20 offset:46080
  s_waitcnt vmcnt(5) lgkmcnt(0)
  v_mfma_f32_16x16x32_bf16 v[68:71], v[48:51], v[124:127], v[68:71]
  ds_read_b128 v[28:31], v20 offset:47104
  v_mfma_f32_16x16x32_bf16 v[72:75], v[52:55], v[124:127], v[72:75]
  ds_read_b128 v[32:35], v20 offset:48128
  v_mfma_f32_16x16x32_bf16 v[76:79], v[56:59], v[124:127], v[76:79]
  ds_read_b128 v[36:39], v20 offset:49152
  v_mfma_f32_16x16x32_bf16 v[80:83], v[60:63], v[124:127], v[80:83]
  ds_read_b128 v[40:43], v20 offset:50176
  v_mfma_f32_16x16x32_bf16 v[84:87], v[64:67], v[124:127], v[84:87]
  ds_read_b128 v[44:47], v20 offset:51200
  s_waitcnt vmcnt(4) lgkmcnt(0)
  v_mfma_f32_16x16x32_bf16 v[68:71], v[28:31], v[128:131], v[68:71]
  ds_read_b128 v[48:51], v20 offset:52224
  v_mfma_f32_16x16x32_bf16 v[72:75], v[32:35], v[128:131], v[72:75]
  ds_read_b128 v[52:55], v20 offset:53248
  v_mfma_f32_16x16x32_bf16 v[76:79], v[36:39], v[128:131], v[76:79]
  ds_read_b128 v[56:59], v20 offset:54272
  v_mfma_f32_16x16x32_bf16 v[80:83], v[40:43], v[128:131], v[80:83]
  ds_read_b128 v[60:63], v20 offset:55296
  v_mfma_f32_16x16x32_bf16 v[84:87], v[44:47], v[128:131], v[84:87]
  ds_read_b128 v[64:67], v20 offset:56320
  s_waitcnt vmcnt(3) lgkmcnt(0)
  v_mfma_f32_16x16x32_bf16 v[68:71], v[48:51], v[132:135], v[68:71]
  v_mfma_f32_16x16x32_bf16 v[72:75], v[52:55], v[132:135], v[72:75]
  v_mfma_f32_16x16x32_bf16 v[76:79], v[56:59], v[132:135], v[76:79]
  v_mfma_f32_16x16x32_bf16 v[80:83], v[60:63], v[132:135], v[80:83]
  v_mfma_f32_16x16x32_bf16 v[84:87], v[64:67], v[132:135], v[84:87]
  s_waitcnt vmcnt(0)
  v_mul_u32_u24 v12, 160, v3
  v_lshlrev_b32 v13, 3, v2
  v_add_u32 v12, v12, v13
  s_add_u32 s40, s37, 122880
  v_add_u32 v12, s40, v12
  v_lshlrev_b32 v13, 7, v2
  v_lshlrev_b32 v14, 3, v3
  v_add_u32 v13, v13, v14
  s_add_u32 s40, s37, 133120
  v_add_u32 v13, s40, v13
  ds_read_b64 v[88:89], v12 offset:0
  ds_read_b64_tr_b16 v[98:99], v13 offset:0
  ds_read_b64 v[90:91], v12 offset:32
  ds_read_b64_tr_b16 v[100:101], v13 offset:512
  ds_read_b64 v[92:93], v12 offset:64
  ds_read_b64_tr_b16 v[102:103], v13 offset:1024
  ds_read_b64 v[94:95], v12 offset:96
  ds_read_b64_tr_b16 v[104:105], v13 offset:1536
  ds_read_b64 v[96:97], v12 offset:128
  ds_read_b64_tr_b16 v[106:107], v13 offset:2048
  v_sub_f32 v14, 0, v24
  v_mov_b32 v16, v25
  s_mov_b32 s48, 1.0
  s_mov_b32 s49, 1.0
  v_mov_b32 v18, 0xbfb8aa3b
  v_mov_b32 v19, 0xbfb8aa3b
  s_waitcnt lgkmcnt(0)
  v_lshlrev_b32 v108, 16, v88
  v_and_b32 v109, s47, v88
  v_lshlrev_b32 v110, 16, v98
  v_and_b32 v111, s47, v98
  v_pk_mul_f32 v[112:113], v[68:69], v[18:19]
  v_exp_f32 v112, v112
  v_exp_f32 v113, v113
  v_pk_add_f32 v[114:115], v[108:109], v[14:15] op_sel_hi:[1,0]
  v_pk_add_f32 v[112:113], v[112:113], s[48:49]
  v_pk_mul_f32 v[114:115], v[114:115], v[16:17] op_sel_hi:[1,0]
  v_rcp_f32 v112, v112
  v_rcp_f32 v113, v113
  v_pk_mul_f32 v[114:115], v[114:115], v[110:111]
  v_pk_mul_f32 v[112:113], v[112:113], v[68:69]
  v_pk_fma_f32 v[114:115], v[114:115], v[112:113], v[108:109]
  v_cvt_pk_bf16_f32 v88, v114, v115
  v_lshlrev_b32 v116, 16, v89
  v_and_b32 v117, s47, v89
  v_lshlrev_b32 v118, 16, v99
  v_and_b32 v119, s47, v99
  v_pk_mul_f32 v[120:121], v[70:71], v[18:19]
  v_exp_f32 v120, v120
  v_exp_f32 v121, v121
  v_pk_add_f32 v[122:123], v[116:117], v[14:15] op_sel_hi:[1,0]
  v_pk_add_f32 v[120:121], v[120:121], s[48:49]
  v_pk_mul_f32 v[122:123], v[122:123], v[16:17] op_sel_hi:[1,0]
  v_rcp_f32 v120, v120
  v_rcp_f32 v121, v121
  v_pk_mul_f32 v[122:123], v[122:123], v[118:119]
  v_pk_mul_f32 v[120:121], v[120:121], v[70:71]
  v_pk_fma_f32 v[122:123], v[122:123], v[120:121], v[116:117]
  v_cvt_pk_bf16_f32 v89, v122, v123
  ds_write_b64 v12, v[88:89] offset:0
  v_lshlrev_b32 v108, 16, v90
  v_and_b32 v109, s47, v90
  v_lshlrev_b32 v110, 16, v100
  v_and_b32 v111, s47, v100
  v_pk_mul_f32 v[112:113], v[72:73], v[18:19]
  v_exp_f32 v112, v112
  v_exp_f32 v113, v113
  v_pk_add_f32 v[114:115], v[108:109], v[14:15] op_sel_hi:[1,0]
  v_pk_add_f32 v[112:113], v[112:113], s[48:49]
  v_pk_mul_f32 v[114:115], v[114:115], v[16:17] op_sel_hi:[1,0]
  v_rcp_f32 v112, v112
  v_rcp_f32 v113, v113
  v_pk_mul_f32 v[114:115], v[114:115], v[110:111]
  v_pk_mul_f32 v[112:113], v[112:113], v[72:73]
  v_pk_fma_f32 v[114:115], v[114:115], v[112:113], v[108:109]
  v_cvt_pk_bf16_f32 v90, v114, v115
  v_lshlrev_b32 v116, 16, v91
  v_and_b32 v117, s47, v91
  v_lshlrev_b32 v118, 16, v101
  v_and_b32 v119, s47, v101
  v_pk_mul_f32 v[120:121], v[74:75], v[18:19]
  v_exp_f32 v120, v120
  v_exp_f32 v121, v121
  v_pk_add_f32 v[122:123], v[116:117], v[14:15] op_sel_hi:[1,0]
  v_pk_add_f32 v[120:121], v[120:121], s[48:49]
  v_pk_mul_f32 v[122:123], v[122:123], v[16:17] op_sel_hi:[1,0]
  v_rcp_f32 v120, v120
  v_rcp_f32 v121, v121
  v_pk_mul_f32 v[122:123], v[122:123], v[118:119]
  v_pk_mul_f32 v[120:121], v[120:121], v[74:75]
  v_pk_fma_f32 v[122:123], v[122:123], v[120:121], v[116:117]
  v_cvt_pk_bf16_f32 v91, v122, v123
  ds_write_b64 v12, v[90:91] offset:32
  v_lshlrev_b32 v108, 16, v92
  v_and_b32 v109, s47, v92
  v_lshlrev_b32 v110, 16, v102
  v_and_b32 v111, s47, v102
  v_pk_mul_f32 v[112:113], v[76:77], v[18:19]
  v_exp_f32 v112, v112
  v_exp_f32 v113, v113
  v_pk_add_f32 v[114:115], v[108:109], v[14:15] op_sel_hi:[1,0]
  v_pk_add_f32 v[112:113], v[112:113], s[48:49]
  v_pk_mul_f32 v[114:115], v[114:115], v[16:17] op_sel_hi:[1,0]
  v_rcp_f32 v112, v112
  v_rcp_f32 v113, v113
  v_pk_mul_f32 v[114:115], v[114:115], v[110:111]
  v_pk_mul_f32 v[112:113], v[112:113], v[76:77]
  v_pk_fma_f32 v[114:115], v[114:115], v[112:113], v[108:109]
  v_cvt_pk_bf16_f32 v92, v114, v115
  v_lshlrev_b32 v116, 16, v93
  v_and_b32 v117, s47, v93
  v_lshlrev_b32 v118, 16, v103
  v_and_b32 v119, s47, v103
  v_pk_mul_f32 v[120:121], v[78:79], v[18:19]
  v_exp_f32 v120, v120
  v_exp_f32 v121, v121
  v_pk_add_f32 v[122:123], v[116:117], v[14:15] op_sel_hi:[1,0]
  v_pk_add_f32 v[120:121], v[120:121], s[48:49]
  v_pk_mul_f32 v[122:123], v[122:123], v[16:17] op_sel_hi:[1,0]
  v_rcp_f32 v120, v120
  v_rcp_f32 v121, v121
  v_pk_mul_f32 v[122:123], v[122:123], v[118:119]
  v_pk_mul_f32 v[120:121], v[120:121], v[78:79]
  v_pk_fma_f32 v[122:123], v[122:123], v[120:121], v[116:117]
  v_cvt_pk_bf16_f32 v93, v122, v123
  ds_write_b64 v12, v[92:93] offset:64
  v_lshlrev_b32 v108, 16, v94
  v_and_b32 v109, s47, v94
  v_lshlrev_b32 v110, 16, v104
  v_and_b32 v111, s47, v104
  v_pk_mul_f32 v[112:113], v[80:81], v[18:19]
  v_exp_f32 v112, v112
  v_exp_f32 v113, v113
  v_pk_add_f32 v[114:115], v[108:109], v[14:15] op_sel_hi:[1,0]
  v_pk_add_f32 v[112:113], v[112:113], s[48:49]
  v_pk_mul_f32 v[114:115], v[114:115], v[16:17] op_sel_hi:[1,0]
  v_rcp_f32 v112, v112
  v_rcp_f32 v113, v113
  v_pk_mul_f32 v[114:115], v[114:115], v[110:111]
  v_pk_mul_f32 v[112:113], v[112:113], v[80:81]
  v_pk_fma_f32 v[114:115], v[114:115], v[112:113], v[108:109]
  v_cvt_pk_bf16_f32 v94, v114, v115
  v_lshlrev_b32 v116, 16, v95
  v_and_b32 v117, s47, v95
  v_lshlrev_b32 v118, 16, v105
  v_and_b32 v119, s47, v105
  v_pk_mul_f32 v[120:121], v[82:83], v[18:19]
  v_exp_f32 v120, v120
  v_exp_f32 v121, v121
  v_pk_add_f32 v[122:123], v[116:117], v[14:15] op_sel_hi:[1,0]
  v_pk_add_f32 v[120:121], v[120:121], s[48:49]
  v_pk_mul_f32 v[122:123], v[122:123], v[16:17] op_sel_hi:[1,0]
  v_rcp_f32 v120, v120
  v_rcp_f32 v121, v121
  v_pk_mul_f32 v[122:123], v[122:123], v[118:119]
  v_pk_mul_f32 v[120:121], v[120:121], v[82:83]
  v_pk_fma_f32 v[122:123], v[122:123], v[120:121], v[116:117]
  v_cvt_pk_bf16_f32 v95, v122, v123
  ds_write_b64 v12, v[94:95] offset:96
  v_lshlrev_b32 v108, 16, v96
  v_and_b32 v109, s47, v96
  v_lshlrev_b32 v110, 16, v106
  v_and_b32 v111, s47, v106
  v_pk_mul_f32 v[112:113], v[84:85], v[18:19]
  v_exp_f32 v112, v112
  v_exp_f32 v113, v113
  v_pk_add_f32 v[114:115], v[108:109], v[14:15] op_sel_hi:[1,0]
  v_pk_add_f32 v[112:113], v[112:113], s[48:49]
  v_pk_mul_f32 v[114:115], v[114:115], v[16:17] op_sel_hi:[1,0]
  v_rcp_f32 v112, v112
  v_rcp_f32 v113, v113
  v_pk_mul_f32 v[114:115], v[114:115], v[110:111]
  v_pk_mul_f32 v[112:113], v[112:113], v[84:85]
  v_pk_fma_f32 v[114:115], v[114:115], v[112:113], v[108:109]
  v_cvt_pk_bf16_f32 v96, v114, v115
  v_lshlrev_b32 v116, 16, v97
  v_and_b32 v117, s47, v97
  v_lshlrev_b32 v118, 16, v107
  v_and_b32 v119, s47, v107
  v_pk_mul_f32 v[120:121], v[86:87], v[18:19]
  v_exp_f32 v120, v120
  v_exp_f32 v121, v121
  v_pk_add_f32 v[122:123], v[116:117], v[14:15] op_sel_hi:[1,0]
  v_pk_add_f32 v[120:121], v[120:121], s[48:49]
  v_pk_mul_f32 v[122:123], v[122:123], v[16:17] op_sel_hi:[1,0]
  v_rcp_f32 v120, v120
  v_rcp_f32 v121, v121
  v_pk_mul_f32 v[122:123], v[122:123], v[118:119]
  v_pk_mul_f32 v[120:121], v[120:121], v[86:87]
  v_pk_fma_f32 v[122:123], v[122:123], v[120:121], v[116:117]
  v_cvt_pk_bf16_f32 v97, v122, v123
  ds_write_b64 v12, v[96:97] offset:128
  s_waitcnt lgkmcnt(0)
  s_add_u32 s40, s37, 122880
  v_add_u32 v13, s40, v4
  ds_read_b128 v[124:127], v13 offset:0
  ds_read_b128 v[128:131], v13 offset:1024
  ds_read_b128 v[132:135], v13 offset:2048
  s_waitcnt lgkmcnt(0)
  buffer_store_dwordx4 v[124:127], v5, s[12:15], 0 offen
  buffer_store_dwordx4 v[128:131], v6, s[12:15], 0 offen
  s_mov_b32 exec_lo, 0xffffffff
  s_mov_b32 exec_hi, 0x0
  buffer_store_dwordx4 v[132:135], v7, s[12:15], 0 offen
  s_mov_b64 exec, s[52:53]
  s_endpgm
K1_B:
  s_cmp_eq_u32 s34, 4
  s_cbranch_scc0 K1_NORST
  s_lshl_b32 s40, s32, 3
  s_add_u32 s40, s40, s33
  s_lshl_b32 s40, s40, 9
  s_add_u32 s40, s40, 16842752
  v_lshlrev_b32 v15, 3, v1
  v_mov_b32 v20, 0
  v_mov_b32 v21, 0xbf800000
  buffer_store_dwordx2 v[20:21], v15, s[16:19], s40 offen sc1
  s_lshl_b32 s40, s33, 7
  s_lshl_b32 s41, s32, 2
  s_add_u32 s40, s40, s41
  s_add_u32 s41, s40, 17040384
  s_add_u32 s40, s40, 17039360
  v_mov_b32 v15, s40
  v_mov_b32 v16, s41
  v_cmp_eq_u32 vcc, 1, v1
  s_nop 1
  v_cndmask_b32 v15, v15, v16, vcc
  s_lshl_b32 s40, s32, 5
  s_lshl_b32 s41, s33, 2
  s_add_u32 s40, s40, s41
  s_add_u32 s40, s40, 17041408
  v_mov_b32 v16, s40
  v_cmp_eq_u32 vcc, 2, v1
  s_nop 1
  v_cndmask_b32 v15, v15, v16, vcc
  s_lshl_b32 s40, s33, 7
  s_lshl_b32 s41, s32, 2
  s_add_u32 s40, s40, s41
  s_add_u32 s40, s40, 17042432
  v_mov_b32 v16, s40
  v_cmp_eq_u32 vcc, 3, v1
  s_nop 1
  v_cndmask_b32 v15, v15, v16, vcc
  s_mov_b32 exec_lo, 0xf
  s_mov_b32 exec_hi, 0x0
  buffer_store_dword v20, v15, s[16:19], 0 offen sc1
  s_mov_b64 exec, s[52:53]
K1_NORST:
  s_lshl_b32 s40, s2, 2
  s_add_u32 s40, s40, s55
  s_mul_i32 s41, s40, 2731
  s_lshr_b32 s41, s41, 16
  s_mul_i32 s42, s41, 24
  s_sub_u32 s42, s40, s42
  s_mov_b32 s72, s40
  v_mul_u32_u24 v17, 5120, v2
  v_lshlrev_b32 v18, 1, v3
  v_add_u32 v17, v17, v18
  s_lshl_b32 s41, s41, 5
  s_mul_i32 s42, s42, 40960
  s_add_u32 s41, s41, s42
  s_add_u32 s42, s41, 20480
  s_barrier
  s_mov_b32 s28, s66
  s_and_b32 s29, s67, 0xffff
  s_mov_b32 s30, 983040
  s_mov_b32 s31, 0x20000
  buffer_load_ushort v152, v17, s[28:31], s41 offen offset:0
  buffer_load_ushort v153, v17, s[28:31], s41 offen offset:1280
  buffer_load_ushort v154, v17, s[28:31], s41 offen offset:2560
  buffer_load_ushort v155, v17, s[28:31], s41 offen offset:3840
  buffer_load_ushort v156, v17, s[28:31], s42 offen offset:0
  buffer_load_ushort v157, v17, s[28:31], s42 offen offset:1280
  buffer_load_ushort v158, v17, s[28:31], s42 offen offset:2560
  buffer_load_ushort v159, v17, s[28:31], s42 offen offset:3840
  s_barrier
  s_barrier
  s_cmp_eq_u32 s34, 4
  s_cbranch_scc0 K1_NOCNT
  s_waitcnt vmcnt(8)
  s_lshl_b32 s39, s32, 2
  v_mov_b32 v20, s39
  v_mov_b32 v21, 1
  s_mov_b32 exec_lo, 0x1
  s_mov_b32 exec_hi, 0x0
  buffer_atomic_add v21, v20, s[4:7], 0 offen offset:0 sc1
  s_mov_b64 exec, s[52:53]
K1_NOCNT:
  s_barrier
  s_barrier
  s_barrier
  s_barrier
  s_barrier
  s_barrier
  v_lshlrev_b32 v144, 6, v1
  s_and_b32 s54, s2, 7
  s_lshl_b32 s54, s54, 8
  s_lshr_b32 s39, s2, 3
  s_lshl_b32 s39, s39, 3
  s_add_u32 s54, s54, s39
  s_lshl_b32 s54, s54, 12
  s_mov_b32 s20, s74
  s_and_b32 s21, s75, 0xffff
  s_mov_b32 s22, 8388608
  s_mov_b32 s23, 0x20000
  s_mov_b32 s46, 0
  s_cmp_ge_u32 s72, 960
  s_cbranch_scc1 K1_NOWOF
  s_waitcnt vmcnt(0)
  v_lshl_or_b32 v164, v153, 16, v152
  v_lshl_or_b32 v165, v155, 16, v154
  v_lshl_or_b32 v166, v157, 16, v156
  v_lshl_or_b32 v167, v159, 16, v158
  v_lshlrev_b32 v17, 4, v1
  s_lshl_b32 s40, s72, 10
  s_add_u32 s40, s40, 15728640
  buffer_store_dwordx4 v[164:167], v17, s[16:19], s40 offen sc1
K1_NOWOF:
  s_barrier
  v_mov_b32 v102, 0x3f803f80
  v_mov_b32 v103, 0x3f803f80
  v_mov_b32 v104, 0x3f803f80
  v_mov_b32 v105, 0x3f803f80
  v_mov_b32 v66, 0
  v_mov_b32 v67, 0
  v_mov_b32 v68, 0
  v_mov_b32 v69, 0
  v_mov_b32 v70, 0
  v_mov_b32 v71, 0
  v_mov_b32 v72, 0
  v_mov_b32 v73, 0
  v_mov_b32 v74, 0
  v_mov_b32 v75, 0
  v_mov_b32 v76, 0
  v_mov_b32 v77, 0
  v_mov_b32 v78, 0
  v_mov_b32 v79, 0
  v_mov_b32 v80, 0
  v_mov_b32 v81, 0
  v_mov_b32 v82, 0
  v_mov_b32 v83, 0
  v_mov_b32 v84, 0
  v_mov_b32 v85, 0
  v_mov_b32 v86, 0
  v_mov_b32 v87, 0
  v_mov_b32 v88, 0
  v_mov_b32 v89, 0
  v_mov_b32 v90, 0
  v_mov_b32 v91, 0
  v_mov_b32 v92, 0
  v_mov_b32 v93, 0
  v_mov_b32 v94, 0
  v_mov_b32 v95, 0
  v_mov_b32 v96, 0
  v_mov_b32 v97, 0
  v_mov_b32 v98, 0
  v_mov_b32 v99, 0
  v_mov_b32 v100, 0
  v_mov_b32 v101, 0
  v_mov_b32 v106, 0
  v_mov_b32 v107, 0
  v_mov_b32 v108, 0
  v_mov_b32 v109, 0
  v_mov_b32 v110, 0
  v_mov_b32 v111, 0
  v_mov_b32 v112, 0
  v_mov_b32 v113, 0
  s_barrier
  s_mov_b32 s37, 0
  ds_read_b128 v[26:29], v4 offset:0
  ds_read_b64_tr_b16 v[42:43], v8 offset:0
  ds_read_b64_tr_b16 v[44:45], v8 offset:768
  ds_read_b128 v[30:33], v6 offset:0
  ds_read_b64_tr_b16 v[46:47], v9 offset:0
  ds_read_b64_tr_b16 v[48:49], v9 offset:768
  ds_read_b64_tr_b16 v[50:51], v10 offset:0
  ds_read_b64_tr_b16 v[52:53], v10 offset:768
K1_LOOP2:
  s_waitcnt lgkmcnt(0)
  v_mfma_f32_16x16x32_bf16 v[66:69], v[42:45], v[26:29], v[66:69]
  ds_read_b128 v[34:37], v5 offset:0
  ds_read_b64_tr_b16 v[54:55], v8 offset:6144
  v_mfma_f32_16x16x32_bf16 v[78:81], v[42:45], v[30:33], v[78:81]
  ds_read_b64_tr_b16 v[56:57], v8 offset:6912
  ds_read_b128 v[38:41], v7 offset:0
  v_mfma_f32_16x16x32_bf16 v[70:73], v[46:49], v[26:29], v[70:73]
  ds_read_b64_tr_b16 v[58:59], v9 offset:6144
  ds_read_b64_tr_b16 v[60:61], v9 offset:6912
  v_mfma_f32_16x16x32_bf16 v[82:85], v[46:49], v[30:33], v[82:85]
  ds_read_b64_tr_b16 v[62:63], v10 offset:6144
  ds_read_b64_tr_b16 v[64:65], v10 offset:6912
  v_mfma_f32_16x16x32_bf16 v[74:77], v[50:53], v[26:29], v[74:77]
  v_mfma_f32_16x16x32_bf16 v[86:89], v[50:53], v[30:33], v[86:89]
  s_cmp_eq_u32 s35, 0
  s_cbranch_scc0 K1_SK_2a0
  v_mfma_f32_16x16x32_bf16 v[90:93], v[42:45], v[102:105], v[90:93]
  v_mfma_f32_16x16x32_bf16 v[94:97], v[46:49], v[102:105], v[94:97]
  v_mfma_f32_16x16x32_bf16 v[98:101], v[50:53], v[102:105], v[98:101]
K1_SK_2a0:
  s_waitcnt lgkmcnt(0)
  s_barrier
  v_mfma_f32_16x16x32_bf16 v[66:69], v[54:57], v[34:37], v[66:69]
  ds_read_b128 v[26:29], v4 offset:8192
  ds_read_b64_tr_b16 v[42:43], v8 offset:12288
  v_mfma_f32_16x16x32_bf16 v[78:81], v[54:57], v[38:41], v[78:81]
  ds_read_b64_tr_b16 v[44:45], v8 offset:13056
  ds_read_b128 v[30:33], v6 offset:8192
  v_mfma_f32_16x16x32_bf16 v[70:73], v[58:61], v[34:37], v[70:73]
  ds_read_b64_tr_b16 v[46:47], v9 offset:12288
  ds_read_b64_tr_b16 v[48:49], v9 offset:13056
  v_mfma_f32_16x16x32_bf16 v[82:85], v[58:61], v[38:41], v[82:85]
  ds_read_b64_tr_b16 v[50:51], v10 offset:12288
  ds_read_b64_tr_b16 v[52:53], v10 offset:13056
  v_mfma_f32_16x16x32_bf16 v[74:77], v[62:65], v[34:37], v[74:77]
  v_mfma_f32_16x16x32_bf16 v[86:89], v[62:65], v[38:41], v[86:89]
  s_cmp_eq_u32 s35, 1
  s_cbranch_scc0 K1_SK_2b0
  v_mfma_f32_16x16x32_bf16 v[90:93], v[54:57], v[102:105], v[90:93]
  v_mfma_f32_16x16x32_bf16 v[94:97], v[58:61], v[102:105], v[94:97]
  v_mfma_f32_16x16x32_bf16 v[98:101], v[62:65], v[102:105], v[98:101]
K1_SK_2b0:
  s_waitcnt lgkmcnt(0)
  v_mfma_f32_16x16x32_bf16 v[66:69], v[42:45], v[26:29], v[66:69]
  ds_read_b128 v[34:37], v5 offset:8192
  ds_read_b64_tr_b16 v[54:55], v8 offset:18432
  v_mfma_f32_16x16x32_bf16 v[78:81], v[42:45], v[30:33], v[78:81]
  ds_read_b64_tr_b16 v[56:57], v8 offset:19200
  ds_read_b128 v[38:41], v7 offset:8192
  v_mfma_f32_16x16x32_bf16 v[70:73], v[46:49], v[26:29], v[70:73]
  ds_read_b64_tr_b16 v[58:59], v9 offset:18432
  ds_read_b64_tr_b16 v[60:61], v9 offset:19200
  v_mfma_f32_16x16x32_bf16 v[82:85], v[46:49], v[30:33], v[82:85]
  ds_read_b64_tr_b16 v[62:63], v10 offset:18432
  ds_read_b64_tr_b16 v[64:65], v10 offset:19200
  v_mfma_f32_16x16x32_bf16 v[74:77], v[50:53], v[26:29], v[74:77]
  v_mfma_f32_16x16x32_bf16 v[86:89], v[50:53], v[30:33], v[86:89]
  s_cmp_eq_u32 s35, 0
  s_cbranch_scc0 K1_SK_2a1
  v_mfma_f32_16x16x32_bf16 v[90:93], v[42:45], v[102:105], v[90:93]
  v_mfma_f32_16x16x32_bf16 v[94:97], v[46:49], v[102:105], v[94:97]
  v_mfma_f32_16x16x32_bf16 v[98:101], v[50:53], v[102:105], v[98:101]
K1_SK_2a1:
  s_waitcnt lgkmcnt(0)
  s_barrier
  v_mfma_f32_16x16x32_bf16 v[66:69], v[54:57], v[34:37], v[66:69]
  ds_read_b128 v[26:29], v4 offset:16384
  ds_read_b64_tr_b16 v[42:43], v8 offset:24576
  v_mfma_f32_16x16x32_bf16 v[78:81], v[54:57], v[38:41], v[78:81]
  ds_read_b64_tr_b16 v[44:45], v8 offset:25344
  ds_read_b128 v[30:33], v6 offset:16384
  v_mfma_f32_16x16x32_bf16 v[70:73], v[58:61], v[34:37], v[70:73]
  ds_read_b64_tr_b16 v[46:47], v9 offset:24576
  ds_read_b64_tr_b16 v[48:49], v9 offset:25344
  v_mfma_f32_16x16x32_bf16 v[82:85], v[58:61], v[38:41], v[82:85]
  ds_read_b64_tr_b16 v[50:51], v10 offset:24576
  ds_read_b64_tr_b16 v[52:53], v10 offset:25344
  v_mfma_f32_16x16x32_bf16 v[74:77], v[62:65], v[34:37], v[74:77]
  v_mfma_f32_16x16x32_bf16 v[86:89], v[62:65], v[38:41], v[86:89]
  s_cmp_eq_u32 s35, 1
  s_cbranch_scc0 K1_SK_2b1
  v_mfma_f32_16x16x32_bf16 v[90:93], v[54:57], v[102:105], v[90:93]
  v_mfma_f32_16x16x32_bf16 v[94:97], v[58:61], v[102:105], v[94:97]
  v_mfma_f32_16x16x32_bf16 v[98:101], v[62:65], v[102:105], v[98:101]
K1_SK_2b1:
  s_waitcnt lgkmcnt(0)
  v_mfma_f32_16x16x32_bf16 v[66:69], v[42:45], v[26:29], v[66:69]
  ds_read_b128 v[34:37], v5 offset:16384
  ds_read_b64_tr_b16 v[54:55], v8 offset:30720
  v_mfma_f32_16x16x32_bf16 v[78:81], v[42:45], v[30:33], v[78:81]
  ds_read_b64_tr_b16 v[56:57], v8 offset:31488
  ds_read_b128 v[38:41], v7 offset:16384
  v_mfma_f32_16x16x32_bf16 v[70:73], v[46:49], v[26:29], v[70:73]
  ds_read_b64_tr_b16 v[58:59], v9 offset:30720
  ds_read_b64_tr_b16 v[60:61], v9 offset:31488
  v_mfma_f32_16x16x32_bf16 v[82:85], v[46:49], v[30:33], v[82:85]
  ds_read_b64_tr_b16 v[62:63], v10 offset:30720
  ds_read_b64_tr_b16 v[64:65], v10 offset:31488
  v_mfma_f32_16x16x32_bf16 v[74:77], v[50:53], v[26:29], v[74:77]
  v_mfma_f32_16x16x32_bf16 v[86:89], v[50:53], v[30:33], v[86:89]
  s_cmp_eq_u32 s35, 0
  s_cbranch_scc0 K1_SK_2a2
  v_mfma_f32_16x16x32_bf16 v[90:93], v[42:45], v[102:105], v[90:93]
  v_mfma_f32_16x16x32_bf16 v[94:97], v[46:49], v[102:105], v[94:97]
  v_mfma_f32_16x16x32_bf16 v[98:101], v[50:53], v[102:105], v[98:101]
K1_SK_2a2:
  s_waitcnt lgkmcnt(0)
  s_barrier
  v_mfma_f32_16x16x32_bf16 v[66:69], v[54:57], v[34:37], v[66:69]
  ds_read_b128 v[26:29], v4 offset:24576
  ds_read_b64_tr_b16 v[42:43], v8 offset:36864
  v_mfma_f32_16x16x32_bf16 v[78:81], v[54:57], v[38:41], v[78:81]
  ds_read_b64_tr_b16 v[44:45], v8 offset:37632
  ds_read_b128 v[30:33], v6 offset:24576
  v_mfma_f32_16x16x32_bf16 v[70:73], v[58:61], v[34:37], v[70:73]
  ds_read_b64_tr_b16 v[46:47], v9 offset:36864
  ds_read_b64_tr_b16 v[48:49], v9 offset:37632
  v_mfma_f32_16x16x32_bf16 v[82:85], v[58:61], v[38:41], v[82:85]
  ds_read_b64_tr_b16 v[50:51], v10 offset:36864
  ds_read_b64_tr_b16 v[52:53], v10 offset:37632
  v_mfma_f32_16x16x32_bf16 v[74:77], v[62:65], v[34:37], v[74:77]
  v_mfma_f32_16x16x32_bf16 v[86:89], v[62:65], v[38:41], v[86:89]
  s_cmp_eq_u32 s35, 1
  s_cbranch_scc0 K1_SK_2b2
  v_mfma_f32_16x16x32_bf16 v[90:93], v[54:57], v[102:105], v[90:93]
  v_mfma_f32_16x16x32_bf16 v[94:97], v[58:61], v[102:105], v[94:97]
  v_mfma_f32_16x16x32_bf16 v[98:101], v[62:65], v[102:105], v[98:101]
K1_SK_2b2:
  s_waitcnt lgkmcnt(0)
  v_mfma_f32_16x16x32_bf16 v[66:69], v[42:45], v[26:29], v[66:69]
  ds_read_b128 v[34:37], v5 offset:24576
  ds_read_b64_tr_b16 v[54:55], v8 offset:43008
  v_mfma_f32_16x16x32_bf16 v[78:81], v[42:45], v[30:33], v[78:81]
  ds_read_b64_tr_b16 v[56:57], v8 offset:43776
  ds_read_b128 v[38:41], v7 offset:24576
  v_mfma_f32_16x16x32_bf16 v[70:73], v[46:49], v[26:29], v[70:73]
  ds_read_b64_tr_b16 v[58:59], v9 offset:43008
  ds_read_b64_tr_b16 v[60:61], v9 offset:43776
  v_mfma_f32_16x16x32_bf16 v[82:85], v[46:49], v[30:33], v[82:85]
  ds_read_b64_tr_b16 v[62:63], v10 offset:43008
  ds_read_b64_tr_b16 v[64:65], v10 offset:43776
  v_mfma_f32_16x16x32_bf16 v[74:77], v[50:53], v[26:29], v[74:77]
  v_mfma_f32_16x16x32_bf16 v[86:89], v[50:53], v[30:33], v[86:89]
  s_cmp_eq_u32 s35, 0
  s_cbranch_scc0 K1_SK_2a3
  v_mfma_f32_16x16x32_bf16 v[90:93], v[42:45], v[102:105], v[90:93]
  v_mfma_f32_16x16x32_bf16 v[94:97], v[46:49], v[102:105], v[94:97]
  v_mfma_f32_16x16x32_bf16 v[98:101], v[50:53], v[102:105], v[98:101]
K1_SK_2a3:
  s_waitcnt lgkmcnt(0)
  s_barrier
  v_mfma_f32_16x16x32_bf16 v[66:69], v[54:57], v[34:37], v[66:69]
  ds_read_b128 v[26:29], v4 offset:32768
  ds_read_b64_tr_b16 v[42:43], v8 offset:49152
  v_mfma_f32_16x16x32_bf16 v[78:81], v[54:57], v[38:41], v[78:81]
  ds_read_b64_tr_b16 v[44:45], v8 offset:49920
  ds_read_b128 v[30:33], v6 offset:32768
  v_mfma_f32_16x16x32_bf16 v[70:73], v[58:61], v[34:37], v[70:73]
  ds_read_b64_tr_b16 v[46:47], v9 offset:49152
  ds_read_b64_tr_b16 v[48:49], v9 offset:49920
  v_mfma_f32_16x16x32_bf16 v[82:85], v[58:61], v[38:41], v[82:85]
  ds_read_b64_tr_b16 v[50:51], v10 offset:49152
  ds_read_b64_tr_b16 v[52:53], v10 offset:49920
  v_mfma_f32_16x16x32_bf16 v[74:77], v[62:65], v[34:37], v[74:77]
  v_mfma_f32_16x16x32_bf16 v[86:89], v[62:65], v[38:41], v[86:89]
  s_cmp_eq_u32 s35, 1
  s_cbranch_scc0 K1_SK_2b3
  v_mfma_f32_16x16x32_bf16 v[90:93], v[54:57], v[102:105], v[90:93]
  v_mfma_f32_16x16x32_bf16 v[94:97], v[58:61], v[102:105], v[94:97]
  v_mfma_f32_16x16x32_bf16 v[98:101], v[62:65], v[102:105], v[98:101]
K1_SK_2b3:
  s_waitcnt lgkmcnt(0)
  v_mfma_f32_16x16x32_bf16 v[66:69], v[42:45], v[26:29], v[66:69]
  ds_read_b128 v[34:37], v5 offset:32768
  ds_read_b64_tr_b16 v[54:55], v8 offset:55296
  v_mfma_f32_16x16x32_bf16 v[78:81], v[42:45], v[30:33], v[78:81]
  ds_read_b64_tr_b16 v[56:57], v8 offset:56064
  ds_read_b128 v[38:41], v7 offset:32768
  v_mfma_f32_16x16x32_bf16 v[70:73], v[46:49], v[26:29], v[70:73]
  ds_read_b64_tr_b16 v[58:59], v9 offset:55296
  ds_read_b64_tr_b16 v[60:61], v9 offset:56064
  v_mfma_f32_16x16x32_bf16 v[82:85], v[46:49], v[30:33], v[82:85]
  ds_read_b64_tr_b16 v[62:63], v10 offset:55296
  ds_read_b64_tr_b16 v[64:65], v10 offset:56064
  v_mfma_f32_16x16x32_bf16 v[74:77], v[50:53], v[26:29], v[74:77]
  v_mfma_f32_16x16x32_bf16 v[86:89], v[50:53], v[30:33], v[86:89]
  s_cmp_eq_u32 s35, 0
  s_cbranch_scc0 K1_SK_2a4
  v_mfma_f32_16x16x32_bf16 v[90:93], v[42:45], v[102:105], v[90:93]
  v_mfma_f32_16x16x32_bf16 v[94:97], v[46:49], v[102:105], v[94:97]
  v_mfma_f32_16x16x32_bf16 v[98:101], v[50:53], v[102:105], v[98:101]
K1_SK_2a4:
  s_waitcnt lgkmcnt(0)
  s_barrier
  v_add_u32 v4, 40960, v4
  v_add_u32 v5, 40960, v5
  v_add_u32 v6, 40960, v6
  v_add_u32 v7, 40960, v7
  v_mfma_f32_16x16x32_bf16 v[66:69], v[54:57], v[34:37], v[66:69]
  ds_read_b128 v[26:29], v4 offset:0
  ds_read_b64_tr_b16 v[42:43], v8 offset:0
  v_mfma_f32_16x16x32_bf16 v[78:81], v[54:57], v[38:41], v[78:81]
  ds_read_b64_tr_b16 v[44:45], v8 offset:768
  ds_read_b128 v[30:33], v6 offset:0
  v_mfma_f32_16x16x32_bf16 v[70:73], v[58:61], v[34:37], v[70:73]
  ds_read_b64_tr_b16 v[46:47], v9 offset:0
  ds_read_b64_tr_b16 v[48:49], v9 offset:768
  v_mfma_f32_16x16x32_bf16 v[82:85], v[58:61], v[38:41], v[82:85]
  ds_read_b64_tr_b16 v[50:51], v10 offset:0
  ds_read_b64_tr_b16 v[52:53], v10 offset:768
  v_mfma_f32_16x16x32_bf16 v[74:77], v[62:65], v[34:37], v[74:77]
  v_mfma_f32_16x16x32_bf16 v[86:89], v[62:65], v[38:41], v[86:89]
  s_cmp_eq_u32 s35, 1
  s_cbranch_scc0 K1_SK_2b4
  v_mfma_f32_16x16x32_bf16 v[90:93], v[54:57], v[102:105], v[90:93]
  v_mfma_f32_16x16x32_bf16 v[94:97], v[58:61], v[102:105], v[94:97]
  v_mfma_f32_16x16x32_bf16 v[98:101], v[62:65], v[102:105], v[98:101]
K1_SK_2b4:
  s_add_u32 s37, s37, 1
  s_cmp_lt_u32 s37, 2
  s_cbranch_scc1 K1_LOOP2
  s_mul_i32 s40, s55, 192
  s_add_u32 s40, s40, 144640
  v_lshlrev_b32 v18, 4, v2
  v_add_u32 v19, s40, v18
  s_mov_b32 exec_lo, 0x10001
  s_mov_b32 exec_hi, 0x10001
  ds_write_b128 v19, v[90:93] offset:0
  ds_write_b128 v19, v[94:97] offset:64
  ds_write_b128 v19, v[98:101] offset:128
  s_mov_b64 exec, s[52:53]
  v_mov_b32 v126, 0xc0135761
  v_mov_b32 v127, 0xc0135761
  s_waitcnt lgkmcnt(0)
  s_barrier
  s_load_dwordx4 s[64:67], s[0:1], 32
  s_sub_u32 s42, s34, 4
  s_mul_i32 s44, s33, 80
  s_mul_i32 s40, s32, 3
  s_lshl_b32 s41, s32, 1
  s_add_u32 s41, s41, 16
  s_cmp_lt_u32 s32, 16
  s_cselect_b32 s40, s40, s41
  s_cselect_b32 s41, 3, 2
  s_add_u32 s44, s44, s40
  s_add_u32 s44, s44, s42
  s_cmp_lt_u32 s42, s41
  s_cselect_b32 s45, 1, 0
  s_cmp_eq_u32 s34, 7
  s_cbranch_scc0 F2_NOCE
  v_lshlrev_b32 v166, 2, v1
  buffer_load_dword v167, v166, s[4:7], 0 offen offset:0 sc1
F2_NOCE:
  s_xor_b32 s41, s55, 2
  s_mul_i32 s41, s41, 192
  s_add_u32 s41, s41, 144640
  v_add_u32 v19, s41, v18
  ds_read_b128 v[26:29], v19 offset:0
  ds_read_b128 v[30:33], v19 offset:64
  ds_read_b128 v[34:37], v19 offset:128
  s_lshl_b32 s40, s35, 7
  s_lshl_b32 s41, s36, 6
  s_add_u32 s40, s40, s41
  s_add_u32 s40, s40, 143360
  v_lshlrev_b32 v20, 2, v3
  v_add_u32 v20, s40, v20
  v_xor_b32 v21, 64, v20
  ds_read_b32 v42, v20
  ds_read_b32 v44, v21
  ds_read_b32 v46, v20 offset:256
  ds_read_b32 v48, v21 offset:256
  s_lshl_b32 s40, s32, 2
  s_lshl_b32 s41, s35, 1
  s_add_u32 s40, s40, s41
  s_add_u32 s41, s40, s36
  s_xor_b32 s42, s41, 1
  s_mul_i32 s39, s33, 6
  s_mul_i32 s38, s36, 3
  s_add_u32 s39, s39, s38
  s_mul_i32 s41, s41, 48
  s_add_u32 s41, s41, s39
  s_lshl_b32 s41, s41, 9
  s_add_u32 s41, s41, 0
  s_mul_i32 s42, s42, 48
  s_add_u32 s42, s42, s39
  s_lshl_b32 s42, s42, 9
  s_add_u32 s42, s42, 0
  v_lshlrev_b32 v20, 3, v1
  s_lshl_b32 s38, s35, 1
  s_add_u32 s38, s38, s36
  s_mul_i32 s39, s38, 3072
  s_mul_i32 s40, s36, 1536
  s_add_u32 s39, s39, s40
  s_add_u32 s39, s39, 147456
  v_add_u32 v22, s39, v20
  s_xor_b32 s38, s38, 1
  s_mul_i32 s39, s38, 3072
  s_add_u32 s39, s39, s40
  s_add_u32 s39, s39, 147456
  v_add_u32 v23, s39, v20
  s_waitcnt lgkmcnt(0)
  v_add_f32 v26, v26, v90
  v_sub_f32 v26, 0, v26
  v_add_f32 v27, v27, v91
  v_sub_f32 v27, 0, v27
  v_add_f32 v28, v28, v92
  v_sub_f32 v28, 0, v28
  v_add_f32 v29, v29, v93
  v_sub_f32 v29, 0, v29
  v_add_f32 v30, v30, v94
  v_sub_f32 v30, 0, v30
  v_add_f32 v31, v31, v95
  v_sub_f32 v31, 0, v31
  v_add_f32 v32, v32, v96
  v_sub_f32 v32, 0, v32
  v_add_f32 v33, v33, v97
  v_sub_f32 v33, 0, v33
  v_add_f32 v34, v34, v98
  v_sub_f32 v34, 0, v34
  v_add_f32 v35, v35, v99
  v_sub_f32 v35, 0, v35
  v_add_f32 v36, v36, v100
  v_sub_f32 v36, 0, v36
  v_add_f32 v37, v37, v101
  v_sub_f32 v37, 0, v37
  v_pk_fma_f32 v[66:67], v[26:27], v[42:43], v[66:67] op_sel_hi:[1,0,1]
  v_pk_mul_f32 v[66:67], v[66:67], v[46:47] op_sel_hi:[1,0]
  v_pk_mul_f32 v[128:129], v[66:67], v[66:67]
  v_pk_fma_f32 v[128:129], v[128:129], s[48:49], v[126:127]
  v_pk_mul_f32 v[128:129], v[128:129], v[66:67]
  v_exp_f32 v128, v128
  v_exp_f32 v129, v129
  s_nop 0
  v_pk_add_f32 v[128:129], v[128:129], s[50:51]
  v_rcp_f32 v128, v128
  v_rcp_f32 v129, v129
  s_nop 0
  v_pk_mul_f32 v[128:129], v[128:129], v[66:67]
  v_cvt_pk_bf16_f32 v114, v128, v129
  v_pk_fma_f32 v[68:69], v[28:29], v[42:43], v[68:69] op_sel_hi:[1,0,1]
  v_pk_mul_f32 v[68:69], v[68:69], v[46:47] op_sel_hi:[1,0]
  v_pk_mul_f32 v[132:133], v[68:69], v[68:69]
  v_pk_fma_f32 v[132:133], v[132:133], s[48:49], v[126:127]
  v_pk_mul_f32 v[132:133], v[132:133], v[68:69]
  v_exp_f32 v132, v132
  v_exp_f32 v133, v133
  s_nop 0
  v_pk_add_f32 v[132:133], v[132:133], s[50:51]
  v_rcp_f32 v132, v132
  v_rcp_f32 v133, v133
  s_nop 0
  v_pk_mul_f32 v[132:133], v[132:133], v[68:69]
  v_cvt_pk_bf16_f32 v115, v132, v133
  ds_write_b64 v22, v[114:115] offset:0
  v_pk_fma_f32 v[70:71], v[30:31], v[42:43], v[70:71] op_sel_hi:[1,0,1]
  v_pk_mul_f32 v[70:71], v[70:71], v[46:47] op_sel_hi:[1,0]
  v_pk_mul_f32 v[128:129], v[70:71], v[70:71]
  v_pk_fma_f32 v[128:129], v[128:129], s[48:49], v[126:127]
  v_pk_mul_f32 v[128:129], v[128:129], v[70:71]
  v_exp_f32 v128, v128
  v_exp_f32 v129, v129
  s_nop 0
  v_pk_add_f32 v[128:129], v[128:129], s[50:51]
  v_rcp_f32 v128, v128
  v_rcp_f32 v129, v129
  s_nop 0
  v_pk_mul_f32 v[128:129], v[128:129], v[70:71]
  v_cvt_pk_bf16_f32 v116, v128, v129
  v_pk_fma_f32 v[72:73], v[32:33], v[42:43], v[72:73] op_sel_hi:[1,0,1]
  v_pk_mul_f32 v[72:73], v[72:73], v[46:47] op_sel_hi:[1,0]
  v_pk_mul_f32 v[132:133], v[72:73], v[72:73]
  v_pk_fma_f32 v[132:133], v[132:133], s[48:49], v[126:127]
  v_pk_mul_f32 v[132:133], v[132:133], v[72:73]
  v_exp_f32 v132, v132
  v_exp_f32 v133, v133
  s_nop 0
  v_pk_add_f32 v[132:133], v[132:133], s[50:51]
  v_rcp_f32 v132, v132
  v_rcp_f32 v133, v133
  s_nop 0
  v_pk_mul_f32 v[132:133], v[132:133], v[72:73]
  v_cvt_pk_bf16_f32 v117, v132, v133
  ds_write_b64 v22, v[116:117] offset:512
  v_pk_fma_f32 v[74:75], v[34:35], v[42:43], v[74:75] op_sel_hi:[1,0,1]
  v_pk_mul_f32 v[74:75], v[74:75], v[46:47] op_sel_hi:[1,0]
  v_pk_mul_f32 v[128:129], v[74:75], v[74:75]
  v_pk_fma_f32 v[128:129], v[128:129], s[48:49], v[126:127]
  v_pk_mul_f32 v[128:129], v[128:129], v[74:75]
  v_exp_f32 v128, v128
  v_exp_f32 v129, v129
  s_nop 0
  v_pk_add_f32 v[128:129], v[128:129], s[50:51]
  v_rcp_f32 v128, v128
  v_rcp_f32 v129, v129
  s_nop 0
  v_pk_mul_f32 v[128:129], v[128:129], v[74:75]
  v_cvt_pk_bf16_f32 v118, v128, v129
  v_pk_fma_f32 v[76:77], v[36:37], v[42:43], v[76:77] op_sel_hi:[1,0,1]
  v_pk_mul_f32 v[76:77], v[76:77], v[46:47] op_sel_hi:[1,0]
  v_pk_mul_f32 v[132:133], v[76:77], v[76:77]
  v_pk_fma_f32 v[132:133], v[132:133], s[48:49], v[126:127]
  v_pk_mul_f32 v[132:133], v[132:133], v[76:77]
  v_exp_f32 v132, v132
  v_exp_f32 v133, v133
  s_nop 0
  v_pk_add_f32 v[132:133], v[132:133], s[50:51]
  v_rcp_f32 v132, v132
  v_rcp_f32 v133, v133
  s_nop 0
  v_pk_mul_f32 v[132:133], v[132:133], v[76:77]
  v_cvt_pk_bf16_f32 v119, v132, v133
  ds_write_b64 v22, v[118:119] offset:1024
  v_pk_fma_f32 v[78:79], v[26:27], v[44:45], v[78:79] op_sel_hi:[1,0,1]
  v_pk_mul_f32 v[78:79], v[78:79], v[48:49] op_sel_hi:[1,0]
  v_pk_mul_f32 v[128:129], v[78:79], v[78:79]
  v_pk_fma_f32 v[128:129], v[128:129], s[48:49], v[126:127]
  v_pk_mul_f32 v[128:129], v[128:129], v[78:79]
  v_exp_f32 v128, v128
  v_exp_f32 v129, v129
  s_nop 0
  v_pk_add_f32 v[128:129], v[128:129], s[50:51]
  v_rcp_f32 v128, v128
  v_rcp_f32 v129, v129
  s_nop 0
  v_pk_mul_f32 v[128:129], v[128:129], v[78:79]
  v_cvt_pk_bf16_f32 v120, v128, v129
  v_pk_fma_f32 v[80:81], v[28:29], v[44:45], v[80:81] op_sel_hi:[1,0,1]
  v_pk_mul_f32 v[80:81], v[80:81], v[48:49] op_sel_hi:[1,0]
  v_pk_mul_f32 v[132:133], v[80:81], v[80:81]
  v_pk_fma_f32 v[132:133], v[132:133], s[48:49], v[126:127]
  v_pk_mul_f32 v[132:133], v[132:133], v[80:81]
  v_exp_f32 v132, v132
  v_exp_f32 v133, v133
  s_nop 0
  v_pk_add_f32 v[132:133], v[132:133], s[50:51]
  v_rcp_f32 v132, v132
  v_rcp_f32 v133, v133
  s_nop 0
  v_pk_mul_f32 v[132:133], v[132:133], v[80:81]
  v_cvt_pk_bf16_f32 v121, v132, v133
  ds_write_b64 v23, v[120:121] offset:0
  v_pk_fma_f32 v[82:83], v[30:31], v[44:45], v[82:83] op_sel_hi:[1,0,1]
  v_pk_mul_f32 v[82:83], v[82:83], v[48:49] op_sel_hi:[1,0]
  v_pk_mul_f32 v[128:129], v[82:83], v[82:83]
  v_pk_fma_f32 v[128:129], v[128:129], s[48:49], v[126:127]
  v_pk_mul_f32 v[128:129], v[128:129], v[82:83]
  v_exp_f32 v128, v128
  v_exp_f32 v129, v129
  s_nop 0
  v_pk_add_f32 v[128:129], v[128:129], s[50:51]
  v_rcp_f32 v128, v128
  v_rcp_f32 v129, v129
  s_nop 0
  v_pk_mul_f32 v[128:129], v[128:129], v[82:83]
  v_cvt_pk_bf16_f32 v122, v128, v129
  v_pk_fma_f32 v[84:85], v[32:33], v[44:45], v[84:85] op_sel_hi:[1,0,1]
  v_pk_mul_f32 v[84:85], v[84:85], v[48:49] op_sel_hi:[1,0]
  v_pk_mul_f32 v[132:133], v[84:85], v[84:85]
  v_pk_fma_f32 v[132:133], v[132:133], s[48:49], v[126:127]
  v_pk_mul_f32 v[132:133], v[132:133], v[84:85]
  v_exp_f32 v132, v132
  v_exp_f32 v133, v133
  s_nop 0
  v_pk_add_f32 v[132:133], v[132:133], s[50:51]
  v_rcp_f32 v132, v132
  v_rcp_f32 v133, v133
  s_nop 0
  v_pk_mul_f32 v[132:133], v[132:133], v[84:85]
  v_cvt_pk_bf16_f32 v123, v132, v133
  ds_write_b64 v23, v[122:123] offset:512
  v_pk_fma_f32 v[86:87], v[34:35], v[44:45], v[86:87] op_sel_hi:[1,0,1]
  v_pk_mul_f32 v[86:87], v[86:87], v[48:49] op_sel_hi:[1,0]
  v_pk_mul_f32 v[128:129], v[86:87], v[86:87]
  v_pk_fma_f32 v[128:129], v[128:129], s[48:49], v[126:127]
  v_pk_mul_f32 v[128:129], v[128:129], v[86:87]
  v_exp_f32 v128, v128
  v_exp_f32 v129, v129
  s_nop 0
  v_pk_add_f32 v[128:129], v[128:129], s[50:51]
  v_rcp_f32 v128, v128
  v_rcp_f32 v129, v129
  s_nop 0
  v_pk_mul_f32 v[128:129], v[128:129], v[86:87]
  v_cvt_pk_bf16_f32 v124, v128, v129
  v_pk_fma_f32 v[88:89], v[36:37], v[44:45], v[88:89] op_sel_hi:[1,0,1]
  v_pk_mul_f32 v[88:89], v[88:89], v[48:49] op_sel_hi:[1,0]
  v_pk_mul_f32 v[132:133], v[88:89], v[88:89]
  v_pk_fma_f32 v[132:133], v[132:133], s[48:49], v[126:127]
  v_pk_mul_f32 v[132:133], v[132:133], v[88:89]
  v_exp_f32 v132, v132
  v_exp_f32 v133, v133
  s_nop 0
  v_pk_add_f32 v[132:133], v[132:133], s[50:51]
  v_rcp_f32 v132, v132
  v_rcp_f32 v133, v133
  s_nop 0
  v_pk_mul_f32 v[132:133], v[132:133], v[88:89]
  v_cvt_pk_bf16_f32 v125, v132, v133
  ds_write_b64 v23, v[124:125] offset:1024
  s_cmp_eq_u32 s34, 7
  s_cbranch_scc0 F2_NOCNT
  s_waitcnt vmcnt(0)
  s_mov_b32 exec_lo, 0xffffffff
  s_mov_b32 exec_hi, 0x0
  v_cmp_gt_u32 vcc, 8, v167
  s_mov_b64 exec, s[52:53]
  s_cmp_eq_u64 vcc, 0
  s_cbranch_scc1 F2_NOCNT
  v_lshlrev_b32 v6, 2, v1
  s_mov_b32 s42, 0
  s_mov_b32 exec_lo, 0xffffffff
  s_mov_b32 exec_hi, 0x0
FP_CNT:
  buffer_load_dword v7, v6, s[4:7], 0 offen offset:0 sc1
  s_waitcnt vmcnt(0)
  v_cmp_gt_u32 vcc, 8, v7
  s_add_u32 s42, s42, 1
  s_cmp_eq_u64 vcc, 0
  s_cbranch_scc1 FP_CNT_OK
  s_cmp_lt_u32 s42, 2097152
  s_cbranch_scc0 FP_CNT_OK
  s_sleep 1
  s_branch FP_CNT
FP_CNT_OK:
  s_mov_b64 exec, s[52:53]
F2_NOCNT:
  s_waitcnt lgkmcnt(0)
  s_cmp_eq_u32 s34, 7
  s_cbranch_scc1 F2_SYNC
  s_cmp_eq_u32 s45, 0
  s_cbranch_scc1 F2_IDLE
  s_mov_b32 s35, s44
  s_sub_u32 s42, s34, 4
  s_mul_i32 s36, s42, 21248
  s_add_u32 s36, s36, 65536
  v_add_u32 v10, 1, v3
  v_and_b32 v10, 3, v10
  v_lshrrev_b32 v11, 1, v2
  v_and_b32 v12, 1, v2
  v_lshlrev_b32 v13, 4, v11
  v_add_u32 v13, v13, v3
  v_lshlrev_b32 v14, 3, v12
  v_sub_u32 v13, v13, v14
  v_add_u32 v13, 9, v13
  v_sub_u32 v13, v13, v10
  v_lshlrev_b32 v13, 1, v13
  v_mul_u32_u24 v10, 4160, v10
  v_add_u32 v13, v13, v10
  v_add_u32 v4, s36, v13
  v_sub_u32 v13, v3, v11
  v_lshlrev_b32 v13, 1, v13
  v_add_u32 v13, v13, v12
  v_lshlrev_b32 v13, 4, v13
  s_add_u32 s40, s36, 17152
  v_add_u32 v5, s40, v13
  s_waitcnt vmcnt(0)
  s_barrier
  s_sleep 3
  s_sub_u32 s42, s34, 4
  v_lshrrev_b32 v8, 3, v1
  s_lshl_b32 s40, s42, 3
  v_add_u32 v8, s40, v8
  v_and_b32 v9, 7, v1
  v_lshlrev_b32 v9, 4, v9
  v_mul_u32_u24 v10, 144, v8
  v_add_u32 v10, v10, v9
  v_add_u32 v10, 49152, v10
  v_lshlrev_b32 v8, 12, v8
  v_add_u32 v8, v8, v9
  ds_read_b128 v[16:19], v10 offset:0
  ds_read_b128 v[20:23], v10 offset:3456
  ds_read_b128 v[24:27], v10 offset:6912
  ds_read_b128 v[28:31], v10 offset:10368
  s_mul_i32 s40, s33, 327680
  s_lshl_b32 s41, s32, 7
  s_add_u32 s40, s40, s41
  s_add_u32 s40, s40, 6291456
  s_waitcnt lgkmcnt(0)
  buffer_store_dwordx4 v[16:19], v8, s[16:19], s40 offen sc1
  s_add_u32 s40, s40, 98304
  buffer_store_dwordx4 v[20:23], v8, s[16:19], s40 offen sc1
  s_add_u32 s40, s40, 98304
  buffer_store_dwordx4 v[24:27], v8, s[16:19], s40 offen sc1
  s_add_u32 s40, s40, 98304
  s_cmp_eq_u32 s42, 0
  s_cselect_b32 s40, s40, 0x80000000
  buffer_store_dwordx4 v[28:31], v8, s[16:19], s40 offen sc1
  s_add_u32 s40, s40, 98304
  s_waitcnt lgkmcnt(0)
  s_lshl_b32 s40, s44, 12
  s_add_u32 s20, s64, s40
  s_addc_u32 s21, s65, 0
  s_and_b32 s21, s21, 0xffff
  s_mov_b32 s22, 4096
  s_mov_b32 s23, 0x20000
  s_mov_b32 s24, s66
  s_and_b32 s25, s67, 0xffff
  s_mov_b32 s26, 1280
  s_mov_b32 s27, 0x20000
  v_lshlrev_b32 v167, 4, v1
  buffer_load_dwordx4 v[136:139], v167, s[20:23], 0 offen offset:0
  buffer_load_dwordx2 v[140:141], v167, s[20:23], 0 offen offset:16
  buffer_load_dwordx4 v[142:145], v167, s[20:23], 0 offen offset:1024
  buffer_load_dwordx2 v[146:147], v167, s[20:23], 0 offen offset:1040
  buffer_load_dwordx4 v[148:151], v167, s[20:23], 0 offen offset:2048
  buffer_load_dwordx2 v[152:153], v167, s[20:23], 0 offen offset:2064
  buffer_load_dwordx4 v[154:157], v167, s[20:23], 0 offen offset:3072
  buffer_load_dwordx2 v[158:159], v167, s[20:23], 0 offen offset:3088
  v_mov_b32 v167, 0
  buffer_load_dwordx2 v[164:165], v167, s[20:23], 0 offen
  s_lshl_b32 s40, s44, 1
  buffer_load_ushort v166, v167, s[24:27], s40 offen
  s_barrier
  s_waitcnt vmcnt(0)
  v_mov_b32 v46, v166
  v_mov_b32 v8, 0
  v_mov_b32 v9, 0
  v_lshlrev_b32 v10, 3, v1
  v_add_u32 v10, s36, v10
  ds_write_b64 v10, v[8:9] offset:16640
  v_lshlrev_b32 v10, 4, v1
  v_add_u32 v10, s36, v10
  v_alignbit_b32 v80, v137, v136, 16
  v_alignbit_b32 v81, v138, v137, 16
  v_alignbit_b32 v82, v139, v138, 16
  v_alignbit_b32 v83, v140, v139, 16
  v_mov_b32 v84, v137
  v_mov_b32 v85, v138
  v_mov_b32 v86, v139
  v_mov_b32 v87, v140
  v_mov_b32 v88, v81
  v_mov_b32 v89, v82
  v_mov_b32 v90, v83
  v_alignbit_b32 v91, v141, v140, 16
  ds_write_b128 v10, v[136:139] offset:32
  ds_write_b128 v10, v[80:83] offset:4192
  ds_write_b128 v10, v[84:87] offset:8352
  ds_write_b128 v10, v[88:91] offset:12512
  s_waitcnt lgkmcnt(4)
  v_alignbit_b32 v92, v143, v142, 16
  v_alignbit_b32 v93, v144, v143, 16
  v_alignbit_b32 v94, v145, v144, 16
  v_alignbit_b32 v95, v146, v145, 16
  v_mov_b32 v96, v143
  v_mov_b32 v97, v144
  v_mov_b32 v98, v145
  v_mov_b32 v99, v146
  v_mov_b32 v100, v93
  v_mov_b32 v101, v94
  v_mov_b32 v102, v95
  v_alignbit_b32 v103, v147, v146, 16
  ds_write_b128 v10, v[142:145] offset:1056
  ds_write_b128 v10, v[92:95] offset:5216
  ds_write_b128 v10, v[96:99] offset:9376
  ds_write_b128 v10, v[100:103] offset:13536
  s_waitcnt lgkmcnt(4)
  s_waitcnt vmcnt(0)
  s_barrier
  v_alignbit_b32 v104, v149, v148, 16
  v_alignbit_b32 v105, v150, v149, 16
  v_alignbit_b32 v106, v151, v150, 16
  v_alignbit_b32 v107, v152, v151, 16
  v_mov_b32 v108, v149
  v_mov_b32 v109, v150
  v_mov_b32 v110, v151
  v_mov_b32 v111, v152
  v_mov_b32 v112, v105
  v_mov_b32 v113, v106
  v_mov_b32 v114, v107
  v_alignbit_b32 v115, v153, v152, 16
  ds_write_b128 v10, v[148:151] offset:2080
  ds_write_b128 v10, v[104:107] offset:6240
  ds_write_b128 v10, v[108:111] offset:10400
  ds_write_b128 v10, v[112:115] offset:14560
  s_waitcnt lgkmcnt(4)
  s_barrier
  v_alignbit_b32 v116, v155, v154, 16
  v_alignbit_b32 v117, v156, v155, 16
  v_alignbit_b32 v118, v157, v156, 16
  v_alignbit_b32 v119, v158, v157, 16
  v_mov_b32 v120, v155
  v_mov_b32 v121, v156
  v_mov_b32 v122, v157
  v_mov_b32 v123, v158
  v_mov_b32 v124, v117
  v_mov_b32 v125, v118
  v_mov_b32 v126, v119
  v_alignbit_b32 v127, v159, v158, 16
  ds_write_b128 v10, v[154:157] offset:3104
  ds_write_b128 v10, v[116:119] offset:7264
  ds_write_b128 v10, v[120:123] offset:11424
  ds_write_b128 v10, v[124:127] offset:15584
  s_waitcnt lgkmcnt(4)
  v_mov_b32 v160, 0
  v_mov_b32 v161, 0
  v_mov_b32 v162, 0
  v_mov_b32 v163, 0
  v_cmp_eq_u32 vcc, 1, v1
  s_nop 1
  v_cndmask_b32 v164, 0, v164, vcc
  v_cndmask_b32 v165, 0, v165, vcc
  s_waitcnt lgkmcnt(0)
  s_mov_b32 exec_lo, 0x3
  s_mov_b32 exec_hi, 0x0
  v_alignbit_b32 v80, v161, v160, 16
  v_alignbit_b32 v81, v162, v161, 16
  v_alignbit_b32 v82, v163, v162, 16
  v_alignbit_b32 v83, v164, v163, 16
  v_mov_b32 v84, v161
  v_mov_b32 v85, v162
  v_mov_b32 v86, v163
  v_mov_b32 v87, v164
  v_mov_b32 v88, v81
  v_mov_b32 v89, v82
  v_mov_b32 v90, v83
  v_alignbit_b32 v91, v165, v164, 16
  ds_write_b128 v10, v[160:163] offset:0
  ds_write_b128 v10, v[80:83] offset:4160
  ds_write_b128 v10, v[84:87] offset:8320
  ds_write_b128 v10, v[88:91] offset:12480
  s_mov_b64 exec, s[52:53]
  v_lshlrev_b32 v46, 16, v46
  v_mov_b32 v48, 0
  v_mov_b32 v49, 0
  v_mov_b32 v50, 0
  v_mov_b32 v51, 0
  v_mov_b32 v52, 0
  v_mov_b32 v53, 0
  v_mov_b32 v54, 0
  v_mov_b32 v55, 0
  v_mov_b32 v56, 0
  v_mov_b32 v57, 0
  v_mov_b32 v58, 0
  v_mov_b32 v59, 0
  v_mov_b32 v60, 0
  v_mov_b32 v61, 0
  v_mov_b32 v62, 0
  v_mov_b32 v63, 0
  v_mov_b32 v64, 0
  v_mov_b32 v65, 0
  v_mov_b32 v66, 0
  v_mov_b32 v67, 0
  v_mov_b32 v68, 0
  v_mov_b32 v69, 0
  v_mov_b32 v70, 0
  v_mov_b32 v71, 0
  v_mov_b32 v72, 0
  v_mov_b32 v73, 0
  v_mov_b32 v74, 0
  v_mov_b32 v75, 0
  v_mov_b32 v76, 0
  v_mov_b32 v77, 0
  v_mov_b32 v78, 0
  v_mov_b32 v79, 0
  s_waitcnt vmcnt(0) lgkmcnt(0)
  s_barrier
  s_barrier
  s_barrier
  v_lshlrev_b32 v6, 4, v1
  s_lshl_b32 s40, s35, 12
  s_add_u32 s40, s40, 6291456
  s_add_u32 m0, s36, 17152
  s_add_u32 s41, s40, 0
  buffer_load_dwordx4 v6, s[16:19], s41 offen sc1 lds
  s_add_u32 m0, s36, 18176
  s_add_u32 s41, s40, 1024
  buffer_load_dwordx4 v6, s[16:19], s41 offen sc1 lds
  s_add_u32 m0, s36, 19200
  s_add_u32 s41, s40, 2048
  buffer_load_dwordx4 v6, s[16:19], s41 offen sc1 lds
  s_add_u32 m0, s36, 20224
  s_add_u32 s41, s40, 3072
  buffer_load_dwordx4 v6, s[16:19], s41 offen sc1 lds
  ds_read_b64 v[80:81], v4 offset:0
  ds_read_b64 v[82:83], v4 offset:8
  ds_read_b64 v[84:85], v4 offset:512
  ds_read_b64 v[86:87], v4 offset:520
  ds_read_b64 v[88:89], v4 offset:1024
  ds_read_b64 v[90:91], v4 offset:1032
  ds_read_b64 v[92:93], v4 offset:1536
  ds_read_b64 v[94:95], v4 offset:1544
  s_waitcnt lgkmcnt(6)
  ds_read_b64 v[96:97], v4 offset:2048
  ds_read_b64 v[98:99], v4 offset:2056
  ds_read_b64 v[100:101], v4 offset:2560
  ds_read_b64 v[102:103], v4 offset:2568
  ds_read_b64 v[104:105], v4 offset:3072
  ds_read_b64 v[106:107], v4 offset:3080
  ds_read_b64 v[108:109], v4 offset:3584
  ds_read_b64 v[110:111], v4 offset:3592
  s_waitcnt lgkmcnt(6)
  s_barrier
  s_waitcnt vmcnt(0)
  ds_read_b128 v[112:115], v5 offset:0
  ds_read_b128 v[116:119], v5 offset:512
  ds_read_b128 v[120:123], v5 offset:1024
  ds_read_b128 v[124:127], v5 offset:1536
  ds_read_b128 v[128:131], v5 offset:2048
  ds_read_b128 v[132:135], v5 offset:2560
  ds_read_b128 v[136:139], v5 offset:3072
  ds_read_b128 v[140:143], v5 offset:3584
  s_mov_b32 s37, 0
F2_CLOOP:
  v_add_u32 v4, 64, v4
  v_subrev_u32 v5, 64, v5
  s_waitcnt lgkmcnt(0)
  v_mfma_f32_16x16x32_bf16 v[48:51], v[80:83], v[112:115], v[48:51]
  v_mfma_f32_16x16x32_bf16 v[52:55], v[80:83], v[116:119], v[52:55]
  v_mfma_f32_16x16x32_bf16 v[56:59], v[80:83], v[120:123], v[56:59]
  v_mfma_f32_16x16x32_bf16 v[60:63], v[80:83], v[124:127], v[60:63]
  v_mfma_f32_16x16x32_bf16 v[64:67], v[80:83], v[128:131], v[64:67]
  v_mfma_f32_16x16x32_bf16 v[68:71], v[80:83], v[132:135], v[68:71]
  v_mfma_f32_16x16x32_bf16 v[72:75], v[80:83], v[136:139], v[72:75]
  v_mfma_f32_16x16x32_bf16 v[76:79], v[80:83], v[140:143], v[76:79]
  ds_read_b64 v[80:81], v4 offset:0
  ds_read_b64 v[82:83], v4 offset:8
  ds_read_b128 v[140:143], v5 offset:3584
  v_mfma_f32_16x16x32_bf16 v[52:55], v[84:87], v[112:115], v[52:55]
  v_mfma_f32_16x16x32_bf16 v[56:59], v[84:87], v[116:119], v[56:59]
  v_mfma_f32_16x16x32_bf16 v[60:63], v[84:87], v[120:123], v[60:63]
  v_mfma_f32_16x16x32_bf16 v[64:67], v[84:87], v[124:127], v[64:67]
  v_mfma_f32_16x16x32_bf16 v[68:71], v[84:87], v[128:131], v[68:71]
  v_mfma_f32_16x16x32_bf16 v[72:75], v[84:87], v[132:135], v[72:75]
  v_mfma_f32_16x16x32_bf16 v[76:79], v[84:87], v[136:139], v[76:79]
  ds_read_b64 v[84:85], v4 offset:512
  ds_read_b64 v[86:87], v4 offset:520
  ds_read_b128 v[136:139], v5 offset:3072
  v_mfma_f32_16x16x32_bf16 v[56:59], v[88:91], v[112:115], v[56:59]
  v_mfma_f32_16x16x32_bf16 v[60:63], v[88:91], v[116:119], v[60:63]
  v_mfma_f32_16x16x32_bf16 v[64:67], v[88:91], v[120:123], v[64:67]
  v_mfma_f32_16x16x32_bf16 v[68:71], v[88:91], v[124:127], v[68:71]
  v_mfma_f32_16x16x32_bf16 v[72:75], v[88:91], v[128:131], v[72:75]
  v_mfma_f32_16x16x32_bf16 v[76:79], v[88:91], v[132:135], v[76:79]
  ds_read_b64 v[88:89], v4 offset:1024
  ds_read_b64 v[90:91], v4 offset:1032
  ds_read_b128 v[132:135], v5 offset:2560
  v_mfma_f32_16x16x32_bf16 v[60:63], v[92:95], v[112:115], v[60:63]
  v_mfma_f32_16x16x32_bf16 v[64:67], v[92:95], v[116:119], v[64:67]
  v_mfma_f32_16x16x32_bf16 v[68:71], v[92:95], v[120:123], v[68:71]
  v_mfma_f32_16x16x32_bf16 v[72:75], v[92:95], v[124:127], v[72:75]
  v_mfma_f32_16x16x32_bf16 v[76:79], v[92:95], v[128:131], v[76:79]
  ds_read_b64 v[92:93], v4 offset:1536
  ds_read_b64 v[94:95], v4 offset:1544
  ds_read_b128 v[128:131], v5 offset:2048
  s_waitcnt lgkmcnt(6)
  s_barrier
  v_mfma_f32_16x16x32_bf16 v[64:67], v[96:99], v[112:115], v[64:67]
  v_mfma_f32_16x16x32_bf16 v[68:71], v[96:99], v[116:119], v[68:71]
  v_mfma_f32_16x16x32_bf16 v[72:75], v[96:99], v[120:123], v[72:75]
  v_mfma_f32_16x16x32_bf16 v[76:79], v[96:99], v[124:127], v[76:79]
  ds_read_b64 v[96:97], v4 offset:2048
  ds_read_b64 v[98:99], v4 offset:2056
  ds_read_b128 v[124:127], v5 offset:1536
  v_mfma_f32_16x16x32_bf16 v[68:71], v[100:103], v[112:115], v[68:71]
  v_mfma_f32_16x16x32_bf16 v[72:75], v[100:103], v[116:119], v[72:75]
  v_mfma_f32_16x16x32_bf16 v[76:79], v[100:103], v[120:123], v[76:79]
  ds_read_b64 v[100:101], v4 offset:2560
  ds_read_b64 v[102:103], v4 offset:2568
  ds_read_b128 v[120:123], v5 offset:1024
  v_mfma_f32_16x16x32_bf16 v[72:75], v[104:107], v[112:115], v[72:75]
  v_mfma_f32_16x16x32_bf16 v[76:79], v[104:107], v[116:119], v[76:79]
  ds_read_b64 v[104:105], v4 offset:3072
  ds_read_b64 v[106:107], v4 offset:3080
  ds_read_b128 v[116:119], v5 offset:512
  s_waitcnt lgkmcnt(6)
  v_mfma_f32_16x16x32_bf16 v[76:79], v[108:111], v[112:115], v[76:79]
  ds_read_b64 v[108:109], v4 offset:3584
  ds_read_b64 v[110:111], v4 offset:3592
  ds_read_b128 v[112:115], v5 offset:0
  v_add_u32 v4, 64, v4
  v_subrev_u32 v5, 64, v5
  s_waitcnt lgkmcnt(0)
  v_mfma_f32_16x16x32_bf16 v[48:51], v[80:83], v[112:115], v[48:51]
  v_mfma_f32_16x16x32_bf16 v[52:55], v[80:83], v[116:119], v[52:55]
  v_mfma_f32_16x16x32_bf16 v[56:59], v[80:83], v[120:123], v[56:59]
  v_mfma_f32_16x16x32_bf16 v[60:63], v[80:83], v[124:127], v[60:63]
  v_mfma_f32_16x16x32_bf16 v[64:67], v[80:83], v[128:131], v[64:67]
  v_mfma_f32_16x16x32_bf16 v[68:71], v[80:83], v[132:135], v[68:71]
  v_mfma_f32_16x16x32_bf16 v[72:75], v[80:83], v[136:139], v[72:75]
  v_mfma_f32_16x16x32_bf16 v[76:79], v[80:83], v[140:143], v[76:79]
  ds_read_b64 v[80:81], v4 offset:0
  ds_read_b64 v[82:83], v4 offset:8
  ds_read_b128 v[140:143], v5 offset:3584
  v_mfma_f32_16x16x32_bf16 v[52:55], v[84:87], v[112:115], v[52:55]
  v_mfma_f32_16x16x32_bf16 v[56:59], v[84:87], v[116:119], v[56:59]
  v_mfma_f32_16x16x32_bf16 v[60:63], v[84:87], v[120:123], v[60:63]
  v_mfma_f32_16x16x32_bf16 v[64:67], v[84:87], v[124:127], v[64:67]
  v_mfma_f32_16x16x32_bf16 v[68:71], v[84:87], v[128:131], v[68:71]
  v_mfma_f32_16x16x32_bf16 v[72:75], v[84:87], v[132:135], v[72:75]
  v_mfma_f32_16x16x32_bf16 v[76:79], v[84:87], v[136:139], v[76:79]
  ds_read_b64 v[84:85], v4 offset:512
  ds_read_b64 v[86:87], v4 offset:520
  ds_read_b128 v[136:139], v5 offset:3072
  s_barrier
  v_mfma_f32_16x16x32_bf16 v[56:59], v[88:91], v[112:115], v[56:59]
  v_mfma_f32_16x16x32_bf16 v[60:63], v[88:91], v[116:119], v[60:63]
  v_mfma_f32_16x16x32_bf16 v[64:67], v[88:91], v[120:123], v[64:67]
  v_mfma_f32_16x16x32_bf16 v[68:71], v[88:91], v[124:127], v[68:71]
  v_mfma_f32_16x16x32_bf16 v[72:75], v[88:91], v[128:131], v[72:75]
  v_mfma_f32_16x16x32_bf16 v[76:79], v[88:91], v[132:135], v[76:79]
  ds_read_b64 v[88:89], v4 offset:1024
  ds_read_b64 v[90:91], v4 offset:1032
  ds_read_b128 v[132:135], v5 offset:2560
  v_mfma_f32_16x16x32_bf16 v[60:63], v[92:95], v[112:115], v[60:63]
  v_mfma_f32_16x16x32_bf16 v[64:67], v[92:95], v[116:119], v[64:67]
  v_mfma_f32_16x16x32_bf16 v[68:71], v[92:95], v[120:123], v[68:71]
  v_mfma_f32_16x16x32_bf16 v[72:75], v[92:95], v[124:127], v[72:75]
  v_mfma_f32_16x16x32_bf16 v[76:79], v[92:95], v[128:131], v[76:79]
  ds_read_b64 v[92:93], v4 offset:1536
  ds_read_b64 v[94:95], v4 offset:1544
  ds_read_b128 v[128:131], v5 offset:2048
  s_waitcnt lgkmcnt(6)
  v_mfma_f32_16x16x32_bf16 v[64:67], v[96:99], v[112:115], v[64:67]
  v_mfma_f32_16x16x32_bf16 v[68:71], v[96:99], v[116:119], v[68:71]
  v_mfma_f32_16x16x32_bf16 v[72:75], v[96:99], v[120:123], v[72:75]
  v_mfma_f32_16x16x32_bf16 v[76:79], v[96:99], v[124:127], v[76:79]
  ds_read_b64 v[96:97], v4 offset:2048
  ds_read_b64 v[98:99], v4 offset:2056
  ds_read_b128 v[124:127], v5 offset:1536
  v_mfma_f32_16x16x32_bf16 v[68:71], v[100:103], v[112:115], v[68:71]
  v_mfma_f32_16x16x32_bf16 v[72:75], v[100:103], v[116:119], v[72:75]
  v_mfma_f32_16x16x32_bf16 v[76:79], v[100:103], v[120:123], v[76:79]
  ds_read_b64 v[100:101], v4 offset:2560
  ds_read_b64 v[102:103], v4 offset:2568
  ds_read_b128 v[120:123], v5 offset:1024
  v_mfma_f32_16x16x32_bf16 v[72:75], v[104:107], v[112:115], v[72:75]
  v_mfma_f32_16x16x32_bf16 v[76:79], v[104:107], v[116:119], v[76:79]
  ds_read_b64 v[104:105], v4 offset:3072
  ds_read_b64 v[106:107], v4 offset:3080
  ds_read_b128 v[116:119], v5 offset:512
  s_waitcnt lgkmcnt(6)
  v_mfma_f32_16x16x32_bf16 v[76:79], v[108:111], v[112:115], v[76:79]
  ds_read_b64 v[108:109], v4 offset:3584
  ds_read_b64 v[110:111], v4 offset:3592
  ds_read_b128 v[112:115], v5 offset:0
  s_barrier
  s_add_u32 s37, s37, 2
  s_cmp_lt_u32 s37, 8
  s_cbranch_scc1 F2_CLOOP
  s_waitcnt lgkmcnt(0)
  v_lshlrev_b32 v6, 5, v3
  v_lshrrev_b32 v7, 1, v2
  v_lshlrev_b32 v7, 4, v7
  v_add_u32 v6, v6, v7
  v_and_b32 v7, 1, v2
  v_xor_b32 v7, 1, v7
  v_lshlrev_b32 v7, 3, v7
  v_add_u32 v6, v6, v7
  s_add_u32 s40, s36, 17152
  v_add_u32 v6, s40, v6
  ds_read_b64 v[80:81], v6 offset:0
  ds_read_b64 v[82:83], v6 offset:512
  ds_read_b64 v[84:85], v6 offset:1024
  ds_read_b64 v[86:87], v6 offset:1536
  ds_read_b64 v[88:89], v6 offset:2048
  ds_read_b64 v[90:91], v6 offset:2560
  ds_read_b64 v[92:93], v6 offset:3072
  ds_read_b64 v[94:95], v6 offset:3584
  v_lshlrev_b32 v8, 5, v3
  v_lshlrev_b32 v9, 3, v2
  v_add_u32 v8, v8, v9
  s_lshl_b32 s40, s35, 12
  s_add_u32 s40, s40, 9437184
  s_waitcnt lgkmcnt(0)
  v_and_b32 v112, s47, v81
  v_lshlrev_b32 v113, 16, v81
  v_and_b32 v114, s47, v80
  v_lshlrev_b32 v115, 16, v80
  v_fmac_f32 v48, v112, v46
  v_fmac_f32 v49, v113, v46
  v_fmac_f32 v50, v114, v46
  v_fmac_f32 v51, v115, v46
  v_cvt_pk_bf16_f32 v116, v48, v49
  v_cvt_pk_bf16_f32 v117, v50, v51
  buffer_store_dwordx2 v[116:117], v8, s[16:19], s40 offen offset:0 sc1
  v_and_b32 v120, s47, v83
  v_lshlrev_b32 v121, 16, v83
  v_and_b32 v122, s47, v82
  v_lshlrev_b32 v123, 16, v82
  v_fmac_f32 v52, v120, v46
  v_fmac_f32 v53, v121, v46
  v_fmac_f32 v54, v122, v46
  v_fmac_f32 v55, v123, v46
  v_cvt_pk_bf16_f32 v124, v52, v53
  v_cvt_pk_bf16_f32 v125, v54, v55
  buffer_store_dwordx2 v[124:125], v8, s[16:19], s40 offen offset:512 sc1
  v_and_b32 v128, s47, v85
  v_lshlrev_b32 v129, 16, v85
  v_and_b32 v130, s47, v84
  v_lshlrev_b32 v131, 16, v84
  v_fmac_f32 v56, v128, v46
  v_fmac_f32 v57, v129, v46
  v_fmac_f32 v58, v130, v46
  v_fmac_f32 v59, v131, v46
  v_cvt_pk_bf16_f32 v132, v56, v57
  v_cvt_pk_bf16_f32 v133, v58, v59
  buffer_store_dwordx2 v[132:133], v8, s[16:19], s40 offen offset:1024 sc1
  v_and_b32 v136, s47, v87
  v_lshlrev_b32 v137, 16, v87
  v_and_b32 v138, s47, v86
  v_lshlrev_b32 v139, 16, v86
  v_fmac_f32 v60, v136, v46
  v_fmac_f32 v61, v137, v46
  v_fmac_f32 v62, v138, v46
  v_fmac_f32 v63, v139, v46
  v_cvt_pk_bf16_f32 v140, v60, v61
  v_cvt_pk_bf16_f32 v141, v62, v63
  buffer_store_dwordx2 v[140:141], v8, s[16:19], s40 offen offset:1536 sc1
  v_and_b32 v112, s47, v89
  v_lshlrev_b32 v113, 16, v89
  v_and_b32 v114, s47, v88
  v_lshlrev_b32 v115, 16, v88
  v_fmac_f32 v64, v112, v46
  v_fmac_f32 v65, v113, v46
  v_fmac_f32 v66, v114, v46
  v_fmac_f32 v67, v115, v46
  v_cvt_pk_bf16_f32 v116, v64, v65
  v_cvt_pk_bf16_f32 v117, v66, v67
  buffer_store_dwordx2 v[116:117], v8, s[16:19], s40 offen offset:2048 sc1
  v_and_b32 v120, s47, v91
  v_lshlrev_b32 v121, 16, v91
  v_and_b32 v122, s47, v90
  v_lshlrev_b32 v123, 16, v90
  v_fmac_f32 v68, v120, v46
  v_fmac_f32 v69, v121, v46
  v_fmac_f32 v70, v122, v46
  v_fmac_f32 v71, v123, v46
  v_cvt_pk_bf16_f32 v124, v68, v69
  v_cvt_pk_bf16_f32 v125, v70, v71
  buffer_store_dwordx2 v[124:125], v8, s[16:19], s40 offen offset:2560 sc1
  v_and_b32 v128, s47, v93
  v_lshlrev_b32 v129, 16, v93
  v_and_b32 v130, s47, v92
  v_lshlrev_b32 v131, 16, v92
  v_fmac_f32 v72, v128, v46
  v_fmac_f32 v73, v129, v46
  v_fmac_f32 v74, v130, v46
  v_fmac_f32 v75, v131, v46
  v_cvt_pk_bf16_f32 v132, v72, v73
  v_cvt_pk_bf16_f32 v133, v74, v75
  buffer_store_dwordx2 v[132:133], v8, s[16:19], s40 offen offset:3072 sc1
  v_and_b32 v136, s47, v95
  v_lshlrev_b32 v137, 16, v95
  v_and_b32 v138, s47, v94
  v_lshlrev_b32 v139, 16, v94
  v_fmac_f32 v76, v136, v46
  v_fmac_f32 v77, v137, v46
  v_fmac_f32 v78, v138, v46
  v_fmac_f32 v79, v139, v46
  v_cvt_pk_bf16_f32 v140, v76, v77
  v_cvt_pk_bf16_f32 v141, v78, v79
  buffer_store_dwordx2 v[140:141], v8, s[16:19], s40 offen offset:3584 sc1
  s_waitcnt vmcnt(0)
  s_barrier
F3_IDLE:
  s_barrier
  s_barrier
  s_barrier
  s_barrier
  s_barrier
  s_barrier
  s_barrier
  s_endpgm
F2_IDLE:
  s_waitcnt vmcnt(0)
  s_barrier
  s_sleep 3
  s_sub_u32 s42, s34, 4
  v_lshrrev_b32 v8, 3, v1
  s_lshl_b32 s40, s42, 3
  v_add_u32 v8, s40, v8
  v_and_b32 v9, 7, v1
  v_lshlrev_b32 v9, 4, v9
  v_mul_u32_u24 v10, 144, v8
  v_add_u32 v10, v10, v9
  v_add_u32 v10, 49152, v10
  v_lshlrev_b32 v8, 12, v8
  v_add_u32 v8, v8, v9
  ds_read_b128 v[16:19], v10 offset:0
  ds_read_b128 v[20:23], v10 offset:3456
  ds_read_b128 v[24:27], v10 offset:6912
  ds_read_b128 v[28:31], v10 offset:10368
  s_mul_i32 s40, s33, 327680
  s_lshl_b32 s41, s32, 7
  s_add_u32 s40, s40, s41
  s_add_u32 s40, s40, 6291456
  s_waitcnt lgkmcnt(0)
  buffer_store_dwordx4 v[16:19], v8, s[16:19], s40 offen sc1
  s_add_u32 s40, s40, 98304
  buffer_store_dwordx4 v[20:23], v8, s[16:19], s40 offen sc1
  s_add_u32 s40, s40, 98304
  buffer_store_dwordx4 v[24:27], v8, s[16:19], s40 offen sc1
  s_add_u32 s40, s40, 98304
  s_cmp_eq_u32 s42, 0
  s_cselect_b32 s40, s40, 0x80000000
  buffer_store_dwordx4 v[28:31], v8, s[16:19], s40 offen sc1
  s_add_u32 s40, s40, 98304
  s_barrier
  s_waitcnt vmcnt(0)
  s_barrier
  s_barrier
  s_barrier
  s_barrier
  s_barrier
  s_barrier
  s_barrier
  s_barrier
  s_barrier
  s_barrier
  s_barrier
  s_barrier
  s_barrier
  s_barrier
  s_barrier
  s_barrier
  s_barrier
  s_barrier
  s_barrier
  s_branch F3_IDLE
F2_SYNC:
  s_load_dwordx2 s[72:73], s[0:1], 104
  s_waitcnt lgkmcnt(0)
  s_load_dwordx2 s[70:71], s[0:1], 64
  s_lshl_b32 s40, s32, 6
  s_lshl_b32 s41, s33, 3
  s_add_u32 s40, s40, s41
  v_lshrrev_b32 v20, 3, v1
  v_add_u32 v20, s40, v20
  v_lshlrev_b32 v20, 12, v20
  v_and_b32 v21, 7, v1
  v_lshlrev_b32 v21, 6, v21
  v_add_u32 v20, v20, v21
  v_lshrrev_b32 v22, 2, v1
  v_add_u32 v22, s40, v22
  v_lshlrev_b32 v22, 12, v22
  v_and_b32 v21, 3, v1
  v_lshlrev_b32 v21, 6, v21
  v_add_u32 v22, v22, v21
  s_waitcnt lgkmcnt(0)
  s_mov_b32 s8, s70
  s_and_b32 s9, s71, 0xffff
  s_mov_b32 s10, 8388608
  s_mov_b32 s11, 0x20000
  s_lshl_b32 s40, s33, 7
  s_lshl_b32 s41, s32, 2
  s_add_u32 s40, s40, s41
  s_add_u32 s41, s40, 17040384
  s_add_u32 s40, s40, 17039360
  v_mov_b32 v8, s40
  v_mov_b32 v9, s41
  v_cmp_eq_u32 vcc, 1, v1
  s_nop 1
  v_cndmask_b32 v8, v8, v9, vcc
  s_lshl_b32 s40, s32, 5
  s_lshl_b32 s41, s33, 2
  s_add_u32 s40, s40, s41
  s_add_u32 s40, s40, 17041408
  v_mov_b32 v9, s40
  v_cmp_eq_u32 vcc, 2, v1
  s_nop 1
  v_cndmask_b32 v8, v8, v9, vcc
  s_lshl_b32 s40, s33, 7
  s_lshl_b32 s41, s32, 2
  s_add_u32 s40, s40, s41
  s_add_u32 s40, s40, 17042432
  v_mov_b32 v9, s40
  v_cmp_eq_u32 vcc, 3, v1
  s_nop 1
  v_cndmask_b32 v8, v8, v9, vcc
  v_mov_b32 v10, 1
  s_waitcnt vmcnt(0)
  s_barrier
  s_mov_b32 exec_lo, 0x1
  s_mov_b32 exec_hi, 0x0
  buffer_store_dword v10, v8, s[16:19], 0 offen sc1
  s_mov_b64 exec, s[52:53]
  buffer_load_dword v25, v20, s[8:11], 0 offen offset:512
  buffer_load_dword v26, v20, s[8:11], 0 offen offset:1024
  s_lshl_b32 s40, s33, 7
  s_add_u32 s75, s40, 17039360
  s_add_u32 s40, s40, 17039360
  v_lshlrev_b32 v6, 2, v1
  v_add_u32 v6, s40, v6
  s_add_u32 s74, s75, 0
  s_mov_b32 s42, 0
SP_F1a:
  s_load_dwordx8 s[56:63], s[72:73], s74 glc
  s_waitcnt lgkmcnt(0)
  s_and_b64 s[56:57], s[56:57], s[60:61]
  s_and_b64 s[58:59], s[58:59], s[62:63]
  s_and_b64 s[56:57], s[56:57], s[58:59]
  s_and_b32 s56, s56, s57
  s_add_u32 s42, s42, 1
  s_cmp_eq_u32 s56, 1
  s_cbranch_scc1 SP_F1a_OK
  s_cmp_lt_u32 s42, 2097152
  s_cbranch_scc1 SP_F1a
SP_F1a_OK:
  s_barrier
  s_barrier
  s_mov_b32 exec_hi, 0
  s_movk_i32 s40, 1536
  buffer_load_dword v28, v22, s[8:11], s40 offen
  s_mov_b32 exec_hi, -1
  s_mov_b32 exec_lo, 0x8
  s_mov_b32 exec_hi, 0x0
  buffer_store_dword v10, v8, s[16:19], 0 offen sc1
  s_mov_b64 exec, s[52:53]
  s_add_u32 s74, s75, 32
  s_mov_b32 s42, 0
SP_F1b:
  s_load_dwordx8 s[56:63], s[72:73], s74 glc
  s_waitcnt lgkmcnt(0)
  s_and_b64 s[56:57], s[56:57], s[60:61]
  s_and_b64 s[58:59], s[58:59], s[62:63]
  s_and_b64 s[56:57], s[56:57], s[58:59]
  s_and_b32 s56, s56, s57
  s_add_u32 s42, s42, 1
  s_cmp_eq_u32 s56, 1
  s_cbranch_scc1 SP_F1b_OK
  s_cmp_lt_u32 s42, 2097152
  s_cbranch_scc1 SP_F1b
SP_F1b_OK:
  s_barrier
  s_mov_b32 exec_hi, 0
  s_movk_i32 s40, 1792
  buffer_load_dword v29, v22, s[8:11], s40 offen
  s_mov_b32 exec_hi, -1
  s_barrier
  s_mov_b32 exec_hi, 0
  s_movk_i32 s40, 2048
  buffer_load_dword v30, v22, s[8:11], s40 offen
  s_mov_b32 exec_hi, -1
  s_add_u32 s74, s75, 64
  s_mov_b32 s42, 0
SP_F1c:
  s_load_dwordx16 s[56:71], s[72:73], s74 glc
  s_waitcnt lgkmcnt(0)
  s_and_b64 s[56:57], s[56:57], s[64:65]
  s_and_b64 s[58:59], s[58:59], s[66:67]
  s_and_b64 s[60:61], s[60:61], s[68:69]
  s_and_b64 s[62:63], s[62:63], s[70:71]
  s_and_b64 s[56:57], s[56:57], s[60:61]
  s_and_b64 s[58:59], s[58:59], s[62:63]
  s_and_b64 s[56:57], s[56:57], s[58:59]
  s_and_b32 s56, s56, s57
  s_add_u32 s42, s42, 1
  s_cmp_eq_u32 s56, 1
  s_cbranch_scc1 SP_F1c_OK
  s_cmp_lt_u32 s42, 2097152
  s_cbranch_scc1 SP_F1c
SP_F1c_OK:
  s_barrier
  s_mov_b32 exec_hi, 0
  s_movk_i32 s40, 2304
  buffer_load_dword v31, v22, s[8:11], s40 offen
  s_mov_b32 exec_hi, -1
  s_add_u32 s75, s75, 3072
  s_add_u32 s74, s75, 0
  s_mov_b32 s42, 0
SP_FKa:
  s_load_dwordx16 s[56:71], s[72:73], s74 glc
  s_waitcnt lgkmcnt(0)
  s_and_b64 s[56:57], s[56:57], s[64:65]
  s_and_b64 s[58:59], s[58:59], s[66:67]
  s_and_b64 s[60:61], s[60:61], s[68:69]
  s_and_b64 s[62:63], s[62:63], s[70:71]
  s_and_b64 s[56:57], s[56:57], s[60:61]
  s_and_b64 s[58:59], s[58:59], s[62:63]
  s_and_b64 s[56:57], s[56:57], s[58:59]
  s_and_b32 s56, s56, s57
  s_add_u32 s42, s42, 1
  s_cmp_eq_u32 s56, 1
  s_cbranch_scc1 SP_FKa_OK
  s_cmp_lt_u32 s42, 2097152
  s_cbranch_scc1 SP_FKa
SP_FKa_OK:
  s_add_u32 s74, s75, 64
  s_mov_b32 s42, 0
SP_FKb:
  s_load_dwordx16 s[56:71], s[72:73], s74 glc
  s_waitcnt lgkmcnt(0)
  s_and_b64 s[56:57], s[56:57], s[64:65]
  s_and_b64 s[58:59], s[58:59], s[66:67]
  s_and_b64 s[60:61], s[60:61], s[68:69]
  s_and_b64 s[62:63], s[62:63], s[70:71]
  s_and_b64 s[56:57], s[56:57], s[60:61]
  s_and_b64 s[58:59], s[58:59], s[62:63]
  s_and_b64 s[56:57], s[56:57], s[58:59]
  s_and_b32 s56, s56, s57
  s_add_u32 s42, s42, 1
  s_cmp_eq_u32 s56, 1
  s_cbranch_scc1 SP_FKb_OK
  s_cmp_lt_u32 s42, 2097152
  s_cbranch_scc1 SP_FKb
SP_FKb_OK:
  s_barrier
  s_mov_b32 exec_hi, 0
  s_movk_i32 s40, 2560
  buffer_load_dword v28, v22, s[8:11], s40 offen
  s_mov_b32 exec_hi, -1
  s_barrier
  s_mov_b32 exec_hi, 0
  s_movk_i32 s40, 2816
  buffer_load_dword v29, v22, s[8:11], s40 offen
  s_mov_b32 exec_hi, -1
  s_barrier
  s_mov_b32 exec_hi, 0
  s_movk_i32 s40, 3072
  buffer_load_dword v30, v22, s[8:11], s40 offen
  s_mov_b32 exec_hi, -1
  s_barrier
  s_mov_b32 exec_hi, 0
  s_movk_i32 s40, 3328
  buffer_load_dword v31, v22, s[8:11], s40 offen
  s_mov_b32 exec_hi, -1
  s_barrier
  s_mov_b32 exec_hi, 0
  s_movk_i32 s40, 3584
  buffer_load_dword v28, v22, s[8:11], s40 offen
  s_mov_b32 exec_hi, -1
  s_barrier
  s_mov_b32 exec_hi, 0
  s_movk_i32 s40, 3840
  buffer_load_dword v29, v22, s[8:11], s40 offen
  s_mov_b32 exec_hi, -1
  s_barrier
  s_barrier
  s_barrier
  s_barrier
  s_barrier
  s_barrier
  s_barrier
  s_barrier
  s_barrier
  s_mov_b32 exec_lo, 0x6
  s_mov_b32 exec_hi, 0x0
  buffer_store_dword v10, v8, s[16:19], 0 offen sc1
  s_mov_b64 exec, s[52:53]
  s_lshl_b32 s40, s32, 5
  s_add_u32 s75, s40, 17041408
  s_add_u32 s40, s40, 17041408
  v_lshlrev_b32 v6, 2, v1
  v_add_u32 v12, s40, v6
  s_add_u32 s74, s75, 0
  s_mov_b32 s42, 0
SP_F2B:
  s_load_dwordx8 s[56:63], s[72:73], s74 glc
  s_waitcnt lgkmcnt(0)
  s_and_b64 s[56:57], s[56:57], s[60:61]
  s_and_b64 s[58:59], s[58:59], s[62:63]
  s_and_b64 s[56:57], s[56:57], s[58:59]
  s_and_b32 s56, s56, s57
  s_add_u32 s42, s42, 1
  s_cmp_eq_u32 s56, 1
  s_cbranch_scc1 SP_F2B_OK
  s_cmp_lt_u32 s42, 2097152
  s_cbranch_scc1 SP_F2B
SP_F2B_OK:
  s_barrier
  s_lshl_b32 s40, s33, 7
  s_add_u32 s75, s40, 17040384
  s_add_u32 s40, s40, 17040384
  v_add_u32 v11, s40, v6
  s_barrier
  s_add_u32 s74, s75, 0
  s_mov_b32 s42, 0
SP_F2Aa:
  s_load_dwordx16 s[56:71], s[72:73], s74 glc
  s_waitcnt lgkmcnt(0)
  s_and_b64 s[56:57], s[56:57], s[64:65]
  s_and_b64 s[58:59], s[58:59], s[66:67]
  s_and_b64 s[60:61], s[60:61], s[68:69]
  s_and_b64 s[62:63], s[62:63], s[70:71]
  s_and_b64 s[56:57], s[56:57], s[60:61]
  s_and_b64 s[58:59], s[58:59], s[62:63]
  s_and_b64 s[56:57], s[56:57], s[58:59]
  s_and_b32 s56, s56, s57
  s_add_u32 s42, s42, 1
  s_cmp_eq_u32 s56, 1
  s_cbranch_scc1 SP_F2Aa_OK
  s_cmp_lt_u32 s42, 2097152
  s_cbranch_scc1 SP_F2Aa
SP_F2Aa_OK:
  s_add_u32 s74, s75, 64
  s_mov_b32 s42, 0
SP_F2Ab:
  s_load_dwordx16 s[56:71], s[72:73], s74 glc
  s_waitcnt lgkmcnt(0)
  s_and_b64 s[56:57], s[56:57], s[64:65]
  s_and_b64 s[58:59], s[58:59], s[66:67]
  s_and_b64 s[60:61], s[60:61], s[68:69]
  s_and_b64 s[62:63], s[62:63], s[70:71]
  s_and_b64 s[56:57], s[56:57], s[60:61]
  s_and_b64 s[58:59], s[58:59], s[62:63]
  s_and_b64 s[56:57], s[56:57], s[58:59]
  s_and_b32 s56, s56, s57
  s_add_u32 s42, s42, 1
  s_cmp_eq_u32 s56, 1
  s_cbranch_scc1 SP_F2Ab_OK
  s_cmp_lt_u32 s42, 2097152
  s_cbranch_scc1 SP_F2Ab
SP_F2Ab_OK:
  s_barrier
  s_barrier
  s_barrier
  s_barrier
  s_barrier
  s_endpgm
K1_END:
  s_endpgm

.section .rodata,"a"
.p2align 6
.amdhsa_kernel recurrent_scan__ssm_conv_h3__mixer_gmlp__prompt_kernel
  .amdhsa_next_free_vgpr 168
  .amdhsa_next_free_sgpr 96
  .amdhsa_accum_offset 168
  .amdhsa_group_segment_fixed_size 0
  .amdhsa_kernarg_size 112
  .amdhsa_user_sgpr_count 2
  .amdhsa_user_sgpr_kernarg_segment_ptr 1
  .amdhsa_system_sgpr_workgroup_id_x 1
  .amdhsa_float_denorm_mode_32 3
.end_amdhsa_kernel
.text
```

```asm
; @launch grid=(256,1,1) block=(768,1,1) lds=159744
.amdgcn_target "amdgcn-amd-amdhsa--gfx950"
.text
.globl recurrent_scan__ssm_conv_h3__mixer_gmlp__prompt_kernel
.p2align 8
.type recurrent_scan__ssm_conv_h3__mixer_gmlp__prompt_kernel,@function
recurrent_scan__ssm_conv_h3__mixer_gmlp__prompt_kernel:
  s_cmp_ge_u32 s2, 256
  s_cbranch_scc1 K1_END
  s_load_dwordx4 s[56:59], s[0:1], 0
  s_load_dwordx4 s[60:63], s[0:1], 16
  s_load_dwordx2 s[64:65], s[0:1], 56
  s_load_dwordx2 s[66:67], s[0:1], 80
  s_load_dwordx4 s[68:71], s[0:1], 96
  s_load_dwordx2 s[74:75], s[0:1], 64
  s_load_dwordx2 s[76:77], s[0:1], 32
  v_and_b32 v1, 63, v0
  v_lshrrev_b32 v14, 6, v0
  v_lshrrev_b32 v2, 4, v1
  v_readfirstlane_b32 s34, v14
  v_and_b32 v3, 15, v1
  s_and_b32 s40, s2, 7
  s_lshr_b32 s41, s2, 3
  s_lshr_b32 s32, s40, 1
  s_lshl_b32 s32, s32, 3
  s_lshr_b32 s42, s41, 2
  s_add_u32 s32, s32, s42
  s_and_b32 s33, s40, 1
  s_lshl_b32 s33, s33, 2
  s_and_b32 s42, s41, 3
  s_add_u32 s33, s33, s42
  s_and_b32 s55, s34, 3
  s_lshr_b32 s35, s55, 1
  s_and_b32 s36, s55, 1
  s_mov_b32 s47, 0xffff0000
  s_mov_b64 s[52:53], exec
  s_mul_i32 s44, s33, 192
  s_add_u32 s43, s44, 1536
  s_cmp_ge_u32 s34, 8
  s_cbranch_scc0 K1_AB
  s_lshl_b32 s40, s32, 6
  s_lshl_b32 s41, s55, 3
  s_add_u32 s40, s40, s41
  s_lshl_b32 s45, s55, 10
  v_lshrrev_b32 v30, 3, v1
  v_add_u32 v32, s41, v30
  v_lshrrev_b32 v31, 1, v32
  v_xor_b32 v31, v31, v1
  v_and_b32 v31, 7, v31
  v_lshlrev_b32 v31, 4, v31
  v_add_u32 v30, s40, v30
  v_mul_u32_u24 v30, 1280, v30
  v_add_u32 v8, v30, v31
  v_add_u32 v9, 40960, v8
  s_waitcnt lgkmcnt(0)
  s_mov_b32 s8, s56
  s_and_b32 s9, s57, 0xffff
  s_mov_b32 s10, 2621440
  s_mov_b32 s11, 0x20000
  s_mov_b32 s12, s64
  s_and_b32 s13, s65, 0xffff
  s_mov_b32 s14, 1966080
  s_mov_b32 s15, 0x20000
  s_and_b32 s40, s32, 7
  s_and_b32 s41, s33, 3
  s_mul_i32 s41, s41, 3
  s_add_u32 s37, s40, s41
  s_sub_u32 s40, s37, 10
  s_cmp_ge_u32 s37, 10
  s_cselect_b32 s37, s40, s37
  s_lshl_b32 s40, s55, 6
  s_add_u32 s40, s40, 0
  v_add_u32 v30, s40, v1
  v_mul_u32_u24 v31, 5462, v30
  v_lshrrev_b32 v31, 16, v31
  v_mul_u32_u24 v32, 12, v31
  v_sub_u32 v32, v30, v32
  v_lshrrev_b32 v33, 2, v31
  v_and_b32 v33, 2, v33
  v_xor_b32 v32, v32, v33
  v_lshlrev_b32 v32, 4, v32
  v_mul_u32_u24 v31, 3072, v31
  v_add_u32 v12, v31, v32
  s_lshl_b32 s40, s55, 6
  s_add_u32 s40, s40, 256
  v_add_u32 v30, s40, v1
  v_mul_u32_u24 v31, 5462, v30
  v_lshrrev_b32 v31, 16, v31
  v_mul_u32_u24 v32, 12, v31
  v_sub_u32 v32, v30, v32
  v_lshrrev_b32 v33, 2, v31
  v_and_b32 v33, 2, v33
  v_xor_b32 v32, v32, v33
  v_lshlrev_b32 v32, 4, v32
  v_mul_u32_u24 v31, 3072, v31
  v_add_u32 v13, v31, v32
  s_lshl_b32 s40, s55, 6
  s_add_u32 s40, s40, 512
  v_add_u32 v30, s40, v1
  v_mul_u32_u24 v31, 5462, v30
  v_lshrrev_b32 v31, 16, v31
  v_mul_u32_u24 v32, 12, v31
  v_sub_u32 v32, v30, v32
  v_lshrrev_b32 v33, 2, v31
  v_and_b32 v33, 2, v33
  v_xor_b32 v32, v32, v33
  v_lshlrev_b32 v32, 4, v32
  v_mul_u32_u24 v31, 3072, v31
  v_add_u32 v14, v31, v32
  s_add_u32 s38, s37, 0
  s_sub_u32 s40, s38, 10
  s_cmp_ge_u32 s38, 10
  s_cselect_b32 s38, s40, s38
  s_lshl_b32 s38, s38, 7
  s_add_u32 m0, s45, 61440
  s_nop 0
  buffer_load_dwordx4 v8, s[8:11], s38 offen  lds
  s_add_u32 m0, s45, 65536
  s_nop 0
  buffer_load_dwordx4 v9, s[8:11], s38 offen  lds
  s_add_u32 s39, s37, 0
  s_sub_u32 s40, s39, 10
  s_cmp_ge_u32 s39, 10
  s_cselect_b32 s39, s40, s39
  s_mul_i32 s39, s39, 196608
  s_add_u32 s39, s39, s43
  s_add_u32 m0, s45, 0
  s_nop 0
  buffer_load_dwordx4 v12, s[12:15], s39 offen  lds
  s_add_u32 m0, s45, 4096
  s_nop 0
  buffer_load_dwordx4 v13, s[12:15], s39 offen  lds
  s_add_u32 m0, s45, 8192
  s_nop 0
  buffer_load_dwordx4 v14, s[12:15], s39 offen  lds
  s_add_u32 s38, s37, 1
  s_sub_u32 s40, s38, 10
  s_cmp_ge_u32 s38, 10
  s_cselect_b32 s38, s40, s38
  s_lshl_b32 s38, s38, 7
  s_add_u32 m0, s45, 69632
  s_nop 0
  buffer_load_dwordx4 v8, s[8:11], s38 offen  lds
  s_add_u32 m0, s45, 73728
  s_nop 0
  buffer_load_dwordx4 v9, s[8:11], s38 offen  lds
  s_add_u32 s39, s37, 1
  s_sub_u32 s40, s39, 10
  s_cmp_ge_u32 s39, 10
  s_cselect_b32 s39, s40, s39
  s_mul_i32 s39, s39, 196608
  s_add_u32 s39, s39, s43
  s_add_u32 m0, s45, 12288
  s_nop 0
  buffer_load_dwordx4 v12, s[12:15], s39 offen  lds
  s_add_u32 m0, s45, 16384
  s_nop 0
  buffer_load_dwordx4 v13, s[12:15], s39 offen  lds
  s_add_u32 m0, s45, 20480
  s_nop 0
  buffer_load_dwordx4 v14, s[12:15], s39 offen  lds
  s_waitcnt vmcnt(5)
  s_barrier
  s_add_u32 s38, s37, 2
  s_sub_u32 s40, s38, 10
  s_cmp_ge_u32 s38, 10
  s_cselect_b32 s38, s40, s38
  s_lshl_b32 s38, s38, 7
  s_add_u32 m0, s45, 77824
  s_nop 0
  buffer_load_dwordx4 v8, s[8:11], s38 offen  lds
  s_add_u32 m0, s45, 81920
  s_nop 0
  buffer_load_dwordx4 v9, s[8:11], s38 offen  lds
  s_add_u32 s39, s37, 2
  s_sub_u32 s40, s39, 10
  s_cmp_ge_u32 s39, 10
  s_cselect_b32 s39, s40, s39
  s_mul_i32 s39, s39, 196608
  s_add_u32 s39, s39, s43
  s_add_u32 m0, s45, 24576
  s_nop 0
  buffer_load_dwordx4 v12, s[12:15], s39 offen  lds
  s_add_u32 m0, s45, 28672
  s_nop 0
  buffer_load_dwordx4 v13, s[12:15], s39 offen  lds
  s_add_u32 m0, s45, 32768
  s_nop 0
  buffer_load_dwordx4 v14, s[12:15], s39 offen  lds
  s_add_u32 s38, s37, 3
  s_sub_u32 s40, s38, 10
  s_cmp_ge_u32 s38, 10
  s_cselect_b32 s38, s40, s38
  s_lshl_b32 s38, s38, 7
  s_add_u32 m0, s45, 86016
  s_nop 0
  buffer_load_dwordx4 v8, s[8:11], s38 offen  lds
  s_add_u32 m0, s45, 90112
  s_nop 0
  buffer_load_dwordx4 v9, s[8:11], s38 offen  lds
  s_add_u32 s39, s37, 3
  s_sub_u32 s40, s39, 10
  s_cmp_ge_u32 s39, 10
  s_cselect_b32 s39, s40, s39
  s_mul_i32 s39, s39, 196608
  s_add_u32 s39, s39, s43
  s_add_u32 m0, s45, 36864
  s_nop 0
  buffer_load_dwordx4 v12, s[12:15], s39 offen  lds
  s_add_u32 m0, s45, 40960
  s_nop 0
  buffer_load_dwordx4 v13, s[12:15], s39 offen  lds
  s_add_u32 m0, s45, 45056
  s_nop 0
  buffer_load_dwordx4 v14, s[12:15], s39 offen  lds
  s_waitcnt vmcnt(10)
  s_barrier
  s_add_u32 s38, s37, 4
  s_sub_u32 s40, s38, 10
  s_cmp_ge_u32 s38, 10
  s_cselect_b32 s38, s40, s38
  s_lshl_b32 s38, s38, 7
  s_add_u32 m0, s45, 94208
  s_nop 0
  buffer_load_dwordx4 v8, s[8:11], s38 offen  lds
  s_add_u32 m0, s45, 98304
  s_nop 0
  buffer_load_dwordx4 v9, s[8:11], s38 offen  lds
  s_add_u32 s39, s37, 4
  s_sub_u32 s40, s39, 10
  s_cmp_ge_u32 s39, 10
  s_cselect_b32 s39, s40, s39
  s_mul_i32 s39, s39, 196608
  s_add_u32 s39, s39, s43
  s_add_u32 m0, s45, 49152
  s_nop 0
  buffer_load_dwordx4 v12, s[12:15], s39 offen  lds
  s_add_u32 m0, s45, 53248
  s_nop 0
  buffer_load_dwordx4 v13, s[12:15], s39 offen  lds
  s_add_u32 m0, s45, 57344
  s_nop 0
  buffer_load_dwordx4 v14, s[12:15], s39 offen  lds
  s_add_u32 s38, s37, 5
  s_sub_u32 s40, s38, 10
  s_cmp_ge_u32 s38, 10
  s_cselect_b32 s38, s40, s38
  s_lshl_b32 s38, s38, 7
  s_add_u32 m0, s45, 102400
  s_nop 0
  buffer_load_dwordx4 v8, s[8:11], s38 offen  lds
  s_add_u32 m0, s45, 106496
  s_nop 0
  buffer_load_dwordx4 v9, s[8:11], s38 offen  lds
  s_waitcnt vmcnt(12)
  s_barrier
  s_add_u32 s38, s37, 6
  s_sub_u32 s40, s38, 10
  s_cmp_ge_u32 s38, 10
  s_cselect_b32 s38, s40, s38
  s_lshl_b32 s38, s38, 7
  s_add_u32 m0, s45, 110592
  s_nop 0
  buffer_load_dwordx4 v8, s[8:11], s38 offen  lds
  s_add_u32 m0, s45, 114688
  s_nop 0
  buffer_load_dwordx4 v9, s[8:11], s38 offen  lds
  s_add_u32 s39, s37, 5
  s_sub_u32 s40, s39, 10
  s_cmp_ge_u32 s39, 10
  s_cselect_b32 s39, s40, s39
  s_mul_i32 s39, s39, 196608
  s_add_u32 s39, s39, s43
  s_add_u32 m0, s45, 0
  s_nop 0
  buffer_load_dwordx4 v12, s[12:15], s39 offen  lds
  s_add_u32 m0, s45, 4096
  s_nop 0
  buffer_load_dwordx4 v13, s[12:15], s39 offen  lds
  s_add_u32 m0, s45, 8192
  s_nop 0
  buffer_load_dwordx4 v14, s[12:15], s39 offen  lds
  s_add_u32 s38, s37, 7
  s_sub_u32 s40, s38, 10
  s_cmp_ge_u32 s38, 10
  s_cselect_b32 s38, s40, s38
  s_lshl_b32 s38, s38, 7
  s_add_u32 m0, s45, 118784
  s_nop 0
  buffer_load_dwordx4 v8, s[8:11], s38 offen  lds
  s_add_u32 m0, s45, 122880
  s_nop 0
  buffer_load_dwordx4 v9, s[8:11], s38 offen  lds
  s_waitcnt vmcnt(14)
  s_barrier
  s_add_u32 s38, s37, 8
  s_sub_u32 s40, s38, 10
  s_cmp_ge_u32 s38, 10
  s_cselect_b32 s38, s40, s38
  s_lshl_b32 s38, s38, 7
  s_add_u32 m0, s45, 126976
  s_nop 0
  buffer_load_dwordx4 v8, s[8:11], s38 offen  lds
  s_add_u32 m0, s45, 131072
  s_nop 0
  buffer_load_dwordx4 v9, s[8:11], s38 offen  lds
  s_add_u32 s39, s37, 6
  s_sub_u32 s40, s39, 10
  s_cmp_ge_u32 s39, 10
  s_cselect_b32 s39, s40, s39
  s_mul_i32 s39, s39, 196608
  s_add_u32 s39, s39, s43
  s_add_u32 m0, s45, 12288
  s_nop 0
  buffer_load_dwordx4 v12, s[12:15], s39 offen  lds
  s_add_u32 m0, s45, 16384
  s_nop 0
  buffer_load_dwordx4 v13, s[12:15], s39 offen  lds
  s_add_u32 m0, s45, 20480
  s_nop 0
  buffer_load_dwordx4 v14, s[12:15], s39 offen  lds
  s_add_u32 s38, s37, 9
  s_sub_u32 s40, s38, 10
  s_cmp_ge_u32 s38, 10
  s_cselect_b32 s38, s40, s38
  s_lshl_b32 s38, s38, 7
  s_add_u32 m0, s45, 135168
  s_nop 0
  buffer_load_dwordx4 v8, s[8:11], s38 offen  lds
  s_add_u32 m0, s45, 139264
  s_nop 0
  buffer_load_dwordx4 v9, s[8:11], s38 offen  lds
  s_waitcnt vmcnt(16)
  s_barrier
  s_add_u32 s39, s37, 7
  s_sub_u32 s40, s39, 10
  s_cmp_ge_u32 s39, 10
  s_cselect_b32 s39, s40, s39
  s_mul_i32 s39, s39, 196608
  s_add_u32 s39, s39, s43
  s_add_u32 m0, s45, 24576
  s_nop 0
  buffer_load_dwordx4 v12, s[12:15], s39 offen  lds
  s_add_u32 m0, s45, 28672
  s_nop 0
  buffer_load_dwordx4 v13, s[12:15], s39 offen  lds
  s_add_u32 m0, s45, 32768
  s_nop 0
  buffer_load_dwordx4 v14, s[12:15], s39 offen  lds
  s_waitcnt vmcnt(12)
  s_barrier
  s_add_u32 s39, s37, 8
  s_sub_u32 s40, s39, 10
  s_cmp_ge_u32 s39, 10
  s_cselect_b32 s39, s40, s39
  s_mul_i32 s39, s39, 196608
  s_add_u32 s39, s39, s43
  s_add_u32 m0, s45, 36864
  s_nop 0
  buffer_load_dwordx4 v12, s[12:15], s39 offen  lds
  s_add_u32 m0, s45, 40960
  s_nop 0
  buffer_load_dwordx4 v13, s[12:15], s39 offen  lds
  s_add_u32 m0, s45, 45056
  s_nop 0
  buffer_load_dwordx4 v14, s[12:15], s39 offen  lds
  s_add_u32 s39, s37, 9
  s_sub_u32 s40, s39, 10
  s_cmp_ge_u32 s39, 10
  s_cselect_b32 s39, s40, s39
  s_mul_i32 s39, s39, 196608
  s_add_u32 s39, s39, s43
  s_add_u32 m0, s45, 49152
  s_nop 0
  buffer_load_dwordx4 v12, s[12:15], s39 offen  lds
  s_add_u32 m0, s45, 53248
  s_nop 0
  buffer_load_dwordx4 v13, s[12:15], s39 offen  lds
  s_add_u32 m0, s45, 57344
  s_nop 0
  buffer_load_dwordx4 v14, s[12:15], s39 offen  lds
  s_waitcnt vmcnt(11)
  s_barrier
  s_add_u32 s39, s37, 0
  s_sub_u32 s40, s39, 10
  s_cmp_ge_u32 s39, 10
  s_cselect_b32 s39, s40, s39
  s_mul_i32 s39, s39, 196608
  s_add_u32 s39, s39, s44
  s_add_u32 m0, s45, 0
  s_nop 0
  buffer_load_dwordx4 v12, s[12:15], s39 offen  lds
  s_add_u32 m0, s45, 4096
  s_nop 0
  buffer_load_dwordx4 v13, s[12:15], s39 offen  lds
  s_add_u32 m0, s45, 8192
  s_nop 0
  buffer_load_dwordx4 v14, s[12:15], s39 offen  lds
  s_waitcnt vmcnt(9)
  s_barrier
  s_add_u32 s39, s37, 1
  s_sub_u32 s40, s39, 10
  s_cmp_ge_u32 s39, 10
  s_cselect_b32 s39, s40, s39
  s_mul_i32 s39, s39, 196608
  s_add_u32 s39, s39, s44
  s_add_u32 m0, s45, 12288
  s_nop 0
  buffer_load_dwordx4 v12, s[12:15], s39 offen  lds
  s_add_u32 m0, s45, 16384
  s_nop 0
  buffer_load_dwordx4 v13, s[12:15], s39 offen  lds
  s_add_u32 m0, s45, 20480
  s_nop 0
  buffer_load_dwordx4 v14, s[12:15], s39 offen  lds
  s_waitcnt vmcnt(9)
  s_barrier
  s_add_u32 s39, s37, 2
  s_sub_u32 s40, s39, 10
  s_cmp_ge_u32 s39, 10
  s_cselect_b32 s39, s40, s39
  s_mul_i32 s39, s39, 196608
  s_add_u32 s39, s39, s44
  s_add_u32 m0, s45, 24576
  s_nop 0
  buffer_load_dwordx4 v12, s[12:15], s39 offen  lds
  s_add_u32 m0, s45, 28672
  s_nop 0
  buffer_load_dwordx4 v13, s[12:15], s39 offen  lds
  s_add_u32 m0, s45, 32768
  s_nop 0
  buffer_load_dwordx4 v14, s[12:15], s39 offen  lds
  s_waitcnt vmcnt(9)
  s_barrier
  s_add_u32 s39, s37, 3
  s_sub_u32 s40, s39, 10
  s_cmp_ge_u32 s39, 10
  s_cselect_b32 s39, s40, s39
  s_mul_i32 s39, s39, 196608
  s_add_u32 s39, s39, s44
  s_add_u32 m0, s45, 36864
  s_nop 0
  buffer_load_dwordx4 v12, s[12:15], s39 offen  lds
  s_add_u32 m0, s45, 40960
  s_nop 0
  buffer_load_dwordx4 v13, s[12:15], s39 offen  lds
  s_add_u32 m0, s45, 45056
  s_nop 0
  buffer_load_dwordx4 v14, s[12:15], s39 offen  lds
  s_waitcnt vmcnt(9)
  s_barrier
  s_add_u32 s39, s37, 4
  s_sub_u32 s40, s39, 10
  s_cmp_ge_u32 s39, 10
  s_cselect_b32 s39, s40, s39
  s_mul_i32 s39, s39, 196608
  s_add_u32 s39, s39, s44
  s_add_u32 m0, s45, 49152
  s_nop 0
  buffer_load_dwordx4 v12, s[12:15], s39 offen  lds
  s_add_u32 m0, s45, 53248
  s_nop 0
  buffer_load_dwordx4 v13, s[12:15], s39 offen  lds
  s_add_u32 m0, s45, 57344
  s_nop 0
  buffer_load_dwordx4 v14, s[12:15], s39 offen  lds
  v_mul_u32_u24 v5, 6554, v1
  v_lshrrev_b32 v5, 16, v5
  v_mul_u32_u24 v4, 10, v5
  v_sub_u32 v4, v1, v4
  v_lshlrev_b32 v4, 4, v4
  v_mul_u32_u24 v30, 1280, v5
  v_add_u32 v4, v4, v30
  s_mov_b32 s20, s58
  s_and_b32 s21, s59, 0xffff
  s_mov_b32 s22, 2621440
  s_mov_b32 s23, 0x20000
  s_mov_b32 s24, s60
  s_and_b32 s25, s61, 0xffff
  s_mov_b32 s26, 2621440
  s_mov_b32 s27, 0x20000
  s_lshl_b32 s40, s32, 6
  s_lshl_b32 s41, s55, 4
  s_add_u32 s40, s40, s41
  s_mul_i32 s46, s40, 1280
  s_mul_i32 s41, s33, 160
  s_add_u32 s46, s46, s41
  s_mul_i32 s78, s55, 6720
  s_add_u32 s78, s78, 61440
  v_mov_b32 v20, v4
  s_sub_u32 s79, s46, 3840
  s_cmp_eq_u32 s40, 0
  s_cbranch_scc0 K1_NONNEG
  v_subrev_u32 v20, 3840, v4
  v_cmp_gt_u32 vcc, 3, v5
  v_mov_b32 v31, 0x80000000
  s_nop 0
  v_cndmask_b32 v20, v20, v31, vcc
  s_mov_b32 s79, s46
K1_NONNEG:
  s_mov_b32 s28, s62
  s_and_b32 s29, s63, 0xffff
  s_mov_b32 s30, 5120
  s_mov_b32 s31, 0x20000
  v_lshlrev_b32 v21, 4, v1
  s_mul_i32 s54, s33, 640
  s_waitcnt vmcnt(9)
  s_barrier
  s_add_u32 s39, s37, 5
  s_sub_u32 s40, s39, 10
  s_cmp_ge_u32 s39, 10
  s_cselect_b32 s39, s40, s39
  s_mul_i32 s39, s39, 196608
  s_add_u32 s39, s39, s44
  s_add_u32 m0, s45, 0
  s_nop 0
  buffer_load_dwordx4 v12, s[12:15], s39 offen  lds
  s_add_u32 m0, s45, 4096
  s_nop 0
  buffer_load_dwordx4 v13, s[12:15], s39 offen  lds
  s_add_u32 m0, s45, 8192
  s_nop 0
  buffer_load_dwordx4 v14, s[12:15], s39 offen  lds
  s_waitcnt vmcnt(9)
  s_barrier
  s_add_u32 s39, s37, 6
  s_sub_u32 s40, s39, 10
  s_cmp_ge_u32 s39, 10
  s_cselect_b32 s39, s40, s39
  s_mul_i32 s39, s39, 196608
  s_add_u32 s39, s39, s44
  s_add_u32 m0, s45, 12288
  s_nop 0
  buffer_load_dwordx4 v12, s[12:15], s39 offen  lds
  s_add_u32 m0, s45, 16384
  s_nop 0
  buffer_load_dwordx4 v13, s[12:15], s39 offen  lds
  s_add_u32 m0, s45, 20480
  s_nop 0
  buffer_load_dwordx4 v14, s[12:15], s39 offen  lds
  s_waitcnt vmcnt(9)
  s_barrier
  s_add_u32 s39, s37, 7
  s_sub_u32 s40, s39, 10
  s_cmp_ge_u32 s39, 10
  s_cselect_b32 s39, s40, s39
  s_mul_i32 s39, s39, 196608
  s_add_u32 s39, s39, s44
  s_add_u32 m0, s45, 24576
  s_nop 0
  buffer_load_dwordx4 v12, s[12:15], s39 offen  lds
  s_add_u32 m0, s45, 28672
  s_nop 0
  buffer_load_dwordx4 v13, s[12:15], s39 offen  lds
  s_add_u32 m0, s45, 32768
  s_nop 0
  buffer_load_dwordx4 v14, s[12:15], s39 offen  lds
  s_waitcnt vmcnt(9)
  s_barrier
  s_add_u32 s39, s37, 8
  s_sub_u32 s40, s39, 10
  s_cmp_ge_u32 s39, 10
  s_cselect_b32 s39, s40, s39
  s_mul_i32 s39, s39, 196608
  s_add_u32 s39, s39, s44
  s_add_u32 m0, s45, 36864
  s_nop 0
  buffer_load_dwordx4 v12, s[12:15], s39 offen  lds
  s_add_u32 m0, s45, 40960
  s_nop 0
  buffer_load_dwordx4 v13, s[12:15], s39 offen  lds
  s_add_u32 m0, s45, 45056
  s_nop 0
  buffer_load_dwordx4 v14, s[12:15], s39 offen  lds
  s_waitcnt vmcnt(9)
  s_barrier
  s_add_u32 s39, s37, 9
  s_sub_u32 s40, s39, 10
  s_cmp_ge_u32 s39, 10
  s_cselect_b32 s39, s40, s39
  s_mul_i32 s39, s39, 196608
  s_add_u32 s39, s39, s44
  s_add_u32 m0, s45, 49152
  s_nop 0
  buffer_load_dwordx4 v12, s[12:15], s39 offen  lds
  s_add_u32 m0, s45, 53248
  s_nop 0
  buffer_load_dwordx4 v13, s[12:15], s39 offen  lds
  s_add_u32 m0, s45, 57344
  s_nop 0
  buffer_load_dwordx4 v14, s[12:15], s39 offen  lds
  s_mov_b32 exec_lo, 0xffffffff
  s_mov_b32 exec_hi, 0xfffffff
  s_add_u32 m0, s78, 0
  s_nop 0
  buffer_load_dwordx4 v20, s[20:23], s79 offen  lds
  s_add_u32 m0, s78, 960
  s_add_u32 s79, s46, 3840
  buffer_load_dwordx4 v4, s[20:23], s79 offen  lds
  s_add_u32 m0, s78, 1920
  s_add_u32 s79, s46, 11520
  buffer_load_dwordx4 v4, s[20:23], s79 offen  lds
  s_add_u32 m0, s78, 2880
  s_add_u32 s79, s46, 19200
  buffer_load_dwordx4 v4, s[20:23], s79 offen  lds
  s_add_u32 m0, s78, 3840
  s_add_u32 s79, s46, 0
  buffer_load_dwordx4 v4, s[24:27], s79 offen  lds
  s_add_u32 m0, s78, 4800
  s_add_u32 s79, s46, 7680
  buffer_load_dwordx4 v4, s[24:27], s79 offen  lds
  s_add_u32 m0, s78, 5760
  s_add_u32 s79, s46, 15360
  buffer_load_dwordx4 v4, s[24:27], s79 offen  lds
  s_mov_b64 exec, s[52:53]
  buffer_load_dwordx4 v[156:159], v21, s[28:31], s54 offen
  s_waitcnt vmcnt(17)
  s_barrier
  s_waitcnt vmcnt(14)
  s_barrier
  s_waitcnt vmcnt(11)
  s_barrier
  s_waitcnt vmcnt(8)
  s_barrier
  s_waitcnt vmcnt(0)
  v_lshlrev_b32 v30, 2, v1
  v_min_u32 v30, 156, v30
  v_add_u32 v30, s78, v30
  ds_read_b32 v40, v30 offset:0
  ds_read_b32 v41, v30 offset:160
  ds_read_b32 v42, v30 offset:320
  ds_read_b32 v43, v30 offset:480
  ds_read_b32 v44, v30 offset:640
  ds_read_b32 v45, v30 offset:800
  ds_read_b32 v46, v30 offset:960
  ds_read_b32 v47, v30 offset:1120
  ds_read_b32 v48, v30 offset:1280
  ds_read_b32 v49, v30 offset:1440
  ds_read_b32 v50, v30 offset:1600
  ds_read_b32 v51, v30 offset:1760
  ds_read_b32 v52, v30 offset:1920
  ds_read_b32 v53, v30 offset:2080
  s_waitcnt lgkmcnt(6)
  ds_read_b32 v54, v30 offset:2240
  ds_read_b32 v55, v30 offset:2400
  ds_read_b32 v56, v30 offset:2560
  ds_read_b32 v57, v30 offset:2720
  ds_read_b32 v58, v30 offset:2880
  s_barrier
  ds_read_b32 v59, v30 offset:3840
  ds_read_b32 v60, v30 offset:4000
  s_waitcnt lgkmcnt(6)
  ds_read_b32 v61, v30 offset:4160
  ds_read_b32 v62, v30 offset:4320
  ds_read_b32 v63, v30 offset:4480
  ds_read_b32 v64, v30 offset:4640
  ds_read_b32 v65, v30 offset:4800
  ds_read_b32 v66, v30 offset:4960
  ds_read_b32 v67, v30 offset:5120
  ds_read_b32 v68, v30 offset:5280
  s_waitcnt lgkmcnt(6)
  ds_read_b32 v69, v30 offset:5440
  ds_read_b32 v70, v30 offset:5600
  ds_read_b32 v71, v30 offset:5760
  ds_read_b32 v72, v30 offset:5920
  ds_read_b32 v73, v30 offset:6080
  ds_read_b32 v74, v30 offset:6240
  v_lshlrev_b32 v114, 16, v156
  v_lshlrev_b32 v115, 16, v158
  v_and_b32 v116, s47, v156
  v_and_b32 v117, s47, v158
  v_lshlrev_b32 v118, 16, v157
  v_lshlrev_b32 v119, 16, v159
  v_and_b32 v120, s47, v157
  v_and_b32 v121, s47, v159
  s_waitcnt lgkmcnt(0)
  s_barrier
  v_lshlrev_b32 v76, 16, v40
  v_and_b32 v77, s47, v40
  v_lshlrev_b32 v78, 16, v41
  v_and_b32 v79, s47, v41
  v_lshlrev_b32 v80, 16, v42
  v_and_b32 v81, s47, v42
  v_lshlrev_b32 v82, 16, v43
  v_and_b32 v83, s47, v43
  v_lshlrev_b32 v84, 16, v44
  v_and_b32 v85, s47, v44
  v_lshlrev_b32 v86, 16, v45
  v_and_b32 v87, s47, v45
  v_lshlrev_b32 v88, 16, v46
  v_and_b32 v89, s47, v46
  v_lshlrev_b32 v90, 16, v47
  v_and_b32 v91, s47, v47
  v_lshlrev_b32 v92, 16, v48
  v_and_b32 v93, s47, v48
  v_lshlrev_b32 v94, 16, v49
  v_and_b32 v95, s47, v49
  v_lshlrev_b32 v96, 16, v50
  v_and_b32 v97, s47, v50
  v_lshlrev_b32 v98, 16, v51
  v_and_b32 v99, s47, v51
  v_lshlrev_b32 v100, 16, v52
  v_and_b32 v101, s47, v52
  v_lshlrev_b32 v102, 16, v53
  v_and_b32 v103, s47, v53
  v_lshlrev_b32 v104, 16, v54
  v_and_b32 v105, s47, v54
  v_lshlrev_b32 v106, 16, v55
  v_and_b32 v107, s47, v55
  v_lshlrev_b32 v108, 16, v56
  v_and_b32 v109, s47, v56
  v_lshlrev_b32 v110, 16, v57
  v_and_b32 v111, s47, v57
  v_lshlrev_b32 v112, 16, v58
  v_and_b32 v113, s47, v58
  v_pk_mul_f32 v[122:123], v[120:121], v[76:77]
  v_lshlrev_b32 v32, 16, v59
  v_pk_fma_f32 v[122:123], v[118:119], v[78:79], v[122:123]
  v_and_b32 v33, s47, v59
  v_pk_fma_f32 v[122:123], v[116:117], v[80:81], v[122:123]
  v_pk_fma_f32 v[122:123], v[114:115], v[82:83], v[122:123]
  v_pk_mul_f32 v[122:123], v[122:123], v[32:33]
  v_pk_mul_f32 v[124:125], v[120:121], v[78:79]
  v_lshlrev_b32 v32, 16, v60
  v_pk_fma_f32 v[124:125], v[118:119], v[80:81], v[124:125]
  v_and_b32 v33, s47, v60
  v_pk_fma_f32 v[124:125], v[116:117], v[82:83], v[124:125]
  v_pk_fma_f32 v[124:125], v[114:115], v[84:85], v[124:125]
  v_pk_mul_f32 v[124:125], v[124:125], v[32:33]
  v_pk_mul_f32 v[126:127], v[120:121], v[80:81]
  v_lshlrev_b32 v32, 16, v61
  v_pk_fma_f32 v[126:127], v[118:119], v[82:83], v[126:127]
  v_and_b32 v33, s47, v61
  v_pk_fma_f32 v[126:127], v[116:117], v[84:85], v[126:127]
  v_pk_fma_f32 v[126:127], v[114:115], v[86:87], v[126:127]
  v_pk_mul_f32 v[126:127], v[126:127], v[32:33]
  v_pk_mul_f32 v[128:129], v[120:121], v[82:83]
  v_lshlrev_b32 v32, 16, v62
  v_pk_fma_f32 v[128:129], v[118:119], v[84:85], v[128:129]
  v_and_b32 v33, s47, v62
  v_pk_fma_f32 v[128:129], v[116:117], v[86:87], v[128:129]
  v_pk_fma_f32 v[128:129], v[114:115], v[88:89], v[128:129]
  v_pk_mul_f32 v[128:129], v[128:129], v[32:33]
  v_pk_mul_f32 v[130:131], v[120:121], v[84:85]
  v_lshlrev_b32 v32, 16, v63
  v_pk_fma_f32 v[130:131], v[118:119], v[86:87], v[130:131]
  v_and_b32 v33, s47, v63
  v_pk_fma_f32 v[130:131], v[116:117], v[88:89], v[130:131]
  v_pk_fma_f32 v[130:131], v[114:115], v[90:91], v[130:131]
  v_pk_mul_f32 v[130:131], v[130:131], v[32:33]
  v_pk_mul_f32 v[132:133], v[120:121], v[86:87]
  v_lshlrev_b32 v32, 16, v64
  v_pk_fma_f32 v[132:133], v[118:119], v[88:89], v[132:133]
  v_and_b32 v33, s47, v64
  v_pk_fma_f32 v[132:133], v[116:117], v[90:91], v[132:133]
  v_pk_fma_f32 v[132:133], v[114:115], v[92:93], v[132:133]
  v_pk_mul_f32 v[132:133], v[132:133], v[32:33]
  v_pk_mul_f32 v[134:135], v[120:121], v[88:89]
  v_lshlrev_b32 v32, 16, v65
  v_pk_fma_f32 v[134:135], v[118:119], v[90:91], v[134:135]
  v_and_b32 v33, s47, v65
  v_pk_fma_f32 v[134:135], v[116:117], v[92:93], v[134:135]
  v_pk_fma_f32 v[134:135], v[114:115], v[94:95], v[134:135]
  v_pk_mul_f32 v[134:135], v[134:135], v[32:33]
  v_pk_mul_f32 v[136:137], v[120:121], v[90:91]
  v_lshlrev_b32 v32, 16, v66
  v_pk_fma_f32 v[136:137], v[118:119], v[92:93], v[136:137]
  v_and_b32 v33, s47, v66
  v_pk_fma_f32 v[136:137], v[116:117], v[94:95], v[136:137]
  v_pk_fma_f32 v[136:137], v[114:115], v[96:97], v[136:137]
  v_pk_mul_f32 v[136:137], v[136:137], v[32:33]
  v_pk_mul_f32 v[138:139], v[120:121], v[92:93]
  v_lshlrev_b32 v32, 16, v67
  v_pk_fma_f32 v[138:139], v[118:119], v[94:95], v[138:139]
  v_and_b32 v33, s47, v67
  v_pk_fma_f32 v[138:139], v[116:117], v[96:97], v[138:139]
  v_pk_fma_f32 v[138:139], v[114:115], v[98:99], v[138:139]
  v_pk_mul_f32 v[138:139], v[138:139], v[32:33]
  v_pk_mul_f32 v[140:141], v[120:121], v[94:95]
  v_lshlrev_b32 v32, 16, v68
  v_pk_fma_f32 v[140:141], v[118:119], v[96:97], v[140:141]
  v_and_b32 v33, s47, v68
  v_pk_fma_f32 v[140:141], v[116:117], v[98:99], v[140:141]
  v_pk_fma_f32 v[140:141], v[114:115], v[100:101], v[140:141]
  v_pk_mul_f32 v[140:141], v[140:141], v[32:33]
  v_pk_mul_f32 v[142:143], v[120:121], v[96:97]
  v_lshlrev_b32 v32, 16, v69
  v_pk_fma_f32 v[142:143], v[118:119], v[98:99], v[142:143]
  v_and_b32 v33, s47, v69
  v_pk_fma_f32 v[142:143], v[116:117], v[100:101], v[142:143]
  v_pk_fma_f32 v[142:143], v[114:115], v[102:103], v[142:143]
  v_pk_mul_f32 v[142:143], v[142:143], v[32:33]
  v_pk_mul_f32 v[144:145], v[120:121], v[98:99]
  v_lshlrev_b32 v32, 16, v70
  v_pk_fma_f32 v[144:145], v[118:119], v[100:101], v[144:145]
  v_and_b32 v33, s47, v70
  v_pk_fma_f32 v[144:145], v[116:117], v[102:103], v[144:145]
  v_pk_fma_f32 v[144:145], v[114:115], v[104:105], v[144:145]
  v_pk_mul_f32 v[144:145], v[144:145], v[32:33]
  v_pk_mul_f32 v[146:147], v[120:121], v[100:101]
  v_lshlrev_b32 v32, 16, v71
  v_pk_fma_f32 v[146:147], v[118:119], v[102:103], v[146:147]
  v_and_b32 v33, s47, v71
  v_pk_fma_f32 v[146:147], v[116:117], v[104:105], v[146:147]
  v_pk_fma_f32 v[146:147], v[114:115], v[106:107], v[146:147]
  v_pk_mul_f32 v[146:147], v[146:147], v[32:33]
  v_pk_mul_f32 v[148:149], v[120:121], v[102:103]
  v_lshlrev_b32 v32, 16, v72
  v_pk_fma_f32 v[148:149], v[118:119], v[104:105], v[148:149]
  v_and_b32 v33, s47, v72
  v_pk_fma_f32 v[148:149], v[116:117], v[106:107], v[148:149]
  v_pk_fma_f32 v[148:149], v[114:115], v[108:109], v[148:149]
  v_pk_mul_f32 v[148:149], v[148:149], v[32:33]
  v_pk_mul_f32 v[150:151], v[120:121], v[104:105]
  v_lshlrev_b32 v32, 16, v73
  v_pk_fma_f32 v[150:151], v[118:119], v[106:107], v[150:151]
  v_and_b32 v33, s47, v73
  v_pk_fma_f32 v[150:151], v[116:117], v[108:109], v[150:151]
  v_pk_fma_f32 v[150:151], v[114:115], v[110:111], v[150:151]
  v_pk_mul_f32 v[150:151], v[150:151], v[32:33]
  v_pk_mul_f32 v[152:153], v[120:121], v[106:107]
  v_lshlrev_b32 v32, 16, v74
  v_pk_fma_f32 v[152:153], v[118:119], v[108:109], v[152:153]
  v_and_b32 v33, s47, v74
  v_pk_fma_f32 v[152:153], v[116:117], v[110:111], v[152:153]
  v_pk_fma_f32 v[152:153], v[114:115], v[112:113], v[152:153]
  v_pk_mul_f32 v[152:153], v[152:153], v[32:33]
  v_cvt_pk_bf16_f32 v40, v136, v134
  v_cvt_pk_bf16_f32 v41, v132, v130
  v_cvt_pk_bf16_f32 v42, v128, v126
  v_cvt_pk_bf16_f32 v43, v124, v122
  v_cvt_pk_bf16_f32 v44, v152, v150
  v_cvt_pk_bf16_f32 v45, v148, v146
  v_cvt_pk_bf16_f32 v46, v144, v142
  v_cvt_pk_bf16_f32 v47, v140, v138
  v_cvt_pk_bf16_f32 v48, v137, v135
  v_cvt_pk_bf16_f32 v49, v133, v131
  v_cvt_pk_bf16_f32 v50, v129, v127
  v_cvt_pk_bf16_f32 v51, v125, v123
  v_cvt_pk_bf16_f32 v52, v153, v151
  v_cvt_pk_bf16_f32 v53, v149, v147
  v_cvt_pk_bf16_f32 v54, v145, v143
  v_cvt_pk_bf16_f32 v55, v141, v139
  v_mul_u32_u24 v30, 288, v1
  s_lshl_b32 s40, s55, 5
  s_add_u32 s40, s40, 49152
  v_add_u32 v30, s40, v30
  s_mov_b32 exec_lo, 0xffffffff
  s_mov_b32 exec_hi, 0xff
  ds_write_b128 v30, v[40:43] offset:0
  ds_write_b128 v30, v[44:47] offset:16
  ds_write_b128 v30, v[48:51] offset:144
  ds_write_b128 v30, v[52:55] offset:160
  s_mov_b64 exec, s[52:53]
  s_load_dwordx2 s[56:57], s[0:1], 64
  s_load_dwordx2 s[60:61], s[0:1], 104
  s_lshl_b32 s40, s32, 6
  s_lshl_b32 s41, s55, 4
  s_add_u32 s40, s40, s41
  v_add_u32 v10, 0, v2
  v_xor_b32 v11, v10, v3
  v_lshlrev_b32 v11, 4, v11
  v_add_u32 v10, s40, v10
  v_lshlrev_b32 v10, 12, v10
  v_add_u32 v4, v10, v11
  v_add_u32 v10, 4, v2
  v_xor_b32 v11, v10, v3
  v_lshlrev_b32 v11, 4, v11
  v_add_u32 v10, s40, v10
  v_lshlrev_b32 v10, 12, v10
  v_add_u32 v5, v10, v11
  v_add_u32 v10, 8, v2
  v_xor_b32 v11, v10, v3
  v_lshlrev_b32 v11, 4, v11
  v_add_u32 v10, s40, v10
  v_lshlrev_b32 v10, 12, v10
  v_add_u32 v6, v10, v11
  v_add_u32 v10, 12, v2
  v_xor_b32 v11, v10, v3
  v_lshlrev_b32 v11, 4, v11
  v_add_u32 v10, s40, v10
  v_lshlrev_b32 v10, 12, v10
  v_add_u32 v7, v10, v11
  s_lshl_b32 s39, s55, 12
  s_waitcnt lgkmcnt(0)
  s_mov_b32 s8, s56
  s_and_b32 s9, s57, 0xffff
  s_mov_b32 s10, 8388608
  s_mov_b32 s11, 0x20000
  s_mov_b32 s16, s60
  s_and_b32 s17, s61, 0xffff
  s_mov_b32 s18, 18874368
  s_mov_b32 s19, 0x20000
  s_waitcnt lgkmcnt(0)
  s_barrier
  s_sleep 5
  s_movk_i32 s38, 0
  s_add_u32 m0, s39, 0
  s_nop 0
  buffer_load_dwordx4 v4, s[8:11], s38 offen  lds
  s_add_u32 m0, s39, 1024
  s_nop 0
  buffer_load_dwordx4 v5, s[8:11], s38 offen  lds
  s_add_u32 m0, s39, 2048
  s_nop 0
  buffer_load_dwordx4 v6, s[8:11], s38 offen  lds
  s_add_u32 m0, s39, 3072
  s_nop 0
  buffer_load_dwordx4 v7, s[8:11], s38 offen  lds
  s_movk_i32 s38, 256
  s_add_u32 m0, s39, 16384
  s_nop 0
  buffer_load_dwordx4 v4, s[8:11], s38 offen  lds
  s_add_u32 m0, s39, 17408
  s_nop 0
  buffer_load_dwordx4 v5, s[8:11], s38 offen  lds
  s_add_u32 m0, s39, 18432
  s_nop 0
  buffer_load_dwordx4 v6, s[8:11], s38 offen  lds
  s_add_u32 m0, s39, 19456
  s_nop 0
  buffer_load_dwordx4 v7, s[8:11], s38 offen  lds
  s_waitcnt vmcnt(4)
  s_barrier
  s_movk_i32 s38, 512
  s_add_u32 m0, s39, 32768
  s_nop 0
  buffer_load_dwordx4 v4, s[8:11], s38 offen  lds
  s_add_u32 m0, s39, 33792
  s_nop 0
  buffer_load_dwordx4 v5, s[8:11], s38 offen  lds
  s_add_u32 m0, s39, 34816
  s_nop 0
  buffer_load_dwordx4 v6, s[8:11], s38 offen  lds
  s_add_u32 m0, s39, 35840
  s_nop 0
  buffer_load_dwordx4 v7, s[8:11], s38 offen  lds
  s_movk_i32 s38, 768
  s_add_u32 m0, s39, 49152
  s_nop 0
  buffer_load_dwordx4 v4, s[8:11], s38 offen  lds
  s_add_u32 m0, s39, 50176
  s_nop 0
  buffer_load_dwordx4 v5, s[8:11], s38 offen  lds
  s_add_u32 m0, s39, 51200
  s_nop 0
  buffer_load_dwordx4 v6, s[8:11], s38 offen  lds
  s_add_u32 m0, s39, 52224
  s_nop 0
  buffer_load_dwordx4 v7, s[8:11], s38 offen  lds
  s_waitcnt vmcnt(8)
  s_barrier
  s_movk_i32 s38, 1024
  s_add_u32 m0, s39, 0
  s_nop 0
  buffer_load_dwordx4 v4, s[8:11], s38 offen  lds
  s_add_u32 m0, s39, 1024
  s_nop 0
  buffer_load_dwordx4 v5, s[8:11], s38 offen  lds
  s_add_u32 m0, s39, 2048
  s_nop 0
  buffer_load_dwordx4 v6, s[8:11], s38 offen  lds
  s_add_u32 m0, s39, 3072
  s_nop 0
  buffer_load_dwordx4 v7, s[8:11], s38 offen  lds
  s_waitcnt vmcnt(8)
  s_barrier
  s_movk_i32 s38, 1280
  s_add_u32 m0, s39, 16384
  s_nop 0
  buffer_load_dwordx4 v4, s[8:11], s38 offen  lds
  s_add_u32 m0, s39, 17408
  s_nop 0
  buffer_load_dwordx4 v5, s[8:11], s38 offen  lds
  s_add_u32 m0, s39, 18432
  s_nop 0
  buffer_load_dwordx4 v6, s[8:11], s38 offen  lds
  s_add_u32 m0, s39, 19456
  s_nop 0
  buffer_load_dwordx4 v7, s[8:11], s38 offen  lds
  s_waitcnt vmcnt(8)
  s_barrier
  s_movk_i32 s38, 1536
  s_add_u32 m0, s39, 32768
  s_nop 0
  buffer_load_dwordx4 v4, s[8:11], s38 offen  lds
  s_add_u32 m0, s39, 33792
  s_nop 0
  buffer_load_dwordx4 v5, s[8:11], s38 offen  lds
  s_add_u32 m0, s39, 34816
  s_nop 0
  buffer_load_dwordx4 v6, s[8:11], s38 offen  lds
  s_add_u32 m0, s39, 35840
  s_nop 0
  buffer_load_dwordx4 v7, s[8:11], s38 offen  lds
  s_waitcnt vmcnt(8)
  s_barrier
  s_movk_i32 s38, 1792
  s_add_u32 m0, s39, 49152
  s_nop 0
  buffer_load_dwordx4 v4, s[8:11], s38 offen  lds
  s_add_u32 m0, s39, 50176
  s_nop 0
  buffer_load_dwordx4 v5, s[8:11], s38 offen  lds
  s_add_u32 m0, s39, 51200
  s_nop 0
  buffer_load_dwordx4 v6, s[8:11], s38 offen  lds
  s_add_u32 m0, s39, 52224
  s_nop 0
  buffer_load_dwordx4 v7, s[8:11], s38 offen  lds
  s_waitcnt vmcnt(8)
  s_barrier
  s_movk_i32 s38, 2048
  s_add_u32 m0, s39, 0
  s_nop 0
  buffer_load_dwordx4 v4, s[8:11], s38 offen  lds
  s_add_u32 m0, s39, 1024
  s_nop 0
  buffer_load_dwordx4 v5, s[8:11], s38 offen  lds
  s_add_u32 m0, s39, 2048
  s_nop 0
  buffer_load_dwordx4 v6, s[8:11], s38 offen  lds
  s_add_u32 m0, s39, 3072
  s_nop 0
  buffer_load_dwordx4 v7, s[8:11], s38 offen  lds
  s_waitcnt vmcnt(8)
  s_barrier
  s_movk_i32 s38, 2304
  s_add_u32 m0, s39, 16384
  s_nop 0
  buffer_load_dwordx4 v4, s[8:11], s38 offen  lds
  s_add_u32 m0, s39, 17408
  s_nop 0
  buffer_load_dwordx4 v5, s[8:11], s38 offen  lds
  s_add_u32 m0, s39, 18432
  s_nop 0
  buffer_load_dwordx4 v6, s[8:11], s38 offen  lds
  s_add_u32 m0, s39, 19456
  s_nop 0
  buffer_load_dwordx4 v7, s[8:11], s38 offen  lds
  s_waitcnt vmcnt(8)
  s_barrier
  s_movk_i32 s38, 2560
  s_add_u32 m0, s39, 32768
  s_nop 0
  buffer_load_dwordx4 v4, s[8:11], s38 offen  lds
  s_add_u32 m0, s39, 33792
  s_nop 0
  buffer_load_dwordx4 v5, s[8:11], s38 offen  lds
  s_add_u32 m0, s39, 34816
  s_nop 0
  buffer_load_dwordx4 v6, s[8:11], s38 offen  lds
  s_add_u32 m0, s39, 35840
  s_nop 0
  buffer_load_dwordx4 v7, s[8:11], s38 offen  lds
  s_waitcnt vmcnt(8)
  s_barrier
  s_movk_i32 s38, 2816
  s_add_u32 m0, s39, 49152
  s_nop 0
  buffer_load_dwordx4 v4, s[8:11], s38 offen  lds
  s_add_u32 m0, s39, 50176
  s_nop 0
  buffer_load_dwordx4 v5, s[8:11], s38 offen  lds
  s_add_u32 m0, s39, 51200
  s_nop 0
  buffer_load_dwordx4 v6, s[8:11], s38 offen  lds
  s_add_u32 m0, s39, 52224
  s_nop 0
  buffer_load_dwordx4 v7, s[8:11], s38 offen  lds
  s_waitcnt vmcnt(8)
  s_barrier
  s_movk_i32 s38, 3072
  s_add_u32 m0, s39, 0
  s_nop 0
  buffer_load_dwordx4 v4, s[8:11], s38 offen  lds
  s_add_u32 m0, s39, 1024
  s_nop 0
  buffer_load_dwordx4 v5, s[8:11], s38 offen  lds
  s_add_u32 m0, s39, 2048
  s_nop 0
  buffer_load_dwordx4 v6, s[8:11], s38 offen  lds
  s_add_u32 m0, s39, 3072
  s_nop 0
  buffer_load_dwordx4 v7, s[8:11], s38 offen  lds
  s_waitcnt vmcnt(8)
  s_barrier
  s_movk_i32 s38, 3328
  s_add_u32 m0, s39, 16384
  s_nop 0
  buffer_load_dwordx4 v4, s[8:11], s38 offen  lds
  s_add_u32 m0, s39, 17408
  s_nop 0
  buffer_load_dwordx4 v5, s[8:11], s38 offen  lds
  s_add_u32 m0, s39, 18432
  s_nop 0
  buffer_load_dwordx4 v6, s[8:11], s38 offen  lds
  s_add_u32 m0, s39, 19456
  s_nop 0
  buffer_load_dwordx4 v7, s[8:11], s38 offen  lds
  s_waitcnt vmcnt(8)
  s_barrier
  s_movk_i32 s38, 3584
  s_add_u32 m0, s39, 32768
  s_nop 0
  buffer_load_dwordx4 v4, s[8:11], s38 offen  lds
  s_add_u32 m0, s39, 33792
  s_nop 0
  buffer_load_dwordx4 v5, s[8:11], s38 offen  lds
  s_add_u32 m0, s39, 34816
  s_nop 0
  buffer_load_dwordx4 v6, s[8:11], s38 offen  lds
  s_add_u32 m0, s39, 35840
  s_nop 0
  buffer_load_dwordx4 v7, s[8:11], s38 offen  lds
  s_waitcnt vmcnt(8)
  s_barrier
  s_movk_i32 s38, 3840
  s_add_u32 m0, s39, 49152
  s_nop 0
  buffer_load_dwordx4 v4, s[8:11], s38 offen  lds
  s_add_u32 m0, s39, 50176
  s_nop 0
  buffer_load_dwordx4 v5, s[8:11], s38 offen  lds
  s_add_u32 m0, s39, 51200
  s_nop 0
  buffer_load_dwordx4 v6, s[8:11], s38 offen  lds
  s_add_u32 m0, s39, 52224
  s_nop 0
  buffer_load_dwordx4 v7, s[8:11], s38 offen  lds
  s_waitcnt vmcnt(8)
  s_barrier
  s_waitcnt vmcnt(4)
  s_barrier
  s_waitcnt vmcnt(0)
  s_barrier
  s_barrier
  s_barrier
  s_barrier
  s_barrier
  v_lshlrev_b32 v4, 4, v1
  s_mul_i32 s35, s33, 122880
  s_lshl_b32 s40, s55, 10
  s_add_u32 s35, s35, s40
  s_add_u32 s35, s35, 15728640
  s_mul_i32 s36, s55, 5120
  s_sleep 4
  s_add_u32 m0, s36, 0
  s_add_u32 s40, s35, 0
  buffer_load_dwordx4 v4, s[16:19], s40 offen sc1 lds
  s_add_u32 m0, s36, 1024
  s_add_u32 s40, s35, 24576
  buffer_load_dwordx4 v4, s[16:19], s40 offen sc1 lds
  s_add_u32 m0, s36, 2048
  s_add_u32 s40, s35, 49152
  buffer_load_dwordx4 v4, s[16:19], s40 offen sc1 lds
  s_add_u32 m0, s36, 3072
  s_add_u32 s40, s35, 73728
  buffer_load_dwordx4 v4, s[16:19], s40 offen sc1 lds
  s_add_u32 m0, s36, 4096
  s_add_u32 s40, s35, 98304
  buffer_load_dwordx4 v4, s[16:19], s40 offen sc1 lds
  s_add_u32 m0, s36, 61440
  s_add_u32 s40, s35, 12288
  buffer_load_dwordx4 v4, s[16:19], s40 offen sc1 lds
  s_add_u32 m0, s36, 62464
  s_add_u32 s40, s35, 36864
  buffer_load_dwordx4 v4, s[16:19], s40 offen sc1 lds
  s_add_u32 m0, s36, 63488
  s_add_u32 s40, s35, 61440
  buffer_load_dwordx4 v4, s[16:19], s40 offen sc1 lds
  s_add_u32 m0, s36, 64512
  s_add_u32 s40, s35, 86016
  buffer_load_dwordx4 v4, s[16:19], s40 offen sc1 lds
  s_add_u32 m0, s36, 65536
  s_add_u32 s40, s35, 110592
  buffer_load_dwordx4 v4, s[16:19], s40 offen sc1 lds
  s_add_u32 m0, s36, 20480
  s_add_u32 s40, s35, 4096
  buffer_load_dwordx4 v4, s[16:19], s40 offen sc1 lds
  s_add_u32 m0, s36, 21504
  s_add_u32 s40, s35, 28672
  buffer_load_dwordx4 v4, s[16:19], s40 offen sc1 lds
  s_add_u32 m0, s36, 22528
  s_add_u32 s40, s35, 53248
  buffer_load_dwordx4 v4, s[16:19], s40 offen sc1 lds
  s_add_u32 m0, s36, 23552
  s_add_u32 s40, s35, 77824
  buffer_load_dwordx4 v4, s[16:19], s40 offen sc1 lds
  s_add_u32 m0, s36, 24576
  s_add_u32 s40, s35, 102400
  buffer_load_dwordx4 v4, s[16:19], s40 offen sc1 lds
  s_add_u32 m0, s36, 81920
  s_add_u32 s40, s35, 16384
  buffer_load_dwordx4 v4, s[16:19], s40 offen sc1 lds
  s_add_u32 m0, s36, 82944
  s_add_u32 s40, s35, 40960
  buffer_load_dwordx4 v4, s[16:19], s40 offen sc1 lds
  s_add_u32 m0, s36, 83968
  s_add_u32 s40, s35, 65536
  buffer_load_dwordx4 v4, s[16:19], s40 offen sc1 lds
  s_add_u32 m0, s36, 84992
  s_add_u32 s40, s35, 90112
  buffer_load_dwordx4 v4, s[16:19], s40 offen sc1 lds
  s_add_u32 m0, s36, 86016
  s_add_u32 s40, s35, 114688
  buffer_load_dwordx4 v4, s[16:19], s40 offen sc1 lds
  s_add_u32 m0, s36, 40960
  s_add_u32 s40, s35, 8192
  buffer_load_dwordx4 v4, s[16:19], s40 offen sc1 lds
  s_add_u32 m0, s36, 41984
  s_add_u32 s40, s35, 32768
  buffer_load_dwordx4 v4, s[16:19], s40 offen sc1 lds
  s_add_u32 m0, s36, 43008
  s_add_u32 s40, s35, 57344
  buffer_load_dwordx4 v4, s[16:19], s40 offen sc1 lds
  s_add_u32 m0, s36, 44032
  s_add_u32 s40, s35, 81920
  buffer_load_dwordx4 v4, s[16:19], s40 offen sc1 lds
  s_add_u32 m0, s36, 45056
  s_add_u32 s40, s35, 106496
  buffer_load_dwordx4 v4, s[16:19], s40 offen sc1 lds
  s_add_u32 m0, s36, 102400
  s_add_u32 s40, s35, 20480
  buffer_load_dwordx4 v4, s[16:19], s40 offen sc1 lds
  s_add_u32 m0, s36, 103424
  s_add_u32 s40, s35, 45056
  buffer_load_dwordx4 v4, s[16:19], s40 offen sc1 lds
  s_add_u32 m0, s36, 104448
  s_add_u32 s40, s35, 69632
  buffer_load_dwordx4 v4, s[16:19], s40 offen sc1 lds
  s_add_u32 m0, s36, 105472
  s_add_u32 s40, s35, 94208
  buffer_load_dwordx4 v4, s[16:19], s40 offen sc1 lds
  s_add_u32 m0, s36, 106496
  s_add_u32 s40, s35, 118784
  buffer_load_dwordx4 v4, s[16:19], s40 offen sc1 lds
  s_barrier
  s_waitcnt vmcnt(20)
  s_barrier
  s_cmp_eq_u32 s34, 8
  s_cbranch_scc0 F3_NOYP
  s_load_dwordx2 s[72:73], s[0:1], 104
  s_lshl_b32 s75, s33, 7
  s_add_u32 s75, s75, 17040384
  s_waitcnt lgkmcnt(0)
  s_add_u32 s74, s75, 0
  s_mov_b32 s42, 0
SP_F2Aa:
  s_load_dwordx16 s[56:71], s[72:73], s74 glc
  s_waitcnt lgkmcnt(0)
  s_and_b64 s[56:57], s[56:57], s[64:65]
  s_and_b64 s[58:59], s[58:59], s[66:67]
  s_and_b64 s[60:61], s[60:61], s[68:69]
  s_and_b64 s[62:63], s[62:63], s[70:71]
  s_and_b64 s[56:57], s[56:57], s[60:61]
  s_and_b64 s[58:59], s[58:59], s[62:63]
  s_and_b64 s[56:57], s[56:57], s[58:59]
  s_and_b32 s56, s56, s57
  s_add_u32 s42, s42, 1
  s_cmp_eq_u32 s56, 1
  s_cbranch_scc1 SP_F2Aa_OK
  s_cmp_lt_u32 s42, 2097152
  s_cbranch_scc1 SP_F2Aa
SP_F2Aa_OK:
  s_add_u32 s74, s75, 64
  s_mov_b32 s42, 0
SP_F2Ab:
  s_load_dwordx16 s[56:71], s[72:73], s74 glc
  s_waitcnt lgkmcnt(0)
  s_and_b64 s[56:57], s[56:57], s[64:65]
  s_and_b64 s[58:59], s[58:59], s[66:67]
  s_and_b64 s[60:61], s[60:61], s[68:69]
  s_and_b64 s[62:63], s[62:63], s[70:71]
  s_and_b64 s[56:57], s[56:57], s[60:61]
  s_and_b64 s[58:59], s[58:59], s[62:63]
  s_and_b64 s[56:57], s[56:57], s[58:59]
  s_and_b32 s56, s56, s57
  s_add_u32 s42, s42, 1
  s_cmp_eq_u32 s56, 1
  s_cbranch_scc1 SP_F2Ab_OK
  s_cmp_lt_u32 s42, 2097152
  s_cbranch_scc1 SP_F2Ab
SP_F2Ab_OK:
F3_NOYP:
  s_waitcnt vmcnt(10)
  s_barrier
  s_waitcnt vmcnt(0)
  s_barrier
  s_barrier
  s_barrier
  s_barrier
  s_endpgm
K1_AB:
  v_lshrrev_b32 v17, 1, v3
  v_xor_b32 v17, v17, v2
  v_lshlrev_b32 v17, 4, v17
  v_lshlrev_b32 v18, 7, v3
  v_add_u32 v17, v17, v18
  v_xor_b32 v18, 64, v17
  s_lshl_b32 s40, s35, 12
  s_lshl_b32 s41, s36, 11
  s_add_u32 s42, s40, s41
  s_add_u32 s42, s42, 61440
  v_add_u32 v4, s42, v17
  v_add_u32 v5, s42, v18
  s_xor_b32 s41, s41, 2048
  s_add_u32 s42, s40, s41
  s_add_u32 s42, s42, 61440
  v_add_u32 v6, s42, v17
  v_add_u32 v7, s42, v18
  v_lshrrev_b32 v17, 2, v1
  v_and_b32 v17, 3, v17
  v_lshlrev_b32 v18, 3, v2
  v_add_u32 v17, v17, v18
  v_mul_u32_u24 v17, 192, v17
  v_and_b32 v18, 3, v1
  v_lshlrev_b32 v18, 3, v18
  v_add_u32 v17, v17, v18
  v_and_b32 v19, 1, v2
  s_mul_i32 s40, s36, 3
  s_add_u32 s41, s40, 0
  v_xor_b32 v18, s41, v19
  v_lshlrev_b32 v18, 5, v18
  v_add_u32 v8, v17, v18
  s_add_u32 s41, s40, 1
  v_xor_b32 v18, s41, v19
  v_lshlrev_b32 v18, 5, v18
  v_add_u32 v9, v17, v18
  s_add_u32 s41, s40, 2
  v_xor_b32 v18, s41, v19
  v_lshlrev_b32 v18, 5, v18
  v_add_u32 v10, v17, v18
  s_mov_b32 s48, 0xbdd2d3e8
  s_mov_b32 s49, 0xbdd2d3e8
  s_mov_b32 s50, 1.0
  s_mov_b32 s51, 1.0
  s_waitcnt lgkmcnt(0)
  s_mov_b32 s16, s70
  s_and_b32 s17, s71, 0xffff
  s_mov_b32 s18, 18874368
  s_mov_b32 s19, 0x20000
  s_mov_b32 s4, s68
  s_and_b32 s5, s69, 0xffff
  s_mov_b32 s6, 256
  s_mov_b32 s7, 0x20000
  s_cmp_ge_u32 s34, 4
  s_cbranch_scc1 K1_B
  v_mov_b32 v102, 0x3f803f80
  v_mov_b32 v103, 0x3f803f80
  v_mov_b32 v104, 0x3f803f80
  v_mov_b32 v105, 0x3f803f80
  v_mov_b32 v66, 0
  v_mov_b32 v67, 0
  v_mov_b32 v68, 0
  v_mov_b32 v69, 0
  v_mov_b32 v70, 0
  v_mov_b32 v71, 0
  v_mov_b32 v72, 0
  v_mov_b32 v73, 0
  v_mov_b32 v74, 0
  v_mov_b32 v75, 0
  v_mov_b32 v76, 0
  v_mov_b32 v77, 0
  v_mov_b32 v78, 0
  v_mov_b32 v79, 0
  v_mov_b32 v80, 0
  v_mov_b32 v81, 0
  v_mov_b32 v82, 0
  v_mov_b32 v83, 0
  v_mov_b32 v84, 0
  v_mov_b32 v85, 0
  v_mov_b32 v86, 0
  v_mov_b32 v87, 0
  v_mov_b32 v88, 0
  v_mov_b32 v89, 0
  v_mov_b32 v90, 0
  v_mov_b32 v91, 0
  v_mov_b32 v92, 0
  v_mov_b32 v93, 0
  v_mov_b32 v94, 0
  v_mov_b32 v95, 0
  v_mov_b32 v96, 0
  v_mov_b32 v97, 0
  v_mov_b32 v98, 0
  v_mov_b32 v99, 0
  v_mov_b32 v100, 0
  v_mov_b32 v101, 0
  v_mov_b32 v106, 0
  v_mov_b32 v107, 0
  v_mov_b32 v108, 0
  v_mov_b32 v109, 0
  v_mov_b32 v110, 0
  v_mov_b32 v111, 0
  v_mov_b32 v112, 0
  v_mov_b32 v113, 0
  s_barrier
  s_mov_b32 s37, 0
  ds_read_b128 v[26:29], v4 offset:0
  ds_read_b64_tr_b16 v[42:43], v8 offset:0
  ds_read_b64_tr_b16 v[44:45], v8 offset:768
  ds_read_b128 v[30:33], v6 offset:0
  ds_read_b64_tr_b16 v[46:47], v9 offset:0
  ds_read_b64_tr_b16 v[48:49], v9 offset:768
  ds_read_b64_tr_b16 v[50:51], v10 offset:0
  ds_read_b64_tr_b16 v[52:53], v10 offset:768
K1_LOOP1:
  s_waitcnt lgkmcnt(0)
  v_mfma_f32_16x16x32_bf16 v[66:69], v[26:29], v[42:45], v[66:69]
  ds_read_b128 v[34:37], v5 offset:0
  ds_read_b64_tr_b16 v[54:55], v8 offset:6144
  v_mfma_f32_16x16x32_bf16 v[78:81], v[30:33], v[42:45], v[78:81]
  ds_read_b64_tr_b16 v[56:57], v8 offset:6912
  ds_read_b128 v[38:41], v7 offset:0
  v_mfma_f32_16x16x32_bf16 v[70:73], v[26:29], v[46:49], v[70:73]
  ds_read_b64_tr_b16 v[58:59], v9 offset:6144
  ds_read_b64_tr_b16 v[60:61], v9 offset:6912
  v_mfma_f32_16x16x32_bf16 v[82:85], v[30:33], v[46:49], v[82:85]
  ds_read_b64_tr_b16 v[62:63], v10 offset:6144
  ds_read_b64_tr_b16 v[64:65], v10 offset:6912
  v_mfma_f32_16x16x32_bf16 v[74:77], v[26:29], v[50:53], v[74:77]
  v_mfma_f32_16x16x32_bf16 v[86:89], v[30:33], v[50:53], v[86:89]
  v_mfma_f32_16x16x32_bf16 v[106:109], v[102:105], v[26:29], v[106:109]
  v_mfma_f32_16x16x32_bf16 v[110:113], v[26:29], v[26:29], v[110:113]
  s_cmp_eq_u32 s35, 0
  s_cbranch_scc0 K1_SK_1a0
  v_mfma_f32_16x16x32_bf16 v[90:93], v[102:105], v[42:45], v[90:93]
  v_mfma_f32_16x16x32_bf16 v[94:97], v[102:105], v[46:49], v[94:97]
  v_mfma_f32_16x16x32_bf16 v[98:101], v[102:105], v[50:53], v[98:101]
K1_SK_1a0:
  s_waitcnt lgkmcnt(0)
  s_barrier
  v_mfma_f32_16x16x32_bf16 v[66:69], v[34:37], v[54:57], v[66:69]
  ds_read_b128 v[26:29], v4 offset:8192
  ds_read_b64_tr_b16 v[42:43], v8 offset:12288
  v_mfma_f32_16x16x32_bf16 v[78:81], v[38:41], v[54:57], v[78:81]
  ds_read_b64_tr_b16 v[44:45], v8 offset:13056
  ds_read_b128 v[30:33], v6 offset:8192
  v_mfma_f32_16x16x32_bf16 v[70:73], v[34:37], v[58:61], v[70:73]
  ds_read_b64_tr_b16 v[46:47], v9 offset:12288
  ds_read_b64_tr_b16 v[48:49], v9 offset:13056
  v_mfma_f32_16x16x32_bf16 v[82:85], v[38:41], v[58:61], v[82:85]
  ds_read_b64_tr_b16 v[50:51], v10 offset:12288
  ds_read_b64_tr_b16 v[52:53], v10 offset:13056
  v_mfma_f32_16x16x32_bf16 v[74:77], v[34:37], v[62:65], v[74:77]
  v_mfma_f32_16x16x32_bf16 v[86:89], v[38:41], v[62:65], v[86:89]
  v_mfma_f32_16x16x32_bf16 v[106:109], v[102:105], v[34:37], v[106:109]
  v_mfma_f32_16x16x32_bf16 v[110:113], v[34:37], v[34:37], v[110:113]
  s_cmp_eq_u32 s35, 1
  s_cbranch_scc0 K1_SK_1b0
  v_mfma_f32_16x16x32_bf16 v[90:93], v[102:105], v[54:57], v[90:93]
  v_mfma_f32_16x16x32_bf16 v[94:97], v[102:105], v[58:61], v[94:97]
  v_mfma_f32_16x16x32_bf16 v[98:101], v[102:105], v[62:65], v[98:101]
K1_SK_1b0:
  s_waitcnt lgkmcnt(0)
  v_mfma_f32_16x16x32_bf16 v[66:69], v[26:29], v[42:45], v[66:69]
  ds_read_b128 v[34:37], v5 offset:8192
  ds_read_b64_tr_b16 v[54:55], v8 offset:18432
  v_mfma_f32_16x16x32_bf16 v[78:81], v[30:33], v[42:45], v[78:81]
  ds_read_b64_tr_b16 v[56:57], v8 offset:19200
  ds_read_b128 v[38:41], v7 offset:8192
  v_mfma_f32_16x16x32_bf16 v[70:73], v[26:29], v[46:49], v[70:73]
  ds_read_b64_tr_b16 v[58:59], v9 offset:18432
  ds_read_b64_tr_b16 v[60:61], v9 offset:19200
  v_mfma_f32_16x16x32_bf16 v[82:85], v[30:33], v[46:49], v[82:85]
  ds_read_b64_tr_b16 v[62:63], v10 offset:18432
  ds_read_b64_tr_b16 v[64:65], v10 offset:19200
  v_mfma_f32_16x16x32_bf16 v[74:77], v[26:29], v[50:53], v[74:77]
  v_mfma_f32_16x16x32_bf16 v[86:89], v[30:33], v[50:53], v[86:89]
  v_mfma_f32_16x16x32_bf16 v[106:109], v[102:105], v[26:29], v[106:109]
  v_mfma_f32_16x16x32_bf16 v[110:113], v[26:29], v[26:29], v[110:113]
  s_cmp_eq_u32 s35, 0
  s_cbranch_scc0 K1_SK_1a1
  v_mfma_f32_16x16x32_bf16 v[90:93], v[102:105], v[42:45], v[90:93]
  v_mfma_f32_16x16x32_bf16 v[94:97], v[102:105], v[46:49], v[94:97]
  v_mfma_f32_16x16x32_bf16 v[98:101], v[102:105], v[50:53], v[98:101]
K1_SK_1a1:
  s_waitcnt lgkmcnt(0)
  s_barrier
  v_mfma_f32_16x16x32_bf16 v[66:69], v[34:37], v[54:57], v[66:69]
  ds_read_b128 v[26:29], v4 offset:16384
  ds_read_b64_tr_b16 v[42:43], v8 offset:24576
  v_mfma_f32_16x16x32_bf16 v[78:81], v[38:41], v[54:57], v[78:81]
  ds_read_b64_tr_b16 v[44:45], v8 offset:25344
  ds_read_b128 v[30:33], v6 offset:16384
  v_mfma_f32_16x16x32_bf16 v[70:73], v[34:37], v[58:61], v[70:73]
  ds_read_b64_tr_b16 v[46:47], v9 offset:24576
  ds_read_b64_tr_b16 v[48:49], v9 offset:25344
  v_mfma_f32_16x16x32_bf16 v[82:85], v[38:41], v[58:61], v[82:85]
  ds_read_b64_tr_b16 v[50:51], v10 offset:24576
  ds_read_b64_tr_b16 v[52:53], v10 offset:25344
  v_mfma_f32_16x16x32_bf16 v[74:77], v[34:37], v[62:65], v[74:77]
  v_mfma_f32_16x16x32_bf16 v[86:89], v[38:41], v[62:65], v[86:89]
  v_mfma_f32_16x16x32_bf16 v[106:109], v[102:105], v[34:37], v[106:109]
  v_mfma_f32_16x16x32_bf16 v[110:113], v[34:37], v[34:37], v[110:113]
  s_cmp_eq_u32 s35, 1
  s_cbranch_scc0 K1_SK_1b1
  v_mfma_f32_16x16x32_bf16 v[90:93], v[102:105], v[54:57], v[90:93]
  v_mfma_f32_16x16x32_bf16 v[94:97], v[102:105], v[58:61], v[94:97]
  v_mfma_f32_16x16x32_bf16 v[98:101], v[102:105], v[62:65], v[98:101]
K1_SK_1b1:
  s_waitcnt lgkmcnt(0)
  v_mfma_f32_16x16x32_bf16 v[66:69], v[26:29], v[42:45], v[66:69]
  ds_read_b128 v[34:37], v5 offset:16384
  ds_read_b64_tr_b16 v[54:55], v8 offset:30720
  v_mfma_f32_16x16x32_bf16 v[78:81], v[30:33], v[42:45], v[78:81]
  ds_read_b64_tr_b16 v[56:57], v8 offset:31488
  ds_read_b128 v[38:41], v7 offset:16384
  v_mfma_f32_16x16x32_bf16 v[70:73], v[26:29], v[46:49], v[70:73]
  ds_read_b64_tr_b16 v[58:59], v9 offset:30720
  ds_read_b64_tr_b16 v[60:61], v9 offset:31488
  v_mfma_f32_16x16x32_bf16 v[82:85], v[30:33], v[46:49], v[82:85]
  ds_read_b64_tr_b16 v[62:63], v10 offset:30720
  ds_read_b64_tr_b16 v[64:65], v10 offset:31488
  v_mfma_f32_16x16x32_bf16 v[74:77], v[26:29], v[50:53], v[74:77]
  v_mfma_f32_16x16x32_bf16 v[86:89], v[30:33], v[50:53], v[86:89]
  v_mfma_f32_16x16x32_bf16 v[106:109], v[102:105], v[26:29], v[106:109]
  v_mfma_f32_16x16x32_bf16 v[110:113], v[26:29], v[26:29], v[110:113]
  s_cmp_eq_u32 s35, 0
  s_cbranch_scc0 K1_SK_1a2
  v_mfma_f32_16x16x32_bf16 v[90:93], v[102:105], v[42:45], v[90:93]
  v_mfma_f32_16x16x32_bf16 v[94:97], v[102:105], v[46:49], v[94:97]
  v_mfma_f32_16x16x32_bf16 v[98:101], v[102:105], v[50:53], v[98:101]
K1_SK_1a2:
  s_waitcnt lgkmcnt(0)
  s_barrier
  v_mfma_f32_16x16x32_bf16 v[66:69], v[34:37], v[54:57], v[66:69]
  ds_read_b128 v[26:29], v4 offset:24576
  ds_read_b64_tr_b16 v[42:43], v8 offset:36864
  v_mfma_f32_16x16x32_bf16 v[78:81], v[38:41], v[54:57], v[78:81]
  ds_read_b64_tr_b16 v[44:45], v8 offset:37632
  ds_read_b128 v[30:33], v6 offset:24576
  v_mfma_f32_16x16x32_bf16 v[70:73], v[34:37], v[58:61], v[70:73]
  ds_read_b64_tr_b16 v[46:47], v9 offset:36864
  ds_read_b64_tr_b16 v[48:49], v9 offset:37632
  v_mfma_f32_16x16x32_bf16 v[82:85], v[38:41], v[58:61], v[82:85]
  ds_read_b64_tr_b16 v[50:51], v10 offset:36864
  ds_read_b64_tr_b16 v[52:53], v10 offset:37632
  v_mfma_f32_16x16x32_bf16 v[74:77], v[34:37], v[62:65], v[74:77]
  v_mfma_f32_16x16x32_bf16 v[86:89], v[38:41], v[62:65], v[86:89]
  v_mfma_f32_16x16x32_bf16 v[106:109], v[102:105], v[34:37], v[106:109]
  v_mfma_f32_16x16x32_bf16 v[110:113], v[34:37], v[34:37], v[110:113]
  s_cmp_eq_u32 s35, 1
  s_cbranch_scc0 K1_SK_1b2
  v_mfma_f32_16x16x32_bf16 v[90:93], v[102:105], v[54:57], v[90:93]
  v_mfma_f32_16x16x32_bf16 v[94:97], v[102:105], v[58:61], v[94:97]
  v_mfma_f32_16x16x32_bf16 v[98:101], v[102:105], v[62:65], v[98:101]
K1_SK_1b2:
  s_waitcnt lgkmcnt(0)
  v_mfma_f32_16x16x32_bf16 v[66:69], v[26:29], v[42:45], v[66:69]
  ds_read_b128 v[34:37], v5 offset:24576
  ds_read_b64_tr_b16 v[54:55], v8 offset:43008
  v_mfma_f32_16x16x32_bf16 v[78:81], v[30:33], v[42:45], v[78:81]
  ds_read_b64_tr_b16 v[56:57], v8 offset:43776
  ds_read_b128 v[38:41], v7 offset:24576
  v_mfma_f32_16x16x32_bf16 v[70:73], v[26:29], v[46:49], v[70:73]
  ds_read_b64_tr_b16 v[58:59], v9 offset:43008
  ds_read_b64_tr_b16 v[60:61], v9 offset:43776
  v_mfma_f32_16x16x32_bf16 v[82:85], v[30:33], v[46:49], v[82:85]
  ds_read_b64_tr_b16 v[62:63], v10 offset:43008
  ds_read_b64_tr_b16 v[64:65], v10 offset:43776
  v_mfma_f32_16x16x32_bf16 v[74:77], v[26:29], v[50:53], v[74:77]
  v_mfma_f32_16x16x32_bf16 v[86:89], v[30:33], v[50:53], v[86:89]
  v_mfma_f32_16x16x32_bf16 v[106:109], v[102:105], v[26:29], v[106:109]
  v_mfma_f32_16x16x32_bf16 v[110:113], v[26:29], v[26:29], v[110:113]
  s_cmp_eq_u32 s35, 0
  s_cbranch_scc0 K1_SK_1a3
  v_mfma_f32_16x16x32_bf16 v[90:93], v[102:105], v[42:45], v[90:93]
  v_mfma_f32_16x16x32_bf16 v[94:97], v[102:105], v[46:49], v[94:97]
  v_mfma_f32_16x16x32_bf16 v[98:101], v[102:105], v[50:53], v[98:101]
K1_SK_1a3:
  s_waitcnt lgkmcnt(0)
  s_barrier
  v_mfma_f32_16x16x32_bf16 v[66:69], v[34:37], v[54:57], v[66:69]
  ds_read_b128 v[26:29], v4 offset:32768
  ds_read_b64_tr_b16 v[42:43], v8 offset:49152
  v_mfma_f32_16x16x32_bf16 v[78:81], v[38:41], v[54:57], v[78:81]
  ds_read_b64_tr_b16 v[44:45], v8 offset:49920
  ds_read_b128 v[30:33], v6 offset:32768
  v_mfma_f32_16x16x32_bf16 v[70:73], v[34:37], v[58:61], v[70:73]
  ds_read_b64_tr_b16 v[46:47], v9 offset:49152
  ds_read_b64_tr_b16 v[48:49], v9 offset:49920
  v_mfma_f32_16x16x32_bf16 v[82:85], v[38:41], v[58:61], v[82:85]
  ds_read_b64_tr_b16 v[50:51], v10 offset:49152
  ds_read_b64_tr_b16 v[52:53], v10 offset:49920
  v_mfma_f32_16x16x32_bf16 v[74:77], v[34:37], v[62:65], v[74:77]
  v_mfma_f32_16x16x32_bf16 v[86:89], v[38:41], v[62:65], v[86:89]
  v_mfma_f32_16x16x32_bf16 v[106:109], v[102:105], v[34:37], v[106:109]
  v_mfma_f32_16x16x32_bf16 v[110:113], v[34:37], v[34:37], v[110:113]
  s_cmp_eq_u32 s35, 1
  s_cbranch_scc0 K1_SK_1b3
  v_mfma_f32_16x16x32_bf16 v[90:93], v[102:105], v[54:57], v[90:93]
  v_mfma_f32_16x16x32_bf16 v[94:97], v[102:105], v[58:61], v[94:97]
  v_mfma_f32_16x16x32_bf16 v[98:101], v[102:105], v[62:65], v[98:101]
K1_SK_1b3:
  s_waitcnt lgkmcnt(0)
  v_mfma_f32_16x16x32_bf16 v[66:69], v[26:29], v[42:45], v[66:69]
  ds_read_b128 v[34:37], v5 offset:32768
  ds_read_b64_tr_b16 v[54:55], v8 offset:55296
  v_mfma_f32_16x16x32_bf16 v[78:81], v[30:33], v[42:45], v[78:81]
  ds_read_b64_tr_b16 v[56:57], v8 offset:56064
  ds_read_b128 v[38:41], v7 offset:32768
  v_mfma_f32_16x16x32_bf16 v[70:73], v[26:29], v[46:49], v[70:73]
  ds_read_b64_tr_b16 v[58:59], v9 offset:55296
  ds_read_b64_tr_b16 v[60:61], v9 offset:56064
  v_mfma_f32_16x16x32_bf16 v[82:85], v[30:33], v[46:49], v[82:85]
  ds_read_b64_tr_b16 v[62:63], v10 offset:55296
  ds_read_b64_tr_b16 v[64:65], v10 offset:56064
  v_mfma_f32_16x16x32_bf16 v[74:77], v[26:29], v[50:53], v[74:77]
  v_mfma_f32_16x16x32_bf16 v[86:89], v[30:33], v[50:53], v[86:89]
  v_mfma_f32_16x16x32_bf16 v[106:109], v[102:105], v[26:29], v[106:109]
  v_mfma_f32_16x16x32_bf16 v[110:113], v[26:29], v[26:29], v[110:113]
  s_cmp_eq_u32 s35, 0
  s_cbranch_scc0 K1_SK_1a4
  v_mfma_f32_16x16x32_bf16 v[90:93], v[102:105], v[42:45], v[90:93]
  v_mfma_f32_16x16x32_bf16 v[94:97], v[102:105], v[46:49], v[94:97]
  v_mfma_f32_16x16x32_bf16 v[98:101], v[102:105], v[50:53], v[98:101]
K1_SK_1a4:
  s_waitcnt lgkmcnt(0)
  s_barrier
  v_add_u32 v4, 40960, v4
  v_add_u32 v5, 40960, v5
  v_add_u32 v6, 40960, v6
  v_add_u32 v7, 40960, v7
  v_mfma_f32_16x16x32_bf16 v[66:69], v[34:37], v[54:57], v[66:69]
  ds_read_b128 v[26:29], v4 offset:0
  ds_read_b64_tr_b16 v[42:43], v8 offset:0
  v_mfma_f32_16x16x32_bf16 v[78:81], v[38:41], v[54:57], v[78:81]
  ds_read_b64_tr_b16 v[44:45], v8 offset:768
  ds_read_b128 v[30:33], v6 offset:0
  v_mfma_f32_16x16x32_bf16 v[70:73], v[34:37], v[58:61], v[70:73]
  ds_read_b64_tr_b16 v[46:47], v9 offset:0
  ds_read_b64_tr_b16 v[48:49], v9 offset:768
  v_mfma_f32_16x16x32_bf16 v[82:85], v[38:41], v[58:61], v[82:85]
  ds_read_b64_tr_b16 v[50:51], v10 offset:0
  ds_read_b64_tr_b16 v[52:53], v10 offset:768
  v_mfma_f32_16x16x32_bf16 v[74:77], v[34:37], v[62:65], v[74:77]
  v_mfma_f32_16x16x32_bf16 v[86:89], v[38:41], v[62:65], v[86:89]
  v_mfma_f32_16x16x32_bf16 v[106:109], v[102:105], v[34:37], v[106:109]
  v_mfma_f32_16x16x32_bf16 v[110:113], v[34:37], v[34:37], v[110:113]
  s_cmp_eq_u32 s35, 1
  s_cbranch_scc0 K1_SK_1b4
  v_mfma_f32_16x16x32_bf16 v[90:93], v[102:105], v[54:57], v[90:93]
  v_mfma_f32_16x16x32_bf16 v[94:97], v[102:105], v[58:61], v[94:97]
  v_mfma_f32_16x16x32_bf16 v[98:101], v[102:105], v[62:65], v[98:101]
K1_SK_1b4:
  s_add_u32 s37, s37, 1
  s_cmp_lt_u32 s37, 2
  s_cbranch_scc1 K1_LOOP1
  s_setprio 2
  s_lshl_b32 s40, s32, 2
  v_mov_b32 v22, s40
  v_and_b32 v14, 3, v3
  v_cmp_eq_u32 vcc, 1, v14
  s_nop 1
  v_cndmask_b32 v110, v110, v111, vcc
  v_cmp_eq_u32 vcc, 2, v14
  s_nop 1
  v_cndmask_b32 v110, v110, v112, vcc
  v_cmp_eq_u32 vcc, 3, v14
  s_nop 1
  v_cndmask_b32 v110, v110, v113, vcc
  v_mul_f32 v16, 0x3acccccd, v106
  v_mul_f32 v18, 0x3acccccd, v110
  v_fma_f32 v18, -v16, v16, v18
  v_max_f32 v18, 0, v18
  v_cvt_pk_bf16_f32 v16, v16, v16
  v_lshlrev_b32 v16, 16, v16
  v_cvt_pk_bf16_f32 v18, v18, v18
  v_lshlrev_b32 v18, 16, v18
  v_add_f32 v18, 0x3727c5ac, v18
  v_cvt_pk_bf16_f32 v18, v18, v18
  v_lshlrev_b32 v18, 16, v18
  v_sqrt_f32 v18, v18
  s_nop 0
  v_cvt_pk_bf16_f32 v18, v18, v18
  v_lshlrev_b32 v18, 16, v18
  v_rcp_f32 v17, v18
  s_lshl_b32 s40, s35, 5
  s_lshl_b32 s41, s36, 4
  s_add_u32 s40, s40, s41
  v_add_u32 v18, s40, v3
  v_lshlrev_b32 v19, 2, v18
  v_add_u32 v19, 143360, v19
  s_mov_b32 exec_lo, 0xf0000f
  s_mov_b32 exec_hi, 0xf0000f00
  ds_write_b32 v19, v16
  ds_write_b32 v19, v17 offset:256
  s_branch K1_NOST1X
  s_cmp_eq_u32 s33, 0
  s_cbranch_scc0 K1_NOST1X
  s_lshl_b32 s41, s32, 9
  s_add_u32 s41, s41, 16777216
  v_lshlrev_b32 v18, 3, v18
  buffer_store_dwordx2 v[16:17], v18, s[16:19], s41 offen sc1
K1_NOST1X:
  s_mov_b64 exec, s[52:53]
  s_mul_i32 s40, s55, 192
  s_add_u32 s40, s40, 143872
  v_lshlrev_b32 v20, 2, v3
  v_add_u32 v20, s40, v20
  ds_write_b32 v20, v90 offset:0
  ds_write_b32 v20, v94 offset:64
  ds_write_b32 v20, v98 offset:128
  s_waitcnt lgkmcnt(0)
  s_barrier
  s_xor_b32 s41, s55, 2
  s_mul_i32 s41, s41, 192
  s_add_u32 s41, s41, 143872
  v_lshlrev_b32 v18, 2, v3
  v_add_u32 v18, s41, v18
  ds_read_b32 v136, v18 offset:0
  ds_read_b32 v138, v18 offset:64
  ds_read_b32 v140, v18 offset:128
  s_lshl_b32 s40, s35, 7
  s_lshl_b32 s41, s36, 6
  s_add_u32 s40, s40, s41
  s_add_u32 s40, s40, 143360
  v_lshlrev_b32 v19, 4, v2
  v_add_u32 v19, s40, v19
  v_xor_b32 v20, 64, v19
  ds_read_b128 v[26:29], v19
  ds_read_b128 v[30:33], v20
  ds_read_b128 v[34:37], v19 offset:256
  ds_read_b128 v[38:41], v20 offset:256
  v_mov_b32 v126, 0xc0135761
  v_mov_b32 v127, 0xc0135761
  v_mov_b32 v42, 0
  v_mov_b32 v43, 0
  v_mov_b32 v44, 0
  v_mov_b32 v45, 0
  v_mov_b32 v46, 0
  v_mov_b32 v47, 0
  v_mov_b32 v48, 0
  v_mov_b32 v49, 0
  v_mov_b32 v50, 0
  v_mov_b32 v51, 0
  v_mov_b32 v52, 0
  v_mov_b32 v53, 0
  v_mov_b32 v54, 0
  v_mov_b32 v55, 0
  v_mov_b32 v56, 0
  v_mov_b32 v57, 0
  s_waitcnt lgkmcnt(0)
  v_add_f32 v136, v136, v90
  v_sub_f32 v136, 0, v136
  v_add_f32 v138, v138, v94
  v_sub_f32 v138, 0, v138
  v_add_f32 v140, v140, v98
  v_sub_f32 v140, 0, v140
  v_fma_f32 v66, v26, v136, v66
  v_fma_f32 v67, v27, v136, v67
  v_mul_f32 v66, v66, v34
  v_mul_f32 v67, v67, v35
  v_mul_f32 v128, v66, v66
  v_mul_f32 v129, v67, v67
  v_fma_f32 v128, v128, s48, v126
  v_fma_f32 v129, v129, s48, v126
  v_mul_f32 v128, v128, v66
  v_mul_f32 v129, v129, v67
  v_exp_f32 v128, v128
  v_exp_f32 v129, v129
  v_add_f32 v128, 1.0, v128
  v_add_f32 v129, 1.0, v129
  v_rcp_f32 v128, v128
  v_rcp_f32 v129, v129
  v_mul_f32 v128, v128, v66
  v_mul_f32 v129, v129, v67
  v_cvt_pk_bf16_f32 v114, v128, v129
  v_add_f32 v42, v42, v128
  v_add_f32 v43, v43, v129
  v_fma_f32 v50, v128, v128, v50
  v_fma_f32 v51, v129, v129, v51
  v_fma_f32 v68, v28, v136, v68
  v_fma_f32 v69, v29, v136, v69
  v_mul_f32 v68, v68, v36
  v_mul_f32 v69, v69, v37
  v_mul_f32 v132, v68, v68
  v_mul_f32 v133, v69, v69
  v_fma_f32 v132, v132, s48, v126
  v_fma_f32 v133, v133, s48, v126
  v_mul_f32 v132, v132, v68
  v_mul_f32 v133, v133, v69
  v_exp_f32 v132, v132
  v_exp_f32 v133, v133
  v_add_f32 v132, 1.0, v132
  v_add_f32 v133, 1.0, v133
  v_rcp_f32 v132, v132
  v_rcp_f32 v133, v133
  v_mul_f32 v132, v132, v68
  v_mul_f32 v133, v133, v69
  v_cvt_pk_bf16_f32 v115, v132, v133
  v_add_f32 v44, v44, v132
  v_add_f32 v45, v45, v133
  v_fma_f32 v52, v132, v132, v52
  v_fma_f32 v53, v133, v133, v53
  s_barrier
  v_fma_f32 v78, v30, v136, v78
  v_fma_f32 v79, v31, v136, v79
  v_mul_f32 v78, v78, v38
  v_mul_f32 v79, v79, v39
  v_mul_f32 v128, v78, v78
  v_mul_f32 v129, v79, v79
  v_fma_f32 v128, v128, s48, v126
  v_fma_f32 v129, v129, s48, v126
  v_mul_f32 v128, v128, v78
  v_mul_f32 v129, v129, v79
  v_exp_f32 v128, v128
  v_exp_f32 v129, v129
  v_add_f32 v128, 1.0, v128
  v_add_f32 v129, 1.0, v129
  v_rcp_f32 v128, v128
  v_rcp_f32 v129, v129
  v_mul_f32 v128, v128, v78
  v_mul_f32 v129, v129, v79
  v_cvt_pk_bf16_f32 v116, v128, v129
  v_add_f32 v46, v46, v128
  v_add_f32 v47, v47, v129
  v_fma_f32 v54, v128, v128, v54
  v_fma_f32 v55, v129, v129, v55
  v_fma_f32 v80, v32, v136, v80
  v_fma_f32 v81, v33, v136, v81
  v_mul_f32 v80, v80, v40
  v_mul_f32 v81, v81, v41
  v_mul_f32 v132, v80, v80
  v_mul_f32 v133, v81, v81
  v_fma_f32 v132, v132, s48, v126
  v_fma_f32 v133, v133, s48, v126
  v_mul_f32 v132, v132, v80
  v_mul_f32 v133, v133, v81
  v_exp_f32 v132, v132
  v_exp_f32 v133, v133
  v_add_f32 v132, 1.0, v132
  v_add_f32 v133, 1.0, v133
  v_rcp_f32 v132, v132
  v_rcp_f32 v133, v133
  v_mul_f32 v132, v132, v80
  v_mul_f32 v133, v133, v81
  v_cvt_pk_bf16_f32 v117, v132, v133
  v_add_f32 v48, v48, v132
  v_add_f32 v49, v49, v133
  v_fma_f32 v56, v132, v132, v56
  v_fma_f32 v57, v133, v133, v57
  v_fma_f32 v70, v26, v138, v70
  v_fma_f32 v71, v27, v138, v71
  v_mul_f32 v70, v70, v34
  v_mul_f32 v71, v71, v35
  v_mul_f32 v128, v70, v70
  v_mul_f32 v129, v71, v71
  v_fma_f32 v128, v128, s48, v126
  v_fma_f32 v129, v129, s48, v126
  v_mul_f32 v128, v128, v70
  v_mul_f32 v129, v129, v71
  v_exp_f32 v128, v128
  v_exp_f32 v129, v129
  v_add_f32 v128, 1.0, v128
  v_add_f32 v129, 1.0, v129
  v_rcp_f32 v128, v128
  v_rcp_f32 v129, v129
  v_mul_f32 v128, v128, v70
  v_mul_f32 v129, v129, v71
  v_cvt_pk_bf16_f32 v118, v128, v129
  v_add_f32 v42, v42, v128
  v_add_f32 v43, v43, v129
  v_fma_f32 v50, v128, v128, v50
  v_fma_f32 v51, v129, v129, v51
  s_barrier
  v_fma_f32 v72, v28, v138, v72
  v_fma_f32 v73, v29, v138, v73
  v_mul_f32 v72, v72, v36
  v_mul_f32 v73, v73, v37
  v_mul_f32 v132, v72, v72
  v_mul_f32 v133, v73, v73
  v_fma_f32 v132, v132, s48, v126
  v_fma_f32 v133, v133, s48, v126
  v_mul_f32 v132, v132, v72
  v_mul_f32 v133, v133, v73
  v_exp_f32 v132, v132
  v_exp_f32 v133, v133
  v_add_f32 v132, 1.0, v132
  v_add_f32 v133, 1.0, v133
  v_rcp_f32 v132, v132
  v_rcp_f32 v133, v133
  v_mul_f32 v132, v132, v72
  v_mul_f32 v133, v133, v73
  v_cvt_pk_bf16_f32 v119, v132, v133
  v_add_f32 v44, v44, v132
  v_add_f32 v45, v45, v133
  v_fma_f32 v52, v132, v132, v52
  v_fma_f32 v53, v133, v133, v53
  v_fma_f32 v82, v30, v138, v82
  v_fma_f32 v83, v31, v138, v83
  v_mul_f32 v82, v82, v38
  v_mul_f32 v83, v83, v39
  v_mul_f32 v128, v82, v82
  v_mul_f32 v129, v83, v83
  v_fma_f32 v128, v128, s48, v126
  v_fma_f32 v129, v129, s48, v126
  v_mul_f32 v128, v128, v82
  v_mul_f32 v129, v129, v83
  v_exp_f32 v128, v128
  v_exp_f32 v129, v129
  v_add_f32 v128, 1.0, v128
  v_add_f32 v129, 1.0, v129
  v_rcp_f32 v128, v128
  v_rcp_f32 v129, v129
  v_mul_f32 v128, v128, v82
  v_mul_f32 v129, v129, v83
  v_cvt_pk_bf16_f32 v120, v128, v129
  v_add_f32 v46, v46, v128
  v_add_f32 v47, v47, v129
  v_fma_f32 v54, v128, v128, v54
  v_fma_f32 v55, v129, v129, v55
  s_barrier
  v_fma_f32 v84, v32, v138, v84
  v_fma_f32 v85, v33, v138, v85
  v_mul_f32 v84, v84, v40
  v_mul_f32 v85, v85, v41
  v_mul_f32 v132, v84, v84
  v_mul_f32 v133, v85, v85
  v_fma_f32 v132, v132, s48, v126
  v_fma_f32 v133, v133, s48, v126
  v_mul_f32 v132, v132, v84
  v_mul_f32 v133, v133, v85
  v_exp_f32 v132, v132
  v_exp_f32 v133, v133
  v_add_f32 v132, 1.0, v132
  v_add_f32 v133, 1.0, v133
  v_rcp_f32 v132, v132
  v_rcp_f32 v133, v133
  v_mul_f32 v132, v132, v84
  v_mul_f32 v133, v133, v85
  v_cvt_pk_bf16_f32 v121, v132, v133
  v_add_f32 v48, v48, v132
  v_add_f32 v49, v49, v133
  v_fma_f32 v56, v132, v132, v56
  v_fma_f32 v57, v133, v133, v57
  v_fma_f32 v74, v26, v140, v74
  v_fma_f32 v75, v27, v140, v75
  v_mul_f32 v74, v74, v34
  v_mul_f32 v75, v75, v35
  v_mul_f32 v128, v74, v74
  v_mul_f32 v129, v75, v75
  v_fma_f32 v128, v128, s48, v126
  v_fma_f32 v129, v129, s48, v126
  v_mul_f32 v128, v128, v74
  v_mul_f32 v129, v129, v75
  v_exp_f32 v128, v128
  v_exp_f32 v129, v129
  v_add_f32 v128, 1.0, v128
  v_add_f32 v129, 1.0, v129
  v_rcp_f32 v128, v128
  v_rcp_f32 v129, v129
  v_mul_f32 v128, v128, v74
  v_mul_f32 v129, v129, v75
  v_cvt_pk_bf16_f32 v122, v128, v129
  v_add_f32 v42, v42, v128
  v_add_f32 v43, v43, v129
  v_fma_f32 v50, v128, v128, v50
  v_fma_f32 v51, v129, v129, v51
  v_fma_f32 v76, v28, v140, v76
  v_fma_f32 v77, v29, v140, v77
  v_mul_f32 v76, v76, v36
  v_mul_f32 v77, v77, v37
  v_mul_f32 v132, v76, v76
  v_mul_f32 v133, v77, v77
  v_fma_f32 v132, v132, s48, v126
  v_fma_f32 v133, v133, s48, v126
  v_mul_f32 v132, v132, v76
  v_mul_f32 v133, v133, v77
  v_exp_f32 v132, v132
  v_exp_f32 v133, v133
  v_add_f32 v132, 1.0, v132
  v_add_f32 v133, 1.0, v133
  v_rcp_f32 v132, v132
  v_rcp_f32 v133, v133
  v_mul_f32 v132, v132, v76
  v_mul_f32 v133, v133, v77
  v_cvt_pk_bf16_f32 v123, v132, v133
  v_add_f32 v44, v44, v132
  v_add_f32 v45, v45, v133
  v_fma_f32 v52, v132, v132, v52
  v_fma_f32 v53, v133, v133, v53
  s_barrier
  v_fma_f32 v86, v30, v140, v86
  v_fma_f32 v87, v31, v140, v87
  v_mul_f32 v86, v86, v38
  v_mul_f32 v87, v87, v39
  v_mul_f32 v128, v86, v86
  v_mul_f32 v129, v87, v87
  v_fma_f32 v128, v128, s48, v126
  v_fma_f32 v129, v129, s48, v126
  v_mul_f32 v128, v128, v86
  v_mul_f32 v129, v129, v87
  v_exp_f32 v128, v128
  v_exp_f32 v129, v129
  v_add_f32 v128, 1.0, v128
  v_add_f32 v129, 1.0, v129
  v_rcp_f32 v128, v128
  v_rcp_f32 v129, v129
  v_mul_f32 v128, v128, v86
  v_mul_f32 v129, v129, v87
  v_cvt_pk_bf16_f32 v124, v128, v129
  v_add_f32 v46, v46, v128
  v_add_f32 v47, v47, v129
  v_fma_f32 v54, v128, v128, v54
  v_fma_f32 v55, v129, v129, v55
  v_fma_f32 v88, v32, v140, v88
  v_fma_f32 v89, v33, v140, v89
  v_mul_f32 v88, v88, v40
  v_mul_f32 v89, v89, v41
  v_mul_f32 v132, v88, v88
  v_mul_f32 v133, v89, v89
  v_fma_f32 v132, v132, s48, v126
  v_fma_f32 v133, v133, s48, v126
  v_mul_f32 v132, v132, v88
  v_mul_f32 v133, v133, v89
  v_exp_f32 v132, v132
  v_exp_f32 v133, v133
  v_add_f32 v132, 1.0, v132
  v_add_f32 v133, 1.0, v133
  v_rcp_f32 v132, v132
  v_rcp_f32 v133, v133
  v_mul_f32 v132, v132, v88
  v_mul_f32 v133, v133, v89
  v_cvt_pk_bf16_f32 v125, v132, v133
  v_add_f32 v48, v48, v132
  v_add_f32 v49, v49, v133
  v_fma_f32 v56, v132, v132, v56
  v_fma_f32 v57, v133, v133, v57
  s_barrier
  v_add_f32_dpp v42, v42, v42 row_ror:8 row_mask:0xf bank_mask:0xf
  v_add_f32_dpp v43, v43, v43 row_ror:8 row_mask:0xf bank_mask:0xf
  v_add_f32_dpp v44, v44, v44 row_ror:8 row_mask:0xf bank_mask:0xf
  v_add_f32_dpp v45, v45, v45 row_ror:8 row_mask:0xf bank_mask:0xf
  v_add_f32_dpp v46, v46, v46 row_ror:8 row_mask:0xf bank_mask:0xf
  v_add_f32_dpp v47, v47, v47 row_ror:8 row_mask:0xf bank_mask:0xf
  v_add_f32_dpp v48, v48, v48 row_ror:8 row_mask:0xf bank_mask:0xf
  v_add_f32_dpp v49, v49, v49 row_ror:8 row_mask:0xf bank_mask:0xf
  v_add_f32_dpp v50, v50, v50 row_ror:8 row_mask:0xf bank_mask:0xf
  v_add_f32_dpp v51, v51, v51 row_ror:8 row_mask:0xf bank_mask:0xf
  v_add_f32_dpp v52, v52, v52 row_ror:8 row_mask:0xf bank_mask:0xf
  v_add_f32_dpp v53, v53, v53 row_ror:8 row_mask:0xf bank_mask:0xf
  v_add_f32_dpp v54, v54, v54 row_ror:8 row_mask:0xf bank_mask:0xf
  v_add_f32_dpp v55, v55, v55 row_ror:8 row_mask:0xf bank_mask:0xf
  v_add_f32_dpp v56, v56, v56 row_ror:8 row_mask:0xf bank_mask:0xf
  v_add_f32_dpp v57, v57, v57 row_ror:8 row_mask:0xf bank_mask:0xf
  v_add_f32_dpp v42, v42, v42 row_ror:4 row_mask:0xf bank_mask:0xf
  v_add_f32_dpp v43, v43, v43 row_ror:4 row_mask:0xf bank_mask:0xf
  v_add_f32_dpp v44, v44, v44 row_ror:4 row_mask:0xf bank_mask:0xf
  v_add_f32_dpp v45, v45, v45 row_ror:4 row_mask:0xf bank_mask:0xf
  v_add_f32_dpp v46, v46, v46 row_ror:4 row_mask:0xf bank_mask:0xf
  v_add_f32_dpp v47, v47, v47 row_ror:4 row_mask:0xf bank_mask:0xf
  v_add_f32_dpp v48, v48, v48 row_ror:4 row_mask:0xf bank_mask:0xf
  v_add_f32_dpp v49, v49, v49 row_ror:4 row_mask:0xf bank_mask:0xf
  v_add_f32_dpp v50, v50, v50 row_ror:4 row_mask:0xf bank_mask:0xf
  v_add_f32_dpp v51, v51, v51 row_ror:4 row_mask:0xf bank_mask:0xf
  v_add_f32_dpp v52, v52, v52 row_ror:4 row_mask:0xf bank_mask:0xf
  v_add_f32_dpp v53, v53, v53 row_ror:4 row_mask:0xf bank_mask:0xf
  v_add_f32_dpp v54, v54, v54 row_ror:4 row_mask:0xf bank_mask:0xf
  v_add_f32_dpp v55, v55, v55 row_ror:4 row_mask:0xf bank_mask:0xf
  v_add_f32_dpp v56, v56, v56 row_ror:4 row_mask:0xf bank_mask:0xf
  v_add_f32_dpp v57, v57, v57 row_ror:4 row_mask:0xf bank_mask:0xf
  v_add_f32_dpp v42, v42, v42 row_ror:2 row_mask:0xf bank_mask:0xf
  v_add_f32_dpp v43, v43, v43 row_ror:2 row_mask:0xf bank_mask:0xf
  v_add_f32_dpp v44, v44, v44 row_ror:2 row_mask:0xf bank_mask:0xf
  v_add_f32_dpp v45, v45, v45 row_ror:2 row_mask:0xf bank_mask:0xf
  v_add_f32_dpp v46, v46, v46 row_ror:2 row_mask:0xf bank_mask:0xf
  v_add_f32_dpp v47, v47, v47 row_ror:2 row_mask:0xf bank_mask:0xf
  v_add_f32_dpp v48, v48, v48 row_ror:2 row_mask:0xf bank_mask:0xf
  v_add_f32_dpp v49, v49, v49 row_ror:2 row_mask:0xf bank_mask:0xf
  v_add_f32_dpp v50, v50, v50 row_ror:2 row_mask:0xf bank_mask:0xf
  v_add_f32_dpp v51, v51, v51 row_ror:2 row_mask:0xf bank_mask:0xf
  v_add_f32_dpp v52, v52, v52 row_ror:2 row_mask:0xf bank_mask:0xf
  v_add_f32_dpp v53, v53, v53 row_ror:2 row_mask:0xf bank_mask:0xf
  v_add_f32_dpp v54, v54, v54 row_ror:2 row_mask:0xf bank_mask:0xf
  v_add_f32_dpp v55, v55, v55 row_ror:2 row_mask:0xf bank_mask:0xf
  v_add_f32_dpp v56, v56, v56 row_ror:2 row_mask:0xf bank_mask:0xf
  v_add_f32_dpp v57, v57, v57 row_ror:2 row_mask:0xf bank_mask:0xf
  v_add_f32_dpp v42, v42, v42 row_ror:1 row_mask:0xf bank_mask:0xf
  v_add_f32_dpp v43, v43, v43 row_ror:1 row_mask:0xf bank_mask:0xf
  v_add_f32_dpp v44, v44, v44 row_ror:1 row_mask:0xf bank_mask:0xf
  v_add_f32_dpp v45, v45, v45 row_ror:1 row_mask:0xf bank_mask:0xf
  v_add_f32_dpp v46, v46, v46 row_ror:1 row_mask:0xf bank_mask:0xf
  v_add_f32_dpp v47, v47, v47 row_ror:1 row_mask:0xf bank_mask:0xf
  v_add_f32_dpp v48, v48, v48 row_ror:1 row_mask:0xf bank_mask:0xf
  v_add_f32_dpp v49, v49, v49 row_ror:1 row_mask:0xf bank_mask:0xf
  v_add_f32_dpp v50, v50, v50 row_ror:1 row_mask:0xf bank_mask:0xf
  v_add_f32_dpp v51, v51, v51 row_ror:1 row_mask:0xf bank_mask:0xf
  v_add_f32_dpp v52, v52, v52 row_ror:1 row_mask:0xf bank_mask:0xf
  v_add_f32_dpp v53, v53, v53 row_ror:1 row_mask:0xf bank_mask:0xf
  v_add_f32_dpp v54, v54, v54 row_ror:1 row_mask:0xf bank_mask:0xf
  v_add_f32_dpp v55, v55, v55 row_ror:1 row_mask:0xf bank_mask:0xf
  v_add_f32_dpp v56, v56, v56 row_ror:1 row_mask:0xf bank_mask:0xf
  v_add_f32_dpp v57, v57, v57 row_ror:1 row_mask:0xf bank_mask:0xf
  s_lshl_b32 s40, s36, 8
  s_add_u32 s40, s40, 2048
  v_add_u32 v19, s40, v19
  v_add_u32 v20, s40, v20
  s_mov_b32 exec_lo, 0x10001
  s_mov_b32 exec_hi, 0x10001
  ds_write_b128 v19, v[42:45]
  ds_write_b128 v20, v[46:49]
  ds_write_b128 v19, v[50:53] offset:512
  ds_write_b128 v20, v[54:57] offset:512
  s_mov_b64 exec, s[52:53]
  s_waitcnt lgkmcnt(0)
  s_barrier
  s_cmp_eq_u32 s34, 0
  s_cbranch_scc0 K1_NOPUB
  v_lshlrev_b32 v14, 2, v1
  v_add_u32 v14, 145408, v14
  ds_read_b32 v16, v14
  ds_read_b32 v18, v14 offset:256
  ds_read_b32 v17, v14 offset:512
  ds_read_b32 v19, v14 offset:768
  s_lshl_b32 s40, s32, 3
  s_add_u32 s40, s40, s33
  s_lshl_b32 s40, s40, 9
  s_add_u32 s40, s40, 16842752
  v_lshlrev_b32 v15, 3, v1
  s_waitcnt lgkmcnt(0)
  v_add_f32 v16, v16, v18
  v_add_f32 v17, v17, v19
  v_max_f32 v17, 0, v17
  buffer_store_dwordx2 v[16:17], v15, s[16:19], s40 offen sc1
K1_NOPUB:
  s_mul_i32 s40, s33, 6
  s_mul_i32 s41, s36, 3
  s_add_u32 s40, s40, s41
  s_lshl_b32 s40, s40, 6
  s_lshl_b32 s41, s32, 1
  s_add_u32 s40, s40, s41
  s_add_u32 s40, s40, s35
  s_lshl_b32 s40, s40, 10
  s_add_u32 s39, s40, 3145728
  v_and_b32 v21, 1, v2
  v_lshlrev_b32 v21, 1, v21
  v_lshrrev_b32 v24, 1, v2
  v_or_b32 v21, v21, v24
  s_lshl_b32 s41, s36, 1
  v_xor_b32 v21, s41, v21
  v_lshlrev_b32 v21, 4, v21
  v_add_u32 v21, v21, v3
  v_lshlrev_b32 v21, 4, v21
  v_and_b32 v24, 31, v1
  s_lshl_b32 s38, s35, 5
  v_add_u32 v24, s38, v24
  v_lshlrev_b32 v24, 3, v24
  s_lshl_b32 s38, s32, 12
  s_add_u32 s38, s38, 16842752
  buffer_load_dword v23, v22, s[4:7], 0 offen offset:0 sc1
  s_barrier
  s_barrier
  s_barrier
  s_waitcnt vmcnt(0)
  s_mov_b32 s54, 0
K1_CCHK:
  v_readfirstlane_b32 s40, v23
  s_nop 0
  s_cmp_ge_u32 s40, 8
  s_cbranch_scc1 K1_COK
  s_add_u32 s54, s54, 1
  s_cmp_lt_u32 s54, 0x200000
  s_cbranch_scc0 K1_COK
  s_sleep 4
  buffer_load_dword v23, v22, s[4:7], 0 offen offset:0 sc1
  s_waitcnt vmcnt(0)
  s_branch K1_CCHK
K1_COK:
  buffer_load_dwordx2 v[44:45], v24, s[16:19], s38 offen offset:0 sc1
  buffer_load_dwordx2 v[46:47], v24, s[16:19], s38 offen offset:512 sc1
  buffer_load_dwordx2 v[48:49], v24, s[16:19], s38 offen offset:1024 sc1
  buffer_load_dwordx2 v[50:51], v24, s[16:19], s38 offen offset:1536 sc1
  buffer_load_dwordx2 v[52:53], v24, s[16:19], s38 offen offset:2048 sc1
  buffer_load_dwordx2 v[54:55], v24, s[16:19], s38 offen offset:2560 sc1
  buffer_load_dwordx2 v[56:57], v24, s[16:19], s38 offen offset:3072 sc1
  buffer_load_dwordx2 v[58:59], v24, s[16:19], s38 offen offset:3584 sc1
  s_barrier
  s_setprio 0
  s_waitcnt vmcnt(0)
  s_mov_b32 s54, 0
K1_CHECK:
  s_mov_b32 s40, 0xbf800000
  v_cmp_eq_u32 vcc, s40, v45
  v_cmp_eq_u32 s[56:57], s40, v47
  s_nop 0
  s_or_b64 vcc, vcc, s[56:57]
  v_cmp_eq_u32 s[56:57], s40, v49
  s_nop 0
  s_or_b64 vcc, vcc, s[56:57]
  v_cmp_eq_u32 s[56:57], s40, v51
  s_nop 0
  s_or_b64 vcc, vcc, s[56:57]
  v_cmp_eq_u32 s[56:57], s40, v53
  s_nop 0
  s_or_b64 vcc, vcc, s[56:57]
  v_cmp_eq_u32 s[56:57], s40, v55
  s_nop 0
  s_or_b64 vcc, vcc, s[56:57]
  v_cmp_eq_u32 s[56:57], s40, v57
  s_nop 0
  s_or_b64 vcc, vcc, s[56:57]
  v_cmp_eq_u32 s[56:57], s40, v59
  s_nop 0
  s_or_b64 vcc, vcc, s[56:57]
  s_cmp_eq_u64 vcc, 0
  s_cbranch_scc1 K1_POLLED
  s_add_u32 s54, s54, 1
  s_cmp_lt_u32 s54, 0x200000
  s_cbranch_scc0 K1_POLLED
  buffer_load_dwordx2 v[44:45], v24, s[16:19], s38 offen offset:0 sc1
  buffer_load_dwordx2 v[46:47], v24, s[16:19], s38 offen offset:512 sc1
  buffer_load_dwordx2 v[48:49], v24, s[16:19], s38 offen offset:1024 sc1
  buffer_load_dwordx2 v[50:51], v24, s[16:19], s38 offen offset:1536 sc1
  buffer_load_dwordx2 v[52:53], v24, s[16:19], s38 offen offset:2048 sc1
  buffer_load_dwordx2 v[54:55], v24, s[16:19], s38 offen offset:2560 sc1
  buffer_load_dwordx2 v[56:57], v24, s[16:19], s38 offen offset:3072 sc1
  buffer_load_dwordx2 v[58:59], v24, s[16:19], s38 offen offset:3584 sc1
  s_waitcnt vmcnt(0)
  s_branch K1_CHECK
K1_POLLED:
  v_pk_add_f32 v[44:45], v[44:45], v[46:47]
  v_pk_add_f32 v[44:45], v[44:45], v[48:49]
  v_pk_add_f32 v[44:45], v[44:45], v[50:51]
  v_pk_add_f32 v[44:45], v[44:45], v[52:53]
  v_pk_add_f32 v[44:45], v[44:45], v[54:55]
  v_pk_add_f32 v[44:45], v[44:45], v[56:57]
  v_pk_add_f32 v[44:45], v[44:45], v[58:59]
  v_mul_f32 v16, 0x3aaaaaab, v44
  v_mul_f32 v18, 0x3aaaaaab, v45
  v_fma_f32 v18, -v16, v16, v18
  v_max_f32 v18, 0, v18
  v_cvt_pk_bf16_f32 v16, v16, v16
  v_lshlrev_b32 v16, 16, v16
  v_cvt_pk_bf16_f32 v18, v18, v18
  v_lshlrev_b32 v18, 16, v18
  v_add_f32 v18, 0x3727c5ac, v18
  v_cvt_pk_bf16_f32 v18, v18, v18
  v_lshlrev_b32 v18, 16, v18
  v_sqrt_f32 v18, v18
  s_nop 0
  v_cvt_pk_bf16_f32 v18, v18, v18
  v_lshlrev_b32 v18, 16, v18
  v_rcp_f32 v17, v18
  s_nop 0
  v_mul_f32 v16, v16, v17
  v_sub_f32 v16, 0, v16
  s_lshl_b32 s40, s55, 8
  s_add_u32 s40, s40, 146432
  v_and_b32 v18, 31, v1
  v_lshlrev_b32 v18, 2, v18
  v_add_u32 v18, s40, v18
  ds_write_b32 v18, v16
  ds_write_b32 v18, v17 offset:128
  s_lshl_b32 s41, s36, 6
  s_add_u32 s40, s40, s41
  v_lshlrev_b32 v19, 4, v2
  v_add_u32 v19, s40, v19
  v_xor_b32 v20, 64, v19
  s_waitcnt lgkmcnt(0)
  ds_read_b128 v[26:29], v19
  ds_read_b128 v[30:33], v20
  ds_read_b128 v[34:37], v19 offset:128
  ds_read_b128 v[38:41], v20 offset:128
  s_waitcnt lgkmcnt(0)
  v_lshlrev_b32 v128, 16, v114
  v_and_b32 v129, s47, v114
  v_pk_fma_f32 v[128:129], v[128:129], v[34:35], v[26:27]
  v_cvt_pk_bf16_f32 v114, v128, v129
  v_lshlrev_b32 v132, 16, v115
  v_and_b32 v133, s47, v115
  v_pk_fma_f32 v[132:133], v[132:133], v[36:37], v[28:29]
  v_cvt_pk_bf16_f32 v115, v132, v133
  v_lshlrev_b32 v128, 16, v116
  v_and_b32 v129, s47, v116
  v_pk_fma_f32 v[128:129], v[128:129], v[38:39], v[30:31]
  v_cvt_pk_bf16_f32 v116, v128, v129
  v_lshlrev_b32 v132, 16, v117
  v_and_b32 v133, s47, v117
  v_pk_fma_f32 v[132:133], v[132:133], v[40:41], v[32:33]
  v_cvt_pk_bf16_f32 v117, v132, v133
  v_permlane16_swap_b32 v114, v116
  s_nop 0
  v_permlane16_swap_b32 v115, v117
  s_add_u32 s41, s39, 0
  buffer_store_dwordx4 v[114:117], v21, s[16:19], s41 offen sc1
  v_lshlrev_b32 v128, 16, v118
  v_and_b32 v129, s47, v118
  v_pk_fma_f32 v[128:129], v[128:129], v[34:35], v[26:27]
  v_cvt_pk_bf16_f32 v118, v128, v129
  v_lshlrev_b32 v132, 16, v119
  v_and_b32 v133, s47, v119
  v_pk_fma_f32 v[132:133], v[132:133], v[36:37], v[28:29]
  v_cvt_pk_bf16_f32 v119, v132, v133
  v_lshlrev_b32 v128, 16, v120
  v_and_b32 v129, s47, v120
  v_pk_fma_f32 v[128:129], v[128:129], v[38:39], v[30:31]
  v_cvt_pk_bf16_f32 v120, v128, v129
  v_lshlrev_b32 v132, 16, v121
  v_and_b32 v133, s47, v121
  v_pk_fma_f32 v[132:133], v[132:133], v[40:41], v[32:33]
  v_cvt_pk_bf16_f32 v121, v132, v133
  v_permlane16_swap_b32 v118, v120
  s_nop 0
  v_permlane16_swap_b32 v119, v121
  s_add_u32 s41, s39, 65536
  buffer_store_dwordx4 v[118:121], v21, s[16:19], s41 offen sc1
  v_lshlrev_b32 v128, 16, v122
  v_and_b32 v129, s47, v122
  v_pk_fma_f32 v[128:129], v[128:129], v[34:35], v[26:27]
  v_cvt_pk_bf16_f32 v122, v128, v129
  v_lshlrev_b32 v132, 16, v123
  v_and_b32 v133, s47, v123
  v_pk_fma_f32 v[132:133], v[132:133], v[36:37], v[28:29]
  v_cvt_pk_bf16_f32 v123, v132, v133
  v_lshlrev_b32 v128, 16, v124
  v_and_b32 v129, s47, v124
  v_pk_fma_f32 v[128:129], v[128:129], v[38:39], v[30:31]
  v_cvt_pk_bf16_f32 v124, v128, v129
  v_lshlrev_b32 v132, 16, v125
  v_and_b32 v133, s47, v125
  v_pk_fma_f32 v[132:133], v[132:133], v[40:41], v[32:33]
  v_cvt_pk_bf16_f32 v125, v132, v133
  v_permlane16_swap_b32 v122, v124
  s_nop 0
  v_permlane16_swap_b32 v123, v125
  s_add_u32 s41, s39, 131072
  buffer_store_dwordx4 v[122:125], v21, s[16:19], s41 offen sc1
  s_waitcnt vmcnt(0)
  s_barrier
  s_load_dwordx2 s[56:57], s[0:1], 72
  s_and_b32 s35, s34, 1
  s_lshr_b32 s36, s34, 1
  v_xor_b32 v9, v2, v3
  v_lshlrev_b32 v9, 4, v9
  s_lshl_b32 s40, s36, 6
  v_xor_b32 v9, s40, v9
  v_lshlrev_b32 v10, 8, v3
  v_add_u32 v4, v9, v10
  v_xor_b32 v5, 128, v4
  s_mul_i32 s40, s33, 6
  s_mul_i32 s41, s35, 3
  s_add_u32 s40, s40, s41
  s_lshl_b32 s40, s40, 16
  s_add_u32 s40, s40, 3145728
  v_lshlrev_b32 v9, 4, v1
  s_add_u32 s41, s40, 0
  v_add_u32 v6, s41, v9
  s_add_u32 s41, s40, 65536
  v_add_u32 v7, s41, v9
  s_add_u32 s41, s40, 131072
  v_add_u32 v8, s41, v9
  s_lshl_b32 s39, s36, 10
  v_mov_b32 v48, 0
  v_mov_b32 v49, 0
  v_mov_b32 v50, 0
  v_mov_b32 v51, 0
  v_mov_b32 v52, 0
  v_mov_b32 v53, 0
  v_mov_b32 v54, 0
  v_mov_b32 v55, 0
  v_mov_b32 v56, 0
  v_mov_b32 v57, 0
  v_mov_b32 v58, 0
  v_mov_b32 v59, 0
  v_mov_b32 v60, 0
  v_mov_b32 v61, 0
  v_mov_b32 v62, 0
  v_mov_b32 v63, 0
  v_mov_b32 v64, 0
  v_mov_b32 v65, 0
  v_mov_b32 v66, 0
  v_mov_b32 v67, 0
  v_mov_b32 v68, 0
  v_mov_b32 v69, 0
  v_mov_b32 v70, 0
  v_mov_b32 v71, 0
  v_mov_b32 v72, 0
  v_mov_b32 v73, 0
  v_mov_b32 v74, 0
  v_mov_b32 v75, 0
  v_mov_b32 v76, 0
  v_mov_b32 v77, 0
  v_mov_b32 v78, 0
  v_mov_b32 v79, 0
  v_mov_b32 v80, 0
  v_mov_b32 v81, 0
  v_mov_b32 v82, 0
  v_mov_b32 v83, 0
  v_mov_b32 v84, 0
  v_mov_b32 v85, 0
  v_mov_b32 v86, 0
  v_mov_b32 v87, 0
  v_mov_b32 v88, 0
  v_mov_b32 v89, 0
  v_mov_b32 v90, 0
  v_mov_b32 v91, 0
  v_mov_b32 v92, 0
  v_mov_b32 v93, 0
  v_mov_b32 v94, 0
  v_mov_b32 v95, 0
  s_waitcnt lgkmcnt(0)
  s_mov_b32 s12, s56
  s_and_b32 s13, s57, 0xffff
  s_mov_b32 s14, 4096
  s_mov_b32 s15, 0x20000
  s_barrier
  s_add_u32 s38, s39, 0
  buffer_load_dwordx4 v[96:99], v6, s[16:19], s38 offen sc1
  buffer_load_dwordx4 v[100:103], v7, s[16:19], s38 offen sc1
  buffer_load_dwordx4 v[104:107], v8, s[16:19], s38 offen sc1
  s_add_u32 s38, s39, 2048
  buffer_load_dwordx4 v[108:111], v6, s[16:19], s38 offen sc1
  buffer_load_dwordx4 v[112:115], v7, s[16:19], s38 offen sc1
  buffer_load_dwordx4 v[116:119], v8, s[16:19], s38 offen sc1
  s_add_u32 s38, s39, 4096
  buffer_load_dwordx4 v[120:123], v6, s[16:19], s38 offen sc1
  buffer_load_dwordx4 v[124:127], v7, s[16:19], s38 offen sc1
  buffer_load_dwordx4 v[128:131], v8, s[16:19], s38 offen sc1
  s_add_u32 s38, s39, 6144
  buffer_load_dwordx4 v[132:135], v6, s[16:19], s38 offen sc1
  buffer_load_dwordx4 v[136:139], v7, s[16:19], s38 offen sc1
  buffer_load_dwordx4 v[140:143], v8, s[16:19], s38 offen sc1
  s_add_u32 s38, s39, 8192
  buffer_load_dwordx4 v[144:147], v6, s[16:19], s38 offen sc1
  buffer_load_dwordx4 v[148:151], v7, s[16:19], s38 offen sc1
  buffer_load_dwordx4 v[152:155], v8, s[16:19], s38 offen sc1
  s_mov_b32 s37, 0
  ds_read_b128 v[16:19], v4 offset:0
  ds_read_b128 v[20:23], v4 offset:4096
  ds_read_b128 v[24:27], v4 offset:8192
  ds_read_b128 v[28:31], v4 offset:12288
F2_GLOOP:
  s_lshl_b32 s40, s37, 1
  s_add_u32 s40, s40, 5
  s_lshl_b32 s38, s40, 11
  s_add_u32 s38, s38, s39
  s_cmp_lt_u32 s40, 32
  s_cselect_b32 s38, s38, 0x80000000
  s_waitcnt vmcnt(12) lgkmcnt(0)
  v_mfma_f32_16x16x32_bf16 v[48:51], v[96:99], v[16:19], v[48:51]
  ds_read_b128 v[32:35], v5 offset:0
  v_mfma_f32_16x16x32_bf16 v[64:67], v[100:103], v[16:19], v[64:67]
  ds_read_b128 v[36:39], v5 offset:4096
  v_mfma_f32_16x16x32_bf16 v[80:83], v[104:107], v[16:19], v[80:83]
  ds_read_b128 v[40:43], v5 offset:8192
  v_mfma_f32_16x16x32_bf16 v[52:55], v[96:99], v[20:23], v[52:55]
  ds_read_b128 v[44:47], v5 offset:12288
  v_mfma_f32_16x16x32_bf16 v[68:71], v[100:103], v[20:23], v[68:71]
  buffer_load_dwordx4 v[156:159], v6, s[16:19], s38 offen sc1
  v_mfma_f32_16x16x32_bf16 v[84:87], v[104:107], v[20:23], v[84:87]
  v_mfma_f32_16x16x32_bf16 v[56:59], v[96:99], v[24:27], v[56:59]
  buffer_load_dwordx4 v[160:163], v7, s[16:19], s38 offen sc1
  v_mfma_f32_16x16x32_bf16 v[72:75], v[100:103], v[24:27], v[72:75]
  v_mfma_f32_16x16x32_bf16 v[88:91], v[104:107], v[24:27], v[88:91]
  buffer_load_dwordx4 v[164:167], v8, s[16:19], s38 offen sc1
  v_mfma_f32_16x16x32_bf16 v[60:63], v[96:99], v[28:31], v[60:63]
  v_mfma_f32_16x16x32_bf16 v[76:79], v[100:103], v[28:31], v[76:79]
  v_mfma_f32_16x16x32_bf16 v[92:95], v[104:107], v[28:31], v[92:95]
  s_and_b32 s40, s37, 3
  s_movk_i32 s43, 16384
  s_cmp_eq_u32 s40, 3
  s_cselect_b32 s43, 4294918144, s43
  s_lshl_b32 s40, s37, 1
  s_add_u32 s40, s40, 6
  s_lshl_b32 s38, s40, 11
  s_add_u32 s38, s38, s39
  s_cmp_lt_u32 s40, 32
  s_cselect_b32 s38, s38, 0x80000000
  s_waitcnt lgkmcnt(0)
  s_barrier
  v_add_u32 v4, s43, v4
  s_waitcnt vmcnt(12)
  v_mfma_f32_16x16x32_bf16 v[48:51], v[108:111], v[32:35], v[48:51]
  ds_read_b128 v[16:19], v4 offset:0
  v_mfma_f32_16x16x32_bf16 v[64:67], v[112:115], v[32:35], v[64:67]
  ds_read_b128 v[20:23], v4 offset:4096
  v_mfma_f32_16x16x32_bf16 v[80:83], v[116:119], v[32:35], v[80:83]
  ds_read_b128 v[24:27], v4 offset:8192
  v_mfma_f32_16x16x32_bf16 v[52:55], v[108:111], v[36:39], v[52:55]
  ds_read_b128 v[28:31], v4 offset:12288
  v_mfma_f32_16x16x32_bf16 v[68:71], v[112:115], v[36:39], v[68:71]
  buffer_load_dwordx4 v[96:99], v6, s[16:19], s38 offen sc1
  v_mfma_f32_16x16x32_bf16 v[84:87], v[116:119], v[36:39], v[84:87]
  v_mfma_f32_16x16x32_bf16 v[56:59], v[108:111], v[40:43], v[56:59]
  buffer_load_dwordx4 v[100:103], v7, s[16:19], s38 offen sc1
  v_mfma_f32_16x16x32_bf16 v[72:75], v[112:115], v[40:43], v[72:75]
  v_mfma_f32_16x16x32_bf16 v[88:91], v[116:119], v[40:43], v[88:91]
  buffer_load_dwordx4 v[104:107], v8, s[16:19], s38 offen sc1
  v_mfma_f32_16x16x32_bf16 v[60:63], v[108:111], v[44:47], v[60:63]
  v_mfma_f32_16x16x32_bf16 v[76:79], v[112:115], v[44:47], v[76:79]
  v_mfma_f32_16x16x32_bf16 v[92:95], v[116:119], v[44:47], v[92:95]
  v_add_u32 v5, s43, v5
  s_add_u32 s37, s37, 1
  s_cmp_eq_u32 s37, 16
  s_cbranch_scc1 F2_GDONE
  s_lshl_b32 s40, s37, 1
  s_add_u32 s40, s40, 5
  s_lshl_b32 s38, s40, 11
  s_add_u32 s38, s38, s39
  s_cmp_lt_u32 s40, 32
  s_cselect_b32 s38, s38, 0x80000000
  s_waitcnt vmcnt(12) lgkmcnt(0)
  v_mfma_f32_16x16x32_bf16 v[48:51], v[120:123], v[16:19], v[48:51]
  ds_read_b128 v[32:35], v5 offset:0
  v_mfma_f32_16x16x32_bf16 v[64:67], v[124:127], v[16:19], v[64:67]
  ds_read_b128 v[36:39], v5 offset:4096
  v_mfma_f32_16x16x32_bf16 v[80:83], v[128:131], v[16:19], v[80:83]
  ds_read_b128 v[40:43], v5 offset:8192
  v_mfma_f32_16x16x32_bf16 v[52:55], v[120:123], v[20:23], v[52:55]
  ds_read_b128 v[44:47], v5 offset:12288
  v_mfma_f32_16x16x32_bf16 v[68:71], v[124:127], v[20:23], v[68:71]
  buffer_load_dwordx4 v[108:111], v6, s[16:19], s38 offen sc1
  v_mfma_f32_16x16x32_bf16 v[84:87], v[128:131], v[20:23], v[84:87]
  v_mfma_f32_16x16x32_bf16 v[56:59], v[120:123], v[24:27], v[56:59]
  buffer_load_dwordx4 v[112:115], v7, s[16:19], s38 offen sc1
  v_mfma_f32_16x16x32_bf16 v[72:75], v[124:127], v[24:27], v[72:75]
  v_mfma_f32_16x16x32_bf16 v[88:91], v[128:131], v[24:27], v[88:91]
  buffer_load_dwordx4 v[116:119], v8, s[16:19], s38 offen sc1
  v_mfma_f32_16x16x32_bf16 v[60:63], v[120:123], v[28:31], v[60:63]
  v_mfma_f32_16x16x32_bf16 v[76:79], v[124:127], v[28:31], v[76:79]
  v_mfma_f32_16x16x32_bf16 v[92:95], v[128:131], v[28:31], v[92:95]
  s_and_b32 s40, s37, 3
  s_movk_i32 s43, 16384
  s_cmp_eq_u32 s40, 3
  s_cselect_b32 s43, 4294918144, s43
  s_lshl_b32 s40, s37, 1
  s_add_u32 s40, s40, 6
  s_lshl_b32 s38, s40, 11
  s_add_u32 s38, s38, s39
  s_cmp_lt_u32 s40, 32
  s_cselect_b32 s38, s38, 0x80000000
  s_waitcnt lgkmcnt(0)
  s_barrier
  v_add_u32 v4, s43, v4
  s_waitcnt vmcnt(12)
  v_mfma_f32_16x16x32_bf16 v[48:51], v[132:135], v[32:35], v[48:51]
  ds_read_b128 v[16:19], v4 offset:0
  v_mfma_f32_16x16x32_bf16 v[64:67], v[136:139], v[32:35], v[64:67]
  ds_read_b128 v[20:23], v4 offset:4096
  v_mfma_f32_16x16x32_bf16 v[80:83], v[140:143], v[32:35], v[80:83]
  ds_read_b128 v[24:27], v4 offset:8192
  v_mfma_f32_16x16x32_bf16 v[52:55], v[132:135], v[36:39], v[52:55]
  ds_read_b128 v[28:31], v4 offset:12288
  v_mfma_f32_16x16x32_bf16 v[68:71], v[136:139], v[36:39], v[68:71]
  buffer_load_dwordx4 v[120:123], v6, s[16:19], s38 offen sc1
  v_mfma_f32_16x16x32_bf16 v[84:87], v[140:143], v[36:39], v[84:87]
  v_mfma_f32_16x16x32_bf16 v[56:59], v[132:135], v[40:43], v[56:59]
  buffer_load_dwordx4 v[124:127], v7, s[16:19], s38 offen sc1
  v_mfma_f32_16x16x32_bf16 v[72:75], v[136:139], v[40:43], v[72:75]
  v_mfma_f32_16x16x32_bf16 v[88:91], v[140:143], v[40:43], v[88:91]
  buffer_load_dwordx4 v[128:131], v8, s[16:19], s38 offen sc1
  v_mfma_f32_16x16x32_bf16 v[60:63], v[132:135], v[44:47], v[60:63]
  v_mfma_f32_16x16x32_bf16 v[76:79], v[136:139], v[44:47], v[76:79]
  v_mfma_f32_16x16x32_bf16 v[92:95], v[140:143], v[44:47], v[92:95]
  v_add_u32 v5, s43, v5
  s_add_u32 s37, s37, 1
  s_cmp_eq_u32 s37, 16
  s_cbranch_scc1 F2_GDONE
  s_lshl_b32 s40, s37, 1
  s_add_u32 s40, s40, 5
  s_lshl_b32 s38, s40, 11
  s_add_u32 s38, s38, s39
  s_cmp_lt_u32 s40, 32
  s_cselect_b32 s38, s38, 0x80000000
  s_waitcnt vmcnt(12) lgkmcnt(0)
  v_mfma_f32_16x16x32_bf16 v[48:51], v[144:147], v[16:19], v[48:51]
  ds_read_b128 v[32:35], v5 offset:0
  v_mfma_f32_16x16x32_bf16 v[64:67], v[148:151], v[16:19], v[64:67]
  ds_read_b128 v[36:39], v5 offset:4096
  v_mfma_f32_16x16x32_bf16 v[80:83], v[152:155], v[16:19], v[80:83]
  ds_read_b128 v[40:43], v5 offset:8192
  v_mfma_f32_16x16x32_bf16 v[52:55], v[144:147], v[20:23], v[52:55]
  ds_read_b128 v[44:47], v5 offset:12288
  v_mfma_f32_16x16x32_bf16 v[68:71], v[148:151], v[20:23], v[68:71]
  buffer_load_dwordx4 v[132:135], v6, s[16:19], s38 offen sc1
  v_mfma_f32_16x16x32_bf16 v[84:87], v[152:155], v[20:23], v[84:87]
  v_mfma_f32_16x16x32_bf16 v[56:59], v[144:147], v[24:27], v[56:59]
  buffer_load_dwordx4 v[136:139], v7, s[16:19], s38 offen sc1
  v_mfma_f32_16x16x32_bf16 v[72:75], v[148:151], v[24:27], v[72:75]
  v_mfma_f32_16x16x32_bf16 v[88:91], v[152:155], v[24:27], v[88:91]
  buffer_load_dwordx4 v[140:143], v8, s[16:19], s38 offen sc1
  v_mfma_f32_16x16x32_bf16 v[60:63], v[144:147], v[28:31], v[60:63]
  v_mfma_f32_16x16x32_bf16 v[76:79], v[148:151], v[28:31], v[76:79]
  v_mfma_f32_16x16x32_bf16 v[92:95], v[152:155], v[28:31], v[92:95]
  s_and_b32 s40, s37, 3
  s_movk_i32 s43, 16384
  s_cmp_eq_u32 s40, 3
  s_cselect_b32 s43, 4294918144, s43
  s_lshl_b32 s40, s37, 1
  s_add_u32 s40, s40, 6
  s_lshl_b32 s38, s40, 11
  s_add_u32 s38, s38, s39
  s_cmp_lt_u32 s40, 32
  s_cselect_b32 s38, s38, 0x80000000
  s_waitcnt lgkmcnt(0)
  s_barrier
  v_add_u32 v4, s43, v4
  s_waitcnt vmcnt(12)
  v_mfma_f32_16x16x32_bf16 v[48:51], v[156:159], v[32:35], v[48:51]
  ds_read_b128 v[16:19], v4 offset:0
  v_mfma_f32_16x16x32_bf16 v[64:67], v[160:163], v[32:35], v[64:67]
  ds_read_b128 v[20:23], v4 offset:4096
  v_mfma_f32_16x16x32_bf16 v[80:83], v[164:167], v[32:35], v[80:83]
  ds_read_b128 v[24:27], v4 offset:8192
  v_mfma_f32_16x16x32_bf16 v[52:55], v[156:159], v[36:39], v[52:55]
  ds_read_b128 v[28:31], v4 offset:12288
  v_mfma_f32_16x16x32_bf16 v[68:71], v[160:163], v[36:39], v[68:71]
  buffer_load_dwordx4 v[144:147], v6, s[16:19], s38 offen sc1
  v_mfma_f32_16x16x32_bf16 v[84:87], v[164:167], v[36:39], v[84:87]
  v_mfma_f32_16x16x32_bf16 v[56:59], v[156:159], v[40:43], v[56:59]
  buffer_load_dwordx4 v[148:151], v7, s[16:19], s38 offen sc1
  v_mfma_f32_16x16x32_bf16 v[72:75], v[160:163], v[40:43], v[72:75]
  v_mfma_f32_16x16x32_bf16 v[88:91], v[164:167], v[40:43], v[88:91]
  buffer_load_dwordx4 v[152:155], v8, s[16:19], s38 offen sc1
  v_mfma_f32_16x16x32_bf16 v[60:63], v[156:159], v[44:47], v[60:63]
  v_mfma_f32_16x16x32_bf16 v[76:79], v[160:163], v[44:47], v[76:79]
  v_mfma_f32_16x16x32_bf16 v[92:95], v[164:167], v[44:47], v[92:95]
  v_add_u32 v5, s43, v5
  s_add_u32 s37, s37, 1
  s_cmp_eq_u32 s37, 16
  s_cbranch_scc0 F2_GLOOP
F2_GDONE:
  s_lshl_b32 s40, s32, 2
  s_add_u32 s45, s40, s34
  v_lshlrev_b32 v10, 1, v3
  s_lshl_b32 s40, s45, 5
  buffer_load_ushort v15, v10, s[12:15], s40 offen
  s_waitcnt lgkmcnt(0)
  s_barrier
  s_mul_i32 s40, s34, 3072
  v_lshlrev_b32 v9, 4, v1
  v_add_u32 v10, s40, v9
  ds_write_b128 v10, v[48:51] offset:0
  ds_write_b128 v10, v[64:67] offset:1024
  ds_write_b128 v10, v[80:83] offset:2048
  ds_write_b128 v10, v[52:55] offset:12288
  ds_write_b128 v10, v[68:71] offset:13312
  ds_write_b128 v10, v[84:87] offset:14336
  s_waitcnt lgkmcnt(6)
  ds_write_b128 v10, v[56:59] offset:24576
  ds_write_b128 v10, v[72:75] offset:25600
  ds_write_b128 v10, v[88:91] offset:26624
  ds_write_b128 v10, v[60:63] offset:36864
  ds_write_b128 v10, v[76:79] offset:37888
  ds_write_b128 v10, v[92:95] offset:38912
  s_waitcnt lgkmcnt(6)
  s_waitcnt lgkmcnt(0)
  s_barrier
  s_mul_i32 s40, s34, 12288
  v_add_u32 v10, s40, v9
  ds_read_b128 v[16:19], v10 offset:0
  ds_read_b128 v[20:23], v10 offset:1024
  ds_read_b128 v[24:27], v10 offset:2048
  ds_read_b128 v[28:31], v10 offset:3072
  ds_read_b128 v[32:35], v10 offset:4096
  ds_read_b128 v[36:39], v10 offset:5120
  ds_read_b128 v[40:43], v10 offset:6144
  ds_read_b128 v[44:47], v10 offset:7168
  ds_read_b128 v[48:51], v10 offset:8192
  s_waitcnt lgkmcnt(6)
  ds_read_b128 v[52:55], v10 offset:9216
  ds_read_b128 v[56:59], v10 offset:10240
  ds_read_b128 v[60:63], v10 offset:11264
  s_mul_i32 s40, s34, 3072
  s_add_u32 s40, s40, 147456
  v_lshlrev_b32 v11, 3, v1
  v_add_u32 v11, s40, v11
  s_waitcnt lgkmcnt(6)
  ds_read_b64 v[64:65], v11 offset:0
  ds_read_b64 v[66:67], v11 offset:512
  ds_read_b64 v[68:69], v11 offset:1024
  ds_read_b64 v[70:71], v11 offset:1536
  ds_read_b64 v[72:73], v11 offset:2048
  ds_read_b64 v[74:75], v11 offset:2560
  s_waitcnt vmcnt(0)
  v_lshlrev_b32 v92, 16, v15
  s_mul_i32 s40, s45, 24576
  s_mul_i32 s41, s33, 3072
  s_add_u32 s40, s40, s41
  s_add_u32 s40, s40, 12582912
  s_waitcnt lgkmcnt(0)
  v_pk_add_f32 v[16:17], v[16:17], v[40:41]
  v_pk_add_f32 v[18:19], v[18:19], v[42:43]
  v_lshlrev_b32 v88, 16, v64
  v_and_b32 v89, s47, v64
  v_lshlrev_b32 v90, 16, v65
  v_and_b32 v91, s47, v65
  v_pk_add_f32 v[16:17], v[16:17], v[92:93] op_sel_hi:[1,0]
  v_pk_add_f32 v[18:19], v[18:19], v[92:93] op_sel_hi:[1,0]
  v_pk_mul_f32 v[16:17], v[16:17], v[88:89]
  v_pk_mul_f32 v[18:19], v[18:19], v[90:91]
  v_cvt_pk_bf16_f32 v76, v16, v17
  v_cvt_pk_bf16_f32 v77, v18, v19
  v_pk_add_f32 v[20:21], v[20:21], v[44:45]
  v_pk_add_f32 v[22:23], v[22:23], v[46:47]
  v_lshlrev_b32 v88, 16, v66
  v_and_b32 v89, s47, v66
  v_lshlrev_b32 v90, 16, v67
  v_and_b32 v91, s47, v67
  v_pk_add_f32 v[20:21], v[20:21], v[92:93] op_sel_hi:[1,0]
  v_pk_add_f32 v[22:23], v[22:23], v[92:93] op_sel_hi:[1,0]
  v_pk_mul_f32 v[20:21], v[20:21], v[88:89]
  v_pk_mul_f32 v[22:23], v[22:23], v[90:91]
  v_cvt_pk_bf16_f32 v78, v20, v21
  v_cvt_pk_bf16_f32 v79, v22, v23
  buffer_store_dwordx4 v[76:79], v9, s[16:19], s40 offen offset:0 sc1
  v_pk_add_f32 v[24:25], v[24:25], v[48:49]
  v_pk_add_f32 v[26:27], v[26:27], v[50:51]
  v_lshlrev_b32 v88, 16, v68
  v_and_b32 v89, s47, v68
  v_lshlrev_b32 v90, 16, v69
  v_and_b32 v91, s47, v69
  v_pk_add_f32 v[24:25], v[24:25], v[92:93] op_sel_hi:[1,0]
  v_pk_add_f32 v[26:27], v[26:27], v[92:93] op_sel_hi:[1,0]
  v_pk_mul_f32 v[24:25], v[24:25], v[88:89]
  v_pk_mul_f32 v[26:27], v[26:27], v[90:91]
  v_cvt_pk_bf16_f32 v80, v24, v25
  v_cvt_pk_bf16_f32 v81, v26, v27
  v_pk_add_f32 v[28:29], v[28:29], v[52:53]
  v_pk_add_f32 v[30:31], v[30:31], v[54:55]
  v_lshlrev_b32 v88, 16, v70
  v_and_b32 v89, s47, v70
  v_lshlrev_b32 v90, 16, v71
  v_and_b32 v91, s47, v71
  v_pk_add_f32 v[28:29], v[28:29], v[92:93] op_sel_hi:[1,0]
  v_pk_add_f32 v[30:31], v[30:31], v[92:93] op_sel_hi:[1,0]
  v_pk_mul_f32 v[28:29], v[28:29], v[88:89]
  v_pk_mul_f32 v[30:31], v[30:31], v[90:91]
  v_cvt_pk_bf16_f32 v82, v28, v29
  v_cvt_pk_bf16_f32 v83, v30, v31
  buffer_store_dwordx4 v[80:83], v9, s[16:19], s40 offen offset:1024 sc1
  v_pk_add_f32 v[32:33], v[32:33], v[56:57]
  v_pk_add_f32 v[34:35], v[34:35], v[58:59]
  v_lshlrev_b32 v88, 16, v72
  v_and_b32 v89, s47, v72
  v_lshlrev_b32 v90, 16, v73
  v_and_b32 v91, s47, v73
  v_pk_add_f32 v[32:33], v[32:33], v[92:93] op_sel_hi:[1,0]
  v_pk_add_f32 v[34:35], v[34:35], v[92:93] op_sel_hi:[1,0]
  v_pk_mul_f32 v[32:33], v[32:33], v[88:89]
  v_pk_mul_f32 v[34:35], v[34:35], v[90:91]
  v_cvt_pk_bf16_f32 v84, v32, v33
  v_cvt_pk_bf16_f32 v85, v34, v35
  v_pk_add_f32 v[36:37], v[36:37], v[60:61]
  v_pk_add_f32 v[38:39], v[38:39], v[62:63]
  v_lshlrev_b32 v88, 16, v74
  v_and_b32 v89, s47, v74
  v_lshlrev_b32 v90, 16, v75
  v_and_b32 v91, s47, v75
  v_pk_add_f32 v[36:37], v[36:37], v[92:93] op_sel_hi:[1,0]
  v_pk_add_f32 v[38:39], v[38:39], v[92:93] op_sel_hi:[1,0]
  v_pk_mul_f32 v[36:37], v[36:37], v[88:89]
  v_pk_mul_f32 v[38:39], v[38:39], v[90:91]
  v_cvt_pk_bf16_f32 v86, v36, v37
  v_cvt_pk_bf16_f32 v87, v38, v39
  buffer_store_dwordx4 v[84:87], v9, s[16:19], s40 offen offset:2048 sc1
  s_waitcnt vmcnt(0)
  s_barrier
  s_load_dwordx2 s[56:57], s[0:1], 0
  s_load_dwordx2 s[58:59], s[0:1], 88
  v_lshlrev_b32 v4, 4, v1
  s_lshl_b32 s35, s32, 2
  s_add_u32 s35, s35, s55
  s_lshr_b32 s39, s34, 2
  s_mul_i32 s36, s35, 24576
  s_mul_i32 s40, s39, 12288
  s_add_u32 s36, s36, s40
  s_add_u32 s36, s36, 12582912
  s_mul_i32 s40, s39, 61440
  v_add_u32 v26, s40, v4
  s_lshl_b32 s40, s35, 4
  s_mul_i32 s40, s40, 1280
  s_mul_i32 s41, s33, 160
  s_add_u32 s40, s40, s41
  v_add_u32 v12, 0, v1
  v_mul_u32_u24 v13, 6554, v12
  v_lshrrev_b32 v13, 16, v13
  v_mul_u32_u24 v14, 10, v13
  v_sub_u32 v14, v12, v14
  v_lshlrev_b32 v14, 4, v14
  v_mul_u32_u24 v13, 1280, v13
  v_add_u32 v13, v13, v14
  v_add_u32 v5, s40, v13
  v_add_u32 v12, 64, v1
  v_mul_u32_u24 v13, 6554, v12
  v_lshrrev_b32 v13, 16, v13
  v_mul_u32_u24 v14, 10, v13
  v_sub_u32 v14, v12, v14
  v_lshlrev_b32 v14, 4, v14
  v_mul_u32_u24 v13, 1280, v13
  v_add_u32 v13, v13, v14
  v_add_u32 v6, s40, v13
  v_add_u32 v12, 128, v1
  v_mul_u32_u24 v13, 6554, v12
  v_lshrrev_b32 v13, 16, v13
  v_mul_u32_u24 v14, 10, v13
  v_sub_u32 v14, v12, v14
  v_lshlrev_b32 v14, 4, v14
  v_mul_u32_u24 v13, 1280, v13
  v_add_u32 v13, v13, v14
  v_add_u32 v7, s40, v13
  s_mul_i32 s37, s55, 2560
  s_mul_i32 s38, s33, 327680
  s_lshl_b32 s41, s35, 5
  s_add_u32 s38, s38, s41
  s_add_u32 s38, s38, 9437184
  s_lshl_b32 s40, s55, 6
  s_add_u32 s40, s40, 143360
  v_lshlrev_b32 v21, 2, v3
  v_add_u32 v21, s40, v21
  ds_read_b32 v24, v21
  ds_read_b32 v25, v21 offset:256
  v_mov_b32 v68, 0
  v_mov_b32 v69, 0
  v_mov_b32 v70, 0
  v_mov_b32 v71, 0
  v_mov_b32 v72, 0
  v_mov_b32 v73, 0
  v_mov_b32 v74, 0
  v_mov_b32 v75, 0
  v_mov_b32 v76, 0
  v_mov_b32 v77, 0
  v_mov_b32 v78, 0
  v_mov_b32 v79, 0
  v_mov_b32 v80, 0
  v_mov_b32 v81, 0
  v_mov_b32 v82, 0
  v_mov_b32 v83, 0
  v_mov_b32 v84, 0
  v_mov_b32 v85, 0
  v_mov_b32 v86, 0
  v_mov_b32 v87, 0
  s_waitcnt lgkmcnt(0)
  s_mov_b32 s8, s56
  s_and_b32 s9, s57, 0xffff
  s_mov_b32 s10, 2621440
  s_mov_b32 s11, 0x20000
  s_mov_b32 s12, s58
  s_and_b32 s13, s59, 0xffff
  s_mov_b32 s14, 2621440
  s_mov_b32 s15, 0x20000
  s_add_u32 m0, s37, 122880
  s_nop 0
  buffer_load_dwordx4 v5, s[8:11], 0 offen lds
  s_add_u32 m0, s37, 123904
  s_nop 0
  buffer_load_dwordx4 v6, s[8:11], 0 offen lds
  s_mov_b32 exec_hi, 0
  s_add_u32 m0, s37, 124928
  s_nop 0
  buffer_load_dwordx4 v7, s[8:11], 0 offen lds
  s_mov_b32 exec_hi, -1
  s_barrier
  s_add_u32 s40, s36, 0
  buffer_load_dwordx4 v[88:91], v4, s[16:19], s40 offen offset:0 sc1
  s_add_u32 s40, s36, 0
  buffer_load_dwordx4 v[92:95], v4, s[16:19], s40 offen offset:1024 sc1
  s_add_u32 s40, s36, 0
  buffer_load_dwordx4 v[96:99], v4, s[16:19], s40 offen offset:2048 sc1
  s_add_u32 s40, s36, 0
  buffer_load_dwordx4 v[100:103], v4, s[16:19], s40 offen offset:3072 sc1
  s_add_u32 s40, s36, 4096
  buffer_load_dwordx4 v[104:107], v4, s[16:19], s40 offen offset:0 sc1
  s_barrier
  ds_read_b128 v[28:31], v26 offset:0
  ds_read_b128 v[32:35], v26 offset:1024
  ds_read_b128 v[36:39], v26 offset:2048
  ds_read_b128 v[40:43], v26 offset:3072
  ds_read_b128 v[44:47], v26 offset:4096
  s_waitcnt vmcnt(4) lgkmcnt(0)
  v_mfma_f32_16x16x32_bf16 v[68:71], v[28:31], v[88:91], v[68:71]
  ds_read_b128 v[48:51], v26 offset:5120
  v_mfma_f32_16x16x32_bf16 v[72:75], v[32:35], v[88:91], v[72:75]
  ds_read_b128 v[52:55], v26 offset:6144
  v_mfma_f32_16x16x32_bf16 v[76:79], v[36:39], v[88:91], v[76:79]
  ds_read_b128 v[56:59], v26 offset:7168
  s_add_u32 s40, s36, 4096
  buffer_load_dwordx4 v[108:111], v4, s[16:19], s40 offen offset:1024 sc1
  v_mfma_f32_16x16x32_bf16 v[80:83], v[40:43], v[88:91], v[80:83]
  ds_read_b128 v[60:63], v26 offset:8192
  v_mfma_f32_16x16x32_bf16 v[84:87], v[44:47], v[88:91], v[84:87]
  ds_read_b128 v[64:67], v26 offset:9216
  s_waitcnt vmcnt(4) lgkmcnt(0)
  v_mfma_f32_16x16x32_bf16 v[68:71], v[48:51], v[92:95], v[68:71]
  ds_read_b128 v[28:31], v26 offset:10240
  v_mfma_f32_16x16x32_bf16 v[72:75], v[52:55], v[92:95], v[72:75]
  ds_read_b128 v[32:35], v26 offset:11264
  v_mfma_f32_16x16x32_bf16 v[76:79], v[56:59], v[92:95], v[76:79]
  ds_read_b128 v[36:39], v26 offset:12288
  s_add_u32 s40, s36, 4096
  buffer_load_dwordx4 v[112:115], v4, s[16:19], s40 offen offset:2048 sc1
  v_mfma_f32_16x16x32_bf16 v[80:83], v[60:63], v[92:95], v[80:83]
  ds_read_b128 v[40:43], v26 offset:13312
  v_mfma_f32_16x16x32_bf16 v[84:87], v[64:67], v[92:95], v[84:87]
  ds_read_b128 v[44:47], v26 offset:14336
  s_waitcnt vmcnt(4) lgkmcnt(0)
  v_mfma_f32_16x16x32_bf16 v[68:71], v[28:31], v[96:99], v[68:71]
  ds_read_b128 v[48:51], v26 offset:15360
  v_mfma_f32_16x16x32_bf16 v[72:75], v[32:35], v[96:99], v[72:75]
  ds_read_b128 v[52:55], v26 offset:16384
  v_mfma_f32_16x16x32_bf16 v[76:79], v[36:39], v[96:99], v[76:79]
  ds_read_b128 v[56:59], v26 offset:17408
  s_add_u32 s40, s36, 4096
  buffer_load_dwordx4 v[116:119], v4, s[16:19], s40 offen offset:3072 sc1
  v_mfma_f32_16x16x32_bf16 v[80:83], v[40:43], v[96:99], v[80:83]
  ds_read_b128 v[60:63], v26 offset:18432
  v_mfma_f32_16x16x32_bf16 v[84:87], v[44:47], v[96:99], v[84:87]
  ds_read_b128 v[64:67], v26 offset:19456
  s_waitcnt vmcnt(4) lgkmcnt(0)
  s_barrier
  v_mfma_f32_16x16x32_bf16 v[68:71], v[48:51], v[100:103], v[68:71]
  ds_read_b128 v[28:31], v26 offset:20480
  v_mfma_f32_16x16x32_bf16 v[72:75], v[52:55], v[100:103], v[72:75]
  ds_read_b128 v[32:35], v26 offset:21504
  v_mfma_f32_16x16x32_bf16 v[76:79], v[56:59], v[100:103], v[76:79]
  ds_read_b128 v[36:39], v26 offset:22528
  s_add_u32 s40, s36, 8192
  buffer_load_dwordx4 v[120:123], v4, s[16:19], s40 offen offset:0 sc1
  v_mfma_f32_16x16x32_bf16 v[80:83], v[60:63], v[100:103], v[80:83]
  ds_read_b128 v[40:43], v26 offset:23552
  v_mfma_f32_16x16x32_bf16 v[84:87], v[64:67], v[100:103], v[84:87]
  ds_read_b128 v[44:47], v26 offset:24576
  s_waitcnt vmcnt(4) lgkmcnt(0)
  v_mfma_f32_16x16x32_bf16 v[68:71], v[28:31], v[104:107], v[68:71]
  ds_read_b128 v[48:51], v26 offset:25600
  v_mfma_f32_16x16x32_bf16 v[72:75], v[32:35], v[104:107], v[72:75]
  ds_read_b128 v[52:55], v26 offset:26624
  v_mfma_f32_16x16x32_bf16 v[76:79], v[36:39], v[104:107], v[76:79]
  ds_read_b128 v[56:59], v26 offset:27648
  s_add_u32 s40, s36, 8192
  buffer_load_dwordx4 v[124:127], v4, s[16:19], s40 offen offset:1024 sc1
  v_mfma_f32_16x16x32_bf16 v[80:83], v[40:43], v[104:107], v[80:83]
  ds_read_b128 v[60:63], v26 offset:28672
  v_mfma_f32_16x16x32_bf16 v[84:87], v[44:47], v[104:107], v[84:87]
  ds_read_b128 v[64:67], v26 offset:29696
  s_waitcnt vmcnt(4) lgkmcnt(0)
  v_mfma_f32_16x16x32_bf16 v[68:71], v[48:51], v[108:111], v[68:71]
  ds_read_b128 v[28:31], v26 offset:30720
  v_mfma_f32_16x16x32_bf16 v[72:75], v[52:55], v[108:111], v[72:75]
  ds_read_b128 v[32:35], v26 offset:31744
  v_mfma_f32_16x16x32_bf16 v[76:79], v[56:59], v[108:111], v[76:79]
  ds_read_b128 v[36:39], v26 offset:32768
  s_add_u32 s40, s36, 8192
  buffer_load_dwordx4 v[128:131], v4, s[16:19], s40 offen offset:2048 sc1
  v_mfma_f32_16x16x32_bf16 v[80:83], v[60:63], v[108:111], v[80:83]
  ds_read_b128 v[40:43], v26 offset:33792
  v_mfma_f32_16x16x32_bf16 v[84:87], v[64:67], v[108:111], v[84:87]
  ds_read_b128 v[44:47], v26 offset:34816
  s_waitcnt vmcnt(4) lgkmcnt(0)
  v_mfma_f32_16x16x32_bf16 v[68:71], v[28:31], v[112:115], v[68:71]
  ds_read_b128 v[48:51], v26 offset:35840
  v_mfma_f32_16x16x32_bf16 v[72:75], v[32:35], v[112:115], v[72:75]
  ds_read_b128 v[52:55], v26 offset:36864
  v_mfma_f32_16x16x32_bf16 v[76:79], v[36:39], v[112:115], v[76:79]
  ds_read_b128 v[56:59], v26 offset:37888
  s_add_u32 s40, s36, 8192
  buffer_load_dwordx4 v[132:135], v4, s[16:19], s40 offen offset:3072 sc1
  v_mfma_f32_16x16x32_bf16 v[80:83], v[40:43], v[112:115], v[80:83]
  ds_read_b128 v[60:63], v26 offset:38912
  v_mfma_f32_16x16x32_bf16 v[84:87], v[44:47], v[112:115], v[84:87]
  ds_read_b128 v[64:67], v26 offset:39936
  s_waitcnt vmcnt(4) lgkmcnt(0)
  s_barrier
  v_mfma_f32_16x16x32_bf16 v[68:71], v[48:51], v[116:119], v[68:71]
  ds_read_b128 v[28:31], v26 offset:40960
  v_mfma_f32_16x16x32_bf16 v[72:75], v[52:55], v[116:119], v[72:75]
  ds_read_b128 v[32:35], v26 offset:41984
  v_mfma_f32_16x16x32_bf16 v[76:79], v[56:59], v[116:119], v[76:79]
  ds_read_b128 v[36:39], v26 offset:43008
  v_mfma_f32_16x16x32_bf16 v[80:83], v[60:63], v[116:119], v[80:83]
  ds_read_b128 v[40:43], v26 offset:44032
  v_mfma_f32_16x16x32_bf16 v[84:87], v[64:67], v[116:119], v[84:87]
  ds_read_b128 v[44:47], v26 offset:45056
  s_waitcnt vmcnt(3) lgkmcnt(0)
  v_mfma_f32_16x16x32_bf16 v[68:71], v[28:31], v[120:123], v[68:71]
  ds_read_b128 v[48:51], v26 offset:46080
  v_mfma_f32_16x16x32_bf16 v[72:75], v[32:35], v[120:123], v[72:75]
  ds_read_b128 v[52:55], v26 offset:47104
  v_mfma_f32_16x16x32_bf16 v[76:79], v[36:39], v[120:123], v[76:79]
  ds_read_b128 v[56:59], v26 offset:48128
  v_mfma_f32_16x16x32_bf16 v[80:83], v[40:43], v[120:123], v[80:83]
  ds_read_b128 v[60:63], v26 offset:49152
  v_mfma_f32_16x16x32_bf16 v[84:87], v[44:47], v[120:123], v[84:87]
  ds_read_b128 v[64:67], v26 offset:50176
  s_waitcnt vmcnt(2) lgkmcnt(0)
  v_mfma_f32_16x16x32_bf16 v[68:71], v[48:51], v[124:127], v[68:71]
  ds_read_b128 v[28:31], v26 offset:51200
  v_mfma_f32_16x16x32_bf16 v[72:75], v[52:55], v[124:127], v[72:75]
  ds_read_b128 v[32:35], v26 offset:52224
  v_mfma_f32_16x16x32_bf16 v[76:79], v[56:59], v[124:127], v[76:79]
  ds_read_b128 v[36:39], v26 offset:53248
  v_mfma_f32_16x16x32_bf16 v[80:83], v[60:63], v[124:127], v[80:83]
  ds_read_b128 v[40:43], v26 offset:54272
  v_mfma_f32_16x16x32_bf16 v[84:87], v[64:67], v[124:127], v[84:87]
  ds_read_b128 v[44:47], v26 offset:55296
  s_waitcnt vmcnt(1) lgkmcnt(0)
  v_mfma_f32_16x16x32_bf16 v[68:71], v[28:31], v[128:131], v[68:71]
  ds_read_b128 v[48:51], v26 offset:56320
  v_mfma_f32_16x16x32_bf16 v[72:75], v[32:35], v[128:131], v[72:75]
  ds_read_b128 v[52:55], v26 offset:57344
  v_mfma_f32_16x16x32_bf16 v[76:79], v[36:39], v[128:131], v[76:79]
  ds_read_b128 v[56:59], v26 offset:58368
  v_mfma_f32_16x16x32_bf16 v[80:83], v[40:43], v[128:131], v[80:83]
  ds_read_b128 v[60:63], v26 offset:59392
  v_mfma_f32_16x16x32_bf16 v[84:87], v[44:47], v[128:131], v[84:87]
  ds_read_b128 v[64:67], v26 offset:60416
  s_waitcnt vmcnt(0) lgkmcnt(0)
  v_mfma_f32_16x16x32_bf16 v[68:71], v[48:51], v[132:135], v[68:71]
  v_mfma_f32_16x16x32_bf16 v[72:75], v[52:55], v[132:135], v[72:75]
  v_mfma_f32_16x16x32_bf16 v[76:79], v[56:59], v[132:135], v[76:79]
  v_mfma_f32_16x16x32_bf16 v[80:83], v[60:63], v[132:135], v[80:83]
  v_mfma_f32_16x16x32_bf16 v[84:87], v[64:67], v[132:135], v[84:87]
  s_waitcnt vmcnt(0) lgkmcnt(0)
  s_barrier
  s_mul_i32 s40, s55, 5120
  v_add_u32 v12, s40, v4
  s_nop 2
  ds_write_b128 v12, v[80:83] offset:3072
  ds_write_b128 v12, v[84:87] offset:4096
  v_mul_u32_u24 v13, 160, v3
  v_lshlrev_b32 v14, 3, v2
  v_add_u32 v13, v13, v14
  s_add_u32 s40, s37, 122880
  v_add_u32 v13, s40, v13
  v_lshlrev_b32 v14, 7, v2
  v_lshlrev_b32 v15, 3, v3
  v_add_u32 v14, v14, v15
  s_add_u32 s40, s37, 133120
  v_add_u32 v14, s40, v14
  ds_read_b64 v[88:89], v13 offset:0
  ds_read_b64_tr_b16 v[98:99], v14 offset:0
  ds_read_b64 v[90:91], v13 offset:32
  ds_read_b64_tr_b16 v[100:101], v14 offset:512
  ds_read_b64 v[92:93], v13 offset:64
  ds_read_b64_tr_b16 v[102:103], v14 offset:1024
  v_sub_f32 v16, 0, v24
  v_mov_b32 v18, v25
  s_mov_b32 s48, 1.0
  s_mov_b32 s49, 1.0
  v_mov_b32 v20, 0xbfb8aa3b
  v_mov_b32 v21, 0xbfb8aa3b
  s_waitcnt lgkmcnt(0)
  s_barrier
  ds_read_b128 v[108:111], v12 offset:0
  ds_read_b128 v[112:115], v12 offset:1024
  ds_read_b128 v[116:119], v12 offset:2048
  s_waitcnt lgkmcnt(0)
  v_pk_add_f32 v[68:69], v[68:69], v[108:109]
  v_lshlrev_b32 v28, 16, v88
  v_and_b32 v29, s47, v88
  v_pk_mul_f32 v[32:33], v[68:69], v[20:21]
  v_lshlrev_b32 v30, 16, v98
  v_and_b32 v31, s47, v98
  v_exp_f32 v32, v32
  v_exp_f32 v33, v33
  v_pk_add_f32 v[34:35], v[28:29], v[16:17] op_sel_hi:[1,0]
  v_pk_add_f32 v[32:33], v[32:33], s[48:49]
  v_pk_mul_f32 v[34:35], v[34:35], v[18:19] op_sel_hi:[1,0]
  v_rcp_f32 v32, v32
  v_rcp_f32 v33, v33
  v_pk_mul_f32 v[34:35], v[34:35], v[30:31]
  v_pk_mul_f32 v[32:33], v[32:33], v[68:69]
  v_pk_fma_f32 v[34:35], v[34:35], v[32:33], v[28:29]
  v_cvt_pk_bf16_f32 v88, v34, v35
  v_pk_add_f32 v[70:71], v[70:71], v[110:111]
  v_lshlrev_b32 v36, 16, v89
  v_and_b32 v37, s47, v89
  v_pk_mul_f32 v[40:41], v[70:71], v[20:21]
  v_lshlrev_b32 v38, 16, v99
  v_and_b32 v39, s47, v99
  v_exp_f32 v40, v40
  v_exp_f32 v41, v41
  v_pk_add_f32 v[42:43], v[36:37], v[16:17] op_sel_hi:[1,0]
  v_pk_add_f32 v[40:41], v[40:41], s[48:49]
  v_pk_mul_f32 v[42:43], v[42:43], v[18:19] op_sel_hi:[1,0]
  v_rcp_f32 v40, v40
  v_rcp_f32 v41, v41
  v_pk_mul_f32 v[42:43], v[42:43], v[38:39]
  v_pk_mul_f32 v[40:41], v[40:41], v[70:71]
  v_pk_fma_f32 v[42:43], v[42:43], v[40:41], v[36:37]
  v_cvt_pk_bf16_f32 v89, v42, v43
  ds_write_b64 v13, v[88:89] offset:0
  v_pk_add_f32 v[72:73], v[72:73], v[112:113]
  v_lshlrev_b32 v28, 16, v90
  v_and_b32 v29, s47, v90
  v_pk_mul_f32 v[32:33], v[72:73], v[20:21]
  v_lshlrev_b32 v30, 16, v100
  v_and_b32 v31, s47, v100
  v_exp_f32 v32, v32
  v_exp_f32 v33, v33
  v_pk_add_f32 v[34:35], v[28:29], v[16:17] op_sel_hi:[1,0]
  v_pk_add_f32 v[32:33], v[32:33], s[48:49]
  v_pk_mul_f32 v[34:35], v[34:35], v[18:19] op_sel_hi:[1,0]
  v_rcp_f32 v32, v32
  v_rcp_f32 v33, v33
  v_pk_mul_f32 v[34:35], v[34:35], v[30:31]
  v_pk_mul_f32 v[32:33], v[32:33], v[72:73]
  v_pk_fma_f32 v[34:35], v[34:35], v[32:33], v[28:29]
  v_cvt_pk_bf16_f32 v90, v34, v35
  v_pk_add_f32 v[74:75], v[74:75], v[114:115]
  v_lshlrev_b32 v36, 16, v91
  v_and_b32 v37, s47, v91
  v_pk_mul_f32 v[40:41], v[74:75], v[20:21]
  v_lshlrev_b32 v38, 16, v101
  v_and_b32 v39, s47, v101
  v_exp_f32 v40, v40
  v_exp_f32 v41, v41
  v_pk_add_f32 v[42:43], v[36:37], v[16:17] op_sel_hi:[1,0]
  v_pk_add_f32 v[40:41], v[40:41], s[48:49]
  v_pk_mul_f32 v[42:43], v[42:43], v[18:19] op_sel_hi:[1,0]
  v_rcp_f32 v40, v40
  v_rcp_f32 v41, v41
  v_pk_mul_f32 v[42:43], v[42:43], v[38:39]
  v_pk_mul_f32 v[40:41], v[40:41], v[74:75]
  v_pk_fma_f32 v[42:43], v[42:43], v[40:41], v[36:37]
  v_cvt_pk_bf16_f32 v91, v42, v43
  ds_write_b64 v13, v[90:91] offset:32
  v_pk_add_f32 v[76:77], v[76:77], v[116:117]
  v_lshlrev_b32 v28, 16, v92
  v_and_b32 v29, s47, v92
  v_pk_mul_f32 v[32:33], v[76:77], v[20:21]
  v_lshlrev_b32 v30, 16, v102
  v_and_b32 v31, s47, v102
  v_exp_f32 v32, v32
  v_exp_f32 v33, v33
  v_pk_add_f32 v[34:35], v[28:29], v[16:17] op_sel_hi:[1,0]
  v_pk_add_f32 v[32:33], v[32:33], s[48:49]
  v_pk_mul_f32 v[34:35], v[34:35], v[18:19] op_sel_hi:[1,0]
  v_rcp_f32 v32, v32
  v_rcp_f32 v33, v33
  v_pk_mul_f32 v[34:35], v[34:35], v[30:31]
  v_pk_mul_f32 v[32:33], v[32:33], v[76:77]
  v_pk_fma_f32 v[34:35], v[34:35], v[32:33], v[28:29]
  v_cvt_pk_bf16_f32 v92, v34, v35
  v_pk_add_f32 v[78:79], v[78:79], v[118:119]
  v_lshlrev_b32 v36, 16, v93
  v_and_b32 v37, s47, v93
  v_pk_mul_f32 v[40:41], v[78:79], v[20:21]
  v_lshlrev_b32 v38, 16, v103
  v_and_b32 v39, s47, v103
  v_exp_f32 v40, v40
  v_exp_f32 v41, v41
  v_pk_add_f32 v[42:43], v[36:37], v[16:17] op_sel_hi:[1,0]
  v_pk_add_f32 v[40:41], v[40:41], s[48:49]
  v_pk_mul_f32 v[42:43], v[42:43], v[18:19] op_sel_hi:[1,0]
  v_rcp_f32 v40, v40
  v_rcp_f32 v41, v41
  v_pk_mul_f32 v[42:43], v[42:43], v[38:39]
  v_pk_mul_f32 v[40:41], v[40:41], v[78:79]
  v_pk_fma_f32 v[42:43], v[42:43], v[40:41], v[36:37]
  v_cvt_pk_bf16_f32 v93, v42, v43
  ds_write_b64 v13, v[92:93] offset:64
  s_waitcnt lgkmcnt(0)
  s_barrier
  s_add_u32 s40, s37, 122880
  v_add_u32 v13, s40, v4
  ds_read_b128 v[108:111], v13 offset:0
  ds_read_b128 v[112:115], v13 offset:1024
  s_waitcnt lgkmcnt(0)
  buffer_store_dwordx4 v[108:111], v5, s[12:15], 0 offen
  buffer_store_dwordx4 v[112:115], v6, s[12:15], 0 offen
  s_mov_b64 exec, s[52:53]
  s_endpgm
K1_B:
  s_cmp_eq_u32 s34, 4
  s_cbranch_scc0 K1_NORST
  s_lshl_b32 s40, s32, 3
  s_add_u32 s40, s40, s33
  s_lshl_b32 s40, s40, 9
  s_add_u32 s40, s40, 16842752
  v_lshlrev_b32 v15, 3, v1
  v_mov_b32 v20, 0
  v_mov_b32 v21, 0xbf800000
  buffer_store_dwordx2 v[20:21], v15, s[16:19], s40 offen sc1
  s_lshl_b32 s40, s33, 7
  s_lshl_b32 s41, s32, 2
  s_add_u32 s40, s40, s41
  s_add_u32 s41, s40, 17040384
  s_add_u32 s40, s40, 17039360
  v_mov_b32 v15, s40
  v_mov_b32 v16, s41
  v_cmp_eq_u32 vcc, 1, v1
  s_nop 1
  v_cndmask_b32 v15, v15, v16, vcc
  s_lshl_b32 s40, s32, 5
  s_lshl_b32 s41, s33, 2
  s_add_u32 s40, s40, s41
  s_add_u32 s40, s40, 17041408
  v_mov_b32 v16, s40
  v_cmp_eq_u32 vcc, 2, v1
  s_nop 1
  v_cndmask_b32 v15, v15, v16, vcc
  s_lshl_b32 s40, s33, 7
  s_lshl_b32 s41, s32, 2
  s_add_u32 s40, s40, s41
  s_add_u32 s40, s40, 17042432
  v_mov_b32 v16, s40
  v_cmp_eq_u32 vcc, 3, v1
  s_nop 1
  v_cndmask_b32 v15, v15, v16, vcc
  s_mov_b32 exec_lo, 0xf
  s_mov_b32 exec_hi, 0x0
  buffer_store_dword v20, v15, s[16:19], 0 offen sc1
  s_mov_b64 exec, s[52:53]
K1_NORST:
  s_lshl_b32 s40, s2, 2
  s_add_u32 s40, s40, s55
  s_mul_i32 s41, s40, 2731
  s_lshr_b32 s41, s41, 16
  s_mul_i32 s42, s41, 24
  s_sub_u32 s42, s40, s42
  s_mov_b32 s72, s40
  v_mul_u32_u24 v17, 5120, v2
  v_lshlrev_b32 v18, 1, v3
  v_add_u32 v17, v17, v18
  s_lshl_b32 s41, s41, 5
  s_mul_i32 s42, s42, 40960
  s_add_u32 s41, s41, s42
  s_add_u32 s42, s41, 20480
  s_barrier
  s_mov_b32 s28, s66
  s_and_b32 s29, s67, 0xffff
  s_mov_b32 s30, 983040
  s_mov_b32 s31, 0x20000
  buffer_load_ushort v152, v17, s[28:31], s41 offen offset:0
  buffer_load_ushort v153, v17, s[28:31], s41 offen offset:1280
  buffer_load_ushort v154, v17, s[28:31], s41 offen offset:2560
  buffer_load_ushort v155, v17, s[28:31], s41 offen offset:3840
  buffer_load_ushort v156, v17, s[28:31], s42 offen offset:0
  buffer_load_ushort v157, v17, s[28:31], s42 offen offset:1280
  buffer_load_ushort v158, v17, s[28:31], s42 offen offset:2560
  buffer_load_ushort v159, v17, s[28:31], s42 offen offset:3840
  s_barrier
  s_barrier
  s_cmp_eq_u32 s34, 4
  s_cbranch_scc0 K1_NOCNT
  s_waitcnt vmcnt(8)
  s_lshl_b32 s39, s32, 2
  v_mov_b32 v20, s39
  v_mov_b32 v21, 1
  s_mov_b32 exec_lo, 0x1
  s_mov_b32 exec_hi, 0x0
  buffer_atomic_add v21, v20, s[4:7], 0 offen offset:0 sc1
  s_mov_b64 exec, s[52:53]
K1_NOCNT:
  s_barrier
  s_barrier
  s_barrier
  s_barrier
  s_barrier
  s_barrier
  v_lshlrev_b32 v144, 6, v1
  s_and_b32 s54, s2, 7
  s_lshl_b32 s54, s54, 8
  s_lshr_b32 s39, s2, 3
  s_lshl_b32 s39, s39, 3
  s_add_u32 s54, s54, s39
  s_lshl_b32 s54, s54, 12
  s_mov_b32 s20, s74
  s_and_b32 s21, s75, 0xffff
  s_mov_b32 s22, 8388608
  s_mov_b32 s23, 0x20000
  s_mov_b32 s46, 0
  s_cmp_ge_u32 s72, 960
  s_cbranch_scc1 K1_NOWOF
  s_waitcnt vmcnt(0)
  v_lshl_or_b32 v164, v153, 16, v152
  v_lshl_or_b32 v165, v155, 16, v154
  v_lshl_or_b32 v166, v157, 16, v156
  v_lshl_or_b32 v167, v159, 16, v158
  v_lshlrev_b32 v17, 4, v1
  s_lshl_b32 s40, s72, 10
  s_add_u32 s40, s40, 15728640
  buffer_store_dwordx4 v[164:167], v17, s[16:19], s40 offen sc1
K1_NOWOF:
  s_barrier
  v_mov_b32 v102, 0x3f803f80
  v_mov_b32 v103, 0x3f803f80
  v_mov_b32 v104, 0x3f803f80
  v_mov_b32 v105, 0x3f803f80
  v_mov_b32 v66, 0
  v_mov_b32 v67, 0
  v_mov_b32 v68, 0
  v_mov_b32 v69, 0
  v_mov_b32 v70, 0
  v_mov_b32 v71, 0
  v_mov_b32 v72, 0
  v_mov_b32 v73, 0
  v_mov_b32 v74, 0
  v_mov_b32 v75, 0
  v_mov_b32 v76, 0
  v_mov_b32 v77, 0
  v_mov_b32 v78, 0
  v_mov_b32 v79, 0
  v_mov_b32 v80, 0
  v_mov_b32 v81, 0
  v_mov_b32 v82, 0
  v_mov_b32 v83, 0
  v_mov_b32 v84, 0
  v_mov_b32 v85, 0
  v_mov_b32 v86, 0
  v_mov_b32 v87, 0
  v_mov_b32 v88, 0
  v_mov_b32 v89, 0
  v_mov_b32 v90, 0
  v_mov_b32 v91, 0
  v_mov_b32 v92, 0
  v_mov_b32 v93, 0
  v_mov_b32 v94, 0
  v_mov_b32 v95, 0
  v_mov_b32 v96, 0
  v_mov_b32 v97, 0
  v_mov_b32 v98, 0
  v_mov_b32 v99, 0
  v_mov_b32 v100, 0
  v_mov_b32 v101, 0
  v_mov_b32 v106, 0
  v_mov_b32 v107, 0
  v_mov_b32 v108, 0
  v_mov_b32 v109, 0
  v_mov_b32 v110, 0
  v_mov_b32 v111, 0
  v_mov_b32 v112, 0
  v_mov_b32 v113, 0
  s_barrier
  s_mov_b32 s37, 0
  ds_read_b128 v[26:29], v4 offset:0
  ds_read_b64_tr_b16 v[42:43], v8 offset:0
  ds_read_b64_tr_b16 v[44:45], v8 offset:768
  ds_read_b128 v[30:33], v6 offset:0
  ds_read_b64_tr_b16 v[46:47], v9 offset:0
  ds_read_b64_tr_b16 v[48:49], v9 offset:768
  ds_read_b64_tr_b16 v[50:51], v10 offset:0
  ds_read_b64_tr_b16 v[52:53], v10 offset:768
K1_LOOP2:
  s_waitcnt lgkmcnt(0)
  v_mfma_f32_16x16x32_bf16 v[66:69], v[42:45], v[26:29], v[66:69]
  ds_read_b128 v[34:37], v5 offset:0
  ds_read_b64_tr_b16 v[54:55], v8 offset:6144
  v_mfma_f32_16x16x32_bf16 v[78:81], v[42:45], v[30:33], v[78:81]
  ds_read_b64_tr_b16 v[56:57], v8 offset:6912
  ds_read_b128 v[38:41], v7 offset:0
  v_mfma_f32_16x16x32_bf16 v[70:73], v[46:49], v[26:29], v[70:73]
  ds_read_b64_tr_b16 v[58:59], v9 offset:6144
  ds_read_b64_tr_b16 v[60:61], v9 offset:6912
  v_mfma_f32_16x16x32_bf16 v[82:85], v[46:49], v[30:33], v[82:85]
  ds_read_b64_tr_b16 v[62:63], v10 offset:6144
  ds_read_b64_tr_b16 v[64:65], v10 offset:6912
  v_mfma_f32_16x16x32_bf16 v[74:77], v[50:53], v[26:29], v[74:77]
  v_mfma_f32_16x16x32_bf16 v[86:89], v[50:53], v[30:33], v[86:89]
  s_cmp_eq_u32 s35, 0
  s_cbranch_scc0 K1_SK_2a0
  v_mfma_f32_16x16x32_bf16 v[90:93], v[42:45], v[102:105], v[90:93]
  v_mfma_f32_16x16x32_bf16 v[94:97], v[46:49], v[102:105], v[94:97]
  v_mfma_f32_16x16x32_bf16 v[98:101], v[50:53], v[102:105], v[98:101]
K1_SK_2a0:
  s_waitcnt lgkmcnt(0)
  s_barrier
  v_mfma_f32_16x16x32_bf16 v[66:69], v[54:57], v[34:37], v[66:69]
  ds_read_b128 v[26:29], v4 offset:8192
  ds_read_b64_tr_b16 v[42:43], v8 offset:12288
  v_mfma_f32_16x16x32_bf16 v[78:81], v[54:57], v[38:41], v[78:81]
  ds_read_b64_tr_b16 v[44:45], v8 offset:13056
  ds_read_b128 v[30:33], v6 offset:8192
  v_mfma_f32_16x16x32_bf16 v[70:73], v[58:61], v[34:37], v[70:73]
  ds_read_b64_tr_b16 v[46:47], v9 offset:12288
  ds_read_b64_tr_b16 v[48:49], v9 offset:13056
  v_mfma_f32_16x16x32_bf16 v[82:85], v[58:61], v[38:41], v[82:85]
  ds_read_b64_tr_b16 v[50:51], v10 offset:12288
  ds_read_b64_tr_b16 v[52:53], v10 offset:13056
  v_mfma_f32_16x16x32_bf16 v[74:77], v[62:65], v[34:37], v[74:77]
  v_mfma_f32_16x16x32_bf16 v[86:89], v[62:65], v[38:41], v[86:89]
  s_cmp_eq_u32 s35, 1
  s_cbranch_scc0 K1_SK_2b0
  v_mfma_f32_16x16x32_bf16 v[90:93], v[54:57], v[102:105], v[90:93]
  v_mfma_f32_16x16x32_bf16 v[94:97], v[58:61], v[102:105], v[94:97]
  v_mfma_f32_16x16x32_bf16 v[98:101], v[62:65], v[102:105], v[98:101]
K1_SK_2b0:
  s_and_b32 s40, s46, 3
  s_cmp_eq_u32 s40, s55
  s_cbranch_scc0 K1_NT0
  s_cmp_lt_u32 s46, 8
  s_cbranch_scc0 K1_NT0
  buffer_load_dword v148, v144, s[20:23], s54 offen
K1_NT0:
  s_add_u32 s46, s46, 1
  s_add_u32 s54, s54, 4096
  s_waitcnt lgkmcnt(0)
  v_mfma_f32_16x16x32_bf16 v[66:69], v[42:45], v[26:29], v[66:69]
  ds_read_b128 v[34:37], v5 offset:8192
  ds_read_b64_tr_b16 v[54:55], v8 offset:18432
  v_mfma_f32_16x16x32_bf16 v[78:81], v[42:45], v[30:33], v[78:81]
  ds_read_b64_tr_b16 v[56:57], v8 offset:19200
  ds_read_b128 v[38:41], v7 offset:8192
  v_mfma_f32_16x16x32_bf16 v[70:73], v[46:49], v[26:29], v[70:73]
  ds_read_b64_tr_b16 v[58:59], v9 offset:18432
  ds_read_b64_tr_b16 v[60:61], v9 offset:19200
  v_mfma_f32_16x16x32_bf16 v[82:85], v[46:49], v[30:33], v[82:85]
  ds_read_b64_tr_b16 v[62:63], v10 offset:18432
  ds_read_b64_tr_b16 v[64:65], v10 offset:19200
  v_mfma_f32_16x16x32_bf16 v[74:77], v[50:53], v[26:29], v[74:77]
  v_mfma_f32_16x16x32_bf16 v[86:89], v[50:53], v[30:33], v[86:89]
  s_cmp_eq_u32 s35, 0
  s_cbranch_scc0 K1_SK_2a1
  v_mfma_f32_16x16x32_bf16 v[90:93], v[42:45], v[102:105], v[90:93]
  v_mfma_f32_16x16x32_bf16 v[94:97], v[46:49], v[102:105], v[94:97]
  v_mfma_f32_16x16x32_bf16 v[98:101], v[50:53], v[102:105], v[98:101]
K1_SK_2a1:
  s_waitcnt lgkmcnt(0)
  s_barrier
  v_mfma_f32_16x16x32_bf16 v[66:69], v[54:57], v[34:37], v[66:69]
  ds_read_b128 v[26:29], v4 offset:16384
  ds_read_b64_tr_b16 v[42:43], v8 offset:24576
  v_mfma_f32_16x16x32_bf16 v[78:81], v[54:57], v[38:41], v[78:81]
  ds_read_b64_tr_b16 v[44:45], v8 offset:25344
  ds_read_b128 v[30:33], v6 offset:16384
  v_mfma_f32_16x16x32_bf16 v[70:73], v[58:61], v[34:37], v[70:73]
  ds_read_b64_tr_b16 v[46:47], v9 offset:24576
  ds_read_b64_tr_b16 v[48:49], v9 offset:25344
  v_mfma_f32_16x16x32_bf16 v[82:85], v[58:61], v[38:41], v[82:85]
  ds_read_b64_tr_b16 v[50:51], v10 offset:24576
  ds_read_b64_tr_b16 v[52:53], v10 offset:25344
  v_mfma_f32_16x16x32_bf16 v[74:77], v[62:65], v[34:37], v[74:77]
  v_mfma_f32_16x16x32_bf16 v[86:89], v[62:65], v[38:41], v[86:89]
  s_cmp_eq_u32 s35, 1
  s_cbranch_scc0 K1_SK_2b1
  v_mfma_f32_16x16x32_bf16 v[90:93], v[54:57], v[102:105], v[90:93]
  v_mfma_f32_16x16x32_bf16 v[94:97], v[58:61], v[102:105], v[94:97]
  v_mfma_f32_16x16x32_bf16 v[98:101], v[62:65], v[102:105], v[98:101]
K1_SK_2b1:
  s_and_b32 s40, s46, 3
  s_cmp_eq_u32 s40, s55
  s_cbranch_scc0 K1_NT1
  s_cmp_lt_u32 s46, 8
  s_cbranch_scc0 K1_NT1
  buffer_load_dword v148, v144, s[20:23], s54 offen
K1_NT1:
  s_add_u32 s46, s46, 1
  s_add_u32 s54, s54, 4096
  s_waitcnt lgkmcnt(0)
  v_mfma_f32_16x16x32_bf16 v[66:69], v[42:45], v[26:29], v[66:69]
  ds_read_b128 v[34:37], v5 offset:16384
  ds_read_b64_tr_b16 v[54:55], v8 offset:30720
  v_mfma_f32_16x16x32_bf16 v[78:81], v[42:45], v[30:33], v[78:81]
  ds_read_b64_tr_b16 v[56:57], v8 offset:31488
  ds_read_b128 v[38:41], v7 offset:16384
  v_mfma_f32_16x16x32_bf16 v[70:73], v[46:49], v[26:29], v[70:73]
  ds_read_b64_tr_b16 v[58:59], v9 offset:30720
  ds_read_b64_tr_b16 v[60:61], v9 offset:31488
  v_mfma_f32_16x16x32_bf16 v[82:85], v[46:49], v[30:33], v[82:85]
  ds_read_b64_tr_b16 v[62:63], v10 offset:30720
  ds_read_b64_tr_b16 v[64:65], v10 offset:31488
  v_mfma_f32_16x16x32_bf16 v[74:77], v[50:53], v[26:29], v[74:77]
  v_mfma_f32_16x16x32_bf16 v[86:89], v[50:53], v[30:33], v[86:89]
  s_cmp_eq_u32 s35, 0
  s_cbranch_scc0 K1_SK_2a2
  v_mfma_f32_16x16x32_bf16 v[90:93], v[42:45], v[102:105], v[90:93]
  v_mfma_f32_16x16x32_bf16 v[94:97], v[46:49], v[102:105], v[94:97]
  v_mfma_f32_16x16x32_bf16 v[98:101], v[50:53], v[102:105], v[98:101]
K1_SK_2a2:
  s_waitcnt lgkmcnt(0)
  s_barrier
  v_mfma_f32_16x16x32_bf16 v[66:69], v[54:57], v[34:37], v[66:69]
  ds_read_b128 v[26:29], v4 offset:24576
  ds_read_b64_tr_b16 v[42:43], v8 offset:36864
  v_mfma_f32_16x16x32_bf16 v[78:81], v[54:57], v[38:41], v[78:81]
  ds_read_b64_tr_b16 v[44:45], v8 offset:37632
  ds_read_b128 v[30:33], v6 offset:24576
  v_mfma_f32_16x16x32_bf16 v[70:73], v[58:61], v[34:37], v[70:73]
  ds_read_b64_tr_b16 v[46:47], v9 offset:36864
  ds_read_b64_tr_b16 v[48:49], v9 offset:37632
  v_mfma_f32_16x16x32_bf16 v[82:85], v[58:61], v[38:41], v[82:85]
  ds_read_b64_tr_b16 v[50:51], v10 offset:36864
  ds_read_b64_tr_b16 v[52:53], v10 offset:37632
  v_mfma_f32_16x16x32_bf16 v[74:77], v[62:65], v[34:37], v[74:77]
  v_mfma_f32_16x16x32_bf16 v[86:89], v[62:65], v[38:41], v[86:89]
  s_cmp_eq_u32 s35, 1
  s_cbranch_scc0 K1_SK_2b2
  v_mfma_f32_16x16x32_bf16 v[90:93], v[54:57], v[102:105], v[90:93]
  v_mfma_f32_16x16x32_bf16 v[94:97], v[58:61], v[102:105], v[94:97]
  v_mfma_f32_16x16x32_bf16 v[98:101], v[62:65], v[102:105], v[98:101]
K1_SK_2b2:
  s_and_b32 s40, s46, 3
  s_cmp_eq_u32 s40, s55
  s_cbranch_scc0 K1_NT2
  s_cmp_lt_u32 s46, 8
  s_cbranch_scc0 K1_NT2
  buffer_load_dword v148, v144, s[20:23], s54 offen
K1_NT2:
  s_add_u32 s46, s46, 1
  s_add_u32 s54, s54, 4096
  s_waitcnt lgkmcnt(0)
  v_mfma_f32_16x16x32_bf16 v[66:69], v[42:45], v[26:29], v[66:69]
  ds_read_b128 v[34:37], v5 offset:24576
  ds_read_b64_tr_b16 v[54:55], v8 offset:43008
  v_mfma_f32_16x16x32_bf16 v[78:81], v[42:45], v[30:33], v[78:81]
  ds_read_b64_tr_b16 v[56:57], v8 offset:43776
  ds_read_b128 v[38:41], v7 offset:24576
  v_mfma_f32_16x16x32_bf16 v[70:73], v[46:49], v[26:29], v[70:73]
  ds_read_b64_tr_b16 v[58:59], v9 offset:43008
  ds_read_b64_tr_b16 v[60:61], v9 offset:43776
  v_mfma_f32_16x16x32_bf16 v[82:85], v[46:49], v[30:33], v[82:85]
  ds_read_b64_tr_b16 v[62:63], v10 offset:43008
  ds_read_b64_tr_b16 v[64:65], v10 offset:43776
  v_mfma_f32_16x16x32_bf16 v[74:77], v[50:53], v[26:29], v[74:77]
  v_mfma_f32_16x16x32_bf16 v[86:89], v[50:53], v[30:33], v[86:89]
  s_cmp_eq_u32 s35, 0
  s_cbranch_scc0 K1_SK_2a3
  v_mfma_f32_16x16x32_bf16 v[90:93], v[42:45], v[102:105], v[90:93]
  v_mfma_f32_16x16x32_bf16 v[94:97], v[46:49], v[102:105], v[94:97]
  v_mfma_f32_16x16x32_bf16 v[98:101], v[50:53], v[102:105], v[98:101]
K1_SK_2a3:
  s_waitcnt lgkmcnt(0)
  s_barrier
  v_mfma_f32_16x16x32_bf16 v[66:69], v[54:57], v[34:37], v[66:69]
  ds_read_b128 v[26:29], v4 offset:32768
  ds_read_b64_tr_b16 v[42:43], v8 offset:49152
  v_mfma_f32_16x16x32_bf16 v[78:81], v[54:57], v[38:41], v[78:81]
  ds_read_b64_tr_b16 v[44:45], v8 offset:49920
  ds_read_b128 v[30:33], v6 offset:32768
  v_mfma_f32_16x16x32_bf16 v[70:73], v[58:61], v[34:37], v[70:73]
  ds_read_b64_tr_b16 v[46:47], v9 offset:49152
  ds_read_b64_tr_b16 v[48:49], v9 offset:49920
  v_mfma_f32_16x16x32_bf16 v[82:85], v[58:61], v[38:41], v[82:85]
  ds_read_b64_tr_b16 v[50:51], v10 offset:49152
  ds_read_b64_tr_b16 v[52:53], v10 offset:49920
  v_mfma_f32_16x16x32_bf16 v[74:77], v[62:65], v[34:37], v[74:77]
  v_mfma_f32_16x16x32_bf16 v[86:89], v[62:65], v[38:41], v[86:89]
  s_cmp_eq_u32 s35, 1
  s_cbranch_scc0 K1_SK_2b3
  v_mfma_f32_16x16x32_bf16 v[90:93], v[54:57], v[102:105], v[90:93]
  v_mfma_f32_16x16x32_bf16 v[94:97], v[58:61], v[102:105], v[94:97]
  v_mfma_f32_16x16x32_bf16 v[98:101], v[62:65], v[102:105], v[98:101]
K1_SK_2b3:
  s_and_b32 s40, s46, 3
  s_cmp_eq_u32 s40, s55
  s_cbranch_scc0 K1_NT3
  s_cmp_lt_u32 s46, 8
  s_cbranch_scc0 K1_NT3
  buffer_load_dword v148, v144, s[20:23], s54 offen
K1_NT3:
  s_add_u32 s46, s46, 1
  s_add_u32 s54, s54, 4096
  s_waitcnt lgkmcnt(0)
  v_mfma_f32_16x16x32_bf16 v[66:69], v[42:45], v[26:29], v[66:69]
  ds_read_b128 v[34:37], v5 offset:32768
  ds_read_b64_tr_b16 v[54:55], v8 offset:55296
  v_mfma_f32_16x16x32_bf16 v[78:81], v[42:45], v[30:33], v[78:81]
  ds_read_b64_tr_b16 v[56:57], v8 offset:56064
  ds_read_b128 v[38:41], v7 offset:32768
  v_mfma_f32_16x16x32_bf16 v[70:73], v[46:49], v[26:29], v[70:73]
  ds_read_b64_tr_b16 v[58:59], v9 offset:55296
  ds_read_b64_tr_b16 v[60:61], v9 offset:56064
  v_mfma_f32_16x16x32_bf16 v[82:85], v[46:49], v[30:33], v[82:85]
  ds_read_b64_tr_b16 v[62:63], v10 offset:55296
  ds_read_b64_tr_b16 v[64:65], v10 offset:56064
  v_mfma_f32_16x16x32_bf16 v[74:77], v[50:53], v[26:29], v[74:77]
  v_mfma_f32_16x16x32_bf16 v[86:89], v[50:53], v[30:33], v[86:89]
  s_cmp_eq_u32 s35, 0
  s_cbranch_scc0 K1_SK_2a4
  v_mfma_f32_16x16x32_bf16 v[90:93], v[42:45], v[102:105], v[90:93]
  v_mfma_f32_16x16x32_bf16 v[94:97], v[46:49], v[102:105], v[94:97]
  v_mfma_f32_16x16x32_bf16 v[98:101], v[50:53], v[102:105], v[98:101]
K1_SK_2a4:
  s_waitcnt lgkmcnt(0)
  s_barrier
  v_add_u32 v4, 40960, v4
  v_add_u32 v5, 40960, v5
  v_add_u32 v6, 40960, v6
  v_add_u32 v7, 40960, v7
  v_mfma_f32_16x16x32_bf16 v[66:69], v[54:57], v[34:37], v[66:69]
  ds_read_b128 v[26:29], v4 offset:0
  ds_read_b64_tr_b16 v[42:43], v8 offset:0
  v_mfma_f32_16x16x32_bf16 v[78:81], v[54:57], v[38:41], v[78:81]
  ds_read_b64_tr_b16 v[44:45], v8 offset:768
  ds_read_b128 v[30:33], v6 offset:0
  v_mfma_f32_16x16x32_bf16 v[70:73], v[58:61], v[34:37], v[70:73]
  ds_read_b64_tr_b16 v[46:47], v9 offset:0
  ds_read_b64_tr_b16 v[48:49], v9 offset:768
  v_mfma_f32_16x16x32_bf16 v[82:85], v[58:61], v[38:41], v[82:85]
  ds_read_b64_tr_b16 v[50:51], v10 offset:0
  ds_read_b64_tr_b16 v[52:53], v10 offset:768
  v_mfma_f32_16x16x32_bf16 v[74:77], v[62:65], v[34:37], v[74:77]
  v_mfma_f32_16x16x32_bf16 v[86:89], v[62:65], v[38:41], v[86:89]
  s_cmp_eq_u32 s35, 1
  s_cbranch_scc0 K1_SK_2b4
  v_mfma_f32_16x16x32_bf16 v[90:93], v[54:57], v[102:105], v[90:93]
  v_mfma_f32_16x16x32_bf16 v[94:97], v[58:61], v[102:105], v[94:97]
  v_mfma_f32_16x16x32_bf16 v[98:101], v[62:65], v[102:105], v[98:101]
K1_SK_2b4:
  s_and_b32 s40, s46, 3
  s_cmp_eq_u32 s40, s55
  s_cbranch_scc0 K1_NT4
  s_cmp_lt_u32 s46, 8
  s_cbranch_scc0 K1_NT4
  buffer_load_dword v148, v144, s[20:23], s54 offen
K1_NT4:
  s_add_u32 s46, s46, 1
  s_add_u32 s54, s54, 4096
  s_add_u32 s37, s37, 1
  s_cmp_lt_u32 s37, 2
  s_cbranch_scc1 K1_LOOP2
  s_mul_i32 s40, s55, 192
  s_add_u32 s40, s40, 144640
  v_lshlrev_b32 v18, 4, v2
  v_add_u32 v19, s40, v18
  s_mov_b32 exec_lo, 0x10001
  s_mov_b32 exec_hi, 0x10001
  ds_write_b128 v19, v[90:93] offset:0
  ds_write_b128 v19, v[94:97] offset:64
  ds_write_b128 v19, v[98:101] offset:128
  s_mov_b64 exec, s[52:53]
  v_mov_b32 v126, 0xc0135761
  v_mov_b32 v127, 0xc0135761
  s_waitcnt lgkmcnt(0)
  s_barrier
  s_load_dwordx4 s[64:67], s[0:1], 32
  s_sub_u32 s42, s34, 4
  s_mul_i32 s44, s33, 80
  s_mul_i32 s40, s32, 3
  s_lshl_b32 s41, s32, 1
  s_add_u32 s41, s41, 16
  s_cmp_lt_u32 s32, 16
  s_cselect_b32 s40, s40, s41
  s_cselect_b32 s41, 3, 2
  s_add_u32 s44, s44, s40
  s_add_u32 s44, s44, s42
  s_cmp_lt_u32 s42, s41
  s_cselect_b32 s45, 1, 0
  s_cmp_eq_u32 s34, 7
  s_cbranch_scc0 F2_NOCE
  v_lshlrev_b32 v166, 2, v1
  buffer_load_dword v167, v166, s[4:7], 0 offen offset:0 sc1
F2_NOCE:
  s_xor_b32 s41, s55, 2
  s_mul_i32 s41, s41, 192
  s_add_u32 s41, s41, 144640
  v_add_u32 v19, s41, v18
  ds_read_b128 v[26:29], v19 offset:0
  ds_read_b128 v[30:33], v19 offset:64
  ds_read_b128 v[34:37], v19 offset:128
  s_lshl_b32 s40, s35, 7
  s_lshl_b32 s41, s36, 6
  s_add_u32 s40, s40, s41
  s_add_u32 s40, s40, 143360
  v_lshlrev_b32 v20, 2, v3
  v_add_u32 v20, s40, v20
  v_xor_b32 v21, 64, v20
  ds_read_b32 v42, v20
  ds_read_b32 v44, v21
  ds_read_b32 v46, v20 offset:256
  ds_read_b32 v48, v21 offset:256
  s_lshl_b32 s40, s32, 2
  s_lshl_b32 s41, s35, 1
  s_add_u32 s40, s40, s41
  s_add_u32 s41, s40, s36
  s_xor_b32 s42, s41, 1
  s_mul_i32 s39, s33, 6
  s_mul_i32 s38, s36, 3
  s_add_u32 s39, s39, s38
  s_mul_i32 s41, s41, 48
  s_add_u32 s41, s41, s39
  s_lshl_b32 s41, s41, 9
  s_add_u32 s41, s41, 0
  s_mul_i32 s42, s42, 48
  s_add_u32 s42, s42, s39
  s_lshl_b32 s42, s42, 9
  s_add_u32 s42, s42, 0
  v_lshlrev_b32 v20, 3, v1
  s_lshl_b32 s38, s35, 1
  s_add_u32 s38, s38, s36
  s_mul_i32 s39, s38, 3072
  s_mul_i32 s40, s36, 1536
  s_add_u32 s39, s39, s40
  s_add_u32 s39, s39, 147456
  v_add_u32 v22, s39, v20
  s_xor_b32 s38, s38, 1
  s_mul_i32 s39, s38, 3072
  s_add_u32 s39, s39, s40
  s_add_u32 s39, s39, 147456
  v_add_u32 v23, s39, v20
  s_waitcnt lgkmcnt(0)
  v_add_f32 v26, v26, v90
  v_sub_f32 v26, 0, v26
  v_add_f32 v27, v27, v91
  v_sub_f32 v27, 0, v27
  v_add_f32 v28, v28, v92
  v_sub_f32 v28, 0, v28
  v_add_f32 v29, v29, v93
  v_sub_f32 v29, 0, v29
  v_add_f32 v30, v30, v94
  v_sub_f32 v30, 0, v30
  v_add_f32 v31, v31, v95
  v_sub_f32 v31, 0, v31
  v_add_f32 v32, v32, v96
  v_sub_f32 v32, 0, v32
  v_add_f32 v33, v33, v97
  v_sub_f32 v33, 0, v33
  v_add_f32 v34, v34, v98
  v_sub_f32 v34, 0, v34
  v_add_f32 v35, v35, v99
  v_sub_f32 v35, 0, v35
  v_add_f32 v36, v36, v100
  v_sub_f32 v36, 0, v36
  v_add_f32 v37, v37, v101
  v_sub_f32 v37, 0, v37
  v_pk_fma_f32 v[66:67], v[26:27], v[42:43], v[66:67] op_sel_hi:[1,0,1]
  v_pk_mul_f32 v[66:67], v[66:67], v[46:47] op_sel_hi:[1,0]
  v_pk_mul_f32 v[128:129], v[66:67], v[66:67]
  v_pk_fma_f32 v[128:129], v[128:129], s[48:49], v[126:127]
  v_pk_mul_f32 v[128:129], v[128:129], v[66:67]
  v_exp_f32 v128, v128
  v_exp_f32 v129, v129
  s_nop 0
  v_pk_add_f32 v[128:129], v[128:129], s[50:51]
  v_rcp_f32 v128, v128
  v_rcp_f32 v129, v129
  s_nop 0
  v_pk_mul_f32 v[128:129], v[128:129], v[66:67]
  v_cvt_pk_bf16_f32 v114, v128, v129
  v_pk_fma_f32 v[68:69], v[28:29], v[42:43], v[68:69] op_sel_hi:[1,0,1]
  v_pk_mul_f32 v[68:69], v[68:69], v[46:47] op_sel_hi:[1,0]
  v_pk_mul_f32 v[132:133], v[68:69], v[68:69]
  v_pk_fma_f32 v[132:133], v[132:133], s[48:49], v[126:127]
  v_pk_mul_f32 v[132:133], v[132:133], v[68:69]
  v_exp_f32 v132, v132
  v_exp_f32 v133, v133
  s_nop 0
  v_pk_add_f32 v[132:133], v[132:133], s[50:51]
  v_rcp_f32 v132, v132
  v_rcp_f32 v133, v133
  s_nop 0
  v_pk_mul_f32 v[132:133], v[132:133], v[68:69]
  v_cvt_pk_bf16_f32 v115, v132, v133
  ds_write_b64 v22, v[114:115] offset:0
  v_pk_fma_f32 v[70:71], v[30:31], v[42:43], v[70:71] op_sel_hi:[1,0,1]
  v_pk_mul_f32 v[70:71], v[70:71], v[46:47] op_sel_hi:[1,0]
  v_pk_mul_f32 v[128:129], v[70:71], v[70:71]
  v_pk_fma_f32 v[128:129], v[128:129], s[48:49], v[126:127]
  v_pk_mul_f32 v[128:129], v[128:129], v[70:71]
  v_exp_f32 v128, v128
  v_exp_f32 v129, v129
  s_nop 0
  v_pk_add_f32 v[128:129], v[128:129], s[50:51]
  v_rcp_f32 v128, v128
  v_rcp_f32 v129, v129
  s_nop 0
  v_pk_mul_f32 v[128:129], v[128:129], v[70:71]
  v_cvt_pk_bf16_f32 v116, v128, v129
  v_pk_fma_f32 v[72:73], v[32:33], v[42:43], v[72:73] op_sel_hi:[1,0,1]
  v_pk_mul_f32 v[72:73], v[72:73], v[46:47] op_sel_hi:[1,0]
  v_pk_mul_f32 v[132:133], v[72:73], v[72:73]
  v_pk_fma_f32 v[132:133], v[132:133], s[48:49], v[126:127]
  v_pk_mul_f32 v[132:133], v[132:133], v[72:73]
  v_exp_f32 v132, v132
  v_exp_f32 v133, v133
  s_nop 0
  v_pk_add_f32 v[132:133], v[132:133], s[50:51]
  v_rcp_f32 v132, v132
  v_rcp_f32 v133, v133
  s_nop 0
  v_pk_mul_f32 v[132:133], v[132:133], v[72:73]
  v_cvt_pk_bf16_f32 v117, v132, v133
  ds_write_b64 v22, v[116:117] offset:512
  v_pk_fma_f32 v[74:75], v[34:35], v[42:43], v[74:75] op_sel_hi:[1,0,1]
  v_pk_mul_f32 v[74:75], v[74:75], v[46:47] op_sel_hi:[1,0]
  v_pk_mul_f32 v[128:129], v[74:75], v[74:75]
  v_pk_fma_f32 v[128:129], v[128:129], s[48:49], v[126:127]
  v_pk_mul_f32 v[128:129], v[128:129], v[74:75]
  v_exp_f32 v128, v128
  v_exp_f32 v129, v129
  s_nop 0
  v_pk_add_f32 v[128:129], v[128:129], s[50:51]
  v_rcp_f32 v128, v128
  v_rcp_f32 v129, v129
  s_nop 0
  v_pk_mul_f32 v[128:129], v[128:129], v[74:75]
  v_cvt_pk_bf16_f32 v118, v128, v129
  v_pk_fma_f32 v[76:77], v[36:37], v[42:43], v[76:77] op_sel_hi:[1,0,1]
  v_pk_mul_f32 v[76:77], v[76:77], v[46:47] op_sel_hi:[1,0]
  v_pk_mul_f32 v[132:133], v[76:77], v[76:77]
  v_pk_fma_f32 v[132:133], v[132:133], s[48:49], v[126:127]
  v_pk_mul_f32 v[132:133], v[132:133], v[76:77]
  v_exp_f32 v132, v132
  v_exp_f32 v133, v133
  s_nop 0
  v_pk_add_f32 v[132:133], v[132:133], s[50:51]
  v_rcp_f32 v132, v132
  v_rcp_f32 v133, v133
  s_nop 0
  v_pk_mul_f32 v[132:133], v[132:133], v[76:77]
  v_cvt_pk_bf16_f32 v119, v132, v133
  ds_write_b64 v22, v[118:119] offset:1024
  v_pk_fma_f32 v[78:79], v[26:27], v[44:45], v[78:79] op_sel_hi:[1,0,1]
  v_pk_mul_f32 v[78:79], v[78:79], v[48:49] op_sel_hi:[1,0]
  v_pk_mul_f32 v[128:129], v[78:79], v[78:79]
  v_pk_fma_f32 v[128:129], v[128:129], s[48:49], v[126:127]
  v_pk_mul_f32 v[128:129], v[128:129], v[78:79]
  v_exp_f32 v128, v128
  v_exp_f32 v129, v129
  s_nop 0
  v_pk_add_f32 v[128:129], v[128:129], s[50:51]
  v_rcp_f32 v128, v128
  v_rcp_f32 v129, v129
  s_nop 0
  v_pk_mul_f32 v[128:129], v[128:129], v[78:79]
  v_cvt_pk_bf16_f32 v120, v128, v129
  v_pk_fma_f32 v[80:81], v[28:29], v[44:45], v[80:81] op_sel_hi:[1,0,1]
  v_pk_mul_f32 v[80:81], v[80:81], v[48:49] op_sel_hi:[1,0]
  v_pk_mul_f32 v[132:133], v[80:81], v[80:81]
  v_pk_fma_f32 v[132:133], v[132:133], s[48:49], v[126:127]
  v_pk_mul_f32 v[132:133], v[132:133], v[80:81]
  v_exp_f32 v132, v132
  v_exp_f32 v133, v133
  s_nop 0
  v_pk_add_f32 v[132:133], v[132:133], s[50:51]
  v_rcp_f32 v132, v132
  v_rcp_f32 v133, v133
  s_nop 0
  v_pk_mul_f32 v[132:133], v[132:133], v[80:81]
  v_cvt_pk_bf16_f32 v121, v132, v133
  ds_write_b64 v23, v[120:121] offset:0
  v_pk_fma_f32 v[82:83], v[30:31], v[44:45], v[82:83] op_sel_hi:[1,0,1]
  v_pk_mul_f32 v[82:83], v[82:83], v[48:49] op_sel_hi:[1,0]
  v_pk_mul_f32 v[128:129], v[82:83], v[82:83]
  v_pk_fma_f32 v[128:129], v[128:129], s[48:49], v[126:127]
  v_pk_mul_f32 v[128:129], v[128:129], v[82:83]
  v_exp_f32 v128, v128
  v_exp_f32 v129, v129
  s_nop 0
  v_pk_add_f32 v[128:129], v[128:129], s[50:51]
  v_rcp_f32 v128, v128
  v_rcp_f32 v129, v129
  s_nop 0
  v_pk_mul_f32 v[128:129], v[128:129], v[82:83]
  v_cvt_pk_bf16_f32 v122, v128, v129
  v_pk_fma_f32 v[84:85], v[32:33], v[44:45], v[84:85] op_sel_hi:[1,0,1]
  v_pk_mul_f32 v[84:85], v[84:85], v[48:49] op_sel_hi:[1,0]
  v_pk_mul_f32 v[132:133], v[84:85], v[84:85]
  v_pk_fma_f32 v[132:133], v[132:133], s[48:49], v[126:127]
  v_pk_mul_f32 v[132:133], v[132:133], v[84:85]
  v_exp_f32 v132, v132
  v_exp_f32 v133, v133
  s_nop 0
  v_pk_add_f32 v[132:133], v[132:133], s[50:51]
  v_rcp_f32 v132, v132
  v_rcp_f32 v133, v133
  s_nop 0
  v_pk_mul_f32 v[132:133], v[132:133], v[84:85]
  v_cvt_pk_bf16_f32 v123, v132, v133
  ds_write_b64 v23, v[122:123] offset:512
  v_pk_fma_f32 v[86:87], v[34:35], v[44:45], v[86:87] op_sel_hi:[1,0,1]
  v_pk_mul_f32 v[86:87], v[86:87], v[48:49] op_sel_hi:[1,0]
  v_pk_mul_f32 v[128:129], v[86:87], v[86:87]
  v_pk_fma_f32 v[128:129], v[128:129], s[48:49], v[126:127]
  v_pk_mul_f32 v[128:129], v[128:129], v[86:87]
  v_exp_f32 v128, v128
  v_exp_f32 v129, v129
  s_nop 0
  v_pk_add_f32 v[128:129], v[128:129], s[50:51]
  v_rcp_f32 v128, v128
  v_rcp_f32 v129, v129
  s_nop 0
  v_pk_mul_f32 v[128:129], v[128:129], v[86:87]
  v_cvt_pk_bf16_f32 v124, v128, v129
  v_pk_fma_f32 v[88:89], v[36:37], v[44:45], v[88:89] op_sel_hi:[1,0,1]
  v_pk_mul_f32 v[88:89], v[88:89], v[48:49] op_sel_hi:[1,0]
  v_pk_mul_f32 v[132:133], v[88:89], v[88:89]
  v_pk_fma_f32 v[132:133], v[132:133], s[48:49], v[126:127]
  v_pk_mul_f32 v[132:133], v[132:133], v[88:89]
  v_exp_f32 v132, v132
  v_exp_f32 v133, v133
  s_nop 0
  v_pk_add_f32 v[132:133], v[132:133], s[50:51]
  v_rcp_f32 v132, v132
  v_rcp_f32 v133, v133
  s_nop 0
  v_pk_mul_f32 v[132:133], v[132:133], v[88:89]
  v_cvt_pk_bf16_f32 v125, v132, v133
  ds_write_b64 v23, v[124:125] offset:1024
  s_cmp_eq_u32 s34, 7
  s_cbranch_scc0 F2_NOCNT
  s_waitcnt vmcnt(0)
  s_mov_b32 exec_lo, 0xffffffff
  s_mov_b32 exec_hi, 0x0
  v_cmp_gt_u32 vcc, 8, v167
  s_mov_b64 exec, s[52:53]
  s_cmp_eq_u64 vcc, 0
  s_cbranch_scc1 F2_NOCNT
  v_lshlrev_b32 v6, 2, v1
  s_mov_b32 s42, 0
  s_mov_b32 exec_lo, 0xffffffff
  s_mov_b32 exec_hi, 0x0
FP_CNT:
  buffer_load_dword v7, v6, s[4:7], 0 offen offset:0 sc1
  s_waitcnt vmcnt(0)
  v_cmp_gt_u32 vcc, 8, v7
  s_add_u32 s42, s42, 1
  s_cmp_eq_u64 vcc, 0
  s_cbranch_scc1 FP_CNT_OK
  s_cmp_lt_u32 s42, 2097152
  s_cbranch_scc0 FP_CNT_OK
  s_sleep 1
  s_branch FP_CNT
FP_CNT_OK:
  s_mov_b64 exec, s[52:53]
F2_NOCNT:
  s_waitcnt lgkmcnt(0)
  s_cmp_eq_u32 s34, 7
  s_cbranch_scc1 F2_SYNC
  s_cmp_eq_u32 s45, 0
  s_cbranch_scc1 F2_IDLE
  s_mov_b32 s35, s44
  s_sub_u32 s42, s34, 4
  s_mul_i32 s36, s42, 21248
  s_add_u32 s36, s36, 65536
  v_add_u32 v10, 1, v3
  v_and_b32 v10, 3, v10
  v_lshrrev_b32 v11, 1, v2
  v_and_b32 v12, 1, v2
  v_lshlrev_b32 v13, 4, v11
  v_add_u32 v13, v13, v3
  v_lshlrev_b32 v14, 3, v12
  v_sub_u32 v13, v13, v14
  v_add_u32 v13, 9, v13
  v_sub_u32 v13, v13, v10
  v_lshlrev_b32 v13, 1, v13
  v_mul_u32_u24 v10, 4160, v10
  v_add_u32 v13, v13, v10
  v_add_u32 v4, s36, v13
  v_sub_u32 v13, v3, v11
  v_lshlrev_b32 v13, 1, v13
  v_add_u32 v13, v13, v12
  v_lshlrev_b32 v13, 4, v13
  s_add_u32 s40, s36, 17152
  v_add_u32 v5, s40, v13
  s_waitcnt vmcnt(0)
  s_barrier
  s_sleep 3
  s_sub_u32 s42, s34, 4
  v_lshrrev_b32 v8, 3, v1
  s_lshl_b32 s40, s42, 3
  v_add_u32 v8, s40, v8
  v_and_b32 v9, 7, v1
  v_lshlrev_b32 v9, 4, v9
  v_mul_u32_u24 v10, 144, v8
  v_add_u32 v10, v10, v9
  v_add_u32 v10, 49152, v10
  v_lshlrev_b32 v8, 12, v8
  v_add_u32 v8, v8, v9
  ds_read_b128 v[16:19], v10 offset:0
  ds_read_b128 v[20:23], v10 offset:3456
  ds_read_b128 v[24:27], v10 offset:6912
  ds_read_b128 v[28:31], v10 offset:10368
  s_mul_i32 s40, s33, 327680
  s_lshl_b32 s41, s32, 7
  s_add_u32 s40, s40, s41
  s_add_u32 s40, s40, 6291456
  s_waitcnt lgkmcnt(0)
  buffer_store_dwordx4 v[16:19], v8, s[16:19], s40 offen sc1
  s_add_u32 s40, s40, 98304
  buffer_store_dwordx4 v[20:23], v8, s[16:19], s40 offen sc1
  s_add_u32 s40, s40, 98304
  buffer_store_dwordx4 v[24:27], v8, s[16:19], s40 offen sc1
  s_add_u32 s40, s40, 98304
  s_cmp_eq_u32 s42, 0
  s_cselect_b32 s40, s40, 0x80000000
  buffer_store_dwordx4 v[28:31], v8, s[16:19], s40 offen sc1
  s_add_u32 s40, s40, 98304
  s_waitcnt lgkmcnt(0)
  s_lshl_b32 s40, s44, 12
  s_add_u32 s20, s64, s40
  s_addc_u32 s21, s65, 0
  s_and_b32 s21, s21, 0xffff
  s_mov_b32 s22, 4096
  s_mov_b32 s23, 0x20000
  s_mov_b32 s24, s66
  s_and_b32 s25, s67, 0xffff
  s_mov_b32 s26, 1280
  s_mov_b32 s27, 0x20000
  v_lshlrev_b32 v167, 4, v1
  buffer_load_dwordx4 v[136:139], v167, s[20:23], 0 offen offset:0
  buffer_load_dwordx2 v[140:141], v167, s[20:23], 0 offen offset:16
  buffer_load_dwordx4 v[142:145], v167, s[20:23], 0 offen offset:1024
  buffer_load_dwordx2 v[146:147], v167, s[20:23], 0 offen offset:1040
  buffer_load_dwordx4 v[148:151], v167, s[20:23], 0 offen offset:2048
  buffer_load_dwordx2 v[152:153], v167, s[20:23], 0 offen offset:2064
  buffer_load_dwordx4 v[154:157], v167, s[20:23], 0 offen offset:3072
  buffer_load_dwordx2 v[158:159], v167, s[20:23], 0 offen offset:3088
  v_mov_b32 v167, 0
  buffer_load_dwordx2 v[164:165], v167, s[20:23], 0 offen
  s_lshl_b32 s40, s44, 1
  buffer_load_ushort v166, v167, s[24:27], s40 offen
  s_barrier
  s_waitcnt vmcnt(0)
  v_mov_b32 v46, v166
  v_mov_b32 v8, 0
  v_mov_b32 v9, 0
  v_lshlrev_b32 v10, 3, v1
  v_add_u32 v10, s36, v10
  ds_write_b64 v10, v[8:9] offset:16640
  v_lshlrev_b32 v10, 4, v1
  v_add_u32 v10, s36, v10
  v_alignbit_b32 v80, v137, v136, 16
  v_alignbit_b32 v81, v138, v137, 16
  v_alignbit_b32 v82, v139, v138, 16
  v_alignbit_b32 v83, v140, v139, 16
  v_mov_b32 v84, v137
  v_mov_b32 v85, v138
  v_mov_b32 v86, v139
  v_mov_b32 v87, v140
  v_mov_b32 v88, v81
  v_mov_b32 v89, v82
  v_mov_b32 v90, v83
  v_alignbit_b32 v91, v141, v140, 16
  ds_write_b128 v10, v[136:139] offset:32
  ds_write_b128 v10, v[80:83] offset:4192
  ds_write_b128 v10, v[84:87] offset:8352
  ds_write_b128 v10, v[88:91] offset:12512
  s_waitcnt lgkmcnt(4)
  v_alignbit_b32 v92, v143, v142, 16
  v_alignbit_b32 v93, v144, v143, 16
  v_alignbit_b32 v94, v145, v144, 16
  v_alignbit_b32 v95, v146, v145, 16
  v_mov_b32 v96, v143
  v_mov_b32 v97, v144
  v_mov_b32 v98, v145
  v_mov_b32 v99, v146
  v_mov_b32 v100, v93
  v_mov_b32 v101, v94
  v_mov_b32 v102, v95
  v_alignbit_b32 v103, v147, v146, 16
  ds_write_b128 v10, v[142:145] offset:1056
  ds_write_b128 v10, v[92:95] offset:5216
  ds_write_b128 v10, v[96:99] offset:9376
  ds_write_b128 v10, v[100:103] offset:13536
  s_waitcnt lgkmcnt(4)
  s_waitcnt vmcnt(0)
  s_barrier
  v_alignbit_b32 v104, v149, v148, 16
  v_alignbit_b32 v105, v150, v149, 16
  v_alignbit_b32 v106, v151, v150, 16
  v_alignbit_b32 v107, v152, v151, 16
  v_mov_b32 v108, v149
  v_mov_b32 v109, v150
  v_mov_b32 v110, v151
  v_mov_b32 v111, v152
  v_mov_b32 v112, v105
  v_mov_b32 v113, v106
  v_mov_b32 v114, v107
  v_alignbit_b32 v115, v153, v152, 16
  ds_write_b128 v10, v[148:151] offset:2080
  ds_write_b128 v10, v[104:107] offset:6240
  ds_write_b128 v10, v[108:111] offset:10400
  ds_write_b128 v10, v[112:115] offset:14560
  s_waitcnt lgkmcnt(4)
  s_barrier
  v_alignbit_b32 v116, v155, v154, 16
  v_alignbit_b32 v117, v156, v155, 16
  v_alignbit_b32 v118, v157, v156, 16
  v_alignbit_b32 v119, v158, v157, 16
  v_mov_b32 v120, v155
  v_mov_b32 v121, v156
  v_mov_b32 v122, v157
  v_mov_b32 v123, v158
  v_mov_b32 v124, v117
  v_mov_b32 v125, v118
  v_mov_b32 v126, v119
  v_alignbit_b32 v127, v159, v158, 16
  ds_write_b128 v10, v[154:157] offset:3104
  ds_write_b128 v10, v[116:119] offset:7264
  ds_write_b128 v10, v[120:123] offset:11424
  ds_write_b128 v10, v[124:127] offset:15584
  s_waitcnt lgkmcnt(4)
  v_mov_b32 v160, 0
  v_mov_b32 v161, 0
  v_mov_b32 v162, 0
  v_mov_b32 v163, 0
  v_cmp_eq_u32 vcc, 1, v1
  s_nop 1
  v_cndmask_b32 v164, 0, v164, vcc
  v_cndmask_b32 v165, 0, v165, vcc
  s_waitcnt lgkmcnt(0)
  s_mov_b32 exec_lo, 0x3
  s_mov_b32 exec_hi, 0x0
  v_alignbit_b32 v80, v161, v160, 16
  v_alignbit_b32 v81, v162, v161, 16
  v_alignbit_b32 v82, v163, v162, 16
  v_alignbit_b32 v83, v164, v163, 16
  v_mov_b32 v84, v161
  v_mov_b32 v85, v162
  v_mov_b32 v86, v163
  v_mov_b32 v87, v164
  v_mov_b32 v88, v81
  v_mov_b32 v89, v82
  v_mov_b32 v90, v83
  v_alignbit_b32 v91, v165, v164, 16
  ds_write_b128 v10, v[160:163] offset:0
  ds_write_b128 v10, v[80:83] offset:4160
  ds_write_b128 v10, v[84:87] offset:8320
  ds_write_b128 v10, v[88:91] offset:12480
  s_mov_b64 exec, s[52:53]
  v_lshlrev_b32 v46, 16, v46
  v_mov_b32 v48, 0
  v_mov_b32 v49, 0
  v_mov_b32 v50, 0
  v_mov_b32 v51, 0
  v_mov_b32 v52, 0
  v_mov_b32 v53, 0
  v_mov_b32 v54, 0
  v_mov_b32 v55, 0
  v_mov_b32 v56, 0
  v_mov_b32 v57, 0
  v_mov_b32 v58, 0
  v_mov_b32 v59, 0
  v_mov_b32 v60, 0
  v_mov_b32 v61, 0
  v_mov_b32 v62, 0
  v_mov_b32 v63, 0
  v_mov_b32 v64, 0
  v_mov_b32 v65, 0
  v_mov_b32 v66, 0
  v_mov_b32 v67, 0
  v_mov_b32 v68, 0
  v_mov_b32 v69, 0
  v_mov_b32 v70, 0
  v_mov_b32 v71, 0
  v_mov_b32 v72, 0
  v_mov_b32 v73, 0
  v_mov_b32 v74, 0
  v_mov_b32 v75, 0
  v_mov_b32 v76, 0
  v_mov_b32 v77, 0
  v_mov_b32 v78, 0
  v_mov_b32 v79, 0
  s_waitcnt vmcnt(0) lgkmcnt(0)
  s_barrier
  s_barrier
  s_barrier
  v_lshlrev_b32 v6, 4, v1
  s_lshl_b32 s40, s35, 12
  s_add_u32 s40, s40, 6291456
  s_add_u32 m0, s36, 17152
  s_add_u32 s41, s40, 0
  buffer_load_dwordx4 v6, s[16:19], s41 offen sc1 lds
  s_add_u32 m0, s36, 18176
  s_add_u32 s41, s40, 1024
  buffer_load_dwordx4 v6, s[16:19], s41 offen sc1 lds
  s_add_u32 m0, s36, 19200
  s_add_u32 s41, s40, 2048
  buffer_load_dwordx4 v6, s[16:19], s41 offen sc1 lds
  s_add_u32 m0, s36, 20224
  s_add_u32 s41, s40, 3072
  buffer_load_dwordx4 v6, s[16:19], s41 offen sc1 lds
  ds_read_b64 v[80:81], v4 offset:0
  ds_read_b64 v[82:83], v4 offset:8
  ds_read_b64 v[84:85], v4 offset:512
  ds_read_b64 v[86:87], v4 offset:520
  ds_read_b64 v[88:89], v4 offset:1024
  ds_read_b64 v[90:91], v4 offset:1032
  ds_read_b64 v[92:93], v4 offset:1536
  ds_read_b64 v[94:95], v4 offset:1544
  s_waitcnt lgkmcnt(6)
  ds_read_b64 v[96:97], v4 offset:2048
  ds_read_b64 v[98:99], v4 offset:2056
  ds_read_b64 v[100:101], v4 offset:2560
  ds_read_b64 v[102:103], v4 offset:2568
  ds_read_b64 v[104:105], v4 offset:3072
  ds_read_b64 v[106:107], v4 offset:3080
  ds_read_b64 v[108:109], v4 offset:3584
  ds_read_b64 v[110:111], v4 offset:3592
  s_waitcnt lgkmcnt(6)
  s_barrier
  s_waitcnt vmcnt(0)
  ds_read_b128 v[112:115], v5 offset:0
  ds_read_b128 v[116:119], v5 offset:512
  ds_read_b128 v[120:123], v5 offset:1024
  ds_read_b128 v[124:127], v5 offset:1536
  ds_read_b128 v[128:131], v5 offset:2048
  ds_read_b128 v[132:135], v5 offset:2560
  ds_read_b128 v[136:139], v5 offset:3072
  ds_read_b128 v[140:143], v5 offset:3584
  s_mov_b32 s37, 0
F2_CLOOP:
  v_add_u32 v4, 64, v4
  v_subrev_u32 v5, 64, v5
  s_waitcnt lgkmcnt(0)
  v_mfma_f32_16x16x32_bf16 v[48:51], v[80:83], v[112:115], v[48:51]
  v_mfma_f32_16x16x32_bf16 v[52:55], v[80:83], v[116:119], v[52:55]
  v_mfma_f32_16x16x32_bf16 v[56:59], v[80:83], v[120:123], v[56:59]
  v_mfma_f32_16x16x32_bf16 v[60:63], v[80:83], v[124:127], v[60:63]
  v_mfma_f32_16x16x32_bf16 v[64:67], v[80:83], v[128:131], v[64:67]
  v_mfma_f32_16x16x32_bf16 v[68:71], v[80:83], v[132:135], v[68:71]
  v_mfma_f32_16x16x32_bf16 v[72:75], v[80:83], v[136:139], v[72:75]
  v_mfma_f32_16x16x32_bf16 v[76:79], v[80:83], v[140:143], v[76:79]
  ds_read_b64 v[80:81], v4 offset:0
  ds_read_b64 v[82:83], v4 offset:8
  ds_read_b128 v[140:143], v5 offset:3584
  v_mfma_f32_16x16x32_bf16 v[52:55], v[84:87], v[112:115], v[52:55]
  v_mfma_f32_16x16x32_bf16 v[56:59], v[84:87], v[116:119], v[56:59]
  v_mfma_f32_16x16x32_bf16 v[60:63], v[84:87], v[120:123], v[60:63]
  v_mfma_f32_16x16x32_bf16 v[64:67], v[84:87], v[124:127], v[64:67]
  v_mfma_f32_16x16x32_bf16 v[68:71], v[84:87], v[128:131], v[68:71]
  v_mfma_f32_16x16x32_bf16 v[72:75], v[84:87], v[132:135], v[72:75]
  v_mfma_f32_16x16x32_bf16 v[76:79], v[84:87], v[136:139], v[76:79]
  ds_read_b64 v[84:85], v4 offset:512
  ds_read_b64 v[86:87], v4 offset:520
  ds_read_b128 v[136:139], v5 offset:3072
  v_mfma_f32_16x16x32_bf16 v[56:59], v[88:91], v[112:115], v[56:59]
  v_mfma_f32_16x16x32_bf16 v[60:63], v[88:91], v[116:119], v[60:63]
  v_mfma_f32_16x16x32_bf16 v[64:67], v[88:91], v[120:123], v[64:67]
  v_mfma_f32_16x16x32_bf16 v[68:71], v[88:91], v[124:127], v[68:71]
  v_mfma_f32_16x16x32_bf16 v[72:75], v[88:91], v[128:131], v[72:75]
  v_mfma_f32_16x16x32_bf16 v[76:79], v[88:91], v[132:135], v[76:79]
  ds_read_b64 v[88:89], v4 offset:1024
  ds_read_b64 v[90:91], v4 offset:1032
  ds_read_b128 v[132:135], v5 offset:2560
  v_mfma_f32_16x16x32_bf16 v[60:63], v[92:95], v[112:115], v[60:63]
  v_mfma_f32_16x16x32_bf16 v[64:67], v[92:95], v[116:119], v[64:67]
  v_mfma_f32_16x16x32_bf16 v[68:71], v[92:95], v[120:123], v[68:71]
  v_mfma_f32_16x16x32_bf16 v[72:75], v[92:95], v[124:127], v[72:75]
  v_mfma_f32_16x16x32_bf16 v[76:79], v[92:95], v[128:131], v[76:79]
  ds_read_b64 v[92:93], v4 offset:1536
  ds_read_b64 v[94:95], v4 offset:1544
  ds_read_b128 v[128:131], v5 offset:2048
  s_waitcnt lgkmcnt(6)
  s_barrier
  v_mfma_f32_16x16x32_bf16 v[64:67], v[96:99], v[112:115], v[64:67]
  v_mfma_f32_16x16x32_bf16 v[68:71], v[96:99], v[116:119], v[68:71]
  v_mfma_f32_16x16x32_bf16 v[72:75], v[96:99], v[120:123], v[72:75]
  v_mfma_f32_16x16x32_bf16 v[76:79], v[96:99], v[124:127], v[76:79]
  ds_read_b64 v[96:97], v4 offset:2048
  ds_read_b64 v[98:99], v4 offset:2056
  ds_read_b128 v[124:127], v5 offset:1536
  v_mfma_f32_16x16x32_bf16 v[68:71], v[100:103], v[112:115], v[68:71]
  v_mfma_f32_16x16x32_bf16 v[72:75], v[100:103], v[116:119], v[72:75]
  v_mfma_f32_16x16x32_bf16 v[76:79], v[100:103], v[120:123], v[76:79]
  ds_read_b64 v[100:101], v4 offset:2560
  ds_read_b64 v[102:103], v4 offset:2568
  ds_read_b128 v[120:123], v5 offset:1024
  v_mfma_f32_16x16x32_bf16 v[72:75], v[104:107], v[112:115], v[72:75]
  v_mfma_f32_16x16x32_bf16 v[76:79], v[104:107], v[116:119], v[76:79]
  ds_read_b64 v[104:105], v4 offset:3072
  ds_read_b64 v[106:107], v4 offset:3080
  ds_read_b128 v[116:119], v5 offset:512
  s_waitcnt lgkmcnt(6)
  v_mfma_f32_16x16x32_bf16 v[76:79], v[108:111], v[112:115], v[76:79]
  ds_read_b64 v[108:109], v4 offset:3584
  ds_read_b64 v[110:111], v4 offset:3592
  ds_read_b128 v[112:115], v5 offset:0
  v_add_u32 v4, 64, v4
  v_subrev_u32 v5, 64, v5
  s_waitcnt lgkmcnt(0)
  v_mfma_f32_16x16x32_bf16 v[48:51], v[80:83], v[112:115], v[48:51]
  v_mfma_f32_16x16x32_bf16 v[52:55], v[80:83], v[116:119], v[52:55]
  v_mfma_f32_16x16x32_bf16 v[56:59], v[80:83], v[120:123], v[56:59]
  v_mfma_f32_16x16x32_bf16 v[60:63], v[80:83], v[124:127], v[60:63]
  v_mfma_f32_16x16x32_bf16 v[64:67], v[80:83], v[128:131], v[64:67]
  v_mfma_f32_16x16x32_bf16 v[68:71], v[80:83], v[132:135], v[68:71]
  v_mfma_f32_16x16x32_bf16 v[72:75], v[80:83], v[136:139], v[72:75]
  v_mfma_f32_16x16x32_bf16 v[76:79], v[80:83], v[140:143], v[76:79]
  ds_read_b64 v[80:81], v4 offset:0
  ds_read_b64 v[82:83], v4 offset:8
  ds_read_b128 v[140:143], v5 offset:3584
  v_mfma_f32_16x16x32_bf16 v[52:55], v[84:87], v[112:115], v[52:55]
  v_mfma_f32_16x16x32_bf16 v[56:59], v[84:87], v[116:119], v[56:59]
  v_mfma_f32_16x16x32_bf16 v[60:63], v[84:87], v[120:123], v[60:63]
  v_mfma_f32_16x16x32_bf16 v[64:67], v[84:87], v[124:127], v[64:67]
  v_mfma_f32_16x16x32_bf16 v[68:71], v[84:87], v[128:131], v[68:71]
  v_mfma_f32_16x16x32_bf16 v[72:75], v[84:87], v[132:135], v[72:75]
  v_mfma_f32_16x16x32_bf16 v[76:79], v[84:87], v[136:139], v[76:79]
  ds_read_b64 v[84:85], v4 offset:512
  ds_read_b64 v[86:87], v4 offset:520
  ds_read_b128 v[136:139], v5 offset:3072
  s_barrier
  v_mfma_f32_16x16x32_bf16 v[56:59], v[88:91], v[112:115], v[56:59]
  v_mfma_f32_16x16x32_bf16 v[60:63], v[88:91], v[116:119], v[60:63]
  v_mfma_f32_16x16x32_bf16 v[64:67], v[88:91], v[120:123], v[64:67]
  v_mfma_f32_16x16x32_bf16 v[68:71], v[88:91], v[124:127], v[68:71]
  v_mfma_f32_16x16x32_bf16 v[72:75], v[88:91], v[128:131], v[72:75]
  v_mfma_f32_16x16x32_bf16 v[76:79], v[88:91], v[132:135], v[76:79]
  ds_read_b64 v[88:89], v4 offset:1024
  ds_read_b64 v[90:91], v4 offset:1032
  ds_read_b128 v[132:135], v5 offset:2560
  v_mfma_f32_16x16x32_bf16 v[60:63], v[92:95], v[112:115], v[60:63]
  v_mfma_f32_16x16x32_bf16 v[64:67], v[92:95], v[116:119], v[64:67]
  v_mfma_f32_16x16x32_bf16 v[68:71], v[92:95], v[120:123], v[68:71]
  v_mfma_f32_16x16x32_bf16 v[72:75], v[92:95], v[124:127], v[72:75]
  v_mfma_f32_16x16x32_bf16 v[76:79], v[92:95], v[128:131], v[76:79]
  ds_read_b64 v[92:93], v4 offset:1536
  ds_read_b64 v[94:95], v4 offset:1544
  ds_read_b128 v[128:131], v5 offset:2048
  s_waitcnt lgkmcnt(6)
  v_mfma_f32_16x16x32_bf16 v[64:67], v[96:99], v[112:115], v[64:67]
  v_mfma_f32_16x16x32_bf16 v[68:71], v[96:99], v[116:119], v[68:71]
  v_mfma_f32_16x16x32_bf16 v[72:75], v[96:99], v[120:123], v[72:75]
  v_mfma_f32_16x16x32_bf16 v[76:79], v[96:99], v[124:127], v[76:79]
  ds_read_b64 v[96:97], v4 offset:2048
  ds_read_b64 v[98:99], v4 offset:2056
  ds_read_b128 v[124:127], v5 offset:1536
  v_mfma_f32_16x16x32_bf16 v[68:71], v[100:103], v[112:115], v[68:71]
  v_mfma_f32_16x16x32_bf16 v[72:75], v[100:103], v[116:119], v[72:75]
  v_mfma_f32_16x16x32_bf16 v[76:79], v[100:103], v[120:123], v[76:79]
  ds_read_b64 v[100:101], v4 offset:2560
  ds_read_b64 v[102:103], v4 offset:2568
  ds_read_b128 v[120:123], v5 offset:1024
  v_mfma_f32_16x16x32_bf16 v[72:75], v[104:107], v[112:115], v[72:75]
  v_mfma_f32_16x16x32_bf16 v[76:79], v[104:107], v[116:119], v[76:79]
  ds_read_b64 v[104:105], v4 offset:3072
  ds_read_b64 v[106:107], v4 offset:3080
  ds_read_b128 v[116:119], v5 offset:512
  s_waitcnt lgkmcnt(6)
  v_mfma_f32_16x16x32_bf16 v[76:79], v[108:111], v[112:115], v[76:79]
  ds_read_b64 v[108:109], v4 offset:3584
  ds_read_b64 v[110:111], v4 offset:3592
  ds_read_b128 v[112:115], v5 offset:0
  s_barrier
  s_add_u32 s37, s37, 2
  s_cmp_lt_u32 s37, 8
  s_cbranch_scc1 F2_CLOOP
  s_waitcnt lgkmcnt(0)
  v_lshlrev_b32 v6, 5, v3
  v_lshrrev_b32 v7, 1, v2
  v_lshlrev_b32 v7, 4, v7
  v_add_u32 v6, v6, v7
  v_and_b32 v7, 1, v2
  v_xor_b32 v7, 1, v7
  v_lshlrev_b32 v7, 3, v7
  v_add_u32 v6, v6, v7
  s_add_u32 s40, s36, 17152
  v_add_u32 v6, s40, v6
  ds_read_b64 v[80:81], v6 offset:0
  ds_read_b64 v[82:83], v6 offset:512
  ds_read_b64 v[84:85], v6 offset:1024
  ds_read_b64 v[86:87], v6 offset:1536
  ds_read_b64 v[88:89], v6 offset:2048
  ds_read_b64 v[90:91], v6 offset:2560
  ds_read_b64 v[92:93], v6 offset:3072
  ds_read_b64 v[94:95], v6 offset:3584
  v_lshlrev_b32 v8, 5, v3
  v_lshlrev_b32 v9, 3, v2
  v_add_u32 v8, v8, v9
  s_lshl_b32 s40, s35, 12
  s_add_u32 s40, s40, 9437184
  s_waitcnt lgkmcnt(0)
  v_and_b32 v112, s47, v81
  v_lshlrev_b32 v113, 16, v81
  v_and_b32 v114, s47, v80
  v_lshlrev_b32 v115, 16, v80
  v_fmac_f32 v48, v112, v46
  v_fmac_f32 v49, v113, v46
  v_fmac_f32 v50, v114, v46
  v_fmac_f32 v51, v115, v46
  v_cvt_pk_bf16_f32 v116, v48, v49
  v_cvt_pk_bf16_f32 v117, v50, v51
  buffer_store_dwordx2 v[116:117], v8, s[16:19], s40 offen offset:0 sc1
  v_and_b32 v120, s47, v83
  v_lshlrev_b32 v121, 16, v83
  v_and_b32 v122, s47, v82
  v_lshlrev_b32 v123, 16, v82
  v_fmac_f32 v52, v120, v46
  v_fmac_f32 v53, v121, v46
  v_fmac_f32 v54, v122, v46
  v_fmac_f32 v55, v123, v46
  v_cvt_pk_bf16_f32 v124, v52, v53
  v_cvt_pk_bf16_f32 v125, v54, v55
  buffer_store_dwordx2 v[124:125], v8, s[16:19], s40 offen offset:512 sc1
  v_and_b32 v128, s47, v85
  v_lshlrev_b32 v129, 16, v85
  v_and_b32 v130, s47, v84
  v_lshlrev_b32 v131, 16, v84
  v_fmac_f32 v56, v128, v46
  v_fmac_f32 v57, v129, v46
  v_fmac_f32 v58, v130, v46
  v_fmac_f32 v59, v131, v46
  v_cvt_pk_bf16_f32 v132, v56, v57
  v_cvt_pk_bf16_f32 v133, v58, v59
  buffer_store_dwordx2 v[132:133], v8, s[16:19], s40 offen offset:1024 sc1
  v_and_b32 v136, s47, v87
  v_lshlrev_b32 v137, 16, v87
  v_and_b32 v138, s47, v86
  v_lshlrev_b32 v139, 16, v86
  v_fmac_f32 v60, v136, v46
  v_fmac_f32 v61, v137, v46
  v_fmac_f32 v62, v138, v46
  v_fmac_f32 v63, v139, v46
  v_cvt_pk_bf16_f32 v140, v60, v61
  v_cvt_pk_bf16_f32 v141, v62, v63
  buffer_store_dwordx2 v[140:141], v8, s[16:19], s40 offen offset:1536 sc1
  v_and_b32 v112, s47, v89
  v_lshlrev_b32 v113, 16, v89
  v_and_b32 v114, s47, v88
  v_lshlrev_b32 v115, 16, v88
  v_fmac_f32 v64, v112, v46
  v_fmac_f32 v65, v113, v46
  v_fmac_f32 v66, v114, v46
  v_fmac_f32 v67, v115, v46
  v_cvt_pk_bf16_f32 v116, v64, v65
  v_cvt_pk_bf16_f32 v117, v66, v67
  buffer_store_dwordx2 v[116:117], v8, s[16:19], s40 offen offset:2048 sc1
  v_and_b32 v120, s47, v91
  v_lshlrev_b32 v121, 16, v91
  v_and_b32 v122, s47, v90
  v_lshlrev_b32 v123, 16, v90
  v_fmac_f32 v68, v120, v46
  v_fmac_f32 v69, v121, v46
  v_fmac_f32 v70, v122, v46
  v_fmac_f32 v71, v123, v46
  v_cvt_pk_bf16_f32 v124, v68, v69
  v_cvt_pk_bf16_f32 v125, v70, v71
  buffer_store_dwordx2 v[124:125], v8, s[16:19], s40 offen offset:2560 sc1
  v_and_b32 v128, s47, v93
  v_lshlrev_b32 v129, 16, v93
  v_and_b32 v130, s47, v92
  v_lshlrev_b32 v131, 16, v92
  v_fmac_f32 v72, v128, v46
  v_fmac_f32 v73, v129, v46
  v_fmac_f32 v74, v130, v46
  v_fmac_f32 v75, v131, v46
  v_cvt_pk_bf16_f32 v132, v72, v73
  v_cvt_pk_bf16_f32 v133, v74, v75
  buffer_store_dwordx2 v[132:133], v8, s[16:19], s40 offen offset:3072 sc1
  v_and_b32 v136, s47, v95
  v_lshlrev_b32 v137, 16, v95
  v_and_b32 v138, s47, v94
  v_lshlrev_b32 v139, 16, v94
  v_fmac_f32 v76, v136, v46
  v_fmac_f32 v77, v137, v46
  v_fmac_f32 v78, v138, v46
  v_fmac_f32 v79, v139, v46
  v_cvt_pk_bf16_f32 v140, v76, v77
  v_cvt_pk_bf16_f32 v141, v78, v79
  buffer_store_dwordx2 v[140:141], v8, s[16:19], s40 offen offset:3584 sc1
  s_waitcnt vmcnt(0)
  s_barrier
F3_IDLE:
  s_load_dwordx2 s[56:57], s[0:1], 0
  s_load_dwordx2 s[58:59], s[0:1], 88
  v_lshlrev_b32 v4, 4, v1
  s_lshl_b32 s35, s32, 2
  s_add_u32 s35, s35, s55
  s_lshr_b32 s39, s34, 2
  s_mul_i32 s36, s35, 24576
  s_mul_i32 s40, s39, 12288
  s_add_u32 s36, s36, s40
  s_add_u32 s36, s36, 12582912
  s_mul_i32 s40, s39, 61440
  v_add_u32 v26, s40, v4
  s_lshl_b32 s40, s35, 4
  s_mul_i32 s40, s40, 1280
  s_mul_i32 s41, s33, 160
  s_add_u32 s40, s40, s41
  v_add_u32 v12, 0, v1
  v_mul_u32_u24 v13, 6554, v12
  v_lshrrev_b32 v13, 16, v13
  v_mul_u32_u24 v14, 10, v13
  v_sub_u32 v14, v12, v14
  v_lshlrev_b32 v14, 4, v14
  v_mul_u32_u24 v13, 1280, v13
  v_add_u32 v13, v13, v14
  v_add_u32 v5, s40, v13
  v_lshrrev_b32 v13, 1, v12
  v_lshlrev_b32 v13, 12, v13
  v_and_b32 v14, 1, v12
  v_lshlrev_b32 v14, 4, v14
  v_add_u32 v8, v13, v14
  v_add_u32 v12, 64, v1
  v_mul_u32_u24 v13, 6554, v12
  v_lshrrev_b32 v13, 16, v13
  v_mul_u32_u24 v14, 10, v13
  v_sub_u32 v14, v12, v14
  v_lshlrev_b32 v14, 4, v14
  v_mul_u32_u24 v13, 1280, v13
  v_add_u32 v13, v13, v14
  v_add_u32 v6, s40, v13
  v_lshrrev_b32 v13, 1, v12
  v_lshlrev_b32 v13, 12, v13
  v_and_b32 v14, 1, v12
  v_lshlrev_b32 v14, 4, v14
  v_add_u32 v9, v13, v14
  v_add_u32 v12, 128, v1
  v_mul_u32_u24 v13, 6554, v12
  v_lshrrev_b32 v13, 16, v13
  v_mul_u32_u24 v14, 10, v13
  v_sub_u32 v14, v12, v14
  v_lshlrev_b32 v14, 4, v14
  v_mul_u32_u24 v13, 1280, v13
  v_add_u32 v13, v13, v14
  v_add_u32 v7, s40, v13
  v_lshrrev_b32 v13, 1, v12
  v_lshlrev_b32 v13, 12, v13
  v_and_b32 v14, 1, v12
  v_lshlrev_b32 v14, 4, v14
  v_add_u32 v10, v13, v14
  s_mul_i32 s37, s55, 2560
  s_mul_i32 s38, s33, 327680
  s_lshl_b32 s41, s35, 5
  s_add_u32 s38, s38, s41
  s_add_u32 s38, s38, 9437184
  s_lshl_b32 s40, s55, 6
  s_add_u32 s40, s40, 143360
  v_lshlrev_b32 v21, 2, v3
  v_add_u32 v21, s40, v21
  ds_read_b32 v24, v21
  ds_read_b32 v25, v21 offset:256
  v_mov_b32 v68, 0
  v_mov_b32 v69, 0
  v_mov_b32 v70, 0
  v_mov_b32 v71, 0
  v_mov_b32 v72, 0
  v_mov_b32 v73, 0
  v_mov_b32 v74, 0
  v_mov_b32 v75, 0
  v_mov_b32 v76, 0
  v_mov_b32 v77, 0
  v_mov_b32 v78, 0
  v_mov_b32 v79, 0
  v_mov_b32 v80, 0
  v_mov_b32 v81, 0
  v_mov_b32 v82, 0
  v_mov_b32 v83, 0
  v_mov_b32 v84, 0
  v_mov_b32 v85, 0
  v_mov_b32 v86, 0
  v_mov_b32 v87, 0
  s_waitcnt lgkmcnt(0)
  s_mov_b32 s8, s56
  s_and_b32 s9, s57, 0xffff
  s_mov_b32 s10, 2621440
  s_mov_b32 s11, 0x20000
  s_mov_b32 s12, s58
  s_and_b32 s13, s59, 0xffff
  s_mov_b32 s14, 2621440
  s_mov_b32 s15, 0x20000
  s_barrier
F3_BMAIN:
  s_add_u32 s40, s36, 0
  buffer_load_dwordx4 v[88:91], v4, s[16:19], s40 offen offset:0 sc1
  s_add_u32 s40, s36, 0
  buffer_load_dwordx4 v[92:95], v4, s[16:19], s40 offen offset:1024 sc1
  s_add_u32 s40, s36, 0
  buffer_load_dwordx4 v[96:99], v4, s[16:19], s40 offen offset:2048 sc1
  s_add_u32 s40, s36, 0
  buffer_load_dwordx4 v[100:103], v4, s[16:19], s40 offen offset:3072 sc1
  s_add_u32 s40, s36, 4096
  buffer_load_dwordx4 v[104:107], v4, s[16:19], s40 offen offset:0 sc1
  s_barrier
  ds_read_b128 v[28:31], v26 offset:0
  ds_read_b128 v[32:35], v26 offset:1024
  ds_read_b128 v[36:39], v26 offset:2048
  ds_read_b128 v[40:43], v26 offset:3072
  ds_read_b128 v[44:47], v26 offset:4096
  s_waitcnt vmcnt(4) lgkmcnt(0)
  v_mfma_f32_16x16x32_bf16 v[68:71], v[28:31], v[88:91], v[68:71]
  ds_read_b128 v[48:51], v26 offset:5120
  v_mfma_f32_16x16x32_bf16 v[72:75], v[32:35], v[88:91], v[72:75]
  ds_read_b128 v[52:55], v26 offset:6144
  v_mfma_f32_16x16x32_bf16 v[76:79], v[36:39], v[88:91], v[76:79]
  ds_read_b128 v[56:59], v26 offset:7168
  s_add_u32 s40, s36, 4096
  buffer_load_dwordx4 v[108:111], v4, s[16:19], s40 offen offset:1024 sc1
  v_mfma_f32_16x16x32_bf16 v[80:83], v[40:43], v[88:91], v[80:83]
  ds_read_b128 v[60:63], v26 offset:8192
  v_mfma_f32_16x16x32_bf16 v[84:87], v[44:47], v[88:91], v[84:87]
  ds_read_b128 v[64:67], v26 offset:9216
  s_waitcnt vmcnt(4) lgkmcnt(0)
  v_mfma_f32_16x16x32_bf16 v[68:71], v[48:51], v[92:95], v[68:71]
  ds_read_b128 v[28:31], v26 offset:10240
  v_mfma_f32_16x16x32_bf16 v[72:75], v[52:55], v[92:95], v[72:75]
  ds_read_b128 v[32:35], v26 offset:11264
  v_mfma_f32_16x16x32_bf16 v[76:79], v[56:59], v[92:95], v[76:79]
  ds_read_b128 v[36:39], v26 offset:12288
  s_add_u32 s40, s36, 4096
  buffer_load_dwordx4 v[112:115], v4, s[16:19], s40 offen offset:2048 sc1
  v_mfma_f32_16x16x32_bf16 v[80:83], v[60:63], v[92:95], v[80:83]
  ds_read_b128 v[40:43], v26 offset:13312
  v_mfma_f32_16x16x32_bf16 v[84:87], v[64:67], v[92:95], v[84:87]
  ds_read_b128 v[44:47], v26 offset:14336
  s_waitcnt vmcnt(4) lgkmcnt(0)
  v_mfma_f32_16x16x32_bf16 v[68:71], v[28:31], v[96:99], v[68:71]
  ds_read_b128 v[48:51], v26 offset:15360
  v_mfma_f32_16x16x32_bf16 v[72:75], v[32:35], v[96:99], v[72:75]
  ds_read_b128 v[52:55], v26 offset:16384
  v_mfma_f32_16x16x32_bf16 v[76:79], v[36:39], v[96:99], v[76:79]
  ds_read_b128 v[56:59], v26 offset:17408
  s_add_u32 s40, s36, 4096
  buffer_load_dwordx4 v[116:119], v4, s[16:19], s40 offen offset:3072 sc1
  v_mfma_f32_16x16x32_bf16 v[80:83], v[40:43], v[96:99], v[80:83]
  ds_read_b128 v[60:63], v26 offset:18432
  v_mfma_f32_16x16x32_bf16 v[84:87], v[44:47], v[96:99], v[84:87]
  ds_read_b128 v[64:67], v26 offset:19456
  s_waitcnt vmcnt(4) lgkmcnt(0)
  s_barrier
  v_mfma_f32_16x16x32_bf16 v[68:71], v[48:51], v[100:103], v[68:71]
  ds_read_b128 v[28:31], v26 offset:20480
  v_mfma_f32_16x16x32_bf16 v[72:75], v[52:55], v[100:103], v[72:75]
  ds_read_b128 v[32:35], v26 offset:21504
  v_mfma_f32_16x16x32_bf16 v[76:79], v[56:59], v[100:103], v[76:79]
  ds_read_b128 v[36:39], v26 offset:22528
  s_add_u32 s40, s36, 8192
  buffer_load_dwordx4 v[120:123], v4, s[16:19], s40 offen offset:0 sc1
  v_mfma_f32_16x16x32_bf16 v[80:83], v[60:63], v[100:103], v[80:83]
  ds_read_b128 v[40:43], v26 offset:23552
  v_mfma_f32_16x16x32_bf16 v[84:87], v[64:67], v[100:103], v[84:87]
  ds_read_b128 v[44:47], v26 offset:24576
  s_waitcnt vmcnt(4) lgkmcnt(0)
  v_mfma_f32_16x16x32_bf16 v[68:71], v[28:31], v[104:107], v[68:71]
  ds_read_b128 v[48:51], v26 offset:25600
  v_mfma_f32_16x16x32_bf16 v[72:75], v[32:35], v[104:107], v[72:75]
  ds_read_b128 v[52:55], v26 offset:26624
  v_mfma_f32_16x16x32_bf16 v[76:79], v[36:39], v[104:107], v[76:79]
  ds_read_b128 v[56:59], v26 offset:27648
  s_add_u32 s40, s36, 8192
  buffer_load_dwordx4 v[124:127], v4, s[16:19], s40 offen offset:1024 sc1
  v_mfma_f32_16x16x32_bf16 v[80:83], v[40:43], v[104:107], v[80:83]
  ds_read_b128 v[60:63], v26 offset:28672
  v_mfma_f32_16x16x32_bf16 v[84:87], v[44:47], v[104:107], v[84:87]
  ds_read_b128 v[64:67], v26 offset:29696
  s_add_u32 m0, s37, 133120
  s_nop 0
  buffer_load_dwordx4 v8, s[16:19], s38 offen sc1 lds
  s_waitcnt vmcnt(5) lgkmcnt(0)
  v_mfma_f32_16x16x32_bf16 v[68:71], v[48:51], v[108:111], v[68:71]
  ds_read_b128 v[28:31], v26 offset:30720
  v_mfma_f32_16x16x32_bf16 v[72:75], v[52:55], v[108:111], v[72:75]
  ds_read_b128 v[32:35], v26 offset:31744
  v_mfma_f32_16x16x32_bf16 v[76:79], v[56:59], v[108:111], v[76:79]
  ds_read_b128 v[36:39], v26 offset:32768
  s_add_u32 s40, s36, 8192
  buffer_load_dwordx4 v[128:131], v4, s[16:19], s40 offen offset:2048 sc1
  v_mfma_f32_16x16x32_bf16 v[80:83], v[60:63], v[108:111], v[80:83]
  ds_read_b128 v[40:43], v26 offset:33792
  v_mfma_f32_16x16x32_bf16 v[84:87], v[64:67], v[108:111], v[84:87]
  ds_read_b128 v[44:47], v26 offset:34816
  s_add_u32 m0, s37, 134144
  s_nop 0
  buffer_load_dwordx4 v9, s[16:19], s38 offen sc1 lds
  s_waitcnt vmcnt(6) lgkmcnt(0)
  v_mfma_f32_16x16x32_bf16 v[68:71], v[28:31], v[112:115], v[68:71]
  ds_read_b128 v[48:51], v26 offset:35840
  v_mfma_f32_16x16x32_bf16 v[72:75], v[32:35], v[112:115], v[72:75]
  ds_read_b128 v[52:55], v26 offset:36864
  v_mfma_f32_16x16x32_bf16 v[76:79], v[36:39], v[112:115], v[76:79]
  ds_read_b128 v[56:59], v26 offset:37888
  s_add_u32 s40, s36, 8192
  buffer_load_dwordx4 v[132:135], v4, s[16:19], s40 offen offset:3072 sc1
  v_mfma_f32_16x16x32_bf16 v[80:83], v[40:43], v[112:115], v[80:83]
  ds_read_b128 v[60:63], v26 offset:38912
  v_mfma_f32_16x16x32_bf16 v[84:87], v[44:47], v[112:115], v[84:87]
  ds_read_b128 v[64:67], v26 offset:39936
  s_mov_b32 exec_hi, 0
  s_add_u32 m0, s37, 135168
  s_nop 0
  buffer_load_dwordx4 v10, s[16:19], s38 offen sc1 lds
  s_mov_b32 exec_hi, -1
  s_waitcnt vmcnt(7) lgkmcnt(0)
  s_barrier
  v_mfma_f32_16x16x32_bf16 v[68:71], v[48:51], v[116:119], v[68:71]
  ds_read_b128 v[28:31], v26 offset:40960
  v_mfma_f32_16x16x32_bf16 v[72:75], v[52:55], v[116:119], v[72:75]
  ds_read_b128 v[32:35], v26 offset:41984
  v_mfma_f32_16x16x32_bf16 v[76:79], v[56:59], v[116:119], v[76:79]
  ds_read_b128 v[36:39], v26 offset:43008
  v_mfma_f32_16x16x32_bf16 v[80:83], v[60:63], v[116:119], v[80:83]
  ds_read_b128 v[40:43], v26 offset:44032
  v_mfma_f32_16x16x32_bf16 v[84:87], v[64:67], v[116:119], v[84:87]
  ds_read_b128 v[44:47], v26 offset:45056
  s_waitcnt vmcnt(6) lgkmcnt(0)
  v_mfma_f32_16x16x32_bf16 v[68:71], v[28:31], v[120:123], v[68:71]
  ds_read_b128 v[48:51], v26 offset:46080
  v_mfma_f32_16x16x32_bf16 v[72:75], v[32:35], v[120:123], v[72:75]
  ds_read_b128 v[52:55], v26 offset:47104
  v_mfma_f32_16x16x32_bf16 v[76:79], v[36:39], v[120:123], v[76:79]
  ds_read_b128 v[56:59], v26 offset:48128
  v_mfma_f32_16x16x32_bf16 v[80:83], v[40:43], v[120:123], v[80:83]
  ds_read_b128 v[60:63], v26 offset:49152
  v_mfma_f32_16x16x32_bf16 v[84:87], v[44:47], v[120:123], v[84:87]
  ds_read_b128 v[64:67], v26 offset:50176
  s_waitcnt vmcnt(5) lgkmcnt(0)
  v_mfma_f32_16x16x32_bf16 v[68:71], v[48:51], v[124:127], v[68:71]
  ds_read_b128 v[28:31], v26 offset:51200
  v_mfma_f32_16x16x32_bf16 v[72:75], v[52:55], v[124:127], v[72:75]
  ds_read_b128 v[32:35], v26 offset:52224
  v_mfma_f32_16x16x32_bf16 v[76:79], v[56:59], v[124:127], v[76:79]
  ds_read_b128 v[36:39], v26 offset:53248
  v_mfma_f32_16x16x32_bf16 v[80:83], v[60:63], v[124:127], v[80:83]
  ds_read_b128 v[40:43], v26 offset:54272
  v_mfma_f32_16x16x32_bf16 v[84:87], v[64:67], v[124:127], v[84:87]
  ds_read_b128 v[44:47], v26 offset:55296
  s_waitcnt vmcnt(3) lgkmcnt(0)
  v_mfma_f32_16x16x32_bf16 v[68:71], v[28:31], v[128:131], v[68:71]
  ds_read_b128 v[48:51], v26 offset:56320
  v_mfma_f32_16x16x32_bf16 v[72:75], v[32:35], v[128:131], v[72:75]
  ds_read_b128 v[52:55], v26 offset:57344
  v_mfma_f32_16x16x32_bf16 v[76:79], v[36:39], v[128:131], v[76:79]
  ds_read_b128 v[56:59], v26 offset:58368
  v_mfma_f32_16x16x32_bf16 v[80:83], v[40:43], v[128:131], v[80:83]
  ds_read_b128 v[60:63], v26 offset:59392
  v_mfma_f32_16x16x32_bf16 v[84:87], v[44:47], v[128:131], v[84:87]
  ds_read_b128 v[64:67], v26 offset:60416
  s_waitcnt vmcnt(1) lgkmcnt(0)
  v_mfma_f32_16x16x32_bf16 v[68:71], v[48:51], v[132:135], v[68:71]
  v_mfma_f32_16x16x32_bf16 v[72:75], v[52:55], v[132:135], v[72:75]
  v_mfma_f32_16x16x32_bf16 v[76:79], v[56:59], v[132:135], v[76:79]
  v_mfma_f32_16x16x32_bf16 v[80:83], v[60:63], v[132:135], v[80:83]
  v_mfma_f32_16x16x32_bf16 v[84:87], v[64:67], v[132:135], v[84:87]
  s_waitcnt vmcnt(0) lgkmcnt(0)
  s_barrier
  s_mul_i32 s40, s55, 5120
  v_add_u32 v12, s40, v4
  ds_write_b128 v12, v[68:71] offset:0
  ds_write_b128 v12, v[72:75] offset:1024
  ds_write_b128 v12, v[76:79] offset:2048
  v_mul_u32_u24 v13, 160, v3
  v_lshlrev_b32 v14, 3, v2
  v_add_u32 v13, v13, v14
  s_add_u32 s40, s37, 122880
  v_add_u32 v13, s40, v13
  v_lshlrev_b32 v14, 7, v2
  v_lshlrev_b32 v15, 3, v3
  v_add_u32 v14, v14, v15
  s_add_u32 s40, s37, 133120
  v_add_u32 v14, s40, v14
  ds_read_b64 v[94:95], v13 offset:96
  ds_read_b64_tr_b16 v[104:105], v14 offset:1536
  ds_read_b64 v[96:97], v13 offset:128
  ds_read_b64_tr_b16 v[106:107], v14 offset:2048
  v_sub_f32 v16, 0, v24
  v_mov_b32 v18, v25
  s_mov_b32 s48, 1.0
  s_mov_b32 s49, 1.0
  v_mov_b32 v20, 0xbfb8aa3b
  v_mov_b32 v21, 0xbfb8aa3b
  s_waitcnt lgkmcnt(0)
  s_barrier
  ds_read_b128 v[120:123], v12 offset:3072
  ds_read_b128 v[124:127], v12 offset:4096
  s_waitcnt lgkmcnt(0)
  v_pk_add_f32 v[80:81], v[80:81], v[120:121]
  v_lshlrev_b32 v28, 16, v94
  v_and_b32 v29, s47, v94
  v_pk_mul_f32 v[32:33], v[80:81], v[20:21]
  v_lshlrev_b32 v30, 16, v104
  v_and_b32 v31, s47, v104
  v_exp_f32 v32, v32
  v_exp_f32 v33, v33
  v_pk_add_f32 v[34:35], v[28:29], v[16:17] op_sel_hi:[1,0]
  v_pk_add_f32 v[32:33], v[32:33], s[48:49]
  v_pk_mul_f32 v[34:35], v[34:35], v[18:19] op_sel_hi:[1,0]
  v_rcp_f32 v32, v32
  v_rcp_f32 v33, v33
  v_pk_mul_f32 v[34:35], v[34:35], v[30:31]
  v_pk_mul_f32 v[32:33], v[32:33], v[80:81]
  v_pk_fma_f32 v[34:35], v[34:35], v[32:33], v[28:29]
  v_cvt_pk_bf16_f32 v94, v34, v35
  v_pk_add_f32 v[82:83], v[82:83], v[122:123]
  v_lshlrev_b32 v36, 16, v95
  v_and_b32 v37, s47, v95
  v_pk_mul_f32 v[40:41], v[82:83], v[20:21]
  v_lshlrev_b32 v38, 16, v105
  v_and_b32 v39, s47, v105
  v_exp_f32 v40, v40
  v_exp_f32 v41, v41
  v_pk_add_f32 v[42:43], v[36:37], v[16:17] op_sel_hi:[1,0]
  v_pk_add_f32 v[40:41], v[40:41], s[48:49]
  v_pk_mul_f32 v[42:43], v[42:43], v[18:19] op_sel_hi:[1,0]
  v_rcp_f32 v40, v40
  v_rcp_f32 v41, v41
  v_pk_mul_f32 v[42:43], v[42:43], v[38:39]
  v_pk_mul_f32 v[40:41], v[40:41], v[82:83]
  v_pk_fma_f32 v[42:43], v[42:43], v[40:41], v[36:37]
  v_cvt_pk_bf16_f32 v95, v42, v43
  ds_write_b64 v13, v[94:95] offset:96
  v_pk_add_f32 v[84:85], v[84:85], v[124:125]
  v_lshlrev_b32 v28, 16, v96
  v_and_b32 v29, s47, v96
  v_pk_mul_f32 v[32:33], v[84:85], v[20:21]
  v_lshlrev_b32 v30, 16, v106
  v_and_b32 v31, s47, v106
  v_exp_f32 v32, v32
  v_exp_f32 v33, v33
  v_pk_add_f32 v[34:35], v[28:29], v[16:17] op_sel_hi:[1,0]
  v_pk_add_f32 v[32:33], v[32:33], s[48:49]
  v_pk_mul_f32 v[34:35], v[34:35], v[18:19] op_sel_hi:[1,0]
  v_rcp_f32 v32, v32
  v_rcp_f32 v33, v33
  v_pk_mul_f32 v[34:35], v[34:35], v[30:31]
  v_pk_mul_f32 v[32:33], v[32:33], v[84:85]
  v_pk_fma_f32 v[34:35], v[34:35], v[32:33], v[28:29]
  v_cvt_pk_bf16_f32 v96, v34, v35
  v_pk_add_f32 v[86:87], v[86:87], v[126:127]
  v_lshlrev_b32 v36, 16, v97
  v_and_b32 v37, s47, v97
  v_pk_mul_f32 v[40:41], v[86:87], v[20:21]
  v_lshlrev_b32 v38, 16, v107
  v_and_b32 v39, s47, v107
  v_exp_f32 v40, v40
  v_exp_f32 v41, v41
  v_pk_add_f32 v[42:43], v[36:37], v[16:17] op_sel_hi:[1,0]
  v_pk_add_f32 v[40:41], v[40:41], s[48:49]
  v_pk_mul_f32 v[42:43], v[42:43], v[18:19] op_sel_hi:[1,0]
  v_rcp_f32 v40, v40
  v_rcp_f32 v41, v41
  v_pk_mul_f32 v[42:43], v[42:43], v[38:39]
  v_pk_mul_f32 v[40:41], v[40:41], v[86:87]
  v_pk_fma_f32 v[42:43], v[42:43], v[40:41], v[36:37]
  v_cvt_pk_bf16_f32 v97, v42, v43
  ds_write_b64 v13, v[96:97] offset:128
  s_waitcnt lgkmcnt(0)
  s_barrier
  s_add_u32 s40, s37, 122880
  v_add_u32 v13, s40, v4
  ds_read_b128 v[108:111], v13 offset:2048
  s_waitcnt lgkmcnt(0)
  s_mov_b32 exec_lo, 0xffffffff
  s_mov_b32 exec_hi, 0x0
  buffer_store_dwordx4 v[108:111], v7, s[12:15], 0 offen
  s_mov_b64 exec, s[52:53]
  s_endpgm
F2_IDLE:
  s_waitcnt vmcnt(0)
  s_barrier
  s_sleep 3
  s_sub_u32 s42, s34, 4
  v_lshrrev_b32 v8, 3, v1
  s_lshl_b32 s40, s42, 3
  v_add_u32 v8, s40, v8
  v_and_b32 v9, 7, v1
  v_lshlrev_b32 v9, 4, v9
  v_mul_u32_u24 v10, 144, v8
  v_add_u32 v10, v10, v9
  v_add_u32 v10, 49152, v10
  v_lshlrev_b32 v8, 12, v8
  v_add_u32 v8, v8, v9
  ds_read_b128 v[16:19], v10 offset:0
  ds_read_b128 v[20:23], v10 offset:3456
  ds_read_b128 v[24:27], v10 offset:6912
  ds_read_b128 v[28:31], v10 offset:10368
  s_mul_i32 s40, s33, 327680
  s_lshl_b32 s41, s32, 7
  s_add_u32 s40, s40, s41
  s_add_u32 s40, s40, 6291456
  s_waitcnt lgkmcnt(0)
  buffer_store_dwordx4 v[16:19], v8, s[16:19], s40 offen sc1
  s_add_u32 s40, s40, 98304
  buffer_store_dwordx4 v[20:23], v8, s[16:19], s40 offen sc1
  s_add_u32 s40, s40, 98304
  buffer_store_dwordx4 v[24:27], v8, s[16:19], s40 offen sc1
  s_add_u32 s40, s40, 98304
  s_cmp_eq_u32 s42, 0
  s_cselect_b32 s40, s40, 0x80000000
  buffer_store_dwordx4 v[28:31], v8, s[16:19], s40 offen sc1
  s_add_u32 s40, s40, 98304
  s_barrier
  s_waitcnt vmcnt(0)
  s_barrier
  s_barrier
  s_barrier
  s_barrier
  s_barrier
  s_barrier
  s_barrier
  s_barrier
  s_barrier
  s_barrier
  s_barrier
  s_barrier
  s_barrier
  s_barrier
  s_barrier
  s_barrier
  s_barrier
  s_barrier
  s_barrier
  s_branch F3_IDLE
F2_SYNC:
  s_load_dwordx2 s[72:73], s[0:1], 104
  s_waitcnt lgkmcnt(0)
  s_load_dwordx2 s[70:71], s[0:1], 64
  s_lshl_b32 s40, s32, 6
  s_lshl_b32 s41, s33, 3
  s_add_u32 s40, s40, s41
  v_lshrrev_b32 v20, 3, v1
  v_add_u32 v20, s40, v20
  v_lshlrev_b32 v20, 12, v20
  v_and_b32 v21, 7, v1
  v_lshlrev_b32 v21, 6, v21
  v_add_u32 v20, v20, v21
  v_lshrrev_b32 v22, 2, v1
  v_add_u32 v22, s40, v22
  v_lshlrev_b32 v22, 12, v22
  v_and_b32 v21, 3, v1
  v_lshlrev_b32 v21, 6, v21
  v_add_u32 v22, v22, v21
  s_waitcnt lgkmcnt(0)
  s_mov_b32 s8, s70
  s_and_b32 s9, s71, 0xffff
  s_mov_b32 s10, 8388608
  s_mov_b32 s11, 0x20000
  s_lshl_b32 s40, s33, 7
  s_lshl_b32 s41, s32, 2
  s_add_u32 s40, s40, s41
  s_add_u32 s41, s40, 17040384
  s_add_u32 s40, s40, 17039360
  v_mov_b32 v152, s40
  v_mov_b32 v153, s41
  v_cmp_eq_u32 vcc, 1, v1
  s_nop 1
  v_cndmask_b32 v152, v152, v153, vcc
  s_lshl_b32 s40, s32, 5
  s_lshl_b32 s41, s33, 2
  s_add_u32 s40, s40, s41
  s_add_u32 s40, s40, 17041408
  v_mov_b32 v153, s40
  v_cmp_eq_u32 vcc, 2, v1
  s_nop 1
  v_cndmask_b32 v152, v152, v153, vcc
  s_lshl_b32 s40, s33, 7
  s_lshl_b32 s41, s32, 2
  s_add_u32 s40, s40, s41
  s_add_u32 s40, s40, 17042432
  v_mov_b32 v153, s40
  v_cmp_eq_u32 vcc, 3, v1
  s_nop 1
  v_cndmask_b32 v152, v152, v153, vcc
  v_mov_b32 v154, 1
  s_waitcnt vmcnt(0)
  s_barrier
  s_mov_b32 exec_lo, 0x1
  s_mov_b32 exec_hi, 0x0
  buffer_store_dword v154, v152, s[16:19], 0 offen sc1
  s_mov_b64 exec, s[52:53]
  s_lshl_b32 s40, s33, 7
  s_add_u32 s75, s40, 17039360
  s_add_u32 s40, s40, 17039360
  v_lshlrev_b32 v150, 2, v1
  v_add_u32 v150, s40, v150
  s_add_u32 s74, s75, 0
  s_mov_b32 s42, 0
SP_F1a:
  s_load_dwordx8 s[56:63], s[72:73], s74 glc
  s_waitcnt lgkmcnt(0)
  s_and_b64 s[56:57], s[56:57], s[60:61]
  s_and_b64 s[58:59], s[58:59], s[62:63]
  s_and_b64 s[56:57], s[56:57], s[58:59]
  s_and_b32 s56, s56, s57
  s_add_u32 s42, s42, 1
  s_cmp_eq_u32 s56, 1
  s_cbranch_scc1 SP_F1a_OK
  s_cmp_lt_u32 s42, 2097152
  s_cbranch_scc1 SP_F1a
SP_F1a_OK:
  s_barrier
  s_barrier
  s_mov_b32 exec_lo, 0x8
  s_mov_b32 exec_hi, 0x0
  buffer_store_dword v154, v152, s[16:19], 0 offen sc1
  s_mov_b64 exec, s[52:53]
  s_add_u32 s74, s75, 32
  s_mov_b32 s42, 0
SP_F1b:
  s_load_dwordx8 s[56:63], s[72:73], s74 glc
  s_waitcnt lgkmcnt(0)
  s_and_b64 s[56:57], s[56:57], s[60:61]
  s_and_b64 s[58:59], s[58:59], s[62:63]
  s_and_b64 s[56:57], s[56:57], s[58:59]
  s_and_b32 s56, s56, s57
  s_add_u32 s42, s42, 1
  s_cmp_eq_u32 s56, 1
  s_cbranch_scc1 SP_F1b_OK
  s_cmp_lt_u32 s42, 2097152
  s_cbranch_scc1 SP_F1b
SP_F1b_OK:
  s_barrier
  s_barrier
  s_add_u32 s74, s75, 64
  s_mov_b32 s42, 0
SP_F1c:
  s_load_dwordx16 s[56:71], s[72:73], s74 glc
  s_waitcnt lgkmcnt(0)
  s_and_b64 s[56:57], s[56:57], s[64:65]
  s_and_b64 s[58:59], s[58:59], s[66:67]
  s_and_b64 s[60:61], s[60:61], s[68:69]
  s_and_b64 s[62:63], s[62:63], s[70:71]
  s_and_b64 s[56:57], s[56:57], s[60:61]
  s_and_b64 s[58:59], s[58:59], s[62:63]
  s_and_b64 s[56:57], s[56:57], s[58:59]
  s_and_b32 s56, s56, s57
  s_add_u32 s42, s42, 1
  s_cmp_eq_u32 s56, 1
  s_cbranch_scc1 SP_F1c_OK
  s_cmp_lt_u32 s42, 2097152
  s_cbranch_scc1 SP_F1c
SP_F1c_OK:
  s_barrier
  s_add_u32 s75, s75, 3072
  s_add_u32 s74, s75, 0
  s_mov_b32 s42, 0
SP_FKa:
  s_load_dwordx16 s[56:71], s[72:73], s74 glc
  s_waitcnt lgkmcnt(0)
  s_and_b64 s[56:57], s[56:57], s[64:65]
  s_and_b64 s[58:59], s[58:59], s[66:67]
  s_and_b64 s[60:61], s[60:61], s[68:69]
  s_and_b64 s[62:63], s[62:63], s[70:71]
  s_and_b64 s[56:57], s[56:57], s[60:61]
  s_and_b64 s[58:59], s[58:59], s[62:63]
  s_and_b64 s[56:57], s[56:57], s[58:59]
  s_and_b32 s56, s56, s57
  s_add_u32 s42, s42, 1
  s_cmp_eq_u32 s56, 1
  s_cbranch_scc1 SP_FKa_OK
  s_cmp_lt_u32 s42, 2097152
  s_cbranch_scc1 SP_FKa
SP_FKa_OK:
  s_add_u32 s74, s75, 64
  s_mov_b32 s42, 0
SP_FKb:
  s_load_dwordx16 s[56:71], s[72:73], s74 glc
  s_waitcnt lgkmcnt(0)
  s_and_b64 s[56:57], s[56:57], s[64:65]
  s_and_b64 s[58:59], s[58:59], s[66:67]
  s_and_b64 s[60:61], s[60:61], s[68:69]
  s_and_b64 s[62:63], s[62:63], s[70:71]
  s_and_b64 s[56:57], s[56:57], s[60:61]
  s_and_b64 s[58:59], s[58:59], s[62:63]
  s_and_b64 s[56:57], s[56:57], s[58:59]
  s_and_b32 s56, s56, s57
  s_add_u32 s42, s42, 1
  s_cmp_eq_u32 s56, 1
  s_cbranch_scc1 SP_FKb_OK
  s_cmp_lt_u32 s42, 2097152
  s_cbranch_scc1 SP_FKb
SP_FKb_OK:
  s_barrier
  s_barrier
  s_barrier
  s_barrier
  s_barrier
  s_barrier
  s_barrier
  s_barrier
  s_barrier
  s_barrier
  s_barrier
  s_barrier
  s_barrier
  s_load_dwordx2 s[56:57], s[0:1], 0
  s_load_dwordx2 s[58:59], s[0:1], 88
  v_lshlrev_b32 v4, 4, v1
  s_lshl_b32 s35, s32, 2
  s_add_u32 s35, s35, s55
  s_lshr_b32 s39, s34, 2
  s_mul_i32 s36, s35, 24576
  s_mul_i32 s40, s39, 12288
  s_add_u32 s36, s36, s40
  s_add_u32 s36, s36, 12582912
  s_mul_i32 s40, s39, 61440
  v_add_u32 v26, s40, v4
  s_lshl_b32 s40, s35, 4
  s_mul_i32 s40, s40, 1280
  s_mul_i32 s41, s33, 160
  s_add_u32 s40, s40, s41
  v_add_u32 v12, 0, v1
  v_mul_u32_u24 v13, 6554, v12
  v_lshrrev_b32 v13, 16, v13
  v_mul_u32_u24 v14, 10, v13
  v_sub_u32 v14, v12, v14
  v_lshlrev_b32 v14, 4, v14
  v_mul_u32_u24 v13, 1280, v13
  v_add_u32 v13, v13, v14
  v_add_u32 v5, s40, v13
  v_lshrrev_b32 v13, 1, v12
  v_lshlrev_b32 v13, 12, v13
  v_and_b32 v14, 1, v12
  v_lshlrev_b32 v14, 4, v14
  v_add_u32 v8, v13, v14
  v_add_u32 v12, 64, v1
  v_mul_u32_u24 v13, 6554, v12
  v_lshrrev_b32 v13, 16, v13
  v_mul_u32_u24 v14, 10, v13
  v_sub_u32 v14, v12, v14
  v_lshlrev_b32 v14, 4, v14
  v_mul_u32_u24 v13, 1280, v13
  v_add_u32 v13, v13, v14
  v_add_u32 v6, s40, v13
  v_lshrrev_b32 v13, 1, v12
  v_lshlrev_b32 v13, 12, v13
  v_and_b32 v14, 1, v12
  v_lshlrev_b32 v14, 4, v14
  v_add_u32 v9, v13, v14
  v_add_u32 v12, 128, v1
  v_mul_u32_u24 v13, 6554, v12
  v_lshrrev_b32 v13, 16, v13
  v_mul_u32_u24 v14, 10, v13
  v_sub_u32 v14, v12, v14
  v_lshlrev_b32 v14, 4, v14
  v_mul_u32_u24 v13, 1280, v13
  v_add_u32 v13, v13, v14
  v_add_u32 v7, s40, v13
  v_lshrrev_b32 v13, 1, v12
  v_lshlrev_b32 v13, 12, v13
  v_and_b32 v14, 1, v12
  v_lshlrev_b32 v14, 4, v14
  v_add_u32 v10, v13, v14
  s_mul_i32 s37, s55, 2560
  s_mul_i32 s38, s33, 327680
  s_lshl_b32 s41, s35, 5
  s_add_u32 s38, s38, s41
  s_add_u32 s38, s38, 9437184
  s_lshl_b32 s40, s55, 6
  s_add_u32 s40, s40, 143360
  v_lshlrev_b32 v21, 2, v3
  v_add_u32 v21, s40, v21
  ds_read_b32 v24, v21
  ds_read_b32 v25, v21 offset:256
  v_mov_b32 v68, 0
  v_mov_b32 v69, 0
  v_mov_b32 v70, 0
  v_mov_b32 v71, 0
  v_mov_b32 v72, 0
  v_mov_b32 v73, 0
  v_mov_b32 v74, 0
  v_mov_b32 v75, 0
  v_mov_b32 v76, 0
  v_mov_b32 v77, 0
  v_mov_b32 v78, 0
  v_mov_b32 v79, 0
  v_mov_b32 v80, 0
  v_mov_b32 v81, 0
  v_mov_b32 v82, 0
  v_mov_b32 v83, 0
  v_mov_b32 v84, 0
  v_mov_b32 v85, 0
  v_mov_b32 v86, 0
  v_mov_b32 v87, 0
  s_waitcnt lgkmcnt(0)
  s_mov_b32 s8, s56
  s_and_b32 s9, s57, 0xffff
  s_mov_b32 s10, 2621440
  s_mov_b32 s11, 0x20000
  s_mov_b32 s12, s58
  s_and_b32 s13, s59, 0xffff
  s_mov_b32 s14, 2621440
  s_mov_b32 s15, 0x20000
  s_barrier
  s_barrier
  s_mov_b32 exec_lo, 0x6
  s_mov_b32 exec_hi, 0x0
  buffer_store_dword v154, v152, s[16:19], 0 offen sc1
  s_mov_b64 exec, s[52:53]
  s_lshl_b32 s40, s32, 5
  s_add_u32 s75, s40, 17041408
  s_add_u32 s74, s75, 0
  s_mov_b32 s42, 0
SP_F2B:
  s_load_dwordx8 s[56:63], s[72:73], s74 glc
  s_waitcnt lgkmcnt(0)
  s_and_b64 s[56:57], s[56:57], s[60:61]
  s_and_b64 s[58:59], s[58:59], s[62:63]
  s_and_b64 s[56:57], s[56:57], s[58:59]
  s_and_b32 s56, s56, s57
  s_add_u32 s42, s42, 1
  s_cmp_eq_u32 s56, 1
  s_cbranch_scc1 SP_F2B_OK
  s_cmp_lt_u32 s42, 2097152
  s_cbranch_scc1 SP_F2B
SP_F2B_OK:
  s_barrier
  s_branch F3_BMAIN
K1_END:
  s_endpgm
KF_CODE_END:

.section .rodata,"a"
.p2align 6
.amdhsa_kernel recurrent_scan__ssm_conv_h3__mixer_gmlp__prompt_kernel
  .amdhsa_next_free_vgpr 168
  .amdhsa_next_free_sgpr 96
  .amdhsa_accum_offset 168
  .amdhsa_group_segment_fixed_size 0
  .amdhsa_kernarg_size 112
  .amdhsa_user_sgpr_count 2
  .amdhsa_user_sgpr_kernarg_segment_ptr 1
  .amdhsa_system_sgpr_workgroup_id_x 1
  .amdhsa_float_denorm_mode_32 3
.end_amdhsa_kernel
.text
```

```asm
; @launch grid=(256,1,1) block=(768,1,1) lds=159744
.amdgcn_target "amdgcn-amd-amdhsa--gfx950"
.text
.globl recurrent_scan__ssm_conv_h3__mixer_gmlp__prompt_kernel
.p2align 8
.type recurrent_scan__ssm_conv_h3__mixer_gmlp__prompt_kernel,@function
recurrent_scan__ssm_conv_h3__mixer_gmlp__prompt_kernel:
  s_cmp_ge_u32 s2, 256
  s_cbranch_scc1 K1_END
  s_load_dwordx4 s[56:59], s[0:1], 0
  s_load_dwordx4 s[60:63], s[0:1], 16
  s_load_dwordx2 s[64:65], s[0:1], 56
  s_load_dwordx2 s[66:67], s[0:1], 80
  s_load_dwordx4 s[68:71], s[0:1], 96
  s_load_dwordx2 s[74:75], s[0:1], 64
  s_load_dwordx2 s[76:77], s[0:1], 32
  v_and_b32 v1, 63, v0
  v_lshrrev_b32 v14, 6, v0
  v_lshrrev_b32 v2, 4, v1
  v_readfirstlane_b32 s34, v14
  v_and_b32 v3, 15, v1
  s_and_b32 s40, s2, 7
  s_lshr_b32 s41, s2, 3
  s_lshr_b32 s32, s40, 1
  s_lshl_b32 s32, s32, 3
  s_lshr_b32 s42, s41, 2
  s_add_u32 s32, s32, s42
  s_and_b32 s33, s40, 1
  s_lshl_b32 s33, s33, 2
  s_and_b32 s42, s41, 3
  s_add_u32 s33, s33, s42
  s_and_b32 s55, s34, 3
  s_lshr_b32 s35, s55, 1
  s_and_b32 s36, s55, 1
  s_mov_b32 s47, 0xffff0000
  s_mov_b64 s[52:53], exec
  s_mul_i32 s44, s33, 192
  s_add_u32 s43, s44, 1536
  s_cmp_ge_u32 s34, 8
  s_cbranch_scc0 K1_AB
  s_lshl_b32 s40, s32, 6
  s_lshl_b32 s41, s55, 3
  s_add_u32 s40, s40, s41
  s_lshl_b32 s45, s55, 10
  v_lshrrev_b32 v30, 3, v1
  v_add_u32 v32, s41, v30
  v_lshrrev_b32 v31, 1, v32
  v_xor_b32 v31, v31, v1
  v_and_b32 v31, 7, v31
  v_lshlrev_b32 v31, 4, v31
  v_add_u32 v30, s40, v30
  v_mul_u32_u24 v30, 1280, v30
  v_add_u32 v8, v30, v31
  v_add_u32 v9, 40960, v8
  s_waitcnt lgkmcnt(0)
  s_mov_b32 s8, s56
  s_and_b32 s9, s57, 0xffff
  s_mov_b32 s10, 2621440
  s_mov_b32 s11, 0x20000
  s_mov_b32 s12, s64
  s_and_b32 s13, s65, 0xffff
  s_mov_b32 s14, 1966080
  s_mov_b32 s15, 0x20000
  s_and_b32 s40, s32, 7
  s_and_b32 s41, s33, 3
  s_mul_i32 s41, s41, 3
  s_add_u32 s37, s40, s41
  s_sub_u32 s40, s37, 10
  s_cmp_ge_u32 s37, 10
  s_cselect_b32 s37, s40, s37
  s_lshl_b32 s40, s55, 6
  s_add_u32 s40, s40, 0
  v_add_u32 v30, s40, v1
  v_mul_u32_u24 v31, 5462, v30
  v_lshrrev_b32 v31, 16, v31
  v_mul_u32_u24 v32, 12, v31
  v_sub_u32 v32, v30, v32
  v_lshrrev_b32 v33, 2, v31
  v_and_b32 v33, 2, v33
  v_xor_b32 v32, v32, v33
  v_lshlrev_b32 v32, 4, v32
  v_mul_u32_u24 v31, 3072, v31
  v_add_u32 v12, v31, v32
  s_lshl_b32 s40, s55, 6
  s_add_u32 s40, s40, 256
  v_add_u32 v30, s40, v1
  v_mul_u32_u24 v31, 5462, v30
  v_lshrrev_b32 v31, 16, v31
  v_mul_u32_u24 v32, 12, v31
  v_sub_u32 v32, v30, v32
  v_lshrrev_b32 v33, 2, v31
  v_and_b32 v33, 2, v33
  v_xor_b32 v32, v32, v33
  v_lshlrev_b32 v32, 4, v32
  v_mul_u32_u24 v31, 3072, v31
  v_add_u32 v13, v31, v32
  s_lshl_b32 s40, s55, 6
  s_add_u32 s40, s40, 512
  v_add_u32 v30, s40, v1
  v_mul_u32_u24 v31, 5462, v30
  v_lshrrev_b32 v31, 16, v31
  v_mul_u32_u24 v32, 12, v31
  v_sub_u32 v32, v30, v32
  v_lshrrev_b32 v33, 2, v31
  v_and_b32 v33, 2, v33
  v_xor_b32 v32, v32, v33
  v_lshlrev_b32 v32, 4, v32
  v_mul_u32_u24 v31, 3072, v31
  v_add_u32 v14, v31, v32
  s_add_u32 s38, s37, 0
  s_sub_u32 s40, s38, 10
  s_cmp_ge_u32 s38, 10
  s_cselect_b32 s38, s40, s38
  s_lshl_b32 s38, s38, 7
  s_add_u32 m0, s45, 61440
  s_nop 0
  buffer_load_dwordx4 v8, s[8:11], s38 offen  lds
  s_add_u32 m0, s45, 65536
  s_nop 0
  buffer_load_dwordx4 v9, s[8:11], s38 offen  lds
  s_add_u32 s39, s37, 0
  s_sub_u32 s40, s39, 10
  s_cmp_ge_u32 s39, 10
  s_cselect_b32 s39, s40, s39
  s_mul_i32 s39, s39, 196608
  s_add_u32 s39, s39, s43
  s_add_u32 m0, s45, 0
  s_nop 0
  buffer_load_dwordx4 v12, s[12:15], s39 offen  lds
  s_add_u32 m0, s45, 4096
  s_nop 0
  buffer_load_dwordx4 v13, s[12:15], s39 offen  lds
  s_add_u32 m0, s45, 8192
  s_nop 0
  buffer_load_dwordx4 v14, s[12:15], s39 offen  lds
  s_add_u32 s38, s37, 1
  s_sub_u32 s40, s38, 10
  s_cmp_ge_u32 s38, 10
  s_cselect_b32 s38, s40, s38
  s_lshl_b32 s38, s38, 7
  s_add_u32 m0, s45, 69632
  s_nop 0
  buffer_load_dwordx4 v8, s[8:11], s38 offen  lds
  s_add_u32 m0, s45, 73728
  s_nop 0
  buffer_load_dwordx4 v9, s[8:11], s38 offen  lds
  s_add_u32 s39, s37, 1
  s_sub_u32 s40, s39, 10
  s_cmp_ge_u32 s39, 10
  s_cselect_b32 s39, s40, s39
  s_mul_i32 s39, s39, 196608
  s_add_u32 s39, s39, s43
  s_add_u32 m0, s45, 12288
  s_nop 0
  buffer_load_dwordx4 v12, s[12:15], s39 offen  lds
  s_add_u32 m0, s45, 16384
  s_nop 0
  buffer_load_dwordx4 v13, s[12:15], s39 offen  lds
  s_add_u32 m0, s45, 20480
  s_nop 0
  buffer_load_dwordx4 v14, s[12:15], s39 offen  lds
  s_waitcnt vmcnt(5)
  s_barrier
  s_add_u32 s38, s37, 2
  s_sub_u32 s40, s38, 10
  s_cmp_ge_u32 s38, 10
  s_cselect_b32 s38, s40, s38
  s_lshl_b32 s38, s38, 7
  s_add_u32 m0, s45, 77824
  s_nop 0
  buffer_load_dwordx4 v8, s[8:11], s38 offen  lds
  s_add_u32 m0, s45, 81920
  s_nop 0
  buffer_load_dwordx4 v9, s[8:11], s38 offen  lds
  s_add_u32 s39, s37, 2
  s_sub_u32 s40, s39, 10
  s_cmp_ge_u32 s39, 10
  s_cselect_b32 s39, s40, s39
  s_mul_i32 s39, s39, 196608
  s_add_u32 s39, s39, s43
  s_add_u32 m0, s45, 24576
  s_nop 0
  buffer_load_dwordx4 v12, s[12:15], s39 offen  lds
  s_add_u32 m0, s45, 28672
  s_nop 0
  buffer_load_dwordx4 v13, s[12:15], s39 offen  lds
  s_add_u32 m0, s45, 32768
  s_nop 0
  buffer_load_dwordx4 v14, s[12:15], s39 offen  lds
  s_add_u32 s38, s37, 3
  s_sub_u32 s40, s38, 10
  s_cmp_ge_u32 s38, 10
  s_cselect_b32 s38, s40, s38
  s_lshl_b32 s38, s38, 7
  s_add_u32 m0, s45, 86016
  s_nop 0
  buffer_load_dwordx4 v8, s[8:11], s38 offen  lds
  s_add_u32 m0, s45, 90112
  s_nop 0
  buffer_load_dwordx4 v9, s[8:11], s38 offen  lds
  s_add_u32 s39, s37, 3
  s_sub_u32 s40, s39, 10
  s_cmp_ge_u32 s39, 10
  s_cselect_b32 s39, s40, s39
  s_mul_i32 s39, s39, 196608
  s_add_u32 s39, s39, s43
  s_add_u32 m0, s45, 36864
  s_nop 0
  buffer_load_dwordx4 v12, s[12:15], s39 offen  lds
  s_add_u32 m0, s45, 40960
  s_nop 0
  buffer_load_dwordx4 v13, s[12:15], s39 offen  lds
  s_add_u32 m0, s45, 45056
  s_nop 0
  buffer_load_dwordx4 v14, s[12:15], s39 offen  lds
  s_waitcnt vmcnt(10)
  s_barrier
  s_add_u32 s38, s37, 4
  s_sub_u32 s40, s38, 10
  s_cmp_ge_u32 s38, 10
  s_cselect_b32 s38, s40, s38
  s_lshl_b32 s38, s38, 7
  s_add_u32 m0, s45, 94208
  s_nop 0
  buffer_load_dwordx4 v8, s[8:11], s38 offen  lds
  s_add_u32 m0, s45, 98304
  s_nop 0
  buffer_load_dwordx4 v9, s[8:11], s38 offen  lds
  s_add_u32 s39, s37, 4
  s_sub_u32 s40, s39, 10
  s_cmp_ge_u32 s39, 10
  s_cselect_b32 s39, s40, s39
  s_mul_i32 s39, s39, 196608
  s_add_u32 s39, s39, s43
  s_add_u32 m0, s45, 49152
  s_nop 0
  buffer_load_dwordx4 v12, s[12:15], s39 offen  lds
  s_add_u32 m0, s45, 53248
  s_nop 0
  buffer_load_dwordx4 v13, s[12:15], s39 offen  lds
  s_add_u32 m0, s45, 57344
  s_nop 0
  buffer_load_dwordx4 v14, s[12:15], s39 offen  lds
  s_add_u32 s38, s37, 5
  s_sub_u32 s40, s38, 10
  s_cmp_ge_u32 s38, 10
  s_cselect_b32 s38, s40, s38
  s_lshl_b32 s38, s38, 7
  s_add_u32 m0, s45, 102400
  s_nop 0
  buffer_load_dwordx4 v8, s[8:11], s38 offen  lds
  s_add_u32 m0, s45, 106496
  s_nop 0
  buffer_load_dwordx4 v9, s[8:11], s38 offen  lds
  s_waitcnt vmcnt(12)
  s_barrier
  s_add_u32 s38, s37, 6
  s_sub_u32 s40, s38, 10
  s_cmp_ge_u32 s38, 10
  s_cselect_b32 s38, s40, s38
  s_lshl_b32 s38, s38, 7
  s_add_u32 m0, s45, 110592
  s_nop 0
  buffer_load_dwordx4 v8, s[8:11], s38 offen  lds
  s_add_u32 m0, s45, 114688
  s_nop 0
  buffer_load_dwordx4 v9, s[8:11], s38 offen  lds
  s_add_u32 s39, s37, 5
  s_sub_u32 s40, s39, 10
  s_cmp_ge_u32 s39, 10
  s_cselect_b32 s39, s40, s39
  s_mul_i32 s39, s39, 196608
  s_add_u32 s39, s39, s43
  s_add_u32 m0, s45, 0
  s_nop 0
  buffer_load_dwordx4 v12, s[12:15], s39 offen  lds
  s_add_u32 m0, s45, 4096
  s_nop 0
  buffer_load_dwordx4 v13, s[12:15], s39 offen  lds
  s_add_u32 m0, s45, 8192
  s_nop 0
  buffer_load_dwordx4 v14, s[12:15], s39 offen  lds
  s_add_u32 s38, s37, 7
  s_sub_u32 s40, s38, 10
  s_cmp_ge_u32 s38, 10
  s_cselect_b32 s38, s40, s38
  s_lshl_b32 s38, s38, 7
  s_add_u32 m0, s45, 118784
  s_nop 0
  buffer_load_dwordx4 v8, s[8:11], s38 offen  lds
  s_add_u32 m0, s45, 122880
  s_nop 0
  buffer_load_dwordx4 v9, s[8:11], s38 offen  lds
  s_waitcnt vmcnt(14)
  s_barrier
  s_add_u32 s38, s37, 8
  s_sub_u32 s40, s38, 10
  s_cmp_ge_u32 s38, 10
  s_cselect_b32 s38, s40, s38
  s_lshl_b32 s38, s38, 7
  s_add_u32 m0, s45, 126976
  s_nop 0
  buffer_load_dwordx4 v8, s[8:11], s38 offen  lds
  s_add_u32 m0, s45, 131072
  s_nop 0
  buffer_load_dwordx4 v9, s[8:11], s38 offen  lds
  s_add_u32 s39, s37, 6
  s_sub_u32 s40, s39, 10
  s_cmp_ge_u32 s39, 10
  s_cselect_b32 s39, s40, s39
  s_mul_i32 s39, s39, 196608
  s_add_u32 s39, s39, s43
  s_add_u32 m0, s45, 12288
  s_nop 0
  buffer_load_dwordx4 v12, s[12:15], s39 offen  lds
  s_add_u32 m0, s45, 16384
  s_nop 0
  buffer_load_dwordx4 v13, s[12:15], s39 offen  lds
  s_add_u32 m0, s45, 20480
  s_nop 0
  buffer_load_dwordx4 v14, s[12:15], s39 offen  lds
  s_add_u32 s38, s37, 9
  s_sub_u32 s40, s38, 10
  s_cmp_ge_u32 s38, 10
  s_cselect_b32 s38, s40, s38
  s_lshl_b32 s38, s38, 7
  s_add_u32 m0, s45, 135168
  s_nop 0
  buffer_load_dwordx4 v8, s[8:11], s38 offen  lds
  s_add_u32 m0, s45, 139264
  s_nop 0
  buffer_load_dwordx4 v9, s[8:11], s38 offen  lds
  s_waitcnt vmcnt(16)
  s_barrier
  s_add_u32 s39, s37, 7
  s_sub_u32 s40, s39, 10
  s_cmp_ge_u32 s39, 10
  s_cselect_b32 s39, s40, s39
  s_mul_i32 s39, s39, 196608
  s_add_u32 s39, s39, s43
  s_add_u32 m0, s45, 24576
  s_nop 0
  buffer_load_dwordx4 v12, s[12:15], s39 offen  lds
  s_add_u32 m0, s45, 28672
  s_nop 0
  buffer_load_dwordx4 v13, s[12:15], s39 offen  lds
  s_add_u32 m0, s45, 32768
  s_nop 0
  buffer_load_dwordx4 v14, s[12:15], s39 offen  lds
  s_waitcnt vmcnt(12)
  s_barrier
  s_add_u32 s39, s37, 8
  s_sub_u32 s40, s39, 10
  s_cmp_ge_u32 s39, 10
  s_cselect_b32 s39, s40, s39
  s_mul_i32 s39, s39, 196608
  s_add_u32 s39, s39, s43
  s_add_u32 m0, s45, 36864
  s_nop 0
  buffer_load_dwordx4 v12, s[12:15], s39 offen  lds
  s_add_u32 m0, s45, 40960
  s_nop 0
  buffer_load_dwordx4 v13, s[12:15], s39 offen  lds
  s_add_u32 m0, s45, 45056
  s_nop 0
  buffer_load_dwordx4 v14, s[12:15], s39 offen  lds
  s_add_u32 s39, s37, 9
  s_sub_u32 s40, s39, 10
  s_cmp_ge_u32 s39, 10
  s_cselect_b32 s39, s40, s39
  s_mul_i32 s39, s39, 196608
  s_add_u32 s39, s39, s43
  s_add_u32 m0, s45, 49152
  s_nop 0
  buffer_load_dwordx4 v12, s[12:15], s39 offen  lds
  s_add_u32 m0, s45, 53248
  s_nop 0
  buffer_load_dwordx4 v13, s[12:15], s39 offen  lds
  s_add_u32 m0, s45, 57344
  s_nop 0
  buffer_load_dwordx4 v14, s[12:15], s39 offen  lds
  s_waitcnt vmcnt(11)
  s_barrier
  s_add_u32 s39, s37, 0
  s_sub_u32 s40, s39, 10
  s_cmp_ge_u32 s39, 10
  s_cselect_b32 s39, s40, s39
  s_mul_i32 s39, s39, 196608
  s_add_u32 s39, s39, s44
  s_add_u32 m0, s45, 0
  s_nop 0
  buffer_load_dwordx4 v12, s[12:15], s39 offen  lds
  s_add_u32 m0, s45, 4096
  s_nop 0
  buffer_load_dwordx4 v13, s[12:15], s39 offen  lds
  s_add_u32 m0, s45, 8192
  s_nop 0
  buffer_load_dwordx4 v14, s[12:15], s39 offen  lds
  s_waitcnt vmcnt(9)
  s_barrier
  s_add_u32 s39, s37, 1
  s_sub_u32 s40, s39, 10
  s_cmp_ge_u32 s39, 10
  s_cselect_b32 s39, s40, s39
  s_mul_i32 s39, s39, 196608
  s_add_u32 s39, s39, s44
  s_add_u32 m0, s45, 12288
  s_nop 0
  buffer_load_dwordx4 v12, s[12:15], s39 offen  lds
  s_add_u32 m0, s45, 16384
  s_nop 0
  buffer_load_dwordx4 v13, s[12:15], s39 offen  lds
  s_add_u32 m0, s45, 20480
  s_nop 0
  buffer_load_dwordx4 v14, s[12:15], s39 offen  lds
  s_waitcnt vmcnt(9)
  s_barrier
  s_add_u32 s39, s37, 2
  s_sub_u32 s40, s39, 10
  s_cmp_ge_u32 s39, 10
  s_cselect_b32 s39, s40, s39
  s_mul_i32 s39, s39, 196608
  s_add_u32 s39, s39, s44
  s_add_u32 m0, s45, 24576
  s_nop 0
  buffer_load_dwordx4 v12, s[12:15], s39 offen  lds
  s_add_u32 m0, s45, 28672
  s_nop 0
  buffer_load_dwordx4 v13, s[12:15], s39 offen  lds
  s_add_u32 m0, s45, 32768
  s_nop 0
  buffer_load_dwordx4 v14, s[12:15], s39 offen  lds
  s_waitcnt vmcnt(9)
  s_barrier
  s_add_u32 s39, s37, 3
  s_sub_u32 s40, s39, 10
  s_cmp_ge_u32 s39, 10
  s_cselect_b32 s39, s40, s39
  s_mul_i32 s39, s39, 196608
  s_add_u32 s39, s39, s44
  s_add_u32 m0, s45, 36864
  s_nop 0
  buffer_load_dwordx4 v12, s[12:15], s39 offen  lds
  s_add_u32 m0, s45, 40960
  s_nop 0
  buffer_load_dwordx4 v13, s[12:15], s39 offen  lds
  s_add_u32 m0, s45, 45056
  s_nop 0
  buffer_load_dwordx4 v14, s[12:15], s39 offen  lds
  s_waitcnt vmcnt(9)
  s_barrier
  s_add_u32 s39, s37, 4
  s_sub_u32 s40, s39, 10
  s_cmp_ge_u32 s39, 10
  s_cselect_b32 s39, s40, s39
  s_mul_i32 s39, s39, 196608
  s_add_u32 s39, s39, s44
  s_add_u32 m0, s45, 49152
  s_nop 0
  buffer_load_dwordx4 v12, s[12:15], s39 offen  lds
  s_add_u32 m0, s45, 53248
  s_nop 0
  buffer_load_dwordx4 v13, s[12:15], s39 offen  lds
  s_add_u32 m0, s45, 57344
  s_nop 0
  buffer_load_dwordx4 v14, s[12:15], s39 offen  lds
  v_mul_u32_u24 v5, 6554, v1
  v_lshrrev_b32 v5, 16, v5
  v_mul_u32_u24 v4, 10, v5
  v_sub_u32 v4, v1, v4
  v_lshlrev_b32 v4, 4, v4
  v_mul_u32_u24 v30, 1280, v5
  v_add_u32 v4, v4, v30
  s_mov_b32 s20, s58
  s_and_b32 s21, s59, 0xffff
  s_mov_b32 s22, 2621440
  s_mov_b32 s23, 0x20000
  s_mov_b32 s24, s60
  s_and_b32 s25, s61, 0xffff
  s_mov_b32 s26, 2621440
  s_mov_b32 s27, 0x20000
  s_lshl_b32 s40, s32, 6
  s_lshl_b32 s41, s55, 4
  s_add_u32 s40, s40, s41
  s_mul_i32 s46, s40, 1280
  s_mul_i32 s41, s33, 160
  s_add_u32 s46, s46, s41
  s_mul_i32 s78, s55, 6720
  s_add_u32 s78, s78, 61440
  v_mov_b32 v20, v4
  s_sub_u32 s79, s46, 3840
  s_cmp_eq_u32 s40, 0
  s_cbranch_scc0 K1_NONNEG
  v_subrev_u32 v20, 3840, v4
  v_cmp_gt_u32 vcc, 3, v5
  v_mov_b32 v31, 0x80000000
  s_nop 0
  v_cndmask_b32 v20, v20, v31, vcc
  s_mov_b32 s79, s46
K1_NONNEG:
  s_mov_b32 s28, s62
  s_and_b32 s29, s63, 0xffff
  s_mov_b32 s30, 5120
  s_mov_b32 s31, 0x20000
  v_lshlrev_b32 v21, 4, v1
  s_mul_i32 s54, s33, 640
  s_waitcnt vmcnt(9)
  s_barrier
  s_add_u32 s39, s37, 5
  s_sub_u32 s40, s39, 10
  s_cmp_ge_u32 s39, 10
  s_cselect_b32 s39, s40, s39
  s_mul_i32 s39, s39, 196608
  s_add_u32 s39, s39, s44
  s_add_u32 m0, s45, 0
  s_nop 0
  buffer_load_dwordx4 v12, s[12:15], s39 offen  lds
  s_add_u32 m0, s45, 4096
  s_nop 0
  buffer_load_dwordx4 v13, s[12:15], s39 offen  lds
  s_add_u32 m0, s45, 8192
  s_nop 0
  buffer_load_dwordx4 v14, s[12:15], s39 offen  lds
  s_waitcnt vmcnt(9)
  s_barrier
  s_add_u32 s39, s37, 6
  s_sub_u32 s40, s39, 10
  s_cmp_ge_u32 s39, 10
  s_cselect_b32 s39, s40, s39
  s_mul_i32 s39, s39, 196608
  s_add_u32 s39, s39, s44
  s_add_u32 m0, s45, 12288
  s_nop 0
  buffer_load_dwordx4 v12, s[12:15], s39 offen  lds
  s_add_u32 m0, s45, 16384
  s_nop 0
  buffer_load_dwordx4 v13, s[12:15], s39 offen  lds
  s_add_u32 m0, s45, 20480
  s_nop 0
  buffer_load_dwordx4 v14, s[12:15], s39 offen  lds
  s_waitcnt vmcnt(9)
  s_barrier
  s_add_u32 s39, s37, 7
  s_sub_u32 s40, s39, 10
  s_cmp_ge_u32 s39, 10
  s_cselect_b32 s39, s40, s39
  s_mul_i32 s39, s39, 196608
  s_add_u32 s39, s39, s44
  s_add_u32 m0, s45, 24576
  s_nop 0
  buffer_load_dwordx4 v12, s[12:15], s39 offen  lds
  s_add_u32 m0, s45, 28672
  s_nop 0
  buffer_load_dwordx4 v13, s[12:15], s39 offen  lds
  s_add_u32 m0, s45, 32768
  s_nop 0
  buffer_load_dwordx4 v14, s[12:15], s39 offen  lds
  s_waitcnt vmcnt(9)
  s_barrier
  s_add_u32 s39, s37, 8
  s_sub_u32 s40, s39, 10
  s_cmp_ge_u32 s39, 10
  s_cselect_b32 s39, s40, s39
  s_mul_i32 s39, s39, 196608
  s_add_u32 s39, s39, s44
  s_add_u32 m0, s45, 36864
  s_nop 0
  buffer_load_dwordx4 v12, s[12:15], s39 offen  lds
  s_add_u32 m0, s45, 40960
  s_nop 0
  buffer_load_dwordx4 v13, s[12:15], s39 offen  lds
  s_add_u32 m0, s45, 45056
  s_nop 0
  buffer_load_dwordx4 v14, s[12:15], s39 offen  lds
  s_waitcnt vmcnt(9)
  s_barrier
  s_add_u32 s39, s37, 9
  s_sub_u32 s40, s39, 10
  s_cmp_ge_u32 s39, 10
  s_cselect_b32 s39, s40, s39
  s_mul_i32 s39, s39, 196608
  s_add_u32 s39, s39, s44
  s_add_u32 m0, s45, 49152
  s_nop 0
  buffer_load_dwordx4 v12, s[12:15], s39 offen  lds
  s_add_u32 m0, s45, 53248
  s_nop 0
  buffer_load_dwordx4 v13, s[12:15], s39 offen  lds
  s_add_u32 m0, s45, 57344
  s_nop 0
  buffer_load_dwordx4 v14, s[12:15], s39 offen  lds
  s_mov_b32 exec_lo, 0xffffffff
  s_mov_b32 exec_hi, 0xfffffff
  s_add_u32 m0, s78, 0
  s_nop 0
  buffer_load_dwordx4 v20, s[20:23], s79 offen  lds
  s_add_u32 m0, s78, 960
  s_add_u32 s79, s46, 3840
  buffer_load_dwordx4 v4, s[20:23], s79 offen  lds
  s_add_u32 m0, s78, 1920
  s_add_u32 s79, s46, 11520
  buffer_load_dwordx4 v4, s[20:23], s79 offen  lds
  s_add_u32 m0, s78, 2880
  s_add_u32 s79, s46, 19200
  buffer_load_dwordx4 v4, s[20:23], s79 offen  lds
  s_add_u32 m0, s78, 3840
  s_add_u32 s79, s46, 0
  buffer_load_dwordx4 v4, s[24:27], s79 offen  lds
  s_add_u32 m0, s78, 4800
  s_add_u32 s79, s46, 7680
  buffer_load_dwordx4 v4, s[24:27], s79 offen  lds
  s_add_u32 m0, s78, 5760
  s_add_u32 s79, s46, 15360
  buffer_load_dwordx4 v4, s[24:27], s79 offen  lds
  s_mov_b64 exec, s[52:53]
  buffer_load_dwordx4 v[156:159], v21, s[28:31], s54 offen
  s_waitcnt vmcnt(17)
  s_barrier
  s_waitcnt vmcnt(14)
  s_barrier
  s_waitcnt vmcnt(11)
  s_barrier
  s_waitcnt vmcnt(8)
  s_barrier
  s_waitcnt vmcnt(0)
  v_lshlrev_b32 v30, 2, v1
  v_min_u32 v30, 156, v30
  v_add_u32 v30, s78, v30
  ds_read_b32 v40, v30 offset:0
  ds_read_b32 v41, v30 offset:160
  ds_read_b32 v42, v30 offset:320
  ds_read_b32 v43, v30 offset:480
  ds_read_b32 v44, v30 offset:640
  ds_read_b32 v45, v30 offset:800
  ds_read_b32 v46, v30 offset:960
  ds_read_b32 v47, v30 offset:1120
  ds_read_b32 v48, v30 offset:1280
  ds_read_b32 v49, v30 offset:1440
  ds_read_b32 v50, v30 offset:1600
  ds_read_b32 v51, v30 offset:1760
  ds_read_b32 v52, v30 offset:1920
  ds_read_b32 v53, v30 offset:2080
  s_waitcnt lgkmcnt(6)
  ds_read_b32 v54, v30 offset:2240
  ds_read_b32 v55, v30 offset:2400
  ds_read_b32 v56, v30 offset:2560
  ds_read_b32 v57, v30 offset:2720
  ds_read_b32 v58, v30 offset:2880
  s_barrier
  ds_read_b32 v59, v30 offset:3840
  ds_read_b32 v60, v30 offset:4000
  s_waitcnt lgkmcnt(6)
  ds_read_b32 v61, v30 offset:4160
  ds_read_b32 v62, v30 offset:4320
  ds_read_b32 v63, v30 offset:4480
  ds_read_b32 v64, v30 offset:4640
  ds_read_b32 v65, v30 offset:4800
  ds_read_b32 v66, v30 offset:4960
  ds_read_b32 v67, v30 offset:5120
  ds_read_b32 v68, v30 offset:5280
  s_waitcnt lgkmcnt(6)
  ds_read_b32 v69, v30 offset:5440
  ds_read_b32 v70, v30 offset:5600
  ds_read_b32 v71, v30 offset:5760
  ds_read_b32 v72, v30 offset:5920
  ds_read_b32 v73, v30 offset:6080
  ds_read_b32 v74, v30 offset:6240
  v_lshlrev_b32 v114, 16, v156
  v_lshlrev_b32 v115, 16, v158
  v_and_b32 v116, s47, v156
  v_and_b32 v117, s47, v158
  v_lshlrev_b32 v118, 16, v157
  v_lshlrev_b32 v119, 16, v159
  v_and_b32 v120, s47, v157
  v_and_b32 v121, s47, v159
  s_waitcnt lgkmcnt(0)
  s_barrier
  v_lshlrev_b32 v76, 16, v40
  v_and_b32 v77, s47, v40
  v_lshlrev_b32 v78, 16, v41
  v_and_b32 v79, s47, v41
  v_lshlrev_b32 v80, 16, v42
  v_and_b32 v81, s47, v42
  v_lshlrev_b32 v82, 16, v43
  v_and_b32 v83, s47, v43
  v_lshlrev_b32 v84, 16, v44
  v_and_b32 v85, s47, v44
  v_lshlrev_b32 v86, 16, v45
  v_and_b32 v87, s47, v45
  v_lshlrev_b32 v88, 16, v46
  v_and_b32 v89, s47, v46
  v_lshlrev_b32 v90, 16, v47
  v_and_b32 v91, s47, v47
  v_lshlrev_b32 v92, 16, v48
  v_and_b32 v93, s47, v48
  v_lshlrev_b32 v94, 16, v49
  v_and_b32 v95, s47, v49
  v_lshlrev_b32 v96, 16, v50
  v_and_b32 v97, s47, v50
  v_lshlrev_b32 v98, 16, v51
  v_and_b32 v99, s47, v51
  v_lshlrev_b32 v100, 16, v52
  v_and_b32 v101, s47, v52
  v_lshlrev_b32 v102, 16, v53
  v_and_b32 v103, s47, v53
  v_lshlrev_b32 v104, 16, v54
  v_and_b32 v105, s47, v54
  v_lshlrev_b32 v106, 16, v55
  v_and_b32 v107, s47, v55
  v_lshlrev_b32 v108, 16, v56
  v_and_b32 v109, s47, v56
  v_lshlrev_b32 v110, 16, v57
  v_and_b32 v111, s47, v57
  v_lshlrev_b32 v112, 16, v58
  v_and_b32 v113, s47, v58
  v_pk_mul_f32 v[122:123], v[120:121], v[76:77]
  v_lshlrev_b32 v32, 16, v59
  v_pk_fma_f32 v[122:123], v[118:119], v[78:79], v[122:123]
  v_and_b32 v33, s47, v59
  v_pk_fma_f32 v[122:123], v[116:117], v[80:81], v[122:123]
  v_pk_fma_f32 v[122:123], v[114:115], v[82:83], v[122:123]
  v_pk_mul_f32 v[122:123], v[122:123], v[32:33]
  v_pk_mul_f32 v[124:125], v[120:121], v[78:79]
  v_lshlrev_b32 v32, 16, v60
  v_pk_fma_f32 v[124:125], v[118:119], v[80:81], v[124:125]
  v_and_b32 v33, s47, v60
  v_pk_fma_f32 v[124:125], v[116:117], v[82:83], v[124:125]
  v_pk_fma_f32 v[124:125], v[114:115], v[84:85], v[124:125]
  v_pk_mul_f32 v[124:125], v[124:125], v[32:33]
  v_pk_mul_f32 v[126:127], v[120:121], v[80:81]
  v_lshlrev_b32 v32, 16, v61
  v_pk_fma_f32 v[126:127], v[118:119], v[82:83], v[126:127]
  v_and_b32 v33, s47, v61
  v_pk_fma_f32 v[126:127], v[116:117], v[84:85], v[126:127]
  v_pk_fma_f32 v[126:127], v[114:115], v[86:87], v[126:127]
  v_pk_mul_f32 v[126:127], v[126:127], v[32:33]
  v_pk_mul_f32 v[128:129], v[120:121], v[82:83]
  v_lshlrev_b32 v32, 16, v62
  v_pk_fma_f32 v[128:129], v[118:119], v[84:85], v[128:129]
  v_and_b32 v33, s47, v62
  v_pk_fma_f32 v[128:129], v[116:117], v[86:87], v[128:129]
  v_pk_fma_f32 v[128:129], v[114:115], v[88:89], v[128:129]
  v_pk_mul_f32 v[128:129], v[128:129], v[32:33]
  v_pk_mul_f32 v[130:131], v[120:121], v[84:85]
  v_lshlrev_b32 v32, 16, v63
  v_pk_fma_f32 v[130:131], v[118:119], v[86:87], v[130:131]
  v_and_b32 v33, s47, v63
  v_pk_fma_f32 v[130:131], v[116:117], v[88:89], v[130:131]
  v_pk_fma_f32 v[130:131], v[114:115], v[90:91], v[130:131]
  v_pk_mul_f32 v[130:131], v[130:131], v[32:33]
  v_pk_mul_f32 v[132:133], v[120:121], v[86:87]
  v_lshlrev_b32 v32, 16, v64
  v_pk_fma_f32 v[132:133], v[118:119], v[88:89], v[132:133]
  v_and_b32 v33, s47, v64
  v_pk_fma_f32 v[132:133], v[116:117], v[90:91], v[132:133]
  v_pk_fma_f32 v[132:133], v[114:115], v[92:93], v[132:133]
  v_pk_mul_f32 v[132:133], v[132:133], v[32:33]
  v_pk_mul_f32 v[134:135], v[120:121], v[88:89]
  v_lshlrev_b32 v32, 16, v65
  v_pk_fma_f32 v[134:135], v[118:119], v[90:91], v[134:135]
  v_and_b32 v33, s47, v65
  v_pk_fma_f32 v[134:135], v[116:117], v[92:93], v[134:135]
  v_pk_fma_f32 v[134:135], v[114:115], v[94:95], v[134:135]
  v_pk_mul_f32 v[134:135], v[134:135], v[32:33]
  v_pk_mul_f32 v[136:137], v[120:121], v[90:91]
  v_lshlrev_b32 v32, 16, v66
  v_pk_fma_f32 v[136:137], v[118:119], v[92:93], v[136:137]
  v_and_b32 v33, s47, v66
  v_pk_fma_f32 v[136:137], v[116:117], v[94:95], v[136:137]
  v_pk_fma_f32 v[136:137], v[114:115], v[96:97], v[136:137]
  v_pk_mul_f32 v[136:137], v[136:137], v[32:33]
  v_pk_mul_f32 v[138:139], v[120:121], v[92:93]
  v_lshlrev_b32 v32, 16, v67
  v_pk_fma_f32 v[138:139], v[118:119], v[94:95], v[138:139]
  v_and_b32 v33, s47, v67
  v_pk_fma_f32 v[138:139], v[116:117], v[96:97], v[138:139]
  v_pk_fma_f32 v[138:139], v[114:115], v[98:99], v[138:139]
  v_pk_mul_f32 v[138:139], v[138:139], v[32:33]
  v_pk_mul_f32 v[140:141], v[120:121], v[94:95]
  v_lshlrev_b32 v32, 16, v68
  v_pk_fma_f32 v[140:141], v[118:119], v[96:97], v[140:141]
  v_and_b32 v33, s47, v68
  v_pk_fma_f32 v[140:141], v[116:117], v[98:99], v[140:141]
  v_pk_fma_f32 v[140:141], v[114:115], v[100:101], v[140:141]
  v_pk_mul_f32 v[140:141], v[140:141], v[32:33]
  v_pk_mul_f32 v[142:143], v[120:121], v[96:97]
  v_lshlrev_b32 v32, 16, v69
  v_pk_fma_f32 v[142:143], v[118:119], v[98:99], v[142:143]
  v_and_b32 v33, s47, v69
  v_pk_fma_f32 v[142:143], v[116:117], v[100:101], v[142:143]
  v_pk_fma_f32 v[142:143], v[114:115], v[102:103], v[142:143]
  v_pk_mul_f32 v[142:143], v[142:143], v[32:33]
  v_pk_mul_f32 v[144:145], v[120:121], v[98:99]
  v_lshlrev_b32 v32, 16, v70
  v_pk_fma_f32 v[144:145], v[118:119], v[100:101], v[144:145]
  v_and_b32 v33, s47, v70
  v_pk_fma_f32 v[144:145], v[116:117], v[102:103], v[144:145]
  v_pk_fma_f32 v[144:145], v[114:115], v[104:105], v[144:145]
  v_pk_mul_f32 v[144:145], v[144:145], v[32:33]
  v_pk_mul_f32 v[146:147], v[120:121], v[100:101]
  v_lshlrev_b32 v32, 16, v71
  v_pk_fma_f32 v[146:147], v[118:119], v[102:103], v[146:147]
  v_and_b32 v33, s47, v71
  v_pk_fma_f32 v[146:147], v[116:117], v[104:105], v[146:147]
  v_pk_fma_f32 v[146:147], v[114:115], v[106:107], v[146:147]
  v_pk_mul_f32 v[146:147], v[146:147], v[32:33]
  v_pk_mul_f32 v[148:149], v[120:121], v[102:103]
  v_lshlrev_b32 v32, 16, v72
  v_pk_fma_f32 v[148:149], v[118:119], v[104:105], v[148:149]
  v_and_b32 v33, s47, v72
  v_pk_fma_f32 v[148:149], v[116:117], v[106:107], v[148:149]
  v_pk_fma_f32 v[148:149], v[114:115], v[108:109], v[148:149]
  v_pk_mul_f32 v[148:149], v[148:149], v[32:33]
  v_pk_mul_f32 v[150:151], v[120:121], v[104:105]
  v_lshlrev_b32 v32, 16, v73
  v_pk_fma_f32 v[150:151], v[118:119], v[106:107], v[150:151]
  v_and_b32 v33, s47, v73
  v_pk_fma_f32 v[150:151], v[116:117], v[108:109], v[150:151]
  v_pk_fma_f32 v[150:151], v[114:115], v[110:111], v[150:151]
  v_pk_mul_f32 v[150:151], v[150:151], v[32:33]
  v_pk_mul_f32 v[152:153], v[120:121], v[106:107]
  v_lshlrev_b32 v32, 16, v74
  v_pk_fma_f32 v[152:153], v[118:119], v[108:109], v[152:153]
  v_and_b32 v33, s47, v74
  v_pk_fma_f32 v[152:153], v[116:117], v[110:111], v[152:153]
  v_pk_fma_f32 v[152:153], v[114:115], v[112:113], v[152:153]
  v_pk_mul_f32 v[152:153], v[152:153], v[32:33]
  v_cvt_pk_bf16_f32 v40, v136, v134
  v_cvt_pk_bf16_f32 v41, v132, v130
  v_cvt_pk_bf16_f32 v42, v128, v126
  v_cvt_pk_bf16_f32 v43, v124, v122
  v_cvt_pk_bf16_f32 v44, v152, v150
  v_cvt_pk_bf16_f32 v45, v148, v146
  v_cvt_pk_bf16_f32 v46, v144, v142
  v_cvt_pk_bf16_f32 v47, v140, v138
  v_cvt_pk_bf16_f32 v48, v137, v135
  v_cvt_pk_bf16_f32 v49, v133, v131
  v_cvt_pk_bf16_f32 v50, v129, v127
  v_cvt_pk_bf16_f32 v51, v125, v123
  v_cvt_pk_bf16_f32 v52, v153, v151
  v_cvt_pk_bf16_f32 v53, v149, v147
  v_cvt_pk_bf16_f32 v54, v145, v143
  v_cvt_pk_bf16_f32 v55, v141, v139
  v_mul_u32_u24 v30, 288, v1
  s_lshl_b32 s40, s55, 5
  s_add_u32 s40, s40, 49152
  v_add_u32 v30, s40, v30
  s_mov_b32 exec_lo, 0xffffffff
  s_mov_b32 exec_hi, 0xff
  ds_write_b128 v30, v[40:43] offset:0
  ds_write_b128 v30, v[44:47] offset:16
  ds_write_b128 v30, v[48:51] offset:144
  ds_write_b128 v30, v[52:55] offset:160
  s_mov_b64 exec, s[52:53]
  s_load_dwordx2 s[56:57], s[0:1], 64
  s_load_dwordx2 s[60:61], s[0:1], 104
  s_lshl_b32 s40, s32, 6
  s_lshl_b32 s41, s55, 4
  s_add_u32 s40, s40, s41
  v_add_u32 v10, 0, v2
  v_xor_b32 v11, v10, v3
  v_lshlrev_b32 v11, 4, v11
  v_add_u32 v10, s40, v10
  v_lshlrev_b32 v10, 12, v10
  v_add_u32 v4, v10, v11
  v_add_u32 v10, 4, v2
  v_xor_b32 v11, v10, v3
  v_lshlrev_b32 v11, 4, v11
  v_add_u32 v10, s40, v10
  v_lshlrev_b32 v10, 12, v10
  v_add_u32 v5, v10, v11
  v_add_u32 v10, 8, v2
  v_xor_b32 v11, v10, v3
  v_lshlrev_b32 v11, 4, v11
  v_add_u32 v10, s40, v10
  v_lshlrev_b32 v10, 12, v10
  v_add_u32 v6, v10, v11
  v_add_u32 v10, 12, v2
  v_xor_b32 v11, v10, v3
  v_lshlrev_b32 v11, 4, v11
  v_add_u32 v10, s40, v10
  v_lshlrev_b32 v10, 12, v10
  v_add_u32 v7, v10, v11
  s_lshl_b32 s39, s55, 12
  s_waitcnt lgkmcnt(0)
  s_mov_b32 s8, s56
  s_and_b32 s9, s57, 0xffff
  s_mov_b32 s10, 8388608
  s_mov_b32 s11, 0x20000
  s_mov_b32 s16, s60
  s_and_b32 s17, s61, 0xffff
  s_mov_b32 s18, 18874368
  s_mov_b32 s19, 0x20000
  s_waitcnt lgkmcnt(0)
  s_barrier
  s_sleep 5
  s_movk_i32 s38, 0
  s_add_u32 m0, s39, 0
  s_nop 0
  buffer_load_dwordx4 v4, s[8:11], s38 offen  lds
  s_add_u32 m0, s39, 1024
  s_nop 0
  buffer_load_dwordx4 v5, s[8:11], s38 offen  lds
  s_add_u32 m0, s39, 2048
  s_nop 0
  buffer_load_dwordx4 v6, s[8:11], s38 offen  lds
  s_add_u32 m0, s39, 3072
  s_nop 0
  buffer_load_dwordx4 v7, s[8:11], s38 offen  lds
  s_movk_i32 s38, 256
  s_add_u32 m0, s39, 16384
  s_nop 0
  buffer_load_dwordx4 v4, s[8:11], s38 offen  lds
  s_add_u32 m0, s39, 17408
  s_nop 0
  buffer_load_dwordx4 v5, s[8:11], s38 offen  lds
  s_add_u32 m0, s39, 18432
  s_nop 0
  buffer_load_dwordx4 v6, s[8:11], s38 offen  lds
  s_add_u32 m0, s39, 19456
  s_nop 0
  buffer_load_dwordx4 v7, s[8:11], s38 offen  lds
  s_movk_i32 s38, 512
  s_add_u32 m0, s39, 32768
  s_nop 0
  buffer_load_dwordx4 v4, s[8:11], s38 offen  lds
  s_add_u32 m0, s39, 33792
  s_nop 0
  buffer_load_dwordx4 v5, s[8:11], s38 offen  lds
  s_add_u32 m0, s39, 34816
  s_nop 0
  buffer_load_dwordx4 v6, s[8:11], s38 offen  lds
  s_add_u32 m0, s39, 35840
  s_nop 0
  buffer_load_dwordx4 v7, s[8:11], s38 offen  lds
  s_waitcnt vmcnt(8)
  s_barrier
  s_waitcnt vmcnt(4)
  s_barrier
  s_movk_i32 s38, 768
  s_add_u32 m0, s39, 49152
  s_nop 0
  buffer_load_dwordx4 v4, s[8:11], s38 offen  lds
  s_add_u32 m0, s39, 50176
  s_nop 0
  buffer_load_dwordx4 v5, s[8:11], s38 offen  lds
  s_add_u32 m0, s39, 51200
  s_nop 0
  buffer_load_dwordx4 v6, s[8:11], s38 offen  lds
  s_add_u32 m0, s39, 52224
  s_nop 0
  buffer_load_dwordx4 v7, s[8:11], s38 offen  lds
  s_waitcnt vmcnt(4)
  s_barrier
  s_movk_i32 s38, 1024
  s_add_u32 m0, s39, 0
  s_nop 0
  buffer_load_dwordx4 v4, s[8:11], s38 offen  lds
  s_add_u32 m0, s39, 1024
  s_nop 0
  buffer_load_dwordx4 v5, s[8:11], s38 offen  lds
  s_add_u32 m0, s39, 2048
  s_nop 0
  buffer_load_dwordx4 v6, s[8:11], s38 offen  lds
  s_add_u32 m0, s39, 3072
  s_nop 0
  buffer_load_dwordx4 v7, s[8:11], s38 offen  lds
  s_waitcnt vmcnt(4)
  s_barrier
  s_movk_i32 s38, 1280
  s_add_u32 m0, s39, 16384
  s_nop 0
  buffer_load_dwordx4 v4, s[8:11], s38 offen  lds
  s_add_u32 m0, s39, 17408
  s_nop 0
  buffer_load_dwordx4 v5, s[8:11], s38 offen  lds
  s_add_u32 m0, s39, 18432
  s_nop 0
  buffer_load_dwordx4 v6, s[8:11], s38 offen  lds
  s_add_u32 m0, s39, 19456
  s_nop 0
  buffer_load_dwordx4 v7, s[8:11], s38 offen  lds
  s_waitcnt vmcnt(4)
  s_barrier
  s_movk_i32 s38, 1536
  s_add_u32 m0, s39, 32768
  s_nop 0
  buffer_load_dwordx4 v4, s[8:11], s38 offen  lds
  s_add_u32 m0, s39, 33792
  s_nop 0
  buffer_load_dwordx4 v5, s[8:11], s38 offen  lds
  s_add_u32 m0, s39, 34816
  s_nop 0
  buffer_load_dwordx4 v6, s[8:11], s38 offen  lds
  s_add_u32 m0, s39, 35840
  s_nop 0
  buffer_load_dwordx4 v7, s[8:11], s38 offen  lds
  s_waitcnt vmcnt(4)
  s_barrier
  s_movk_i32 s38, 1792
  s_add_u32 m0, s39, 49152
  s_nop 0
  buffer_load_dwordx4 v4, s[8:11], s38 offen  lds
  s_add_u32 m0, s39, 50176
  s_nop 0
  buffer_load_dwordx4 v5, s[8:11], s38 offen  lds
  s_add_u32 m0, s39, 51200
  s_nop 0
  buffer_load_dwordx4 v6, s[8:11], s38 offen  lds
  s_add_u32 m0, s39, 52224
  s_nop 0
  buffer_load_dwordx4 v7, s[8:11], s38 offen  lds
  s_waitcnt vmcnt(4)
  s_barrier
  s_movk_i32 s38, 2048
  s_add_u32 m0, s39, 0
  s_nop 0
  buffer_load_dwordx4 v4, s[8:11], s38 offen  lds
  s_add_u32 m0, s39, 1024
  s_nop 0
  buffer_load_dwordx4 v5, s[8:11], s38 offen  lds
  s_add_u32 m0, s39, 2048
  s_nop 0
  buffer_load_dwordx4 v6, s[8:11], s38 offen  lds
  s_add_u32 m0, s39, 3072
  s_nop 0
  buffer_load_dwordx4 v7, s[8:11], s38 offen  lds
  s_waitcnt vmcnt(4)
  s_barrier
  s_movk_i32 s38, 2304
  s_add_u32 m0, s39, 16384
  s_nop 0
  buffer_load_dwordx4 v4, s[8:11], s38 offen  lds
  s_add_u32 m0, s39, 17408
  s_nop 0
  buffer_load_dwordx4 v5, s[8:11], s38 offen  lds
  s_add_u32 m0, s39, 18432
  s_nop 0
  buffer_load_dwordx4 v6, s[8:11], s38 offen  lds
  s_add_u32 m0, s39, 19456
  s_nop 0
  buffer_load_dwordx4 v7, s[8:11], s38 offen  lds
  s_waitcnt vmcnt(4)
  s_barrier
  s_movk_i32 s38, 2560
  s_add_u32 m0, s39, 32768
  s_nop 0
  buffer_load_dwordx4 v4, s[8:11], s38 offen  lds
  s_add_u32 m0, s39, 33792
  s_nop 0
  buffer_load_dwordx4 v5, s[8:11], s38 offen  lds
  s_add_u32 m0, s39, 34816
  s_nop 0
  buffer_load_dwordx4 v6, s[8:11], s38 offen  lds
  s_add_u32 m0, s39, 35840
  s_nop 0
  buffer_load_dwordx4 v7, s[8:11], s38 offen  lds
  s_waitcnt vmcnt(4)
  s_barrier
  s_movk_i32 s38, 2816
  s_add_u32 m0, s39, 49152
  s_nop 0
  buffer_load_dwordx4 v4, s[8:11], s38 offen  lds
  s_add_u32 m0, s39, 50176
  s_nop 0
  buffer_load_dwordx4 v5, s[8:11], s38 offen  lds
  s_add_u32 m0, s39, 51200
  s_nop 0
  buffer_load_dwordx4 v6, s[8:11], s38 offen  lds
  s_add_u32 m0, s39, 52224
  s_nop 0
  buffer_load_dwordx4 v7, s[8:11], s38 offen  lds
  s_waitcnt vmcnt(4)
  s_barrier
  s_movk_i32 s38, 3072
  s_add_u32 m0, s39, 0
  s_nop 0
  buffer_load_dwordx4 v4, s[8:11], s38 offen  lds
  s_add_u32 m0, s39, 1024
  s_nop 0
  buffer_load_dwordx4 v5, s[8:11], s38 offen  lds
  s_add_u32 m0, s39, 2048
  s_nop 0
  buffer_load_dwordx4 v6, s[8:11], s38 offen  lds
  s_add_u32 m0, s39, 3072
  s_nop 0
  buffer_load_dwordx4 v7, s[8:11], s38 offen  lds
  s_waitcnt vmcnt(4)
  s_barrier
  s_movk_i32 s38, 3328
  s_add_u32 m0, s39, 16384
  s_nop 0
  buffer_load_dwordx4 v4, s[8:11], s38 offen  lds
  s_add_u32 m0, s39, 17408
  s_nop 0
  buffer_load_dwordx4 v5, s[8:11], s38 offen  lds
  s_add_u32 m0, s39, 18432
  s_nop 0
  buffer_load_dwordx4 v6, s[8:11], s38 offen  lds
  s_add_u32 m0, s39, 19456
  s_nop 0
  buffer_load_dwordx4 v7, s[8:11], s38 offen  lds
  s_waitcnt vmcnt(4)
  s_barrier
  s_movk_i32 s38, 3584
  s_add_u32 m0, s39, 32768
  s_nop 0
  buffer_load_dwordx4 v4, s[8:11], s38 offen  lds
  s_add_u32 m0, s39, 33792
  s_nop 0
  buffer_load_dwordx4 v5, s[8:11], s38 offen  lds
  s_add_u32 m0, s39, 34816
  s_nop 0
  buffer_load_dwordx4 v6, s[8:11], s38 offen  lds
  s_add_u32 m0, s39, 35840
  s_nop 0
  buffer_load_dwordx4 v7, s[8:11], s38 offen  lds
  s_waitcnt vmcnt(4)
  s_barrier
  s_movk_i32 s38, 3840
  s_add_u32 m0, s39, 49152
  s_nop 0
  buffer_load_dwordx4 v4, s[8:11], s38 offen  lds
  s_add_u32 m0, s39, 50176
  s_nop 0
  buffer_load_dwordx4 v5, s[8:11], s38 offen  lds
  s_add_u32 m0, s39, 51200
  s_nop 0
  buffer_load_dwordx4 v6, s[8:11], s38 offen  lds
  s_add_u32 m0, s39, 52224
  s_nop 0
  buffer_load_dwordx4 v7, s[8:11], s38 offen  lds
  s_waitcnt vmcnt(4)
  s_barrier
  s_waitcnt vmcnt(0)
  s_barrier
  s_barrier
  s_barrier
  s_barrier
  s_barrier
  v_lshlrev_b32 v4, 4, v1
  s_mul_i32 s35, s33, 122880
  s_lshl_b32 s40, s55, 10
  s_add_u32 s35, s35, s40
  s_add_u32 s35, s35, 15728640
  s_mul_i32 s36, s55, 5120
  s_sleep 4
  s_add_u32 m0, s36, 0
  s_add_u32 s40, s35, 0
  buffer_load_dwordx4 v4, s[16:19], s40 offen sc1 lds
  s_add_u32 m0, s36, 1024
  s_add_u32 s40, s35, 24576
  buffer_load_dwordx4 v4, s[16:19], s40 offen sc1 lds
  s_add_u32 m0, s36, 2048
  s_add_u32 s40, s35, 49152
  buffer_load_dwordx4 v4, s[16:19], s40 offen sc1 lds
  s_add_u32 m0, s36, 3072
  s_add_u32 s40, s35, 73728
  buffer_load_dwordx4 v4, s[16:19], s40 offen sc1 lds
  s_add_u32 m0, s36, 4096
  s_add_u32 s40, s35, 98304
  buffer_load_dwordx4 v4, s[16:19], s40 offen sc1 lds
  s_add_u32 m0, s36, 61440
  s_add_u32 s40, s35, 12288
  buffer_load_dwordx4 v4, s[16:19], s40 offen sc1 lds
  s_add_u32 m0, s36, 62464
  s_add_u32 s40, s35, 36864
  buffer_load_dwordx4 v4, s[16:19], s40 offen sc1 lds
  s_add_u32 m0, s36, 63488
  s_add_u32 s40, s35, 61440
  buffer_load_dwordx4 v4, s[16:19], s40 offen sc1 lds
  s_add_u32 m0, s36, 64512
  s_add_u32 s40, s35, 86016
  buffer_load_dwordx4 v4, s[16:19], s40 offen sc1 lds
  s_add_u32 m0, s36, 65536
  s_add_u32 s40, s35, 110592
  buffer_load_dwordx4 v4, s[16:19], s40 offen sc1 lds
  s_add_u32 m0, s36, 20480
  s_add_u32 s40, s35, 4096
  buffer_load_dwordx4 v4, s[16:19], s40 offen sc1 lds
  s_add_u32 m0, s36, 21504
  s_add_u32 s40, s35, 28672
  buffer_load_dwordx4 v4, s[16:19], s40 offen sc1 lds
  s_add_u32 m0, s36, 22528
  s_add_u32 s40, s35, 53248
  buffer_load_dwordx4 v4, s[16:19], s40 offen sc1 lds
  s_add_u32 m0, s36, 23552
  s_add_u32 s40, s35, 77824
  buffer_load_dwordx4 v4, s[16:19], s40 offen sc1 lds
  s_add_u32 m0, s36, 24576
  s_add_u32 s40, s35, 102400
  buffer_load_dwordx4 v4, s[16:19], s40 offen sc1 lds
  s_add_u32 m0, s36, 81920
  s_add_u32 s40, s35, 16384
  buffer_load_dwordx4 v4, s[16:19], s40 offen sc1 lds
  s_add_u32 m0, s36, 82944
  s_add_u32 s40, s35, 40960
  buffer_load_dwordx4 v4, s[16:19], s40 offen sc1 lds
  s_add_u32 m0, s36, 83968
  s_add_u32 s40, s35, 65536
  buffer_load_dwordx4 v4, s[16:19], s40 offen sc1 lds
  s_add_u32 m0, s36, 84992
  s_add_u32 s40, s35, 90112
  buffer_load_dwordx4 v4, s[16:19], s40 offen sc1 lds
  s_add_u32 m0, s36, 86016
  s_add_u32 s40, s35, 114688
  buffer_load_dwordx4 v4, s[16:19], s40 offen sc1 lds
  s_add_u32 m0, s36, 40960
  s_add_u32 s40, s35, 8192
  buffer_load_dwordx4 v4, s[16:19], s40 offen sc1 lds
  s_add_u32 m0, s36, 41984
  s_add_u32 s40, s35, 32768
  buffer_load_dwordx4 v4, s[16:19], s40 offen sc1 lds
  s_add_u32 m0, s36, 43008
  s_add_u32 s40, s35, 57344
  buffer_load_dwordx4 v4, s[16:19], s40 offen sc1 lds
  s_add_u32 m0, s36, 44032
  s_add_u32 s40, s35, 81920
  buffer_load_dwordx4 v4, s[16:19], s40 offen sc1 lds
  s_add_u32 m0, s36, 45056
  s_add_u32 s40, s35, 106496
  buffer_load_dwordx4 v4, s[16:19], s40 offen sc1 lds
  s_add_u32 m0, s36, 102400
  s_add_u32 s40, s35, 20480
  buffer_load_dwordx4 v4, s[16:19], s40 offen sc1 lds
  s_add_u32 m0, s36, 103424
  s_add_u32 s40, s35, 45056
  buffer_load_dwordx4 v4, s[16:19], s40 offen sc1 lds
  s_add_u32 m0, s36, 104448
  s_add_u32 s40, s35, 69632
  buffer_load_dwordx4 v4, s[16:19], s40 offen sc1 lds
  s_add_u32 m0, s36, 105472
  s_add_u32 s40, s35, 94208
  buffer_load_dwordx4 v4, s[16:19], s40 offen sc1 lds
  s_add_u32 m0, s36, 106496
  s_add_u32 s40, s35, 118784
  buffer_load_dwordx4 v4, s[16:19], s40 offen sc1 lds
  s_barrier
  s_waitcnt vmcnt(20)
  s_barrier
  s_cmp_eq_u32 s34, 8
  s_cbranch_scc0 F3_NOYP
  s_load_dwordx2 s[72:73], s[0:1], 104
  s_lshl_b32 s75, s33, 7
  s_add_u32 s75, s75, 17040384
  s_waitcnt lgkmcnt(0)
  s_add_u32 s74, s75, 0
  s_mov_b32 s42, 0
SP_F2Aa:
  s_load_dwordx16 s[56:71], s[72:73], s74 glc
  s_waitcnt lgkmcnt(0)
  s_and_b64 s[56:57], s[56:57], s[64:65]
  s_and_b64 s[58:59], s[58:59], s[66:67]
  s_and_b64 s[60:61], s[60:61], s[68:69]
  s_and_b64 s[62:63], s[62:63], s[70:71]
  s_and_b64 s[56:57], s[56:57], s[60:61]
  s_and_b64 s[58:59], s[58:59], s[62:63]
  s_and_b64 s[56:57], s[56:57], s[58:59]
  s_and_b32 s56, s56, s57
  s_add_u32 s42, s42, 1
  s_cmp_eq_u32 s56, 1
  s_cbranch_scc1 SP_F2Aa_OK
  s_cmp_lt_u32 s42, 2097152
  s_cbranch_scc1 SP_F2Aa
SP_F2Aa_OK:
  s_add_u32 s74, s75, 64
  s_mov_b32 s42, 0
SP_F2Ab:
  s_load_dwordx16 s[56:71], s[72:73], s74 glc
  s_waitcnt lgkmcnt(0)
  s_and_b64 s[56:57], s[56:57], s[64:65]
  s_and_b64 s[58:59], s[58:59], s[66:67]
  s_and_b64 s[60:61], s[60:61], s[68:69]
  s_and_b64 s[62:63], s[62:63], s[70:71]
  s_and_b64 s[56:57], s[56:57], s[60:61]
  s_and_b64 s[58:59], s[58:59], s[62:63]
  s_and_b64 s[56:57], s[56:57], s[58:59]
  s_and_b32 s56, s56, s57
  s_add_u32 s42, s42, 1
  s_cmp_eq_u32 s56, 1
  s_cbranch_scc1 SP_F2Ab_OK
  s_cmp_lt_u32 s42, 2097152
  s_cbranch_scc1 SP_F2Ab
SP_F2Ab_OK:
F3_NOYP:
  s_waitcnt vmcnt(10)
  s_barrier
  s_waitcnt vmcnt(0)
  s_barrier
  s_barrier
  s_barrier
  s_barrier
  s_endpgm
K1_AB:
  v_lshrrev_b32 v17, 1, v3
  v_xor_b32 v17, v17, v2
  v_lshlrev_b32 v17, 4, v17
  v_lshlrev_b32 v18, 7, v3
  v_add_u32 v17, v17, v18
  v_xor_b32 v18, 64, v17
  s_lshl_b32 s40, s35, 12
  s_lshl_b32 s41, s36, 11
  s_add_u32 s42, s40, s41
  s_add_u32 s42, s42, 61440
  v_add_u32 v4, s42, v17
  v_add_u32 v5, s42, v18
  s_xor_b32 s41, s41, 2048
  s_add_u32 s42, s40, s41
  s_add_u32 s42, s42, 61440
  v_add_u32 v6, s42, v17
  v_add_u32 v7, s42, v18
  v_lshrrev_b32 v17, 2, v1
  v_and_b32 v17, 3, v17
  v_lshlrev_b32 v18, 3, v2
  v_add_u32 v17, v17, v18
  v_mul_u32_u24 v17, 192, v17
  v_and_b32 v18, 3, v1
  v_lshlrev_b32 v18, 3, v18
  v_add_u32 v17, v17, v18
  v_and_b32 v19, 1, v2
  s_mul_i32 s40, s36, 3
  s_add_u32 s41, s40, 0
  v_xor_b32 v18, s41, v19
  v_lshlrev_b32 v18, 5, v18
  v_add_u32 v8, v17, v18
  s_add_u32 s41, s40, 1
  v_xor_b32 v18, s41, v19
  v_lshlrev_b32 v18, 5, v18
  v_add_u32 v9, v17, v18
  s_add_u32 s41, s40, 2
  v_xor_b32 v18, s41, v19
  v_lshlrev_b32 v18, 5, v18
  v_add_u32 v10, v17, v18
  s_mov_b32 s48, 0xbdd2d3e8
  s_mov_b32 s49, 0xbdd2d3e8
  s_mov_b32 s50, 1.0
  s_mov_b32 s51, 1.0
  s_waitcnt lgkmcnt(0)
  s_mov_b32 s16, s70
  s_and_b32 s17, s71, 0xffff
  s_mov_b32 s18, 18874368
  s_mov_b32 s19, 0x20000
  s_mov_b32 s4, s68
  s_and_b32 s5, s69, 0xffff
  s_mov_b32 s6, 256
  s_mov_b32 s7, 0x20000
  s_cmp_ge_u32 s34, 4
  s_cbranch_scc1 K1_B
  v_mov_b32 v102, 0x3f803f80
  v_mov_b32 v103, 0x3f803f80
  v_mov_b32 v104, 0x3f803f80
  v_mov_b32 v105, 0x3f803f80
  v_mov_b32 v66, 0
  v_mov_b32 v67, 0
  v_mov_b32 v68, 0
  v_mov_b32 v69, 0
  v_mov_b32 v70, 0
  v_mov_b32 v71, 0
  v_mov_b32 v72, 0
  v_mov_b32 v73, 0
  v_mov_b32 v74, 0
  v_mov_b32 v75, 0
  v_mov_b32 v76, 0
  v_mov_b32 v77, 0
  v_mov_b32 v78, 0
  v_mov_b32 v79, 0
  v_mov_b32 v80, 0
  v_mov_b32 v81, 0
  v_mov_b32 v82, 0
  v_mov_b32 v83, 0
  v_mov_b32 v84, 0
  v_mov_b32 v85, 0
  v_mov_b32 v86, 0
  v_mov_b32 v87, 0
  v_mov_b32 v88, 0
  v_mov_b32 v89, 0
  v_mov_b32 v90, 0
  v_mov_b32 v91, 0
  v_mov_b32 v92, 0
  v_mov_b32 v93, 0
  v_mov_b32 v94, 0
  v_mov_b32 v95, 0
  v_mov_b32 v96, 0
  v_mov_b32 v97, 0
  v_mov_b32 v98, 0
  v_mov_b32 v99, 0
  v_mov_b32 v100, 0
  v_mov_b32 v101, 0
  v_mov_b32 v106, 0
  v_mov_b32 v107, 0
  v_mov_b32 v108, 0
  v_mov_b32 v109, 0
  v_mov_b32 v110, 0
  v_mov_b32 v111, 0
  v_mov_b32 v112, 0
  v_mov_b32 v113, 0
  s_barrier
  s_mov_b32 s37, 0
  ds_read_b128 v[26:29], v4 offset:0
  ds_read_b64_tr_b16 v[42:43], v8 offset:0
  ds_read_b64_tr_b16 v[44:45], v8 offset:768
  ds_read_b128 v[30:33], v6 offset:0
  ds_read_b64_tr_b16 v[46:47], v9 offset:0
  ds_read_b64_tr_b16 v[48:49], v9 offset:768
  ds_read_b64_tr_b16 v[50:51], v10 offset:0
  ds_read_b64_tr_b16 v[52:53], v10 offset:768
K1_LOOP1:
  s_waitcnt lgkmcnt(0)
  v_mfma_f32_16x16x32_bf16 v[66:69], v[26:29], v[42:45], v[66:69]
  ds_read_b128 v[34:37], v5 offset:0
  ds_read_b64_tr_b16 v[54:55], v8 offset:6144
  v_mfma_f32_16x16x32_bf16 v[78:81], v[30:33], v[42:45], v[78:81]
  ds_read_b64_tr_b16 v[56:57], v8 offset:6912
  ds_read_b128 v[38:41], v7 offset:0
  v_mfma_f32_16x16x32_bf16 v[70:73], v[26:29], v[46:49], v[70:73]
  ds_read_b64_tr_b16 v[58:59], v9 offset:6144
  ds_read_b64_tr_b16 v[60:61], v9 offset:6912
  v_mfma_f32_16x16x32_bf16 v[82:85], v[30:33], v[46:49], v[82:85]
  ds_read_b64_tr_b16 v[62:63], v10 offset:6144
  ds_read_b64_tr_b16 v[64:65], v10 offset:6912
  v_mfma_f32_16x16x32_bf16 v[74:77], v[26:29], v[50:53], v[74:77]
  v_mfma_f32_16x16x32_bf16 v[86:89], v[30:33], v[50:53], v[86:89]
  v_mfma_f32_16x16x32_bf16 v[106:109], v[102:105], v[26:29], v[106:109]
  v_mfma_f32_16x16x32_bf16 v[110:113], v[26:29], v[26:29], v[110:113]
  s_cmp_eq_u32 s35, 0
  s_cbranch_scc0 K1_SK_1a0
  v_mfma_f32_16x16x32_bf16 v[90:93], v[102:105], v[42:45], v[90:93]
  v_mfma_f32_16x16x32_bf16 v[94:97], v[102:105], v[46:49], v[94:97]
  v_mfma_f32_16x16x32_bf16 v[98:101], v[102:105], v[50:53], v[98:101]
K1_SK_1a0:
  s_waitcnt lgkmcnt(0)
  s_barrier
  v_mfma_f32_16x16x32_bf16 v[66:69], v[34:37], v[54:57], v[66:69]
  ds_read_b128 v[26:29], v4 offset:8192
  ds_read_b64_tr_b16 v[42:43], v8 offset:12288
  v_mfma_f32_16x16x32_bf16 v[78:81], v[38:41], v[54:57], v[78:81]
  ds_read_b64_tr_b16 v[44:45], v8 offset:13056
  ds_read_b128 v[30:33], v6 offset:8192
  v_mfma_f32_16x16x32_bf16 v[70:73], v[34:37], v[58:61], v[70:73]
  ds_read_b64_tr_b16 v[46:47], v9 offset:12288
  ds_read_b64_tr_b16 v[48:49], v9 offset:13056
  v_mfma_f32_16x16x32_bf16 v[82:85], v[38:41], v[58:61], v[82:85]
  ds_read_b64_tr_b16 v[50:51], v10 offset:12288
  ds_read_b64_tr_b16 v[52:53], v10 offset:13056
  v_mfma_f32_16x16x32_bf16 v[74:77], v[34:37], v[62:65], v[74:77]
  v_mfma_f32_16x16x32_bf16 v[86:89], v[38:41], v[62:65], v[86:89]
  v_mfma_f32_16x16x32_bf16 v[106:109], v[102:105], v[34:37], v[106:109]
  v_mfma_f32_16x16x32_bf16 v[110:113], v[34:37], v[34:37], v[110:113]
  s_cmp_eq_u32 s35, 1
  s_cbranch_scc0 K1_SK_1b0
  v_mfma_f32_16x16x32_bf16 v[90:93], v[102:105], v[54:57], v[90:93]
  v_mfma_f32_16x16x32_bf16 v[94:97], v[102:105], v[58:61], v[94:97]
  v_mfma_f32_16x16x32_bf16 v[98:101], v[102:105], v[62:65], v[98:101]
K1_SK_1b0:
  s_waitcnt lgkmcnt(0)
  v_mfma_f32_16x16x32_bf16 v[66:69], v[26:29], v[42:45], v[66:69]
  ds_read_b128 v[34:37], v5 offset:8192
  ds_read_b64_tr_b16 v[54:55], v8 offset:18432
  v_mfma_f32_16x16x32_bf16 v[78:81], v[30:33], v[42:45], v[78:81]
  ds_read_b64_tr_b16 v[56:57], v8 offset:19200
  ds_read_b128 v[38:41], v7 offset:8192
  v_mfma_f32_16x16x32_bf16 v[70:73], v[26:29], v[46:49], v[70:73]
  ds_read_b64_tr_b16 v[58:59], v9 offset:18432
  ds_read_b64_tr_b16 v[60:61], v9 offset:19200
  v_mfma_f32_16x16x32_bf16 v[82:85], v[30:33], v[46:49], v[82:85]
  ds_read_b64_tr_b16 v[62:63], v10 offset:18432
  ds_read_b64_tr_b16 v[64:65], v10 offset:19200
  v_mfma_f32_16x16x32_bf16 v[74:77], v[26:29], v[50:53], v[74:77]
  v_mfma_f32_16x16x32_bf16 v[86:89], v[30:33], v[50:53], v[86:89]
  v_mfma_f32_16x16x32_bf16 v[106:109], v[102:105], v[26:29], v[106:109]
  v_mfma_f32_16x16x32_bf16 v[110:113], v[26:29], v[26:29], v[110:113]
  s_cmp_eq_u32 s35, 0
  s_cbranch_scc0 K1_SK_1a1
  v_mfma_f32_16x16x32_bf16 v[90:93], v[102:105], v[42:45], v[90:93]
  v_mfma_f32_16x16x32_bf16 v[94:97], v[102:105], v[46:49], v[94:97]
  v_mfma_f32_16x16x32_bf16 v[98:101], v[102:105], v[50:53], v[98:101]
K1_SK_1a1:
  s_waitcnt lgkmcnt(0)
  s_barrier
  v_mfma_f32_16x16x32_bf16 v[66:69], v[34:37], v[54:57], v[66:69]
  ds_read_b128 v[26:29], v4 offset:16384
  ds_read_b64_tr_b16 v[42:43], v8 offset:24576
  v_mfma_f32_16x16x32_bf16 v[78:81], v[38:41], v[54:57], v[78:81]
  ds_read_b64_tr_b16 v[44:45], v8 offset:25344
  ds_read_b128 v[30:33], v6 offset:16384
  v_mfma_f32_16x16x32_bf16 v[70:73], v[34:37], v[58:61], v[70:73]
  ds_read_b64_tr_b16 v[46:47], v9 offset:24576
  ds_read_b64_tr_b16 v[48:49], v9 offset:25344
  v_mfma_f32_16x16x32_bf16 v[82:85], v[38:41], v[58:61], v[82:85]
  ds_read_b64_tr_b16 v[50:51], v10 offset:24576
  ds_read_b64_tr_b16 v[52:53], v10 offset:25344
  v_mfma_f32_16x16x32_bf16 v[74:77], v[34:37], v[62:65], v[74:77]
  v_mfma_f32_16x16x32_bf16 v[86:89], v[38:41], v[62:65], v[86:89]
  v_mfma_f32_16x16x32_bf16 v[106:109], v[102:105], v[34:37], v[106:109]
  v_mfma_f32_16x16x32_bf16 v[110:113], v[34:37], v[34:37], v[110:113]
  s_cmp_eq_u32 s35, 1
  s_cbranch_scc0 K1_SK_1b1
  v_mfma_f32_16x16x32_bf16 v[90:93], v[102:105], v[54:57], v[90:93]
  v_mfma_f32_16x16x32_bf16 v[94:97], v[102:105], v[58:61], v[94:97]
  v_mfma_f32_16x16x32_bf16 v[98:101], v[102:105], v[62:65], v[98:101]
K1_SK_1b1:
  s_waitcnt lgkmcnt(0)
  v_mfma_f32_16x16x32_bf16 v[66:69], v[26:29], v[42:45], v[66:69]
  ds_read_b128 v[34:37], v5 offset:16384
  ds_read_b64_tr_b16 v[54:55], v8 offset:30720
  v_mfma_f32_16x16x32_bf16 v[78:81], v[30:33], v[42:45], v[78:81]
  ds_read_b64_tr_b16 v[56:57], v8 offset:31488
  ds_read_b128 v[38:41], v7 offset:16384
  v_mfma_f32_16x16x32_bf16 v[70:73], v[26:29], v[46:49], v[70:73]
  ds_read_b64_tr_b16 v[58:59], v9 offset:30720
  ds_read_b64_tr_b16 v[60:61], v9 offset:31488
  v_mfma_f32_16x16x32_bf16 v[82:85], v[30:33], v[46:49], v[82:85]
  ds_read_b64_tr_b16 v[62:63], v10 offset:30720
  ds_read_b64_tr_b16 v[64:65], v10 offset:31488
  v_mfma_f32_16x16x32_bf16 v[74:77], v[26:29], v[50:53], v[74:77]
  v_mfma_f32_16x16x32_bf16 v[86:89], v[30:33], v[50:53], v[86:89]
  v_mfma_f32_16x16x32_bf16 v[106:109], v[102:105], v[26:29], v[106:109]
  v_mfma_f32_16x16x32_bf16 v[110:113], v[26:29], v[26:29], v[110:113]
  s_cmp_eq_u32 s35, 0
  s_cbranch_scc0 K1_SK_1a2
  v_mfma_f32_16x16x32_bf16 v[90:93], v[102:105], v[42:45], v[90:93]
  v_mfma_f32_16x16x32_bf16 v[94:97], v[102:105], v[46:49], v[94:97]
  v_mfma_f32_16x16x32_bf16 v[98:101], v[102:105], v[50:53], v[98:101]
K1_SK_1a2:
  s_waitcnt lgkmcnt(0)
  s_barrier
  v_mfma_f32_16x16x32_bf16 v[66:69], v[34:37], v[54:57], v[66:69]
  ds_read_b128 v[26:29], v4 offset:24576
  ds_read_b64_tr_b16 v[42:43], v8 offset:36864
  v_mfma_f32_16x16x32_bf16 v[78:81], v[38:41], v[54:57], v[78:81]
  ds_read_b64_tr_b16 v[44:45], v8 offset:37632
  ds_read_b128 v[30:33], v6 offset:24576
  v_mfma_f32_16x16x32_bf16 v[70:73], v[34:37], v[58:61], v[70:73]
  ds_read_b64_tr_b16 v[46:47], v9 offset:36864
  ds_read_b64_tr_b16 v[48:49], v9 offset:37632
  v_mfma_f32_16x16x32_bf16 v[82:85], v[38:41], v[58:61], v[82:85]
  ds_read_b64_tr_b16 v[50:51], v10 offset:36864
  ds_read_b64_tr_b16 v[52:53], v10 offset:37632
  v_mfma_f32_16x16x32_bf16 v[74:77], v[34:37], v[62:65], v[74:77]
  v_mfma_f32_16x16x32_bf16 v[86:89], v[38:41], v[62:65], v[86:89]
  v_mfma_f32_16x16x32_bf16 v[106:109], v[102:105], v[34:37], v[106:109]
  v_mfma_f32_16x16x32_bf16 v[110:113], v[34:37], v[34:37], v[110:113]
  s_cmp_eq_u32 s35, 1
  s_cbranch_scc0 K1_SK_1b2
  v_mfma_f32_16x16x32_bf16 v[90:93], v[102:105], v[54:57], v[90:93]
  v_mfma_f32_16x16x32_bf16 v[94:97], v[102:105], v[58:61], v[94:97]
  v_mfma_f32_16x16x32_bf16 v[98:101], v[102:105], v[62:65], v[98:101]
K1_SK_1b2:
  s_waitcnt lgkmcnt(0)
  v_mfma_f32_16x16x32_bf16 v[66:69], v[26:29], v[42:45], v[66:69]
  ds_read_b128 v[34:37], v5 offset:24576
  ds_read_b64_tr_b16 v[54:55], v8 offset:43008
  v_mfma_f32_16x16x32_bf16 v[78:81], v[30:33], v[42:45], v[78:81]
  ds_read_b64_tr_b16 v[56:57], v8 offset:43776
  ds_read_b128 v[38:41], v7 offset:24576
  v_mfma_f32_16x16x32_bf16 v[70:73], v[26:29], v[46:49], v[70:73]
  ds_read_b64_tr_b16 v[58:59], v9 offset:43008
  ds_read_b64_tr_b16 v[60:61], v9 offset:43776
  v_mfma_f32_16x16x32_bf16 v[82:85], v[30:33], v[46:49], v[82:85]
  ds_read_b64_tr_b16 v[62:63], v10 offset:43008
  ds_read_b64_tr_b16 v[64:65], v10 offset:43776
  v_mfma_f32_16x16x32_bf16 v[74:77], v[26:29], v[50:53], v[74:77]
  v_mfma_f32_16x16x32_bf16 v[86:89], v[30:33], v[50:53], v[86:89]
  v_mfma_f32_16x16x32_bf16 v[106:109], v[102:105], v[26:29], v[106:109]
  v_mfma_f32_16x16x32_bf16 v[110:113], v[26:29], v[26:29], v[110:113]
  s_cmp_eq_u32 s35, 0
  s_cbranch_scc0 K1_SK_1a3
  v_mfma_f32_16x16x32_bf16 v[90:93], v[102:105], v[42:45], v[90:93]
  v_mfma_f32_16x16x32_bf16 v[94:97], v[102:105], v[46:49], v[94:97]
  v_mfma_f32_16x16x32_bf16 v[98:101], v[102:105], v[50:53], v[98:101]
K1_SK_1a3:
  s_waitcnt lgkmcnt(0)
  s_barrier
  v_mfma_f32_16x16x32_bf16 v[66:69], v[34:37], v[54:57], v[66:69]
  ds_read_b128 v[26:29], v4 offset:32768
  ds_read_b64_tr_b16 v[42:43], v8 offset:49152
  v_mfma_f32_16x16x32_bf16 v[78:81], v[38:41], v[54:57], v[78:81]
  ds_read_b64_tr_b16 v[44:45], v8 offset:49920
  ds_read_b128 v[30:33], v6 offset:32768
  v_mfma_f32_16x16x32_bf16 v[70:73], v[34:37], v[58:61], v[70:73]
  ds_read_b64_tr_b16 v[46:47], v9 offset:49152
  ds_read_b64_tr_b16 v[48:49], v9 offset:49920
  v_mfma_f32_16x16x32_bf16 v[82:85], v[38:41], v[58:61], v[82:85]
  ds_read_b64_tr_b16 v[50:51], v10 offset:49152
  ds_read_b64_tr_b16 v[52:53], v10 offset:49920
  v_mfma_f32_16x16x32_bf16 v[74:77], v[34:37], v[62:65], v[74:77]
  v_mfma_f32_16x16x32_bf16 v[86:89], v[38:41], v[62:65], v[86:89]
  v_mfma_f32_16x16x32_bf16 v[106:109], v[102:105], v[34:37], v[106:109]
  v_mfma_f32_16x16x32_bf16 v[110:113], v[34:37], v[34:37], v[110:113]
  s_cmp_eq_u32 s35, 1
  s_cbranch_scc0 K1_SK_1b3
  v_mfma_f32_16x16x32_bf16 v[90:93], v[102:105], v[54:57], v[90:93]
  v_mfma_f32_16x16x32_bf16 v[94:97], v[102:105], v[58:61], v[94:97]
  v_mfma_f32_16x16x32_bf16 v[98:101], v[102:105], v[62:65], v[98:101]
K1_SK_1b3:
  s_waitcnt lgkmcnt(0)
  v_mfma_f32_16x16x32_bf16 v[66:69], v[26:29], v[42:45], v[66:69]
  ds_read_b128 v[34:37], v5 offset:32768
  ds_read_b64_tr_b16 v[54:55], v8 offset:55296
  v_mfma_f32_16x16x32_bf16 v[78:81], v[30:33], v[42:45], v[78:81]
  ds_read_b64_tr_b16 v[56:57], v8 offset:56064
  ds_read_b128 v[38:41], v7 offset:32768
  v_mfma_f32_16x16x32_bf16 v[70:73], v[26:29], v[46:49], v[70:73]
  ds_read_b64_tr_b16 v[58:59], v9 offset:55296
  ds_read_b64_tr_b16 v[60:61], v9 offset:56064
  v_mfma_f32_16x16x32_bf16 v[82:85], v[30:33], v[46:49], v[82:85]
  ds_read_b64_tr_b16 v[62:63], v10 offset:55296
  ds_read_b64_tr_b16 v[64:65], v10 offset:56064
  v_mfma_f32_16x16x32_bf16 v[74:77], v[26:29], v[50:53], v[74:77]
  v_mfma_f32_16x16x32_bf16 v[86:89], v[30:33], v[50:53], v[86:89]
  v_mfma_f32_16x16x32_bf16 v[106:109], v[102:105], v[26:29], v[106:109]
  v_mfma_f32_16x16x32_bf16 v[110:113], v[26:29], v[26:29], v[110:113]
  s_cmp_eq_u32 s35, 0
  s_cbranch_scc0 K1_SK_1a4
  v_mfma_f32_16x16x32_bf16 v[90:93], v[102:105], v[42:45], v[90:93]
  v_mfma_f32_16x16x32_bf16 v[94:97], v[102:105], v[46:49], v[94:97]
  v_mfma_f32_16x16x32_bf16 v[98:101], v[102:105], v[50:53], v[98:101]
K1_SK_1a4:
  s_waitcnt lgkmcnt(0)
  s_barrier
  v_add_u32 v4, 40960, v4
  v_add_u32 v5, 40960, v5
  v_add_u32 v6, 40960, v6
  v_add_u32 v7, 40960, v7
  v_mfma_f32_16x16x32_bf16 v[66:69], v[34:37], v[54:57], v[66:69]
  ds_read_b128 v[26:29], v4 offset:0
  ds_read_b64_tr_b16 v[42:43], v8 offset:0
  v_mfma_f32_16x16x32_bf16 v[78:81], v[38:41], v[54:57], v[78:81]
  ds_read_b64_tr_b16 v[44:45], v8 offset:768
  ds_read_b128 v[30:33], v6 offset:0
  v_mfma_f32_16x16x32_bf16 v[70:73], v[34:37], v[58:61], v[70:73]
  ds_read_b64_tr_b16 v[46:47], v9 offset:0
  ds_read_b64_tr_b16 v[48:49], v9 offset:768
  v_mfma_f32_16x16x32_bf16 v[82:85], v[38:41], v[58:61], v[82:85]
  ds_read_b64_tr_b16 v[50:51], v10 offset:0
  ds_read_b64_tr_b16 v[52:53], v10 offset:768
  v_mfma_f32_16x16x32_bf16 v[74:77], v[34:37], v[62:65], v[74:77]
  v_mfma_f32_16x16x32_bf16 v[86:89], v[38:41], v[62:65], v[86:89]
  v_mfma_f32_16x16x32_bf16 v[106:109], v[102:105], v[34:37], v[106:109]
  v_mfma_f32_16x16x32_bf16 v[110:113], v[34:37], v[34:37], v[110:113]
  s_cmp_eq_u32 s35, 1
  s_cbranch_scc0 K1_SK_1b4
  v_mfma_f32_16x16x32_bf16 v[90:93], v[102:105], v[54:57], v[90:93]
  v_mfma_f32_16x16x32_bf16 v[94:97], v[102:105], v[58:61], v[94:97]
  v_mfma_f32_16x16x32_bf16 v[98:101], v[102:105], v[62:65], v[98:101]
K1_SK_1b4:
  s_add_u32 s37, s37, 1
  s_cmp_lt_u32 s37, 2
  s_cbranch_scc1 K1_LOOP1
  s_setprio 2
  s_lshl_b32 s40, s32, 2
  v_mov_b32 v22, s40
  v_and_b32 v14, 3, v3
  v_cmp_eq_u32 vcc, 1, v14
  s_nop 1
  v_cndmask_b32 v110, v110, v111, vcc
  v_cmp_eq_u32 vcc, 2, v14
  s_nop 1
  v_cndmask_b32 v110, v110, v112, vcc
  v_cmp_eq_u32 vcc, 3, v14
  s_nop 1
  v_cndmask_b32 v110, v110, v113, vcc
  v_mul_f32 v16, 0x3acccccd, v106
  v_mul_f32 v18, 0x3acccccd, v110
  v_fma_f32 v18, -v16, v16, v18
  v_max_f32 v18, 0, v18
  v_cvt_pk_bf16_f32 v16, v16, v16
  v_lshlrev_b32 v16, 16, v16
  v_cvt_pk_bf16_f32 v18, v18, v18
  v_lshlrev_b32 v18, 16, v18
  v_add_f32 v18, 0x3727c5ac, v18
  v_cvt_pk_bf16_f32 v18, v18, v18
  v_lshlrev_b32 v18, 16, v18
  v_sqrt_f32 v18, v18
  s_nop 0
  v_cvt_pk_bf16_f32 v18, v18, v18
  v_lshlrev_b32 v18, 16, v18
  v_rcp_f32 v17, v18
  s_lshl_b32 s40, s35, 5
  s_lshl_b32 s41, s36, 4
  s_add_u32 s40, s40, s41
  v_add_u32 v18, s40, v3
  v_lshlrev_b32 v19, 2, v18
  v_add_u32 v19, 143360, v19
  s_mov_b32 exec_lo, 0xf0000f
  s_mov_b32 exec_hi, 0xf0000f00
  ds_write_b32 v19, v16
  ds_write_b32 v19, v17 offset:256
  s_branch K1_NOST1X
  s_cmp_eq_u32 s33, 0
  s_cbranch_scc0 K1_NOST1X
  s_lshl_b32 s41, s32, 9
  s_add_u32 s41, s41, 16777216
  v_lshlrev_b32 v18, 3, v18
  buffer_store_dwordx2 v[16:17], v18, s[16:19], s41 offen sc1
K1_NOST1X:
  s_mov_b64 exec, s[52:53]
  s_mul_i32 s40, s55, 192
  s_add_u32 s40, s40, 143872
  v_lshlrev_b32 v20, 2, v3
  v_add_u32 v20, s40, v20
  ds_write_b32 v20, v90 offset:0
  ds_write_b32 v20, v94 offset:64
  ds_write_b32 v20, v98 offset:128
  s_waitcnt lgkmcnt(0)
  s_barrier
  s_xor_b32 s41, s55, 2
  s_mul_i32 s41, s41, 192
  s_add_u32 s41, s41, 143872
  v_lshlrev_b32 v18, 2, v3
  v_add_u32 v18, s41, v18
  ds_read_b32 v136, v18 offset:0
  ds_read_b32 v138, v18 offset:64
  ds_read_b32 v140, v18 offset:128
  s_lshl_b32 s40, s35, 7
  s_lshl_b32 s41, s36, 6
  s_add_u32 s40, s40, s41
  s_add_u32 s40, s40, 143360
  v_lshlrev_b32 v19, 4, v2
  v_add_u32 v19, s40, v19
  v_xor_b32 v20, 64, v19
  ds_read_b128 v[26:29], v19
  ds_read_b128 v[30:33], v20
  ds_read_b128 v[34:37], v19 offset:256
  ds_read_b128 v[38:41], v20 offset:256
  v_mov_b32 v126, 0xc0135761
  v_mov_b32 v127, 0xc0135761
  v_mov_b32 v42, 0
  v_mov_b32 v43, 0
  v_mov_b32 v44, 0
  v_mov_b32 v45, 0
  v_mov_b32 v46, 0
  v_mov_b32 v47, 0
  v_mov_b32 v48, 0
  v_mov_b32 v49, 0
  v_mov_b32 v50, 0
  v_mov_b32 v51, 0
  v_mov_b32 v52, 0
  v_mov_b32 v53, 0
  v_mov_b32 v54, 0
  v_mov_b32 v55, 0
  v_mov_b32 v56, 0
  v_mov_b32 v57, 0
  s_waitcnt lgkmcnt(0)
  v_add_f32 v136, v136, v90
  v_sub_f32 v136, 0, v136
  v_add_f32 v138, v138, v94
  v_sub_f32 v138, 0, v138
  v_add_f32 v140, v140, v98
  v_sub_f32 v140, 0, v140
  v_fma_f32 v66, v26, v136, v66
  v_fma_f32 v67, v27, v136, v67
  v_mul_f32 v66, v66, v34
  v_mul_f32 v67, v67, v35
  v_mul_f32 v128, v66, v66
  v_mul_f32 v129, v67, v67
  v_fma_f32 v128, v128, s48, v126
  v_fma_f32 v129, v129, s48, v126
  v_mul_f32 v128, v128, v66
  v_mul_f32 v129, v129, v67
  v_exp_f32 v128, v128
  v_exp_f32 v129, v129
  v_add_f32 v128, 1.0, v128
  v_add_f32 v129, 1.0, v129
  v_rcp_f32 v128, v128
  v_rcp_f32 v129, v129
  v_mul_f32 v128, v128, v66
  v_mul_f32 v129, v129, v67
  v_cvt_pk_bf16_f32 v114, v128, v129
  v_add_f32 v42, v42, v128
  v_add_f32 v43, v43, v129
  v_fma_f32 v50, v128, v128, v50
  v_fma_f32 v51, v129, v129, v51
  v_fma_f32 v68, v28, v136, v68
  v_fma_f32 v69, v29, v136, v69
  v_mul_f32 v68, v68, v36
  v_mul_f32 v69, v69, v37
  v_mul_f32 v132, v68, v68
  v_mul_f32 v133, v69, v69
  v_fma_f32 v132, v132, s48, v126
  v_fma_f32 v133, v133, s48, v126
  v_mul_f32 v132, v132, v68
  v_mul_f32 v133, v133, v69
  v_exp_f32 v132, v132
  v_exp_f32 v133, v133
  v_add_f32 v132, 1.0, v132
  v_add_f32 v133, 1.0, v133
  v_rcp_f32 v132, v132
  v_rcp_f32 v133, v133
  v_mul_f32 v132, v132, v68
  v_mul_f32 v133, v133, v69
  v_cvt_pk_bf16_f32 v115, v132, v133
  v_add_f32 v44, v44, v132
  v_add_f32 v45, v45, v133
  v_fma_f32 v52, v132, v132, v52
  v_fma_f32 v53, v133, v133, v53
  s_barrier
  v_fma_f32 v78, v30, v136, v78
  v_fma_f32 v79, v31, v136, v79
  v_mul_f32 v78, v78, v38
  v_mul_f32 v79, v79, v39
  v_mul_f32 v128, v78, v78
  v_mul_f32 v129, v79, v79
  v_fma_f32 v128, v128, s48, v126
  v_fma_f32 v129, v129, s48, v126
  v_mul_f32 v128, v128, v78
  v_mul_f32 v129, v129, v79
  v_exp_f32 v128, v128
  v_exp_f32 v129, v129
  v_add_f32 v128, 1.0, v128
  v_add_f32 v129, 1.0, v129
  v_rcp_f32 v128, v128
  v_rcp_f32 v129, v129
  v_mul_f32 v128, v128, v78
  v_mul_f32 v129, v129, v79
  v_cvt_pk_bf16_f32 v116, v128, v129
  v_add_f32 v46, v46, v128
  v_add_f32 v47, v47, v129
  v_fma_f32 v54, v128, v128, v54
  v_fma_f32 v55, v129, v129, v55
  v_fma_f32 v80, v32, v136, v80
  v_fma_f32 v81, v33, v136, v81
  v_mul_f32 v80, v80, v40
  v_mul_f32 v81, v81, v41
  v_mul_f32 v132, v80, v80
  v_mul_f32 v133, v81, v81
  v_fma_f32 v132, v132, s48, v126
  v_fma_f32 v133, v133, s48, v126
  v_mul_f32 v132, v132, v80
  v_mul_f32 v133, v133, v81
  v_exp_f32 v132, v132
  v_exp_f32 v133, v133
  v_add_f32 v132, 1.0, v132
  v_add_f32 v133, 1.0, v133
  v_rcp_f32 v132, v132
  v_rcp_f32 v133, v133
  v_mul_f32 v132, v132, v80
  v_mul_f32 v133, v133, v81
  v_cvt_pk_bf16_f32 v117, v132, v133
  v_add_f32 v48, v48, v132
  v_add_f32 v49, v49, v133
  v_fma_f32 v56, v132, v132, v56
  v_fma_f32 v57, v133, v133, v57
  v_fma_f32 v70, v26, v138, v70
  v_fma_f32 v71, v27, v138, v71
  v_mul_f32 v70, v70, v34
  v_mul_f32 v71, v71, v35
  v_mul_f32 v128, v70, v70
  v_mul_f32 v129, v71, v71
  v_fma_f32 v128, v128, s48, v126
  v_fma_f32 v129, v129, s48, v126
  v_mul_f32 v128, v128, v70
  v_mul_f32 v129, v129, v71
  v_exp_f32 v128, v128
  v_exp_f32 v129, v129
  v_add_f32 v128, 1.0, v128
  v_add_f32 v129, 1.0, v129
  v_rcp_f32 v128, v128
  v_rcp_f32 v129, v129
  v_mul_f32 v128, v128, v70
  v_mul_f32 v129, v129, v71
  v_cvt_pk_bf16_f32 v118, v128, v129
  v_add_f32 v42, v42, v128
  v_add_f32 v43, v43, v129
  v_fma_f32 v50, v128, v128, v50
  v_fma_f32 v51, v129, v129, v51
  s_barrier
  v_fma_f32 v72, v28, v138, v72
  v_fma_f32 v73, v29, v138, v73
  v_mul_f32 v72, v72, v36
  v_mul_f32 v73, v73, v37
  v_mul_f32 v132, v72, v72
  v_mul_f32 v133, v73, v73
  v_fma_f32 v132, v132, s48, v126
  v_fma_f32 v133, v133, s48, v126
  v_mul_f32 v132, v132, v72
  v_mul_f32 v133, v133, v73
  v_exp_f32 v132, v132
  v_exp_f32 v133, v133
  v_add_f32 v132, 1.0, v132
  v_add_f32 v133, 1.0, v133
  v_rcp_f32 v132, v132
  v_rcp_f32 v133, v133
  v_mul_f32 v132, v132, v72
  v_mul_f32 v133, v133, v73
  v_cvt_pk_bf16_f32 v119, v132, v133
  v_add_f32 v44, v44, v132
  v_add_f32 v45, v45, v133
  v_fma_f32 v52, v132, v132, v52
  v_fma_f32 v53, v133, v133, v53
  v_fma_f32 v82, v30, v138, v82
  v_fma_f32 v83, v31, v138, v83
  v_mul_f32 v82, v82, v38
  v_mul_f32 v83, v83, v39
  v_mul_f32 v128, v82, v82
  v_mul_f32 v129, v83, v83
  v_fma_f32 v128, v128, s48, v126
  v_fma_f32 v129, v129, s48, v126
  v_mul_f32 v128, v128, v82
  v_mul_f32 v129, v129, v83
  v_exp_f32 v128, v128
  v_exp_f32 v129, v129
  v_add_f32 v128, 1.0, v128
  v_add_f32 v129, 1.0, v129
  v_rcp_f32 v128, v128
  v_rcp_f32 v129, v129
  v_mul_f32 v128, v128, v82
  v_mul_f32 v129, v129, v83
  v_cvt_pk_bf16_f32 v120, v128, v129
  v_add_f32 v46, v46, v128
  v_add_f32 v47, v47, v129
  v_fma_f32 v54, v128, v128, v54
  v_fma_f32 v55, v129, v129, v55
  s_barrier
  v_fma_f32 v84, v32, v138, v84
  v_fma_f32 v85, v33, v138, v85
  v_mul_f32 v84, v84, v40
  v_mul_f32 v85, v85, v41
  v_mul_f32 v132, v84, v84
  v_mul_f32 v133, v85, v85
  v_fma_f32 v132, v132, s48, v126
  v_fma_f32 v133, v133, s48, v126
  v_mul_f32 v132, v132, v84
  v_mul_f32 v133, v133, v85
  v_exp_f32 v132, v132
  v_exp_f32 v133, v133
  v_add_f32 v132, 1.0, v132
  v_add_f32 v133, 1.0, v133
  v_rcp_f32 v132, v132
  v_rcp_f32 v133, v133
  v_mul_f32 v132, v132, v84
  v_mul_f32 v133, v133, v85
  v_cvt_pk_bf16_f32 v121, v132, v133
  v_add_f32 v48, v48, v132
  v_add_f32 v49, v49, v133
  v_fma_f32 v56, v132, v132, v56
  v_fma_f32 v57, v133, v133, v57
  v_fma_f32 v74, v26, v140, v74
  v_fma_f32 v75, v27, v140, v75
  v_mul_f32 v74, v74, v34
  v_mul_f32 v75, v75, v35
  v_mul_f32 v128, v74, v74
  v_mul_f32 v129, v75, v75
  v_fma_f32 v128, v128, s48, v126
  v_fma_f32 v129, v129, s48, v126
  v_mul_f32 v128, v128, v74
  v_mul_f32 v129, v129, v75
  v_exp_f32 v128, v128
  v_exp_f32 v129, v129
  v_add_f32 v128, 1.0, v128
  v_add_f32 v129, 1.0, v129
  v_rcp_f32 v128, v128
  v_rcp_f32 v129, v129
  v_mul_f32 v128, v128, v74
  v_mul_f32 v129, v129, v75
  v_cvt_pk_bf16_f32 v122, v128, v129
  v_add_f32 v42, v42, v128
  v_add_f32 v43, v43, v129
  v_fma_f32 v50, v128, v128, v50
  v_fma_f32 v51, v129, v129, v51
  v_fma_f32 v76, v28, v140, v76
  v_fma_f32 v77, v29, v140, v77
  v_mul_f32 v76, v76, v36
  v_mul_f32 v77, v77, v37
  v_mul_f32 v132, v76, v76
  v_mul_f32 v133, v77, v77
  v_fma_f32 v132, v132, s48, v126
  v_fma_f32 v133, v133, s48, v126
  v_mul_f32 v132, v132, v76
  v_mul_f32 v133, v133, v77
  v_exp_f32 v132, v132
  v_exp_f32 v133, v133
  v_add_f32 v132, 1.0, v132
  v_add_f32 v133, 1.0, v133
  v_rcp_f32 v132, v132
  v_rcp_f32 v133, v133
  v_mul_f32 v132, v132, v76
  v_mul_f32 v133, v133, v77
  v_cvt_pk_bf16_f32 v123, v132, v133
  v_add_f32 v44, v44, v132
  v_add_f32 v45, v45, v133
  v_fma_f32 v52, v132, v132, v52
  v_fma_f32 v53, v133, v133, v53
  s_barrier
  v_fma_f32 v86, v30, v140, v86
  v_fma_f32 v87, v31, v140, v87
  v_mul_f32 v86, v86, v38
  v_mul_f32 v87, v87, v39
  v_mul_f32 v128, v86, v86
  v_mul_f32 v129, v87, v87
  v_fma_f32 v128, v128, s48, v126
  v_fma_f32 v129, v129, s48, v126
  v_mul_f32 v128, v128, v86
  v_mul_f32 v129, v129, v87
  v_exp_f32 v128, v128
  v_exp_f32 v129, v129
  v_add_f32 v128, 1.0, v128
  v_add_f32 v129, 1.0, v129
  v_rcp_f32 v128, v128
  v_rcp_f32 v129, v129
  v_mul_f32 v128, v128, v86
  v_mul_f32 v129, v129, v87
  v_cvt_pk_bf16_f32 v124, v128, v129
  v_add_f32 v46, v46, v128
  v_add_f32 v47, v47, v129
  v_fma_f32 v54, v128, v128, v54
  v_fma_f32 v55, v129, v129, v55
  v_fma_f32 v88, v32, v140, v88
  v_fma_f32 v89, v33, v140, v89
  v_mul_f32 v88, v88, v40
  v_mul_f32 v89, v89, v41
  v_mul_f32 v132, v88, v88
  v_mul_f32 v133, v89, v89
  v_fma_f32 v132, v132, s48, v126
  v_fma_f32 v133, v133, s48, v126
  v_mul_f32 v132, v132, v88
  v_mul_f32 v133, v133, v89
  v_exp_f32 v132, v132
  v_exp_f32 v133, v133
  v_add_f32 v132, 1.0, v132
  v_add_f32 v133, 1.0, v133
  v_rcp_f32 v132, v132
  v_rcp_f32 v133, v133
  v_mul_f32 v132, v132, v88
  v_mul_f32 v133, v133, v89
  v_cvt_pk_bf16_f32 v125, v132, v133
  v_add_f32 v48, v48, v132
  v_add_f32 v49, v49, v133
  v_fma_f32 v56, v132, v132, v56
  v_fma_f32 v57, v133, v133, v57
  s_barrier
  v_add_f32_dpp v42, v42, v42 row_ror:8 row_mask:0xf bank_mask:0xf
  v_add_f32_dpp v43, v43, v43 row_ror:8 row_mask:0xf bank_mask:0xf
  v_add_f32_dpp v44, v44, v44 row_ror:8 row_mask:0xf bank_mask:0xf
  v_add_f32_dpp v45, v45, v45 row_ror:8 row_mask:0xf bank_mask:0xf
  v_add_f32_dpp v46, v46, v46 row_ror:8 row_mask:0xf bank_mask:0xf
  v_add_f32_dpp v47, v47, v47 row_ror:8 row_mask:0xf bank_mask:0xf
  v_add_f32_dpp v48, v48, v48 row_ror:8 row_mask:0xf bank_mask:0xf
  v_add_f32_dpp v49, v49, v49 row_ror:8 row_mask:0xf bank_mask:0xf
  v_add_f32_dpp v50, v50, v50 row_ror:8 row_mask:0xf bank_mask:0xf
  v_add_f32_dpp v51, v51, v51 row_ror:8 row_mask:0xf bank_mask:0xf
  v_add_f32_dpp v52, v52, v52 row_ror:8 row_mask:0xf bank_mask:0xf
  v_add_f32_dpp v53, v53, v53 row_ror:8 row_mask:0xf bank_mask:0xf
  v_add_f32_dpp v54, v54, v54 row_ror:8 row_mask:0xf bank_mask:0xf
  v_add_f32_dpp v55, v55, v55 row_ror:8 row_mask:0xf bank_mask:0xf
  v_add_f32_dpp v56, v56, v56 row_ror:8 row_mask:0xf bank_mask:0xf
  v_add_f32_dpp v57, v57, v57 row_ror:8 row_mask:0xf bank_mask:0xf
  v_add_f32_dpp v42, v42, v42 row_ror:4 row_mask:0xf bank_mask:0xf
  v_add_f32_dpp v43, v43, v43 row_ror:4 row_mask:0xf bank_mask:0xf
  v_add_f32_dpp v44, v44, v44 row_ror:4 row_mask:0xf bank_mask:0xf
  v_add_f32_dpp v45, v45, v45 row_ror:4 row_mask:0xf bank_mask:0xf
  v_add_f32_dpp v46, v46, v46 row_ror:4 row_mask:0xf bank_mask:0xf
  v_add_f32_dpp v47, v47, v47 row_ror:4 row_mask:0xf bank_mask:0xf
  v_add_f32_dpp v48, v48, v48 row_ror:4 row_mask:0xf bank_mask:0xf
  v_add_f32_dpp v49, v49, v49 row_ror:4 row_mask:0xf bank_mask:0xf
  v_add_f32_dpp v50, v50, v50 row_ror:4 row_mask:0xf bank_mask:0xf
  v_add_f32_dpp v51, v51, v51 row_ror:4 row_mask:0xf bank_mask:0xf
  v_add_f32_dpp v52, v52, v52 row_ror:4 row_mask:0xf bank_mask:0xf
  v_add_f32_dpp v53, v53, v53 row_ror:4 row_mask:0xf bank_mask:0xf
  v_add_f32_dpp v54, v54, v54 row_ror:4 row_mask:0xf bank_mask:0xf
  v_add_f32_dpp v55, v55, v55 row_ror:4 row_mask:0xf bank_mask:0xf
  v_add_f32_dpp v56, v56, v56 row_ror:4 row_mask:0xf bank_mask:0xf
  v_add_f32_dpp v57, v57, v57 row_ror:4 row_mask:0xf bank_mask:0xf
  v_add_f32_dpp v42, v42, v42 row_ror:2 row_mask:0xf bank_mask:0xf
  v_add_f32_dpp v43, v43, v43 row_ror:2 row_mask:0xf bank_mask:0xf
  v_add_f32_dpp v44, v44, v44 row_ror:2 row_mask:0xf bank_mask:0xf
  v_add_f32_dpp v45, v45, v45 row_ror:2 row_mask:0xf bank_mask:0xf
  v_add_f32_dpp v46, v46, v46 row_ror:2 row_mask:0xf bank_mask:0xf
  v_add_f32_dpp v47, v47, v47 row_ror:2 row_mask:0xf bank_mask:0xf
  v_add_f32_dpp v48, v48, v48 row_ror:2 row_mask:0xf bank_mask:0xf
  v_add_f32_dpp v49, v49, v49 row_ror:2 row_mask:0xf bank_mask:0xf
  v_add_f32_dpp v50, v50, v50 row_ror:2 row_mask:0xf bank_mask:0xf
  v_add_f32_dpp v51, v51, v51 row_ror:2 row_mask:0xf bank_mask:0xf
  v_add_f32_dpp v52, v52, v52 row_ror:2 row_mask:0xf bank_mask:0xf
  v_add_f32_dpp v53, v53, v53 row_ror:2 row_mask:0xf bank_mask:0xf
  v_add_f32_dpp v54, v54, v54 row_ror:2 row_mask:0xf bank_mask:0xf
  v_add_f32_dpp v55, v55, v55 row_ror:2 row_mask:0xf bank_mask:0xf
  v_add_f32_dpp v56, v56, v56 row_ror:2 row_mask:0xf bank_mask:0xf
  v_add_f32_dpp v57, v57, v57 row_ror:2 row_mask:0xf bank_mask:0xf
  v_add_f32_dpp v42, v42, v42 row_ror:1 row_mask:0xf bank_mask:0xf
  v_add_f32_dpp v43, v43, v43 row_ror:1 row_mask:0xf bank_mask:0xf
  v_add_f32_dpp v44, v44, v44 row_ror:1 row_mask:0xf bank_mask:0xf
  v_add_f32_dpp v45, v45, v45 row_ror:1 row_mask:0xf bank_mask:0xf
  v_add_f32_dpp v46, v46, v46 row_ror:1 row_mask:0xf bank_mask:0xf
  v_add_f32_dpp v47, v47, v47 row_ror:1 row_mask:0xf bank_mask:0xf
  v_add_f32_dpp v48, v48, v48 row_ror:1 row_mask:0xf bank_mask:0xf
  v_add_f32_dpp v49, v49, v49 row_ror:1 row_mask:0xf bank_mask:0xf
  v_add_f32_dpp v50, v50, v50 row_ror:1 row_mask:0xf bank_mask:0xf
  v_add_f32_dpp v51, v51, v51 row_ror:1 row_mask:0xf bank_mask:0xf
  v_add_f32_dpp v52, v52, v52 row_ror:1 row_mask:0xf bank_mask:0xf
  v_add_f32_dpp v53, v53, v53 row_ror:1 row_mask:0xf bank_mask:0xf
  v_add_f32_dpp v54, v54, v54 row_ror:1 row_mask:0xf bank_mask:0xf
  v_add_f32_dpp v55, v55, v55 row_ror:1 row_mask:0xf bank_mask:0xf
  v_add_f32_dpp v56, v56, v56 row_ror:1 row_mask:0xf bank_mask:0xf
  v_add_f32_dpp v57, v57, v57 row_ror:1 row_mask:0xf bank_mask:0xf
  s_lshl_b32 s40, s36, 8
  s_add_u32 s40, s40, 2048
  v_add_u32 v19, s40, v19
  v_add_u32 v20, s40, v20
  s_mov_b32 exec_lo, 0x10001
  s_mov_b32 exec_hi, 0x10001
  ds_write_b128 v19, v[42:45]
  ds_write_b128 v20, v[46:49]
  ds_write_b128 v19, v[50:53] offset:512
  ds_write_b128 v20, v[54:57] offset:512
  s_mov_b64 exec, s[52:53]
  s_waitcnt lgkmcnt(0)
  s_barrier
  s_cmp_eq_u32 s34, 0
  s_cbranch_scc0 K1_NOPUB
  v_lshlrev_b32 v14, 2, v1
  v_add_u32 v14, 145408, v14
  ds_read_b32 v16, v14
  ds_read_b32 v18, v14 offset:256
  ds_read_b32 v17, v14 offset:512
  ds_read_b32 v19, v14 offset:768
  s_lshl_b32 s40, s32, 3
  s_add_u32 s40, s40, s33
  s_lshl_b32 s40, s40, 9
  s_add_u32 s40, s40, 16842752
  v_lshlrev_b32 v15, 3, v1
  s_waitcnt lgkmcnt(0)
  v_add_f32 v16, v16, v18
  v_add_f32 v17, v17, v19
  v_max_f32 v17, 0, v17
  buffer_store_dwordx2 v[16:17], v15, s[16:19], s40 offen sc1
K1_NOPUB:
  s_mul_i32 s40, s33, 6
  s_mul_i32 s41, s36, 3
  s_add_u32 s40, s40, s41
  s_lshl_b32 s40, s40, 6
  s_lshl_b32 s41, s32, 1
  s_add_u32 s40, s40, s41
  s_add_u32 s40, s40, s35
  s_lshl_b32 s40, s40, 10
  s_add_u32 s39, s40, 3145728
  v_and_b32 v21, 1, v2
  v_lshlrev_b32 v21, 1, v21
  v_lshrrev_b32 v24, 1, v2
  v_or_b32 v21, v21, v24
  s_lshl_b32 s41, s36, 1
  v_xor_b32 v21, s41, v21
  v_lshlrev_b32 v21, 4, v21
  v_add_u32 v21, v21, v3
  v_lshlrev_b32 v21, 4, v21
  v_and_b32 v24, 31, v1
  s_lshl_b32 s38, s35, 5
  v_add_u32 v24, s38, v24
  v_lshlrev_b32 v24, 3, v24
  s_lshl_b32 s38, s32, 12
  s_add_u32 s38, s38, 16842752
  buffer_load_dword v23, v22, s[4:7], 0 offen offset:0 sc1
  s_barrier
  s_barrier
  s_barrier
  s_waitcnt vmcnt(0)
  s_mov_b32 s54, 0
K1_CCHK:
  v_readfirstlane_b32 s40, v23
  s_nop 0
  s_cmp_ge_u32 s40, 8
  s_cbranch_scc1 K1_COK
  s_add_u32 s54, s54, 1
  s_cmp_lt_u32 s54, 0x200000
  s_cbranch_scc0 K1_COK
  s_sleep 4
  buffer_load_dword v23, v22, s[4:7], 0 offen offset:0 sc1
  s_waitcnt vmcnt(0)
  s_branch K1_CCHK
K1_COK:
  buffer_load_dwordx2 v[44:45], v24, s[16:19], s38 offen offset:0 sc1
  buffer_load_dwordx2 v[46:47], v24, s[16:19], s38 offen offset:512 sc1
  buffer_load_dwordx2 v[48:49], v24, s[16:19], s38 offen offset:1024 sc1
  buffer_load_dwordx2 v[50:51], v24, s[16:19], s38 offen offset:1536 sc1
  buffer_load_dwordx2 v[52:53], v24, s[16:19], s38 offen offset:2048 sc1
  buffer_load_dwordx2 v[54:55], v24, s[16:19], s38 offen offset:2560 sc1
  buffer_load_dwordx2 v[56:57], v24, s[16:19], s38 offen offset:3072 sc1
  buffer_load_dwordx2 v[58:59], v24, s[16:19], s38 offen offset:3584 sc1
  s_barrier
  s_setprio 0
  s_waitcnt vmcnt(0)
  s_mov_b32 s54, 0
K1_CHECK:
  s_mov_b32 s40, 0xbf800000
  v_cmp_eq_u32 vcc, s40, v45
  v_cmp_eq_u32 s[56:57], s40, v47
  s_nop 0
  s_or_b64 vcc, vcc, s[56:57]
  v_cmp_eq_u32 s[56:57], s40, v49
  s_nop 0
  s_or_b64 vcc, vcc, s[56:57]
  v_cmp_eq_u32 s[56:57], s40, v51
  s_nop 0
  s_or_b64 vcc, vcc, s[56:57]
  v_cmp_eq_u32 s[56:57], s40, v53
  s_nop 0
  s_or_b64 vcc, vcc, s[56:57]
  v_cmp_eq_u32 s[56:57], s40, v55
  s_nop 0
  s_or_b64 vcc, vcc, s[56:57]
  v_cmp_eq_u32 s[56:57], s40, v57
  s_nop 0
  s_or_b64 vcc, vcc, s[56:57]
  v_cmp_eq_u32 s[56:57], s40, v59
  s_nop 0
  s_or_b64 vcc, vcc, s[56:57]
  s_cmp_eq_u64 vcc, 0
  s_cbranch_scc1 K1_POLLED
  s_add_u32 s54, s54, 1
  s_cmp_lt_u32 s54, 0x200000
  s_cbranch_scc0 K1_POLLED
  buffer_load_dwordx2 v[44:45], v24, s[16:19], s38 offen offset:0 sc1
  buffer_load_dwordx2 v[46:47], v24, s[16:19], s38 offen offset:512 sc1
  buffer_load_dwordx2 v[48:49], v24, s[16:19], s38 offen offset:1024 sc1
  buffer_load_dwordx2 v[50:51], v24, s[16:19], s38 offen offset:1536 sc1
  buffer_load_dwordx2 v[52:53], v24, s[16:19], s38 offen offset:2048 sc1
  buffer_load_dwordx2 v[54:55], v24, s[16:19], s38 offen offset:2560 sc1
  buffer_load_dwordx2 v[56:57], v24, s[16:19], s38 offen offset:3072 sc1
  buffer_load_dwordx2 v[58:59], v24, s[16:19], s38 offen offset:3584 sc1
  s_waitcnt vmcnt(0)
  s_branch K1_CHECK
K1_POLLED:
  v_pk_add_f32 v[44:45], v[44:45], v[46:47]
  v_pk_add_f32 v[44:45], v[44:45], v[48:49]
  v_pk_add_f32 v[44:45], v[44:45], v[50:51]
  v_pk_add_f32 v[44:45], v[44:45], v[52:53]
  v_pk_add_f32 v[44:45], v[44:45], v[54:55]
  v_pk_add_f32 v[44:45], v[44:45], v[56:57]
  v_pk_add_f32 v[44:45], v[44:45], v[58:59]
  v_mul_f32 v16, 0x3aaaaaab, v44
  v_mul_f32 v18, 0x3aaaaaab, v45
  v_fma_f32 v18, -v16, v16, v18
  v_max_f32 v18, 0, v18
  v_cvt_pk_bf16_f32 v16, v16, v16
  v_lshlrev_b32 v16, 16, v16
  v_cvt_pk_bf16_f32 v18, v18, v18
  v_lshlrev_b32 v18, 16, v18
  v_add_f32 v18, 0x3727c5ac, v18
  v_cvt_pk_bf16_f32 v18, v18, v18
  v_lshlrev_b32 v18, 16, v18
  v_sqrt_f32 v18, v18
  s_nop 0
  v_cvt_pk_bf16_f32 v18, v18, v18
  v_lshlrev_b32 v18, 16, v18
  v_rcp_f32 v17, v18
  s_nop 0
  v_mul_f32 v16, v16, v17
  v_sub_f32 v16, 0, v16
  s_lshl_b32 s40, s55, 8
  s_add_u32 s40, s40, 146432
  v_and_b32 v18, 31, v1
  v_lshlrev_b32 v18, 2, v18
  v_add_u32 v18, s40, v18
  ds_write_b32 v18, v16
  ds_write_b32 v18, v17 offset:128
  s_lshl_b32 s41, s36, 6
  s_add_u32 s40, s40, s41
  v_lshlrev_b32 v19, 4, v2
  v_add_u32 v19, s40, v19
  v_xor_b32 v20, 64, v19
  s_waitcnt lgkmcnt(0)
  ds_read_b128 v[26:29], v19
  ds_read_b128 v[30:33], v20
  ds_read_b128 v[34:37], v19 offset:128
  ds_read_b128 v[38:41], v20 offset:128
  s_waitcnt lgkmcnt(0)
  v_lshlrev_b32 v128, 16, v114
  v_and_b32 v129, s47, v114
  v_pk_fma_f32 v[128:129], v[128:129], v[34:35], v[26:27]
  v_cvt_pk_bf16_f32 v114, v128, v129
  v_lshlrev_b32 v132, 16, v115
  v_and_b32 v133, s47, v115
  v_pk_fma_f32 v[132:133], v[132:133], v[36:37], v[28:29]
  v_cvt_pk_bf16_f32 v115, v132, v133
  v_lshlrev_b32 v128, 16, v116
  v_and_b32 v129, s47, v116
  v_pk_fma_f32 v[128:129], v[128:129], v[38:39], v[30:31]
  v_cvt_pk_bf16_f32 v116, v128, v129
  v_lshlrev_b32 v132, 16, v117
  v_and_b32 v133, s47, v117
  v_pk_fma_f32 v[132:133], v[132:133], v[40:41], v[32:33]
  v_cvt_pk_bf16_f32 v117, v132, v133
  v_permlane16_swap_b32 v114, v116
  s_nop 0
  v_permlane16_swap_b32 v115, v117
  s_add_u32 s41, s39, 0
  buffer_store_dwordx4 v[114:117], v21, s[16:19], s41 offen sc1
  v_lshlrev_b32 v128, 16, v118
  v_and_b32 v129, s47, v118
  v_pk_fma_f32 v[128:129], v[128:129], v[34:35], v[26:27]
  v_cvt_pk_bf16_f32 v118, v128, v129
  v_lshlrev_b32 v132, 16, v119
  v_and_b32 v133, s47, v119
  v_pk_fma_f32 v[132:133], v[132:133], v[36:37], v[28:29]
  v_cvt_pk_bf16_f32 v119, v132, v133
  v_lshlrev_b32 v128, 16, v120
  v_and_b32 v129, s47, v120
  v_pk_fma_f32 v[128:129], v[128:129], v[38:39], v[30:31]
  v_cvt_pk_bf16_f32 v120, v128, v129
  v_lshlrev_b32 v132, 16, v121
  v_and_b32 v133, s47, v121
  v_pk_fma_f32 v[132:133], v[132:133], v[40:41], v[32:33]
  v_cvt_pk_bf16_f32 v121, v132, v133
  v_permlane16_swap_b32 v118, v120
  s_nop 0
  v_permlane16_swap_b32 v119, v121
  s_add_u32 s41, s39, 65536
  buffer_store_dwordx4 v[118:121], v21, s[16:19], s41 offen sc1
  v_lshlrev_b32 v128, 16, v122
  v_and_b32 v129, s47, v122
  v_pk_fma_f32 v[128:129], v[128:129], v[34:35], v[26:27]
  v_cvt_pk_bf16_f32 v122, v128, v129
  v_lshlrev_b32 v132, 16, v123
  v_and_b32 v133, s47, v123
  v_pk_fma_f32 v[132:133], v[132:133], v[36:37], v[28:29]
  v_cvt_pk_bf16_f32 v123, v132, v133
  v_lshlrev_b32 v128, 16, v124
  v_and_b32 v129, s47, v124
  v_pk_fma_f32 v[128:129], v[128:129], v[38:39], v[30:31]
  v_cvt_pk_bf16_f32 v124, v128, v129
  v_lshlrev_b32 v132, 16, v125
  v_and_b32 v133, s47, v125
  v_pk_fma_f32 v[132:133], v[132:133], v[40:41], v[32:33]
  v_cvt_pk_bf16_f32 v125, v132, v133
  v_permlane16_swap_b32 v122, v124
  s_nop 0
  v_permlane16_swap_b32 v123, v125
  s_add_u32 s41, s39, 131072
  buffer_store_dwordx4 v[122:125], v21, s[16:19], s41 offen sc1
  s_waitcnt vmcnt(0)
  s_barrier
  s_load_dwordx2 s[56:57], s[0:1], 72
  s_and_b32 s35, s34, 1
  s_lshr_b32 s36, s34, 1
  v_xor_b32 v9, v2, v3
  v_lshlrev_b32 v9, 4, v9
  s_lshl_b32 s40, s36, 6
  v_xor_b32 v9, s40, v9
  v_lshlrev_b32 v10, 8, v3
  v_add_u32 v4, v9, v10
  v_xor_b32 v5, 128, v4
  s_mul_i32 s40, s33, 6
  s_mul_i32 s41, s35, 3
  s_add_u32 s40, s40, s41
  s_lshl_b32 s40, s40, 16
  s_add_u32 s40, s40, 3145728
  v_lshlrev_b32 v9, 4, v1
  s_add_u32 s41, s40, 0
  v_add_u32 v6, s41, v9
  s_add_u32 s41, s40, 65536
  v_add_u32 v7, s41, v9
  s_add_u32 s41, s40, 131072
  v_add_u32 v8, s41, v9
  s_lshl_b32 s39, s36, 10
  v_mov_b32 v48, 0
  v_mov_b32 v49, 0
  v_mov_b32 v50, 0
  v_mov_b32 v51, 0
  v_mov_b32 v52, 0
  v_mov_b32 v53, 0
  v_mov_b32 v54, 0
  v_mov_b32 v55, 0
  v_mov_b32 v56, 0
  v_mov_b32 v57, 0
  v_mov_b32 v58, 0
  v_mov_b32 v59, 0
  v_mov_b32 v60, 0
  v_mov_b32 v61, 0
  v_mov_b32 v62, 0
  v_mov_b32 v63, 0
  v_mov_b32 v64, 0
  v_mov_b32 v65, 0
  v_mov_b32 v66, 0
  v_mov_b32 v67, 0
  v_mov_b32 v68, 0
  v_mov_b32 v69, 0
  v_mov_b32 v70, 0
  v_mov_b32 v71, 0
  v_mov_b32 v72, 0
  v_mov_b32 v73, 0
  v_mov_b32 v74, 0
  v_mov_b32 v75, 0
  v_mov_b32 v76, 0
  v_mov_b32 v77, 0
  v_mov_b32 v78, 0
  v_mov_b32 v79, 0
  v_mov_b32 v80, 0
  v_mov_b32 v81, 0
  v_mov_b32 v82, 0
  v_mov_b32 v83, 0
  v_mov_b32 v84, 0
  v_mov_b32 v85, 0
  v_mov_b32 v86, 0
  v_mov_b32 v87, 0
  v_mov_b32 v88, 0
  v_mov_b32 v89, 0
  v_mov_b32 v90, 0
  v_mov_b32 v91, 0
  v_mov_b32 v92, 0
  v_mov_b32 v93, 0
  v_mov_b32 v94, 0
  v_mov_b32 v95, 0
  s_waitcnt lgkmcnt(0)
  s_mov_b32 s12, s56
  s_and_b32 s13, s57, 0xffff
  s_mov_b32 s14, 4096
  s_mov_b32 s15, 0x20000
  s_barrier
  s_add_u32 s38, s39, 0
  buffer_load_dwordx4 v[96:99], v6, s[16:19], s38 offen sc1
  buffer_load_dwordx4 v[100:103], v7, s[16:19], s38 offen sc1
  buffer_load_dwordx4 v[104:107], v8, s[16:19], s38 offen sc1
  s_add_u32 s38, s39, 2048
  buffer_load_dwordx4 v[108:111], v6, s[16:19], s38 offen sc1
  buffer_load_dwordx4 v[112:115], v7, s[16:19], s38 offen sc1
  buffer_load_dwordx4 v[116:119], v8, s[16:19], s38 offen sc1
  s_add_u32 s38, s39, 4096
  buffer_load_dwordx4 v[120:123], v6, s[16:19], s38 offen sc1
  buffer_load_dwordx4 v[124:127], v7, s[16:19], s38 offen sc1
  buffer_load_dwordx4 v[128:131], v8, s[16:19], s38 offen sc1
  s_add_u32 s38, s39, 6144
  buffer_load_dwordx4 v[132:135], v6, s[16:19], s38 offen sc1
  buffer_load_dwordx4 v[136:139], v7, s[16:19], s38 offen sc1
  buffer_load_dwordx4 v[140:143], v8, s[16:19], s38 offen sc1
  s_add_u32 s38, s39, 8192
  buffer_load_dwordx4 v[144:147], v6, s[16:19], s38 offen sc1
  buffer_load_dwordx4 v[148:151], v7, s[16:19], s38 offen sc1
  buffer_load_dwordx4 v[152:155], v8, s[16:19], s38 offen sc1
  s_mov_b32 s37, 0
  ds_read_b128 v[16:19], v4 offset:0
  ds_read_b128 v[20:23], v4 offset:4096
  ds_read_b128 v[24:27], v4 offset:8192
  ds_read_b128 v[28:31], v4 offset:12288
F2_GLOOP:
  s_lshl_b32 s40, s37, 1
  s_add_u32 s40, s40, 5
  s_lshl_b32 s38, s40, 11
  s_add_u32 s38, s38, s39
  s_cmp_lt_u32 s40, 32
  s_cselect_b32 s38, s38, 0x80000000
  s_waitcnt vmcnt(12) lgkmcnt(0)
  v_mfma_f32_16x16x32_bf16 v[48:51], v[96:99], v[16:19], v[48:51]
  ds_read_b128 v[32:35], v5 offset:0
  v_mfma_f32_16x16x32_bf16 v[64:67], v[100:103], v[16:19], v[64:67]
  ds_read_b128 v[36:39], v5 offset:4096
  v_mfma_f32_16x16x32_bf16 v[80:83], v[104:107], v[16:19], v[80:83]
  ds_read_b128 v[40:43], v5 offset:8192
  v_mfma_f32_16x16x32_bf16 v[52:55], v[96:99], v[20:23], v[52:55]
  ds_read_b128 v[44:47], v5 offset:12288
  v_mfma_f32_16x16x32_bf16 v[68:71], v[100:103], v[20:23], v[68:71]
  buffer_load_dwordx4 v[156:159], v6, s[16:19], s38 offen sc1
  v_mfma_f32_16x16x32_bf16 v[84:87], v[104:107], v[20:23], v[84:87]
  v_mfma_f32_16x16x32_bf16 v[56:59], v[96:99], v[24:27], v[56:59]
  buffer_load_dwordx4 v[160:163], v7, s[16:19], s38 offen sc1
  v_mfma_f32_16x16x32_bf16 v[72:75], v[100:103], v[24:27], v[72:75]
  v_mfma_f32_16x16x32_bf16 v[88:91], v[104:107], v[24:27], v[88:91]
  buffer_load_dwordx4 v[164:167], v8, s[16:19], s38 offen sc1
  v_mfma_f32_16x16x32_bf16 v[60:63], v[96:99], v[28:31], v[60:63]
  v_mfma_f32_16x16x32_bf16 v[76:79], v[100:103], v[28:31], v[76:79]
  v_mfma_f32_16x16x32_bf16 v[92:95], v[104:107], v[28:31], v[92:95]
  s_and_b32 s40, s37, 3
  s_movk_i32 s43, 16384
  s_cmp_eq_u32 s40, 3
  s_cselect_b32 s43, 4294918144, s43
  s_lshl_b32 s40, s37, 1
  s_add_u32 s40, s40, 6
  s_lshl_b32 s38, s40, 11
  s_add_u32 s38, s38, s39
  s_cmp_lt_u32 s40, 32
  s_cselect_b32 s38, s38, 0x80000000
  s_waitcnt lgkmcnt(0)
  s_barrier
  v_add_u32 v4, s43, v4
  s_waitcnt vmcnt(12)
  v_mfma_f32_16x16x32_bf16 v[48:51], v[108:111], v[32:35], v[48:51]
  ds_read_b128 v[16:19], v4 offset:0
  v_mfma_f32_16x16x32_bf16 v[64:67], v[112:115], v[32:35], v[64:67]
  ds_read_b128 v[20:23], v4 offset:4096
  v_mfma_f32_16x16x32_bf16 v[80:83], v[116:119], v[32:35], v[80:83]
  ds_read_b128 v[24:27], v4 offset:8192
  v_mfma_f32_16x16x32_bf16 v[52:55], v[108:111], v[36:39], v[52:55]
  ds_read_b128 v[28:31], v4 offset:12288
  v_mfma_f32_16x16x32_bf16 v[68:71], v[112:115], v[36:39], v[68:71]
  buffer_load_dwordx4 v[96:99], v6, s[16:19], s38 offen sc1
  v_mfma_f32_16x16x32_bf16 v[84:87], v[116:119], v[36:39], v[84:87]
  v_mfma_f32_16x16x32_bf16 v[56:59], v[108:111], v[40:43], v[56:59]
  buffer_load_dwordx4 v[100:103], v7, s[16:19], s38 offen sc1
  v_mfma_f32_16x16x32_bf16 v[72:75], v[112:115], v[40:43], v[72:75]
  v_mfma_f32_16x16x32_bf16 v[88:91], v[116:119], v[40:43], v[88:91]
  buffer_load_dwordx4 v[104:107], v8, s[16:19], s38 offen sc1
  v_mfma_f32_16x16x32_bf16 v[60:63], v[108:111], v[44:47], v[60:63]
  v_mfma_f32_16x16x32_bf16 v[76:79], v[112:115], v[44:47], v[76:79]
  v_mfma_f32_16x16x32_bf16 v[92:95], v[116:119], v[44:47], v[92:95]
  v_add_u32 v5, s43, v5
  s_add_u32 s37, s37, 1
  s_cmp_eq_u32 s37, 16
  s_cbranch_scc1 F2_GDONE
  s_lshl_b32 s40, s37, 1
  s_add_u32 s40, s40, 5
  s_lshl_b32 s38, s40, 11
  s_add_u32 s38, s38, s39
  s_cmp_lt_u32 s40, 32
  s_cselect_b32 s38, s38, 0x80000000
  s_waitcnt vmcnt(12) lgkmcnt(0)
  v_mfma_f32_16x16x32_bf16 v[48:51], v[120:123], v[16:19], v[48:51]
  ds_read_b128 v[32:35], v5 offset:0
  v_mfma_f32_16x16x32_bf16 v[64:67], v[124:127], v[16:19], v[64:67]
  ds_read_b128 v[36:39], v5 offset:4096
  v_mfma_f32_16x16x32_bf16 v[80:83], v[128:131], v[16:19], v[80:83]
  ds_read_b128 v[40:43], v5 offset:8192
  v_mfma_f32_16x16x32_bf16 v[52:55], v[120:123], v[20:23], v[52:55]
  ds_read_b128 v[44:47], v5 offset:12288
  v_mfma_f32_16x16x32_bf16 v[68:71], v[124:127], v[20:23], v[68:71]
  buffer_load_dwordx4 v[108:111], v6, s[16:19], s38 offen sc1
  v_mfma_f32_16x16x32_bf16 v[84:87], v[128:131], v[20:23], v[84:87]
  v_mfma_f32_16x16x32_bf16 v[56:59], v[120:123], v[24:27], v[56:59]
  buffer_load_dwordx4 v[112:115], v7, s[16:19], s38 offen sc1
  v_mfma_f32_16x16x32_bf16 v[72:75], v[124:127], v[24:27], v[72:75]
  v_mfma_f32_16x16x32_bf16 v[88:91], v[128:131], v[24:27], v[88:91]
  buffer_load_dwordx4 v[116:119], v8, s[16:19], s38 offen sc1
  v_mfma_f32_16x16x32_bf16 v[60:63], v[120:123], v[28:31], v[60:63]
  v_mfma_f32_16x16x32_bf16 v[76:79], v[124:127], v[28:31], v[76:79]
  v_mfma_f32_16x16x32_bf16 v[92:95], v[128:131], v[28:31], v[92:95]
  s_and_b32 s40, s37, 3
  s_movk_i32 s43, 16384
  s_cmp_eq_u32 s40, 3
  s_cselect_b32 s43, 4294918144, s43
  s_lshl_b32 s40, s37, 1
  s_add_u32 s40, s40, 6
  s_lshl_b32 s38, s40, 11
  s_add_u32 s38, s38, s39
  s_cmp_lt_u32 s40, 32
  s_cselect_b32 s38, s38, 0x80000000
  s_waitcnt lgkmcnt(0)
  s_barrier
  v_add_u32 v4, s43, v4
  s_waitcnt vmcnt(12)
  v_mfma_f32_16x16x32_bf16 v[48:51], v[132:135], v[32:35], v[48:51]
  ds_read_b128 v[16:19], v4 offset:0
  v_mfma_f32_16x16x32_bf16 v[64:67], v[136:139], v[32:35], v[64:67]
  ds_read_b128 v[20:23], v4 offset:4096
  v_mfma_f32_16x16x32_bf16 v[80:83], v[140:143], v[32:35], v[80:83]
  ds_read_b128 v[24:27], v4 offset:8192
  v_mfma_f32_16x16x32_bf16 v[52:55], v[132:135], v[36:39], v[52:55]
  ds_read_b128 v[28:31], v4 offset:12288
  v_mfma_f32_16x16x32_bf16 v[68:71], v[136:139], v[36:39], v[68:71]
  buffer_load_dwordx4 v[120:123], v6, s[16:19], s38 offen sc1
  v_mfma_f32_16x16x32_bf16 v[84:87], v[140:143], v[36:39], v[84:87]
  v_mfma_f32_16x16x32_bf16 v[56:59], v[132:135], v[40:43], v[56:59]
  buffer_load_dwordx4 v[124:127], v7, s[16:19], s38 offen sc1
  v_mfma_f32_16x16x32_bf16 v[72:75], v[136:139], v[40:43], v[72:75]
  v_mfma_f32_16x16x32_bf16 v[88:91], v[140:143], v[40:43], v[88:91]
  buffer_load_dwordx4 v[128:131], v8, s[16:19], s38 offen sc1
  v_mfma_f32_16x16x32_bf16 v[60:63], v[132:135], v[44:47], v[60:63]
  v_mfma_f32_16x16x32_bf16 v[76:79], v[136:139], v[44:47], v[76:79]
  v_mfma_f32_16x16x32_bf16 v[92:95], v[140:143], v[44:47], v[92:95]
  v_add_u32 v5, s43, v5
  s_add_u32 s37, s37, 1
  s_cmp_eq_u32 s37, 16
  s_cbranch_scc1 F2_GDONE
  s_lshl_b32 s40, s37, 1
  s_add_u32 s40, s40, 5
  s_lshl_b32 s38, s40, 11
  s_add_u32 s38, s38, s39
  s_cmp_lt_u32 s40, 32
  s_cselect_b32 s38, s38, 0x80000000
  s_waitcnt vmcnt(12) lgkmcnt(0)
  v_mfma_f32_16x16x32_bf16 v[48:51], v[144:147], v[16:19], v[48:51]
  ds_read_b128 v[32:35], v5 offset:0
  v_mfma_f32_16x16x32_bf16 v[64:67], v[148:151], v[16:19], v[64:67]
  ds_read_b128 v[36:39], v5 offset:4096
  v_mfma_f32_16x16x32_bf16 v[80:83], v[152:155], v[16:19], v[80:83]
  ds_read_b128 v[40:43], v5 offset:8192
  v_mfma_f32_16x16x32_bf16 v[52:55], v[144:147], v[20:23], v[52:55]
  ds_read_b128 v[44:47], v5 offset:12288
  v_mfma_f32_16x16x32_bf16 v[68:71], v[148:151], v[20:23], v[68:71]
  buffer_load_dwordx4 v[132:135], v6, s[16:19], s38 offen sc1
  v_mfma_f32_16x16x32_bf16 v[84:87], v[152:155], v[20:23], v[84:87]
  v_mfma_f32_16x16x32_bf16 v[56:59], v[144:147], v[24:27], v[56:59]
  buffer_load_dwordx4 v[136:139], v7, s[16:19], s38 offen sc1
  v_mfma_f32_16x16x32_bf16 v[72:75], v[148:151], v[24:27], v[72:75]
  v_mfma_f32_16x16x32_bf16 v[88:91], v[152:155], v[24:27], v[88:91]
  buffer_load_dwordx4 v[140:143], v8, s[16:19], s38 offen sc1
  v_mfma_f32_16x16x32_bf16 v[60:63], v[144:147], v[28:31], v[60:63]
  v_mfma_f32_16x16x32_bf16 v[76:79], v[148:151], v[28:31], v[76:79]
  v_mfma_f32_16x16x32_bf16 v[92:95], v[152:155], v[28:31], v[92:95]
  s_and_b32 s40, s37, 3
  s_movk_i32 s43, 16384
  s_cmp_eq_u32 s40, 3
  s_cselect_b32 s43, 4294918144, s43
  s_lshl_b32 s40, s37, 1
  s_add_u32 s40, s40, 6
  s_lshl_b32 s38, s40, 11
  s_add_u32 s38, s38, s39
  s_cmp_lt_u32 s40, 32
  s_cselect_b32 s38, s38, 0x80000000
  s_waitcnt lgkmcnt(0)
  s_barrier
  v_add_u32 v4, s43, v4
  s_waitcnt vmcnt(12)
  v_mfma_f32_16x16x32_bf16 v[48:51], v[156:159], v[32:35], v[48:51]
  ds_read_b128 v[16:19], v4 offset:0
  v_mfma_f32_16x16x32_bf16 v[64:67], v[160:163], v[32:35], v[64:67]
  ds_read_b128 v[20:23], v4 offset:4096
  v_mfma_f32_16x16x32_bf16 v[80:83], v[164:167], v[32:35], v[80:83]
  ds_read_b128 v[24:27], v4 offset:8192
  v_mfma_f32_16x16x32_bf16 v[52:55], v[156:159], v[36:39], v[52:55]
  ds_read_b128 v[28:31], v4 offset:12288
  v_mfma_f32_16x16x32_bf16 v[68:71], v[160:163], v[36:39], v[68:71]
  buffer_load_dwordx4 v[144:147], v6, s[16:19], s38 offen sc1
  v_mfma_f32_16x16x32_bf16 v[84:87], v[164:167], v[36:39], v[84:87]
  v_mfma_f32_16x16x32_bf16 v[56:59], v[156:159], v[40:43], v[56:59]
  buffer_load_dwordx4 v[148:151], v7, s[16:19], s38 offen sc1
  v_mfma_f32_16x16x32_bf16 v[72:75], v[160:163], v[40:43], v[72:75]
  v_mfma_f32_16x16x32_bf16 v[88:91], v[164:167], v[40:43], v[88:91]
  buffer_load_dwordx4 v[152:155], v8, s[16:19], s38 offen sc1
  v_mfma_f32_16x16x32_bf16 v[60:63], v[156:159], v[44:47], v[60:63]
  v_mfma_f32_16x16x32_bf16 v[76:79], v[160:163], v[44:47], v[76:79]
  v_mfma_f32_16x16x32_bf16 v[92:95], v[164:167], v[44:47], v[92:95]
  v_add_u32 v5, s43, v5
  s_add_u32 s37, s37, 1
  s_cmp_eq_u32 s37, 16
  s_cbranch_scc0 F2_GLOOP
F2_GDONE:
  s_lshl_b32 s40, s32, 2
  s_add_u32 s45, s40, s34
  v_lshlrev_b32 v10, 1, v3
  s_lshl_b32 s40, s45, 5
  buffer_load_ushort v15, v10, s[12:15], s40 offen
  s_waitcnt lgkmcnt(0)
  s_barrier
  s_mul_i32 s40, s34, 3072
  v_lshlrev_b32 v9, 4, v1
  v_add_u32 v10, s40, v9
  ds_write_b128 v10, v[48:51] offset:0
  ds_write_b128 v10, v[64:67] offset:1024
  ds_write_b128 v10, v[80:83] offset:2048
  ds_write_b128 v10, v[52:55] offset:12288
  ds_write_b128 v10, v[68:71] offset:13312
  ds_write_b128 v10, v[84:87] offset:14336
  s_waitcnt lgkmcnt(6)
  ds_write_b128 v10, v[56:59] offset:24576
  ds_write_b128 v10, v[72:75] offset:25600
  ds_write_b128 v10, v[88:91] offset:26624
  ds_write_b128 v10, v[60:63] offset:36864
  ds_write_b128 v10, v[76:79] offset:37888
  ds_write_b128 v10, v[92:95] offset:38912
  s_waitcnt lgkmcnt(6)
  s_waitcnt lgkmcnt(0)
  s_barrier
  s_mul_i32 s40, s34, 12288
  v_add_u32 v10, s40, v9
  ds_read_b128 v[16:19], v10 offset:0
  ds_read_b128 v[20:23], v10 offset:1024
  ds_read_b128 v[24:27], v10 offset:2048
  ds_read_b128 v[28:31], v10 offset:3072
  ds_read_b128 v[32:35], v10 offset:4096
  ds_read_b128 v[36:39], v10 offset:5120
  ds_read_b128 v[40:43], v10 offset:6144
  ds_read_b128 v[44:47], v10 offset:7168
  ds_read_b128 v[48:51], v10 offset:8192
  s_waitcnt lgkmcnt(6)
  ds_read_b128 v[52:55], v10 offset:9216
  ds_read_b128 v[56:59], v10 offset:10240
  ds_read_b128 v[60:63], v10 offset:11264
  s_mul_i32 s40, s34, 3072
  s_add_u32 s40, s40, 147456
  v_lshlrev_b32 v11, 3, v1
  v_add_u32 v11, s40, v11
  s_waitcnt lgkmcnt(6)
  ds_read_b64 v[64:65], v11 offset:0
  ds_read_b64 v[66:67], v11 offset:512
  ds_read_b64 v[68:69], v11 offset:1024
  ds_read_b64 v[70:71], v11 offset:1536
  ds_read_b64 v[72:73], v11 offset:2048
  ds_read_b64 v[74:75], v11 offset:2560
  s_waitcnt vmcnt(0)
  v_lshlrev_b32 v92, 16, v15
  s_mul_i32 s40, s45, 24576
  s_mul_i32 s41, s33, 3072
  s_add_u32 s40, s40, s41
  s_add_u32 s40, s40, 12582912
  s_waitcnt lgkmcnt(0)
  v_pk_add_f32 v[16:17], v[16:17], v[40:41]
  v_pk_add_f32 v[18:19], v[18:19], v[42:43]
  v_lshlrev_b32 v88, 16, v64
  v_and_b32 v89, s47, v64
  v_lshlrev_b32 v90, 16, v65
  v_and_b32 v91, s47, v65
  v_pk_add_f32 v[16:17], v[16:17], v[92:93] op_sel_hi:[1,0]
  v_pk_add_f32 v[18:19], v[18:19], v[92:93] op_sel_hi:[1,0]
  v_pk_mul_f32 v[16:17], v[16:17], v[88:89]
  v_pk_mul_f32 v[18:19], v[18:19], v[90:91]
  v_cvt_pk_bf16_f32 v76, v16, v17
  v_cvt_pk_bf16_f32 v77, v18, v19
  v_pk_add_f32 v[20:21], v[20:21], v[44:45]
  v_pk_add_f32 v[22:23], v[22:23], v[46:47]
  v_lshlrev_b32 v88, 16, v66
  v_and_b32 v89, s47, v66
  v_lshlrev_b32 v90, 16, v67
  v_and_b32 v91, s47, v67
  v_pk_add_f32 v[20:21], v[20:21], v[92:93] op_sel_hi:[1,0]
  v_pk_add_f32 v[22:23], v[22:23], v[92:93] op_sel_hi:[1,0]
  v_pk_mul_f32 v[20:21], v[20:21], v[88:89]
  v_pk_mul_f32 v[22:23], v[22:23], v[90:91]
  v_cvt_pk_bf16_f32 v78, v20, v21
  v_cvt_pk_bf16_f32 v79, v22, v23
  buffer_store_dwordx4 v[76:79], v9, s[16:19], s40 offen offset:0 sc1
  v_pk_add_f32 v[24:25], v[24:25], v[48:49]
  v_pk_add_f32 v[26:27], v[26:27], v[50:51]
  v_lshlrev_b32 v88, 16, v68
  v_and_b32 v89, s47, v68
  v_lshlrev_b32 v90, 16, v69
  v_and_b32 v91, s47, v69
  v_pk_add_f32 v[24:25], v[24:25], v[92:93] op_sel_hi:[1,0]
  v_pk_add_f32 v[26:27], v[26:27], v[92:93] op_sel_hi:[1,0]
  v_pk_mul_f32 v[24:25], v[24:25], v[88:89]
  v_pk_mul_f32 v[26:27], v[26:27], v[90:91]
  v_cvt_pk_bf16_f32 v80, v24, v25
  v_cvt_pk_bf16_f32 v81, v26, v27
  v_pk_add_f32 v[28:29], v[28:29], v[52:53]
  v_pk_add_f32 v[30:31], v[30:31], v[54:55]
  v_lshlrev_b32 v88, 16, v70
  v_and_b32 v89, s47, v70
  v_lshlrev_b32 v90, 16, v71
  v_and_b32 v91, s47, v71
  v_pk_add_f32 v[28:29], v[28:29], v[92:93] op_sel_hi:[1,0]
  v_pk_add_f32 v[30:31], v[30:31], v[92:93] op_sel_hi:[1,0]
  v_pk_mul_f32 v[28:29], v[28:29], v[88:89]
  v_pk_mul_f32 v[30:31], v[30:31], v[90:91]
  v_cvt_pk_bf16_f32 v82, v28, v29
  v_cvt_pk_bf16_f32 v83, v30, v31
  buffer_store_dwordx4 v[80:83], v9, s[16:19], s40 offen offset:1024 sc1
  v_pk_add_f32 v[32:33], v[32:33], v[56:57]
  v_pk_add_f32 v[34:35], v[34:35], v[58:59]
  v_lshlrev_b32 v88, 16, v72
  v_and_b32 v89, s47, v72
  v_lshlrev_b32 v90, 16, v73
  v_and_b32 v91, s47, v73
  v_pk_add_f32 v[32:33], v[32:33], v[92:93] op_sel_hi:[1,0]
  v_pk_add_f32 v[34:35], v[34:35], v[92:93] op_sel_hi:[1,0]
  v_pk_mul_f32 v[32:33], v[32:33], v[88:89]
  v_pk_mul_f32 v[34:35], v[34:35], v[90:91]
  v_cvt_pk_bf16_f32 v84, v32, v33
  v_cvt_pk_bf16_f32 v85, v34, v35
  v_pk_add_f32 v[36:37], v[36:37], v[60:61]
  v_pk_add_f32 v[38:39], v[38:39], v[62:63]
  v_lshlrev_b32 v88, 16, v74
  v_and_b32 v89, s47, v74
  v_lshlrev_b32 v90, 16, v75
  v_and_b32 v91, s47, v75
  v_pk_add_f32 v[36:37], v[36:37], v[92:93] op_sel_hi:[1,0]
  v_pk_add_f32 v[38:39], v[38:39], v[92:93] op_sel_hi:[1,0]
  v_pk_mul_f32 v[36:37], v[36:37], v[88:89]
  v_pk_mul_f32 v[38:39], v[38:39], v[90:91]
  v_cvt_pk_bf16_f32 v86, v36, v37
  v_cvt_pk_bf16_f32 v87, v38, v39
  buffer_store_dwordx4 v[84:87], v9, s[16:19], s40 offen offset:2048 sc1
  s_waitcnt vmcnt(0)
  s_barrier
  s_load_dwordx2 s[56:57], s[0:1], 0
  s_load_dwordx2 s[58:59], s[0:1], 88
  v_lshlrev_b32 v4, 4, v1
  s_lshl_b32 s35, s32, 2
  s_add_u32 s35, s35, s55
  s_lshr_b32 s39, s34, 2
  s_mul_i32 s36, s35, 24576
  s_mul_i32 s40, s39, 12288
  s_add_u32 s36, s36, s40
  s_add_u32 s36, s36, 12582912
  s_mul_i32 s40, s39, 61440
  v_add_u32 v26, s40, v4
  s_lshl_b32 s40, s35, 4
  s_mul_i32 s40, s40, 1280
  s_mul_i32 s41, s33, 160
  s_add_u32 s40, s40, s41
  v_add_u32 v12, 0, v1
  v_mul_u32_u24 v13, 6554, v12
  v_lshrrev_b32 v13, 16, v13
  v_mul_u32_u24 v14, 10, v13
  v_sub_u32 v14, v12, v14
  v_lshlrev_b32 v14, 4, v14
  v_mul_u32_u24 v13, 1280, v13
  v_add_u32 v13, v13, v14
  v_add_u32 v5, s40, v13
  v_add_u32 v12, 64, v1
  v_mul_u32_u24 v13, 6554, v12
  v_lshrrev_b32 v13, 16, v13
  v_mul_u32_u24 v14, 10, v13
  v_sub_u32 v14, v12, v14
  v_lshlrev_b32 v14, 4, v14
  v_mul_u32_u24 v13, 1280, v13
  v_add_u32 v13, v13, v14
  v_add_u32 v6, s40, v13
  v_add_u32 v12, 128, v1
  v_mul_u32_u24 v13, 6554, v12
  v_lshrrev_b32 v13, 16, v13
  v_mul_u32_u24 v14, 10, v13
  v_sub_u32 v14, v12, v14
  v_lshlrev_b32 v14, 4, v14
  v_mul_u32_u24 v13, 1280, v13
  v_add_u32 v13, v13, v14
  v_add_u32 v7, s40, v13
  s_mul_i32 s37, s55, 2560
  s_mul_i32 s38, s33, 327680
  s_lshl_b32 s41, s35, 5
  s_add_u32 s38, s38, s41
  s_add_u32 s38, s38, 9437184
  s_lshl_b32 s40, s55, 6
  s_add_u32 s40, s40, 143360
  v_lshlrev_b32 v21, 2, v3
  v_add_u32 v21, s40, v21
  ds_read_b32 v24, v21
  ds_read_b32 v25, v21 offset:256
  v_mov_b32 v68, 0
  v_mov_b32 v69, 0
  v_mov_b32 v70, 0
  v_mov_b32 v71, 0
  v_mov_b32 v72, 0
  v_mov_b32 v73, 0
  v_mov_b32 v74, 0
  v_mov_b32 v75, 0
  v_mov_b32 v76, 0
  v_mov_b32 v77, 0
  v_mov_b32 v78, 0
  v_mov_b32 v79, 0
  v_mov_b32 v80, 0
  v_mov_b32 v81, 0
  v_mov_b32 v82, 0
  v_mov_b32 v83, 0
  v_mov_b32 v84, 0
  v_mov_b32 v85, 0
  v_mov_b32 v86, 0
  v_mov_b32 v87, 0
  s_waitcnt lgkmcnt(0)
  s_mov_b32 s8, s56
  s_and_b32 s9, s57, 0xffff
  s_mov_b32 s10, 2621440
  s_mov_b32 s11, 0x20000
  s_mov_b32 s12, s58
  s_and_b32 s13, s59, 0xffff
  s_mov_b32 s14, 2621440
  s_mov_b32 s15, 0x20000
  s_add_u32 m0, s37, 122880
  s_nop 0
  buffer_load_dwordx4 v5, s[8:11], 0 offen lds
  s_add_u32 m0, s37, 123904
  s_nop 0
  buffer_load_dwordx4 v6, s[8:11], 0 offen lds
  s_mov_b32 exec_hi, 0
  s_add_u32 m0, s37, 124928
  s_nop 0
  buffer_load_dwordx4 v7, s[8:11], 0 offen lds
  s_mov_b32 exec_hi, -1
  s_barrier
  s_add_u32 s40, s36, 0
  buffer_load_dwordx4 v[88:91], v4, s[16:19], s40 offen offset:0 sc1
  s_add_u32 s40, s36, 0
  buffer_load_dwordx4 v[92:95], v4, s[16:19], s40 offen offset:1024 sc1
  s_add_u32 s40, s36, 0
  buffer_load_dwordx4 v[96:99], v4, s[16:19], s40 offen offset:2048 sc1
  s_add_u32 s40, s36, 0
  buffer_load_dwordx4 v[100:103], v4, s[16:19], s40 offen offset:3072 sc1
  s_add_u32 s40, s36, 4096
  buffer_load_dwordx4 v[104:107], v4, s[16:19], s40 offen offset:0 sc1
  s_barrier
  ds_read_b128 v[28:31], v26 offset:0
  ds_read_b128 v[32:35], v26 offset:1024
  ds_read_b128 v[36:39], v26 offset:2048
  ds_read_b128 v[40:43], v26 offset:3072
  ds_read_b128 v[44:47], v26 offset:4096
  s_waitcnt vmcnt(4) lgkmcnt(0)
  v_mfma_f32_16x16x32_bf16 v[68:71], v[28:31], v[88:91], v[68:71]
  ds_read_b128 v[48:51], v26 offset:5120
  v_mfma_f32_16x16x32_bf16 v[72:75], v[32:35], v[88:91], v[72:75]
  ds_read_b128 v[52:55], v26 offset:6144
  v_mfma_f32_16x16x32_bf16 v[76:79], v[36:39], v[88:91], v[76:79]
  ds_read_b128 v[56:59], v26 offset:7168
  s_add_u32 s40, s36, 4096
  buffer_load_dwordx4 v[108:111], v4, s[16:19], s40 offen offset:1024 sc1
  v_mfma_f32_16x16x32_bf16 v[80:83], v[40:43], v[88:91], v[80:83]
  ds_read_b128 v[60:63], v26 offset:8192
  v_mfma_f32_16x16x32_bf16 v[84:87], v[44:47], v[88:91], v[84:87]
  ds_read_b128 v[64:67], v26 offset:9216
  s_waitcnt vmcnt(4) lgkmcnt(0)
  v_mfma_f32_16x16x32_bf16 v[68:71], v[48:51], v[92:95], v[68:71]
  ds_read_b128 v[28:31], v26 offset:10240
  v_mfma_f32_16x16x32_bf16 v[72:75], v[52:55], v[92:95], v[72:75]
  ds_read_b128 v[32:35], v26 offset:11264
  v_mfma_f32_16x16x32_bf16 v[76:79], v[56:59], v[92:95], v[76:79]
  ds_read_b128 v[36:39], v26 offset:12288
  s_add_u32 s40, s36, 4096
  buffer_load_dwordx4 v[112:115], v4, s[16:19], s40 offen offset:2048 sc1
  v_mfma_f32_16x16x32_bf16 v[80:83], v[60:63], v[92:95], v[80:83]
  ds_read_b128 v[40:43], v26 offset:13312
  v_mfma_f32_16x16x32_bf16 v[84:87], v[64:67], v[92:95], v[84:87]
  ds_read_b128 v[44:47], v26 offset:14336
  s_waitcnt vmcnt(4) lgkmcnt(0)
  v_mfma_f32_16x16x32_bf16 v[68:71], v[28:31], v[96:99], v[68:71]
  ds_read_b128 v[48:51], v26 offset:15360
  v_mfma_f32_16x16x32_bf16 v[72:75], v[32:35], v[96:99], v[72:75]
  ds_read_b128 v[52:55], v26 offset:16384
  v_mfma_f32_16x16x32_bf16 v[76:79], v[36:39], v[96:99], v[76:79]
  ds_read_b128 v[56:59], v26 offset:17408
  s_add_u32 s40, s36, 4096
  buffer_load_dwordx4 v[116:119], v4, s[16:19], s40 offen offset:3072 sc1
  v_mfma_f32_16x16x32_bf16 v[80:83], v[40:43], v[96:99], v[80:83]
  ds_read_b128 v[60:63], v26 offset:18432
  v_mfma_f32_16x16x32_bf16 v[84:87], v[44:47], v[96:99], v[84:87]
  ds_read_b128 v[64:67], v26 offset:19456
  s_waitcnt vmcnt(4) lgkmcnt(0)
  s_barrier
  v_mfma_f32_16x16x32_bf16 v[68:71], v[48:51], v[100:103], v[68:71]
  ds_read_b128 v[28:31], v26 offset:20480
  v_mfma_f32_16x16x32_bf16 v[72:75], v[52:55], v[100:103], v[72:75]
  ds_read_b128 v[32:35], v26 offset:21504
  v_mfma_f32_16x16x32_bf16 v[76:79], v[56:59], v[100:103], v[76:79]
  ds_read_b128 v[36:39], v26 offset:22528
  s_add_u32 s40, s36, 8192
  buffer_load_dwordx4 v[120:123], v4, s[16:19], s40 offen offset:0 sc1
  v_mfma_f32_16x16x32_bf16 v[80:83], v[60:63], v[100:103], v[80:83]
  ds_read_b128 v[40:43], v26 offset:23552
  v_mfma_f32_16x16x32_bf16 v[84:87], v[64:67], v[100:103], v[84:87]
  ds_read_b128 v[44:47], v26 offset:24576
  s_waitcnt vmcnt(4) lgkmcnt(0)
  v_mfma_f32_16x16x32_bf16 v[68:71], v[28:31], v[104:107], v[68:71]
  ds_read_b128 v[48:51], v26 offset:25600
  v_mfma_f32_16x16x32_bf16 v[72:75], v[32:35], v[104:107], v[72:75]
  ds_read_b128 v[52:55], v26 offset:26624
  v_mfma_f32_16x16x32_bf16 v[76:79], v[36:39], v[104:107], v[76:79]
  ds_read_b128 v[56:59], v26 offset:27648
  s_add_u32 s40, s36, 8192
  buffer_load_dwordx4 v[124:127], v4, s[16:19], s40 offen offset:1024 sc1
  v_mfma_f32_16x16x32_bf16 v[80:83], v[40:43], v[104:107], v[80:83]
  ds_read_b128 v[60:63], v26 offset:28672
  v_mfma_f32_16x16x32_bf16 v[84:87], v[44:47], v[104:107], v[84:87]
  ds_read_b128 v[64:67], v26 offset:29696
  s_waitcnt vmcnt(4) lgkmcnt(0)
  v_mfma_f32_16x16x32_bf16 v[68:71], v[48:51], v[108:111], v[68:71]
  ds_read_b128 v[28:31], v26 offset:30720
  v_mfma_f32_16x16x32_bf16 v[72:75], v[52:55], v[108:111], v[72:75]
  ds_read_b128 v[32:35], v26 offset:31744
  v_mfma_f32_16x16x32_bf16 v[76:79], v[56:59], v[108:111], v[76:79]
  ds_read_b128 v[36:39], v26 offset:32768
  s_add_u32 s40, s36, 8192
  buffer_load_dwordx4 v[128:131], v4, s[16:19], s40 offen offset:2048 sc1
  v_mfma_f32_16x16x32_bf16 v[80:83], v[60:63], v[108:111], v[80:83]
  ds_read_b128 v[40:43], v26 offset:33792
  v_mfma_f32_16x16x32_bf16 v[84:87], v[64:67], v[108:111], v[84:87]
  ds_read_b128 v[44:47], v26 offset:34816
  s_waitcnt vmcnt(4) lgkmcnt(0)
  v_mfma_f32_16x16x32_bf16 v[68:71], v[28:31], v[112:115], v[68:71]
  ds_read_b128 v[48:51], v26 offset:35840
  v_mfma_f32_16x16x32_bf16 v[72:75], v[32:35], v[112:115], v[72:75]
  ds_read_b128 v[52:55], v26 offset:36864
  v_mfma_f32_16x16x32_bf16 v[76:79], v[36:39], v[112:115], v[76:79]
  ds_read_b128 v[56:59], v26 offset:37888
  s_add_u32 s40, s36, 8192
  buffer_load_dwordx4 v[132:135], v4, s[16:19], s40 offen offset:3072 sc1
  v_mfma_f32_16x16x32_bf16 v[80:83], v[40:43], v[112:115], v[80:83]
  ds_read_b128 v[60:63], v26 offset:38912
  v_mfma_f32_16x16x32_bf16 v[84:87], v[44:47], v[112:115], v[84:87]
  ds_read_b128 v[64:67], v26 offset:39936
  s_waitcnt vmcnt(4) lgkmcnt(0)
  s_barrier
  v_mfma_f32_16x16x32_bf16 v[68:71], v[48:51], v[116:119], v[68:71]
  ds_read_b128 v[28:31], v26 offset:40960
  v_mfma_f32_16x16x32_bf16 v[72:75], v[52:55], v[116:119], v[72:75]
  ds_read_b128 v[32:35], v26 offset:41984
  v_mfma_f32_16x16x32_bf16 v[76:79], v[56:59], v[116:119], v[76:79]
  ds_read_b128 v[36:39], v26 offset:43008
  v_mfma_f32_16x16x32_bf16 v[80:83], v[60:63], v[116:119], v[80:83]
  ds_read_b128 v[40:43], v26 offset:44032
  v_mfma_f32_16x16x32_bf16 v[84:87], v[64:67], v[116:119], v[84:87]
  ds_read_b128 v[44:47], v26 offset:45056
  s_waitcnt vmcnt(3) lgkmcnt(0)
  v_mfma_f32_16x16x32_bf16 v[68:71], v[28:31], v[120:123], v[68:71]
  ds_read_b128 v[48:51], v26 offset:46080
  v_mfma_f32_16x16x32_bf16 v[72:75], v[32:35], v[120:123], v[72:75]
  ds_read_b128 v[52:55], v26 offset:47104
  v_mfma_f32_16x16x32_bf16 v[76:79], v[36:39], v[120:123], v[76:79]
  ds_read_b128 v[56:59], v26 offset:48128
  v_mfma_f32_16x16x32_bf16 v[80:83], v[40:43], v[120:123], v[80:83]
  ds_read_b128 v[60:63], v26 offset:49152
  v_mfma_f32_16x16x32_bf16 v[84:87], v[44:47], v[120:123], v[84:87]
  ds_read_b128 v[64:67], v26 offset:50176
  s_waitcnt vmcnt(2) lgkmcnt(0)
  v_mfma_f32_16x16x32_bf16 v[68:71], v[48:51], v[124:127], v[68:71]
  ds_read_b128 v[28:31], v26 offset:51200
  v_mfma_f32_16x16x32_bf16 v[72:75], v[52:55], v[124:127], v[72:75]
  ds_read_b128 v[32:35], v26 offset:52224
  v_mfma_f32_16x16x32_bf16 v[76:79], v[56:59], v[124:127], v[76:79]
  ds_read_b128 v[36:39], v26 offset:53248
  v_mfma_f32_16x16x32_bf16 v[80:83], v[60:63], v[124:127], v[80:83]
  ds_read_b128 v[40:43], v26 offset:54272
  v_mfma_f32_16x16x32_bf16 v[84:87], v[64:67], v[124:127], v[84:87]
  ds_read_b128 v[44:47], v26 offset:55296
  s_waitcnt vmcnt(1) lgkmcnt(0)
  v_mfma_f32_16x16x32_bf16 v[68:71], v[28:31], v[128:131], v[68:71]
  ds_read_b128 v[48:51], v26 offset:56320
  v_mfma_f32_16x16x32_bf16 v[72:75], v[32:35], v[128:131], v[72:75]
  ds_read_b128 v[52:55], v26 offset:57344
  v_mfma_f32_16x16x32_bf16 v[76:79], v[36:39], v[128:131], v[76:79]
  ds_read_b128 v[56:59], v26 offset:58368
  v_mfma_f32_16x16x32_bf16 v[80:83], v[40:43], v[128:131], v[80:83]
  ds_read_b128 v[60:63], v26 offset:59392
  v_mfma_f32_16x16x32_bf16 v[84:87], v[44:47], v[128:131], v[84:87]
  ds_read_b128 v[64:67], v26 offset:60416
  s_waitcnt vmcnt(0) lgkmcnt(0)
  v_mfma_f32_16x16x32_bf16 v[68:71], v[48:51], v[132:135], v[68:71]
  v_mfma_f32_16x16x32_bf16 v[72:75], v[52:55], v[132:135], v[72:75]
  v_mfma_f32_16x16x32_bf16 v[76:79], v[56:59], v[132:135], v[76:79]
  v_mfma_f32_16x16x32_bf16 v[80:83], v[60:63], v[132:135], v[80:83]
  v_mfma_f32_16x16x32_bf16 v[84:87], v[64:67], v[132:135], v[84:87]
  s_waitcnt vmcnt(0) lgkmcnt(0)
  s_barrier
  s_mul_i32 s40, s55, 5120
  v_add_u32 v12, s40, v4
  s_nop 2
  ds_write_b128 v12, v[80:83] offset:3072
  ds_write_b128 v12, v[84:87] offset:4096
  v_mul_u32_u24 v13, 160, v3
  v_lshlrev_b32 v14, 3, v2
  v_add_u32 v13, v13, v14
  s_add_u32 s40, s37, 122880
  v_add_u32 v13, s40, v13
  v_lshlrev_b32 v14, 7, v2
  v_lshlrev_b32 v15, 3, v3
  v_add_u32 v14, v14, v15
  s_add_u32 s40, s37, 133120
  v_add_u32 v14, s40, v14
  ds_read_b64 v[88:89], v13 offset:0
  ds_read_b64_tr_b16 v[98:99], v14 offset:0
  ds_read_b64 v[90:91], v13 offset:32
  ds_read_b64_tr_b16 v[100:101], v14 offset:512
  ds_read_b64 v[92:93], v13 offset:64
  ds_read_b64_tr_b16 v[102:103], v14 offset:1024
  v_sub_f32 v16, 0, v24
  v_mov_b32 v18, v25
  s_mov_b32 s48, 1.0
  s_mov_b32 s49, 1.0
  v_mov_b32 v20, 0xbfb8aa3b
  v_mov_b32 v21, 0xbfb8aa3b
  s_waitcnt lgkmcnt(0)
  s_barrier
  ds_read_b128 v[108:111], v12 offset:0
  ds_read_b128 v[112:115], v12 offset:1024
  ds_read_b128 v[116:119], v12 offset:2048
  s_waitcnt lgkmcnt(0)
  v_pk_add_f32 v[68:69], v[68:69], v[108:109]
  v_lshlrev_b32 v28, 16, v88
  v_and_b32 v29, s47, v88
  v_pk_mul_f32 v[32:33], v[68:69], v[20:21]
  v_lshlrev_b32 v30, 16, v98
  v_and_b32 v31, s47, v98
  v_exp_f32 v32, v32
  v_exp_f32 v33, v33
  v_pk_add_f32 v[34:35], v[28:29], v[16:17] op_sel_hi:[1,0]
  v_pk_add_f32 v[32:33], v[32:33], s[48:49]
  v_pk_mul_f32 v[34:35], v[34:35], v[18:19] op_sel_hi:[1,0]
  v_rcp_f32 v32, v32
  v_rcp_f32 v33, v33
  v_pk_mul_f32 v[34:35], v[34:35], v[30:31]
  v_pk_mul_f32 v[32:33], v[32:33], v[68:69]
  v_pk_fma_f32 v[34:35], v[34:35], v[32:33], v[28:29]
  v_cvt_pk_bf16_f32 v88, v34, v35
  v_pk_add_f32 v[70:71], v[70:71], v[110:111]
  v_lshlrev_b32 v36, 16, v89
  v_and_b32 v37, s47, v89
  v_pk_mul_f32 v[40:41], v[70:71], v[20:21]
  v_lshlrev_b32 v38, 16, v99
  v_and_b32 v39, s47, v99
  v_exp_f32 v40, v40
  v_exp_f32 v41, v41
  v_pk_add_f32 v[42:43], v[36:37], v[16:17] op_sel_hi:[1,0]
  v_pk_add_f32 v[40:41], v[40:41], s[48:49]
  v_pk_mul_f32 v[42:43], v[42:43], v[18:19] op_sel_hi:[1,0]
  v_rcp_f32 v40, v40
  v_rcp_f32 v41, v41
  v_pk_mul_f32 v[42:43], v[42:43], v[38:39]
  v_pk_mul_f32 v[40:41], v[40:41], v[70:71]
  v_pk_fma_f32 v[42:43], v[42:43], v[40:41], v[36:37]
  v_cvt_pk_bf16_f32 v89, v42, v43
  ds_write_b64 v13, v[88:89] offset:0
  v_pk_add_f32 v[72:73], v[72:73], v[112:113]
  v_lshlrev_b32 v28, 16, v90
  v_and_b32 v29, s47, v90
  v_pk_mul_f32 v[32:33], v[72:73], v[20:21]
  v_lshlrev_b32 v30, 16, v100
  v_and_b32 v31, s47, v100
  v_exp_f32 v32, v32
  v_exp_f32 v33, v33
  v_pk_add_f32 v[34:35], v[28:29], v[16:17] op_sel_hi:[1,0]
  v_pk_add_f32 v[32:33], v[32:33], s[48:49]
  v_pk_mul_f32 v[34:35], v[34:35], v[18:19] op_sel_hi:[1,0]
  v_rcp_f32 v32, v32
  v_rcp_f32 v33, v33
  v_pk_mul_f32 v[34:35], v[34:35], v[30:31]
  v_pk_mul_f32 v[32:33], v[32:33], v[72:73]
  v_pk_fma_f32 v[34:35], v[34:35], v[32:33], v[28:29]
  v_cvt_pk_bf16_f32 v90, v34, v35
  v_pk_add_f32 v[74:75], v[74:75], v[114:115]
  v_lshlrev_b32 v36, 16, v91
  v_and_b32 v37, s47, v91
  v_pk_mul_f32 v[40:41], v[74:75], v[20:21]
  v_lshlrev_b32 v38, 16, v101
  v_and_b32 v39, s47, v101
  v_exp_f32 v40, v40
  v_exp_f32 v41, v41
  v_pk_add_f32 v[42:43], v[36:37], v[16:17] op_sel_hi:[1,0]
  v_pk_add_f32 v[40:41], v[40:41], s[48:49]
  v_pk_mul_f32 v[42:43], v[42:43], v[18:19] op_sel_hi:[1,0]
  v_rcp_f32 v40, v40
  v_rcp_f32 v41, v41
  v_pk_mul_f32 v[42:43], v[42:43], v[38:39]
  v_pk_mul_f32 v[40:41], v[40:41], v[74:75]
  v_pk_fma_f32 v[42:43], v[42:43], v[40:41], v[36:37]
  v_cvt_pk_bf16_f32 v91, v42, v43
  ds_write_b64 v13, v[90:91] offset:32
  v_pk_add_f32 v[76:77], v[76:77], v[116:117]
  v_lshlrev_b32 v28, 16, v92
  v_and_b32 v29, s47, v92
  v_pk_mul_f32 v[32:33], v[76:77], v[20:21]
  v_lshlrev_b32 v30, 16, v102
  v_and_b32 v31, s47, v102
  v_exp_f32 v32, v32
  v_exp_f32 v33, v33
  v_pk_add_f32 v[34:35], v[28:29], v[16:17] op_sel_hi:[1,0]
  v_pk_add_f32 v[32:33], v[32:33], s[48:49]
  v_pk_mul_f32 v[34:35], v[34:35], v[18:19] op_sel_hi:[1,0]
  v_rcp_f32 v32, v32
  v_rcp_f32 v33, v33
  v_pk_mul_f32 v[34:35], v[34:35], v[30:31]
  v_pk_mul_f32 v[32:33], v[32:33], v[76:77]
  v_pk_fma_f32 v[34:35], v[34:35], v[32:33], v[28:29]
  v_cvt_pk_bf16_f32 v92, v34, v35
  v_pk_add_f32 v[78:79], v[78:79], v[118:119]
  v_lshlrev_b32 v36, 16, v93
  v_and_b32 v37, s47, v93
  v_pk_mul_f32 v[40:41], v[78:79], v[20:21]
  v_lshlrev_b32 v38, 16, v103
  v_and_b32 v39, s47, v103
  v_exp_f32 v40, v40
  v_exp_f32 v41, v41
  v_pk_add_f32 v[42:43], v[36:37], v[16:17] op_sel_hi:[1,0]
  v_pk_add_f32 v[40:41], v[40:41], s[48:49]
  v_pk_mul_f32 v[42:43], v[42:43], v[18:19] op_sel_hi:[1,0]
  v_rcp_f32 v40, v40
  v_rcp_f32 v41, v41
  v_pk_mul_f32 v[42:43], v[42:43], v[38:39]
  v_pk_mul_f32 v[40:41], v[40:41], v[78:79]
  v_pk_fma_f32 v[42:43], v[42:43], v[40:41], v[36:37]
  v_cvt_pk_bf16_f32 v93, v42, v43
  ds_write_b64 v13, v[92:93] offset:64
  s_waitcnt lgkmcnt(0)
  s_barrier
  s_add_u32 s40, s37, 122880
  v_add_u32 v13, s40, v4
  ds_read_b128 v[108:111], v13 offset:0
  ds_read_b128 v[112:115], v13 offset:1024
  s_waitcnt lgkmcnt(0)
  buffer_store_dwordx4 v[108:111], v5, s[12:15], 0 offen
  buffer_store_dwordx4 v[112:115], v6, s[12:15], 0 offen
  s_mov_b64 exec, s[52:53]
  s_endpgm
K1_B:
  s_cmp_eq_u32 s34, 4
  s_cbranch_scc0 K1_NORST
  s_lshl_b32 s40, s32, 3
  s_add_u32 s40, s40, s33
  s_lshl_b32 s40, s40, 9
  s_add_u32 s40, s40, 16842752
  v_lshlrev_b32 v15, 3, v1
  v_mov_b32 v20, 0
  v_mov_b32 v21, 0xbf800000
  buffer_store_dwordx2 v[20:21], v15, s[16:19], s40 offen sc1
  s_lshl_b32 s40, s33, 7
  s_lshl_b32 s41, s32, 2
  s_add_u32 s40, s40, s41
  s_add_u32 s41, s40, 17040384
  s_add_u32 s40, s40, 17039360
  v_mov_b32 v15, s40
  v_mov_b32 v16, s41
  v_cmp_eq_u32 vcc, 1, v1
  s_nop 1
  v_cndmask_b32 v15, v15, v16, vcc
  s_lshl_b32 s40, s32, 5
  s_lshl_b32 s41, s33, 2
  s_add_u32 s40, s40, s41
  s_add_u32 s40, s40, 17041408
  v_mov_b32 v16, s40
  v_cmp_eq_u32 vcc, 2, v1
  s_nop 1
  v_cndmask_b32 v15, v15, v16, vcc
  s_lshl_b32 s40, s33, 7
  s_lshl_b32 s41, s32, 2
  s_add_u32 s40, s40, s41
  s_add_u32 s40, s40, 17042432
  v_mov_b32 v16, s40
  v_cmp_eq_u32 vcc, 3, v1
  s_nop 1
  v_cndmask_b32 v15, v15, v16, vcc
  s_mov_b32 exec_lo, 0xf
  s_mov_b32 exec_hi, 0x0
  buffer_store_dword v20, v15, s[16:19], 0 offen sc1
  s_mov_b64 exec, s[52:53]
K1_NORST:
  s_lshl_b32 s40, s2, 2
  s_add_u32 s40, s40, s55
  s_mul_i32 s41, s40, 2731
  s_lshr_b32 s41, s41, 16
  s_mul_i32 s42, s41, 24
  s_sub_u32 s42, s40, s42
  s_mov_b32 s72, s40
  v_mul_u32_u24 v17, 5120, v2
  v_lshlrev_b32 v18, 1, v3
  v_add_u32 v17, v17, v18
  s_lshl_b32 s41, s41, 5
  s_mul_i32 s42, s42, 40960
  s_add_u32 s41, s41, s42
  s_add_u32 s42, s41, 20480
  s_barrier
  s_mov_b32 s28, s66
  s_and_b32 s29, s67, 0xffff
  s_mov_b32 s30, 983040
  s_mov_b32 s31, 0x20000
  buffer_load_ushort v152, v17, s[28:31], s41 offen offset:0
  buffer_load_ushort v153, v17, s[28:31], s41 offen offset:1280
  buffer_load_ushort v154, v17, s[28:31], s41 offen offset:2560
  buffer_load_ushort v155, v17, s[28:31], s41 offen offset:3840
  buffer_load_ushort v156, v17, s[28:31], s42 offen offset:0
  buffer_load_ushort v157, v17, s[28:31], s42 offen offset:1280
  buffer_load_ushort v158, v17, s[28:31], s42 offen offset:2560
  buffer_load_ushort v159, v17, s[28:31], s42 offen offset:3840
  s_barrier
  s_barrier
  s_cmp_eq_u32 s34, 4
  s_cbranch_scc0 K1_NOCNT
  s_waitcnt vmcnt(8)
  s_lshl_b32 s39, s32, 2
  v_mov_b32 v20, s39
  v_mov_b32 v21, 1
  s_mov_b32 exec_lo, 0x1
  s_mov_b32 exec_hi, 0x0
  buffer_atomic_add v21, v20, s[4:7], 0 offen offset:0 sc1
  s_mov_b64 exec, s[52:53]
K1_NOCNT:
  s_barrier
  s_barrier
  s_barrier
  s_barrier
  s_barrier
  s_barrier
  v_lshlrev_b32 v144, 6, v1
  s_and_b32 s54, s2, 7
  s_lshl_b32 s54, s54, 8
  s_lshr_b32 s39, s2, 3
  s_lshl_b32 s39, s39, 3
  s_add_u32 s54, s54, s39
  s_lshl_b32 s54, s54, 12
  s_mov_b32 s20, s74
  s_and_b32 s21, s75, 0xffff
  s_mov_b32 s22, 8388608
  s_mov_b32 s23, 0x20000
  s_mov_b32 s46, 0
  s_cmp_ge_u32 s72, 960
  s_cbranch_scc1 K1_NOWOF
  s_waitcnt vmcnt(0)
  v_lshl_or_b32 v164, v153, 16, v152
  v_lshl_or_b32 v165, v155, 16, v154
  v_lshl_or_b32 v166, v157, 16, v156
  v_lshl_or_b32 v167, v159, 16, v158
  v_lshlrev_b32 v17, 4, v1
  s_lshl_b32 s40, s72, 10
  s_add_u32 s40, s40, 15728640
  buffer_store_dwordx4 v[164:167], v17, s[16:19], s40 offen sc1
K1_NOWOF:
  s_barrier
  v_mov_b32 v102, 0x3f803f80
  v_mov_b32 v103, 0x3f803f80
  v_mov_b32 v104, 0x3f803f80
  v_mov_b32 v105, 0x3f803f80
  v_mov_b32 v66, 0
  v_mov_b32 v67, 0
  v_mov_b32 v68, 0
  v_mov_b32 v69, 0
  v_mov_b32 v70, 0
  v_mov_b32 v71, 0
  v_mov_b32 v72, 0
  v_mov_b32 v73, 0
  v_mov_b32 v74, 0
  v_mov_b32 v75, 0
  v_mov_b32 v76, 0
  v_mov_b32 v77, 0
  v_mov_b32 v78, 0
  v_mov_b32 v79, 0
  v_mov_b32 v80, 0
  v_mov_b32 v81, 0
  v_mov_b32 v82, 0
  v_mov_b32 v83, 0
  v_mov_b32 v84, 0
  v_mov_b32 v85, 0
  v_mov_b32 v86, 0
  v_mov_b32 v87, 0
  v_mov_b32 v88, 0
  v_mov_b32 v89, 0
  v_mov_b32 v90, 0
  v_mov_b32 v91, 0
  v_mov_b32 v92, 0
  v_mov_b32 v93, 0
  v_mov_b32 v94, 0
  v_mov_b32 v95, 0
  v_mov_b32 v96, 0
  v_mov_b32 v97, 0
  v_mov_b32 v98, 0
  v_mov_b32 v99, 0
  v_mov_b32 v100, 0
  v_mov_b32 v101, 0
  v_mov_b32 v106, 0
  v_mov_b32 v107, 0
  v_mov_b32 v108, 0
  v_mov_b32 v109, 0
  v_mov_b32 v110, 0
  v_mov_b32 v111, 0
  v_mov_b32 v112, 0
  v_mov_b32 v113, 0
  s_barrier
  s_mov_b32 s37, 0
  ds_read_b128 v[26:29], v4 offset:0
  ds_read_b64_tr_b16 v[42:43], v8 offset:0
  ds_read_b64_tr_b16 v[44:45], v8 offset:768
  ds_read_b128 v[30:33], v6 offset:0
  ds_read_b64_tr_b16 v[46:47], v9 offset:0
  ds_read_b64_tr_b16 v[48:49], v9 offset:768
  ds_read_b64_tr_b16 v[50:51], v10 offset:0
  ds_read_b64_tr_b16 v[52:53], v10 offset:768
K1_LOOP2:
  s_waitcnt lgkmcnt(0)
  v_mfma_f32_16x16x32_bf16 v[66:69], v[42:45], v[26:29], v[66:69]
  ds_read_b128 v[34:37], v5 offset:0
  ds_read_b64_tr_b16 v[54:55], v8 offset:6144
  v_mfma_f32_16x16x32_bf16 v[78:81], v[42:45], v[30:33], v[78:81]
  ds_read_b64_tr_b16 v[56:57], v8 offset:6912
  ds_read_b128 v[38:41], v7 offset:0
  v_mfma_f32_16x16x32_bf16 v[70:73], v[46:49], v[26:29], v[70:73]
  ds_read_b64_tr_b16 v[58:59], v9 offset:6144
  ds_read_b64_tr_b16 v[60:61], v9 offset:6912
  v_mfma_f32_16x16x32_bf16 v[82:85], v[46:49], v[30:33], v[82:85]
  ds_read_b64_tr_b16 v[62:63], v10 offset:6144
  ds_read_b64_tr_b16 v[64:65], v10 offset:6912
  v_mfma_f32_16x16x32_bf16 v[74:77], v[50:53], v[26:29], v[74:77]
  v_mfma_f32_16x16x32_bf16 v[86:89], v[50:53], v[30:33], v[86:89]
  s_cmp_eq_u32 s35, 0
  s_cbranch_scc0 K1_SK_2a0
  v_mfma_f32_16x16x32_bf16 v[90:93], v[42:45], v[102:105], v[90:93]
  v_mfma_f32_16x16x32_bf16 v[94:97], v[46:49], v[102:105], v[94:97]
  v_mfma_f32_16x16x32_bf16 v[98:101], v[50:53], v[102:105], v[98:101]
K1_SK_2a0:
  s_waitcnt lgkmcnt(0)
  s_barrier
  v_mfma_f32_16x16x32_bf16 v[66:69], v[54:57], v[34:37], v[66:69]
  ds_read_b128 v[26:29], v4 offset:8192
  ds_read_b64_tr_b16 v[42:43], v8 offset:12288
  v_mfma_f32_16x16x32_bf16 v[78:81], v[54:57], v[38:41], v[78:81]
  ds_read_b64_tr_b16 v[44:45], v8 offset:13056
  ds_read_b128 v[30:33], v6 offset:8192
  v_mfma_f32_16x16x32_bf16 v[70:73], v[58:61], v[34:37], v[70:73]
  ds_read_b64_tr_b16 v[46:47], v9 offset:12288
  ds_read_b64_tr_b16 v[48:49], v9 offset:13056
  v_mfma_f32_16x16x32_bf16 v[82:85], v[58:61], v[38:41], v[82:85]
  ds_read_b64_tr_b16 v[50:51], v10 offset:12288
  ds_read_b64_tr_b16 v[52:53], v10 offset:13056
  v_mfma_f32_16x16x32_bf16 v[74:77], v[62:65], v[34:37], v[74:77]
  v_mfma_f32_16x16x32_bf16 v[86:89], v[62:65], v[38:41], v[86:89]
  s_cmp_eq_u32 s35, 1
  s_cbranch_scc0 K1_SK_2b0
  v_mfma_f32_16x16x32_bf16 v[90:93], v[54:57], v[102:105], v[90:93]
  v_mfma_f32_16x16x32_bf16 v[94:97], v[58:61], v[102:105], v[94:97]
  v_mfma_f32_16x16x32_bf16 v[98:101], v[62:65], v[102:105], v[98:101]
K1_SK_2b0:
  s_and_b32 s40, s46, 3
  s_cmp_eq_u32 s40, s55
  s_cbranch_scc0 K1_NT0
  s_cmp_lt_u32 s46, 8
  s_cbranch_scc0 K1_NT0
  buffer_load_dword v148, v144, s[20:23], s54 offen
K1_NT0:
  s_add_u32 s46, s46, 1
  s_add_u32 s54, s54, 4096
  s_waitcnt lgkmcnt(0)
  v_mfma_f32_16x16x32_bf16 v[66:69], v[42:45], v[26:29], v[66:69]
  ds_read_b128 v[34:37], v5 offset:8192
  ds_read_b64_tr_b16 v[54:55], v8 offset:18432
  v_mfma_f32_16x16x32_bf16 v[78:81], v[42:45], v[30:33], v[78:81]
  ds_read_b64_tr_b16 v[56:57], v8 offset:19200
  ds_read_b128 v[38:41], v7 offset:8192
  v_mfma_f32_16x16x32_bf16 v[70:73], v[46:49], v[26:29], v[70:73]
  ds_read_b64_tr_b16 v[58:59], v9 offset:18432
  ds_read_b64_tr_b16 v[60:61], v9 offset:19200
  v_mfma_f32_16x16x32_bf16 v[82:85], v[46:49], v[30:33], v[82:85]
  ds_read_b64_tr_b16 v[62:63], v10 offset:18432
  ds_read_b64_tr_b16 v[64:65], v10 offset:19200
  v_mfma_f32_16x16x32_bf16 v[74:77], v[50:53], v[26:29], v[74:77]
  v_mfma_f32_16x16x32_bf16 v[86:89], v[50:53], v[30:33], v[86:89]
  s_cmp_eq_u32 s35, 0
  s_cbranch_scc0 K1_SK_2a1
  v_mfma_f32_16x16x32_bf16 v[90:93], v[42:45], v[102:105], v[90:93]
  v_mfma_f32_16x16x32_bf16 v[94:97], v[46:49], v[102:105], v[94:97]
  v_mfma_f32_16x16x32_bf16 v[98:101], v[50:53], v[102:105], v[98:101]
K1_SK_2a1:
  s_waitcnt lgkmcnt(0)
  s_barrier
  v_mfma_f32_16x16x32_bf16 v[66:69], v[54:57], v[34:37], v[66:69]
  ds_read_b128 v[26:29], v4 offset:16384
  ds_read_b64_tr_b16 v[42:43], v8 offset:24576
  v_mfma_f32_16x16x32_bf16 v[78:81], v[54:57], v[38:41], v[78:81]
  ds_read_b64_tr_b16 v[44:45], v8 offset:25344
  ds_read_b128 v[30:33], v6 offset:16384
  v_mfma_f32_16x16x32_bf16 v[70:73], v[58:61], v[34:37], v[70:73]
  ds_read_b64_tr_b16 v[46:47], v9 offset:24576
  ds_read_b64_tr_b16 v[48:49], v9 offset:25344
  v_mfma_f32_16x16x32_bf16 v[82:85], v[58:61], v[38:41], v[82:85]
  ds_read_b64_tr_b16 v[50:51], v10 offset:24576
  ds_read_b64_tr_b16 v[52:53], v10 offset:25344
  v_mfma_f32_16x16x32_bf16 v[74:77], v[62:65], v[34:37], v[74:77]
  v_mfma_f32_16x16x32_bf16 v[86:89], v[62:65], v[38:41], v[86:89]
  s_cmp_eq_u32 s35, 1
  s_cbranch_scc0 K1_SK_2b1
  v_mfma_f32_16x16x32_bf16 v[90:93], v[54:57], v[102:105], v[90:93]
  v_mfma_f32_16x16x32_bf16 v[94:97], v[58:61], v[102:105], v[94:97]
  v_mfma_f32_16x16x32_bf16 v[98:101], v[62:65], v[102:105], v[98:101]
K1_SK_2b1:
  s_and_b32 s40, s46, 3
  s_cmp_eq_u32 s40, s55
  s_cbranch_scc0 K1_NT1
  s_cmp_lt_u32 s46, 8
  s_cbranch_scc0 K1_NT1
  buffer_load_dword v148, v144, s[20:23], s54 offen
K1_NT1:
  s_add_u32 s46, s46, 1
  s_add_u32 s54, s54, 4096
  s_waitcnt lgkmcnt(0)
  v_mfma_f32_16x16x32_bf16 v[66:69], v[42:45], v[26:29], v[66:69]
  ds_read_b128 v[34:37], v5 offset:16384
  ds_read_b64_tr_b16 v[54:55], v8 offset:30720
  v_mfma_f32_16x16x32_bf16 v[78:81], v[42:45], v[30:33], v[78:81]
  ds_read_b64_tr_b16 v[56:57], v8 offset:31488
  ds_read_b128 v[38:41], v7 offset:16384
  v_mfma_f32_16x16x32_bf16 v[70:73], v[46:49], v[26:29], v[70:73]
  ds_read_b64_tr_b16 v[58:59], v9 offset:30720
  ds_read_b64_tr_b16 v[60:61], v9 offset:31488
  v_mfma_f32_16x16x32_bf16 v[82:85], v[46:49], v[30:33], v[82:85]
  ds_read_b64_tr_b16 v[62:63], v10 offset:30720
  ds_read_b64_tr_b16 v[64:65], v10 offset:31488
  v_mfma_f32_16x16x32_bf16 v[74:77], v[50:53], v[26:29], v[74:77]
  v_mfma_f32_16x16x32_bf16 v[86:89], v[50:53], v[30:33], v[86:89]
  s_cmp_eq_u32 s35, 0
  s_cbranch_scc0 K1_SK_2a2
  v_mfma_f32_16x16x32_bf16 v[90:93], v[42:45], v[102:105], v[90:93]
  v_mfma_f32_16x16x32_bf16 v[94:97], v[46:49], v[102:105], v[94:97]
  v_mfma_f32_16x16x32_bf16 v[98:101], v[50:53], v[102:105], v[98:101]
K1_SK_2a2:
  s_waitcnt lgkmcnt(0)
  s_barrier
  v_mfma_f32_16x16x32_bf16 v[66:69], v[54:57], v[34:37], v[66:69]
  ds_read_b128 v[26:29], v4 offset:24576
  ds_read_b64_tr_b16 v[42:43], v8 offset:36864
  v_mfma_f32_16x16x32_bf16 v[78:81], v[54:57], v[38:41], v[78:81]
  ds_read_b64_tr_b16 v[44:45], v8 offset:37632
  ds_read_b128 v[30:33], v6 offset:24576
  v_mfma_f32_16x16x32_bf16 v[70:73], v[58:61], v[34:37], v[70:73]
  ds_read_b64_tr_b16 v[46:47], v9 offset:36864
  ds_read_b64_tr_b16 v[48:49], v9 offset:37632
  v_mfma_f32_16x16x32_bf16 v[82:85], v[58:61], v[38:41], v[82:85]
  ds_read_b64_tr_b16 v[50:51], v10 offset:36864
  ds_read_b64_tr_b16 v[52:53], v10 offset:37632
  v_mfma_f32_16x16x32_bf16 v[74:77], v[62:65], v[34:37], v[74:77]
  v_mfma_f32_16x16x32_bf16 v[86:89], v[62:65], v[38:41], v[86:89]
  s_cmp_eq_u32 s35, 1
  s_cbranch_scc0 K1_SK_2b2
  v_mfma_f32_16x16x32_bf16 v[90:93], v[54:57], v[102:105], v[90:93]
  v_mfma_f32_16x16x32_bf16 v[94:97], v[58:61], v[102:105], v[94:97]
  v_mfma_f32_16x16x32_bf16 v[98:101], v[62:65], v[102:105], v[98:101]
K1_SK_2b2:
  s_and_b32 s40, s46, 3
  s_cmp_eq_u32 s40, s55
  s_cbranch_scc0 K1_NT2
  s_cmp_lt_u32 s46, 8
  s_cbranch_scc0 K1_NT2
  buffer_load_dword v148, v144, s[20:23], s54 offen
K1_NT2:
  s_add_u32 s46, s46, 1
  s_add_u32 s54, s54, 4096
  s_waitcnt lgkmcnt(0)
  v_mfma_f32_16x16x32_bf16 v[66:69], v[42:45], v[26:29], v[66:69]
  ds_read_b128 v[34:37], v5 offset:24576
  ds_read_b64_tr_b16 v[54:55], v8 offset:43008
  v_mfma_f32_16x16x32_bf16 v[78:81], v[42:45], v[30:33], v[78:81]
  ds_read_b64_tr_b16 v[56:57], v8 offset:43776
  ds_read_b128 v[38:41], v7 offset:24576
  v_mfma_f32_16x16x32_bf16 v[70:73], v[46:49], v[26:29], v[70:73]
  ds_read_b64_tr_b16 v[58:59], v9 offset:43008
  ds_read_b64_tr_b16 v[60:61], v9 offset:43776
  v_mfma_f32_16x16x32_bf16 v[82:85], v[46:49], v[30:33], v[82:85]
  ds_read_b64_tr_b16 v[62:63], v10 offset:43008
  ds_read_b64_tr_b16 v[64:65], v10 offset:43776
  v_mfma_f32_16x16x32_bf16 v[74:77], v[50:53], v[26:29], v[74:77]
  v_mfma_f32_16x16x32_bf16 v[86:89], v[50:53], v[30:33], v[86:89]
  s_cmp_eq_u32 s35, 0
  s_cbranch_scc0 K1_SK_2a3
  v_mfma_f32_16x16x32_bf16 v[90:93], v[42:45], v[102:105], v[90:93]
  v_mfma_f32_16x16x32_bf16 v[94:97], v[46:49], v[102:105], v[94:97]
  v_mfma_f32_16x16x32_bf16 v[98:101], v[50:53], v[102:105], v[98:101]
K1_SK_2a3:
  s_waitcnt lgkmcnt(0)
  s_barrier
  v_mfma_f32_16x16x32_bf16 v[66:69], v[54:57], v[34:37], v[66:69]
  ds_read_b128 v[26:29], v4 offset:32768
  ds_read_b64_tr_b16 v[42:43], v8 offset:49152
  v_mfma_f32_16x16x32_bf16 v[78:81], v[54:57], v[38:41], v[78:81]
  ds_read_b64_tr_b16 v[44:45], v8 offset:49920
  ds_read_b128 v[30:33], v6 offset:32768
  v_mfma_f32_16x16x32_bf16 v[70:73], v[58:61], v[34:37], v[70:73]
  ds_read_b64_tr_b16 v[46:47], v9 offset:49152
  ds_read_b64_tr_b16 v[48:49], v9 offset:49920
  v_mfma_f32_16x16x32_bf16 v[82:85], v[58:61], v[38:41], v[82:85]
  ds_read_b64_tr_b16 v[50:51], v10 offset:49152
  ds_read_b64_tr_b16 v[52:53], v10 offset:49920
  v_mfma_f32_16x16x32_bf16 v[74:77], v[62:65], v[34:37], v[74:77]
  v_mfma_f32_16x16x32_bf16 v[86:89], v[62:65], v[38:41], v[86:89]
  s_cmp_eq_u32 s35, 1
  s_cbranch_scc0 K1_SK_2b3
  v_mfma_f32_16x16x32_bf16 v[90:93], v[54:57], v[102:105], v[90:93]
  v_mfma_f32_16x16x32_bf16 v[94:97], v[58:61], v[102:105], v[94:97]
  v_mfma_f32_16x16x32_bf16 v[98:101], v[62:65], v[102:105], v[98:101]
K1_SK_2b3:
  s_and_b32 s40, s46, 3
  s_cmp_eq_u32 s40, s55
  s_cbranch_scc0 K1_NT3
  s_cmp_lt_u32 s46, 8
  s_cbranch_scc0 K1_NT3
  buffer_load_dword v148, v144, s[20:23], s54 offen
K1_NT3:
  s_add_u32 s46, s46, 1
  s_add_u32 s54, s54, 4096
  s_waitcnt lgkmcnt(0)
  v_mfma_f32_16x16x32_bf16 v[66:69], v[42:45], v[26:29], v[66:69]
  ds_read_b128 v[34:37], v5 offset:32768
  ds_read_b64_tr_b16 v[54:55], v8 offset:55296
  v_mfma_f32_16x16x32_bf16 v[78:81], v[42:45], v[30:33], v[78:81]
  ds_read_b64_tr_b16 v[56:57], v8 offset:56064
  ds_read_b128 v[38:41], v7 offset:32768
  v_mfma_f32_16x16x32_bf16 v[70:73], v[46:49], v[26:29], v[70:73]
  ds_read_b64_tr_b16 v[58:59], v9 offset:55296
  ds_read_b64_tr_b16 v[60:61], v9 offset:56064
  v_mfma_f32_16x16x32_bf16 v[82:85], v[46:49], v[30:33], v[82:85]
  ds_read_b64_tr_b16 v[62:63], v10 offset:55296
  ds_read_b64_tr_b16 v[64:65], v10 offset:56064
  v_mfma_f32_16x16x32_bf16 v[74:77], v[50:53], v[26:29], v[74:77]
  v_mfma_f32_16x16x32_bf16 v[86:89], v[50:53], v[30:33], v[86:89]
  s_cmp_eq_u32 s35, 0
  s_cbranch_scc0 K1_SK_2a4
  v_mfma_f32_16x16x32_bf16 v[90:93], v[42:45], v[102:105], v[90:93]
  v_mfma_f32_16x16x32_bf16 v[94:97], v[46:49], v[102:105], v[94:97]
  v_mfma_f32_16x16x32_bf16 v[98:101], v[50:53], v[102:105], v[98:101]
K1_SK_2a4:
  s_waitcnt lgkmcnt(0)
  s_barrier
  v_add_u32 v4, 40960, v4
  v_add_u32 v5, 40960, v5
  v_add_u32 v6, 40960, v6
  v_add_u32 v7, 40960, v7
  v_mfma_f32_16x16x32_bf16 v[66:69], v[54:57], v[34:37], v[66:69]
  ds_read_b128 v[26:29], v4 offset:0
  ds_read_b64_tr_b16 v[42:43], v8 offset:0
  v_mfma_f32_16x16x32_bf16 v[78:81], v[54:57], v[38:41], v[78:81]
  ds_read_b64_tr_b16 v[44:45], v8 offset:768
  ds_read_b128 v[30:33], v6 offset:0
  v_mfma_f32_16x16x32_bf16 v[70:73], v[58:61], v[34:37], v[70:73]
  ds_read_b64_tr_b16 v[46:47], v9 offset:0
  ds_read_b64_tr_b16 v[48:49], v9 offset:768
  v_mfma_f32_16x16x32_bf16 v[82:85], v[58:61], v[38:41], v[82:85]
  ds_read_b64_tr_b16 v[50:51], v10 offset:0
  ds_read_b64_tr_b16 v[52:53], v10 offset:768
  v_mfma_f32_16x16x32_bf16 v[74:77], v[62:65], v[34:37], v[74:77]
  v_mfma_f32_16x16x32_bf16 v[86:89], v[62:65], v[38:41], v[86:89]
  s_cmp_eq_u32 s35, 1
  s_cbranch_scc0 K1_SK_2b4
  v_mfma_f32_16x16x32_bf16 v[90:93], v[54:57], v[102:105], v[90:93]
  v_mfma_f32_16x16x32_bf16 v[94:97], v[58:61], v[102:105], v[94:97]
  v_mfma_f32_16x16x32_bf16 v[98:101], v[62:65], v[102:105], v[98:101]
K1_SK_2b4:
  s_and_b32 s40, s46, 3
  s_cmp_eq_u32 s40, s55
  s_cbranch_scc0 K1_NT4
  s_cmp_lt_u32 s46, 8
  s_cbranch_scc0 K1_NT4
  buffer_load_dword v148, v144, s[20:23], s54 offen
K1_NT4:
  s_add_u32 s46, s46, 1
  s_add_u32 s54, s54, 4096
  s_add_u32 s37, s37, 1
  s_cmp_lt_u32 s37, 2
  s_cbranch_scc1 K1_LOOP2
  s_mul_i32 s40, s55, 192
  s_add_u32 s40, s40, 144640
  v_lshlrev_b32 v18, 4, v2
  v_add_u32 v19, s40, v18
  s_mov_b32 exec_lo, 0x10001
  s_mov_b32 exec_hi, 0x10001
  ds_write_b128 v19, v[90:93] offset:0
  ds_write_b128 v19, v[94:97] offset:64
  ds_write_b128 v19, v[98:101] offset:128
  s_mov_b64 exec, s[52:53]
  v_mov_b32 v126, 0xc0135761
  v_mov_b32 v127, 0xc0135761
  s_waitcnt lgkmcnt(0)
  s_barrier
  s_load_dwordx4 s[64:67], s[0:1], 32
  s_sub_u32 s42, s34, 4
  s_mul_i32 s44, s33, 80
  s_mul_i32 s40, s32, 3
  s_lshl_b32 s41, s32, 1
  s_add_u32 s41, s41, 16
  s_cmp_lt_u32 s32, 16
  s_cselect_b32 s40, s40, s41
  s_cselect_b32 s41, 3, 2
  s_add_u32 s44, s44, s40
  s_add_u32 s44, s44, s42
  s_cmp_lt_u32 s42, s41
  s_cselect_b32 s45, 1, 0
  s_cmp_eq_u32 s34, 7
  s_cbranch_scc0 F2_NOCE
  v_lshlrev_b32 v166, 2, v1
  buffer_load_dword v167, v166, s[4:7], 0 offen offset:0 sc1
F2_NOCE:
  s_xor_b32 s41, s55, 2
  s_mul_i32 s41, s41, 192
  s_add_u32 s41, s41, 144640
  v_add_u32 v19, s41, v18
  ds_read_b128 v[26:29], v19 offset:0
  ds_read_b128 v[30:33], v19 offset:64
  ds_read_b128 v[34:37], v19 offset:128
  s_lshl_b32 s40, s35, 7
  s_lshl_b32 s41, s36, 6
  s_add_u32 s40, s40, s41
  s_add_u32 s40, s40, 143360
  v_lshlrev_b32 v20, 2, v3
  v_add_u32 v20, s40, v20
  v_xor_b32 v21, 64, v20
  ds_read_b32 v42, v20
  ds_read_b32 v44, v21
  ds_read_b32 v46, v20 offset:256
  ds_read_b32 v48, v21 offset:256
  s_lshl_b32 s40, s32, 2
  s_lshl_b32 s41, s35, 1
  s_add_u32 s40, s40, s41
  s_add_u32 s41, s40, s36
  s_xor_b32 s42, s41, 1
  s_mul_i32 s39, s33, 6
  s_mul_i32 s38, s36, 3
  s_add_u32 s39, s39, s38
  s_mul_i32 s41, s41, 48
  s_add_u32 s41, s41, s39
  s_lshl_b32 s41, s41, 9
  s_add_u32 s41, s41, 0
  s_mul_i32 s42, s42, 48
  s_add_u32 s42, s42, s39
  s_lshl_b32 s42, s42, 9
  s_add_u32 s42, s42, 0
  v_lshlrev_b32 v20, 3, v1
  s_lshl_b32 s38, s35, 1
  s_add_u32 s38, s38, s36
  s_mul_i32 s39, s38, 3072
  s_mul_i32 s40, s36, 1536
  s_add_u32 s39, s39, s40
  s_add_u32 s39, s39, 147456
  v_add_u32 v22, s39, v20
  s_xor_b32 s38, s38, 1
  s_mul_i32 s39, s38, 3072
  s_add_u32 s39, s39, s40
  s_add_u32 s39, s39, 147456
  v_add_u32 v23, s39, v20
  s_waitcnt lgkmcnt(0)
  v_add_f32 v26, v26, v90
  v_sub_f32 v26, 0, v26
  v_add_f32 v27, v27, v91
  v_sub_f32 v27, 0, v27
  v_add_f32 v28, v28, v92
  v_sub_f32 v28, 0, v28
  v_add_f32 v29, v29, v93
  v_sub_f32 v29, 0, v29
  v_add_f32 v30, v30, v94
  v_sub_f32 v30, 0, v30
  v_add_f32 v31, v31, v95
  v_sub_f32 v31, 0, v31
  v_add_f32 v32, v32, v96
  v_sub_f32 v32, 0, v32
  v_add_f32 v33, v33, v97
  v_sub_f32 v33, 0, v33
  v_add_f32 v34, v34, v98
  v_sub_f32 v34, 0, v34
  v_add_f32 v35, v35, v99
  v_sub_f32 v35, 0, v35
  v_add_f32 v36, v36, v100
  v_sub_f32 v36, 0, v36
  v_add_f32 v37, v37, v101
  v_sub_f32 v37, 0, v37
  v_pk_fma_f32 v[66:67], v[26:27], v[42:43], v[66:67] op_sel_hi:[1,0,1]
  v_pk_mul_f32 v[66:67], v[66:67], v[46:47] op_sel_hi:[1,0]
  v_pk_mul_f32 v[128:129], v[66:67], v[66:67]
  v_pk_fma_f32 v[128:129], v[128:129], s[48:49], v[126:127]
  v_pk_mul_f32 v[128:129], v[128:129], v[66:67]
  v_exp_f32 v128, v128
  v_exp_f32 v129, v129
  s_nop 0
  v_pk_add_f32 v[128:129], v[128:129], s[50:51]
  v_rcp_f32 v128, v128
  v_rcp_f32 v129, v129
  s_nop 0
  v_pk_mul_f32 v[128:129], v[128:129], v[66:67]
  v_cvt_pk_bf16_f32 v114, v128, v129
  v_pk_fma_f32 v[68:69], v[28:29], v[42:43], v[68:69] op_sel_hi:[1,0,1]
  v_pk_mul_f32 v[68:69], v[68:69], v[46:47] op_sel_hi:[1,0]
  v_pk_mul_f32 v[132:133], v[68:69], v[68:69]
  v_pk_fma_f32 v[132:133], v[132:133], s[48:49], v[126:127]
  v_pk_mul_f32 v[132:133], v[132:133], v[68:69]
  v_exp_f32 v132, v132
  v_exp_f32 v133, v133
  s_nop 0
  v_pk_add_f32 v[132:133], v[132:133], s[50:51]
  v_rcp_f32 v132, v132
  v_rcp_f32 v133, v133
  s_nop 0
  v_pk_mul_f32 v[132:133], v[132:133], v[68:69]
  v_cvt_pk_bf16_f32 v115, v132, v133
  ds_write_b64 v22, v[114:115] offset:0
  v_pk_fma_f32 v[70:71], v[30:31], v[42:43], v[70:71] op_sel_hi:[1,0,1]
  v_pk_mul_f32 v[70:71], v[70:71], v[46:47] op_sel_hi:[1,0]
  v_pk_mul_f32 v[128:129], v[70:71], v[70:71]
  v_pk_fma_f32 v[128:129], v[128:129], s[48:49], v[126:127]
  v_pk_mul_f32 v[128:129], v[128:129], v[70:71]
  v_exp_f32 v128, v128
  v_exp_f32 v129, v129
  s_nop 0
  v_pk_add_f32 v[128:129], v[128:129], s[50:51]
  v_rcp_f32 v128, v128
  v_rcp_f32 v129, v129
  s_nop 0
  v_pk_mul_f32 v[128:129], v[128:129], v[70:71]
  v_cvt_pk_bf16_f32 v116, v128, v129
  v_pk_fma_f32 v[72:73], v[32:33], v[42:43], v[72:73] op_sel_hi:[1,0,1]
  v_pk_mul_f32 v[72:73], v[72:73], v[46:47] op_sel_hi:[1,0]
  v_pk_mul_f32 v[132:133], v[72:73], v[72:73]
  v_pk_fma_f32 v[132:133], v[132:133], s[48:49], v[126:127]
  v_pk_mul_f32 v[132:133], v[132:133], v[72:73]
  v_exp_f32 v132, v132
  v_exp_f32 v133, v133
  s_nop 0
  v_pk_add_f32 v[132:133], v[132:133], s[50:51]
  v_rcp_f32 v132, v132
  v_rcp_f32 v133, v133
  s_nop 0
  v_pk_mul_f32 v[132:133], v[132:133], v[72:73]
  v_cvt_pk_bf16_f32 v117, v132, v133
  ds_write_b64 v22, v[116:117] offset:512
  v_pk_fma_f32 v[74:75], v[34:35], v[42:43], v[74:75] op_sel_hi:[1,0,1]
  v_pk_mul_f32 v[74:75], v[74:75], v[46:47] op_sel_hi:[1,0]
  v_pk_mul_f32 v[128:129], v[74:75], v[74:75]
  v_pk_fma_f32 v[128:129], v[128:129], s[48:49], v[126:127]
  v_pk_mul_f32 v[128:129], v[128:129], v[74:75]
  v_exp_f32 v128, v128
  v_exp_f32 v129, v129
  s_nop 0
  v_pk_add_f32 v[128:129], v[128:129], s[50:51]
  v_rcp_f32 v128, v128
  v_rcp_f32 v129, v129
  s_nop 0
  v_pk_mul_f32 v[128:129], v[128:129], v[74:75]
  v_cvt_pk_bf16_f32 v118, v128, v129
  v_pk_fma_f32 v[76:77], v[36:37], v[42:43], v[76:77] op_sel_hi:[1,0,1]
  v_pk_mul_f32 v[76:77], v[76:77], v[46:47] op_sel_hi:[1,0]
  v_pk_mul_f32 v[132:133], v[76:77], v[76:77]
  v_pk_fma_f32 v[132:133], v[132:133], s[48:49], v[126:127]
  v_pk_mul_f32 v[132:133], v[132:133], v[76:77]
  v_exp_f32 v132, v132
  v_exp_f32 v133, v133
  s_nop 0
  v_pk_add_f32 v[132:133], v[132:133], s[50:51]
  v_rcp_f32 v132, v132
  v_rcp_f32 v133, v133
  s_nop 0
  v_pk_mul_f32 v[132:133], v[132:133], v[76:77]
  v_cvt_pk_bf16_f32 v119, v132, v133
  ds_write_b64 v22, v[118:119] offset:1024
  v_pk_fma_f32 v[78:79], v[26:27], v[44:45], v[78:79] op_sel_hi:[1,0,1]
  v_pk_mul_f32 v[78:79], v[78:79], v[48:49] op_sel_hi:[1,0]
  v_pk_mul_f32 v[128:129], v[78:79], v[78:79]
  v_pk_fma_f32 v[128:129], v[128:129], s[48:49], v[126:127]
  v_pk_mul_f32 v[128:129], v[128:129], v[78:79]
  v_exp_f32 v128, v128
  v_exp_f32 v129, v129
  s_nop 0
  v_pk_add_f32 v[128:129], v[128:129], s[50:51]
  v_rcp_f32 v128, v128
  v_rcp_f32 v129, v129
  s_nop 0
  v_pk_mul_f32 v[128:129], v[128:129], v[78:79]
  v_cvt_pk_bf16_f32 v120, v128, v129
  v_pk_fma_f32 v[80:81], v[28:29], v[44:45], v[80:81] op_sel_hi:[1,0,1]
  v_pk_mul_f32 v[80:81], v[80:81], v[48:49] op_sel_hi:[1,0]
  v_pk_mul_f32 v[132:133], v[80:81], v[80:81]
  v_pk_fma_f32 v[132:133], v[132:133], s[48:49], v[126:127]
  v_pk_mul_f32 v[132:133], v[132:133], v[80:81]
  v_exp_f32 v132, v132
  v_exp_f32 v133, v133
  s_nop 0
  v_pk_add_f32 v[132:133], v[132:133], s[50:51]
  v_rcp_f32 v132, v132
  v_rcp_f32 v133, v133
  s_nop 0
  v_pk_mul_f32 v[132:133], v[132:133], v[80:81]
  v_cvt_pk_bf16_f32 v121, v132, v133
  ds_write_b64 v23, v[120:121] offset:0
  v_pk_fma_f32 v[82:83], v[30:31], v[44:45], v[82:83] op_sel_hi:[1,0,1]
  v_pk_mul_f32 v[82:83], v[82:83], v[48:49] op_sel_hi:[1,0]
  v_pk_mul_f32 v[128:129], v[82:83], v[82:83]
  v_pk_fma_f32 v[128:129], v[128:129], s[48:49], v[126:127]
  v_pk_mul_f32 v[128:129], v[128:129], v[82:83]
  v_exp_f32 v128, v128
  v_exp_f32 v129, v129
  s_nop 0
  v_pk_add_f32 v[128:129], v[128:129], s[50:51]
  v_rcp_f32 v128, v128
  v_rcp_f32 v129, v129
  s_nop 0
  v_pk_mul_f32 v[128:129], v[128:129], v[82:83]
  v_cvt_pk_bf16_f32 v122, v128, v129
  v_pk_fma_f32 v[84:85], v[32:33], v[44:45], v[84:85] op_sel_hi:[1,0,1]
  v_pk_mul_f32 v[84:85], v[84:85], v[48:49] op_sel_hi:[1,0]
  v_pk_mul_f32 v[132:133], v[84:85], v[84:85]
  v_pk_fma_f32 v[132:133], v[132:133], s[48:49], v[126:127]
  v_pk_mul_f32 v[132:133], v[132:133], v[84:85]
  v_exp_f32 v132, v132
  v_exp_f32 v133, v133
  s_nop 0
  v_pk_add_f32 v[132:133], v[132:133], s[50:51]
  v_rcp_f32 v132, v132
  v_rcp_f32 v133, v133
  s_nop 0
  v_pk_mul_f32 v[132:133], v[132:133], v[84:85]
  v_cvt_pk_bf16_f32 v123, v132, v133
  ds_write_b64 v23, v[122:123] offset:512
  v_pk_fma_f32 v[86:87], v[34:35], v[44:45], v[86:87] op_sel_hi:[1,0,1]
  v_pk_mul_f32 v[86:87], v[86:87], v[48:49] op_sel_hi:[1,0]
  v_pk_mul_f32 v[128:129], v[86:87], v[86:87]
  v_pk_fma_f32 v[128:129], v[128:129], s[48:49], v[126:127]
  v_pk_mul_f32 v[128:129], v[128:129], v[86:87]
  v_exp_f32 v128, v128
  v_exp_f32 v129, v129
  s_nop 0
  v_pk_add_f32 v[128:129], v[128:129], s[50:51]
  v_rcp_f32 v128, v128
  v_rcp_f32 v129, v129
  s_nop 0
  v_pk_mul_f32 v[128:129], v[128:129], v[86:87]
  v_cvt_pk_bf16_f32 v124, v128, v129
  v_pk_fma_f32 v[88:89], v[36:37], v[44:45], v[88:89] op_sel_hi:[1,0,1]
  v_pk_mul_f32 v[88:89], v[88:89], v[48:49] op_sel_hi:[1,0]
  v_pk_mul_f32 v[132:133], v[88:89], v[88:89]
  v_pk_fma_f32 v[132:133], v[132:133], s[48:49], v[126:127]
  v_pk_mul_f32 v[132:133], v[132:133], v[88:89]
  v_exp_f32 v132, v132
  v_exp_f32 v133, v133
  s_nop 0
  v_pk_add_f32 v[132:133], v[132:133], s[50:51]
  v_rcp_f32 v132, v132
  v_rcp_f32 v133, v133
  s_nop 0
  v_pk_mul_f32 v[132:133], v[132:133], v[88:89]
  v_cvt_pk_bf16_f32 v125, v132, v133
  ds_write_b64 v23, v[124:125] offset:1024
  s_cmp_eq_u32 s34, 7
  s_cbranch_scc0 F2_NOCNT
  s_waitcnt vmcnt(0)
  s_mov_b32 exec_lo, 0xffffffff
  s_mov_b32 exec_hi, 0x0
  v_cmp_gt_u32 vcc, 8, v167
  s_mov_b64 exec, s[52:53]
  s_cmp_eq_u64 vcc, 0
  s_cbranch_scc1 F2_NOCNT
  v_lshlrev_b32 v6, 2, v1
  s_mov_b32 s42, 0
  s_mov_b32 exec_lo, 0xffffffff
  s_mov_b32 exec_hi, 0x0
FP_CNT:
  buffer_load_dword v7, v6, s[4:7], 0 offen offset:0 sc1
  s_waitcnt vmcnt(0)
  v_cmp_gt_u32 vcc, 8, v7
  s_add_u32 s42, s42, 1
  s_cmp_eq_u64 vcc, 0
  s_cbranch_scc1 FP_CNT_OK
  s_cmp_lt_u32 s42, 2097152
  s_cbranch_scc0 FP_CNT_OK
  s_sleep 1
  s_branch FP_CNT
FP_CNT_OK:
  s_mov_b64 exec, s[52:53]
F2_NOCNT:
  s_waitcnt lgkmcnt(0)
  s_cmp_eq_u32 s34, 7
  s_cbranch_scc1 F2_SYNC
  s_cmp_eq_u32 s45, 0
  s_cbranch_scc1 F2_IDLE
  s_mov_b32 s35, s44
  s_sub_u32 s42, s34, 4
  s_mul_i32 s36, s42, 21248
  s_add_u32 s36, s36, 65536
  v_add_u32 v10, 1, v3
  v_and_b32 v10, 3, v10
  v_lshrrev_b32 v11, 1, v2
  v_and_b32 v12, 1, v2
  v_lshlrev_b32 v13, 4, v11
  v_add_u32 v13, v13, v3
  v_lshlrev_b32 v14, 3, v12
  v_sub_u32 v13, v13, v14
  v_add_u32 v13, 9, v13
  v_sub_u32 v13, v13, v10
  v_lshlrev_b32 v13, 1, v13
  v_mul_u32_u24 v10, 4160, v10
  v_add_u32 v13, v13, v10
  v_add_u32 v4, s36, v13
  v_sub_u32 v13, v3, v11
  v_lshlrev_b32 v13, 1, v13
  v_add_u32 v13, v13, v12
  v_lshlrev_b32 v13, 4, v13
  s_add_u32 s40, s36, 17152
  v_add_u32 v5, s40, v13
  s_waitcnt vmcnt(0)
  s_barrier
  s_sleep 3
  s_sub_u32 s42, s34, 4
  v_lshrrev_b32 v8, 3, v1
  s_lshl_b32 s40, s42, 3
  v_add_u32 v8, s40, v8
  v_and_b32 v9, 7, v1
  v_lshlrev_b32 v9, 4, v9
  v_mul_u32_u24 v10, 144, v8
  v_add_u32 v10, v10, v9
  v_add_u32 v10, 49152, v10
  v_lshlrev_b32 v8, 12, v8
  v_add_u32 v8, v8, v9
  ds_read_b128 v[16:19], v10 offset:0
  ds_read_b128 v[20:23], v10 offset:3456
  ds_read_b128 v[24:27], v10 offset:6912
  ds_read_b128 v[28:31], v10 offset:10368
  s_mul_i32 s40, s33, 327680
  s_lshl_b32 s41, s32, 7
  s_add_u32 s40, s40, s41
  s_add_u32 s40, s40, 6291456
  s_waitcnt lgkmcnt(0)
  buffer_store_dwordx4 v[16:19], v8, s[16:19], s40 offen sc1
  s_add_u32 s40, s40, 98304
  buffer_store_dwordx4 v[20:23], v8, s[16:19], s40 offen sc1
  s_add_u32 s40, s40, 98304
  buffer_store_dwordx4 v[24:27], v8, s[16:19], s40 offen sc1
  s_add_u32 s40, s40, 98304
  s_cmp_eq_u32 s42, 0
  s_cselect_b32 s40, s40, 0x80000000
  buffer_store_dwordx4 v[28:31], v8, s[16:19], s40 offen sc1
  s_add_u32 s40, s40, 98304
  s_waitcnt lgkmcnt(0)
  s_lshl_b32 s40, s44, 12
  s_add_u32 s20, s64, s40
  s_addc_u32 s21, s65, 0
  s_and_b32 s21, s21, 0xffff
  s_mov_b32 s22, 4096
  s_mov_b32 s23, 0x20000
  s_mov_b32 s24, s66
  s_and_b32 s25, s67, 0xffff
  s_mov_b32 s26, 1280
  s_mov_b32 s27, 0x20000
  v_lshlrev_b32 v167, 4, v1
  buffer_load_dwordx4 v[136:139], v167, s[20:23], 0 offen offset:0
  buffer_load_dwordx2 v[140:141], v167, s[20:23], 0 offen offset:16
  buffer_load_dwordx4 v[142:145], v167, s[20:23], 0 offen offset:1024
  buffer_load_dwordx2 v[146:147], v167, s[20:23], 0 offen offset:1040
  buffer_load_dwordx4 v[148:151], v167, s[20:23], 0 offen offset:2048
  buffer_load_dwordx2 v[152:153], v167, s[20:23], 0 offen offset:2064
  buffer_load_dwordx4 v[154:157], v167, s[20:23], 0 offen offset:3072
  buffer_load_dwordx2 v[158:159], v167, s[20:23], 0 offen offset:3088
  v_mov_b32 v167, 0
  buffer_load_dwordx2 v[164:165], v167, s[20:23], 0 offen
  s_lshl_b32 s40, s44, 1
  buffer_load_ushort v166, v167, s[24:27], s40 offen
  s_barrier
  s_waitcnt vmcnt(0)
  v_mov_b32 v46, v166
  v_mov_b32 v8, 0
  v_mov_b32 v9, 0
  v_lshlrev_b32 v10, 3, v1
  v_add_u32 v10, s36, v10
  ds_write_b64 v10, v[8:9] offset:16640
  v_lshlrev_b32 v10, 4, v1
  v_add_u32 v10, s36, v10
  v_alignbit_b32 v80, v137, v136, 16
  v_alignbit_b32 v81, v138, v137, 16
  v_alignbit_b32 v82, v139, v138, 16
  v_alignbit_b32 v83, v140, v139, 16
  v_mov_b32 v84, v137
  v_mov_b32 v85, v138
  v_mov_b32 v86, v139
  v_mov_b32 v87, v140
  v_mov_b32 v88, v81
  v_mov_b32 v89, v82
  v_mov_b32 v90, v83
  v_alignbit_b32 v91, v141, v140, 16
  ds_write_b128 v10, v[136:139] offset:32
  ds_write_b128 v10, v[80:83] offset:4192
  ds_write_b128 v10, v[84:87] offset:8352
  ds_write_b128 v10, v[88:91] offset:12512
  s_waitcnt lgkmcnt(4)
  v_alignbit_b32 v92, v143, v142, 16
  v_alignbit_b32 v93, v144, v143, 16
  v_alignbit_b32 v94, v145, v144, 16
  v_alignbit_b32 v95, v146, v145, 16
  v_mov_b32 v96, v143
  v_mov_b32 v97, v144
  v_mov_b32 v98, v145
  v_mov_b32 v99, v146
  v_mov_b32 v100, v93
  v_mov_b32 v101, v94
  v_mov_b32 v102, v95
  v_alignbit_b32 v103, v147, v146, 16
  ds_write_b128 v10, v[142:145] offset:1056
  ds_write_b128 v10, v[92:95] offset:5216
  ds_write_b128 v10, v[96:99] offset:9376
  ds_write_b128 v10, v[100:103] offset:13536
  s_waitcnt lgkmcnt(4)
  s_waitcnt vmcnt(0)
  s_barrier
  v_alignbit_b32 v104, v149, v148, 16
  v_alignbit_b32 v105, v150, v149, 16
  v_alignbit_b32 v106, v151, v150, 16
  v_alignbit_b32 v107, v152, v151, 16
  v_mov_b32 v108, v149
  v_mov_b32 v109, v150
  v_mov_b32 v110, v151
  v_mov_b32 v111, v152
  v_mov_b32 v112, v105
  v_mov_b32 v113, v106
  v_mov_b32 v114, v107
  v_alignbit_b32 v115, v153, v152, 16
  ds_write_b128 v10, v[148:151] offset:2080
  ds_write_b128 v10, v[104:107] offset:6240
  ds_write_b128 v10, v[108:111] offset:10400
  ds_write_b128 v10, v[112:115] offset:14560
  s_waitcnt lgkmcnt(4)
  s_barrier
  v_alignbit_b32 v116, v155, v154, 16
  v_alignbit_b32 v117, v156, v155, 16
  v_alignbit_b32 v118, v157, v156, 16
  v_alignbit_b32 v119, v158, v157, 16
  v_mov_b32 v120, v155
  v_mov_b32 v121, v156
  v_mov_b32 v122, v157
  v_mov_b32 v123, v158
  v_mov_b32 v124, v117
  v_mov_b32 v125, v118
  v_mov_b32 v126, v119
  v_alignbit_b32 v127, v159, v158, 16
  ds_write_b128 v10, v[154:157] offset:3104
  ds_write_b128 v10, v[116:119] offset:7264
  ds_write_b128 v10, v[120:123] offset:11424
  ds_write_b128 v10, v[124:127] offset:15584
  s_waitcnt lgkmcnt(4)
  v_mov_b32 v160, 0
  v_mov_b32 v161, 0
  v_mov_b32 v162, 0
  v_mov_b32 v163, 0
  v_cmp_eq_u32 vcc, 1, v1
  s_nop 1
  v_cndmask_b32 v164, 0, v164, vcc
  v_cndmask_b32 v165, 0, v165, vcc
  s_waitcnt lgkmcnt(0)
  s_mov_b32 exec_lo, 0x3
  s_mov_b32 exec_hi, 0x0
  v_alignbit_b32 v80, v161, v160, 16
  v_alignbit_b32 v81, v162, v161, 16
  v_alignbit_b32 v82, v163, v162, 16
  v_alignbit_b32 v83, v164, v163, 16
  v_mov_b32 v84, v161
  v_mov_b32 v85, v162
  v_mov_b32 v86, v163
  v_mov_b32 v87, v164
  v_mov_b32 v88, v81
  v_mov_b32 v89, v82
  v_mov_b32 v90, v83
  v_alignbit_b32 v91, v165, v164, 16
  ds_write_b128 v10, v[160:163] offset:0
  ds_write_b128 v10, v[80:83] offset:4160
  ds_write_b128 v10, v[84:87] offset:8320
  ds_write_b128 v10, v[88:91] offset:12480
  s_mov_b64 exec, s[52:53]
  v_lshlrev_b32 v46, 16, v46
  v_mov_b32 v48, 0
  v_mov_b32 v49, 0
  v_mov_b32 v50, 0
  v_mov_b32 v51, 0
  v_mov_b32 v52, 0
  v_mov_b32 v53, 0
  v_mov_b32 v54, 0
  v_mov_b32 v55, 0
  v_mov_b32 v56, 0
  v_mov_b32 v57, 0
  v_mov_b32 v58, 0
  v_mov_b32 v59, 0
  v_mov_b32 v60, 0
  v_mov_b32 v61, 0
  v_mov_b32 v62, 0
  v_mov_b32 v63, 0
  v_mov_b32 v64, 0
  v_mov_b32 v65, 0
  v_mov_b32 v66, 0
  v_mov_b32 v67, 0
  v_mov_b32 v68, 0
  v_mov_b32 v69, 0
  v_mov_b32 v70, 0
  v_mov_b32 v71, 0
  v_mov_b32 v72, 0
  v_mov_b32 v73, 0
  v_mov_b32 v74, 0
  v_mov_b32 v75, 0
  v_mov_b32 v76, 0
  v_mov_b32 v77, 0
  v_mov_b32 v78, 0
  v_mov_b32 v79, 0
  s_waitcnt vmcnt(0) lgkmcnt(0)
  s_barrier
  s_barrier
  s_barrier
  v_lshlrev_b32 v6, 4, v1
  s_lshl_b32 s40, s35, 12
  s_add_u32 s40, s40, 6291456
  s_add_u32 m0, s36, 17152
  s_add_u32 s41, s40, 0
  buffer_load_dwordx4 v6, s[16:19], s41 offen sc1 lds
  s_add_u32 m0, s36, 18176
  s_add_u32 s41, s40, 1024
  buffer_load_dwordx4 v6, s[16:19], s41 offen sc1 lds
  s_add_u32 m0, s36, 19200
  s_add_u32 s41, s40, 2048
  buffer_load_dwordx4 v6, s[16:19], s41 offen sc1 lds
  s_add_u32 m0, s36, 20224
  s_add_u32 s41, s40, 3072
  buffer_load_dwordx4 v6, s[16:19], s41 offen sc1 lds
  ds_read_b64 v[80:81], v4 offset:0
  ds_read_b64 v[82:83], v4 offset:8
  ds_read_b64 v[84:85], v4 offset:512
  ds_read_b64 v[86:87], v4 offset:520
  ds_read_b64 v[88:89], v4 offset:1024
  ds_read_b64 v[90:91], v4 offset:1032
  ds_read_b64 v[92:93], v4 offset:1536
  ds_read_b64 v[94:95], v4 offset:1544
  s_waitcnt lgkmcnt(6)
  ds_read_b64 v[96:97], v4 offset:2048
  ds_read_b64 v[98:99], v4 offset:2056
  ds_read_b64 v[100:101], v4 offset:2560
  ds_read_b64 v[102:103], v4 offset:2568
  ds_read_b64 v[104:105], v4 offset:3072
  ds_read_b64 v[106:107], v4 offset:3080
  ds_read_b64 v[108:109], v4 offset:3584
  ds_read_b64 v[110:111], v4 offset:3592
  s_waitcnt lgkmcnt(6)
  s_barrier
  s_waitcnt vmcnt(0)
  ds_read_b128 v[112:115], v5 offset:0
  ds_read_b128 v[116:119], v5 offset:512
  ds_read_b128 v[120:123], v5 offset:1024
  ds_read_b128 v[124:127], v5 offset:1536
  ds_read_b128 v[128:131], v5 offset:2048
  ds_read_b128 v[132:135], v5 offset:2560
  ds_read_b128 v[136:139], v5 offset:3072
  ds_read_b128 v[140:143], v5 offset:3584
  s_mov_b32 s37, 0
F2_CLOOP:
  v_add_u32 v4, 64, v4
  v_subrev_u32 v5, 64, v5
  s_waitcnt lgkmcnt(0)
  v_mfma_f32_16x16x32_bf16 v[48:51], v[80:83], v[112:115], v[48:51]
  v_mfma_f32_16x16x32_bf16 v[52:55], v[80:83], v[116:119], v[52:55]
  v_mfma_f32_16x16x32_bf16 v[56:59], v[80:83], v[120:123], v[56:59]
  v_mfma_f32_16x16x32_bf16 v[60:63], v[80:83], v[124:127], v[60:63]
  v_mfma_f32_16x16x32_bf16 v[64:67], v[80:83], v[128:131], v[64:67]
  v_mfma_f32_16x16x32_bf16 v[68:71], v[80:83], v[132:135], v[68:71]
  v_mfma_f32_16x16x32_bf16 v[72:75], v[80:83], v[136:139], v[72:75]
  v_mfma_f32_16x16x32_bf16 v[76:79], v[80:83], v[140:143], v[76:79]
  ds_read_b64 v[80:81], v4 offset:0
  ds_read_b64 v[82:83], v4 offset:8
  ds_read_b128 v[140:143], v5 offset:3584
  v_mfma_f32_16x16x32_bf16 v[52:55], v[84:87], v[112:115], v[52:55]
  v_mfma_f32_16x16x32_bf16 v[56:59], v[84:87], v[116:119], v[56:59]
  v_mfma_f32_16x16x32_bf16 v[60:63], v[84:87], v[120:123], v[60:63]
  v_mfma_f32_16x16x32_bf16 v[64:67], v[84:87], v[124:127], v[64:67]
  v_mfma_f32_16x16x32_bf16 v[68:71], v[84:87], v[128:131], v[68:71]
  v_mfma_f32_16x16x32_bf16 v[72:75], v[84:87], v[132:135], v[72:75]
  v_mfma_f32_16x16x32_bf16 v[76:79], v[84:87], v[136:139], v[76:79]
  ds_read_b64 v[84:85], v4 offset:512
  ds_read_b64 v[86:87], v4 offset:520
  ds_read_b128 v[136:139], v5 offset:3072
  v_mfma_f32_16x16x32_bf16 v[56:59], v[88:91], v[112:115], v[56:59]
  v_mfma_f32_16x16x32_bf16 v[60:63], v[88:91], v[116:119], v[60:63]
  v_mfma_f32_16x16x32_bf16 v[64:67], v[88:91], v[120:123], v[64:67]
  v_mfma_f32_16x16x32_bf16 v[68:71], v[88:91], v[124:127], v[68:71]
  v_mfma_f32_16x16x32_bf16 v[72:75], v[88:91], v[128:131], v[72:75]
  v_mfma_f32_16x16x32_bf16 v[76:79], v[88:91], v[132:135], v[76:79]
  ds_read_b64 v[88:89], v4 offset:1024
  ds_read_b64 v[90:91], v4 offset:1032
  ds_read_b128 v[132:135], v5 offset:2560
  v_mfma_f32_16x16x32_bf16 v[60:63], v[92:95], v[112:115], v[60:63]
  v_mfma_f32_16x16x32_bf16 v[64:67], v[92:95], v[116:119], v[64:67]
  v_mfma_f32_16x16x32_bf16 v[68:71], v[92:95], v[120:123], v[68:71]
  v_mfma_f32_16x16x32_bf16 v[72:75], v[92:95], v[124:127], v[72:75]
  v_mfma_f32_16x16x32_bf16 v[76:79], v[92:95], v[128:131], v[76:79]
  ds_read_b64 v[92:93], v4 offset:1536
  ds_read_b64 v[94:95], v4 offset:1544
  ds_read_b128 v[128:131], v5 offset:2048
  s_waitcnt lgkmcnt(6)
  s_barrier
  v_mfma_f32_16x16x32_bf16 v[64:67], v[96:99], v[112:115], v[64:67]
  v_mfma_f32_16x16x32_bf16 v[68:71], v[96:99], v[116:119], v[68:71]
  v_mfma_f32_16x16x32_bf16 v[72:75], v[96:99], v[120:123], v[72:75]
  v_mfma_f32_16x16x32_bf16 v[76:79], v[96:99], v[124:127], v[76:79]
  ds_read_b64 v[96:97], v4 offset:2048
  ds_read_b64 v[98:99], v4 offset:2056
  ds_read_b128 v[124:127], v5 offset:1536
  v_mfma_f32_16x16x32_bf16 v[68:71], v[100:103], v[112:115], v[68:71]
  v_mfma_f32_16x16x32_bf16 v[72:75], v[100:103], v[116:119], v[72:75]
  v_mfma_f32_16x16x32_bf16 v[76:79], v[100:103], v[120:123], v[76:79]
  ds_read_b64 v[100:101], v4 offset:2560
  ds_read_b64 v[102:103], v4 offset:2568
  ds_read_b128 v[120:123], v5 offset:1024
  v_mfma_f32_16x16x32_bf16 v[72:75], v[104:107], v[112:115], v[72:75]
  v_mfma_f32_16x16x32_bf16 v[76:79], v[104:107], v[116:119], v[76:79]
  ds_read_b64 v[104:105], v4 offset:3072
  ds_read_b64 v[106:107], v4 offset:3080
  ds_read_b128 v[116:119], v5 offset:512
  s_waitcnt lgkmcnt(6)
  v_mfma_f32_16x16x32_bf16 v[76:79], v[108:111], v[112:115], v[76:79]
  ds_read_b64 v[108:109], v4 offset:3584
  ds_read_b64 v[110:111], v4 offset:3592
  ds_read_b128 v[112:115], v5 offset:0
  v_add_u32 v4, 64, v4
  v_subrev_u32 v5, 64, v5
  s_waitcnt lgkmcnt(0)
  v_mfma_f32_16x16x32_bf16 v[48:51], v[80:83], v[112:115], v[48:51]
  v_mfma_f32_16x16x32_bf16 v[52:55], v[80:83], v[116:119], v[52:55]
  v_mfma_f32_16x16x32_bf16 v[56:59], v[80:83], v[120:123], v[56:59]
  v_mfma_f32_16x16x32_bf16 v[60:63], v[80:83], v[124:127], v[60:63]
  v_mfma_f32_16x16x32_bf16 v[64:67], v[80:83], v[128:131], v[64:67]
  v_mfma_f32_16x16x32_bf16 v[68:71], v[80:83], v[132:135], v[68:71]
  v_mfma_f32_16x16x32_bf16 v[72:75], v[80:83], v[136:139], v[72:75]
  v_mfma_f32_16x16x32_bf16 v[76:79], v[80:83], v[140:143], v[76:79]
  ds_read_b64 v[80:81], v4 offset:0
  ds_read_b64 v[82:83], v4 offset:8
  ds_read_b128 v[140:143], v5 offset:3584
  v_mfma_f32_16x16x32_bf16 v[52:55], v[84:87], v[112:115], v[52:55]
  v_mfma_f32_16x16x32_bf16 v[56:59], v[84:87], v[116:119], v[56:59]
  v_mfma_f32_16x16x32_bf16 v[60:63], v[84:87], v[120:123], v[60:63]
  v_mfma_f32_16x16x32_bf16 v[64:67], v[84:87], v[124:127], v[64:67]
  v_mfma_f32_16x16x32_bf16 v[68:71], v[84:87], v[128:131], v[68:71]
  v_mfma_f32_16x16x32_bf16 v[72:75], v[84:87], v[132:135], v[72:75]
  v_mfma_f32_16x16x32_bf16 v[76:79], v[84:87], v[136:139], v[76:79]
  ds_read_b64 v[84:85], v4 offset:512
  ds_read_b64 v[86:87], v4 offset:520
  ds_read_b128 v[136:139], v5 offset:3072
  s_barrier
  v_mfma_f32_16x16x32_bf16 v[56:59], v[88:91], v[112:115], v[56:59]
  v_mfma_f32_16x16x32_bf16 v[60:63], v[88:91], v[116:119], v[60:63]
  v_mfma_f32_16x16x32_bf16 v[64:67], v[88:91], v[120:123], v[64:67]
  v_mfma_f32_16x16x32_bf16 v[68:71], v[88:91], v[124:127], v[68:71]
  v_mfma_f32_16x16x32_bf16 v[72:75], v[88:91], v[128:131], v[72:75]
  v_mfma_f32_16x16x32_bf16 v[76:79], v[88:91], v[132:135], v[76:79]
  ds_read_b64 v[88:89], v4 offset:1024
  ds_read_b64 v[90:91], v4 offset:1032
  ds_read_b128 v[132:135], v5 offset:2560
  v_mfma_f32_16x16x32_bf16 v[60:63], v[92:95], v[112:115], v[60:63]
  v_mfma_f32_16x16x32_bf16 v[64:67], v[92:95], v[116:119], v[64:67]
  v_mfma_f32_16x16x32_bf16 v[68:71], v[92:95], v[120:123], v[68:71]
  v_mfma_f32_16x16x32_bf16 v[72:75], v[92:95], v[124:127], v[72:75]
  v_mfma_f32_16x16x32_bf16 v[76:79], v[92:95], v[128:131], v[76:79]
  ds_read_b64 v[92:93], v4 offset:1536
  ds_read_b64 v[94:95], v4 offset:1544
  ds_read_b128 v[128:131], v5 offset:2048
  s_waitcnt lgkmcnt(6)
  v_mfma_f32_16x16x32_bf16 v[64:67], v[96:99], v[112:115], v[64:67]
  v_mfma_f32_16x16x32_bf16 v[68:71], v[96:99], v[116:119], v[68:71]
  v_mfma_f32_16x16x32_bf16 v[72:75], v[96:99], v[120:123], v[72:75]
  v_mfma_f32_16x16x32_bf16 v[76:79], v[96:99], v[124:127], v[76:79]
  ds_read_b64 v[96:97], v4 offset:2048
  ds_read_b64 v[98:99], v4 offset:2056
  ds_read_b128 v[124:127], v5 offset:1536
  v_mfma_f32_16x16x32_bf16 v[68:71], v[100:103], v[112:115], v[68:71]
  v_mfma_f32_16x16x32_bf16 v[72:75], v[100:103], v[116:119], v[72:75]
  v_mfma_f32_16x16x32_bf16 v[76:79], v[100:103], v[120:123], v[76:79]
  ds_read_b64 v[100:101], v4 offset:2560
  ds_read_b64 v[102:103], v4 offset:2568
  ds_read_b128 v[120:123], v5 offset:1024
  v_mfma_f32_16x16x32_bf16 v[72:75], v[104:107], v[112:115], v[72:75]
  v_mfma_f32_16x16x32_bf16 v[76:79], v[104:107], v[116:119], v[76:79]
  ds_read_b64 v[104:105], v4 offset:3072
  ds_read_b64 v[106:107], v4 offset:3080
  ds_read_b128 v[116:119], v5 offset:512
  s_waitcnt lgkmcnt(6)
  v_mfma_f32_16x16x32_bf16 v[76:79], v[108:111], v[112:115], v[76:79]
  ds_read_b64 v[108:109], v4 offset:3584
  ds_read_b64 v[110:111], v4 offset:3592
  ds_read_b128 v[112:115], v5 offset:0
  s_barrier
  s_add_u32 s37, s37, 2
  s_cmp_lt_u32 s37, 8
  s_cbranch_scc1 F2_CLOOP
  s_waitcnt lgkmcnt(0)
  v_lshlrev_b32 v6, 5, v3
  v_lshrrev_b32 v7, 1, v2
  v_lshlrev_b32 v7, 4, v7
  v_add_u32 v6, v6, v7
  v_and_b32 v7, 1, v2
  v_xor_b32 v7, 1, v7
  v_lshlrev_b32 v7, 3, v7
  v_add_u32 v6, v6, v7
  s_add_u32 s40, s36, 17152
  v_add_u32 v6, s40, v6
  ds_read_b64 v[80:81], v6 offset:0
  ds_read_b64 v[82:83], v6 offset:512
  ds_read_b64 v[84:85], v6 offset:1024
  ds_read_b64 v[86:87], v6 offset:1536
  ds_read_b64 v[88:89], v6 offset:2048
  ds_read_b64 v[90:91], v6 offset:2560
  ds_read_b64 v[92:93], v6 offset:3072
  ds_read_b64 v[94:95], v6 offset:3584
  v_lshlrev_b32 v8, 5, v3
  v_lshlrev_b32 v9, 3, v2
  v_add_u32 v8, v8, v9
  s_lshl_b32 s40, s35, 12
  s_add_u32 s40, s40, 9437184
  s_waitcnt lgkmcnt(0)
  v_and_b32 v112, s47, v81
  v_lshlrev_b32 v113, 16, v81
  v_and_b32 v114, s47, v80
  v_lshlrev_b32 v115, 16, v80
  v_fmac_f32 v48, v112, v46
  v_fmac_f32 v49, v113, v46
  v_fmac_f32 v50, v114, v46
  v_fmac_f32 v51, v115, v46
  v_cvt_pk_bf16_f32 v116, v48, v49
  v_cvt_pk_bf16_f32 v117, v50, v51
  buffer_store_dwordx2 v[116:117], v8, s[16:19], s40 offen offset:0 sc1
  v_and_b32 v120, s47, v83
  v_lshlrev_b32 v121, 16, v83
  v_and_b32 v122, s47, v82
  v_lshlrev_b32 v123, 16, v82
  v_fmac_f32 v52, v120, v46
  v_fmac_f32 v53, v121, v46
  v_fmac_f32 v54, v122, v46
  v_fmac_f32 v55, v123, v46
  v_cvt_pk_bf16_f32 v124, v52, v53
  v_cvt_pk_bf16_f32 v125, v54, v55
  buffer_store_dwordx2 v[124:125], v8, s[16:19], s40 offen offset:512 sc1
  v_and_b32 v128, s47, v85
  v_lshlrev_b32 v129, 16, v85
  v_and_b32 v130, s47, v84
  v_lshlrev_b32 v131, 16, v84
  v_fmac_f32 v56, v128, v46
  v_fmac_f32 v57, v129, v46
  v_fmac_f32 v58, v130, v46
  v_fmac_f32 v59, v131, v46
  v_cvt_pk_bf16_f32 v132, v56, v57
  v_cvt_pk_bf16_f32 v133, v58, v59
  buffer_store_dwordx2 v[132:133], v8, s[16:19], s40 offen offset:1024 sc1
  v_and_b32 v136, s47, v87
  v_lshlrev_b32 v137, 16, v87
  v_and_b32 v138, s47, v86
  v_lshlrev_b32 v139, 16, v86
  v_fmac_f32 v60, v136, v46
  v_fmac_f32 v61, v137, v46
  v_fmac_f32 v62, v138, v46
  v_fmac_f32 v63, v139, v46
  v_cvt_pk_bf16_f32 v140, v60, v61
  v_cvt_pk_bf16_f32 v141, v62, v63
  buffer_store_dwordx2 v[140:141], v8, s[16:19], s40 offen offset:1536 sc1
  v_and_b32 v112, s47, v89
  v_lshlrev_b32 v113, 16, v89
  v_and_b32 v114, s47, v88
  v_lshlrev_b32 v115, 16, v88
  v_fmac_f32 v64, v112, v46
  v_fmac_f32 v65, v113, v46
  v_fmac_f32 v66, v114, v46
  v_fmac_f32 v67, v115, v46
  v_cvt_pk_bf16_f32 v116, v64, v65
  v_cvt_pk_bf16_f32 v117, v66, v67
  buffer_store_dwordx2 v[116:117], v8, s[16:19], s40 offen offset:2048 sc1
  v_and_b32 v120, s47, v91
  v_lshlrev_b32 v121, 16, v91
  v_and_b32 v122, s47, v90
  v_lshlrev_b32 v123, 16, v90
  v_fmac_f32 v68, v120, v46
  v_fmac_f32 v69, v121, v46
  v_fmac_f32 v70, v122, v46
  v_fmac_f32 v71, v123, v46
  v_cvt_pk_bf16_f32 v124, v68, v69
  v_cvt_pk_bf16_f32 v125, v70, v71
  buffer_store_dwordx2 v[124:125], v8, s[16:19], s40 offen offset:2560 sc1
  v_and_b32 v128, s47, v93
  v_lshlrev_b32 v129, 16, v93
  v_and_b32 v130, s47, v92
  v_lshlrev_b32 v131, 16, v92
  v_fmac_f32 v72, v128, v46
  v_fmac_f32 v73, v129, v46
  v_fmac_f32 v74, v130, v46
  v_fmac_f32 v75, v131, v46
  v_cvt_pk_bf16_f32 v132, v72, v73
  v_cvt_pk_bf16_f32 v133, v74, v75
  buffer_store_dwordx2 v[132:133], v8, s[16:19], s40 offen offset:3072 sc1
  v_and_b32 v136, s47, v95
  v_lshlrev_b32 v137, 16, v95
  v_and_b32 v138, s47, v94
  v_lshlrev_b32 v139, 16, v94
  v_fmac_f32 v76, v136, v46
  v_fmac_f32 v77, v137, v46
  v_fmac_f32 v78, v138, v46
  v_fmac_f32 v79, v139, v46
  v_cvt_pk_bf16_f32 v140, v76, v77
  v_cvt_pk_bf16_f32 v141, v78, v79
  buffer_store_dwordx2 v[140:141], v8, s[16:19], s40 offen offset:3584 sc1
  s_waitcnt vmcnt(0)
  s_barrier
F3_IDLE:
  s_load_dwordx2 s[56:57], s[0:1], 0
  s_load_dwordx2 s[58:59], s[0:1], 88
  v_lshlrev_b32 v4, 4, v1
  s_lshl_b32 s35, s32, 2
  s_add_u32 s35, s35, s55
  s_lshr_b32 s39, s34, 2
  s_mul_i32 s36, s35, 24576
  s_mul_i32 s40, s39, 12288
  s_add_u32 s36, s36, s40
  s_add_u32 s36, s36, 12582912
  s_mul_i32 s40, s39, 61440
  v_add_u32 v26, s40, v4
  s_lshl_b32 s40, s35, 4
  s_mul_i32 s40, s40, 1280
  s_mul_i32 s41, s33, 160
  s_add_u32 s40, s40, s41
  v_add_u32 v12, 0, v1
  v_mul_u32_u24 v13, 6554, v12
  v_lshrrev_b32 v13, 16, v13
  v_mul_u32_u24 v14, 10, v13
  v_sub_u32 v14, v12, v14
  v_lshlrev_b32 v14, 4, v14
  v_mul_u32_u24 v13, 1280, v13
  v_add_u32 v13, v13, v14
  v_add_u32 v5, s40, v13
  v_lshrrev_b32 v13, 1, v12
  v_lshlrev_b32 v13, 12, v13
  v_and_b32 v14, 1, v12
  v_lshlrev_b32 v14, 4, v14
  v_add_u32 v8, v13, v14
  v_add_u32 v12, 64, v1
  v_mul_u32_u24 v13, 6554, v12
  v_lshrrev_b32 v13, 16, v13
  v_mul_u32_u24 v14, 10, v13
  v_sub_u32 v14, v12, v14
  v_lshlrev_b32 v14, 4, v14
  v_mul_u32_u24 v13, 1280, v13
  v_add_u32 v13, v13, v14
  v_add_u32 v6, s40, v13
  v_lshrrev_b32 v13, 1, v12
  v_lshlrev_b32 v13, 12, v13
  v_and_b32 v14, 1, v12
  v_lshlrev_b32 v14, 4, v14
  v_add_u32 v9, v13, v14
  v_add_u32 v12, 128, v1
  v_mul_u32_u24 v13, 6554, v12
  v_lshrrev_b32 v13, 16, v13
  v_mul_u32_u24 v14, 10, v13
  v_sub_u32 v14, v12, v14
  v_lshlrev_b32 v14, 4, v14
  v_mul_u32_u24 v13, 1280, v13
  v_add_u32 v13, v13, v14
  v_add_u32 v7, s40, v13
  v_lshrrev_b32 v13, 1, v12
  v_lshlrev_b32 v13, 12, v13
  v_and_b32 v14, 1, v12
  v_lshlrev_b32 v14, 4, v14
  v_add_u32 v10, v13, v14
  s_mul_i32 s37, s55, 2560
  s_mul_i32 s38, s33, 327680
  s_lshl_b32 s41, s35, 5
  s_add_u32 s38, s38, s41
  s_add_u32 s38, s38, 9437184
  s_lshl_b32 s40, s55, 6
  s_add_u32 s40, s40, 143360
  v_lshlrev_b32 v21, 2, v3
  v_add_u32 v21, s40, v21
  ds_read_b32 v24, v21
  ds_read_b32 v25, v21 offset:256
  v_mov_b32 v68, 0
  v_mov_b32 v69, 0
  v_mov_b32 v70, 0
  v_mov_b32 v71, 0
  v_mov_b32 v72, 0
  v_mov_b32 v73, 0
  v_mov_b32 v74, 0
  v_mov_b32 v75, 0
  v_mov_b32 v76, 0
  v_mov_b32 v77, 0
  v_mov_b32 v78, 0
  v_mov_b32 v79, 0
  v_mov_b32 v80, 0
  v_mov_b32 v81, 0
  v_mov_b32 v82, 0
  v_mov_b32 v83, 0
  v_mov_b32 v84, 0
  v_mov_b32 v85, 0
  v_mov_b32 v86, 0
  v_mov_b32 v87, 0
  s_waitcnt lgkmcnt(0)
  s_mov_b32 s8, s56
  s_and_b32 s9, s57, 0xffff
  s_mov_b32 s10, 2621440
  s_mov_b32 s11, 0x20000
  s_mov_b32 s12, s58
  s_and_b32 s13, s59, 0xffff
  s_mov_b32 s14, 2621440
  s_mov_b32 s15, 0x20000
  s_barrier
F3_BMAIN:
  s_add_u32 s40, s36, 0
  buffer_load_dwordx4 v[88:91], v4, s[16:19], s40 offen offset:0 sc1
  s_add_u32 s40, s36, 0
  buffer_load_dwordx4 v[92:95], v4, s[16:19], s40 offen offset:1024 sc1
  s_add_u32 s40, s36, 0
  buffer_load_dwordx4 v[96:99], v4, s[16:19], s40 offen offset:2048 sc1
  s_add_u32 s40, s36, 0
  buffer_load_dwordx4 v[100:103], v4, s[16:19], s40 offen offset:3072 sc1
  s_add_u32 s40, s36, 4096
  buffer_load_dwordx4 v[104:107], v4, s[16:19], s40 offen offset:0 sc1
  s_barrier
  ds_read_b128 v[28:31], v26 offset:0
  ds_read_b128 v[32:35], v26 offset:1024
  ds_read_b128 v[36:39], v26 offset:2048
  ds_read_b128 v[40:43], v26 offset:3072
  ds_read_b128 v[44:47], v26 offset:4096
  s_waitcnt vmcnt(4) lgkmcnt(0)
  v_mfma_f32_16x16x32_bf16 v[68:71], v[28:31], v[88:91], v[68:71]
  ds_read_b128 v[48:51], v26 offset:5120
  v_mfma_f32_16x16x32_bf16 v[72:75], v[32:35], v[88:91], v[72:75]
  ds_read_b128 v[52:55], v26 offset:6144
  v_mfma_f32_16x16x32_bf16 v[76:79], v[36:39], v[88:91], v[76:79]
  ds_read_b128 v[56:59], v26 offset:7168
  s_add_u32 s40, s36, 4096
  buffer_load_dwordx4 v[108:111], v4, s[16:19], s40 offen offset:1024 sc1
  v_mfma_f32_16x16x32_bf16 v[80:83], v[40:43], v[88:91], v[80:83]
  ds_read_b128 v[60:63], v26 offset:8192
  v_mfma_f32_16x16x32_bf16 v[84:87], v[44:47], v[88:91], v[84:87]
  ds_read_b128 v[64:67], v26 offset:9216
  s_waitcnt vmcnt(4) lgkmcnt(0)
  v_mfma_f32_16x16x32_bf16 v[68:71], v[48:51], v[92:95], v[68:71]
  ds_read_b128 v[28:31], v26 offset:10240
  v_mfma_f32_16x16x32_bf16 v[72:75], v[52:55], v[92:95], v[72:75]
  ds_read_b128 v[32:35], v26 offset:11264
  v_mfma_f32_16x16x32_bf16 v[76:79], v[56:59], v[92:95], v[76:79]
  ds_read_b128 v[36:39], v26 offset:12288
  s_add_u32 s40, s36, 4096
  buffer_load_dwordx4 v[112:115], v4, s[16:19], s40 offen offset:2048 sc1
  v_mfma_f32_16x16x32_bf16 v[80:83], v[60:63], v[92:95], v[80:83]
  ds_read_b128 v[40:43], v26 offset:13312
  v_mfma_f32_16x16x32_bf16 v[84:87], v[64:67], v[92:95], v[84:87]
  ds_read_b128 v[44:47], v26 offset:14336
  s_waitcnt vmcnt(4) lgkmcnt(0)
  v_mfma_f32_16x16x32_bf16 v[68:71], v[28:31], v[96:99], v[68:71]
  ds_read_b128 v[48:51], v26 offset:15360
  v_mfma_f32_16x16x32_bf16 v[72:75], v[32:35], v[96:99], v[72:75]
  ds_read_b128 v[52:55], v26 offset:16384
  v_mfma_f32_16x16x32_bf16 v[76:79], v[36:39], v[96:99], v[76:79]
  ds_read_b128 v[56:59], v26 offset:17408
  s_add_u32 s40, s36, 4096
  buffer_load_dwordx4 v[116:119], v4, s[16:19], s40 offen offset:3072 sc1
  v_mfma_f32_16x16x32_bf16 v[80:83], v[40:43], v[96:99], v[80:83]
  ds_read_b128 v[60:63], v26 offset:18432
  v_mfma_f32_16x16x32_bf16 v[84:87], v[44:47], v[96:99], v[84:87]
  ds_read_b128 v[64:67], v26 offset:19456
  s_waitcnt vmcnt(4) lgkmcnt(0)
  s_barrier
  v_mfma_f32_16x16x32_bf16 v[68:71], v[48:51], v[100:103], v[68:71]
  ds_read_b128 v[28:31], v26 offset:20480
  v_mfma_f32_16x16x32_bf16 v[72:75], v[52:55], v[100:103], v[72:75]
  ds_read_b128 v[32:35], v26 offset:21504
  v_mfma_f32_16x16x32_bf16 v[76:79], v[56:59], v[100:103], v[76:79]
  ds_read_b128 v[36:39], v26 offset:22528
  s_add_u32 s40, s36, 8192
  buffer_load_dwordx4 v[120:123], v4, s[16:19], s40 offen offset:0 sc1
  v_mfma_f32_16x16x32_bf16 v[80:83], v[60:63], v[100:103], v[80:83]
  ds_read_b128 v[40:43], v26 offset:23552
  v_mfma_f32_16x16x32_bf16 v[84:87], v[64:67], v[100:103], v[84:87]
  ds_read_b128 v[44:47], v26 offset:24576
  s_waitcnt vmcnt(4) lgkmcnt(0)
  v_mfma_f32_16x16x32_bf16 v[68:71], v[28:31], v[104:107], v[68:71]
  ds_read_b128 v[48:51], v26 offset:25600
  v_mfma_f32_16x16x32_bf16 v[72:75], v[32:35], v[104:107], v[72:75]
  ds_read_b128 v[52:55], v26 offset:26624
  v_mfma_f32_16x16x32_bf16 v[76:79], v[36:39], v[104:107], v[76:79]
  ds_read_b128 v[56:59], v26 offset:27648
  s_add_u32 s40, s36, 8192
  buffer_load_dwordx4 v[124:127], v4, s[16:19], s40 offen offset:1024 sc1
  v_mfma_f32_16x16x32_bf16 v[80:83], v[40:43], v[104:107], v[80:83]
  ds_read_b128 v[60:63], v26 offset:28672
  v_mfma_f32_16x16x32_bf16 v[84:87], v[44:47], v[104:107], v[84:87]
  ds_read_b128 v[64:67], v26 offset:29696
  s_add_u32 m0, s37, 133120
  s_nop 0
  buffer_load_dwordx4 v8, s[16:19], s38 offen sc1 lds
  s_waitcnt vmcnt(5) lgkmcnt(0)
  v_mfma_f32_16x16x32_bf16 v[68:71], v[48:51], v[108:111], v[68:71]
  ds_read_b128 v[28:31], v26 offset:30720
  v_mfma_f32_16x16x32_bf16 v[72:75], v[52:55], v[108:111], v[72:75]
  ds_read_b128 v[32:35], v26 offset:31744
  v_mfma_f32_16x16x32_bf16 v[76:79], v[56:59], v[108:111], v[76:79]
  ds_read_b128 v[36:39], v26 offset:32768
  s_add_u32 s40, s36, 8192
  buffer_load_dwordx4 v[128:131], v4, s[16:19], s40 offen offset:2048 sc1
  v_mfma_f32_16x16x32_bf16 v[80:83], v[60:63], v[108:111], v[80:83]
  ds_read_b128 v[40:43], v26 offset:33792
  v_mfma_f32_16x16x32_bf16 v[84:87], v[64:67], v[108:111], v[84:87]
  ds_read_b128 v[44:47], v26 offset:34816
  s_add_u32 m0, s37, 134144
  s_nop 0
  buffer_load_dwordx4 v9, s[16:19], s38 offen sc1 lds
  s_waitcnt vmcnt(6) lgkmcnt(0)
  v_mfma_f32_16x16x32_bf16 v[68:71], v[28:31], v[112:115], v[68:71]
  ds_read_b128 v[48:51], v26 offset:35840
  v_mfma_f32_16x16x32_bf16 v[72:75], v[32:35], v[112:115], v[72:75]
  ds_read_b128 v[52:55], v26 offset:36864
  v_mfma_f32_16x16x32_bf16 v[76:79], v[36:39], v[112:115], v[76:79]
  ds_read_b128 v[56:59], v26 offset:37888
  s_add_u32 s40, s36, 8192
  buffer_load_dwordx4 v[132:135], v4, s[16:19], s40 offen offset:3072 sc1
  v_mfma_f32_16x16x32_bf16 v[80:83], v[40:43], v[112:115], v[80:83]
  ds_read_b128 v[60:63], v26 offset:38912
  v_mfma_f32_16x16x32_bf16 v[84:87], v[44:47], v[112:115], v[84:87]
  ds_read_b128 v[64:67], v26 offset:39936
  s_mov_b32 exec_hi, 0
  s_add_u32 m0, s37, 135168
  s_nop 0
  buffer_load_dwordx4 v10, s[16:19], s38 offen sc1 lds
  s_mov_b32 exec_hi, -1
  s_waitcnt vmcnt(7) lgkmcnt(0)
  s_barrier
  v_mfma_f32_16x16x32_bf16 v[68:71], v[48:51], v[116:119], v[68:71]
  ds_read_b128 v[28:31], v26 offset:40960
  v_mfma_f32_16x16x32_bf16 v[72:75], v[52:55], v[116:119], v[72:75]
  ds_read_b128 v[32:35], v26 offset:41984
  v_mfma_f32_16x16x32_bf16 v[76:79], v[56:59], v[116:119], v[76:79]
  ds_read_b128 v[36:39], v26 offset:43008
  v_mfma_f32_16x16x32_bf16 v[80:83], v[60:63], v[116:119], v[80:83]
  ds_read_b128 v[40:43], v26 offset:44032
  v_mfma_f32_16x16x32_bf16 v[84:87], v[64:67], v[116:119], v[84:87]
  ds_read_b128 v[44:47], v26 offset:45056
  s_waitcnt vmcnt(6) lgkmcnt(0)
  v_mfma_f32_16x16x32_bf16 v[68:71], v[28:31], v[120:123], v[68:71]
  ds_read_b128 v[48:51], v26 offset:46080
  v_mfma_f32_16x16x32_bf16 v[72:75], v[32:35], v[120:123], v[72:75]
  ds_read_b128 v[52:55], v26 offset:47104
  v_mfma_f32_16x16x32_bf16 v[76:79], v[36:39], v[120:123], v[76:79]
  ds_read_b128 v[56:59], v26 offset:48128
  v_mfma_f32_16x16x32_bf16 v[80:83], v[40:43], v[120:123], v[80:83]
  ds_read_b128 v[60:63], v26 offset:49152
  v_mfma_f32_16x16x32_bf16 v[84:87], v[44:47], v[120:123], v[84:87]
  ds_read_b128 v[64:67], v26 offset:50176
  s_waitcnt vmcnt(5) lgkmcnt(0)
  v_mfma_f32_16x16x32_bf16 v[68:71], v[48:51], v[124:127], v[68:71]
  ds_read_b128 v[28:31], v26 offset:51200
  v_mfma_f32_16x16x32_bf16 v[72:75], v[52:55], v[124:127], v[72:75]
  ds_read_b128 v[32:35], v26 offset:52224
  v_mfma_f32_16x16x32_bf16 v[76:79], v[56:59], v[124:127], v[76:79]
  ds_read_b128 v[36:39], v26 offset:53248
  v_mfma_f32_16x16x32_bf16 v[80:83], v[60:63], v[124:127], v[80:83]
  ds_read_b128 v[40:43], v26 offset:54272
  v_mfma_f32_16x16x32_bf16 v[84:87], v[64:67], v[124:127], v[84:87]
  ds_read_b128 v[44:47], v26 offset:55296
  s_waitcnt vmcnt(3) lgkmcnt(0)
  v_mfma_f32_16x16x32_bf16 v[68:71], v[28:31], v[128:131], v[68:71]
  ds_read_b128 v[48:51], v26 offset:56320
  v_mfma_f32_16x16x32_bf16 v[72:75], v[32:35], v[128:131], v[72:75]
  ds_read_b128 v[52:55], v26 offset:57344
  v_mfma_f32_16x16x32_bf16 v[76:79], v[36:39], v[128:131], v[76:79]
  ds_read_b128 v[56:59], v26 offset:58368
  v_mfma_f32_16x16x32_bf16 v[80:83], v[40:43], v[128:131], v[80:83]
  ds_read_b128 v[60:63], v26 offset:59392
  v_mfma_f32_16x16x32_bf16 v[84:87], v[44:47], v[128:131], v[84:87]
  ds_read_b128 v[64:67], v26 offset:60416
  s_waitcnt vmcnt(1) lgkmcnt(0)
  v_mfma_f32_16x16x32_bf16 v[68:71], v[48:51], v[132:135], v[68:71]
  v_mfma_f32_16x16x32_bf16 v[72:75], v[52:55], v[132:135], v[72:75]
  v_mfma_f32_16x16x32_bf16 v[76:79], v[56:59], v[132:135], v[76:79]
  v_mfma_f32_16x16x32_bf16 v[80:83], v[60:63], v[132:135], v[80:83]
  v_mfma_f32_16x16x32_bf16 v[84:87], v[64:67], v[132:135], v[84:87]
  s_waitcnt vmcnt(0) lgkmcnt(0)
  s_barrier
  s_mul_i32 s40, s55, 5120
  v_add_u32 v12, s40, v4
  ds_write_b128 v12, v[68:71] offset:0
  ds_write_b128 v12, v[72:75] offset:1024
  ds_write_b128 v12, v[76:79] offset:2048
  v_mul_u32_u24 v13, 160, v3
  v_lshlrev_b32 v14, 3, v2
  v_add_u32 v13, v13, v14
  s_add_u32 s40, s37, 122880
  v_add_u32 v13, s40, v13
  v_lshlrev_b32 v14, 7, v2
  v_lshlrev_b32 v15, 3, v3
  v_add_u32 v14, v14, v15
  s_add_u32 s40, s37, 133120
  v_add_u32 v14, s40, v14
  ds_read_b64 v[94:95], v13 offset:96
  ds_read_b64_tr_b16 v[104:105], v14 offset:1536
  ds_read_b64 v[96:97], v13 offset:128
  ds_read_b64_tr_b16 v[106:107], v14 offset:2048
  v_sub_f32 v16, 0, v24
  v_mov_b32 v18, v25
  s_mov_b32 s48, 1.0
  s_mov_b32 s49, 1.0
  v_mov_b32 v20, 0xbfb8aa3b
  v_mov_b32 v21, 0xbfb8aa3b
  s_waitcnt lgkmcnt(0)
  s_barrier
  ds_read_b128 v[120:123], v12 offset:3072
  ds_read_b128 v[124:127], v12 offset:4096
  s_waitcnt lgkmcnt(0)
  v_pk_add_f32 v[80:81], v[80:81], v[120:121]
  v_lshlrev_b32 v28, 16, v94
  v_and_b32 v29, s47, v94
  v_pk_mul_f32 v[32:33], v[80:81], v[20:21]
  v_lshlrev_b32 v30, 16, v104
  v_and_b32 v31, s47, v104
  v_exp_f32 v32, v32
  v_exp_f32 v33, v33
  v_pk_add_f32 v[34:35], v[28:29], v[16:17] op_sel_hi:[1,0]
  v_pk_add_f32 v[32:33], v[32:33], s[48:49]
  v_pk_mul_f32 v[34:35], v[34:35], v[18:19] op_sel_hi:[1,0]
  v_rcp_f32 v32, v32
  v_rcp_f32 v33, v33
  v_pk_mul_f32 v[34:35], v[34:35], v[30:31]
  v_pk_mul_f32 v[32:33], v[32:33], v[80:81]
  v_pk_fma_f32 v[34:35], v[34:35], v[32:33], v[28:29]
  v_cvt_pk_bf16_f32 v94, v34, v35
  v_pk_add_f32 v[82:83], v[82:83], v[122:123]
  v_lshlrev_b32 v36, 16, v95
  v_and_b32 v37, s47, v95
  v_pk_mul_f32 v[40:41], v[82:83], v[20:21]
  v_lshlrev_b32 v38, 16, v105
  v_and_b32 v39, s47, v105
  v_exp_f32 v40, v40
  v_exp_f32 v41, v41
  v_pk_add_f32 v[42:43], v[36:37], v[16:17] op_sel_hi:[1,0]
  v_pk_add_f32 v[40:41], v[40:41], s[48:49]
  v_pk_mul_f32 v[42:43], v[42:43], v[18:19] op_sel_hi:[1,0]
  v_rcp_f32 v40, v40
  v_rcp_f32 v41, v41
  v_pk_mul_f32 v[42:43], v[42:43], v[38:39]
  v_pk_mul_f32 v[40:41], v[40:41], v[82:83]
  v_pk_fma_f32 v[42:43], v[42:43], v[40:41], v[36:37]
  v_cvt_pk_bf16_f32 v95, v42, v43
  ds_write_b64 v13, v[94:95] offset:96
  v_pk_add_f32 v[84:85], v[84:85], v[124:125]
  v_lshlrev_b32 v28, 16, v96
  v_and_b32 v29, s47, v96
  v_pk_mul_f32 v[32:33], v[84:85], v[20:21]
  v_lshlrev_b32 v30, 16, v106
  v_and_b32 v31, s47, v106
  v_exp_f32 v32, v32
  v_exp_f32 v33, v33
  v_pk_add_f32 v[34:35], v[28:29], v[16:17] op_sel_hi:[1,0]
  v_pk_add_f32 v[32:33], v[32:33], s[48:49]
  v_pk_mul_f32 v[34:35], v[34:35], v[18:19] op_sel_hi:[1,0]
  v_rcp_f32 v32, v32
  v_rcp_f32 v33, v33
  v_pk_mul_f32 v[34:35], v[34:35], v[30:31]
  v_pk_mul_f32 v[32:33], v[32:33], v[84:85]
  v_pk_fma_f32 v[34:35], v[34:35], v[32:33], v[28:29]
  v_cvt_pk_bf16_f32 v96, v34, v35
  v_pk_add_f32 v[86:87], v[86:87], v[126:127]
  v_lshlrev_b32 v36, 16, v97
  v_and_b32 v37, s47, v97
  v_pk_mul_f32 v[40:41], v[86:87], v[20:21]
  v_lshlrev_b32 v38, 16, v107
  v_and_b32 v39, s47, v107
  v_exp_f32 v40, v40
  v_exp_f32 v41, v41
  v_pk_add_f32 v[42:43], v[36:37], v[16:17] op_sel_hi:[1,0]
  v_pk_add_f32 v[40:41], v[40:41], s[48:49]
  v_pk_mul_f32 v[42:43], v[42:43], v[18:19] op_sel_hi:[1,0]
  v_rcp_f32 v40, v40
  v_rcp_f32 v41, v41
  v_pk_mul_f32 v[42:43], v[42:43], v[38:39]
  v_pk_mul_f32 v[40:41], v[40:41], v[86:87]
  v_pk_fma_f32 v[42:43], v[42:43], v[40:41], v[36:37]
  v_cvt_pk_bf16_f32 v97, v42, v43
  ds_write_b64 v13, v[96:97] offset:128
  s_waitcnt lgkmcnt(0)
  s_barrier
  s_add_u32 s40, s37, 122880
  v_add_u32 v13, s40, v4
  ds_read_b128 v[108:111], v13 offset:2048
  s_waitcnt lgkmcnt(0)
  s_mov_b32 exec_lo, 0xffffffff
  s_mov_b32 exec_hi, 0x0
  buffer_store_dwordx4 v[108:111], v7, s[12:15], 0 offen
  s_mov_b64 exec, s[52:53]
  s_endpgm
F2_IDLE:
  s_waitcnt vmcnt(0)
  s_barrier
  s_sleep 3
  s_sub_u32 s42, s34, 4
  v_lshrrev_b32 v8, 3, v1
  s_lshl_b32 s40, s42, 3
  v_add_u32 v8, s40, v8
  v_and_b32 v9, 7, v1
  v_lshlrev_b32 v9, 4, v9
  v_mul_u32_u24 v10, 144, v8
  v_add_u32 v10, v10, v9
  v_add_u32 v10, 49152, v10
  v_lshlrev_b32 v8, 12, v8
  v_add_u32 v8, v8, v9
  ds_read_b128 v[16:19], v10 offset:0
  ds_read_b128 v[20:23], v10 offset:3456
  ds_read_b128 v[24:27], v10 offset:6912
  ds_read_b128 v[28:31], v10 offset:10368
  s_mul_i32 s40, s33, 327680
  s_lshl_b32 s41, s32, 7
  s_add_u32 s40, s40, s41
  s_add_u32 s40, s40, 6291456
  s_waitcnt lgkmcnt(0)
  buffer_store_dwordx4 v[16:19], v8, s[16:19], s40 offen sc1
  s_add_u32 s40, s40, 98304
  buffer_store_dwordx4 v[20:23], v8, s[16:19], s40 offen sc1
  s_add_u32 s40, s40, 98304
  buffer_store_dwordx4 v[24:27], v8, s[16:19], s40 offen sc1
  s_add_u32 s40, s40, 98304
  s_cmp_eq_u32 s42, 0
  s_cselect_b32 s40, s40, 0x80000000
  buffer_store_dwordx4 v[28:31], v8, s[16:19], s40 offen sc1
  s_add_u32 s40, s40, 98304
  s_barrier
  s_waitcnt vmcnt(0)
  s_barrier
  s_barrier
  s_barrier
  s_barrier
  s_barrier
  s_barrier
  s_barrier
  s_barrier
  s_barrier
  s_barrier
  s_barrier
  s_barrier
  s_barrier
  s_barrier
  s_barrier
  s_barrier
  s_barrier
  s_barrier
  s_barrier
  s_branch F3_IDLE
F2_SYNC:
  s_load_dwordx2 s[72:73], s[0:1], 104
  s_waitcnt lgkmcnt(0)
  s_load_dwordx2 s[70:71], s[0:1], 64
  s_lshl_b32 s40, s32, 6
  s_lshl_b32 s41, s33, 3
  s_add_u32 s40, s40, s41
  v_lshrrev_b32 v20, 3, v1
  v_add_u32 v20, s40, v20
  v_lshlrev_b32 v20, 12, v20
  v_and_b32 v21, 7, v1
  v_lshlrev_b32 v21, 6, v21
  v_add_u32 v20, v20, v21
  v_lshrrev_b32 v22, 2, v1
  v_add_u32 v22, s40, v22
  v_lshlrev_b32 v22, 12, v22
  v_and_b32 v21, 3, v1
  v_lshlrev_b32 v21, 6, v21
  v_add_u32 v22, v22, v21
  s_waitcnt lgkmcnt(0)
  s_mov_b32 s8, s70
  s_and_b32 s9, s71, 0xffff
  s_mov_b32 s10, 8388608
  s_mov_b32 s11, 0x20000
  s_lshl_b32 s40, s33, 7
  s_lshl_b32 s41, s32, 2
  s_add_u32 s40, s40, s41
  s_add_u32 s41, s40, 17040384
  s_add_u32 s40, s40, 17039360
  v_mov_b32 v152, s40
  v_mov_b32 v153, s41
  v_cmp_eq_u32 vcc, 1, v1
  s_nop 1
  v_cndmask_b32 v152, v152, v153, vcc
  s_lshl_b32 s40, s32, 5
  s_lshl_b32 s41, s33, 2
  s_add_u32 s40, s40, s41
  s_add_u32 s40, s40, 17041408
  v_mov_b32 v153, s40
  v_cmp_eq_u32 vcc, 2, v1
  s_nop 1
  v_cndmask_b32 v152, v152, v153, vcc
  s_lshl_b32 s40, s33, 7
  s_lshl_b32 s41, s32, 2
  s_add_u32 s40, s40, s41
  s_add_u32 s40, s40, 17042432
  v_mov_b32 v153, s40
  v_cmp_eq_u32 vcc, 3, v1
  s_nop 1
  v_cndmask_b32 v152, v152, v153, vcc
  v_mov_b32 v154, 1
  s_waitcnt vmcnt(0) lgkmcnt(0)
  s_barrier
  s_mov_b32 exec_lo, 0x1
  s_mov_b32 exec_hi, 0x0
  buffer_store_dword v154, v152, s[16:19], 0 offen sc1
  s_mov_b64 exec, s[52:53]
  s_lshl_b32 s40, s33, 7
  s_add_u32 s75, s40, 17039360
  s_add_u32 s40, s40, 17039360
  v_lshlrev_b32 v150, 2, v1
  v_add_u32 v150, s40, v150
  s_add_u32 s74, s75, 0
  s_mov_b32 s42, 0
SP_F1a:
  s_load_dwordx8 s[56:63], s[72:73], s74 glc
  s_waitcnt lgkmcnt(0)
  s_and_b64 s[56:57], s[56:57], s[60:61]
  s_and_b64 s[58:59], s[58:59], s[62:63]
  s_and_b64 s[56:57], s[56:57], s[58:59]
  s_and_b32 s56, s56, s57
  s_add_u32 s42, s42, 1
  s_cmp_eq_u32 s56, 1
  s_cbranch_scc1 SP_F1a_OK
  s_cmp_lt_u32 s42, 2097152
  s_cbranch_scc1 SP_F1a
SP_F1a_OK:
  s_barrier
  s_barrier
  s_mov_b32 exec_lo, 0x8
  s_mov_b32 exec_hi, 0x0
  buffer_store_dword v154, v152, s[16:19], 0 offen sc1
  s_mov_b64 exec, s[52:53]
  s_add_u32 s74, s75, 32
  s_mov_b32 s42, 0
SP_F1b:
  s_load_dwordx8 s[56:63], s[72:73], s74 glc
  s_waitcnt lgkmcnt(0)
  s_and_b64 s[56:57], s[56:57], s[60:61]
  s_and_b64 s[58:59], s[58:59], s[62:63]
  s_and_b64 s[56:57], s[56:57], s[58:59]
  s_and_b32 s56, s56, s57
  s_add_u32 s42, s42, 1
  s_cmp_eq_u32 s56, 1
  s_cbranch_scc1 SP_F1b_OK
  s_cmp_lt_u32 s42, 2097152
  s_cbranch_scc1 SP_F1b
SP_F1b_OK:
  s_barrier
  s_barrier
  s_add_u32 s74, s75, 64
  s_mov_b32 s42, 0
SP_F1c:
  s_load_dwordx16 s[56:71], s[72:73], s74 glc
  s_waitcnt lgkmcnt(0)
  s_and_b64 s[56:57], s[56:57], s[64:65]
  s_and_b64 s[58:59], s[58:59], s[66:67]
  s_and_b64 s[60:61], s[60:61], s[68:69]
  s_and_b64 s[62:63], s[62:63], s[70:71]
  s_and_b64 s[56:57], s[56:57], s[60:61]
  s_and_b64 s[58:59], s[58:59], s[62:63]
  s_and_b64 s[56:57], s[56:57], s[58:59]
  s_and_b32 s56, s56, s57
  s_add_u32 s42, s42, 1
  s_cmp_eq_u32 s56, 1
  s_cbranch_scc1 SP_F1c_OK
  s_cmp_lt_u32 s42, 2097152
  s_cbranch_scc1 SP_F1c
SP_F1c_OK:
  s_barrier
  s_add_u32 s75, s75, 3072
  s_add_u32 s74, s75, 0
  s_mov_b32 s42, 0
SP_FKa:
  s_load_dwordx16 s[56:71], s[72:73], s74 glc
  s_waitcnt lgkmcnt(0)
  s_and_b64 s[56:57], s[56:57], s[64:65]
  s_and_b64 s[58:59], s[58:59], s[66:67]
  s_and_b64 s[60:61], s[60:61], s[68:69]
  s_and_b64 s[62:63], s[62:63], s[70:71]
  s_and_b64 s[56:57], s[56:57], s[60:61]
  s_and_b64 s[58:59], s[58:59], s[62:63]
  s_and_b64 s[56:57], s[56:57], s[58:59]
  s_and_b32 s56, s56, s57
  s_add_u32 s42, s42, 1
  s_cmp_eq_u32 s56, 1
  s_cbranch_scc1 SP_FKa_OK
  s_cmp_lt_u32 s42, 2097152
  s_cbranch_scc1 SP_FKa
SP_FKa_OK:
  s_add_u32 s74, s75, 64
  s_mov_b32 s42, 0
SP_FKb:
  s_load_dwordx16 s[56:71], s[72:73], s74 glc
  s_waitcnt lgkmcnt(0)
  s_and_b64 s[56:57], s[56:57], s[64:65]
  s_and_b64 s[58:59], s[58:59], s[66:67]
  s_and_b64 s[60:61], s[60:61], s[68:69]
  s_and_b64 s[62:63], s[62:63], s[70:71]
  s_and_b64 s[56:57], s[56:57], s[60:61]
  s_and_b64 s[58:59], s[58:59], s[62:63]
  s_and_b64 s[56:57], s[56:57], s[58:59]
  s_and_b32 s56, s56, s57
  s_add_u32 s42, s42, 1
  s_cmp_eq_u32 s56, 1
  s_cbranch_scc1 SP_FKb_OK
  s_cmp_lt_u32 s42, 2097152
  s_cbranch_scc1 SP_FKb
SP_FKb_OK:
  s_barrier
  s_barrier
  s_barrier
  s_barrier
  s_barrier
  s_barrier
  s_barrier
  s_barrier
  s_barrier
  s_barrier
  s_barrier
  s_barrier
  s_barrier
  s_load_dwordx2 s[56:57], s[0:1], 0
  s_load_dwordx2 s[58:59], s[0:1], 88
  v_lshlrev_b32 v4, 4, v1
  s_lshl_b32 s35, s32, 2
  s_add_u32 s35, s35, s55
  s_lshr_b32 s39, s34, 2
  s_mul_i32 s36, s35, 24576
  s_mul_i32 s40, s39, 12288
  s_add_u32 s36, s36, s40
  s_add_u32 s36, s36, 12582912
  s_mul_i32 s40, s39, 61440
  v_add_u32 v26, s40, v4
  s_lshl_b32 s40, s35, 4
  s_mul_i32 s40, s40, 1280
  s_mul_i32 s41, s33, 160
  s_add_u32 s40, s40, s41
  v_add_u32 v12, 0, v1
  v_mul_u32_u24 v13, 6554, v12
  v_lshrrev_b32 v13, 16, v13
  v_mul_u32_u24 v14, 10, v13
  v_sub_u32 v14, v12, v14
  v_lshlrev_b32 v14, 4, v14
  v_mul_u32_u24 v13, 1280, v13
  v_add_u32 v13, v13, v14
  v_add_u32 v5, s40, v13
  v_lshrrev_b32 v13, 1, v12
  v_lshlrev_b32 v13, 12, v13
  v_and_b32 v14, 1, v12
  v_lshlrev_b32 v14, 4, v14
  v_add_u32 v8, v13, v14
  v_add_u32 v12, 64, v1
  v_mul_u32_u24 v13, 6554, v12
  v_lshrrev_b32 v13, 16, v13
  v_mul_u32_u24 v14, 10, v13
  v_sub_u32 v14, v12, v14
  v_lshlrev_b32 v14, 4, v14
  v_mul_u32_u24 v13, 1280, v13
  v_add_u32 v13, v13, v14
  v_add_u32 v6, s40, v13
  v_lshrrev_b32 v13, 1, v12
  v_lshlrev_b32 v13, 12, v13
  v_and_b32 v14, 1, v12
  v_lshlrev_b32 v14, 4, v14
  v_add_u32 v9, v13, v14
  v_add_u32 v12, 128, v1
  v_mul_u32_u24 v13, 6554, v12
  v_lshrrev_b32 v13, 16, v13
  v_mul_u32_u24 v14, 10, v13
  v_sub_u32 v14, v12, v14
  v_lshlrev_b32 v14, 4, v14
  v_mul_u32_u24 v13, 1280, v13
  v_add_u32 v13, v13, v14
  v_add_u32 v7, s40, v13
  v_lshrrev_b32 v13, 1, v12
  v_lshlrev_b32 v13, 12, v13
  v_and_b32 v14, 1, v12
  v_lshlrev_b32 v14, 4, v14
  v_add_u32 v10, v13, v14
  s_mul_i32 s37, s55, 2560
  s_mul_i32 s38, s33, 327680
  s_lshl_b32 s41, s35, 5
  s_add_u32 s38, s38, s41
  s_add_u32 s38, s38, 9437184
  s_lshl_b32 s40, s55, 6
  s_add_u32 s40, s40, 143360
  v_lshlrev_b32 v21, 2, v3
  v_add_u32 v21, s40, v21
  ds_read_b32 v24, v21
  ds_read_b32 v25, v21 offset:256
  v_mov_b32 v68, 0
  v_mov_b32 v69, 0
  v_mov_b32 v70, 0
  v_mov_b32 v71, 0
  v_mov_b32 v72, 0
  v_mov_b32 v73, 0
  v_mov_b32 v74, 0
  v_mov_b32 v75, 0
  v_mov_b32 v76, 0
  v_mov_b32 v77, 0
  v_mov_b32 v78, 0
  v_mov_b32 v79, 0
  v_mov_b32 v80, 0
  v_mov_b32 v81, 0
  v_mov_b32 v82, 0
  v_mov_b32 v83, 0
  v_mov_b32 v84, 0
  v_mov_b32 v85, 0
  v_mov_b32 v86, 0
  v_mov_b32 v87, 0
  s_waitcnt lgkmcnt(0)
  s_mov_b32 s8, s56
  s_and_b32 s9, s57, 0xffff
  s_mov_b32 s10, 2621440
  s_mov_b32 s11, 0x20000
  s_mov_b32 s12, s58
  s_and_b32 s13, s59, 0xffff
  s_mov_b32 s14, 2621440
  s_mov_b32 s15, 0x20000
  s_barrier
  s_barrier
  s_mov_b32 exec_lo, 0x6
  s_mov_b32 exec_hi, 0x0
  buffer_store_dword v154, v152, s[16:19], 0 offen sc1
  s_mov_b64 exec, s[52:53]
  s_lshl_b32 s40, s32, 5
  s_add_u32 s75, s40, 17041408
  s_add_u32 s74, s75, 0
  s_mov_b32 s42, 0
SP_F2B:
  s_load_dwordx8 s[56:63], s[72:73], s74 glc
  s_waitcnt lgkmcnt(0)
  s_and_b64 s[56:57], s[56:57], s[60:61]
  s_and_b64 s[58:59], s[58:59], s[62:63]
  s_and_b64 s[56:57], s[56:57], s[58:59]
  s_and_b32 s56, s56, s57
  s_add_u32 s42, s42, 1
  s_cmp_eq_u32 s56, 1
  s_cbranch_scc1 SP_F2B_OK
  s_cmp_lt_u32 s42, 2097152
  s_cbranch_scc1 SP_F2B
SP_F2B_OK:
  s_barrier
  s_branch F3_BMAIN
K1_END:
  s_endpgm
KF_CODE_END:

.section .rodata,"a"
.p2align 6
.amdhsa_kernel recurrent_scan__ssm_conv_h3__mixer_gmlp__prompt_kernel
  .amdhsa_next_free_vgpr 168
  .amdhsa_next_free_sgpr 96
  .amdhsa_accum_offset 168
  .amdhsa_group_segment_fixed_size 0
  .amdhsa_kernarg_size 112
  .amdhsa_user_sgpr_count 2
  .amdhsa_user_sgpr_kernarg_segment_ptr 1
  .amdhsa_system_sgpr_workgroup_id_x 1
  .amdhsa_float_denorm_mode_32 3
.end_amdhsa_kernel
.text
```

```asm
; @launch grid=(256,1,1) block=(768,1,1) lds=159744
.amdgcn_target "amdgcn-amd-amdhsa--gfx950"
.text
.globl recurrent_scan__ssm_conv_h3__mixer_gmlp__prompt_kernel
.p2align 8
.type recurrent_scan__ssm_conv_h3__mixer_gmlp__prompt_kernel,@function
recurrent_scan__ssm_conv_h3__mixer_gmlp__prompt_kernel:
  s_cmp_ge_u32 s2, 256
  s_cbranch_scc1 K1_END
  s_load_dwordx4 s[56:59], s[0:1], 0
  s_load_dwordx4 s[60:63], s[0:1], 16
  s_load_dwordx2 s[64:65], s[0:1], 56
  s_load_dwordx2 s[66:67], s[0:1], 80
  s_load_dwordx4 s[68:71], s[0:1], 96
  s_load_dwordx2 s[74:75], s[0:1], 64
  s_load_dwordx2 s[76:77], s[0:1], 32
  v_and_b32 v1, 63, v0
  v_lshrrev_b32 v14, 6, v0
  v_lshrrev_b32 v2, 4, v1
  v_readfirstlane_b32 s34, v14
  v_and_b32 v3, 15, v1
  s_and_b32 s40, s2, 7
  s_lshr_b32 s41, s2, 3
  s_lshr_b32 s32, s40, 1
  s_lshl_b32 s32, s32, 3
  s_lshr_b32 s42, s41, 2
  s_add_u32 s32, s32, s42
  s_and_b32 s33, s40, 1
  s_lshl_b32 s33, s33, 2
  s_and_b32 s42, s41, 3
  s_add_u32 s33, s33, s42
  s_and_b32 s55, s34, 3
  s_lshr_b32 s35, s55, 1
  s_and_b32 s36, s55, 1
  s_mov_b32 s47, 0xffff0000
  s_mov_b64 s[52:53], exec
  s_mul_i32 s44, s33, 192
  s_add_u32 s43, s44, 1536
  s_cmp_ge_u32 s34, 8
  s_cbranch_scc0 K1_AB
  s_lshl_b32 s40, s32, 6
  s_lshl_b32 s41, s55, 3
  s_add_u32 s40, s40, s41
  s_lshl_b32 s45, s55, 10
  v_lshrrev_b32 v30, 3, v1
  v_add_u32 v32, s41, v30
  v_lshrrev_b32 v31, 1, v32
  v_xor_b32 v31, v31, v1
  v_and_b32 v31, 7, v31
  v_lshlrev_b32 v31, 4, v31
  v_add_u32 v30, s40, v30
  v_mul_u32_u24 v30, 1280, v30
  v_add_u32 v8, v30, v31
  v_add_u32 v9, 40960, v8
  s_waitcnt lgkmcnt(0)
  s_mov_b32 s8, s56
  s_and_b32 s9, s57, 0xffff
  s_mov_b32 s10, 2621440
  s_mov_b32 s11, 0x20000
  s_mov_b32 s12, s64
  s_and_b32 s13, s65, 0xffff
  s_mov_b32 s14, 1966080
  s_mov_b32 s15, 0x20000
  s_and_b32 s40, s32, 7
  s_and_b32 s41, s33, 3
  s_mul_i32 s41, s41, 3
  s_add_u32 s37, s40, s41
  s_sub_u32 s40, s37, 10
  s_cmp_ge_u32 s37, 10
  s_cselect_b32 s37, s40, s37
  s_lshl_b32 s40, s55, 6
  s_add_u32 s40, s40, 0
  v_add_u32 v30, s40, v1
  v_mul_u32_u24 v31, 5462, v30
  v_lshrrev_b32 v31, 16, v31
  v_mul_u32_u24 v32, 12, v31
  v_sub_u32 v32, v30, v32
  v_lshrrev_b32 v33, 2, v31
  v_and_b32 v33, 2, v33
  v_xor_b32 v32, v32, v33
  v_lshlrev_b32 v32, 4, v32
  v_mul_u32_u24 v31, 3072, v31
  v_add_u32 v12, v31, v32
  s_lshl_b32 s40, s55, 6
  s_add_u32 s40, s40, 256
  v_add_u32 v30, s40, v1
  v_mul_u32_u24 v31, 5462, v30
  v_lshrrev_b32 v31, 16, v31
  v_mul_u32_u24 v32, 12, v31
  v_sub_u32 v32, v30, v32
  v_lshrrev_b32 v33, 2, v31
  v_and_b32 v33, 2, v33
  v_xor_b32 v32, v32, v33
  v_lshlrev_b32 v32, 4, v32
  v_mul_u32_u24 v31, 3072, v31
  v_add_u32 v13, v31, v32
  s_lshl_b32 s40, s55, 6
  s_add_u32 s40, s40, 512
  v_add_u32 v30, s40, v1
  v_mul_u32_u24 v31, 5462, v30
  v_lshrrev_b32 v31, 16, v31
  v_mul_u32_u24 v32, 12, v31
  v_sub_u32 v32, v30, v32
  v_lshrrev_b32 v33, 2, v31
  v_and_b32 v33, 2, v33
  v_xor_b32 v32, v32, v33
  v_lshlrev_b32 v32, 4, v32
  v_mul_u32_u24 v31, 3072, v31
  v_add_u32 v14, v31, v32
  s_add_u32 s38, s37, 0
  s_sub_u32 s40, s38, 10
  s_cmp_ge_u32 s38, 10
  s_cselect_b32 s38, s40, s38
  s_lshl_b32 s38, s38, 7
  s_add_u32 m0, s45, 61440
  s_nop 0
  buffer_load_dwordx4 v8, s[8:11], s38 offen  lds
  s_add_u32 m0, s45, 65536
  s_nop 0
  buffer_load_dwordx4 v9, s[8:11], s38 offen  lds
  s_add_u32 s39, s37, 0
  s_sub_u32 s40, s39, 10
  s_cmp_ge_u32 s39, 10
  s_cselect_b32 s39, s40, s39
  s_mul_i32 s39, s39, 196608
  s_add_u32 s39, s39, s43
  s_add_u32 m0, s45, 0
  s_nop 0
  buffer_load_dwordx4 v12, s[12:15], s39 offen  lds
  s_add_u32 m0, s45, 4096
  s_nop 0
  buffer_load_dwordx4 v13, s[12:15], s39 offen  lds
  s_add_u32 m0, s45, 8192
  s_nop 0
  buffer_load_dwordx4 v14, s[12:15], s39 offen  lds
  s_add_u32 s38, s37, 1
  s_sub_u32 s40, s38, 10
  s_cmp_ge_u32 s38, 10
  s_cselect_b32 s38, s40, s38
  s_lshl_b32 s38, s38, 7
  s_add_u32 m0, s45, 69632
  s_nop 0
  buffer_load_dwordx4 v8, s[8:11], s38 offen  lds
  s_add_u32 m0, s45, 73728
  s_nop 0
  buffer_load_dwordx4 v9, s[8:11], s38 offen  lds
  s_add_u32 s39, s37, 1
  s_sub_u32 s40, s39, 10
  s_cmp_ge_u32 s39, 10
  s_cselect_b32 s39, s40, s39
  s_mul_i32 s39, s39, 196608
  s_add_u32 s39, s39, s43
  s_add_u32 m0, s45, 12288
  s_nop 0
  buffer_load_dwordx4 v12, s[12:15], s39 offen  lds
  s_add_u32 m0, s45, 16384
  s_nop 0
  buffer_load_dwordx4 v13, s[12:15], s39 offen  lds
  s_add_u32 m0, s45, 20480
  s_nop 0
  buffer_load_dwordx4 v14, s[12:15], s39 offen  lds
  s_waitcnt vmcnt(5)
  s_barrier
  s_add_u32 s38, s37, 2
  s_sub_u32 s40, s38, 10
  s_cmp_ge_u32 s38, 10
  s_cselect_b32 s38, s40, s38
  s_lshl_b32 s38, s38, 7
  s_add_u32 m0, s45, 77824
  s_nop 0
  buffer_load_dwordx4 v8, s[8:11], s38 offen  lds
  s_add_u32 m0, s45, 81920
  s_nop 0
  buffer_load_dwordx4 v9, s[8:11], s38 offen  lds
  s_add_u32 s39, s37, 2
  s_sub_u32 s40, s39, 10
  s_cmp_ge_u32 s39, 10
  s_cselect_b32 s39, s40, s39
  s_mul_i32 s39, s39, 196608
  s_add_u32 s39, s39, s43
  s_add_u32 m0, s45, 24576
  s_nop 0
  buffer_load_dwordx4 v12, s[12:15], s39 offen  lds
  s_add_u32 m0, s45, 28672
  s_nop 0
  buffer_load_dwordx4 v13, s[12:15], s39 offen  lds
  s_add_u32 m0, s45, 32768
  s_nop 0
  buffer_load_dwordx4 v14, s[12:15], s39 offen  lds
  s_add_u32 s38, s37, 3
  s_sub_u32 s40, s38, 10
  s_cmp_ge_u32 s38, 10
  s_cselect_b32 s38, s40, s38
  s_lshl_b32 s38, s38, 7
  s_add_u32 m0, s45, 86016
  s_nop 0
  buffer_load_dwordx4 v8, s[8:11], s38 offen  lds
  s_add_u32 m0, s45, 90112
  s_nop 0
  buffer_load_dwordx4 v9, s[8:11], s38 offen  lds
  s_add_u32 s39, s37, 3
  s_sub_u32 s40, s39, 10
  s_cmp_ge_u32 s39, 10
  s_cselect_b32 s39, s40, s39
  s_mul_i32 s39, s39, 196608
  s_add_u32 s39, s39, s43
  s_add_u32 m0, s45, 36864
  s_nop 0
  buffer_load_dwordx4 v12, s[12:15], s39 offen  lds
  s_add_u32 m0, s45, 40960
  s_nop 0
  buffer_load_dwordx4 v13, s[12:15], s39 offen  lds
  s_add_u32 m0, s45, 45056
  s_nop 0
  buffer_load_dwordx4 v14, s[12:15], s39 offen  lds
  s_waitcnt vmcnt(10)
  s_barrier
  s_add_u32 s38, s37, 4
  s_sub_u32 s40, s38, 10
  s_cmp_ge_u32 s38, 10
  s_cselect_b32 s38, s40, s38
  s_lshl_b32 s38, s38, 7
  s_add_u32 m0, s45, 94208
  s_nop 0
  buffer_load_dwordx4 v8, s[8:11], s38 offen  lds
  s_add_u32 m0, s45, 98304
  s_nop 0
  buffer_load_dwordx4 v9, s[8:11], s38 offen  lds
  s_add_u32 s39, s37, 4
  s_sub_u32 s40, s39, 10
  s_cmp_ge_u32 s39, 10
  s_cselect_b32 s39, s40, s39
  s_mul_i32 s39, s39, 196608
  s_add_u32 s39, s39, s43
  s_add_u32 m0, s45, 49152
  s_nop 0
  buffer_load_dwordx4 v12, s[12:15], s39 offen  lds
  s_add_u32 m0, s45, 53248
  s_nop 0
  buffer_load_dwordx4 v13, s[12:15], s39 offen  lds
  s_add_u32 m0, s45, 57344
  s_nop 0
  buffer_load_dwordx4 v14, s[12:15], s39 offen  lds
  s_add_u32 s38, s37, 5
  s_sub_u32 s40, s38, 10
  s_cmp_ge_u32 s38, 10
  s_cselect_b32 s38, s40, s38
  s_lshl_b32 s38, s38, 7
  s_add_u32 m0, s45, 102400
  s_nop 0
  buffer_load_dwordx4 v8, s[8:11], s38 offen  lds
  s_add_u32 m0, s45, 106496
  s_nop 0
  buffer_load_dwordx4 v9, s[8:11], s38 offen  lds
  s_waitcnt vmcnt(12)
  s_barrier
  s_add_u32 s38, s37, 6
  s_sub_u32 s40, s38, 10
  s_cmp_ge_u32 s38, 10
  s_cselect_b32 s38, s40, s38
  s_lshl_b32 s38, s38, 7
  s_add_u32 m0, s45, 110592
  s_nop 0
  buffer_load_dwordx4 v8, s[8:11], s38 offen  lds
  s_add_u32 m0, s45, 114688
  s_nop 0
  buffer_load_dwordx4 v9, s[8:11], s38 offen  lds
  s_add_u32 s39, s37, 5
  s_sub_u32 s40, s39, 10
  s_cmp_ge_u32 s39, 10
  s_cselect_b32 s39, s40, s39
  s_mul_i32 s39, s39, 196608
  s_add_u32 s39, s39, s43
  s_add_u32 m0, s45, 0
  s_nop 0
  buffer_load_dwordx4 v12, s[12:15], s39 offen  lds
  s_add_u32 m0, s45, 4096
  s_nop 0
  buffer_load_dwordx4 v13, s[12:15], s39 offen  lds
  s_add_u32 m0, s45, 8192
  s_nop 0
  buffer_load_dwordx4 v14, s[12:15], s39 offen  lds
  s_add_u32 s38, s37, 7
  s_sub_u32 s40, s38, 10
  s_cmp_ge_u32 s38, 10
  s_cselect_b32 s38, s40, s38
  s_lshl_b32 s38, s38, 7
  s_add_u32 m0, s45, 118784
  s_nop 0
  buffer_load_dwordx4 v8, s[8:11], s38 offen  lds
  s_add_u32 m0, s45, 122880
  s_nop 0
  buffer_load_dwordx4 v9, s[8:11], s38 offen  lds
  s_waitcnt vmcnt(14)
  s_barrier
  s_add_u32 s38, s37, 8
  s_sub_u32 s40, s38, 10
  s_cmp_ge_u32 s38, 10
  s_cselect_b32 s38, s40, s38
  s_lshl_b32 s38, s38, 7
  s_add_u32 m0, s45, 126976
  s_nop 0
  buffer_load_dwordx4 v8, s[8:11], s38 offen  lds
  s_add_u32 m0, s45, 131072
  s_nop 0
  buffer_load_dwordx4 v9, s[8:11], s38 offen  lds
  s_add_u32 s39, s37, 6
  s_sub_u32 s40, s39, 10
  s_cmp_ge_u32 s39, 10
  s_cselect_b32 s39, s40, s39
  s_mul_i32 s39, s39, 196608
  s_add_u32 s39, s39, s43
  s_add_u32 m0, s45, 12288
  s_nop 0
  buffer_load_dwordx4 v12, s[12:15], s39 offen  lds
  s_add_u32 m0, s45, 16384
  s_nop 0
  buffer_load_dwordx4 v13, s[12:15], s39 offen  lds
  s_add_u32 m0, s45, 20480
  s_nop 0
  buffer_load_dwordx4 v14, s[12:15], s39 offen  lds
  s_add_u32 s38, s37, 9
  s_sub_u32 s40, s38, 10
  s_cmp_ge_u32 s38, 10
  s_cselect_b32 s38, s40, s38
  s_lshl_b32 s38, s38, 7
  s_add_u32 m0, s45, 135168
  s_nop 0
  buffer_load_dwordx4 v8, s[8:11], s38 offen  lds
  s_add_u32 m0, s45, 139264
  s_nop 0
  buffer_load_dwordx4 v9, s[8:11], s38 offen  lds
  s_waitcnt vmcnt(16)
  s_barrier
  s_add_u32 s39, s37, 7
  s_sub_u32 s40, s39, 10
  s_cmp_ge_u32 s39, 10
  s_cselect_b32 s39, s40, s39
  s_mul_i32 s39, s39, 196608
  s_add_u32 s39, s39, s43
  s_add_u32 m0, s45, 24576
  s_nop 0
  buffer_load_dwordx4 v12, s[12:15], s39 offen  lds
  s_add_u32 m0, s45, 28672
  s_nop 0
  buffer_load_dwordx4 v13, s[12:15], s39 offen  lds
  s_add_u32 m0, s45, 32768
  s_nop 0
  buffer_load_dwordx4 v14, s[12:15], s39 offen  lds
  s_waitcnt vmcnt(12)
  s_barrier
  s_add_u32 s39, s37, 8
  s_sub_u32 s40, s39, 10
  s_cmp_ge_u32 s39, 10
  s_cselect_b32 s39, s40, s39
  s_mul_i32 s39, s39, 196608
  s_add_u32 s39, s39, s43
  s_add_u32 m0, s45, 36864
  s_nop 0
  buffer_load_dwordx4 v12, s[12:15], s39 offen  lds
  s_add_u32 m0, s45, 40960
  s_nop 0
  buffer_load_dwordx4 v13, s[12:15], s39 offen  lds
  s_add_u32 m0, s45, 45056
  s_nop 0
  buffer_load_dwordx4 v14, s[12:15], s39 offen  lds
  s_add_u32 s39, s37, 9
  s_sub_u32 s40, s39, 10
  s_cmp_ge_u32 s39, 10
  s_cselect_b32 s39, s40, s39
  s_mul_i32 s39, s39, 196608
  s_add_u32 s39, s39, s43
  s_add_u32 m0, s45, 49152
  s_nop 0
  buffer_load_dwordx4 v12, s[12:15], s39 offen  lds
  s_add_u32 m0, s45, 53248
  s_nop 0
  buffer_load_dwordx4 v13, s[12:15], s39 offen  lds
  s_add_u32 m0, s45, 57344
  s_nop 0
  buffer_load_dwordx4 v14, s[12:15], s39 offen  lds
  s_waitcnt vmcnt(11)
  s_barrier
  s_add_u32 s39, s37, 0
  s_sub_u32 s40, s39, 10
  s_cmp_ge_u32 s39, 10
  s_cselect_b32 s39, s40, s39
  s_mul_i32 s39, s39, 196608
  s_add_u32 s39, s39, s44
  s_add_u32 m0, s45, 0
  s_nop 0
  buffer_load_dwordx4 v12, s[12:15], s39 offen  lds
  s_add_u32 m0, s45, 4096
  s_nop 0
  buffer_load_dwordx4 v13, s[12:15], s39 offen  lds
  s_add_u32 m0, s45, 8192
  s_nop 0
  buffer_load_dwordx4 v14, s[12:15], s39 offen  lds
  s_waitcnt vmcnt(9)
  s_barrier
  s_add_u32 s39, s37, 1
  s_sub_u32 s40, s39, 10
  s_cmp_ge_u32 s39, 10
  s_cselect_b32 s39, s40, s39
  s_mul_i32 s39, s39, 196608
  s_add_u32 s39, s39, s44
  s_add_u32 m0, s45, 12288
  s_nop 0
  buffer_load_dwordx4 v12, s[12:15], s39 offen  lds
  s_add_u32 m0, s45, 16384
  s_nop 0
  buffer_load_dwordx4 v13, s[12:15], s39 offen  lds
  s_add_u32 m0, s45, 20480
  s_nop 0
  buffer_load_dwordx4 v14, s[12:15], s39 offen  lds
  s_waitcnt vmcnt(9)
  s_barrier
  s_add_u32 s39, s37, 2
  s_sub_u32 s40, s39, 10
  s_cmp_ge_u32 s39, 10
  s_cselect_b32 s39, s40, s39
  s_mul_i32 s39, s39, 196608
  s_add_u32 s39, s39, s44
  s_add_u32 m0, s45, 24576
  s_nop 0
  buffer_load_dwordx4 v12, s[12:15], s39 offen  lds
  s_add_u32 m0, s45, 28672
  s_nop 0
  buffer_load_dwordx4 v13, s[12:15], s39 offen  lds
  s_add_u32 m0, s45, 32768
  s_nop 0
  buffer_load_dwordx4 v14, s[12:15], s39 offen  lds
  s_waitcnt vmcnt(9)
  s_barrier
  s_add_u32 s39, s37, 3
  s_sub_u32 s40, s39, 10
  s_cmp_ge_u32 s39, 10
  s_cselect_b32 s39, s40, s39
  s_mul_i32 s39, s39, 196608
  s_add_u32 s39, s39, s44
  s_add_u32 m0, s45, 36864
  s_nop 0
  buffer_load_dwordx4 v12, s[12:15], s39 offen  lds
  s_add_u32 m0, s45, 40960
  s_nop 0
  buffer_load_dwordx4 v13, s[12:15], s39 offen  lds
  s_add_u32 m0, s45, 45056
  s_nop 0
  buffer_load_dwordx4 v14, s[12:15], s39 offen  lds
  s_waitcnt vmcnt(9)
  s_barrier
  s_add_u32 s39, s37, 4
  s_sub_u32 s40, s39, 10
  s_cmp_ge_u32 s39, 10
  s_cselect_b32 s39, s40, s39
  s_mul_i32 s39, s39, 196608
  s_add_u32 s39, s39, s44
  s_add_u32 m0, s45, 49152
  s_nop 0
  buffer_load_dwordx4 v12, s[12:15], s39 offen  lds
  s_add_u32 m0, s45, 53248
  s_nop 0
  buffer_load_dwordx4 v13, s[12:15], s39 offen  lds
  s_add_u32 m0, s45, 57344
  s_nop 0
  buffer_load_dwordx4 v14, s[12:15], s39 offen  lds
  v_mul_u32_u24 v5, 6554, v1
  v_lshrrev_b32 v5, 16, v5
  v_mul_u32_u24 v4, 10, v5
  v_sub_u32 v4, v1, v4
  v_lshlrev_b32 v4, 4, v4
  v_mul_u32_u24 v30, 1280, v5
  v_add_u32 v4, v4, v30
  s_mov_b32 s20, s58
  s_and_b32 s21, s59, 0xffff
  s_mov_b32 s22, 2621440
  s_mov_b32 s23, 0x20000
  s_mov_b32 s24, s60
  s_and_b32 s25, s61, 0xffff
  s_mov_b32 s26, 2621440
  s_mov_b32 s27, 0x20000
  s_lshl_b32 s40, s32, 6
  s_lshl_b32 s41, s55, 4
  s_add_u32 s40, s40, s41
  s_mul_i32 s46, s40, 1280
  s_mul_i32 s41, s33, 160
  s_add_u32 s46, s46, s41
  s_mul_i32 s78, s55, 6720
  s_add_u32 s78, s78, 61440
  v_mov_b32 v20, v4
  s_sub_u32 s79, s46, 3840
  s_cmp_eq_u32 s40, 0
  s_cbranch_scc0 K1_NONNEG
  v_subrev_u32 v20, 3840, v4
  v_cmp_gt_u32 vcc, 3, v5
  v_mov_b32 v31, 0x80000000
  s_nop 0
  v_cndmask_b32 v20, v20, v31, vcc
  s_mov_b32 s79, s46
K1_NONNEG:
  s_mov_b32 s28, s62
  s_and_b32 s29, s63, 0xffff
  s_mov_b32 s30, 5120
  s_mov_b32 s31, 0x20000
  v_lshlrev_b32 v21, 4, v1
  s_mul_i32 s54, s33, 640
  s_waitcnt vmcnt(9)
  s_barrier
  s_add_u32 s39, s37, 5
  s_sub_u32 s40, s39, 10
  s_cmp_ge_u32 s39, 10
  s_cselect_b32 s39, s40, s39
  s_mul_i32 s39, s39, 196608
  s_add_u32 s39, s39, s44
  s_add_u32 m0, s45, 0
  s_nop 0
  buffer_load_dwordx4 v12, s[12:15], s39 offen  lds
  s_add_u32 m0, s45, 4096
  s_nop 0
  buffer_load_dwordx4 v13, s[12:15], s39 offen  lds
  s_add_u32 m0, s45, 8192
  s_nop 0
  buffer_load_dwordx4 v14, s[12:15], s39 offen  lds
  s_waitcnt vmcnt(9)
  s_barrier
  s_add_u32 s39, s37, 6
  s_sub_u32 s40, s39, 10
  s_cmp_ge_u32 s39, 10
  s_cselect_b32 s39, s40, s39
  s_mul_i32 s39, s39, 196608
  s_add_u32 s39, s39, s44
  s_add_u32 m0, s45, 12288
  s_nop 0
  buffer_load_dwordx4 v12, s[12:15], s39 offen  lds
  s_add_u32 m0, s45, 16384
  s_nop 0
  buffer_load_dwordx4 v13, s[12:15], s39 offen  lds
  s_add_u32 m0, s45, 20480
  s_nop 0
  buffer_load_dwordx4 v14, s[12:15], s39 offen  lds
  s_waitcnt vmcnt(9)
  s_barrier
  s_add_u32 s39, s37, 7
  s_sub_u32 s40, s39, 10
  s_cmp_ge_u32 s39, 10
  s_cselect_b32 s39, s40, s39
  s_mul_i32 s39, s39, 196608
  s_add_u32 s39, s39, s44
  s_add_u32 m0, s45, 24576
  s_nop 0
  buffer_load_dwordx4 v12, s[12:15], s39 offen  lds
  s_add_u32 m0, s45, 28672
  s_nop 0
  buffer_load_dwordx4 v13, s[12:15], s39 offen  lds
  s_add_u32 m0, s45, 32768
  s_nop 0
  buffer_load_dwordx4 v14, s[12:15], s39 offen  lds
  s_waitcnt vmcnt(9)
  s_barrier
  s_add_u32 s39, s37, 8
  s_sub_u32 s40, s39, 10
  s_cmp_ge_u32 s39, 10
  s_cselect_b32 s39, s40, s39
  s_mul_i32 s39, s39, 196608
  s_add_u32 s39, s39, s44
  s_add_u32 m0, s45, 36864
  s_nop 0
  buffer_load_dwordx4 v12, s[12:15], s39 offen  lds
  s_add_u32 m0, s45, 40960
  s_nop 0
  buffer_load_dwordx4 v13, s[12:15], s39 offen  lds
  s_add_u32 m0, s45, 45056
  s_nop 0
  buffer_load_dwordx4 v14, s[12:15], s39 offen  lds
  s_waitcnt vmcnt(9)
  s_barrier
  s_add_u32 s39, s37, 9
  s_sub_u32 s40, s39, 10
  s_cmp_ge_u32 s39, 10
  s_cselect_b32 s39, s40, s39
  s_mul_i32 s39, s39, 196608
  s_add_u32 s39, s39, s44
  s_add_u32 m0, s45, 49152
  s_nop 0
  buffer_load_dwordx4 v12, s[12:15], s39 offen  lds
  s_add_u32 m0, s45, 53248
  s_nop 0
  buffer_load_dwordx4 v13, s[12:15], s39 offen  lds
  s_add_u32 m0, s45, 57344
  s_nop 0
  buffer_load_dwordx4 v14, s[12:15], s39 offen  lds
  s_mov_b32 exec_lo, 0xffffffff
  s_mov_b32 exec_hi, 0xfffffff
  s_add_u32 m0, s78, 0
  s_nop 0
  buffer_load_dwordx4 v20, s[20:23], s79 offen  lds
  s_add_u32 m0, s78, 960
  s_add_u32 s79, s46, 3840
  buffer_load_dwordx4 v4, s[20:23], s79 offen  lds
  s_add_u32 m0, s78, 1920
  s_add_u32 s79, s46, 11520
  buffer_load_dwordx4 v4, s[20:23], s79 offen  lds
  s_add_u32 m0, s78, 2880
  s_add_u32 s79, s46, 19200
  buffer_load_dwordx4 v4, s[20:23], s79 offen  lds
  s_add_u32 m0, s78, 3840
  s_add_u32 s79, s46, 0
  buffer_load_dwordx4 v4, s[24:27], s79 offen  lds
  s_add_u32 m0, s78, 4800
  s_add_u32 s79, s46, 7680
  buffer_load_dwordx4 v4, s[24:27], s79 offen  lds
  s_add_u32 m0, s78, 5760
  s_add_u32 s79, s46, 15360
  buffer_load_dwordx4 v4, s[24:27], s79 offen  lds
  s_mov_b64 exec, s[52:53]
  buffer_load_dwordx4 v[156:159], v21, s[28:31], s54 offen
  s_waitcnt vmcnt(17)
  s_barrier
  s_waitcnt vmcnt(14)
  s_barrier
  s_waitcnt vmcnt(11)
  s_barrier
  s_waitcnt vmcnt(8)
  s_barrier
  s_waitcnt vmcnt(0)
  v_lshlrev_b32 v30, 2, v1
  v_min_u32 v30, 156, v30
  v_add_u32 v30, s78, v30
  ds_read_b32 v40, v30 offset:0
  ds_read_b32 v41, v30 offset:160
  ds_read_b32 v42, v30 offset:320
  ds_read_b32 v43, v30 offset:480
  ds_read_b32 v44, v30 offset:640
  ds_read_b32 v45, v30 offset:800
  ds_read_b32 v46, v30 offset:960
  ds_read_b32 v47, v30 offset:1120
  ds_read_b32 v48, v30 offset:1280
  ds_read_b32 v49, v30 offset:1440
  ds_read_b32 v50, v30 offset:1600
  ds_read_b32 v51, v30 offset:1760
  ds_read_b32 v52, v30 offset:1920
  ds_read_b32 v53, v30 offset:2080
  s_waitcnt lgkmcnt(6)
  ds_read_b32 v54, v30 offset:2240
  ds_read_b32 v55, v30 offset:2400
  ds_read_b32 v56, v30 offset:2560
  ds_read_b32 v57, v30 offset:2720
  ds_read_b32 v58, v30 offset:2880
  s_barrier
  ds_read_b32 v59, v30 offset:3840
  ds_read_b32 v60, v30 offset:4000
  s_waitcnt lgkmcnt(6)
  ds_read_b32 v61, v30 offset:4160
  ds_read_b32 v62, v30 offset:4320
  ds_read_b32 v63, v30 offset:4480
  ds_read_b32 v64, v30 offset:4640
  ds_read_b32 v65, v30 offset:4800
  ds_read_b32 v66, v30 offset:4960
  ds_read_b32 v67, v30 offset:5120
  ds_read_b32 v68, v30 offset:5280
  s_waitcnt lgkmcnt(6)
  ds_read_b32 v69, v30 offset:5440
  ds_read_b32 v70, v30 offset:5600
  ds_read_b32 v71, v30 offset:5760
  ds_read_b32 v72, v30 offset:5920
  ds_read_b32 v73, v30 offset:6080
  ds_read_b32 v74, v30 offset:6240
  v_lshlrev_b32 v114, 16, v156
  v_lshlrev_b32 v115, 16, v158
  v_and_b32 v116, s47, v156
  v_and_b32 v117, s47, v158
  v_lshlrev_b32 v118, 16, v157
  v_lshlrev_b32 v119, 16, v159
  v_and_b32 v120, s47, v157
  v_and_b32 v121, s47, v159
  s_waitcnt lgkmcnt(0)
  s_barrier
  v_lshlrev_b32 v76, 16, v40
  v_and_b32 v77, s47, v40
  v_lshlrev_b32 v78, 16, v41
  v_and_b32 v79, s47, v41
  v_lshlrev_b32 v80, 16, v42
  v_and_b32 v81, s47, v42
  v_lshlrev_b32 v82, 16, v43
  v_and_b32 v83, s47, v43
  v_lshlrev_b32 v84, 16, v44
  v_and_b32 v85, s47, v44
  v_lshlrev_b32 v86, 16, v45
  v_and_b32 v87, s47, v45
  v_lshlrev_b32 v88, 16, v46
  v_and_b32 v89, s47, v46
  v_lshlrev_b32 v90, 16, v47
  v_and_b32 v91, s47, v47
  v_lshlrev_b32 v92, 16, v48
  v_and_b32 v93, s47, v48
  v_lshlrev_b32 v94, 16, v49
  v_and_b32 v95, s47, v49
  v_lshlrev_b32 v96, 16, v50
  v_and_b32 v97, s47, v50
  v_lshlrev_b32 v98, 16, v51
  v_and_b32 v99, s47, v51
  v_lshlrev_b32 v100, 16, v52
  v_and_b32 v101, s47, v52
  v_lshlrev_b32 v102, 16, v53
  v_and_b32 v103, s47, v53
  v_lshlrev_b32 v104, 16, v54
  v_and_b32 v105, s47, v54
  v_lshlrev_b32 v106, 16, v55
  v_and_b32 v107, s47, v55
  v_lshlrev_b32 v108, 16, v56
  v_and_b32 v109, s47, v56
  v_lshlrev_b32 v110, 16, v57
  v_and_b32 v111, s47, v57
  v_lshlrev_b32 v112, 16, v58
  v_and_b32 v113, s47, v58
  v_pk_mul_f32 v[122:123], v[120:121], v[76:77]
  v_lshlrev_b32 v32, 16, v59
  v_pk_fma_f32 v[122:123], v[118:119], v[78:79], v[122:123]
  v_and_b32 v33, s47, v59
  v_pk_fma_f32 v[122:123], v[116:117], v[80:81], v[122:123]
  v_pk_fma_f32 v[122:123], v[114:115], v[82:83], v[122:123]
  v_pk_mul_f32 v[122:123], v[122:123], v[32:33]
  v_pk_mul_f32 v[124:125], v[120:121], v[78:79]
  v_lshlrev_b32 v32, 16, v60
  v_pk_fma_f32 v[124:125], v[118:119], v[80:81], v[124:125]
  v_and_b32 v33, s47, v60
  v_pk_fma_f32 v[124:125], v[116:117], v[82:83], v[124:125]
  v_pk_fma_f32 v[124:125], v[114:115], v[84:85], v[124:125]
  v_pk_mul_f32 v[124:125], v[124:125], v[32:33]
  v_pk_mul_f32 v[126:127], v[120:121], v[80:81]
  v_lshlrev_b32 v32, 16, v61
  v_pk_fma_f32 v[126:127], v[118:119], v[82:83], v[126:127]
  v_and_b32 v33, s47, v61
  v_pk_fma_f32 v[126:127], v[116:117], v[84:85], v[126:127]
  v_pk_fma_f32 v[126:127], v[114:115], v[86:87], v[126:127]
  v_pk_mul_f32 v[126:127], v[126:127], v[32:33]
  v_pk_mul_f32 v[128:129], v[120:121], v[82:83]
  v_lshlrev_b32 v32, 16, v62
  v_pk_fma_f32 v[128:129], v[118:119], v[84:85], v[128:129]
  v_and_b32 v33, s47, v62
  v_pk_fma_f32 v[128:129], v[116:117], v[86:87], v[128:129]
  v_pk_fma_f32 v[128:129], v[114:115], v[88:89], v[128:129]
  v_pk_mul_f32 v[128:129], v[128:129], v[32:33]
  v_pk_mul_f32 v[130:131], v[120:121], v[84:85]
  v_lshlrev_b32 v32, 16, v63
  v_pk_fma_f32 v[130:131], v[118:119], v[86:87], v[130:131]
  v_and_b32 v33, s47, v63
  v_pk_fma_f32 v[130:131], v[116:117], v[88:89], v[130:131]
  v_pk_fma_f32 v[130:131], v[114:115], v[90:91], v[130:131]
  v_pk_mul_f32 v[130:131], v[130:131], v[32:33]
  v_pk_mul_f32 v[132:133], v[120:121], v[86:87]
  v_lshlrev_b32 v32, 16, v64
  v_pk_fma_f32 v[132:133], v[118:119], v[88:89], v[132:133]
  v_and_b32 v33, s47, v64
  v_pk_fma_f32 v[132:133], v[116:117], v[90:91], v[132:133]
  v_pk_fma_f32 v[132:133], v[114:115], v[92:93], v[132:133]
  v_pk_mul_f32 v[132:133], v[132:133], v[32:33]
  v_pk_mul_f32 v[134:135], v[120:121], v[88:89]
  v_lshlrev_b32 v32, 16, v65
  v_pk_fma_f32 v[134:135], v[118:119], v[90:91], v[134:135]
  v_and_b32 v33, s47, v65
  v_pk_fma_f32 v[134:135], v[116:117], v[92:93], v[134:135]
  v_pk_fma_f32 v[134:135], v[114:115], v[94:95], v[134:135]
  v_pk_mul_f32 v[134:135], v[134:135], v[32:33]
  v_pk_mul_f32 v[136:137], v[120:121], v[90:91]
  v_lshlrev_b32 v32, 16, v66
  v_pk_fma_f32 v[136:137], v[118:119], v[92:93], v[136:137]
  v_and_b32 v33, s47, v66
  v_pk_fma_f32 v[136:137], v[116:117], v[94:95], v[136:137]
  v_pk_fma_f32 v[136:137], v[114:115], v[96:97], v[136:137]
  v_pk_mul_f32 v[136:137], v[136:137], v[32:33]
  v_pk_mul_f32 v[138:139], v[120:121], v[92:93]
  v_lshlrev_b32 v32, 16, v67
  v_pk_fma_f32 v[138:139], v[118:119], v[94:95], v[138:139]
  v_and_b32 v33, s47, v67
  v_pk_fma_f32 v[138:139], v[116:117], v[96:97], v[138:139]
  v_pk_fma_f32 v[138:139], v[114:115], v[98:99], v[138:139]
  v_pk_mul_f32 v[138:139], v[138:139], v[32:33]
  v_pk_mul_f32 v[140:141], v[120:121], v[94:95]
  v_lshlrev_b32 v32, 16, v68
  v_pk_fma_f32 v[140:141], v[118:119], v[96:97], v[140:141]
  v_and_b32 v33, s47, v68
  v_pk_fma_f32 v[140:141], v[116:117], v[98:99], v[140:141]
  v_pk_fma_f32 v[140:141], v[114:115], v[100:101], v[140:141]
  v_pk_mul_f32 v[140:141], v[140:141], v[32:33]
  v_pk_mul_f32 v[142:143], v[120:121], v[96:97]
  v_lshlrev_b32 v32, 16, v69
  v_pk_fma_f32 v[142:143], v[118:119], v[98:99], v[142:143]
  v_and_b32 v33, s47, v69
  v_pk_fma_f32 v[142:143], v[116:117], v[100:101], v[142:143]
  v_pk_fma_f32 v[142:143], v[114:115], v[102:103], v[142:143]
  v_pk_mul_f32 v[142:143], v[142:143], v[32:33]
  v_pk_mul_f32 v[144:145], v[120:121], v[98:99]
  v_lshlrev_b32 v32, 16, v70
  v_pk_fma_f32 v[144:145], v[118:119], v[100:101], v[144:145]
  v_and_b32 v33, s47, v70
  v_pk_fma_f32 v[144:145], v[116:117], v[102:103], v[144:145]
  v_pk_fma_f32 v[144:145], v[114:115], v[104:105], v[144:145]
  v_pk_mul_f32 v[144:145], v[144:145], v[32:33]
  v_pk_mul_f32 v[146:147], v[120:121], v[100:101]
  v_lshlrev_b32 v32, 16, v71
  v_pk_fma_f32 v[146:147], v[118:119], v[102:103], v[146:147]
  v_and_b32 v33, s47, v71
  v_pk_fma_f32 v[146:147], v[116:117], v[104:105], v[146:147]
  v_pk_fma_f32 v[146:147], v[114:115], v[106:107], v[146:147]
  v_pk_mul_f32 v[146:147], v[146:147], v[32:33]
  v_pk_mul_f32 v[148:149], v[120:121], v[102:103]
  v_lshlrev_b32 v32, 16, v72
  v_pk_fma_f32 v[148:149], v[118:119], v[104:105], v[148:149]
  v_and_b32 v33, s47, v72
  v_pk_fma_f32 v[148:149], v[116:117], v[106:107], v[148:149]
  v_pk_fma_f32 v[148:149], v[114:115], v[108:109], v[148:149]
  v_pk_mul_f32 v[148:149], v[148:149], v[32:33]
  v_pk_mul_f32 v[150:151], v[120:121], v[104:105]
  v_lshlrev_b32 v32, 16, v73
  v_pk_fma_f32 v[150:151], v[118:119], v[106:107], v[150:151]
  v_and_b32 v33, s47, v73
  v_pk_fma_f32 v[150:151], v[116:117], v[108:109], v[150:151]
  v_pk_fma_f32 v[150:151], v[114:115], v[110:111], v[150:151]
  v_pk_mul_f32 v[150:151], v[150:151], v[32:33]
  v_pk_mul_f32 v[152:153], v[120:121], v[106:107]
  v_lshlrev_b32 v32, 16, v74
  v_pk_fma_f32 v[152:153], v[118:119], v[108:109], v[152:153]
  v_and_b32 v33, s47, v74
  v_pk_fma_f32 v[152:153], v[116:117], v[110:111], v[152:153]
  v_pk_fma_f32 v[152:153], v[114:115], v[112:113], v[152:153]
  v_pk_mul_f32 v[152:153], v[152:153], v[32:33]
  v_cvt_pk_bf16_f32 v40, v136, v134
  v_cvt_pk_bf16_f32 v41, v132, v130
  v_cvt_pk_bf16_f32 v42, v128, v126
  v_cvt_pk_bf16_f32 v43, v124, v122
  v_cvt_pk_bf16_f32 v44, v152, v150
  v_cvt_pk_bf16_f32 v45, v148, v146
  v_cvt_pk_bf16_f32 v46, v144, v142
  v_cvt_pk_bf16_f32 v47, v140, v138
  v_cvt_pk_bf16_f32 v48, v137, v135
  v_cvt_pk_bf16_f32 v49, v133, v131
  v_cvt_pk_bf16_f32 v50, v129, v127
  v_cvt_pk_bf16_f32 v51, v125, v123
  v_cvt_pk_bf16_f32 v52, v153, v151
  v_cvt_pk_bf16_f32 v53, v149, v147
  v_cvt_pk_bf16_f32 v54, v145, v143
  v_cvt_pk_bf16_f32 v55, v141, v139
  v_mul_u32_u24 v30, 288, v1
  s_lshl_b32 s40, s55, 5
  s_add_u32 s40, s40, 49152
  v_add_u32 v30, s40, v30
  s_mov_b32 exec_lo, 0xffffffff
  s_mov_b32 exec_hi, 0xff
  ds_write_b128 v30, v[40:43] offset:0
  ds_write_b128 v30, v[44:47] offset:16
  ds_write_b128 v30, v[48:51] offset:144
  ds_write_b128 v30, v[52:55] offset:160
  s_mov_b64 exec, s[52:53]
  s_load_dwordx2 s[56:57], s[0:1], 64
  s_load_dwordx2 s[60:61], s[0:1], 104
  s_lshl_b32 s40, s32, 6
  s_lshl_b32 s41, s55, 4
  s_add_u32 s40, s40, s41
  v_add_u32 v10, 0, v2
  v_xor_b32 v11, v10, v3
  v_lshlrev_b32 v11, 4, v11
  v_add_u32 v10, s40, v10
  v_lshlrev_b32 v10, 12, v10
  v_add_u32 v4, v10, v11
  v_add_u32 v10, 4, v2
  v_xor_b32 v11, v10, v3
  v_lshlrev_b32 v11, 4, v11
  v_add_u32 v10, s40, v10
  v_lshlrev_b32 v10, 12, v10
  v_add_u32 v5, v10, v11
  v_add_u32 v10, 8, v2
  v_xor_b32 v11, v10, v3
  v_lshlrev_b32 v11, 4, v11
  v_add_u32 v10, s40, v10
  v_lshlrev_b32 v10, 12, v10
  v_add_u32 v6, v10, v11
  v_add_u32 v10, 12, v2
  v_xor_b32 v11, v10, v3
  v_lshlrev_b32 v11, 4, v11
  v_add_u32 v10, s40, v10
  v_lshlrev_b32 v10, 12, v10
  v_add_u32 v7, v10, v11
  s_lshl_b32 s39, s55, 12
  s_waitcnt lgkmcnt(0)
  s_mov_b32 s8, s56
  s_and_b32 s9, s57, 0xffff
  s_mov_b32 s10, 8388608
  s_mov_b32 s11, 0x20000
  s_mov_b32 s16, s60
  s_and_b32 s17, s61, 0xffff
  s_mov_b32 s18, 18874368
  s_mov_b32 s19, 0x20000
  s_waitcnt lgkmcnt(0)
  s_barrier
  s_sleep 5
  s_movk_i32 s38, 0
  s_add_u32 m0, s39, 0
  s_nop 0
  buffer_load_dwordx4 v4, s[8:11], s38 offen  lds
  s_add_u32 m0, s39, 1024
  s_nop 0
  buffer_load_dwordx4 v5, s[8:11], s38 offen  lds
  s_add_u32 m0, s39, 2048
  s_nop 0
  buffer_load_dwordx4 v6, s[8:11], s38 offen  lds
  s_add_u32 m0, s39, 3072
  s_nop 0
  buffer_load_dwordx4 v7, s[8:11], s38 offen  lds
  s_movk_i32 s38, 256
  s_add_u32 m0, s39, 16384
  s_nop 0
  buffer_load_dwordx4 v4, s[8:11], s38 offen  lds
  s_add_u32 m0, s39, 17408
  s_nop 0
  buffer_load_dwordx4 v5, s[8:11], s38 offen  lds
  s_add_u32 m0, s39, 18432
  s_nop 0
  buffer_load_dwordx4 v6, s[8:11], s38 offen  lds
  s_add_u32 m0, s39, 19456
  s_nop 0
  buffer_load_dwordx4 v7, s[8:11], s38 offen  lds
  s_movk_i32 s38, 512
  s_add_u32 m0, s39, 32768
  s_nop 0
  buffer_load_dwordx4 v4, s[8:11], s38 offen  lds
  s_add_u32 m0, s39, 33792
  s_nop 0
  buffer_load_dwordx4 v5, s[8:11], s38 offen  lds
  s_add_u32 m0, s39, 34816
  s_nop 0
  buffer_load_dwordx4 v6, s[8:11], s38 offen  lds
  s_add_u32 m0, s39, 35840
  s_nop 0
  buffer_load_dwordx4 v7, s[8:11], s38 offen  lds
  s_waitcnt vmcnt(8)
  s_barrier
  s_waitcnt vmcnt(4)
  s_barrier
  s_movk_i32 s38, 768
  s_add_u32 m0, s39, 49152
  s_nop 0
  buffer_load_dwordx4 v4, s[8:11], s38 offen  lds
  s_add_u32 m0, s39, 50176
  s_nop 0
  buffer_load_dwordx4 v5, s[8:11], s38 offen  lds
  s_add_u32 m0, s39, 51200
  s_nop 0
  buffer_load_dwordx4 v6, s[8:11], s38 offen  lds
  s_add_u32 m0, s39, 52224
  s_nop 0
  buffer_load_dwordx4 v7, s[8:11], s38 offen  lds
  s_waitcnt vmcnt(4)
  s_barrier
  s_movk_i32 s38, 1024
  s_add_u32 m0, s39, 0
  s_nop 0
  buffer_load_dwordx4 v4, s[8:11], s38 offen  lds
  s_add_u32 m0, s39, 1024
  s_nop 0
  buffer_load_dwordx4 v5, s[8:11], s38 offen  lds
  s_add_u32 m0, s39, 2048
  s_nop 0
  buffer_load_dwordx4 v6, s[8:11], s38 offen  lds
  s_add_u32 m0, s39, 3072
  s_nop 0
  buffer_load_dwordx4 v7, s[8:11], s38 offen  lds
  s_waitcnt vmcnt(4)
  s_barrier
  s_movk_i32 s38, 1280
  s_add_u32 m0, s39, 16384
  s_nop 0
  buffer_load_dwordx4 v4, s[8:11], s38 offen  lds
  s_add_u32 m0, s39, 17408
  s_nop 0
  buffer_load_dwordx4 v5, s[8:11], s38 offen  lds
  s_add_u32 m0, s39, 18432
  s_nop 0
  buffer_load_dwordx4 v6, s[8:11], s38 offen  lds
  s_add_u32 m0, s39, 19456
  s_nop 0
  buffer_load_dwordx4 v7, s[8:11], s38 offen  lds
  s_waitcnt vmcnt(4)
  s_barrier
  s_movk_i32 s38, 1536
  s_add_u32 m0, s39, 32768
  s_nop 0
  buffer_load_dwordx4 v4, s[8:11], s38 offen  lds
  s_add_u32 m0, s39, 33792
  s_nop 0
  buffer_load_dwordx4 v5, s[8:11], s38 offen  lds
  s_add_u32 m0, s39, 34816
  s_nop 0
  buffer_load_dwordx4 v6, s[8:11], s38 offen  lds
  s_add_u32 m0, s39, 35840
  s_nop 0
  buffer_load_dwordx4 v7, s[8:11], s38 offen  lds
  s_waitcnt vmcnt(4)
  s_barrier
  s_movk_i32 s38, 1792
  s_add_u32 m0, s39, 49152
  s_nop 0
  buffer_load_dwordx4 v4, s[8:11], s38 offen  lds
  s_add_u32 m0, s39, 50176
  s_nop 0
  buffer_load_dwordx4 v5, s[8:11], s38 offen  lds
  s_add_u32 m0, s39, 51200
  s_nop 0
  buffer_load_dwordx4 v6, s[8:11], s38 offen  lds
  s_add_u32 m0, s39, 52224
  s_nop 0
  buffer_load_dwordx4 v7, s[8:11], s38 offen  lds
  s_waitcnt vmcnt(4)
  s_barrier
  s_movk_i32 s38, 2048
  s_add_u32 m0, s39, 0
  s_nop 0
  buffer_load_dwordx4 v4, s[8:11], s38 offen  lds
  s_add_u32 m0, s39, 1024
  s_nop 0
  buffer_load_dwordx4 v5, s[8:11], s38 offen  lds
  s_add_u32 m0, s39, 2048
  s_nop 0
  buffer_load_dwordx4 v6, s[8:11], s38 offen  lds
  s_add_u32 m0, s39, 3072
  s_nop 0
  buffer_load_dwordx4 v7, s[8:11], s38 offen  lds
  s_waitcnt vmcnt(4)
  s_barrier
  s_movk_i32 s38, 2304
  s_add_u32 m0, s39, 16384
  s_nop 0
  buffer_load_dwordx4 v4, s[8:11], s38 offen  lds
  s_add_u32 m0, s39, 17408
  s_nop 0
  buffer_load_dwordx4 v5, s[8:11], s38 offen  lds
  s_add_u32 m0, s39, 18432
  s_nop 0
  buffer_load_dwordx4 v6, s[8:11], s38 offen  lds
  s_add_u32 m0, s39, 19456
  s_nop 0
  buffer_load_dwordx4 v7, s[8:11], s38 offen  lds
  s_waitcnt vmcnt(4)
  s_barrier
  s_movk_i32 s38, 2560
  s_add_u32 m0, s39, 32768
  s_nop 0
  buffer_load_dwordx4 v4, s[8:11], s38 offen  lds
  s_add_u32 m0, s39, 33792
  s_nop 0
  buffer_load_dwordx4 v5, s[8:11], s38 offen  lds
  s_add_u32 m0, s39, 34816
  s_nop 0
  buffer_load_dwordx4 v6, s[8:11], s38 offen  lds
  s_add_u32 m0, s39, 35840
  s_nop 0
  buffer_load_dwordx4 v7, s[8:11], s38 offen  lds
  s_waitcnt vmcnt(4)
  s_barrier
  s_movk_i32 s38, 2816
  s_add_u32 m0, s39, 49152
  s_nop 0
  buffer_load_dwordx4 v4, s[8:11], s38 offen  lds
  s_add_u32 m0, s39, 50176
  s_nop 0
  buffer_load_dwordx4 v5, s[8:11], s38 offen  lds
  s_add_u32 m0, s39, 51200
  s_nop 0
  buffer_load_dwordx4 v6, s[8:11], s38 offen  lds
  s_add_u32 m0, s39, 52224
  s_nop 0
  buffer_load_dwordx4 v7, s[8:11], s38 offen  lds
  s_waitcnt vmcnt(4)
  s_barrier
  s_movk_i32 s38, 3072
  s_add_u32 m0, s39, 0
  s_nop 0
  buffer_load_dwordx4 v4, s[8:11], s38 offen  lds
  s_add_u32 m0, s39, 1024
  s_nop 0
  buffer_load_dwordx4 v5, s[8:11], s38 offen  lds
  s_add_u32 m0, s39, 2048
  s_nop 0
  buffer_load_dwordx4 v6, s[8:11], s38 offen  lds
  s_add_u32 m0, s39, 3072
  s_nop 0
  buffer_load_dwordx4 v7, s[8:11], s38 offen  lds
  s_waitcnt vmcnt(4)
  s_barrier
  s_movk_i32 s38, 3328
  s_add_u32 m0, s39, 16384
  s_nop 0
  buffer_load_dwordx4 v4, s[8:11], s38 offen  lds
  s_add_u32 m0, s39, 17408
  s_nop 0
  buffer_load_dwordx4 v5, s[8:11], s38 offen  lds
  s_add_u32 m0, s39, 18432
  s_nop 0
  buffer_load_dwordx4 v6, s[8:11], s38 offen  lds
  s_add_u32 m0, s39, 19456
  s_nop 0
  buffer_load_dwordx4 v7, s[8:11], s38 offen  lds
  s_waitcnt vmcnt(4)
  s_barrier
  s_movk_i32 s38, 3584
  s_add_u32 m0, s39, 32768
  s_nop 0
  buffer_load_dwordx4 v4, s[8:11], s38 offen  lds
  s_add_u32 m0, s39, 33792
  s_nop 0
  buffer_load_dwordx4 v5, s[8:11], s38 offen  lds
  s_add_u32 m0, s39, 34816
  s_nop 0
  buffer_load_dwordx4 v6, s[8:11], s38 offen  lds
  s_add_u32 m0, s39, 35840
  s_nop 0
  buffer_load_dwordx4 v7, s[8:11], s38 offen  lds
  s_waitcnt vmcnt(4)
  s_barrier
  s_movk_i32 s38, 3840
  s_add_u32 m0, s39, 49152
  s_nop 0
  buffer_load_dwordx4 v4, s[8:11], s38 offen  lds
  s_add_u32 m0, s39, 50176
  s_nop 0
  buffer_load_dwordx4 v5, s[8:11], s38 offen  lds
  s_add_u32 m0, s39, 51200
  s_nop 0
  buffer_load_dwordx4 v6, s[8:11], s38 offen  lds
  s_add_u32 m0, s39, 52224
  s_nop 0
  buffer_load_dwordx4 v7, s[8:11], s38 offen  lds
  s_waitcnt vmcnt(4)
  s_barrier
  s_waitcnt vmcnt(0)
  s_barrier
  s_barrier
  s_barrier
  s_barrier
  s_barrier
  v_lshlrev_b32 v4, 4, v1
  s_mul_i32 s35, s33, 122880
  s_lshl_b32 s40, s55, 10
  s_add_u32 s35, s35, s40
  s_add_u32 s35, s35, 15728640
  s_mul_i32 s36, s55, 5120
  s_sleep 4
  s_add_u32 m0, s36, 0
  s_add_u32 s40, s35, 0
  buffer_load_dwordx4 v4, s[16:19], s40 offen sc1 lds
  s_add_u32 m0, s36, 1024
  s_add_u32 s40, s35, 24576
  buffer_load_dwordx4 v4, s[16:19], s40 offen sc1 lds
  s_add_u32 m0, s36, 2048
  s_add_u32 s40, s35, 49152
  buffer_load_dwordx4 v4, s[16:19], s40 offen sc1 lds
  s_add_u32 m0, s36, 3072
  s_add_u32 s40, s35, 73728
  buffer_load_dwordx4 v4, s[16:19], s40 offen sc1 lds
  s_add_u32 m0, s36, 4096
  s_add_u32 s40, s35, 98304
  buffer_load_dwordx4 v4, s[16:19], s40 offen sc1 lds
  s_add_u32 m0, s36, 61440
  s_add_u32 s40, s35, 12288
  buffer_load_dwordx4 v4, s[16:19], s40 offen sc1 lds
  s_add_u32 m0, s36, 62464
  s_add_u32 s40, s35, 36864
  buffer_load_dwordx4 v4, s[16:19], s40 offen sc1 lds
  s_add_u32 m0, s36, 63488
  s_add_u32 s40, s35, 61440
  buffer_load_dwordx4 v4, s[16:19], s40 offen sc1 lds
  s_add_u32 m0, s36, 64512
  s_add_u32 s40, s35, 86016
  buffer_load_dwordx4 v4, s[16:19], s40 offen sc1 lds
  s_add_u32 m0, s36, 65536
  s_add_u32 s40, s35, 110592
  buffer_load_dwordx4 v4, s[16:19], s40 offen sc1 lds
  s_add_u32 m0, s36, 20480
  s_add_u32 s40, s35, 4096
  buffer_load_dwordx4 v4, s[16:19], s40 offen sc1 lds
  s_add_u32 m0, s36, 21504
  s_add_u32 s40, s35, 28672
  buffer_load_dwordx4 v4, s[16:19], s40 offen sc1 lds
  s_add_u32 m0, s36, 22528
  s_add_u32 s40, s35, 53248
  buffer_load_dwordx4 v4, s[16:19], s40 offen sc1 lds
  s_add_u32 m0, s36, 23552
  s_add_u32 s40, s35, 77824
  buffer_load_dwordx4 v4, s[16:19], s40 offen sc1 lds
  s_add_u32 m0, s36, 24576
  s_add_u32 s40, s35, 102400
  buffer_load_dwordx4 v4, s[16:19], s40 offen sc1 lds
  s_add_u32 m0, s36, 81920
  s_add_u32 s40, s35, 16384
  buffer_load_dwordx4 v4, s[16:19], s40 offen sc1 lds
  s_add_u32 m0, s36, 82944
  s_add_u32 s40, s35, 40960
  buffer_load_dwordx4 v4, s[16:19], s40 offen sc1 lds
  s_add_u32 m0, s36, 83968
  s_add_u32 s40, s35, 65536
  buffer_load_dwordx4 v4, s[16:19], s40 offen sc1 lds
  s_add_u32 m0, s36, 84992
  s_add_u32 s40, s35, 90112
  buffer_load_dwordx4 v4, s[16:19], s40 offen sc1 lds
  s_add_u32 m0, s36, 86016
  s_add_u32 s40, s35, 114688
  buffer_load_dwordx4 v4, s[16:19], s40 offen sc1 lds
  s_add_u32 m0, s36, 40960
  s_add_u32 s40, s35, 8192
  buffer_load_dwordx4 v4, s[16:19], s40 offen sc1 lds
  s_add_u32 m0, s36, 41984
  s_add_u32 s40, s35, 32768
  buffer_load_dwordx4 v4, s[16:19], s40 offen sc1 lds
  s_add_u32 m0, s36, 43008
  s_add_u32 s40, s35, 57344
  buffer_load_dwordx4 v4, s[16:19], s40 offen sc1 lds
  s_add_u32 m0, s36, 44032
  s_add_u32 s40, s35, 81920
  buffer_load_dwordx4 v4, s[16:19], s40 offen sc1 lds
  s_add_u32 m0, s36, 45056
  s_add_u32 s40, s35, 106496
  buffer_load_dwordx4 v4, s[16:19], s40 offen sc1 lds
  s_add_u32 m0, s36, 102400
  s_add_u32 s40, s35, 20480
  buffer_load_dwordx4 v4, s[16:19], s40 offen sc1 lds
  s_add_u32 m0, s36, 103424
  s_add_u32 s40, s35, 45056
  buffer_load_dwordx4 v4, s[16:19], s40 offen sc1 lds
  s_add_u32 m0, s36, 104448
  s_add_u32 s40, s35, 69632
  buffer_load_dwordx4 v4, s[16:19], s40 offen sc1 lds
  s_add_u32 m0, s36, 105472
  s_add_u32 s40, s35, 94208
  buffer_load_dwordx4 v4, s[16:19], s40 offen sc1 lds
  s_add_u32 m0, s36, 106496
  s_add_u32 s40, s35, 118784
  buffer_load_dwordx4 v4, s[16:19], s40 offen sc1 lds
  s_barrier
  s_waitcnt vmcnt(20)
  s_barrier
  s_cmp_eq_u32 s34, 8
  s_cbranch_scc0 F3_NOYP
  s_load_dwordx2 s[72:73], s[0:1], 104
  s_lshl_b32 s75, s33, 7
  s_add_u32 s75, s75, 17040384
  s_waitcnt lgkmcnt(0)
  s_add_u32 s74, s75, 0
  s_mov_b32 s42, 0
SP_F2Aa:
  s_load_dwordx16 s[56:71], s[72:73], s74 glc
  s_waitcnt lgkmcnt(0)
  s_and_b64 s[56:57], s[56:57], s[64:65]
  s_and_b64 s[58:59], s[58:59], s[66:67]
  s_and_b64 s[60:61], s[60:61], s[68:69]
  s_and_b64 s[62:63], s[62:63], s[70:71]
  s_and_b64 s[56:57], s[56:57], s[60:61]
  s_and_b64 s[58:59], s[58:59], s[62:63]
  s_and_b64 s[56:57], s[56:57], s[58:59]
  s_and_b32 s56, s56, s57
  s_add_u32 s42, s42, 1
  s_cmp_eq_u32 s56, 1
  s_cbranch_scc1 SP_F2Aa_OK
  s_cmp_lt_u32 s42, 2097152
  s_cbranch_scc1 SP_F2Aa
SP_F2Aa_OK:
  s_add_u32 s74, s75, 64
  s_mov_b32 s42, 0
SP_F2Ab:
  s_load_dwordx16 s[56:71], s[72:73], s74 glc
  s_waitcnt lgkmcnt(0)
  s_and_b64 s[56:57], s[56:57], s[64:65]
  s_and_b64 s[58:59], s[58:59], s[66:67]
  s_and_b64 s[60:61], s[60:61], s[68:69]
  s_and_b64 s[62:63], s[62:63], s[70:71]
  s_and_b64 s[56:57], s[56:57], s[60:61]
  s_and_b64 s[58:59], s[58:59], s[62:63]
  s_and_b64 s[56:57], s[56:57], s[58:59]
  s_and_b32 s56, s56, s57
  s_add_u32 s42, s42, 1
  s_cmp_eq_u32 s56, 1
  s_cbranch_scc1 SP_F2Ab_OK
  s_cmp_lt_u32 s42, 2097152
  s_cbranch_scc1 SP_F2Ab
SP_F2Ab_OK:
F3_NOYP:
  s_waitcnt vmcnt(10)
  s_barrier
  s_waitcnt vmcnt(0)
  s_barrier
  s_barrier
  s_barrier
  s_endpgm
K1_AB:
  v_lshrrev_b32 v17, 1, v3
  v_xor_b32 v17, v17, v2
  v_lshlrev_b32 v17, 4, v17
  v_lshlrev_b32 v18, 7, v3
  v_add_u32 v17, v17, v18
  v_xor_b32 v18, 64, v17
  s_lshl_b32 s40, s35, 12
  s_lshl_b32 s41, s36, 11
  s_add_u32 s42, s40, s41
  s_add_u32 s42, s42, 61440
  v_add_u32 v4, s42, v17
  v_add_u32 v5, s42, v18
  s_xor_b32 s41, s41, 2048
  s_add_u32 s42, s40, s41
  s_add_u32 s42, s42, 61440
  v_add_u32 v6, s42, v17
  v_add_u32 v7, s42, v18
  v_lshrrev_b32 v17, 2, v1
  v_and_b32 v17, 3, v17
  v_lshlrev_b32 v18, 3, v2
  v_add_u32 v17, v17, v18
  v_mul_u32_u24 v17, 192, v17
  v_and_b32 v18, 3, v1
  v_lshlrev_b32 v18, 3, v18
  v_add_u32 v17, v17, v18
  v_and_b32 v19, 1, v2
  s_mul_i32 s40, s36, 3
  s_add_u32 s41, s40, 0
  v_xor_b32 v18, s41, v19
  v_lshlrev_b32 v18, 5, v18
  v_add_u32 v8, v17, v18
  s_add_u32 s41, s40, 1
  v_xor_b32 v18, s41, v19
  v_lshlrev_b32 v18, 5, v18
  v_add_u32 v9, v17, v18
  s_add_u32 s41, s40, 2
  v_xor_b32 v18, s41, v19
  v_lshlrev_b32 v18, 5, v18
  v_add_u32 v10, v17, v18
  s_mov_b32 s48, 0xbdd2d3e8
  s_mov_b32 s49, 0xbdd2d3e8
  s_mov_b32 s50, 1.0
  s_mov_b32 s51, 1.0
  s_waitcnt lgkmcnt(0)
  s_mov_b32 s16, s70
  s_and_b32 s17, s71, 0xffff
  s_mov_b32 s18, 18874368
  s_mov_b32 s19, 0x20000
  s_mov_b32 s4, s68
  s_and_b32 s5, s69, 0xffff
  s_mov_b32 s6, 256
  s_mov_b32 s7, 0x20000
  s_cmp_ge_u32 s34, 4
  s_cbranch_scc1 K1_B
  v_mov_b32 v102, 0x3f803f80
  v_mov_b32 v103, 0x3f803f80
  v_mov_b32 v104, 0x3f803f80
  v_mov_b32 v105, 0x3f803f80
  v_mov_b32 v66, 0
  v_mov_b32 v67, 0
  v_mov_b32 v68, 0
  v_mov_b32 v69, 0
  v_mov_b32 v70, 0
  v_mov_b32 v71, 0
  v_mov_b32 v72, 0
  v_mov_b32 v73, 0
  v_mov_b32 v74, 0
  v_mov_b32 v75, 0
  v_mov_b32 v76, 0
  v_mov_b32 v77, 0
  v_mov_b32 v78, 0
  v_mov_b32 v79, 0
  v_mov_b32 v80, 0
  v_mov_b32 v81, 0
  v_mov_b32 v82, 0
  v_mov_b32 v83, 0
  v_mov_b32 v84, 0
  v_mov_b32 v85, 0
  v_mov_b32 v86, 0
  v_mov_b32 v87, 0
  v_mov_b32 v88, 0
  v_mov_b32 v89, 0
  v_mov_b32 v90, 0
  v_mov_b32 v91, 0
  v_mov_b32 v92, 0
  v_mov_b32 v93, 0
  v_mov_b32 v94, 0
  v_mov_b32 v95, 0
  v_mov_b32 v96, 0
  v_mov_b32 v97, 0
  v_mov_b32 v98, 0
  v_mov_b32 v99, 0
  v_mov_b32 v100, 0
  v_mov_b32 v101, 0
  v_mov_b32 v106, 0
  v_mov_b32 v107, 0
  v_mov_b32 v108, 0
  v_mov_b32 v109, 0
  v_mov_b32 v110, 0
  v_mov_b32 v111, 0
  v_mov_b32 v112, 0
  v_mov_b32 v113, 0
  s_barrier
  s_mov_b32 s37, 0
  ds_read_b128 v[26:29], v4 offset:0
  ds_read_b64_tr_b16 v[42:43], v8 offset:0
  ds_read_b64_tr_b16 v[44:45], v8 offset:768
  ds_read_b128 v[30:33], v6 offset:0
  ds_read_b64_tr_b16 v[46:47], v9 offset:0
  ds_read_b64_tr_b16 v[48:49], v9 offset:768
  ds_read_b64_tr_b16 v[50:51], v10 offset:0
  ds_read_b64_tr_b16 v[52:53], v10 offset:768
K1_LOOP1:
  s_waitcnt lgkmcnt(0)
  v_mfma_f32_16x16x32_bf16 v[66:69], v[26:29], v[42:45], v[66:69]
  ds_read_b128 v[34:37], v5 offset:0
  ds_read_b64_tr_b16 v[54:55], v8 offset:6144
  v_mfma_f32_16x16x32_bf16 v[78:81], v[30:33], v[42:45], v[78:81]
  ds_read_b64_tr_b16 v[56:57], v8 offset:6912
  ds_read_b128 v[38:41], v7 offset:0
  v_mfma_f32_16x16x32_bf16 v[70:73], v[26:29], v[46:49], v[70:73]
  ds_read_b64_tr_b16 v[58:59], v9 offset:6144
  ds_read_b64_tr_b16 v[60:61], v9 offset:6912
  v_mfma_f32_16x16x32_bf16 v[82:85], v[30:33], v[46:49], v[82:85]
  ds_read_b64_tr_b16 v[62:63], v10 offset:6144
  ds_read_b64_tr_b16 v[64:65], v10 offset:6912
  v_mfma_f32_16x16x32_bf16 v[74:77], v[26:29], v[50:53], v[74:77]
  v_mfma_f32_16x16x32_bf16 v[86:89], v[30:33], v[50:53], v[86:89]
  v_mfma_f32_16x16x32_bf16 v[106:109], v[102:105], v[26:29], v[106:109]
  v_mfma_f32_16x16x32_bf16 v[110:113], v[26:29], v[26:29], v[110:113]
  s_cmp_eq_u32 s35, 0
  s_cbranch_scc0 K1_SK_1a0
  v_mfma_f32_16x16x32_bf16 v[90:93], v[102:105], v[42:45], v[90:93]
  v_mfma_f32_16x16x32_bf16 v[94:97], v[102:105], v[46:49], v[94:97]
  v_mfma_f32_16x16x32_bf16 v[98:101], v[102:105], v[50:53], v[98:101]
K1_SK_1a0:
  s_waitcnt lgkmcnt(0)
  s_barrier
  v_mfma_f32_16x16x32_bf16 v[66:69], v[34:37], v[54:57], v[66:69]
  ds_read_b128 v[26:29], v4 offset:8192
  ds_read_b64_tr_b16 v[42:43], v8 offset:12288
  v_mfma_f32_16x16x32_bf16 v[78:81], v[38:41], v[54:57], v[78:81]
  ds_read_b64_tr_b16 v[44:45], v8 offset:13056
  ds_read_b128 v[30:33], v6 offset:8192
  v_mfma_f32_16x16x32_bf16 v[70:73], v[34:37], v[58:61], v[70:73]
  ds_read_b64_tr_b16 v[46:47], v9 offset:12288
  ds_read_b64_tr_b16 v[48:49], v9 offset:13056
  v_mfma_f32_16x16x32_bf16 v[82:85], v[38:41], v[58:61], v[82:85]
  ds_read_b64_tr_b16 v[50:51], v10 offset:12288
  ds_read_b64_tr_b16 v[52:53], v10 offset:13056
  v_mfma_f32_16x16x32_bf16 v[74:77], v[34:37], v[62:65], v[74:77]
  v_mfma_f32_16x16x32_bf16 v[86:89], v[38:41], v[62:65], v[86:89]
  v_mfma_f32_16x16x32_bf16 v[106:109], v[102:105], v[34:37], v[106:109]
  v_mfma_f32_16x16x32_bf16 v[110:113], v[34:37], v[34:37], v[110:113]
  s_cmp_eq_u32 s35, 1
  s_cbranch_scc0 K1_SK_1b0
  v_mfma_f32_16x16x32_bf16 v[90:93], v[102:105], v[54:57], v[90:93]
  v_mfma_f32_16x16x32_bf16 v[94:97], v[102:105], v[58:61], v[94:97]
  v_mfma_f32_16x16x32_bf16 v[98:101], v[102:105], v[62:65], v[98:101]
K1_SK_1b0:
  s_waitcnt lgkmcnt(0)
  v_mfma_f32_16x16x32_bf16 v[66:69], v[26:29], v[42:45], v[66:69]
  ds_read_b128 v[34:37], v5 offset:8192
  ds_read_b64_tr_b16 v[54:55], v8 offset:18432
  v_mfma_f32_16x16x32_bf16 v[78:81], v[30:33], v[42:45], v[78:81]
  ds_read_b64_tr_b16 v[56:57], v8 offset:19200
  ds_read_b128 v[38:41], v7 offset:8192
  v_mfma_f32_16x16x32_bf16 v[70:73], v[26:29], v[46:49], v[70:73]
  ds_read_b64_tr_b16 v[58:59], v9 offset:18432
  ds_read_b64_tr_b16 v[60:61], v9 offset:19200
  v_mfma_f32_16x16x32_bf16 v[82:85], v[30:33], v[46:49], v[82:85]
  ds_read_b64_tr_b16 v[62:63], v10 offset:18432
  ds_read_b64_tr_b16 v[64:65], v10 offset:19200
  v_mfma_f32_16x16x32_bf16 v[74:77], v[26:29], v[50:53], v[74:77]
  v_mfma_f32_16x16x32_bf16 v[86:89], v[30:33], v[50:53], v[86:89]
  v_mfma_f32_16x16x32_bf16 v[106:109], v[102:105], v[26:29], v[106:109]
  v_mfma_f32_16x16x32_bf16 v[110:113], v[26:29], v[26:29], v[110:113]
  s_cmp_eq_u32 s35, 0
  s_cbranch_scc0 K1_SK_1a1
  v_mfma_f32_16x16x32_bf16 v[90:93], v[102:105], v[42:45], v[90:93]
  v_mfma_f32_16x16x32_bf16 v[94:97], v[102:105], v[46:49], v[94:97]
  v_mfma_f32_16x16x32_bf16 v[98:101], v[102:105], v[50:53], v[98:101]
K1_SK_1a1:
  s_waitcnt lgkmcnt(0)
  s_barrier
  v_mfma_f32_16x16x32_bf16 v[66:69], v[34:37], v[54:57], v[66:69]
  ds_read_b128 v[26:29], v4 offset:16384
  ds_read_b64_tr_b16 v[42:43], v8 offset:24576
  v_mfma_f32_16x16x32_bf16 v[78:81], v[38:41], v[54:57], v[78:81]
  ds_read_b64_tr_b16 v[44:45], v8 offset:25344
  ds_read_b128 v[30:33], v6 offset:16384
  v_mfma_f32_16x16x32_bf16 v[70:73], v[34:37], v[58:61], v[70:73]
  ds_read_b64_tr_b16 v[46:47], v9 offset:24576
  ds_read_b64_tr_b16 v[48:49], v9 offset:25344
  v_mfma_f32_16x16x32_bf16 v[82:85], v[38:41], v[58:61], v[82:85]
  ds_read_b64_tr_b16 v[50:51], v10 offset:24576
  ds_read_b64_tr_b16 v[52:53], v10 offset:25344
  v_mfma_f32_16x16x32_bf16 v[74:77], v[34:37], v[62:65], v[74:77]
  v_mfma_f32_16x16x32_bf16 v[86:89], v[38:41], v[62:65], v[86:89]
  v_mfma_f32_16x16x32_bf16 v[106:109], v[102:105], v[34:37], v[106:109]
  v_mfma_f32_16x16x32_bf16 v[110:113], v[34:37], v[34:37], v[110:113]
  s_cmp_eq_u32 s35, 1
  s_cbranch_scc0 K1_SK_1b1
  v_mfma_f32_16x16x32_bf16 v[90:93], v[102:105], v[54:57], v[90:93]
  v_mfma_f32_16x16x32_bf16 v[94:97], v[102:105], v[58:61], v[94:97]
  v_mfma_f32_16x16x32_bf16 v[98:101], v[102:105], v[62:65], v[98:101]
K1_SK_1b1:
  s_waitcnt lgkmcnt(0)
  v_mfma_f32_16x16x32_bf16 v[66:69], v[26:29], v[42:45], v[66:69]
  ds_read_b128 v[34:37], v5 offset:16384
  ds_read_b64_tr_b16 v[54:55], v8 offset:30720
  v_mfma_f32_16x16x32_bf16 v[78:81], v[30:33], v[42:45], v[78:81]
  ds_read_b64_tr_b16 v[56:57], v8 offset:31488
  ds_read_b128 v[38:41], v7 offset:16384
  v_mfma_f32_16x16x32_bf16 v[70:73], v[26:29], v[46:49], v[70:73]
  ds_read_b64_tr_b16 v[58:59], v9 offset:30720
  ds_read_b64_tr_b16 v[60:61], v9 offset:31488
  v_mfma_f32_16x16x32_bf16 v[82:85], v[30:33], v[46:49], v[82:85]
  ds_read_b64_tr_b16 v[62:63], v10 offset:30720
  ds_read_b64_tr_b16 v[64:65], v10 offset:31488
  v_mfma_f32_16x16x32_bf16 v[74:77], v[26:29], v[50:53], v[74:77]
  v_mfma_f32_16x16x32_bf16 v[86:89], v[30:33], v[50:53], v[86:89]
  v_mfma_f32_16x16x32_bf16 v[106:109], v[102:105], v[26:29], v[106:109]
  v_mfma_f32_16x16x32_bf16 v[110:113], v[26:29], v[26:29], v[110:113]
  s_cmp_eq_u32 s35, 0
  s_cbranch_scc0 K1_SK_1a2
  v_mfma_f32_16x16x32_bf16 v[90:93], v[102:105], v[42:45], v[90:93]
  v_mfma_f32_16x16x32_bf16 v[94:97], v[102:105], v[46:49], v[94:97]
  v_mfma_f32_16x16x32_bf16 v[98:101], v[102:105], v[50:53], v[98:101]
K1_SK_1a2:
  s_waitcnt lgkmcnt(0)
  s_barrier
  v_mfma_f32_16x16x32_bf16 v[66:69], v[34:37], v[54:57], v[66:69]
  ds_read_b128 v[26:29], v4 offset:24576
  ds_read_b64_tr_b16 v[42:43], v8 offset:36864
  v_mfma_f32_16x16x32_bf16 v[78:81], v[38:41], v[54:57], v[78:81]
  ds_read_b64_tr_b16 v[44:45], v8 offset:37632
  ds_read_b128 v[30:33], v6 offset:24576
  v_mfma_f32_16x16x32_bf16 v[70:73], v[34:37], v[58:61], v[70:73]
  ds_read_b64_tr_b16 v[46:47], v9 offset:36864
  ds_read_b64_tr_b16 v[48:49], v9 offset:37632
  v_mfma_f32_16x16x32_bf16 v[82:85], v[38:41], v[58:61], v[82:85]
  ds_read_b64_tr_b16 v[50:51], v10 offset:36864
  ds_read_b64_tr_b16 v[52:53], v10 offset:37632
  v_mfma_f32_16x16x32_bf16 v[74:77], v[34:37], v[62:65], v[74:77]
  v_mfma_f32_16x16x32_bf16 v[86:89], v[38:41], v[62:65], v[86:89]
  v_mfma_f32_16x16x32_bf16 v[106:109], v[102:105], v[34:37], v[106:109]
  v_mfma_f32_16x16x32_bf16 v[110:113], v[34:37], v[34:37], v[110:113]
  s_cmp_eq_u32 s35, 1
  s_cbranch_scc0 K1_SK_1b2
  v_mfma_f32_16x16x32_bf16 v[90:93], v[102:105], v[54:57], v[90:93]
  v_mfma_f32_16x16x32_bf16 v[94:97], v[102:105], v[58:61], v[94:97]
  v_mfma_f32_16x16x32_bf16 v[98:101], v[102:105], v[62:65], v[98:101]
K1_SK_1b2:
  s_waitcnt lgkmcnt(0)
  v_mfma_f32_16x16x32_bf16 v[66:69], v[26:29], v[42:45], v[66:69]
  ds_read_b128 v[34:37], v5 offset:24576
  ds_read_b64_tr_b16 v[54:55], v8 offset:43008
  v_mfma_f32_16x16x32_bf16 v[78:81], v[30:33], v[42:45], v[78:81]
  ds_read_b64_tr_b16 v[56:57], v8 offset:43776
  ds_read_b128 v[38:41], v7 offset:24576
  v_mfma_f32_16x16x32_bf16 v[70:73], v[26:29], v[46:49], v[70:73]
  ds_read_b64_tr_b16 v[58:59], v9 offset:43008
  ds_read_b64_tr_b16 v[60:61], v9 offset:43776
  v_mfma_f32_16x16x32_bf16 v[82:85], v[30:33], v[46:49], v[82:85]
  ds_read_b64_tr_b16 v[62:63], v10 offset:43008
  ds_read_b64_tr_b16 v[64:65], v10 offset:43776
  v_mfma_f32_16x16x32_bf16 v[74:77], v[26:29], v[50:53], v[74:77]
  v_mfma_f32_16x16x32_bf16 v[86:89], v[30:33], v[50:53], v[86:89]
  v_mfma_f32_16x16x32_bf16 v[106:109], v[102:105], v[26:29], v[106:109]
  v_mfma_f32_16x16x32_bf16 v[110:113], v[26:29], v[26:29], v[110:113]
  s_cmp_eq_u32 s35, 0
  s_cbranch_scc0 K1_SK_1a3
  v_mfma_f32_16x16x32_bf16 v[90:93], v[102:105], v[42:45], v[90:93]
  v_mfma_f32_16x16x32_bf16 v[94:97], v[102:105], v[46:49], v[94:97]
  v_mfma_f32_16x16x32_bf16 v[98:101], v[102:105], v[50:53], v[98:101]
K1_SK_1a3:
  s_waitcnt lgkmcnt(0)
  s_barrier
  v_mfma_f32_16x16x32_bf16 v[66:69], v[34:37], v[54:57], v[66:69]
  ds_read_b128 v[26:29], v4 offset:32768
  ds_read_b64_tr_b16 v[42:43], v8 offset:49152
  v_mfma_f32_16x16x32_bf16 v[78:81], v[38:41], v[54:57], v[78:81]
  ds_read_b64_tr_b16 v[44:45], v8 offset:49920
  ds_read_b128 v[30:33], v6 offset:32768
  v_mfma_f32_16x16x32_bf16 v[70:73], v[34:37], v[58:61], v[70:73]
  ds_read_b64_tr_b16 v[46:47], v9 offset:49152
  ds_read_b64_tr_b16 v[48:49], v9 offset:49920
  v_mfma_f32_16x16x32_bf16 v[82:85], v[38:41], v[58:61], v[82:85]
  ds_read_b64_tr_b16 v[50:51], v10 offset:49152
  ds_read_b64_tr_b16 v[52:53], v10 offset:49920
  v_mfma_f32_16x16x32_bf16 v[74:77], v[34:37], v[62:65], v[74:77]
  v_mfma_f32_16x16x32_bf16 v[86:89], v[38:41], v[62:65], v[86:89]
  v_mfma_f32_16x16x32_bf16 v[106:109], v[102:105], v[34:37], v[106:109]
  v_mfma_f32_16x16x32_bf16 v[110:113], v[34:37], v[34:37], v[110:113]
  s_cmp_eq_u32 s35, 1
  s_cbranch_scc0 K1_SK_1b3
  v_mfma_f32_16x16x32_bf16 v[90:93], v[102:105], v[54:57], v[90:93]
  v_mfma_f32_16x16x32_bf16 v[94:97], v[102:105], v[58:61], v[94:97]
  v_mfma_f32_16x16x32_bf16 v[98:101], v[102:105], v[62:65], v[98:101]
K1_SK_1b3:
  s_waitcnt lgkmcnt(0)
  v_mfma_f32_16x16x32_bf16 v[66:69], v[26:29], v[42:45], v[66:69]
  ds_read_b128 v[34:37], v5 offset:32768
  ds_read_b64_tr_b16 v[54:55], v8 offset:55296
  v_mfma_f32_16x16x32_bf16 v[78:81], v[30:33], v[42:45], v[78:81]
  ds_read_b64_tr_b16 v[56:57], v8 offset:56064
  ds_read_b128 v[38:41], v7 offset:32768
  v_mfma_f32_16x16x32_bf16 v[70:73], v[26:29], v[46:49], v[70:73]
  ds_read_b64_tr_b16 v[58:59], v9 offset:55296
  ds_read_b64_tr_b16 v[60:61], v9 offset:56064
  v_mfma_f32_16x16x32_bf16 v[82:85], v[30:33], v[46:49], v[82:85]
  ds_read_b64_tr_b16 v[62:63], v10 offset:55296
  ds_read_b64_tr_b16 v[64:65], v10 offset:56064
  v_mfma_f32_16x16x32_bf16 v[74:77], v[26:29], v[50:53], v[74:77]
  v_mfma_f32_16x16x32_bf16 v[86:89], v[30:33], v[50:53], v[86:89]
  v_mfma_f32_16x16x32_bf16 v[106:109], v[102:105], v[26:29], v[106:109]
  v_mfma_f32_16x16x32_bf16 v[110:113], v[26:29], v[26:29], v[110:113]
  s_cmp_eq_u32 s35, 0
  s_cbranch_scc0 K1_SK_1a4
  v_mfma_f32_16x16x32_bf16 v[90:93], v[102:105], v[42:45], v[90:93]
  v_mfma_f32_16x16x32_bf16 v[94:97], v[102:105], v[46:49], v[94:97]
  v_mfma_f32_16x16x32_bf16 v[98:101], v[102:105], v[50:53], v[98:101]
K1_SK_1a4:
  s_waitcnt lgkmcnt(0)
  s_barrier
  v_add_u32 v4, 40960, v4
  v_add_u32 v5, 40960, v5
  v_add_u32 v6, 40960, v6
  v_add_u32 v7, 40960, v7
  v_mfma_f32_16x16x32_bf16 v[66:69], v[34:37], v[54:57], v[66:69]
  ds_read_b128 v[26:29], v4 offset:0
  ds_read_b64_tr_b16 v[42:43], v8 offset:0
  v_mfma_f32_16x16x32_bf16 v[78:81], v[38:41], v[54:57], v[78:81]
  ds_read_b64_tr_b16 v[44:45], v8 offset:768
  ds_read_b128 v[30:33], v6 offset:0
  v_mfma_f32_16x16x32_bf16 v[70:73], v[34:37], v[58:61], v[70:73]
  ds_read_b64_tr_b16 v[46:47], v9 offset:0
  ds_read_b64_tr_b16 v[48:49], v9 offset:768
  v_mfma_f32_16x16x32_bf16 v[82:85], v[38:41], v[58:61], v[82:85]
  ds_read_b64_tr_b16 v[50:51], v10 offset:0
  ds_read_b64_tr_b16 v[52:53], v10 offset:768
  v_mfma_f32_16x16x32_bf16 v[74:77], v[34:37], v[62:65], v[74:77]
  v_mfma_f32_16x16x32_bf16 v[86:89], v[38:41], v[62:65], v[86:89]
  v_mfma_f32_16x16x32_bf16 v[106:109], v[102:105], v[34:37], v[106:109]
  v_mfma_f32_16x16x32_bf16 v[110:113], v[34:37], v[34:37], v[110:113]
  s_cmp_eq_u32 s35, 1
  s_cbranch_scc0 K1_SK_1b4
  v_mfma_f32_16x16x32_bf16 v[90:93], v[102:105], v[54:57], v[90:93]
  v_mfma_f32_16x16x32_bf16 v[94:97], v[102:105], v[58:61], v[94:97]
  v_mfma_f32_16x16x32_bf16 v[98:101], v[102:105], v[62:65], v[98:101]
K1_SK_1b4:
  s_add_u32 s37, s37, 1
  s_cmp_lt_u32 s37, 2
  s_cbranch_scc1 K1_LOOP1
  s_setprio 2
  s_lshl_b32 s40, s32, 2
  v_mov_b32 v22, s40
  v_and_b32 v14, 3, v3
  v_cmp_eq_u32 vcc, 1, v14
  s_nop 1
  v_cndmask_b32 v110, v110, v111, vcc
  v_cmp_eq_u32 vcc, 2, v14
  s_nop 1
  v_cndmask_b32 v110, v110, v112, vcc
  v_cmp_eq_u32 vcc, 3, v14
  s_nop 1
  v_cndmask_b32 v110, v110, v113, vcc
  v_mul_f32 v16, 0x3acccccd, v106
  v_mul_f32 v18, 0x3acccccd, v110
  v_fma_f32 v18, -v16, v16, v18
  v_max_f32 v18, 0, v18
  v_cvt_pk_bf16_f32 v16, v16, v16
  v_lshlrev_b32 v16, 16, v16
  v_cvt_pk_bf16_f32 v18, v18, v18
  v_lshlrev_b32 v18, 16, v18
  v_add_f32 v18, 0x3727c5ac, v18
  v_cvt_pk_bf16_f32 v18, v18, v18
  v_lshlrev_b32 v18, 16, v18
  v_sqrt_f32 v18, v18
  s_nop 0
  v_cvt_pk_bf16_f32 v18, v18, v18
  v_lshlrev_b32 v18, 16, v18
  v_rcp_f32 v17, v18
  s_lshl_b32 s40, s35, 5
  s_lshl_b32 s41, s36, 4
  s_add_u32 s40, s40, s41
  v_add_u32 v18, s40, v3
  v_lshlrev_b32 v19, 2, v18
  v_add_u32 v19, 143360, v19
  s_mov_b32 exec_lo, 0xf0000f
  s_mov_b32 exec_hi, 0xf0000f00
  ds_write_b32 v19, v16
  ds_write_b32 v19, v17 offset:256
  s_branch K1_NOST1X
  s_cmp_eq_u32 s33, 0
  s_cbranch_scc0 K1_NOST1X
  s_lshl_b32 s41, s32, 9
  s_add_u32 s41, s41, 16777216
  v_lshlrev_b32 v18, 3, v18
  buffer_store_dwordx2 v[16:17], v18, s[16:19], s41 offen sc1
K1_NOST1X:
  s_mov_b64 exec, s[52:53]
  s_mul_i32 s40, s55, 192
  s_add_u32 s40, s40, 143872
  v_lshlrev_b32 v20, 2, v3
  v_add_u32 v20, s40, v20
  ds_write_b32 v20, v90 offset:0
  ds_write_b32 v20, v94 offset:64
  ds_write_b32 v20, v98 offset:128
  s_waitcnt lgkmcnt(0)
  s_barrier
  s_xor_b32 s41, s55, 2
  s_mul_i32 s41, s41, 192
  s_add_u32 s41, s41, 143872
  v_lshlrev_b32 v18, 2, v3
  v_add_u32 v18, s41, v18
  ds_read_b32 v136, v18 offset:0
  ds_read_b32 v138, v18 offset:64
  ds_read_b32 v140, v18 offset:128
  s_lshl_b32 s40, s35, 7
  s_lshl_b32 s41, s36, 6
  s_add_u32 s40, s40, s41
  s_add_u32 s40, s40, 143360
  v_lshlrev_b32 v19, 4, v2
  v_add_u32 v19, s40, v19
  v_xor_b32 v20, 64, v19
  ds_read_b128 v[26:29], v19
  ds_read_b128 v[30:33], v20
  ds_read_b128 v[34:37], v19 offset:256
  ds_read_b128 v[38:41], v20 offset:256
  v_mov_b32 v126, 0xc0135761
  v_mov_b32 v127, 0xc0135761
  v_mov_b32 v42, 0
  v_mov_b32 v43, 0
  v_mov_b32 v44, 0
  v_mov_b32 v45, 0
  v_mov_b32 v46, 0
  v_mov_b32 v47, 0
  v_mov_b32 v48, 0
  v_mov_b32 v49, 0
  v_mov_b32 v50, 0
  v_mov_b32 v51, 0
  v_mov_b32 v52, 0
  v_mov_b32 v53, 0
  v_mov_b32 v54, 0
  v_mov_b32 v55, 0
  v_mov_b32 v56, 0
  v_mov_b32 v57, 0
  s_waitcnt lgkmcnt(0)
  v_add_f32 v136, v136, v90
  v_sub_f32 v136, 0, v136
  v_add_f32 v138, v138, v94
  v_sub_f32 v138, 0, v138
  v_add_f32 v140, v140, v98
  v_sub_f32 v140, 0, v140
  v_fma_f32 v66, v26, v136, v66
  v_fma_f32 v67, v27, v136, v67
  v_mul_f32 v66, v66, v34
  v_mul_f32 v67, v67, v35
  v_mul_f32 v128, v66, v66
  v_mul_f32 v129, v67, v67
  v_fma_f32 v128, v128, s48, v126
  v_fma_f32 v129, v129, s48, v126
  v_mul_f32 v128, v128, v66
  v_mul_f32 v129, v129, v67
  v_exp_f32 v128, v128
  v_exp_f32 v129, v129
  v_add_f32 v128, 1.0, v128
  v_add_f32 v129, 1.0, v129
  v_rcp_f32 v128, v128
  v_rcp_f32 v129, v129
  v_mul_f32 v128, v128, v66
  v_mul_f32 v129, v129, v67
  v_cvt_pk_bf16_f32 v114, v128, v129
  v_add_f32 v42, v42, v128
  v_add_f32 v43, v43, v129
  v_fma_f32 v50, v128, v128, v50
  v_fma_f32 v51, v129, v129, v51
  v_fma_f32 v68, v28, v136, v68
  v_fma_f32 v69, v29, v136, v69
  v_mul_f32 v68, v68, v36
  v_mul_f32 v69, v69, v37
  v_mul_f32 v132, v68, v68
  v_mul_f32 v133, v69, v69
  v_fma_f32 v132, v132, s48, v126
  v_fma_f32 v133, v133, s48, v126
  v_mul_f32 v132, v132, v68
  v_mul_f32 v133, v133, v69
  v_exp_f32 v132, v132
  v_exp_f32 v133, v133
  v_add_f32 v132, 1.0, v132
  v_add_f32 v133, 1.0, v133
  v_rcp_f32 v132, v132
  v_rcp_f32 v133, v133
  v_mul_f32 v132, v132, v68
  v_mul_f32 v133, v133, v69
  v_cvt_pk_bf16_f32 v115, v132, v133
  v_add_f32 v44, v44, v132
  v_add_f32 v45, v45, v133
  v_fma_f32 v52, v132, v132, v52
  v_fma_f32 v53, v133, v133, v53
  s_barrier
  v_fma_f32 v78, v30, v136, v78
  v_fma_f32 v79, v31, v136, v79
  v_mul_f32 v78, v78, v38
  v_mul_f32 v79, v79, v39
  v_mul_f32 v128, v78, v78
  v_mul_f32 v129, v79, v79
  v_fma_f32 v128, v128, s48, v126
  v_fma_f32 v129, v129, s48, v126
  v_mul_f32 v128, v128, v78
  v_mul_f32 v129, v129, v79
  v_exp_f32 v128, v128
  v_exp_f32 v129, v129
  v_add_f32 v128, 1.0, v128
  v_add_f32 v129, 1.0, v129
  v_rcp_f32 v128, v128
  v_rcp_f32 v129, v129
  v_mul_f32 v128, v128, v78
  v_mul_f32 v129, v129, v79
  v_cvt_pk_bf16_f32 v116, v128, v129
  v_add_f32 v46, v46, v128
  v_add_f32 v47, v47, v129
  v_fma_f32 v54, v128, v128, v54
  v_fma_f32 v55, v129, v129, v55
  v_fma_f32 v80, v32, v136, v80
  v_fma_f32 v81, v33, v136, v81
  v_mul_f32 v80, v80, v40
  v_mul_f32 v81, v81, v41
  v_mul_f32 v132, v80, v80
  v_mul_f32 v133, v81, v81
  v_fma_f32 v132, v132, s48, v126
  v_fma_f32 v133, v133, s48, v126
  v_mul_f32 v132, v132, v80
  v_mul_f32 v133, v133, v81
  v_exp_f32 v132, v132
  v_exp_f32 v133, v133
  v_add_f32 v132, 1.0, v132
  v_add_f32 v133, 1.0, v133
  v_rcp_f32 v132, v132
  v_rcp_f32 v133, v133
  v_mul_f32 v132, v132, v80
  v_mul_f32 v133, v133, v81
  v_cvt_pk_bf16_f32 v117, v132, v133
  v_add_f32 v48, v48, v132
  v_add_f32 v49, v49, v133
  v_fma_f32 v56, v132, v132, v56
  v_fma_f32 v57, v133, v133, v57
  v_fma_f32 v70, v26, v138, v70
  v_fma_f32 v71, v27, v138, v71
  v_mul_f32 v70, v70, v34
  v_mul_f32 v71, v71, v35
  v_mul_f32 v128, v70, v70
  v_mul_f32 v129, v71, v71
  v_fma_f32 v128, v128, s48, v126
  v_fma_f32 v129, v129, s48, v126
  v_mul_f32 v128, v128, v70
  v_mul_f32 v129, v129, v71
  v_exp_f32 v128, v128
  v_exp_f32 v129, v129
  v_add_f32 v128, 1.0, v128
  v_add_f32 v129, 1.0, v129
  v_rcp_f32 v128, v128
  v_rcp_f32 v129, v129
  v_mul_f32 v128, v128, v70
  v_mul_f32 v129, v129, v71
  v_cvt_pk_bf16_f32 v118, v128, v129
  v_add_f32 v42, v42, v128
  v_add_f32 v43, v43, v129
  v_fma_f32 v50, v128, v128, v50
  v_fma_f32 v51, v129, v129, v51
  s_barrier
  v_fma_f32 v72, v28, v138, v72
  v_fma_f32 v73, v29, v138, v73
  v_mul_f32 v72, v72, v36
  v_mul_f32 v73, v73, v37
  v_mul_f32 v132, v72, v72
  v_mul_f32 v133, v73, v73
  v_fma_f32 v132, v132, s48, v126
  v_fma_f32 v133, v133, s48, v126
  v_mul_f32 v132, v132, v72
  v_mul_f32 v133, v133, v73
  v_exp_f32 v132, v132
  v_exp_f32 v133, v133
  v_add_f32 v132, 1.0, v132
  v_add_f32 v133, 1.0, v133
  v_rcp_f32 v132, v132
  v_rcp_f32 v133, v133
  v_mul_f32 v132, v132, v72
  v_mul_f32 v133, v133, v73
  v_cvt_pk_bf16_f32 v119, v132, v133
  v_add_f32 v44, v44, v132
  v_add_f32 v45, v45, v133
  v_fma_f32 v52, v132, v132, v52
  v_fma_f32 v53, v133, v133, v53
  v_fma_f32 v82, v30, v138, v82
  v_fma_f32 v83, v31, v138, v83
  v_mul_f32 v82, v82, v38
  v_mul_f32 v83, v83, v39
  v_mul_f32 v128, v82, v82
  v_mul_f32 v129, v83, v83
  v_fma_f32 v128, v128, s48, v126
  v_fma_f32 v129, v129, s48, v126
  v_mul_f32 v128, v128, v82
  v_mul_f32 v129, v129, v83
  v_exp_f32 v128, v128
  v_exp_f32 v129, v129
  v_add_f32 v128, 1.0, v128
  v_add_f32 v129, 1.0, v129
  v_rcp_f32 v128, v128
  v_rcp_f32 v129, v129
  v_mul_f32 v128, v128, v82
  v_mul_f32 v129, v129, v83
  v_cvt_pk_bf16_f32 v120, v128, v129
  v_add_f32 v46, v46, v128
  v_add_f32 v47, v47, v129
  v_fma_f32 v54, v128, v128, v54
  v_fma_f32 v55, v129, v129, v55
  s_barrier
  v_fma_f32 v84, v32, v138, v84
  v_fma_f32 v85, v33, v138, v85
  v_mul_f32 v84, v84, v40
  v_mul_f32 v85, v85, v41
  v_mul_f32 v132, v84, v84
  v_mul_f32 v133, v85, v85
  v_fma_f32 v132, v132, s48, v126
  v_fma_f32 v133, v133, s48, v126
  v_mul_f32 v132, v132, v84
  v_mul_f32 v133, v133, v85
  v_exp_f32 v132, v132
  v_exp_f32 v133, v133
  v_add_f32 v132, 1.0, v132
  v_add_f32 v133, 1.0, v133
  v_rcp_f32 v132, v132
  v_rcp_f32 v133, v133
  v_mul_f32 v132, v132, v84
  v_mul_f32 v133, v133, v85
  v_cvt_pk_bf16_f32 v121, v132, v133
  v_add_f32 v48, v48, v132
  v_add_f32 v49, v49, v133
  v_fma_f32 v56, v132, v132, v56
  v_fma_f32 v57, v133, v133, v57
  v_fma_f32 v74, v26, v140, v74
  v_fma_f32 v75, v27, v140, v75
  v_mul_f32 v74, v74, v34
  v_mul_f32 v75, v75, v35
  v_mul_f32 v128, v74, v74
  v_mul_f32 v129, v75, v75
  v_fma_f32 v128, v128, s48, v126
  v_fma_f32 v129, v129, s48, v126
  v_mul_f32 v128, v128, v74
  v_mul_f32 v129, v129, v75
  v_exp_f32 v128, v128
  v_exp_f32 v129, v129
  v_add_f32 v128, 1.0, v128
  v_add_f32 v129, 1.0, v129
  v_rcp_f32 v128, v128
  v_rcp_f32 v129, v129
  v_mul_f32 v128, v128, v74
  v_mul_f32 v129, v129, v75
  v_cvt_pk_bf16_f32 v122, v128, v129
  v_add_f32 v42, v42, v128
  v_add_f32 v43, v43, v129
  v_fma_f32 v50, v128, v128, v50
  v_fma_f32 v51, v129, v129, v51
  v_fma_f32 v76, v28, v140, v76
  v_fma_f32 v77, v29, v140, v77
  v_mul_f32 v76, v76, v36
  v_mul_f32 v77, v77, v37
  v_mul_f32 v132, v76, v76
  v_mul_f32 v133, v77, v77
  v_fma_f32 v132, v132, s48, v126
  v_fma_f32 v133, v133, s48, v126
  v_mul_f32 v132, v132, v76
  v_mul_f32 v133, v133, v77
  v_exp_f32 v132, v132
  v_exp_f32 v133, v133
  v_add_f32 v132, 1.0, v132
  v_add_f32 v133, 1.0, v133
  v_rcp_f32 v132, v132
  v_rcp_f32 v133, v133
  v_mul_f32 v132, v132, v76
  v_mul_f32 v133, v133, v77
  v_cvt_pk_bf16_f32 v123, v132, v133
  v_add_f32 v44, v44, v132
  v_add_f32 v45, v45, v133
  v_fma_f32 v52, v132, v132, v52
  v_fma_f32 v53, v133, v133, v53
  s_barrier
  v_fma_f32 v86, v30, v140, v86
  v_fma_f32 v87, v31, v140, v87
  v_mul_f32 v86, v86, v38
  v_mul_f32 v87, v87, v39
  v_mul_f32 v128, v86, v86
  v_mul_f32 v129, v87, v87
  v_fma_f32 v128, v128, s48, v126
  v_fma_f32 v129, v129, s48, v126
  v_mul_f32 v128, v128, v86
  v_mul_f32 v129, v129, v87
  v_exp_f32 v128, v128
  v_exp_f32 v129, v129
  v_add_f32 v128, 1.0, v128
  v_add_f32 v129, 1.0, v129
  v_rcp_f32 v128, v128
  v_rcp_f32 v129, v129
  v_mul_f32 v128, v128, v86
  v_mul_f32 v129, v129, v87
  v_cvt_pk_bf16_f32 v124, v128, v129
  v_add_f32 v46, v46, v128
  v_add_f32 v47, v47, v129
  v_fma_f32 v54, v128, v128, v54
  v_fma_f32 v55, v129, v129, v55
  v_fma_f32 v88, v32, v140, v88
  v_fma_f32 v89, v33, v140, v89
  v_mul_f32 v88, v88, v40
  v_mul_f32 v89, v89, v41
  v_mul_f32 v132, v88, v88
  v_mul_f32 v133, v89, v89
  v_fma_f32 v132, v132, s48, v126
  v_fma_f32 v133, v133, s48, v126
  v_mul_f32 v132, v132, v88
  v_mul_f32 v133, v133, v89
  v_exp_f32 v132, v132
  v_exp_f32 v133, v133
  v_add_f32 v132, 1.0, v132
  v_add_f32 v133, 1.0, v133
  v_rcp_f32 v132, v132
  v_rcp_f32 v133, v133
  v_mul_f32 v132, v132, v88
  v_mul_f32 v133, v133, v89
  v_cvt_pk_bf16_f32 v125, v132, v133
  v_add_f32 v48, v48, v132
  v_add_f32 v49, v49, v133
  v_fma_f32 v56, v132, v132, v56
  v_fma_f32 v57, v133, v133, v57
  s_barrier
  v_add_f32_dpp v42, v42, v42 row_ror:8 row_mask:0xf bank_mask:0xf
  v_add_f32_dpp v43, v43, v43 row_ror:8 row_mask:0xf bank_mask:0xf
  v_add_f32_dpp v44, v44, v44 row_ror:8 row_mask:0xf bank_mask:0xf
  v_add_f32_dpp v45, v45, v45 row_ror:8 row_mask:0xf bank_mask:0xf
  v_add_f32_dpp v46, v46, v46 row_ror:8 row_mask:0xf bank_mask:0xf
  v_add_f32_dpp v47, v47, v47 row_ror:8 row_mask:0xf bank_mask:0xf
  v_add_f32_dpp v48, v48, v48 row_ror:8 row_mask:0xf bank_mask:0xf
  v_add_f32_dpp v49, v49, v49 row_ror:8 row_mask:0xf bank_mask:0xf
  v_add_f32_dpp v50, v50, v50 row_ror:8 row_mask:0xf bank_mask:0xf
  v_add_f32_dpp v51, v51, v51 row_ror:8 row_mask:0xf bank_mask:0xf
  v_add_f32_dpp v52, v52, v52 row_ror:8 row_mask:0xf bank_mask:0xf
  v_add_f32_dpp v53, v53, v53 row_ror:8 row_mask:0xf bank_mask:0xf
  v_add_f32_dpp v54, v54, v54 row_ror:8 row_mask:0xf bank_mask:0xf
  v_add_f32_dpp v55, v55, v55 row_ror:8 row_mask:0xf bank_mask:0xf
  v_add_f32_dpp v56, v56, v56 row_ror:8 row_mask:0xf bank_mask:0xf
  v_add_f32_dpp v57, v57, v57 row_ror:8 row_mask:0xf bank_mask:0xf
  v_add_f32_dpp v42, v42, v42 row_ror:4 row_mask:0xf bank_mask:0xf
  v_add_f32_dpp v43, v43, v43 row_ror:4 row_mask:0xf bank_mask:0xf
  v_add_f32_dpp v44, v44, v44 row_ror:4 row_mask:0xf bank_mask:0xf
  v_add_f32_dpp v45, v45, v45 row_ror:4 row_mask:0xf bank_mask:0xf
  v_add_f32_dpp v46, v46, v46 row_ror:4 row_mask:0xf bank_mask:0xf
  v_add_f32_dpp v47, v47, v47 row_ror:4 row_mask:0xf bank_mask:0xf
  v_add_f32_dpp v48, v48, v48 row_ror:4 row_mask:0xf bank_mask:0xf
  v_add_f32_dpp v49, v49, v49 row_ror:4 row_mask:0xf bank_mask:0xf
  v_add_f32_dpp v50, v50, v50 row_ror:4 row_mask:0xf bank_mask:0xf
  v_add_f32_dpp v51, v51, v51 row_ror:4 row_mask:0xf bank_mask:0xf
  v_add_f32_dpp v52, v52, v52 row_ror:4 row_mask:0xf bank_mask:0xf
  v_add_f32_dpp v53, v53, v53 row_ror:4 row_mask:0xf bank_mask:0xf
  v_add_f32_dpp v54, v54, v54 row_ror:4 row_mask:0xf bank_mask:0xf
  v_add_f32_dpp v55, v55, v55 row_ror:4 row_mask:0xf bank_mask:0xf
  v_add_f32_dpp v56, v56, v56 row_ror:4 row_mask:0xf bank_mask:0xf
  v_add_f32_dpp v57, v57, v57 row_ror:4 row_mask:0xf bank_mask:0xf
  v_add_f32_dpp v42, v42, v42 row_ror:2 row_mask:0xf bank_mask:0xf
  v_add_f32_dpp v43, v43, v43 row_ror:2 row_mask:0xf bank_mask:0xf
  v_add_f32_dpp v44, v44, v44 row_ror:2 row_mask:0xf bank_mask:0xf
  v_add_f32_dpp v45, v45, v45 row_ror:2 row_mask:0xf bank_mask:0xf
  v_add_f32_dpp v46, v46, v46 row_ror:2 row_mask:0xf bank_mask:0xf
  v_add_f32_dpp v47, v47, v47 row_ror:2 row_mask:0xf bank_mask:0xf
  v_add_f32_dpp v48, v48, v48 row_ror:2 row_mask:0xf bank_mask:0xf
  v_add_f32_dpp v49, v49, v49 row_ror:2 row_mask:0xf bank_mask:0xf
  v_add_f32_dpp v50, v50, v50 row_ror:2 row_mask:0xf bank_mask:0xf
  v_add_f32_dpp v51, v51, v51 row_ror:2 row_mask:0xf bank_mask:0xf
  v_add_f32_dpp v52, v52, v52 row_ror:2 row_mask:0xf bank_mask:0xf
  v_add_f32_dpp v53, v53, v53 row_ror:2 row_mask:0xf bank_mask:0xf
  v_add_f32_dpp v54, v54, v54 row_ror:2 row_mask:0xf bank_mask:0xf
  v_add_f32_dpp v55, v55, v55 row_ror:2 row_mask:0xf bank_mask:0xf
  v_add_f32_dpp v56, v56, v56 row_ror:2 row_mask:0xf bank_mask:0xf
  v_add_f32_dpp v57, v57, v57 row_ror:2 row_mask:0xf bank_mask:0xf
  v_add_f32_dpp v42, v42, v42 row_ror:1 row_mask:0xf bank_mask:0xf
  v_add_f32_dpp v43, v43, v43 row_ror:1 row_mask:0xf bank_mask:0xf
  v_add_f32_dpp v44, v44, v44 row_ror:1 row_mask:0xf bank_mask:0xf
  v_add_f32_dpp v45, v45, v45 row_ror:1 row_mask:0xf bank_mask:0xf
  v_add_f32_dpp v46, v46, v46 row_ror:1 row_mask:0xf bank_mask:0xf
  v_add_f32_dpp v47, v47, v47 row_ror:1 row_mask:0xf bank_mask:0xf
  v_add_f32_dpp v48, v48, v48 row_ror:1 row_mask:0xf bank_mask:0xf
  v_add_f32_dpp v49, v49, v49 row_ror:1 row_mask:0xf bank_mask:0xf
  v_add_f32_dpp v50, v50, v50 row_ror:1 row_mask:0xf bank_mask:0xf
  v_add_f32_dpp v51, v51, v51 row_ror:1 row_mask:0xf bank_mask:0xf
  v_add_f32_dpp v52, v52, v52 row_ror:1 row_mask:0xf bank_mask:0xf
  v_add_f32_dpp v53, v53, v53 row_ror:1 row_mask:0xf bank_mask:0xf
  v_add_f32_dpp v54, v54, v54 row_ror:1 row_mask:0xf bank_mask:0xf
  v_add_f32_dpp v55, v55, v55 row_ror:1 row_mask:0xf bank_mask:0xf
  v_add_f32_dpp v56, v56, v56 row_ror:1 row_mask:0xf bank_mask:0xf
  v_add_f32_dpp v57, v57, v57 row_ror:1 row_mask:0xf bank_mask:0xf
  s_lshl_b32 s40, s36, 8
  s_add_u32 s40, s40, 2048
  v_add_u32 v19, s40, v19
  v_add_u32 v20, s40, v20
  s_mov_b32 exec_lo, 0x10001
  s_mov_b32 exec_hi, 0x10001
  ds_write_b128 v19, v[42:45]
  ds_write_b128 v20, v[46:49]
  ds_write_b128 v19, v[50:53] offset:512
  ds_write_b128 v20, v[54:57] offset:512
  s_mov_b64 exec, s[52:53]
  s_waitcnt lgkmcnt(0)
  s_barrier
  s_cmp_eq_u32 s34, 0
  s_cbranch_scc0 K1_NOPUB
  v_lshlrev_b32 v14, 2, v1
  v_add_u32 v14, 145408, v14
  ds_read_b32 v16, v14
  ds_read_b32 v18, v14 offset:256
  ds_read_b32 v17, v14 offset:512
  ds_read_b32 v19, v14 offset:768
  s_lshl_b32 s40, s32, 3
  s_add_u32 s40, s40, s33
  s_lshl_b32 s40, s40, 9
  s_add_u32 s40, s40, 16842752
  v_lshlrev_b32 v15, 3, v1
  s_waitcnt lgkmcnt(0)
  v_add_f32 v16, v16, v18
  v_add_f32 v17, v17, v19
  v_max_f32 v17, 0, v17
  buffer_store_dwordx2 v[16:17], v15, s[16:19], s40 offen sc1
K1_NOPUB:
  s_mul_i32 s40, s33, 6
  s_mul_i32 s41, s36, 3
  s_add_u32 s40, s40, s41
  s_lshl_b32 s40, s40, 6
  s_lshl_b32 s41, s32, 1
  s_add_u32 s40, s40, s41
  s_add_u32 s40, s40, s35
  s_lshl_b32 s40, s40, 10
  s_add_u32 s39, s40, 3145728
  v_and_b32 v21, 1, v2
  v_lshlrev_b32 v21, 1, v21
  v_lshrrev_b32 v24, 1, v2
  v_or_b32 v21, v21, v24
  s_lshl_b32 s41, s36, 1
  v_xor_b32 v21, s41, v21
  v_lshlrev_b32 v21, 4, v21
  v_add_u32 v21, v21, v3
  v_lshlrev_b32 v21, 4, v21
  v_and_b32 v24, 31, v1
  s_lshl_b32 s38, s35, 5
  v_add_u32 v24, s38, v24
  v_lshlrev_b32 v24, 3, v24
  s_lshl_b32 s38, s32, 12
  s_add_u32 s38, s38, 16842752
  buffer_load_dword v23, v22, s[4:7], 0 offen offset:0 sc1
  s_barrier
  s_barrier
  s_barrier
  s_waitcnt vmcnt(0)
  s_mov_b32 s54, 0
K1_CCHK:
  v_readfirstlane_b32 s40, v23
  s_nop 0
  s_cmp_ge_u32 s40, 8
  s_cbranch_scc1 K1_COK
  s_add_u32 s54, s54, 1
  s_cmp_lt_u32 s54, 0x200000
  s_cbranch_scc0 K1_COK
  s_sleep 4
  buffer_load_dword v23, v22, s[4:7], 0 offen offset:0 sc1
  s_waitcnt vmcnt(0)
  s_branch K1_CCHK
K1_COK:
  buffer_load_dwordx2 v[44:45], v24, s[16:19], s38 offen offset:0 sc1
  buffer_load_dwordx2 v[46:47], v24, s[16:19], s38 offen offset:512 sc1
  buffer_load_dwordx2 v[48:49], v24, s[16:19], s38 offen offset:1024 sc1
  buffer_load_dwordx2 v[50:51], v24, s[16:19], s38 offen offset:1536 sc1
  buffer_load_dwordx2 v[52:53], v24, s[16:19], s38 offen offset:2048 sc1
  buffer_load_dwordx2 v[54:55], v24, s[16:19], s38 offen offset:2560 sc1
  buffer_load_dwordx2 v[56:57], v24, s[16:19], s38 offen offset:3072 sc1
  buffer_load_dwordx2 v[58:59], v24, s[16:19], s38 offen offset:3584 sc1
  s_barrier
  s_setprio 0
  s_waitcnt vmcnt(0)
  s_mov_b32 s54, 0
K1_CHECK:
  s_mov_b32 s40, 0xbf800000
  v_cmp_eq_u32 vcc, s40, v45
  v_cmp_eq_u32 s[56:57], s40, v47
  s_nop 0
  s_or_b64 vcc, vcc, s[56:57]
  v_cmp_eq_u32 s[56:57], s40, v49
  s_nop 0
  s_or_b64 vcc, vcc, s[56:57]
  v_cmp_eq_u32 s[56:57], s40, v51
  s_nop 0
  s_or_b64 vcc, vcc, s[56:57]
  v_cmp_eq_u32 s[56:57], s40, v53
  s_nop 0
  s_or_b64 vcc, vcc, s[56:57]
  v_cmp_eq_u32 s[56:57], s40, v55
  s_nop 0
  s_or_b64 vcc, vcc, s[56:57]
  v_cmp_eq_u32 s[56:57], s40, v57
  s_nop 0
  s_or_b64 vcc, vcc, s[56:57]
  v_cmp_eq_u32 s[56:57], s40, v59
  s_nop 0
  s_or_b64 vcc, vcc, s[56:57]
  s_cmp_eq_u64 vcc, 0
  s_cbranch_scc1 K1_POLLED
  s_add_u32 s54, s54, 1
  s_cmp_lt_u32 s54, 0x200000
  s_cbranch_scc0 K1_POLLED
  buffer_load_dwordx2 v[44:45], v24, s[16:19], s38 offen offset:0 sc1
  buffer_load_dwordx2 v[46:47], v24, s[16:19], s38 offen offset:512 sc1
  buffer_load_dwordx2 v[48:49], v24, s[16:19], s38 offen offset:1024 sc1
  buffer_load_dwordx2 v[50:51], v24, s[16:19], s38 offen offset:1536 sc1
  buffer_load_dwordx2 v[52:53], v24, s[16:19], s38 offen offset:2048 sc1
  buffer_load_dwordx2 v[54:55], v24, s[16:19], s38 offen offset:2560 sc1
  buffer_load_dwordx2 v[56:57], v24, s[16:19], s38 offen offset:3072 sc1
  buffer_load_dwordx2 v[58:59], v24, s[16:19], s38 offen offset:3584 sc1
  s_waitcnt vmcnt(0)
  s_branch K1_CHECK
K1_POLLED:
  v_add_f32 v44, v44, v46
  v_add_f32 v45, v45, v47
  v_add_f32 v44, v44, v48
  v_add_f32 v45, v45, v49
  v_add_f32 v44, v44, v50
  v_add_f32 v45, v45, v51
  v_add_f32 v44, v44, v52
  v_add_f32 v45, v45, v53
  v_add_f32 v44, v44, v54
  v_add_f32 v45, v45, v55
  v_add_f32 v44, v44, v56
  v_add_f32 v45, v45, v57
  v_add_f32 v44, v44, v58
  v_add_f32 v45, v45, v59
  v_mul_f32 v16, 0x3aaaaaab, v44
  v_mul_f32 v18, 0x3aaaaaab, v45
  v_fma_f32 v18, -v16, v16, v18
  v_max_f32 v18, 0, v18
  v_cvt_pk_bf16_f32 v16, v16, v16
  v_lshlrev_b32 v16, 16, v16
  v_cvt_pk_bf16_f32 v18, v18, v18
  v_lshlrev_b32 v18, 16, v18
  v_add_f32 v18, 0x3727c5ac, v18
  v_cvt_pk_bf16_f32 v18, v18, v18
  v_lshlrev_b32 v18, 16, v18
  v_sqrt_f32 v18, v18
  s_nop 0
  v_cvt_pk_bf16_f32 v18, v18, v18
  v_lshlrev_b32 v18, 16, v18
  v_rcp_f32 v17, v18
  s_nop 0
  v_mul_f32 v16, v16, v17
  v_sub_f32 v16, 0, v16
  s_lshl_b32 s40, s55, 8
  s_add_u32 s40, s40, 146432
  v_and_b32 v18, 31, v1
  v_lshlrev_b32 v18, 2, v18
  v_add_u32 v18, s40, v18
  ds_write_b32 v18, v16
  ds_write_b32 v18, v17 offset:128
  s_lshl_b32 s41, s36, 6
  s_add_u32 s40, s40, s41
  v_lshlrev_b32 v19, 4, v2
  v_add_u32 v19, s40, v19
  v_xor_b32 v20, 64, v19
  s_waitcnt lgkmcnt(0)
  ds_read_b128 v[26:29], v19
  ds_read_b128 v[30:33], v20
  ds_read_b128 v[34:37], v19 offset:128
  ds_read_b128 v[38:41], v20 offset:128
  s_waitcnt lgkmcnt(0)
  v_lshlrev_b32 v128, 16, v114
  v_and_b32 v129, s47, v114
  v_pk_fma_f32 v[128:129], v[128:129], v[34:35], v[26:27]
  v_cvt_pk_bf16_f32 v114, v128, v129
  v_lshlrev_b32 v132, 16, v115
  v_and_b32 v133, s47, v115
  v_pk_fma_f32 v[132:133], v[132:133], v[36:37], v[28:29]
  v_cvt_pk_bf16_f32 v115, v132, v133
  v_lshlrev_b32 v128, 16, v116
  v_and_b32 v129, s47, v116
  v_pk_fma_f32 v[128:129], v[128:129], v[38:39], v[30:31]
  v_cvt_pk_bf16_f32 v116, v128, v129
  v_lshlrev_b32 v132, 16, v117
  v_and_b32 v133, s47, v117
  v_pk_fma_f32 v[132:133], v[132:133], v[40:41], v[32:33]
  v_cvt_pk_bf16_f32 v117, v132, v133
  v_permlane16_swap_b32 v114, v116
  s_nop 0
  v_permlane16_swap_b32 v115, v117
  s_add_u32 s41, s39, 0
  buffer_store_dwordx4 v[114:117], v21, s[16:19], s41 offen sc1
  v_lshlrev_b32 v128, 16, v118
  v_and_b32 v129, s47, v118
  v_pk_fma_f32 v[128:129], v[128:129], v[34:35], v[26:27]
  v_cvt_pk_bf16_f32 v118, v128, v129
  v_lshlrev_b32 v132, 16, v119
  v_and_b32 v133, s47, v119
  v_pk_fma_f32 v[132:133], v[132:133], v[36:37], v[28:29]
  v_cvt_pk_bf16_f32 v119, v132, v133
  v_lshlrev_b32 v128, 16, v120
  v_and_b32 v129, s47, v120
  v_pk_fma_f32 v[128:129], v[128:129], v[38:39], v[30:31]
  v_cvt_pk_bf16_f32 v120, v128, v129
  v_lshlrev_b32 v132, 16, v121
  v_and_b32 v133, s47, v121
  v_pk_fma_f32 v[132:133], v[132:133], v[40:41], v[32:33]
  v_cvt_pk_bf16_f32 v121, v132, v133
  v_permlane16_swap_b32 v118, v120
  s_nop 0
  v_permlane16_swap_b32 v119, v121
  s_add_u32 s41, s39, 65536
  buffer_store_dwordx4 v[118:121], v21, s[16:19], s41 offen sc1
  v_lshlrev_b32 v128, 16, v122
  v_and_b32 v129, s47, v122
  v_pk_fma_f32 v[128:129], v[128:129], v[34:35], v[26:27]
  v_cvt_pk_bf16_f32 v122, v128, v129
  v_lshlrev_b32 v132, 16, v123
  v_and_b32 v133, s47, v123
  v_pk_fma_f32 v[132:133], v[132:133], v[36:37], v[28:29]
  v_cvt_pk_bf16_f32 v123, v132, v133
  v_lshlrev_b32 v128, 16, v124
  v_and_b32 v129, s47, v124
  v_pk_fma_f32 v[128:129], v[128:129], v[38:39], v[30:31]
  v_cvt_pk_bf16_f32 v124, v128, v129
  v_lshlrev_b32 v132, 16, v125
  v_and_b32 v133, s47, v125
  v_pk_fma_f32 v[132:133], v[132:133], v[40:41], v[32:33]
  v_cvt_pk_bf16_f32 v125, v132, v133
  v_permlane16_swap_b32 v122, v124
  s_nop 0
  v_permlane16_swap_b32 v123, v125
  s_add_u32 s41, s39, 131072
  buffer_store_dwordx4 v[122:125], v21, s[16:19], s41 offen sc1
  s_waitcnt vmcnt(0)
  s_barrier
  s_load_dwordx2 s[56:57], s[0:1], 72
  s_and_b32 s35, s34, 1
  s_lshr_b32 s36, s34, 1
  v_xor_b32 v9, v2, v3
  v_lshlrev_b32 v9, 4, v9
  s_lshl_b32 s40, s36, 6
  v_xor_b32 v9, s40, v9
  v_lshlrev_b32 v10, 8, v3
  v_add_u32 v4, v9, v10
  v_xor_b32 v5, 128, v4
  s_mul_i32 s40, s33, 6
  s_mul_i32 s41, s35, 3
  s_add_u32 s40, s40, s41
  s_lshl_b32 s40, s40, 16
  s_add_u32 s40, s40, 3145728
  v_lshlrev_b32 v9, 4, v1
  s_add_u32 s41, s40, 0
  v_add_u32 v6, s41, v9
  s_add_u32 s41, s40, 65536
  v_add_u32 v7, s41, v9
  s_add_u32 s41, s40, 131072
  v_add_u32 v8, s41, v9
  s_lshl_b32 s39, s36, 10
  v_mov_b32 v48, 0
  v_mov_b32 v49, 0
  v_mov_b32 v50, 0
  v_mov_b32 v51, 0
  v_mov_b32 v52, 0
  v_mov_b32 v53, 0
  v_mov_b32 v54, 0
  v_mov_b32 v55, 0
  v_mov_b32 v56, 0
  v_mov_b32 v57, 0
  v_mov_b32 v58, 0
  v_mov_b32 v59, 0
  v_mov_b32 v60, 0
  v_mov_b32 v61, 0
  v_mov_b32 v62, 0
  v_mov_b32 v63, 0
  v_mov_b32 v64, 0
  v_mov_b32 v65, 0
  v_mov_b32 v66, 0
  v_mov_b32 v67, 0
  v_mov_b32 v68, 0
  v_mov_b32 v69, 0
  v_mov_b32 v70, 0
  v_mov_b32 v71, 0
  v_mov_b32 v72, 0
  v_mov_b32 v73, 0
  v_mov_b32 v74, 0
  v_mov_b32 v75, 0
  v_mov_b32 v76, 0
  v_mov_b32 v77, 0
  v_mov_b32 v78, 0
  v_mov_b32 v79, 0
  v_mov_b32 v80, 0
  v_mov_b32 v81, 0
  v_mov_b32 v82, 0
  v_mov_b32 v83, 0
  v_mov_b32 v84, 0
  v_mov_b32 v85, 0
  v_mov_b32 v86, 0
  v_mov_b32 v87, 0
  v_mov_b32 v88, 0
  v_mov_b32 v89, 0
  v_mov_b32 v90, 0
  v_mov_b32 v91, 0
  v_mov_b32 v92, 0
  v_mov_b32 v93, 0
  v_mov_b32 v94, 0
  v_mov_b32 v95, 0
  s_waitcnt lgkmcnt(0)
  s_mov_b32 s12, s56
  s_and_b32 s13, s57, 0xffff
  s_mov_b32 s14, 4096
  s_mov_b32 s15, 0x20000
  s_barrier
  s_add_u32 s38, s39, 0
  buffer_load_dwordx4 v[96:99], v6, s[16:19], s38 offen sc1
  buffer_load_dwordx4 v[100:103], v7, s[16:19], s38 offen sc1
  buffer_load_dwordx4 v[104:107], v8, s[16:19], s38 offen sc1
  s_add_u32 s38, s39, 2048
  buffer_load_dwordx4 v[108:111], v6, s[16:19], s38 offen sc1
  buffer_load_dwordx4 v[112:115], v7, s[16:19], s38 offen sc1
  buffer_load_dwordx4 v[116:119], v8, s[16:19], s38 offen sc1
  s_add_u32 s38, s39, 4096
  buffer_load_dwordx4 v[120:123], v6, s[16:19], s38 offen sc1
  buffer_load_dwordx4 v[124:127], v7, s[16:19], s38 offen sc1
  buffer_load_dwordx4 v[128:131], v8, s[16:19], s38 offen sc1
  s_add_u32 s38, s39, 6144
  buffer_load_dwordx4 v[132:135], v6, s[16:19], s38 offen sc1
  buffer_load_dwordx4 v[136:139], v7, s[16:19], s38 offen sc1
  buffer_load_dwordx4 v[140:143], v8, s[16:19], s38 offen sc1
  s_add_u32 s38, s39, 8192
  buffer_load_dwordx4 v[144:147], v6, s[16:19], s38 offen sc1
  buffer_load_dwordx4 v[148:151], v7, s[16:19], s38 offen sc1
  buffer_load_dwordx4 v[152:155], v8, s[16:19], s38 offen sc1
  s_mov_b32 s37, 0
  ds_read_b128 v[16:19], v4 offset:0
  ds_read_b128 v[20:23], v4 offset:4096
  ds_read_b128 v[24:27], v4 offset:8192
  ds_read_b128 v[28:31], v4 offset:12288
F2_GLOOP:
  s_lshl_b32 s40, s37, 1
  s_add_u32 s40, s40, 5
  s_lshl_b32 s38, s40, 11
  s_add_u32 s38, s38, s39
  s_cmp_lt_u32 s40, 32
  s_cselect_b32 s38, s38, 0x80000000
  s_waitcnt vmcnt(12) lgkmcnt(0)
  v_mfma_f32_16x16x32_bf16 v[48:51], v[96:99], v[16:19], v[48:51]
  ds_read_b128 v[32:35], v5 offset:0
  v_mfma_f32_16x16x32_bf16 v[64:67], v[100:103], v[16:19], v[64:67]
  ds_read_b128 v[36:39], v5 offset:4096
  v_mfma_f32_16x16x32_bf16 v[80:83], v[104:107], v[16:19], v[80:83]
  ds_read_b128 v[40:43], v5 offset:8192
  v_mfma_f32_16x16x32_bf16 v[52:55], v[96:99], v[20:23], v[52:55]
  ds_read_b128 v[44:47], v5 offset:12288
  v_mfma_f32_16x16x32_bf16 v[68:71], v[100:103], v[20:23], v[68:71]
  buffer_load_dwordx4 v[156:159], v6, s[16:19], s38 offen sc1
  v_mfma_f32_16x16x32_bf16 v[84:87], v[104:107], v[20:23], v[84:87]
  v_mfma_f32_16x16x32_bf16 v[56:59], v[96:99], v[24:27], v[56:59]
  buffer_load_dwordx4 v[160:163], v7, s[16:19], s38 offen sc1
  v_mfma_f32_16x16x32_bf16 v[72:75], v[100:103], v[24:27], v[72:75]
  v_mfma_f32_16x16x32_bf16 v[88:91], v[104:107], v[24:27], v[88:91]
  buffer_load_dwordx4 v[164:167], v8, s[16:19], s38 offen sc1
  v_mfma_f32_16x16x32_bf16 v[60:63], v[96:99], v[28:31], v[60:63]
  v_mfma_f32_16x16x32_bf16 v[76:79], v[100:103], v[28:31], v[76:79]
  v_mfma_f32_16x16x32_bf16 v[92:95], v[104:107], v[28:31], v[92:95]
  s_and_b32 s40, s37, 3
  s_movk_i32 s43, 16384
  s_cmp_eq_u32 s40, 3
  s_cselect_b32 s43, 4294918144, s43
  s_lshl_b32 s40, s37, 1
  s_add_u32 s40, s40, 6
  s_lshl_b32 s38, s40, 11
  s_add_u32 s38, s38, s39
  s_cmp_lt_u32 s40, 32
  s_cselect_b32 s38, s38, 0x80000000
  s_waitcnt lgkmcnt(0)
  s_barrier
  v_add_u32 v4, s43, v4
  s_waitcnt vmcnt(12)
  v_mfma_f32_16x16x32_bf16 v[48:51], v[108:111], v[32:35], v[48:51]
  ds_read_b128 v[16:19], v4 offset:0
  v_mfma_f32_16x16x32_bf16 v[64:67], v[112:115], v[32:35], v[64:67]
  ds_read_b128 v[20:23], v4 offset:4096
  v_mfma_f32_16x16x32_bf16 v[80:83], v[116:119], v[32:35], v[80:83]
  ds_read_b128 v[24:27], v4 offset:8192
  v_mfma_f32_16x16x32_bf16 v[52:55], v[108:111], v[36:39], v[52:55]
  ds_read_b128 v[28:31], v4 offset:12288
  v_mfma_f32_16x16x32_bf16 v[68:71], v[112:115], v[36:39], v[68:71]
  buffer_load_dwordx4 v[96:99], v6, s[16:19], s38 offen sc1
  v_mfma_f32_16x16x32_bf16 v[84:87], v[116:119], v[36:39], v[84:87]
  v_mfma_f32_16x16x32_bf16 v[56:59], v[108:111], v[40:43], v[56:59]
  buffer_load_dwordx4 v[100:103], v7, s[16:19], s38 offen sc1
  v_mfma_f32_16x16x32_bf16 v[72:75], v[112:115], v[40:43], v[72:75]
  v_mfma_f32_16x16x32_bf16 v[88:91], v[116:119], v[40:43], v[88:91]
  buffer_load_dwordx4 v[104:107], v8, s[16:19], s38 offen sc1
  v_mfma_f32_16x16x32_bf16 v[60:63], v[108:111], v[44:47], v[60:63]
  v_mfma_f32_16x16x32_bf16 v[76:79], v[112:115], v[44:47], v[76:79]
  v_mfma_f32_16x16x32_bf16 v[92:95], v[116:119], v[44:47], v[92:95]
  v_add_u32 v5, s43, v5
  s_add_u32 s37, s37, 1
  s_cmp_eq_u32 s37, 16
  s_cbranch_scc1 F2_GDONE
  s_lshl_b32 s40, s37, 1
  s_add_u32 s40, s40, 5
  s_lshl_b32 s38, s40, 11
  s_add_u32 s38, s38, s39
  s_cmp_lt_u32 s40, 32
  s_cselect_b32 s38, s38, 0x80000000
  s_waitcnt vmcnt(12) lgkmcnt(0)
  v_mfma_f32_16x16x32_bf16 v[48:51], v[120:123], v[16:19], v[48:51]
  ds_read_b128 v[32:35], v5 offset:0
  v_mfma_f32_16x16x32_bf16 v[64:67], v[124:127], v[16:19], v[64:67]
  ds_read_b128 v[36:39], v5 offset:4096
  v_mfma_f32_16x16x32_bf16 v[80:83], v[128:131], v[16:19], v[80:83]
  ds_read_b128 v[40:43], v5 offset:8192
  v_mfma_f32_16x16x32_bf16 v[52:55], v[120:123], v[20:23], v[52:55]
  ds_read_b128 v[44:47], v5 offset:12288
  v_mfma_f32_16x16x32_bf16 v[68:71], v[124:127], v[20:23], v[68:71]
  buffer_load_dwordx4 v[108:111], v6, s[16:19], s38 offen sc1
  v_mfma_f32_16x16x32_bf16 v[84:87], v[128:131], v[20:23], v[84:87]
  v_mfma_f32_16x16x32_bf16 v[56:59], v[120:123], v[24:27], v[56:59]
  buffer_load_dwordx4 v[112:115], v7, s[16:19], s38 offen sc1
  v_mfma_f32_16x16x32_bf16 v[72:75], v[124:127], v[24:27], v[72:75]
  v_mfma_f32_16x16x32_bf16 v[88:91], v[128:131], v[24:27], v[88:91]
  buffer_load_dwordx4 v[116:119], v8, s[16:19], s38 offen sc1
  v_mfma_f32_16x16x32_bf16 v[60:63], v[120:123], v[28:31], v[60:63]
  v_mfma_f32_16x16x32_bf16 v[76:79], v[124:127], v[28:31], v[76:79]
  v_mfma_f32_16x16x32_bf16 v[92:95], v[128:131], v[28:31], v[92:95]
  s_and_b32 s40, s37, 3
  s_movk_i32 s43, 16384
  s_cmp_eq_u32 s40, 3
  s_cselect_b32 s43, 4294918144, s43
  s_lshl_b32 s40, s37, 1
  s_add_u32 s40, s40, 6
  s_lshl_b32 s38, s40, 11
  s_add_u32 s38, s38, s39
  s_cmp_lt_u32 s40, 32
  s_cselect_b32 s38, s38, 0x80000000
  s_waitcnt lgkmcnt(0)
  s_barrier
  v_add_u32 v4, s43, v4
  s_waitcnt vmcnt(12)
  v_mfma_f32_16x16x32_bf16 v[48:51], v[132:135], v[32:35], v[48:51]
  ds_read_b128 v[16:19], v4 offset:0
  v_mfma_f32_16x16x32_bf16 v[64:67], v[136:139], v[32:35], v[64:67]
  ds_read_b128 v[20:23], v4 offset:4096
  v_mfma_f32_16x16x32_bf16 v[80:83], v[140:143], v[32:35], v[80:83]
  ds_read_b128 v[24:27], v4 offset:8192
  v_mfma_f32_16x16x32_bf16 v[52:55], v[132:135], v[36:39], v[52:55]
  ds_read_b128 v[28:31], v4 offset:12288
  v_mfma_f32_16x16x32_bf16 v[68:71], v[136:139], v[36:39], v[68:71]
  buffer_load_dwordx4 v[120:123], v6, s[16:19], s38 offen sc1
  v_mfma_f32_16x16x32_bf16 v[84:87], v[140:143], v[36:39], v[84:87]
  v_mfma_f32_16x16x32_bf16 v[56:59], v[132:135], v[40:43], v[56:59]
  buffer_load_dwordx4 v[124:127], v7, s[16:19], s38 offen sc1
  v_mfma_f32_16x16x32_bf16 v[72:75], v[136:139], v[40:43], v[72:75]
  v_mfma_f32_16x16x32_bf16 v[88:91], v[140:143], v[40:43], v[88:91]
  buffer_load_dwordx4 v[128:131], v8, s[16:19], s38 offen sc1
  v_mfma_f32_16x16x32_bf16 v[60:63], v[132:135], v[44:47], v[60:63]
  v_mfma_f32_16x16x32_bf16 v[76:79], v[136:139], v[44:47], v[76:79]
  v_mfma_f32_16x16x32_bf16 v[92:95], v[140:143], v[44:47], v[92:95]
  v_add_u32 v5, s43, v5
  s_add_u32 s37, s37, 1
  s_cmp_eq_u32 s37, 16
  s_cbranch_scc1 F2_GDONE
  s_lshl_b32 s40, s37, 1
  s_add_u32 s40, s40, 5
  s_lshl_b32 s38, s40, 11
  s_add_u32 s38, s38, s39
  s_cmp_lt_u32 s40, 32
  s_cselect_b32 s38, s38, 0x80000000
  s_waitcnt vmcnt(12) lgkmcnt(0)
  v_mfma_f32_16x16x32_bf16 v[48:51], v[144:147], v[16:19], v[48:51]
  ds_read_b128 v[32:35], v5 offset:0
  v_mfma_f32_16x16x32_bf16 v[64:67], v[148:151], v[16:19], v[64:67]
  ds_read_b128 v[36:39], v5 offset:4096
  v_mfma_f32_16x16x32_bf16 v[80:83], v[152:155], v[16:19], v[80:83]
  ds_read_b128 v[40:43], v5 offset:8192
  v_mfma_f32_16x16x32_bf16 v[52:55], v[144:147], v[20:23], v[52:55]
  ds_read_b128 v[44:47], v5 offset:12288
  v_mfma_f32_16x16x32_bf16 v[68:71], v[148:151], v[20:23], v[68:71]
  buffer_load_dwordx4 v[132:135], v6, s[16:19], s38 offen sc1
  v_mfma_f32_16x16x32_bf16 v[84:87], v[152:155], v[20:23], v[84:87]
  v_mfma_f32_16x16x32_bf16 v[56:59], v[144:147], v[24:27], v[56:59]
  buffer_load_dwordx4 v[136:139], v7, s[16:19], s38 offen sc1
  v_mfma_f32_16x16x32_bf16 v[72:75], v[148:151], v[24:27], v[72:75]
  v_mfma_f32_16x16x32_bf16 v[88:91], v[152:155], v[24:27], v[88:91]
  buffer_load_dwordx4 v[140:143], v8, s[16:19], s38 offen sc1
  v_mfma_f32_16x16x32_bf16 v[60:63], v[144:147], v[28:31], v[60:63]
  v_mfma_f32_16x16x32_bf16 v[76:79], v[148:151], v[28:31], v[76:79]
  v_mfma_f32_16x16x32_bf16 v[92:95], v[152:155], v[28:31], v[92:95]
  s_and_b32 s40, s37, 3
  s_movk_i32 s43, 16384
  s_cmp_eq_u32 s40, 3
  s_cselect_b32 s43, 4294918144, s43
  s_lshl_b32 s40, s37, 1
  s_add_u32 s40, s40, 6
  s_lshl_b32 s38, s40, 11
  s_add_u32 s38, s38, s39
  s_cmp_lt_u32 s40, 32
  s_cselect_b32 s38, s38, 0x80000000
  s_waitcnt lgkmcnt(0)
  s_barrier
  v_add_u32 v4, s43, v4
  s_waitcnt vmcnt(12)
  v_mfma_f32_16x16x32_bf16 v[48:51], v[156:159], v[32:35], v[48:51]
  ds_read_b128 v[16:19], v4 offset:0
  v_mfma_f32_16x16x32_bf16 v[64:67], v[160:163], v[32:35], v[64:67]
  ds_read_b128 v[20:23], v4 offset:4096
  v_mfma_f32_16x16x32_bf16 v[80:83], v[164:167], v[32:35], v[80:83]
  ds_read_b128 v[24:27], v4 offset:8192
  v_mfma_f32_16x16x32_bf16 v[52:55], v[156:159], v[36:39], v[52:55]
  ds_read_b128 v[28:31], v4 offset:12288
  v_mfma_f32_16x16x32_bf16 v[68:71], v[160:163], v[36:39], v[68:71]
  buffer_load_dwordx4 v[144:147], v6, s[16:19], s38 offen sc1
  v_mfma_f32_16x16x32_bf16 v[84:87], v[164:167], v[36:39], v[84:87]
  v_mfma_f32_16x16x32_bf16 v[56:59], v[156:159], v[40:43], v[56:59]
  buffer_load_dwordx4 v[148:151], v7, s[16:19], s38 offen sc1
  v_mfma_f32_16x16x32_bf16 v[72:75], v[160:163], v[40:43], v[72:75]
  v_mfma_f32_16x16x32_bf16 v[88:91], v[164:167], v[40:43], v[88:91]
  buffer_load_dwordx4 v[152:155], v8, s[16:19], s38 offen sc1
  v_mfma_f32_16x16x32_bf16 v[60:63], v[156:159], v[44:47], v[60:63]
  v_mfma_f32_16x16x32_bf16 v[76:79], v[160:163], v[44:47], v[76:79]
  v_mfma_f32_16x16x32_bf16 v[92:95], v[164:167], v[44:47], v[92:95]
  v_add_u32 v5, s43, v5
  s_add_u32 s37, s37, 1
  s_cmp_eq_u32 s37, 16
  s_cbranch_scc0 F2_GLOOP
F2_GDONE:
  s_lshl_b32 s40, s32, 2
  s_add_u32 s45, s40, s34
  v_lshlrev_b32 v10, 1, v3
  s_lshl_b32 s40, s45, 5
  buffer_load_ushort v15, v10, s[12:15], s40 offen
  s_mul_i32 s40, s34, 3072
  v_lshlrev_b32 v9, 4, v1
  v_add_u32 v10, s40, v9
  ds_write_b128 v10, v[48:51] offset:0
  ds_write_b128 v10, v[64:67] offset:1024
  ds_write_b128 v10, v[80:83] offset:2048
  ds_write_b128 v10, v[52:55] offset:12288
  ds_write_b128 v10, v[68:71] offset:13312
  ds_write_b128 v10, v[84:87] offset:14336
  s_waitcnt lgkmcnt(6)
  ds_write_b128 v10, v[56:59] offset:24576
  ds_write_b128 v10, v[72:75] offset:25600
  ds_write_b128 v10, v[88:91] offset:26624
  ds_write_b128 v10, v[60:63] offset:36864
  ds_write_b128 v10, v[76:79] offset:37888
  ds_write_b128 v10, v[92:95] offset:38912
  s_waitcnt lgkmcnt(6)
  s_waitcnt lgkmcnt(0)
  s_barrier
  s_mul_i32 s40, s34, 12288
  v_add_u32 v10, s40, v9
  ds_read_b128 v[16:19], v10 offset:0
  ds_read_b128 v[20:23], v10 offset:1024
  ds_read_b128 v[24:27], v10 offset:2048
  ds_read_b128 v[28:31], v10 offset:3072
  ds_read_b128 v[32:35], v10 offset:4096
  ds_read_b128 v[36:39], v10 offset:5120
  ds_read_b128 v[40:43], v10 offset:6144
  ds_read_b128 v[44:47], v10 offset:7168
  ds_read_b128 v[48:51], v10 offset:8192
  s_waitcnt lgkmcnt(6)
  ds_read_b128 v[52:55], v10 offset:9216
  ds_read_b128 v[56:59], v10 offset:10240
  ds_read_b128 v[60:63], v10 offset:11264
  s_mul_i32 s40, s34, 3072
  s_add_u32 s40, s40, 147456
  v_lshlrev_b32 v11, 3, v1
  v_add_u32 v11, s40, v11
  s_waitcnt lgkmcnt(6)
  ds_read_b64 v[64:65], v11 offset:0
  ds_read_b64 v[66:67], v11 offset:512
  ds_read_b64 v[68:69], v11 offset:1024
  ds_read_b64 v[70:71], v11 offset:1536
  ds_read_b64 v[72:73], v11 offset:2048
  ds_read_b64 v[74:75], v11 offset:2560
  s_barrier
  s_waitcnt vmcnt(0)
  v_lshlrev_b32 v92, 16, v15
  s_mul_i32 s40, s45, 24576
  s_mul_i32 s41, s33, 3072
  s_add_u32 s40, s40, s41
  s_add_u32 s40, s40, 12582912
  s_waitcnt lgkmcnt(0)
  v_pk_add_f32 v[16:17], v[16:17], v[40:41]
  v_pk_add_f32 v[18:19], v[18:19], v[42:43]
  v_lshlrev_b32 v88, 16, v64
  v_and_b32 v89, s47, v64
  v_lshlrev_b32 v90, 16, v65
  v_and_b32 v91, s47, v65
  v_pk_add_f32 v[16:17], v[16:17], v[92:93] op_sel_hi:[1,0]
  v_pk_add_f32 v[18:19], v[18:19], v[92:93] op_sel_hi:[1,0]
  v_pk_mul_f32 v[16:17], v[16:17], v[88:89]
  v_pk_mul_f32 v[18:19], v[18:19], v[90:91]
  v_cvt_pk_bf16_f32 v76, v16, v17
  v_cvt_pk_bf16_f32 v77, v18, v19
  v_pk_add_f32 v[20:21], v[20:21], v[44:45]
  v_pk_add_f32 v[22:23], v[22:23], v[46:47]
  v_lshlrev_b32 v88, 16, v66
  v_and_b32 v89, s47, v66
  v_lshlrev_b32 v90, 16, v67
  v_and_b32 v91, s47, v67
  v_pk_add_f32 v[20:21], v[20:21], v[92:93] op_sel_hi:[1,0]
  v_pk_add_f32 v[22:23], v[22:23], v[92:93] op_sel_hi:[1,0]
  v_pk_mul_f32 v[20:21], v[20:21], v[88:89]
  v_pk_mul_f32 v[22:23], v[22:23], v[90:91]
  v_cvt_pk_bf16_f32 v78, v20, v21
  v_cvt_pk_bf16_f32 v79, v22, v23
  buffer_store_dwordx4 v[76:79], v9, s[16:19], s40 offen offset:0 sc1
  v_pk_add_f32 v[24:25], v[24:25], v[48:49]
  v_pk_add_f32 v[26:27], v[26:27], v[50:51]
  v_lshlrev_b32 v88, 16, v68
  v_and_b32 v89, s47, v68
  v_lshlrev_b32 v90, 16, v69
  v_and_b32 v91, s47, v69
  v_pk_add_f32 v[24:25], v[24:25], v[92:93] op_sel_hi:[1,0]
  v_pk_add_f32 v[26:27], v[26:27], v[92:93] op_sel_hi:[1,0]
  v_pk_mul_f32 v[24:25], v[24:25], v[88:89]
  v_pk_mul_f32 v[26:27], v[26:27], v[90:91]
  v_cvt_pk_bf16_f32 v80, v24, v25
  v_cvt_pk_bf16_f32 v81, v26, v27
  v_pk_add_f32 v[28:29], v[28:29], v[52:53]
  v_pk_add_f32 v[30:31], v[30:31], v[54:55]
  v_lshlrev_b32 v88, 16, v70
  v_and_b32 v89, s47, v70
  v_lshlrev_b32 v90, 16, v71
  v_and_b32 v91, s47, v71
  v_pk_add_f32 v[28:29], v[28:29], v[92:93] op_sel_hi:[1,0]
  v_pk_add_f32 v[30:31], v[30:31], v[92:93] op_sel_hi:[1,0]
  v_pk_mul_f32 v[28:29], v[28:29], v[88:89]
  v_pk_mul_f32 v[30:31], v[30:31], v[90:91]
  v_cvt_pk_bf16_f32 v82, v28, v29
  v_cvt_pk_bf16_f32 v83, v30, v31
  buffer_store_dwordx4 v[80:83], v9, s[16:19], s40 offen offset:1024 sc1
  v_pk_add_f32 v[32:33], v[32:33], v[56:57]
  v_pk_add_f32 v[34:35], v[34:35], v[58:59]
  v_lshlrev_b32 v88, 16, v72
  v_and_b32 v89, s47, v72
  v_lshlrev_b32 v90, 16, v73
  v_and_b32 v91, s47, v73
  v_pk_add_f32 v[32:33], v[32:33], v[92:93] op_sel_hi:[1,0]
  v_pk_add_f32 v[34:35], v[34:35], v[92:93] op_sel_hi:[1,0]
  v_pk_mul_f32 v[32:33], v[32:33], v[88:89]
  v_pk_mul_f32 v[34:35], v[34:35], v[90:91]
  v_cvt_pk_bf16_f32 v84, v32, v33
  v_cvt_pk_bf16_f32 v85, v34, v35
  v_pk_add_f32 v[36:37], v[36:37], v[60:61]
  v_pk_add_f32 v[38:39], v[38:39], v[62:63]
  v_lshlrev_b32 v88, 16, v74
  v_and_b32 v89, s47, v74
  v_lshlrev_b32 v90, 16, v75
  v_and_b32 v91, s47, v75
  v_pk_add_f32 v[36:37], v[36:37], v[92:93] op_sel_hi:[1,0]
  v_pk_add_f32 v[38:39], v[38:39], v[92:93] op_sel_hi:[1,0]
  v_pk_mul_f32 v[36:37], v[36:37], v[88:89]
  v_pk_mul_f32 v[38:39], v[38:39], v[90:91]
  v_cvt_pk_bf16_f32 v86, v36, v37
  v_cvt_pk_bf16_f32 v87, v38, v39
  buffer_store_dwordx4 v[84:87], v9, s[16:19], s40 offen offset:2048 sc1
  s_waitcnt vmcnt(0)
  s_barrier
  s_load_dwordx2 s[56:57], s[0:1], 0
  s_load_dwordx2 s[58:59], s[0:1], 88
  v_lshlrev_b32 v4, 4, v1
  s_lshl_b32 s35, s32, 2
  s_add_u32 s35, s35, s55
  s_lshr_b32 s39, s34, 2
  s_mul_i32 s36, s35, 24576
  s_mul_i32 s40, s39, 12288
  s_add_u32 s36, s36, s40
  s_add_u32 s36, s36, 12582912
  s_mul_i32 s40, s39, 61440
  v_add_u32 v26, s40, v4
  s_lshl_b32 s40, s35, 4
  s_mul_i32 s40, s40, 1280
  s_mul_i32 s41, s33, 160
  s_add_u32 s40, s40, s41
  v_add_u32 v12, 0, v1
  v_mul_u32_u24 v13, 6554, v12
  v_lshrrev_b32 v13, 16, v13
  v_mul_u32_u24 v14, 10, v13
  v_sub_u32 v14, v12, v14
  v_lshlrev_b32 v14, 4, v14
  v_mul_u32_u24 v13, 1280, v13
  v_add_u32 v13, v13, v14
  v_add_u32 v5, s40, v13
  v_add_u32 v12, 64, v1
  v_mul_u32_u24 v13, 6554, v12
  v_lshrrev_b32 v13, 16, v13
  v_mul_u32_u24 v14, 10, v13
  v_sub_u32 v14, v12, v14
  v_lshlrev_b32 v14, 4, v14
  v_mul_u32_u24 v13, 1280, v13
  v_add_u32 v13, v13, v14
  v_add_u32 v6, s40, v13
  v_add_u32 v12, 128, v1
  v_mul_u32_u24 v13, 6554, v12
  v_lshrrev_b32 v13, 16, v13
  v_mul_u32_u24 v14, 10, v13
  v_sub_u32 v14, v12, v14
  v_lshlrev_b32 v14, 4, v14
  v_mul_u32_u24 v13, 1280, v13
  v_add_u32 v13, v13, v14
  v_add_u32 v7, s40, v13
  s_mul_i32 s37, s55, 2560
  s_mul_i32 s38, s33, 327680
  s_lshl_b32 s41, s35, 5
  s_add_u32 s38, s38, s41
  s_add_u32 s38, s38, 9437184
  s_lshl_b32 s40, s55, 6
  s_add_u32 s40, s40, 143360
  v_lshlrev_b32 v21, 2, v3
  v_add_u32 v21, s40, v21
  ds_read_b32 v24, v21
  ds_read_b32 v25, v21 offset:256
  v_mov_b32 v68, 0
  v_mov_b32 v69, 0
  v_mov_b32 v70, 0
  v_mov_b32 v71, 0
  v_mov_b32 v72, 0
  v_mov_b32 v73, 0
  v_mov_b32 v74, 0
  v_mov_b32 v75, 0
  v_mov_b32 v76, 0
  v_mov_b32 v77, 0
  v_mov_b32 v78, 0
  v_mov_b32 v79, 0
  v_mov_b32 v80, 0
  v_mov_b32 v81, 0
  v_mov_b32 v82, 0
  v_mov_b32 v83, 0
  v_mov_b32 v84, 0
  v_mov_b32 v85, 0
  v_mov_b32 v86, 0
  v_mov_b32 v87, 0
  s_waitcnt lgkmcnt(0)
  s_mov_b32 s8, s56
  s_and_b32 s9, s57, 0xffff
  s_mov_b32 s10, 2621440
  s_mov_b32 s11, 0x20000
  s_mov_b32 s12, s58
  s_and_b32 s13, s59, 0xffff
  s_mov_b32 s14, 2621440
  s_mov_b32 s15, 0x20000
  s_add_u32 m0, s37, 122880
  s_nop 0
  buffer_load_dwordx4 v5, s[8:11], 0 offen lds
  s_add_u32 m0, s37, 123904
  s_nop 0
  buffer_load_dwordx4 v6, s[8:11], 0 offen lds
  s_mov_b32 exec_hi, 0
  s_add_u32 m0, s37, 124928
  s_nop 0
  buffer_load_dwordx4 v7, s[8:11], 0 offen lds
  s_mov_b32 exec_hi, -1
  s_barrier
  s_add_u32 s40, s36, 0
  buffer_load_dwordx4 v[88:91], v4, s[16:19], s40 offen offset:0 sc1
  s_add_u32 s40, s36, 0
  buffer_load_dwordx4 v[92:95], v4, s[16:19], s40 offen offset:1024 sc1
  s_add_u32 s40, s36, 0
  buffer_load_dwordx4 v[96:99], v4, s[16:19], s40 offen offset:2048 sc1
  s_add_u32 s40, s36, 0
  buffer_load_dwordx4 v[100:103], v4, s[16:19], s40 offen offset:3072 sc1
  s_add_u32 s40, s36, 4096
  buffer_load_dwordx4 v[104:107], v4, s[16:19], s40 offen offset:0 sc1
  s_barrier
  ds_read_b128 v[28:31], v26 offset:0
  ds_read_b128 v[32:35], v26 offset:1024
  ds_read_b128 v[36:39], v26 offset:2048
  ds_read_b128 v[40:43], v26 offset:3072
  ds_read_b128 v[44:47], v26 offset:4096
  s_waitcnt vmcnt(4) lgkmcnt(0)
  v_mfma_f32_16x16x32_bf16 v[68:71], v[28:31], v[88:91], v[68:71]
  ds_read_b128 v[48:51], v26 offset:5120
  v_mfma_f32_16x16x32_bf16 v[72:75], v[32:35], v[88:91], v[72:75]
  ds_read_b128 v[52:55], v26 offset:6144
  v_mfma_f32_16x16x32_bf16 v[76:79], v[36:39], v[88:91], v[76:79]
  ds_read_b128 v[56:59], v26 offset:7168
  s_add_u32 s40, s36, 4096
  buffer_load_dwordx4 v[108:111], v4, s[16:19], s40 offen offset:1024 sc1
  v_mfma_f32_16x16x32_bf16 v[80:83], v[40:43], v[88:91], v[80:83]
  ds_read_b128 v[60:63], v26 offset:8192
  v_mfma_f32_16x16x32_bf16 v[84:87], v[44:47], v[88:91], v[84:87]
  ds_read_b128 v[64:67], v26 offset:9216
  s_waitcnt vmcnt(4) lgkmcnt(0)
  v_mfma_f32_16x16x32_bf16 v[68:71], v[48:51], v[92:95], v[68:71]
  ds_read_b128 v[28:31], v26 offset:10240
  v_mfma_f32_16x16x32_bf16 v[72:75], v[52:55], v[92:95], v[72:75]
  ds_read_b128 v[32:35], v26 offset:11264
  v_mfma_f32_16x16x32_bf16 v[76:79], v[56:59], v[92:95], v[76:79]
  ds_read_b128 v[36:39], v26 offset:12288
  s_add_u32 s40, s36, 4096
  buffer_load_dwordx4 v[112:115], v4, s[16:19], s40 offen offset:2048 sc1
  v_mfma_f32_16x16x32_bf16 v[80:83], v[60:63], v[92:95], v[80:83]
  ds_read_b128 v[40:43], v26 offset:13312
  v_mfma_f32_16x16x32_bf16 v[84:87], v[64:67], v[92:95], v[84:87]
  ds_read_b128 v[44:47], v26 offset:14336
  s_waitcnt vmcnt(4) lgkmcnt(0)
  v_mfma_f32_16x16x32_bf16 v[68:71], v[28:31], v[96:99], v[68:71]
  ds_read_b128 v[48:51], v26 offset:15360
  v_mfma_f32_16x16x32_bf16 v[72:75], v[32:35], v[96:99], v[72:75]
  ds_read_b128 v[52:55], v26 offset:16384
  v_mfma_f32_16x16x32_bf16 v[76:79], v[36:39], v[96:99], v[76:79]
  ds_read_b128 v[56:59], v26 offset:17408
  s_add_u32 s40, s36, 4096
  buffer_load_dwordx4 v[116:119], v4, s[16:19], s40 offen offset:3072 sc1
  v_mfma_f32_16x16x32_bf16 v[80:83], v[40:43], v[96:99], v[80:83]
  ds_read_b128 v[60:63], v26 offset:18432
  v_mfma_f32_16x16x32_bf16 v[84:87], v[44:47], v[96:99], v[84:87]
  ds_read_b128 v[64:67], v26 offset:19456
  s_waitcnt vmcnt(4) lgkmcnt(0)
  s_barrier
  v_mfma_f32_16x16x32_bf16 v[68:71], v[48:51], v[100:103], v[68:71]
  ds_read_b128 v[28:31], v26 offset:20480
  v_mfma_f32_16x16x32_bf16 v[72:75], v[52:55], v[100:103], v[72:75]
  ds_read_b128 v[32:35], v26 offset:21504
  v_mfma_f32_16x16x32_bf16 v[76:79], v[56:59], v[100:103], v[76:79]
  ds_read_b128 v[36:39], v26 offset:22528
  s_add_u32 s40, s36, 8192
  buffer_load_dwordx4 v[120:123], v4, s[16:19], s40 offen offset:0 sc1
  v_mfma_f32_16x16x32_bf16 v[80:83], v[60:63], v[100:103], v[80:83]
  ds_read_b128 v[40:43], v26 offset:23552
  v_mfma_f32_16x16x32_bf16 v[84:87], v[64:67], v[100:103], v[84:87]
  ds_read_b128 v[44:47], v26 offset:24576
  s_waitcnt vmcnt(4) lgkmcnt(0)
  v_mfma_f32_16x16x32_bf16 v[68:71], v[28:31], v[104:107], v[68:71]
  ds_read_b128 v[48:51], v26 offset:25600
  v_mfma_f32_16x16x32_bf16 v[72:75], v[32:35], v[104:107], v[72:75]
  ds_read_b128 v[52:55], v26 offset:26624
  v_mfma_f32_16x16x32_bf16 v[76:79], v[36:39], v[104:107], v[76:79]
  ds_read_b128 v[56:59], v26 offset:27648
  s_add_u32 s40, s36, 8192
  buffer_load_dwordx4 v[124:127], v4, s[16:19], s40 offen offset:1024 sc1
  v_mfma_f32_16x16x32_bf16 v[80:83], v[40:43], v[104:107], v[80:83]
  ds_read_b128 v[60:63], v26 offset:28672
  v_mfma_f32_16x16x32_bf16 v[84:87], v[44:47], v[104:107], v[84:87]
  ds_read_b128 v[64:67], v26 offset:29696
  s_waitcnt vmcnt(4) lgkmcnt(0)
  v_mfma_f32_16x16x32_bf16 v[68:71], v[48:51], v[108:111], v[68:71]
  ds_read_b128 v[28:31], v26 offset:30720
  v_mfma_f32_16x16x32_bf16 v[72:75], v[52:55], v[108:111], v[72:75]
  ds_read_b128 v[32:35], v26 offset:31744
  v_mfma_f32_16x16x32_bf16 v[76:79], v[56:59], v[108:111], v[76:79]
  ds_read_b128 v[36:39], v26 offset:32768
  s_add_u32 s40, s36, 8192
  buffer_load_dwordx4 v[128:131], v4, s[16:19], s40 offen offset:2048 sc1
  v_mfma_f32_16x16x32_bf16 v[80:83], v[60:63], v[108:111], v[80:83]
  ds_read_b128 v[40:43], v26 offset:33792
  v_mfma_f32_16x16x32_bf16 v[84:87], v[64:67], v[108:111], v[84:87]
  ds_read_b128 v[44:47], v26 offset:34816
  s_waitcnt vmcnt(4) lgkmcnt(0)
  v_mfma_f32_16x16x32_bf16 v[68:71], v[28:31], v[112:115], v[68:71]
  ds_read_b128 v[48:51], v26 offset:35840
  v_mfma_f32_16x16x32_bf16 v[72:75], v[32:35], v[112:115], v[72:75]
  ds_read_b128 v[52:55], v26 offset:36864
  v_mfma_f32_16x16x32_bf16 v[76:79], v[36:39], v[112:115], v[76:79]
  ds_read_b128 v[56:59], v26 offset:37888
  s_add_u32 s40, s36, 8192
  buffer_load_dwordx4 v[132:135], v4, s[16:19], s40 offen offset:3072 sc1
  v_mfma_f32_16x16x32_bf16 v[80:83], v[40:43], v[112:115], v[80:83]
  ds_read_b128 v[60:63], v26 offset:38912
  v_mfma_f32_16x16x32_bf16 v[84:87], v[44:47], v[112:115], v[84:87]
  ds_read_b128 v[64:67], v26 offset:39936
  s_waitcnt vmcnt(4) lgkmcnt(0)
  s_barrier
  v_mfma_f32_16x16x32_bf16 v[68:71], v[48:51], v[116:119], v[68:71]
  ds_read_b128 v[28:31], v26 offset:40960
  v_mfma_f32_16x16x32_bf16 v[72:75], v[52:55], v[116:119], v[72:75]
  ds_read_b128 v[32:35], v26 offset:41984
  v_mfma_f32_16x16x32_bf16 v[76:79], v[56:59], v[116:119], v[76:79]
  ds_read_b128 v[36:39], v26 offset:43008
  v_mfma_f32_16x16x32_bf16 v[80:83], v[60:63], v[116:119], v[80:83]
  ds_read_b128 v[40:43], v26 offset:44032
  v_mfma_f32_16x16x32_bf16 v[84:87], v[64:67], v[116:119], v[84:87]
  ds_read_b128 v[44:47], v26 offset:45056
  s_waitcnt vmcnt(3) lgkmcnt(0)
  v_mfma_f32_16x16x32_bf16 v[68:71], v[28:31], v[120:123], v[68:71]
  ds_read_b128 v[48:51], v26 offset:46080
  v_mfma_f32_16x16x32_bf16 v[72:75], v[32:35], v[120:123], v[72:75]
  ds_read_b128 v[52:55], v26 offset:47104
  v_mfma_f32_16x16x32_bf16 v[76:79], v[36:39], v[120:123], v[76:79]
  ds_read_b128 v[56:59], v26 offset:48128
  v_mfma_f32_16x16x32_bf16 v[80:83], v[40:43], v[120:123], v[80:83]
  ds_read_b128 v[60:63], v26 offset:49152
  v_mfma_f32_16x16x32_bf16 v[84:87], v[44:47], v[120:123], v[84:87]
  ds_read_b128 v[64:67], v26 offset:50176
  s_waitcnt vmcnt(2) lgkmcnt(0)
  v_mfma_f32_16x16x32_bf16 v[68:71], v[48:51], v[124:127], v[68:71]
  ds_read_b128 v[28:31], v26 offset:51200
  v_mfma_f32_16x16x32_bf16 v[72:75], v[52:55], v[124:127], v[72:75]
  ds_read_b128 v[32:35], v26 offset:52224
  v_mfma_f32_16x16x32_bf16 v[76:79], v[56:59], v[124:127], v[76:79]
  ds_read_b128 v[36:39], v26 offset:53248
  v_mfma_f32_16x16x32_bf16 v[80:83], v[60:63], v[124:127], v[80:83]
  ds_read_b128 v[40:43], v26 offset:54272
  v_mfma_f32_16x16x32_bf16 v[84:87], v[64:67], v[124:127], v[84:87]
  ds_read_b128 v[44:47], v26 offset:55296
  s_waitcnt vmcnt(1) lgkmcnt(0)
  v_mfma_f32_16x16x32_bf16 v[68:71], v[28:31], v[128:131], v[68:71]
  ds_read_b128 v[48:51], v26 offset:56320
  v_mfma_f32_16x16x32_bf16 v[72:75], v[32:35], v[128:131], v[72:75]
  ds_read_b128 v[52:55], v26 offset:57344
  v_mfma_f32_16x16x32_bf16 v[76:79], v[36:39], v[128:131], v[76:79]
  ds_read_b128 v[56:59], v26 offset:58368
  v_mfma_f32_16x16x32_bf16 v[80:83], v[40:43], v[128:131], v[80:83]
  ds_read_b128 v[60:63], v26 offset:59392
  v_mfma_f32_16x16x32_bf16 v[84:87], v[44:47], v[128:131], v[84:87]
  ds_read_b128 v[64:67], v26 offset:60416
  s_waitcnt vmcnt(0) lgkmcnt(0)
  v_mfma_f32_16x16x32_bf16 v[68:71], v[48:51], v[132:135], v[68:71]
  v_mfma_f32_16x16x32_bf16 v[72:75], v[52:55], v[132:135], v[72:75]
  v_mfma_f32_16x16x32_bf16 v[76:79], v[56:59], v[132:135], v[76:79]
  v_mfma_f32_16x16x32_bf16 v[80:83], v[60:63], v[132:135], v[80:83]
  v_mfma_f32_16x16x32_bf16 v[84:87], v[64:67], v[132:135], v[84:87]
  s_mul_i32 s40, s55, 5120
  v_add_u32 v12, s40, v4
  s_nop 4
  ds_write_b128 v12, v[80:83] offset:3072
  ds_write_b128 v12, v[84:87] offset:4096
  v_mul_u32_u24 v13, 160, v3
  v_lshlrev_b32 v14, 3, v2
  v_add_u32 v13, v13, v14
  s_add_u32 s40, s37, 122880
  v_add_u32 v13, s40, v13
  v_lshlrev_b32 v14, 7, v2
  v_lshlrev_b32 v15, 3, v3
  v_add_u32 v14, v14, v15
  s_add_u32 s40, s37, 133120
  v_add_u32 v14, s40, v14
  v_sub_f32 v16, 0, v24
  v_mov_b32 v18, v25
  s_mov_b32 s48, 1.0
  s_mov_b32 s49, 1.0
  v_mov_b32 v20, 0xbfb8aa3b
  v_mov_b32 v21, 0xbfb8aa3b
  s_waitcnt vmcnt(0) lgkmcnt(0)
  s_barrier
  ds_read_b64 v[88:89], v13 offset:0
  ds_read_b64_tr_b16 v[98:99], v14 offset:0
  ds_read_b64 v[90:91], v13 offset:32
  ds_read_b64_tr_b16 v[100:101], v14 offset:512
  ds_read_b64 v[92:93], v13 offset:64
  ds_read_b64_tr_b16 v[102:103], v14 offset:1024
  ds_read_b128 v[108:111], v12 offset:0
  ds_read_b128 v[112:115], v12 offset:1024
  ds_read_b128 v[116:119], v12 offset:2048
  s_waitcnt lgkmcnt(0)
  v_pk_add_f32 v[68:69], v[68:69], v[108:109]
  v_lshlrev_b32 v28, 16, v88
  v_and_b32 v29, s47, v88
  v_pk_mul_f32 v[32:33], v[68:69], v[20:21]
  v_lshlrev_b32 v30, 16, v98
  v_and_b32 v31, s47, v98
  v_exp_f32 v32, v32
  v_exp_f32 v33, v33
  v_pk_add_f32 v[34:35], v[28:29], v[16:17] op_sel_hi:[1,0]
  v_pk_add_f32 v[32:33], v[32:33], s[48:49]
  v_pk_mul_f32 v[34:35], v[34:35], v[18:19] op_sel_hi:[1,0]
  v_rcp_f32 v32, v32
  v_rcp_f32 v33, v33
  v_pk_mul_f32 v[34:35], v[34:35], v[30:31]
  v_pk_mul_f32 v[32:33], v[32:33], v[68:69]
  v_pk_fma_f32 v[34:35], v[34:35], v[32:33], v[28:29]
  v_cvt_pk_bf16_f32 v88, v34, v35
  v_pk_add_f32 v[70:71], v[70:71], v[110:111]
  v_lshlrev_b32 v36, 16, v89
  v_and_b32 v37, s47, v89
  v_pk_mul_f32 v[40:41], v[70:71], v[20:21]
  v_lshlrev_b32 v38, 16, v99
  v_and_b32 v39, s47, v99
  v_exp_f32 v40, v40
  v_exp_f32 v41, v41
  v_pk_add_f32 v[42:43], v[36:37], v[16:17] op_sel_hi:[1,0]
  v_pk_add_f32 v[40:41], v[40:41], s[48:49]
  v_pk_mul_f32 v[42:43], v[42:43], v[18:19] op_sel_hi:[1,0]
  v_rcp_f32 v40, v40
  v_rcp_f32 v41, v41
  v_pk_mul_f32 v[42:43], v[42:43], v[38:39]
  v_pk_mul_f32 v[40:41], v[40:41], v[70:71]
  v_pk_fma_f32 v[42:43], v[42:43], v[40:41], v[36:37]
  v_cvt_pk_bf16_f32 v89, v42, v43
  ds_write_b64 v13, v[88:89] offset:0
  v_pk_add_f32 v[72:73], v[72:73], v[112:113]
  v_lshlrev_b32 v28, 16, v90
  v_and_b32 v29, s47, v90
  v_pk_mul_f32 v[32:33], v[72:73], v[20:21]
  v_lshlrev_b32 v30, 16, v100
  v_and_b32 v31, s47, v100
  v_exp_f32 v32, v32
  v_exp_f32 v33, v33
  v_pk_add_f32 v[34:35], v[28:29], v[16:17] op_sel_hi:[1,0]
  v_pk_add_f32 v[32:33], v[32:33], s[48:49]
  v_pk_mul_f32 v[34:35], v[34:35], v[18:19] op_sel_hi:[1,0]
  v_rcp_f32 v32, v32
  v_rcp_f32 v33, v33
  v_pk_mul_f32 v[34:35], v[34:35], v[30:31]
  v_pk_mul_f32 v[32:33], v[32:33], v[72:73]
  v_pk_fma_f32 v[34:35], v[34:35], v[32:33], v[28:29]
  v_cvt_pk_bf16_f32 v90, v34, v35
  v_pk_add_f32 v[74:75], v[74:75], v[114:115]
  v_lshlrev_b32 v36, 16, v91
  v_and_b32 v37, s47, v91
  v_pk_mul_f32 v[40:41], v[74:75], v[20:21]
  v_lshlrev_b32 v38, 16, v101
  v_and_b32 v39, s47, v101
  v_exp_f32 v40, v40
  v_exp_f32 v41, v41
  v_pk_add_f32 v[42:43], v[36:37], v[16:17] op_sel_hi:[1,0]
  v_pk_add_f32 v[40:41], v[40:41], s[48:49]
  v_pk_mul_f32 v[42:43], v[42:43], v[18:19] op_sel_hi:[1,0]
  v_rcp_f32 v40, v40
  v_rcp_f32 v41, v41
  v_pk_mul_f32 v[42:43], v[42:43], v[38:39]
  v_pk_mul_f32 v[40:41], v[40:41], v[74:75]
  v_pk_fma_f32 v[42:43], v[42:43], v[40:41], v[36:37]
  v_cvt_pk_bf16_f32 v91, v42, v43
  ds_write_b64 v13, v[90:91] offset:32
  v_pk_add_f32 v[76:77], v[76:77], v[116:117]
  v_lshlrev_b32 v28, 16, v92
  v_and_b32 v29, s47, v92
  v_pk_mul_f32 v[32:33], v[76:77], v[20:21]
  v_lshlrev_b32 v30, 16, v102
  v_and_b32 v31, s47, v102
  v_exp_f32 v32, v32
  v_exp_f32 v33, v33
  v_pk_add_f32 v[34:35], v[28:29], v[16:17] op_sel_hi:[1,0]
  v_pk_add_f32 v[32:33], v[32:33], s[48:49]
  v_pk_mul_f32 v[34:35], v[34:35], v[18:19] op_sel_hi:[1,0]
  v_rcp_f32 v32, v32
  v_rcp_f32 v33, v33
  v_pk_mul_f32 v[34:35], v[34:35], v[30:31]
  v_pk_mul_f32 v[32:33], v[32:33], v[76:77]
  v_pk_fma_f32 v[34:35], v[34:35], v[32:33], v[28:29]
  v_cvt_pk_bf16_f32 v92, v34, v35
  v_pk_add_f32 v[78:79], v[78:79], v[118:119]
  v_lshlrev_b32 v36, 16, v93
  v_and_b32 v37, s47, v93
  v_pk_mul_f32 v[40:41], v[78:79], v[20:21]
  v_lshlrev_b32 v38, 16, v103
  v_and_b32 v39, s47, v103
  v_exp_f32 v40, v40
  v_exp_f32 v41, v41
  v_pk_add_f32 v[42:43], v[36:37], v[16:17] op_sel_hi:[1,0]
  v_pk_add_f32 v[40:41], v[40:41], s[48:49]
  v_pk_mul_f32 v[42:43], v[42:43], v[18:19] op_sel_hi:[1,0]
  v_rcp_f32 v40, v40
  v_rcp_f32 v41, v41
  v_pk_mul_f32 v[42:43], v[42:43], v[38:39]
  v_pk_mul_f32 v[40:41], v[40:41], v[78:79]
  v_pk_fma_f32 v[42:43], v[42:43], v[40:41], v[36:37]
  v_cvt_pk_bf16_f32 v93, v42, v43
  ds_write_b64 v13, v[92:93] offset:64
  s_waitcnt lgkmcnt(0)
  s_barrier
  s_add_u32 s40, s37, 122880
  v_add_u32 v13, s40, v4
  ds_read_b128 v[108:111], v13 offset:0
  ds_read_b128 v[112:115], v13 offset:1024
  s_waitcnt lgkmcnt(0)
  buffer_store_dwordx4 v[108:111], v5, s[12:15], 0 offen
  buffer_store_dwordx4 v[112:115], v6, s[12:15], 0 offen
  s_mov_b64 exec, s[52:53]
  s_endpgm
K1_B:
  s_cmp_eq_u32 s34, 4
  s_cbranch_scc0 K1_NORST
  s_lshl_b32 s40, s32, 3
  s_add_u32 s40, s40, s33
  s_lshl_b32 s40, s40, 9
  s_add_u32 s40, s40, 16842752
  v_lshlrev_b32 v15, 3, v1
  v_mov_b32 v20, 0
  v_mov_b32 v21, 0xbf800000
  buffer_store_dwordx2 v[20:21], v15, s[16:19], s40 offen sc1
  s_lshl_b32 s40, s33, 7
  s_lshl_b32 s41, s32, 2
  s_add_u32 s40, s40, s41
  s_add_u32 s41, s40, 17040384
  s_add_u32 s40, s40, 17039360
  v_mov_b32 v15, s40
  v_mov_b32 v16, s41
  v_cmp_eq_u32 vcc, 1, v1
  s_nop 1
  v_cndmask_b32 v15, v15, v16, vcc
  s_lshl_b32 s40, s32, 5
  s_lshl_b32 s41, s33, 2
  s_add_u32 s40, s40, s41
  s_add_u32 s40, s40, 17041408
  v_mov_b32 v16, s40
  v_cmp_eq_u32 vcc, 2, v1
  s_nop 1
  v_cndmask_b32 v15, v15, v16, vcc
  s_lshl_b32 s40, s33, 7
  s_lshl_b32 s41, s32, 2
  s_add_u32 s40, s40, s41
  s_add_u32 s40, s40, 17042432
  v_mov_b32 v16, s40
  v_cmp_eq_u32 vcc, 3, v1
  s_nop 1
  v_cndmask_b32 v15, v15, v16, vcc
  s_mov_b32 exec_lo, 0xf
  s_mov_b32 exec_hi, 0x0
  buffer_store_dword v20, v15, s[16:19], 0 offen sc1
  s_mov_b64 exec, s[52:53]
K1_NORST:
  s_lshl_b32 s40, s2, 2
  s_add_u32 s40, s40, s55
  s_mul_i32 s41, s40, 2731
  s_lshr_b32 s41, s41, 16
  s_mul_i32 s42, s41, 24
  s_sub_u32 s42, s40, s42
  s_mov_b32 s72, s40
  v_mul_u32_u24 v17, 5120, v2
  v_lshlrev_b32 v18, 1, v3
  v_add_u32 v17, v17, v18
  s_lshl_b32 s41, s41, 5
  s_mul_i32 s42, s42, 40960
  s_add_u32 s41, s41, s42
  s_add_u32 s42, s41, 20480
  s_barrier
  s_mov_b32 s28, s66
  s_and_b32 s29, s67, 0xffff
  s_mov_b32 s30, 983040
  s_mov_b32 s31, 0x20000
  buffer_load_ushort v152, v17, s[28:31], s41 offen offset:0
  buffer_load_ushort v153, v17, s[28:31], s41 offen offset:1280
  buffer_load_ushort v154, v17, s[28:31], s41 offen offset:2560
  buffer_load_ushort v155, v17, s[28:31], s41 offen offset:3840
  buffer_load_ushort v156, v17, s[28:31], s42 offen offset:0
  buffer_load_ushort v157, v17, s[28:31], s42 offen offset:1280
  buffer_load_ushort v158, v17, s[28:31], s42 offen offset:2560
  buffer_load_ushort v159, v17, s[28:31], s42 offen offset:3840
  s_barrier
  s_barrier
  s_cmp_eq_u32 s34, 4
  s_cbranch_scc0 K1_NOCNT
  s_waitcnt vmcnt(8)
  s_lshl_b32 s39, s32, 2
  v_mov_b32 v20, s39
  v_mov_b32 v21, 1
  s_mov_b32 exec_lo, 0x1
  s_mov_b32 exec_hi, 0x0
  buffer_atomic_add v21, v20, s[4:7], 0 offen offset:0 sc1
  s_mov_b64 exec, s[52:53]
K1_NOCNT:
  s_barrier
  s_barrier
  s_barrier
  s_barrier
  s_barrier
  s_barrier
  v_lshlrev_b32 v144, 6, v1
  s_and_b32 s54, s2, 7
  s_lshl_b32 s54, s54, 8
  s_lshr_b32 s39, s2, 3
  s_lshl_b32 s39, s39, 3
  s_add_u32 s54, s54, s39
  s_lshl_b32 s54, s54, 12
  s_mov_b32 s20, s74
  s_and_b32 s21, s75, 0xffff
  s_mov_b32 s22, 8388608
  s_mov_b32 s23, 0x20000
  s_mov_b32 s46, 0
  s_cmp_ge_u32 s72, 960
  s_cbranch_scc1 K1_NOWOF
  s_waitcnt vmcnt(0)
  v_lshl_or_b32 v164, v153, 16, v152
  v_lshl_or_b32 v165, v155, 16, v154
  v_lshl_or_b32 v166, v157, 16, v156
  v_lshl_or_b32 v167, v159, 16, v158
  v_lshlrev_b32 v17, 4, v1
  s_lshl_b32 s40, s72, 10
  s_add_u32 s40, s40, 15728640
  buffer_store_dwordx4 v[164:167], v17, s[16:19], s40 offen sc1
K1_NOWOF:
  s_barrier
  v_mov_b32 v102, 0x3f803f80
  v_mov_b32 v103, 0x3f803f80
  v_mov_b32 v104, 0x3f803f80
  v_mov_b32 v105, 0x3f803f80
  v_mov_b32 v66, 0
  v_mov_b32 v67, 0
  v_mov_b32 v68, 0
  v_mov_b32 v69, 0
  v_mov_b32 v70, 0
  v_mov_b32 v71, 0
  v_mov_b32 v72, 0
  v_mov_b32 v73, 0
  v_mov_b32 v74, 0
  v_mov_b32 v75, 0
  v_mov_b32 v76, 0
  v_mov_b32 v77, 0
  v_mov_b32 v78, 0
  v_mov_b32 v79, 0
  v_mov_b32 v80, 0
  v_mov_b32 v81, 0
  v_mov_b32 v82, 0
  v_mov_b32 v83, 0
  v_mov_b32 v84, 0
  v_mov_b32 v85, 0
  v_mov_b32 v86, 0
  v_mov_b32 v87, 0
  v_mov_b32 v88, 0
  v_mov_b32 v89, 0
  v_mov_b32 v90, 0
  v_mov_b32 v91, 0
  v_mov_b32 v92, 0
  v_mov_b32 v93, 0
  v_mov_b32 v94, 0
  v_mov_b32 v95, 0
  v_mov_b32 v96, 0
  v_mov_b32 v97, 0
  v_mov_b32 v98, 0
  v_mov_b32 v99, 0
  v_mov_b32 v100, 0
  v_mov_b32 v101, 0
  v_mov_b32 v106, 0
  v_mov_b32 v107, 0
  v_mov_b32 v108, 0
  v_mov_b32 v109, 0
  v_mov_b32 v110, 0
  v_mov_b32 v111, 0
  v_mov_b32 v112, 0
  v_mov_b32 v113, 0
  s_barrier
  s_mov_b32 s37, 0
  ds_read_b128 v[26:29], v4 offset:0
  ds_read_b64_tr_b16 v[42:43], v8 offset:0
  ds_read_b64_tr_b16 v[44:45], v8 offset:768
  ds_read_b128 v[30:33], v6 offset:0
  ds_read_b64_tr_b16 v[46:47], v9 offset:0
  ds_read_b64_tr_b16 v[48:49], v9 offset:768
  ds_read_b64_tr_b16 v[50:51], v10 offset:0
  ds_read_b64_tr_b16 v[52:53], v10 offset:768
K1_LOOP2:
  s_waitcnt lgkmcnt(0)
  v_mfma_f32_16x16x32_bf16 v[66:69], v[42:45], v[26:29], v[66:69]
  ds_read_b128 v[34:37], v5 offset:0
  ds_read_b64_tr_b16 v[54:55], v8 offset:6144
  v_mfma_f32_16x16x32_bf16 v[78:81], v[42:45], v[30:33], v[78:81]
  ds_read_b64_tr_b16 v[56:57], v8 offset:6912
  ds_read_b128 v[38:41], v7 offset:0
  v_mfma_f32_16x16x32_bf16 v[70:73], v[46:49], v[26:29], v[70:73]
  ds_read_b64_tr_b16 v[58:59], v9 offset:6144
  ds_read_b64_tr_b16 v[60:61], v9 offset:6912
  v_mfma_f32_16x16x32_bf16 v[82:85], v[46:49], v[30:33], v[82:85]
  ds_read_b64_tr_b16 v[62:63], v10 offset:6144
  ds_read_b64_tr_b16 v[64:65], v10 offset:6912
  v_mfma_f32_16x16x32_bf16 v[74:77], v[50:53], v[26:29], v[74:77]
  v_mfma_f32_16x16x32_bf16 v[86:89], v[50:53], v[30:33], v[86:89]
  s_cmp_eq_u32 s35, 0
  s_cbranch_scc0 K1_SK_2a0
  v_mfma_f32_16x16x32_bf16 v[90:93], v[42:45], v[102:105], v[90:93]
  v_mfma_f32_16x16x32_bf16 v[94:97], v[46:49], v[102:105], v[94:97]
  v_mfma_f32_16x16x32_bf16 v[98:101], v[50:53], v[102:105], v[98:101]
K1_SK_2a0:
  s_waitcnt lgkmcnt(0)
  s_barrier
  v_mfma_f32_16x16x32_bf16 v[66:69], v[54:57], v[34:37], v[66:69]
  ds_read_b128 v[26:29], v4 offset:8192
  ds_read_b64_tr_b16 v[42:43], v8 offset:12288
  v_mfma_f32_16x16x32_bf16 v[78:81], v[54:57], v[38:41], v[78:81]
  ds_read_b64_tr_b16 v[44:45], v8 offset:13056
  ds_read_b128 v[30:33], v6 offset:8192
  v_mfma_f32_16x16x32_bf16 v[70:73], v[58:61], v[34:37], v[70:73]
  ds_read_b64_tr_b16 v[46:47], v9 offset:12288
  ds_read_b64_tr_b16 v[48:49], v9 offset:13056
  v_mfma_f32_16x16x32_bf16 v[82:85], v[58:61], v[38:41], v[82:85]
  ds_read_b64_tr_b16 v[50:51], v10 offset:12288
  ds_read_b64_tr_b16 v[52:53], v10 offset:13056
  v_mfma_f32_16x16x32_bf16 v[74:77], v[62:65], v[34:37], v[74:77]
  v_mfma_f32_16x16x32_bf16 v[86:89], v[62:65], v[38:41], v[86:89]
  s_cmp_eq_u32 s35, 1
  s_cbranch_scc0 K1_SK_2b0
  v_mfma_f32_16x16x32_bf16 v[90:93], v[54:57], v[102:105], v[90:93]
  v_mfma_f32_16x16x32_bf16 v[94:97], v[58:61], v[102:105], v[94:97]
  v_mfma_f32_16x16x32_bf16 v[98:101], v[62:65], v[102:105], v[98:101]
K1_SK_2b0:
  s_and_b32 s40, s46, 3
  s_cmp_eq_u32 s40, s55
  s_cbranch_scc0 K1_NT0
  s_cmp_lt_u32 s46, 8
  s_cbranch_scc0 K1_NT0
  buffer_load_dword v148, v144, s[20:23], s54 offen
K1_NT0:
  s_add_u32 s46, s46, 1
  s_add_u32 s54, s54, 4096
  s_waitcnt lgkmcnt(0)
  v_mfma_f32_16x16x32_bf16 v[66:69], v[42:45], v[26:29], v[66:69]
  ds_read_b128 v[34:37], v5 offset:8192
  ds_read_b64_tr_b16 v[54:55], v8 offset:18432
  v_mfma_f32_16x16x32_bf16 v[78:81], v[42:45], v[30:33], v[78:81]
  ds_read_b64_tr_b16 v[56:57], v8 offset:19200
  ds_read_b128 v[38:41], v7 offset:8192
  v_mfma_f32_16x16x32_bf16 v[70:73], v[46:49], v[26:29], v[70:73]
  ds_read_b64_tr_b16 v[58:59], v9 offset:18432
  ds_read_b64_tr_b16 v[60:61], v9 offset:19200
  v_mfma_f32_16x16x32_bf16 v[82:85], v[46:49], v[30:33], v[82:85]
  ds_read_b64_tr_b16 v[62:63], v10 offset:18432
  ds_read_b64_tr_b16 v[64:65], v10 offset:19200
  v_mfma_f32_16x16x32_bf16 v[74:77], v[50:53], v[26:29], v[74:77]
  v_mfma_f32_16x16x32_bf16 v[86:89], v[50:53], v[30:33], v[86:89]
  s_cmp_eq_u32 s35, 0
  s_cbranch_scc0 K1_SK_2a1
  v_mfma_f32_16x16x32_bf16 v[90:93], v[42:45], v[102:105], v[90:93]
  v_mfma_f32_16x16x32_bf16 v[94:97], v[46:49], v[102:105], v[94:97]
  v_mfma_f32_16x16x32_bf16 v[98:101], v[50:53], v[102:105], v[98:101]
K1_SK_2a1:
  s_waitcnt lgkmcnt(0)
  s_barrier
  v_mfma_f32_16x16x32_bf16 v[66:69], v[54:57], v[34:37], v[66:69]
  ds_read_b128 v[26:29], v4 offset:16384
  ds_read_b64_tr_b16 v[42:43], v8 offset:24576
  v_mfma_f32_16x16x32_bf16 v[78:81], v[54:57], v[38:41], v[78:81]
  ds_read_b64_tr_b16 v[44:45], v8 offset:25344
  ds_read_b128 v[30:33], v6 offset:16384
  v_mfma_f32_16x16x32_bf16 v[70:73], v[58:61], v[34:37], v[70:73]
  ds_read_b64_tr_b16 v[46:47], v9 offset:24576
  ds_read_b64_tr_b16 v[48:49], v9 offset:25344
  v_mfma_f32_16x16x32_bf16 v[82:85], v[58:61], v[38:41], v[82:85]
  ds_read_b64_tr_b16 v[50:51], v10 offset:24576
  ds_read_b64_tr_b16 v[52:53], v10 offset:25344
  v_mfma_f32_16x16x32_bf16 v[74:77], v[62:65], v[34:37], v[74:77]
  v_mfma_f32_16x16x32_bf16 v[86:89], v[62:65], v[38:41], v[86:89]
  s_cmp_eq_u32 s35, 1
  s_cbranch_scc0 K1_SK_2b1
  v_mfma_f32_16x16x32_bf16 v[90:93], v[54:57], v[102:105], v[90:93]
  v_mfma_f32_16x16x32_bf16 v[94:97], v[58:61], v[102:105], v[94:97]
  v_mfma_f32_16x16x32_bf16 v[98:101], v[62:65], v[102:105], v[98:101]
K1_SK_2b1:
  s_and_b32 s40, s46, 3
  s_cmp_eq_u32 s40, s55
  s_cbranch_scc0 K1_NT1
  s_cmp_lt_u32 s46, 8
  s_cbranch_scc0 K1_NT1
  buffer_load_dword v148, v144, s[20:23], s54 offen
K1_NT1:
  s_add_u32 s46, s46, 1
  s_add_u32 s54, s54, 4096
  s_waitcnt lgkmcnt(0)
  v_mfma_f32_16x16x32_bf16 v[66:69], v[42:45], v[26:29], v[66:69]
  ds_read_b128 v[34:37], v5 offset:16384
  ds_read_b64_tr_b16 v[54:55], v8 offset:30720
  v_mfma_f32_16x16x32_bf16 v[78:81], v[42:45], v[30:33], v[78:81]
  ds_read_b64_tr_b16 v[56:57], v8 offset:31488
  ds_read_b128 v[38:41], v7 offset:16384
  v_mfma_f32_16x16x32_bf16 v[70:73], v[46:49], v[26:29], v[70:73]
  ds_read_b64_tr_b16 v[58:59], v9 offset:30720
  ds_read_b64_tr_b16 v[60:61], v9 offset:31488
  v_mfma_f32_16x16x32_bf16 v[82:85], v[46:49], v[30:33], v[82:85]
  ds_read_b64_tr_b16 v[62:63], v10 offset:30720
  ds_read_b64_tr_b16 v[64:65], v10 offset:31488
  v_mfma_f32_16x16x32_bf16 v[74:77], v[50:53], v[26:29], v[74:77]
  v_mfma_f32_16x16x32_bf16 v[86:89], v[50:53], v[30:33], v[86:89]
  s_cmp_eq_u32 s35, 0
  s_cbranch_scc0 K1_SK_2a2
  v_mfma_f32_16x16x32_bf16 v[90:93], v[42:45], v[102:105], v[90:93]
  v_mfma_f32_16x16x32_bf16 v[94:97], v[46:49], v[102:105], v[94:97]
  v_mfma_f32_16x16x32_bf16 v[98:101], v[50:53], v[102:105], v[98:101]
K1_SK_2a2:
  s_waitcnt lgkmcnt(0)
  s_barrier
  v_mfma_f32_16x16x32_bf16 v[66:69], v[54:57], v[34:37], v[66:69]
  ds_read_b128 v[26:29], v4 offset:24576
  ds_read_b64_tr_b16 v[42:43], v8 offset:36864
  v_mfma_f32_16x16x32_bf16 v[78:81], v[54:57], v[38:41], v[78:81]
  ds_read_b64_tr_b16 v[44:45], v8 offset:37632
  ds_read_b128 v[30:33], v6 offset:24576
  v_mfma_f32_16x16x32_bf16 v[70:73], v[58:61], v[34:37], v[70:73]
  ds_read_b64_tr_b16 v[46:47], v9 offset:36864
  ds_read_b64_tr_b16 v[48:49], v9 offset:37632
  v_mfma_f32_16x16x32_bf16 v[82:85], v[58:61], v[38:41], v[82:85]
  ds_read_b64_tr_b16 v[50:51], v10 offset:36864
  ds_read_b64_tr_b16 v[52:53], v10 offset:37632
  v_mfma_f32_16x16x32_bf16 v[74:77], v[62:65], v[34:37], v[74:77]
  v_mfma_f32_16x16x32_bf16 v[86:89], v[62:65], v[38:41], v[86:89]
  s_cmp_eq_u32 s35, 1
  s_cbranch_scc0 K1_SK_2b2
  v_mfma_f32_16x16x32_bf16 v[90:93], v[54:57], v[102:105], v[90:93]
  v_mfma_f32_16x16x32_bf16 v[94:97], v[58:61], v[102:105], v[94:97]
  v_mfma_f32_16x16x32_bf16 v[98:101], v[62:65], v[102:105], v[98:101]
K1_SK_2b2:
  s_and_b32 s40, s46, 3
  s_cmp_eq_u32 s40, s55
  s_cbranch_scc0 K1_NT2
  s_cmp_lt_u32 s46, 8
  s_cbranch_scc0 K1_NT2
  buffer_load_dword v148, v144, s[20:23], s54 offen
K1_NT2:
  s_add_u32 s46, s46, 1
  s_add_u32 s54, s54, 4096
  s_waitcnt lgkmcnt(0)
  v_mfma_f32_16x16x32_bf16 v[66:69], v[42:45], v[26:29], v[66:69]
  ds_read_b128 v[34:37], v5 offset:24576
  ds_read_b64_tr_b16 v[54:55], v8 offset:43008
  v_mfma_f32_16x16x32_bf16 v[78:81], v[42:45], v[30:33], v[78:81]
  ds_read_b64_tr_b16 v[56:57], v8 offset:43776
  ds_read_b128 v[38:41], v7 offset:24576
  v_mfma_f32_16x16x32_bf16 v[70:73], v[46:49], v[26:29], v[70:73]
  ds_read_b64_tr_b16 v[58:59], v9 offset:43008
  ds_read_b64_tr_b16 v[60:61], v9 offset:43776
  v_mfma_f32_16x16x32_bf16 v[82:85], v[46:49], v[30:33], v[82:85]
  ds_read_b64_tr_b16 v[62:63], v10 offset:43008
  ds_read_b64_tr_b16 v[64:65], v10 offset:43776
  v_mfma_f32_16x16x32_bf16 v[74:77], v[50:53], v[26:29], v[74:77]
  v_mfma_f32_16x16x32_bf16 v[86:89], v[50:53], v[30:33], v[86:89]
  s_cmp_eq_u32 s35, 0
  s_cbranch_scc0 K1_SK_2a3
  v_mfma_f32_16x16x32_bf16 v[90:93], v[42:45], v[102:105], v[90:93]
  v_mfma_f32_16x16x32_bf16 v[94:97], v[46:49], v[102:105], v[94:97]
  v_mfma_f32_16x16x32_bf16 v[98:101], v[50:53], v[102:105], v[98:101]
K1_SK_2a3:
  s_waitcnt lgkmcnt(0)
  s_barrier
  v_mfma_f32_16x16x32_bf16 v[66:69], v[54:57], v[34:37], v[66:69]
  ds_read_b128 v[26:29], v4 offset:32768
  ds_read_b64_tr_b16 v[42:43], v8 offset:49152
  v_mfma_f32_16x16x32_bf16 v[78:81], v[54:57], v[38:41], v[78:81]
  ds_read_b64_tr_b16 v[44:45], v8 offset:49920
  ds_read_b128 v[30:33], v6 offset:32768
  v_mfma_f32_16x16x32_bf16 v[70:73], v[58:61], v[34:37], v[70:73]
  ds_read_b64_tr_b16 v[46:47], v9 offset:49152
  ds_read_b64_tr_b16 v[48:49], v9 offset:49920
  v_mfma_f32_16x16x32_bf16 v[82:85], v[58:61], v[38:41], v[82:85]
  ds_read_b64_tr_b16 v[50:51], v10 offset:49152
  ds_read_b64_tr_b16 v[52:53], v10 offset:49920
  v_mfma_f32_16x16x32_bf16 v[74:77], v[62:65], v[34:37], v[74:77]
  v_mfma_f32_16x16x32_bf16 v[86:89], v[62:65], v[38:41], v[86:89]
  s_cmp_eq_u32 s35, 1
  s_cbranch_scc0 K1_SK_2b3
  v_mfma_f32_16x16x32_bf16 v[90:93], v[54:57], v[102:105], v[90:93]
  v_mfma_f32_16x16x32_bf16 v[94:97], v[58:61], v[102:105], v[94:97]
  v_mfma_f32_16x16x32_bf16 v[98:101], v[62:65], v[102:105], v[98:101]
K1_SK_2b3:
  s_and_b32 s40, s46, 3
  s_cmp_eq_u32 s40, s55
  s_cbranch_scc0 K1_NT3
  s_cmp_lt_u32 s46, 8
  s_cbranch_scc0 K1_NT3
  buffer_load_dword v148, v144, s[20:23], s54 offen
K1_NT3:
  s_add_u32 s46, s46, 1
  s_add_u32 s54, s54, 4096
  s_waitcnt lgkmcnt(0)
  v_mfma_f32_16x16x32_bf16 v[66:69], v[42:45], v[26:29], v[66:69]
  ds_read_b128 v[34:37], v5 offset:32768
  ds_read_b64_tr_b16 v[54:55], v8 offset:55296
  v_mfma_f32_16x16x32_bf16 v[78:81], v[42:45], v[30:33], v[78:81]
  ds_read_b64_tr_b16 v[56:57], v8 offset:56064
  ds_read_b128 v[38:41], v7 offset:32768
  v_mfma_f32_16x16x32_bf16 v[70:73], v[46:49], v[26:29], v[70:73]
  ds_read_b64_tr_b16 v[58:59], v9 offset:55296
  ds_read_b64_tr_b16 v[60:61], v9 offset:56064
  v_mfma_f32_16x16x32_bf16 v[82:85], v[46:49], v[30:33], v[82:85]
  ds_read_b64_tr_b16 v[62:63], v10 offset:55296
  ds_read_b64_tr_b16 v[64:65], v10 offset:56064
  v_mfma_f32_16x16x32_bf16 v[74:77], v[50:53], v[26:29], v[74:77]
  v_mfma_f32_16x16x32_bf16 v[86:89], v[50:53], v[30:33], v[86:89]
  s_cmp_eq_u32 s35, 0
  s_cbranch_scc0 K1_SK_2a4
  v_mfma_f32_16x16x32_bf16 v[90:93], v[42:45], v[102:105], v[90:93]
  v_mfma_f32_16x16x32_bf16 v[94:97], v[46:49], v[102:105], v[94:97]
  v_mfma_f32_16x16x32_bf16 v[98:101], v[50:53], v[102:105], v[98:101]
K1_SK_2a4:
  s_waitcnt lgkmcnt(0)
  s_barrier
  v_add_u32 v4, 40960, v4
  v_add_u32 v5, 40960, v5
  v_add_u32 v6, 40960, v6
  v_add_u32 v7, 40960, v7
  v_mfma_f32_16x16x32_bf16 v[66:69], v[54:57], v[34:37], v[66:69]
  ds_read_b128 v[26:29], v4 offset:0
  ds_read_b64_tr_b16 v[42:43], v8 offset:0
  v_mfma_f32_16x16x32_bf16 v[78:81], v[54:57], v[38:41], v[78:81]
  ds_read_b64_tr_b16 v[44:45], v8 offset:768
  ds_read_b128 v[30:33], v6 offset:0
  v_mfma_f32_16x16x32_bf16 v[70:73], v[58:61], v[34:37], v[70:73]
  ds_read_b64_tr_b16 v[46:47], v9 offset:0
  ds_read_b64_tr_b16 v[48:49], v9 offset:768
  v_mfma_f32_16x16x32_bf16 v[82:85], v[58:61], v[38:41], v[82:85]
  ds_read_b64_tr_b16 v[50:51], v10 offset:0
  ds_read_b64_tr_b16 v[52:53], v10 offset:768
  v_mfma_f32_16x16x32_bf16 v[74:77], v[62:65], v[34:37], v[74:77]
  v_mfma_f32_16x16x32_bf16 v[86:89], v[62:65], v[38:41], v[86:89]
  s_cmp_eq_u32 s35, 1
  s_cbranch_scc0 K1_SK_2b4
  v_mfma_f32_16x16x32_bf16 v[90:93], v[54:57], v[102:105], v[90:93]
  v_mfma_f32_16x16x32_bf16 v[94:97], v[58:61], v[102:105], v[94:97]
  v_mfma_f32_16x16x32_bf16 v[98:101], v[62:65], v[102:105], v[98:101]
K1_SK_2b4:
  s_and_b32 s40, s46, 3
  s_cmp_eq_u32 s40, s55
  s_cbranch_scc0 K1_NT4
  s_cmp_lt_u32 s46, 8
  s_cbranch_scc0 K1_NT4
  buffer_load_dword v148, v144, s[20:23], s54 offen
K1_NT4:
  s_add_u32 s46, s46, 1
  s_add_u32 s54, s54, 4096
  s_add_u32 s37, s37, 1
  s_cmp_lt_u32 s37, 2
  s_cbranch_scc1 K1_LOOP2
  s_mul_i32 s40, s55, 192
  s_add_u32 s40, s40, 144640
  v_lshlrev_b32 v18, 4, v2
  v_add_u32 v19, s40, v18
  s_mov_b32 exec_lo, 0x10001
  s_mov_b32 exec_hi, 0x10001
  ds_write_b128 v19, v[90:93] offset:0
  ds_write_b128 v19, v[94:97] offset:64
  ds_write_b128 v19, v[98:101] offset:128
  s_mov_b64 exec, s[52:53]
  v_mov_b32 v126, 0xc0135761
  v_mov_b32 v127, 0xc0135761
  s_waitcnt lgkmcnt(0)
  s_barrier
  s_load_dwordx4 s[64:67], s[0:1], 32
  s_sub_u32 s42, s34, 4
  s_mul_i32 s44, s33, 80
  s_mul_i32 s40, s32, 3
  s_lshl_b32 s41, s32, 1
  s_add_u32 s41, s41, 16
  s_cmp_lt_u32 s32, 16
  s_cselect_b32 s40, s40, s41
  s_cselect_b32 s41, 3, 2
  s_add_u32 s44, s44, s40
  s_add_u32 s44, s44, s42
  s_cmp_lt_u32 s42, s41
  s_cselect_b32 s45, 1, 0
  s_cmp_eq_u32 s34, 7
  s_cbranch_scc0 F2_NOCE
  v_lshlrev_b32 v166, 2, v1
  buffer_load_dword v167, v166, s[4:7], 0 offen offset:0 sc1
F2_NOCE:
  s_xor_b32 s41, s55, 2
  s_mul_i32 s41, s41, 192
  s_add_u32 s41, s41, 144640
  v_add_u32 v19, s41, v18
  ds_read_b128 v[26:29], v19 offset:0
  ds_read_b128 v[30:33], v19 offset:64
  ds_read_b128 v[34:37], v19 offset:128
  s_lshl_b32 s40, s35, 7
  s_lshl_b32 s41, s36, 6
  s_add_u32 s40, s40, s41
  s_add_u32 s40, s40, 143360
  v_lshlrev_b32 v20, 2, v3
  v_add_u32 v20, s40, v20
  v_xor_b32 v21, 64, v20
  ds_read_b32 v42, v20
  ds_read_b32 v44, v21
  ds_read_b32 v46, v20 offset:256
  ds_read_b32 v48, v21 offset:256
  s_lshl_b32 s40, s32, 2
  s_lshl_b32 s41, s35, 1
  s_add_u32 s40, s40, s41
  s_add_u32 s41, s40, s36
  s_xor_b32 s42, s41, 1
  s_mul_i32 s39, s33, 6
  s_mul_i32 s38, s36, 3
  s_add_u32 s39, s39, s38
  s_mul_i32 s41, s41, 48
  s_add_u32 s41, s41, s39
  s_lshl_b32 s41, s41, 9
  s_add_u32 s41, s41, 0
  s_mul_i32 s42, s42, 48
  s_add_u32 s42, s42, s39
  s_lshl_b32 s42, s42, 9
  s_add_u32 s42, s42, 0
  v_lshlrev_b32 v20, 3, v1
  s_lshl_b32 s38, s35, 1
  s_add_u32 s38, s38, s36
  s_mul_i32 s39, s38, 3072
  s_mul_i32 s40, s36, 1536
  s_add_u32 s39, s39, s40
  s_add_u32 s39, s39, 147456
  v_add_u32 v22, s39, v20
  s_xor_b32 s38, s38, 1
  s_mul_i32 s39, s38, 3072
  s_add_u32 s39, s39, s40
  s_add_u32 s39, s39, 147456
  v_add_u32 v23, s39, v20
  s_waitcnt lgkmcnt(0)
  v_add_f32 v26, v26, v90
  v_sub_f32 v26, 0, v26
  v_add_f32 v27, v27, v91
  v_sub_f32 v27, 0, v27
  v_add_f32 v28, v28, v92
  v_sub_f32 v28, 0, v28
  v_add_f32 v29, v29, v93
  v_sub_f32 v29, 0, v29
  v_add_f32 v30, v30, v94
  v_sub_f32 v30, 0, v30
  v_add_f32 v31, v31, v95
  v_sub_f32 v31, 0, v31
  v_add_f32 v32, v32, v96
  v_sub_f32 v32, 0, v32
  v_add_f32 v33, v33, v97
  v_sub_f32 v33, 0, v33
  v_add_f32 v34, v34, v98
  v_sub_f32 v34, 0, v34
  v_add_f32 v35, v35, v99
  v_sub_f32 v35, 0, v35
  v_add_f32 v36, v36, v100
  v_sub_f32 v36, 0, v36
  v_add_f32 v37, v37, v101
  v_sub_f32 v37, 0, v37
  v_pk_fma_f32 v[66:67], v[26:27], v[42:43], v[66:67] op_sel_hi:[1,0,1]
  v_pk_mul_f32 v[66:67], v[66:67], v[46:47] op_sel_hi:[1,0]
  v_pk_mul_f32 v[128:129], v[66:67], v[66:67]
  v_pk_fma_f32 v[128:129], v[128:129], s[48:49], v[126:127]
  v_pk_mul_f32 v[128:129], v[128:129], v[66:67]
  v_exp_f32 v128, v128
  v_exp_f32 v129, v129
  s_nop 0
  v_pk_add_f32 v[128:129], v[128:129], s[50:51]
  v_rcp_f32 v128, v128
  v_rcp_f32 v129, v129
  s_nop 0
  v_pk_mul_f32 v[128:129], v[128:129], v[66:67]
  v_cvt_pk_bf16_f32 v114, v128, v129
  v_pk_fma_f32 v[68:69], v[28:29], v[42:43], v[68:69] op_sel_hi:[1,0,1]
  v_pk_mul_f32 v[68:69], v[68:69], v[46:47] op_sel_hi:[1,0]
  v_pk_mul_f32 v[132:133], v[68:69], v[68:69]
  v_pk_fma_f32 v[132:133], v[132:133], s[48:49], v[126:127]
  v_pk_mul_f32 v[132:133], v[132:133], v[68:69]
  v_exp_f32 v132, v132
  v_exp_f32 v133, v133
  s_nop 0
  v_pk_add_f32 v[132:133], v[132:133], s[50:51]
  v_rcp_f32 v132, v132
  v_rcp_f32 v133, v133
  s_nop 0
  v_pk_mul_f32 v[132:133], v[132:133], v[68:69]
  v_cvt_pk_bf16_f32 v115, v132, v133
  ds_write_b64 v22, v[114:115] offset:0
  v_pk_fma_f32 v[70:71], v[30:31], v[42:43], v[70:71] op_sel_hi:[1,0,1]
  v_pk_mul_f32 v[70:71], v[70:71], v[46:47] op_sel_hi:[1,0]
  v_pk_mul_f32 v[128:129], v[70:71], v[70:71]
  v_pk_fma_f32 v[128:129], v[128:129], s[48:49], v[126:127]
  v_pk_mul_f32 v[128:129], v[128:129], v[70:71]
  v_exp_f32 v128, v128
  v_exp_f32 v129, v129
  s_nop 0
  v_pk_add_f32 v[128:129], v[128:129], s[50:51]
  v_rcp_f32 v128, v128
  v_rcp_f32 v129, v129
  s_nop 0
  v_pk_mul_f32 v[128:129], v[128:129], v[70:71]
  v_cvt_pk_bf16_f32 v116, v128, v129
  v_pk_fma_f32 v[72:73], v[32:33], v[42:43], v[72:73] op_sel_hi:[1,0,1]
  v_pk_mul_f32 v[72:73], v[72:73], v[46:47] op_sel_hi:[1,0]
  v_pk_mul_f32 v[132:133], v[72:73], v[72:73]
  v_pk_fma_f32 v[132:133], v[132:133], s[48:49], v[126:127]
  v_pk_mul_f32 v[132:133], v[132:133], v[72:73]
  v_exp_f32 v132, v132
  v_exp_f32 v133, v133
  s_nop 0
  v_pk_add_f32 v[132:133], v[132:133], s[50:51]
  v_rcp_f32 v132, v132
  v_rcp_f32 v133, v133
  s_nop 0
  v_pk_mul_f32 v[132:133], v[132:133], v[72:73]
  v_cvt_pk_bf16_f32 v117, v132, v133
  ds_write_b64 v22, v[116:117] offset:512
  v_pk_fma_f32 v[74:75], v[34:35], v[42:43], v[74:75] op_sel_hi:[1,0,1]
  v_pk_mul_f32 v[74:75], v[74:75], v[46:47] op_sel_hi:[1,0]
  v_pk_mul_f32 v[128:129], v[74:75], v[74:75]
  v_pk_fma_f32 v[128:129], v[128:129], s[48:49], v[126:127]
  v_pk_mul_f32 v[128:129], v[128:129], v[74:75]
  v_exp_f32 v128, v128
  v_exp_f32 v129, v129
  s_nop 0
  v_pk_add_f32 v[128:129], v[128:129], s[50:51]
  v_rcp_f32 v128, v128
  v_rcp_f32 v129, v129
  s_nop 0
  v_pk_mul_f32 v[128:129], v[128:129], v[74:75]
  v_cvt_pk_bf16_f32 v118, v128, v129
  v_pk_fma_f32 v[76:77], v[36:37], v[42:43], v[76:77] op_sel_hi:[1,0,1]
  v_pk_mul_f32 v[76:77], v[76:77], v[46:47] op_sel_hi:[1,0]
  v_pk_mul_f32 v[132:133], v[76:77], v[76:77]
  v_pk_fma_f32 v[132:133], v[132:133], s[48:49], v[126:127]
  v_pk_mul_f32 v[132:133], v[132:133], v[76:77]
  v_exp_f32 v132, v132
  v_exp_f32 v133, v133
  s_nop 0
  v_pk_add_f32 v[132:133], v[132:133], s[50:51]
  v_rcp_f32 v132, v132
  v_rcp_f32 v133, v133
  s_nop 0
  v_pk_mul_f32 v[132:133], v[132:133], v[76:77]
  v_cvt_pk_bf16_f32 v119, v132, v133
  ds_write_b64 v22, v[118:119] offset:1024
  v_pk_fma_f32 v[78:79], v[26:27], v[44:45], v[78:79] op_sel_hi:[1,0,1]
  v_pk_mul_f32 v[78:79], v[78:79], v[48:49] op_sel_hi:[1,0]
  v_pk_mul_f32 v[128:129], v[78:79], v[78:79]
  v_pk_fma_f32 v[128:129], v[128:129], s[48:49], v[126:127]
  v_pk_mul_f32 v[128:129], v[128:129], v[78:79]
  v_exp_f32 v128, v128
  v_exp_f32 v129, v129
  s_nop 0
  v_pk_add_f32 v[128:129], v[128:129], s[50:51]
  v_rcp_f32 v128, v128
  v_rcp_f32 v129, v129
  s_nop 0
  v_pk_mul_f32 v[128:129], v[128:129], v[78:79]
  v_cvt_pk_bf16_f32 v120, v128, v129
  v_pk_fma_f32 v[80:81], v[28:29], v[44:45], v[80:81] op_sel_hi:[1,0,1]
  v_pk_mul_f32 v[80:81], v[80:81], v[48:49] op_sel_hi:[1,0]
  v_pk_mul_f32 v[132:133], v[80:81], v[80:81]
  v_pk_fma_f32 v[132:133], v[132:133], s[48:49], v[126:127]
  v_pk_mul_f32 v[132:133], v[132:133], v[80:81]
  v_exp_f32 v132, v132
  v_exp_f32 v133, v133
  s_nop 0
  v_pk_add_f32 v[132:133], v[132:133], s[50:51]
  v_rcp_f32 v132, v132
  v_rcp_f32 v133, v133
  s_nop 0
  v_pk_mul_f32 v[132:133], v[132:133], v[80:81]
  v_cvt_pk_bf16_f32 v121, v132, v133
  ds_write_b64 v23, v[120:121] offset:0
  v_pk_fma_f32 v[82:83], v[30:31], v[44:45], v[82:83] op_sel_hi:[1,0,1]
  v_pk_mul_f32 v[82:83], v[82:83], v[48:49] op_sel_hi:[1,0]
  v_pk_mul_f32 v[128:129], v[82:83], v[82:83]
  v_pk_fma_f32 v[128:129], v[128:129], s[48:49], v[126:127]
  v_pk_mul_f32 v[128:129], v[128:129], v[82:83]
  v_exp_f32 v128, v128
  v_exp_f32 v129, v129
  s_nop 0
  v_pk_add_f32 v[128:129], v[128:129], s[50:51]
  v_rcp_f32 v128, v128
  v_rcp_f32 v129, v129
  s_nop 0
  v_pk_mul_f32 v[128:129], v[128:129], v[82:83]
  v_cvt_pk_bf16_f32 v122, v128, v129
  v_pk_fma_f32 v[84:85], v[32:33], v[44:45], v[84:85] op_sel_hi:[1,0,1]
  v_pk_mul_f32 v[84:85], v[84:85], v[48:49] op_sel_hi:[1,0]
  v_pk_mul_f32 v[132:133], v[84:85], v[84:85]
  v_pk_fma_f32 v[132:133], v[132:133], s[48:49], v[126:127]
  v_pk_mul_f32 v[132:133], v[132:133], v[84:85]
  v_exp_f32 v132, v132
  v_exp_f32 v133, v133
  s_nop 0
  v_pk_add_f32 v[132:133], v[132:133], s[50:51]
  v_rcp_f32 v132, v132
  v_rcp_f32 v133, v133
  s_nop 0
  v_pk_mul_f32 v[132:133], v[132:133], v[84:85]
  v_cvt_pk_bf16_f32 v123, v132, v133
  ds_write_b64 v23, v[122:123] offset:512
  v_pk_fma_f32 v[86:87], v[34:35], v[44:45], v[86:87] op_sel_hi:[1,0,1]
  v_pk_mul_f32 v[86:87], v[86:87], v[48:49] op_sel_hi:[1,0]
  v_pk_mul_f32 v[128:129], v[86:87], v[86:87]
  v_pk_fma_f32 v[128:129], v[128:129], s[48:49], v[126:127]
  v_pk_mul_f32 v[128:129], v[128:129], v[86:87]
  v_exp_f32 v128, v128
  v_exp_f32 v129, v129
  s_nop 0
  v_pk_add_f32 v[128:129], v[128:129], s[50:51]
  v_rcp_f32 v128, v128
  v_rcp_f32 v129, v129
  s_nop 0
  v_pk_mul_f32 v[128:129], v[128:129], v[86:87]
  v_cvt_pk_bf16_f32 v124, v128, v129
  v_pk_fma_f32 v[88:89], v[36:37], v[44:45], v[88:89] op_sel_hi:[1,0,1]
  v_pk_mul_f32 v[88:89], v[88:89], v[48:49] op_sel_hi:[1,0]
  v_pk_mul_f32 v[132:133], v[88:89], v[88:89]
  v_pk_fma_f32 v[132:133], v[132:133], s[48:49], v[126:127]
  v_pk_mul_f32 v[132:133], v[132:133], v[88:89]
  v_exp_f32 v132, v132
  v_exp_f32 v133, v133
  s_nop 0
  v_pk_add_f32 v[132:133], v[132:133], s[50:51]
  v_rcp_f32 v132, v132
  v_rcp_f32 v133, v133
  s_nop 0
  v_pk_mul_f32 v[132:133], v[132:133], v[88:89]
  v_cvt_pk_bf16_f32 v125, v132, v133
  ds_write_b64 v23, v[124:125] offset:1024
  s_cmp_eq_u32 s34, 7
  s_cbranch_scc0 F2_NOCNT
  s_waitcnt vmcnt(0)
  s_mov_b32 exec_lo, 0xffffffff
  s_mov_b32 exec_hi, 0x0
  v_cmp_gt_u32 vcc, 8, v167
  s_mov_b64 exec, s[52:53]
  s_cmp_eq_u64 vcc, 0
  s_cbranch_scc1 F2_NOCNT
  v_lshlrev_b32 v6, 2, v1
  s_mov_b32 s42, 0
  s_mov_b32 exec_lo, 0xffffffff
  s_mov_b32 exec_hi, 0x0
FP_CNT:
  buffer_load_dword v7, v6, s[4:7], 0 offen offset:0 sc1
  s_waitcnt vmcnt(0)
  v_cmp_gt_u32 vcc, 8, v7
  s_add_u32 s42, s42, 1
  s_cmp_eq_u64 vcc, 0
  s_cbranch_scc1 FP_CNT_OK
  s_cmp_lt_u32 s42, 2097152
  s_cbranch_scc0 FP_CNT_OK
  s_sleep 1
  s_branch FP_CNT
FP_CNT_OK:
  s_mov_b64 exec, s[52:53]
F2_NOCNT:
  s_waitcnt lgkmcnt(0)
  s_cmp_eq_u32 s34, 7
  s_cbranch_scc1 F2_SYNC
  s_cmp_eq_u32 s45, 0
  s_cbranch_scc1 F2_IDLE
  s_mov_b32 s35, s44
  s_sub_u32 s42, s34, 4
  s_mul_i32 s36, s42, 21248
  s_add_u32 s36, s36, 65536
  v_add_u32 v10, 1, v3
  v_and_b32 v10, 3, v10
  v_lshrrev_b32 v11, 1, v2
  v_and_b32 v12, 1, v2
  v_lshlrev_b32 v13, 4, v11
  v_add_u32 v13, v13, v3
  v_lshlrev_b32 v14, 3, v12
  v_sub_u32 v13, v13, v14
  v_add_u32 v13, 9, v13
  v_sub_u32 v13, v13, v10
  v_lshlrev_b32 v13, 1, v13
  v_mul_u32_u24 v10, 4160, v10
  v_add_u32 v13, v13, v10
  v_add_u32 v4, s36, v13
  v_sub_u32 v13, v3, v11
  v_lshlrev_b32 v13, 1, v13
  v_add_u32 v13, v13, v12
  v_lshlrev_b32 v13, 4, v13
  s_add_u32 s40, s36, 17152
  v_add_u32 v5, s40, v13
  s_waitcnt vmcnt(0)
  s_barrier
  s_sleep 3
  s_sub_u32 s42, s34, 4
  v_lshrrev_b32 v8, 3, v1
  s_lshl_b32 s40, s42, 3
  v_add_u32 v8, s40, v8
  v_and_b32 v9, 7, v1
  v_lshlrev_b32 v9, 4, v9
  v_mul_u32_u24 v10, 144, v8
  v_add_u32 v10, v10, v9
  v_add_u32 v10, 49152, v10
  v_lshlrev_b32 v8, 12, v8
  v_add_u32 v8, v8, v9
  ds_read_b128 v[16:19], v10 offset:0
  ds_read_b128 v[20:23], v10 offset:3456
  ds_read_b128 v[24:27], v10 offset:6912
  ds_read_b128 v[28:31], v10 offset:10368
  s_mul_i32 s40, s33, 327680
  s_lshl_b32 s41, s32, 7
  s_add_u32 s40, s40, s41
  s_add_u32 s40, s40, 6291456
  s_waitcnt lgkmcnt(0)
  buffer_store_dwordx4 v[16:19], v8, s[16:19], s40 offen sc1
  s_add_u32 s40, s40, 98304
  buffer_store_dwordx4 v[20:23], v8, s[16:19], s40 offen sc1
  s_add_u32 s40, s40, 98304
  buffer_store_dwordx4 v[24:27], v8, s[16:19], s40 offen sc1
  s_add_u32 s40, s40, 98304
  s_cmp_eq_u32 s42, 0
  s_cselect_b32 s40, s40, 0x80000000
  buffer_store_dwordx4 v[28:31], v8, s[16:19], s40 offen sc1
  s_add_u32 s40, s40, 98304
  s_waitcnt lgkmcnt(0)
  s_lshl_b32 s40, s44, 12
  s_add_u32 s20, s64, s40
  s_addc_u32 s21, s65, 0
  s_and_b32 s21, s21, 0xffff
  s_mov_b32 s22, 4096
  s_mov_b32 s23, 0x20000
  s_mov_b32 s24, s66
  s_and_b32 s25, s67, 0xffff
  s_mov_b32 s26, 1280
  s_mov_b32 s27, 0x20000
  v_lshlrev_b32 v167, 4, v1
  buffer_load_dwordx4 v[136:139], v167, s[20:23], 0 offen offset:0
  buffer_load_dwordx2 v[140:141], v167, s[20:23], 0 offen offset:16
  buffer_load_dwordx4 v[142:145], v167, s[20:23], 0 offen offset:1024
  buffer_load_dwordx2 v[146:147], v167, s[20:23], 0 offen offset:1040
  buffer_load_dwordx4 v[148:151], v167, s[20:23], 0 offen offset:2048
  buffer_load_dwordx2 v[152:153], v167, s[20:23], 0 offen offset:2064
  buffer_load_dwordx4 v[154:157], v167, s[20:23], 0 offen offset:3072
  buffer_load_dwordx2 v[158:159], v167, s[20:23], 0 offen offset:3088
  v_mov_b32 v167, 0
  buffer_load_dwordx2 v[164:165], v167, s[20:23], 0 offen
  s_lshl_b32 s40, s44, 1
  buffer_load_ushort v166, v167, s[24:27], s40 offen
  s_barrier
  s_waitcnt vmcnt(0)
  v_mov_b32 v46, v166
  v_mov_b32 v8, 0
  v_mov_b32 v9, 0
  v_lshlrev_b32 v10, 3, v1
  v_add_u32 v10, s36, v10
  ds_write_b64 v10, v[8:9] offset:16640
  v_lshlrev_b32 v10, 4, v1
  v_add_u32 v10, s36, v10
  v_alignbit_b32 v80, v137, v136, 16
  v_alignbit_b32 v81, v138, v137, 16
  v_alignbit_b32 v82, v139, v138, 16
  v_alignbit_b32 v83, v140, v139, 16
  v_mov_b32 v84, v137
  v_mov_b32 v85, v138
  v_mov_b32 v86, v139
  v_mov_b32 v87, v140
  v_mov_b32 v88, v81
  v_mov_b32 v89, v82
  v_mov_b32 v90, v83
  v_alignbit_b32 v91, v141, v140, 16
  ds_write_b128 v10, v[136:139] offset:32
  ds_write_b128 v10, v[80:83] offset:4192
  ds_write_b128 v10, v[84:87] offset:8352
  ds_write_b128 v10, v[88:91] offset:12512
  s_waitcnt lgkmcnt(4)
  v_alignbit_b32 v92, v143, v142, 16
  v_alignbit_b32 v93, v144, v143, 16
  v_alignbit_b32 v94, v145, v144, 16
  v_alignbit_b32 v95, v146, v145, 16
  v_mov_b32 v96, v143
  v_mov_b32 v97, v144
  v_mov_b32 v98, v145
  v_mov_b32 v99, v146
  v_mov_b32 v100, v93
  v_mov_b32 v101, v94
  v_mov_b32 v102, v95
  v_alignbit_b32 v103, v147, v146, 16
  ds_write_b128 v10, v[142:145] offset:1056
  ds_write_b128 v10, v[92:95] offset:5216
  ds_write_b128 v10, v[96:99] offset:9376
  ds_write_b128 v10, v[100:103] offset:13536
  s_waitcnt lgkmcnt(4)
  s_waitcnt vmcnt(0)
  s_barrier
  v_alignbit_b32 v104, v149, v148, 16
  v_alignbit_b32 v105, v150, v149, 16
  v_alignbit_b32 v106, v151, v150, 16
  v_alignbit_b32 v107, v152, v151, 16
  v_mov_b32 v108, v149
  v_mov_b32 v109, v150
  v_mov_b32 v110, v151
  v_mov_b32 v111, v152
  v_mov_b32 v112, v105
  v_mov_b32 v113, v106
  v_mov_b32 v114, v107
  v_alignbit_b32 v115, v153, v152, 16
  ds_write_b128 v10, v[148:151] offset:2080
  ds_write_b128 v10, v[104:107] offset:6240
  ds_write_b128 v10, v[108:111] offset:10400
  ds_write_b128 v10, v[112:115] offset:14560
  s_waitcnt lgkmcnt(4)
  s_barrier
  v_alignbit_b32 v116, v155, v154, 16
  v_alignbit_b32 v117, v156, v155, 16
  v_alignbit_b32 v118, v157, v156, 16
  v_alignbit_b32 v119, v158, v157, 16
  v_mov_b32 v120, v155
  v_mov_b32 v121, v156
  v_mov_b32 v122, v157
  v_mov_b32 v123, v158
  v_mov_b32 v124, v117
  v_mov_b32 v125, v118
  v_mov_b32 v126, v119
  v_alignbit_b32 v127, v159, v158, 16
  ds_write_b128 v10, v[154:157] offset:3104
  ds_write_b128 v10, v[116:119] offset:7264
  ds_write_b128 v10, v[120:123] offset:11424
  ds_write_b128 v10, v[124:127] offset:15584
  s_waitcnt lgkmcnt(4)
  v_mov_b32 v160, 0
  v_mov_b32 v161, 0
  v_mov_b32 v162, 0
  v_mov_b32 v163, 0
  v_cmp_eq_u32 vcc, 1, v1
  s_nop 1
  v_cndmask_b32 v164, 0, v164, vcc
  v_cndmask_b32 v165, 0, v165, vcc
  s_waitcnt lgkmcnt(0)
  s_mov_b32 exec_lo, 0x3
  s_mov_b32 exec_hi, 0x0
  v_alignbit_b32 v80, v161, v160, 16
  v_alignbit_b32 v81, v162, v161, 16
  v_alignbit_b32 v82, v163, v162, 16
  v_alignbit_b32 v83, v164, v163, 16
  v_mov_b32 v84, v161
  v_mov_b32 v85, v162
  v_mov_b32 v86, v163
  v_mov_b32 v87, v164
  v_mov_b32 v88, v81
  v_mov_b32 v89, v82
  v_mov_b32 v90, v83
  v_alignbit_b32 v91, v165, v164, 16
  ds_write_b128 v10, v[160:163] offset:0
  ds_write_b128 v10, v[80:83] offset:4160
  ds_write_b128 v10, v[84:87] offset:8320
  ds_write_b128 v10, v[88:91] offset:12480
  s_mov_b64 exec, s[52:53]
  v_lshlrev_b32 v46, 16, v46
  v_mov_b32 v48, 0
  v_mov_b32 v49, 0
  v_mov_b32 v50, 0
  v_mov_b32 v51, 0
  v_mov_b32 v52, 0
  v_mov_b32 v53, 0
  v_mov_b32 v54, 0
  v_mov_b32 v55, 0
  v_mov_b32 v56, 0
  v_mov_b32 v57, 0
  v_mov_b32 v58, 0
  v_mov_b32 v59, 0
  v_mov_b32 v60, 0
  v_mov_b32 v61, 0
  v_mov_b32 v62, 0
  v_mov_b32 v63, 0
  v_mov_b32 v64, 0
  v_mov_b32 v65, 0
  v_mov_b32 v66, 0
  v_mov_b32 v67, 0
  v_mov_b32 v68, 0
  v_mov_b32 v69, 0
  v_mov_b32 v70, 0
  v_mov_b32 v71, 0
  v_mov_b32 v72, 0
  v_mov_b32 v73, 0
  v_mov_b32 v74, 0
  v_mov_b32 v75, 0
  v_mov_b32 v76, 0
  v_mov_b32 v77, 0
  v_mov_b32 v78, 0
  v_mov_b32 v79, 0
  s_waitcnt vmcnt(0) lgkmcnt(0)
  s_barrier
  s_barrier
  s_barrier
  v_lshlrev_b32 v6, 4, v1
  s_lshl_b32 s40, s35, 12
  s_add_u32 s40, s40, 6291456
  s_add_u32 m0, s36, 17152
  s_add_u32 s41, s40, 0
  buffer_load_dwordx4 v6, s[16:19], s41 offen sc1 lds
  s_add_u32 m0, s36, 18176
  s_add_u32 s41, s40, 1024
  buffer_load_dwordx4 v6, s[16:19], s41 offen sc1 lds
  s_add_u32 m0, s36, 19200
  s_add_u32 s41, s40, 2048
  buffer_load_dwordx4 v6, s[16:19], s41 offen sc1 lds
  s_add_u32 m0, s36, 20224
  s_add_u32 s41, s40, 3072
  buffer_load_dwordx4 v6, s[16:19], s41 offen sc1 lds
  ds_read_b64 v[80:81], v4 offset:0
  ds_read_b64 v[82:83], v4 offset:8
  ds_read_b64 v[84:85], v4 offset:512
  ds_read_b64 v[86:87], v4 offset:520
  ds_read_b64 v[88:89], v4 offset:1024
  ds_read_b64 v[90:91], v4 offset:1032
  ds_read_b64 v[92:93], v4 offset:1536
  ds_read_b64 v[94:95], v4 offset:1544
  s_waitcnt lgkmcnt(6)
  ds_read_b64 v[96:97], v4 offset:2048
  ds_read_b64 v[98:99], v4 offset:2056
  ds_read_b64 v[100:101], v4 offset:2560
  ds_read_b64 v[102:103], v4 offset:2568
  ds_read_b64 v[104:105], v4 offset:3072
  ds_read_b64 v[106:107], v4 offset:3080
  ds_read_b64 v[108:109], v4 offset:3584
  ds_read_b64 v[110:111], v4 offset:3592
  s_waitcnt lgkmcnt(6)
  s_barrier
  s_waitcnt vmcnt(0)
  ds_read_b128 v[112:115], v5 offset:0
  ds_read_b128 v[116:119], v5 offset:512
  ds_read_b128 v[120:123], v5 offset:1024
  ds_read_b128 v[124:127], v5 offset:1536
  ds_read_b128 v[128:131], v5 offset:2048
  ds_read_b128 v[132:135], v5 offset:2560
  ds_read_b128 v[136:139], v5 offset:3072
  ds_read_b128 v[140:143], v5 offset:3584
  s_mov_b32 s37, 0
F2_CLOOP:
  v_add_u32 v4, 64, v4
  v_subrev_u32 v5, 64, v5
  s_waitcnt lgkmcnt(0)
  v_mfma_f32_16x16x32_bf16 v[48:51], v[80:83], v[112:115], v[48:51]
  v_mfma_f32_16x16x32_bf16 v[52:55], v[80:83], v[116:119], v[52:55]
  v_mfma_f32_16x16x32_bf16 v[56:59], v[80:83], v[120:123], v[56:59]
  v_mfma_f32_16x16x32_bf16 v[60:63], v[80:83], v[124:127], v[60:63]
  v_mfma_f32_16x16x32_bf16 v[64:67], v[80:83], v[128:131], v[64:67]
  v_mfma_f32_16x16x32_bf16 v[68:71], v[80:83], v[132:135], v[68:71]
  v_mfma_f32_16x16x32_bf16 v[72:75], v[80:83], v[136:139], v[72:75]
  v_mfma_f32_16x16x32_bf16 v[76:79], v[80:83], v[140:143], v[76:79]
  ds_read_b64 v[80:81], v4 offset:0
  ds_read_b64 v[82:83], v4 offset:8
  ds_read_b128 v[140:143], v5 offset:3584
  v_mfma_f32_16x16x32_bf16 v[52:55], v[84:87], v[112:115], v[52:55]
  v_mfma_f32_16x16x32_bf16 v[56:59], v[84:87], v[116:119], v[56:59]
  v_mfma_f32_16x16x32_bf16 v[60:63], v[84:87], v[120:123], v[60:63]
  v_mfma_f32_16x16x32_bf16 v[64:67], v[84:87], v[124:127], v[64:67]
  v_mfma_f32_16x16x32_bf16 v[68:71], v[84:87], v[128:131], v[68:71]
  v_mfma_f32_16x16x32_bf16 v[72:75], v[84:87], v[132:135], v[72:75]
  v_mfma_f32_16x16x32_bf16 v[76:79], v[84:87], v[136:139], v[76:79]
  ds_read_b64 v[84:85], v4 offset:512
  ds_read_b64 v[86:87], v4 offset:520
  ds_read_b128 v[136:139], v5 offset:3072
  v_mfma_f32_16x16x32_bf16 v[56:59], v[88:91], v[112:115], v[56:59]
  v_mfma_f32_16x16x32_bf16 v[60:63], v[88:91], v[116:119], v[60:63]
  v_mfma_f32_16x16x32_bf16 v[64:67], v[88:91], v[120:123], v[64:67]
  v_mfma_f32_16x16x32_bf16 v[68:71], v[88:91], v[124:127], v[68:71]
  v_mfma_f32_16x16x32_bf16 v[72:75], v[88:91], v[128:131], v[72:75]
  v_mfma_f32_16x16x32_bf16 v[76:79], v[88:91], v[132:135], v[76:79]
  ds_read_b64 v[88:89], v4 offset:1024
  ds_read_b64 v[90:91], v4 offset:1032
  ds_read_b128 v[132:135], v5 offset:2560
  v_mfma_f32_16x16x32_bf16 v[60:63], v[92:95], v[112:115], v[60:63]
  v_mfma_f32_16x16x32_bf16 v[64:67], v[92:95], v[116:119], v[64:67]
  v_mfma_f32_16x16x32_bf16 v[68:71], v[92:95], v[120:123], v[68:71]
  v_mfma_f32_16x16x32_bf16 v[72:75], v[92:95], v[124:127], v[72:75]
  v_mfma_f32_16x16x32_bf16 v[76:79], v[92:95], v[128:131], v[76:79]
  ds_read_b64 v[92:93], v4 offset:1536
  ds_read_b64 v[94:95], v4 offset:1544
  ds_read_b128 v[128:131], v5 offset:2048
  s_waitcnt lgkmcnt(6)
  s_barrier
  v_mfma_f32_16x16x32_bf16 v[64:67], v[96:99], v[112:115], v[64:67]
  v_mfma_f32_16x16x32_bf16 v[68:71], v[96:99], v[116:119], v[68:71]
  v_mfma_f32_16x16x32_bf16 v[72:75], v[96:99], v[120:123], v[72:75]
  v_mfma_f32_16x16x32_bf16 v[76:79], v[96:99], v[124:127], v[76:79]
  ds_read_b64 v[96:97], v4 offset:2048
  ds_read_b64 v[98:99], v4 offset:2056
  ds_read_b128 v[124:127], v5 offset:1536
  v_mfma_f32_16x16x32_bf16 v[68:71], v[100:103], v[112:115], v[68:71]
  v_mfma_f32_16x16x32_bf16 v[72:75], v[100:103], v[116:119], v[72:75]
  v_mfma_f32_16x16x32_bf16 v[76:79], v[100:103], v[120:123], v[76:79]
  ds_read_b64 v[100:101], v4 offset:2560
  ds_read_b64 v[102:103], v4 offset:2568
  ds_read_b128 v[120:123], v5 offset:1024
  v_mfma_f32_16x16x32_bf16 v[72:75], v[104:107], v[112:115], v[72:75]
  v_mfma_f32_16x16x32_bf16 v[76:79], v[104:107], v[116:119], v[76:79]
  ds_read_b64 v[104:105], v4 offset:3072
  ds_read_b64 v[106:107], v4 offset:3080
  ds_read_b128 v[116:119], v5 offset:512
  s_waitcnt lgkmcnt(6)
  v_mfma_f32_16x16x32_bf16 v[76:79], v[108:111], v[112:115], v[76:79]
  ds_read_b64 v[108:109], v4 offset:3584
  ds_read_b64 v[110:111], v4 offset:3592
  ds_read_b128 v[112:115], v5 offset:0
  v_add_u32 v4, 64, v4
  v_subrev_u32 v5, 64, v5
  s_waitcnt lgkmcnt(0)
  v_mfma_f32_16x16x32_bf16 v[48:51], v[80:83], v[112:115], v[48:51]
  v_mfma_f32_16x16x32_bf16 v[52:55], v[80:83], v[116:119], v[52:55]
  v_mfma_f32_16x16x32_bf16 v[56:59], v[80:83], v[120:123], v[56:59]
  v_mfma_f32_16x16x32_bf16 v[60:63], v[80:83], v[124:127], v[60:63]
  v_mfma_f32_16x16x32_bf16 v[64:67], v[80:83], v[128:131], v[64:67]
  v_mfma_f32_16x16x32_bf16 v[68:71], v[80:83], v[132:135], v[68:71]
  v_mfma_f32_16x16x32_bf16 v[72:75], v[80:83], v[136:139], v[72:75]
  v_mfma_f32_16x16x32_bf16 v[76:79], v[80:83], v[140:143], v[76:79]
  ds_read_b64 v[80:81], v4 offset:0
  ds_read_b64 v[82:83], v4 offset:8
  ds_read_b128 v[140:143], v5 offset:3584
  v_mfma_f32_16x16x32_bf16 v[52:55], v[84:87], v[112:115], v[52:55]
  v_mfma_f32_16x16x32_bf16 v[56:59], v[84:87], v[116:119], v[56:59]
  v_mfma_f32_16x16x32_bf16 v[60:63], v[84:87], v[120:123], v[60:63]
  v_mfma_f32_16x16x32_bf16 v[64:67], v[84:87], v[124:127], v[64:67]
  v_mfma_f32_16x16x32_bf16 v[68:71], v[84:87], v[128:131], v[68:71]
  v_mfma_f32_16x16x32_bf16 v[72:75], v[84:87], v[132:135], v[72:75]
  v_mfma_f32_16x16x32_bf16 v[76:79], v[84:87], v[136:139], v[76:79]
  ds_read_b64 v[84:85], v4 offset:512
  ds_read_b64 v[86:87], v4 offset:520
  ds_read_b128 v[136:139], v5 offset:3072
  s_barrier
  v_mfma_f32_16x16x32_bf16 v[56:59], v[88:91], v[112:115], v[56:59]
  v_mfma_f32_16x16x32_bf16 v[60:63], v[88:91], v[116:119], v[60:63]
  v_mfma_f32_16x16x32_bf16 v[64:67], v[88:91], v[120:123], v[64:67]
  v_mfma_f32_16x16x32_bf16 v[68:71], v[88:91], v[124:127], v[68:71]
  v_mfma_f32_16x16x32_bf16 v[72:75], v[88:91], v[128:131], v[72:75]
  v_mfma_f32_16x16x32_bf16 v[76:79], v[88:91], v[132:135], v[76:79]
  ds_read_b64 v[88:89], v4 offset:1024
  ds_read_b64 v[90:91], v4 offset:1032
  ds_read_b128 v[132:135], v5 offset:2560
  v_mfma_f32_16x16x32_bf16 v[60:63], v[92:95], v[112:115], v[60:63]
  v_mfma_f32_16x16x32_bf16 v[64:67], v[92:95], v[116:119], v[64:67]
  v_mfma_f32_16x16x32_bf16 v[68:71], v[92:95], v[120:123], v[68:71]
  v_mfma_f32_16x16x32_bf16 v[72:75], v[92:95], v[124:127], v[72:75]
  v_mfma_f32_16x16x32_bf16 v[76:79], v[92:95], v[128:131], v[76:79]
  ds_read_b64 v[92:93], v4 offset:1536
  ds_read_b64 v[94:95], v4 offset:1544
  ds_read_b128 v[128:131], v5 offset:2048
  s_waitcnt lgkmcnt(6)
  v_mfma_f32_16x16x32_bf16 v[64:67], v[96:99], v[112:115], v[64:67]
  v_mfma_f32_16x16x32_bf16 v[68:71], v[96:99], v[116:119], v[68:71]
  v_mfma_f32_16x16x32_bf16 v[72:75], v[96:99], v[120:123], v[72:75]
  v_mfma_f32_16x16x32_bf16 v[76:79], v[96:99], v[124:127], v[76:79]
  ds_read_b64 v[96:97], v4 offset:2048
  ds_read_b64 v[98:99], v4 offset:2056
  ds_read_b128 v[124:127], v5 offset:1536
  v_mfma_f32_16x16x32_bf16 v[68:71], v[100:103], v[112:115], v[68:71]
  v_mfma_f32_16x16x32_bf16 v[72:75], v[100:103], v[116:119], v[72:75]
  v_mfma_f32_16x16x32_bf16 v[76:79], v[100:103], v[120:123], v[76:79]
  ds_read_b64 v[100:101], v4 offset:2560
  ds_read_b64 v[102:103], v4 offset:2568
  ds_read_b128 v[120:123], v5 offset:1024
  v_mfma_f32_16x16x32_bf16 v[72:75], v[104:107], v[112:115], v[72:75]
  v_mfma_f32_16x16x32_bf16 v[76:79], v[104:107], v[116:119], v[76:79]
  ds_read_b64 v[104:105], v4 offset:3072
  ds_read_b64 v[106:107], v4 offset:3080
  ds_read_b128 v[116:119], v5 offset:512
  s_waitcnt lgkmcnt(6)
  v_mfma_f32_16x16x32_bf16 v[76:79], v[108:111], v[112:115], v[76:79]
  ds_read_b64 v[108:109], v4 offset:3584
  ds_read_b64 v[110:111], v4 offset:3592
  ds_read_b128 v[112:115], v5 offset:0
  s_barrier
  s_add_u32 s37, s37, 2
  s_cmp_lt_u32 s37, 8
  s_cbranch_scc1 F2_CLOOP
  s_waitcnt lgkmcnt(0)
  v_lshlrev_b32 v6, 5, v3
  v_lshrrev_b32 v7, 1, v2
  v_lshlrev_b32 v7, 4, v7
  v_add_u32 v6, v6, v7
  v_and_b32 v7, 1, v2
  v_xor_b32 v7, 1, v7
  v_lshlrev_b32 v7, 3, v7
  v_add_u32 v6, v6, v7
  s_add_u32 s40, s36, 17152
  v_add_u32 v6, s40, v6
  ds_read_b64 v[80:81], v6 offset:0
  ds_read_b64 v[82:83], v6 offset:512
  ds_read_b64 v[84:85], v6 offset:1024
  ds_read_b64 v[86:87], v6 offset:1536
  ds_read_b64 v[88:89], v6 offset:2048
  ds_read_b64 v[90:91], v6 offset:2560
  ds_read_b64 v[92:93], v6 offset:3072
  ds_read_b64 v[94:95], v6 offset:3584
  v_lshlrev_b32 v8, 5, v3
  v_lshlrev_b32 v9, 3, v2
  v_add_u32 v8, v8, v9
  s_lshl_b32 s40, s35, 12
  s_add_u32 s40, s40, 9437184
  s_waitcnt lgkmcnt(0)
  v_and_b32 v112, s47, v81
  v_lshlrev_b32 v113, 16, v81
  v_and_b32 v114, s47, v80
  v_lshlrev_b32 v115, 16, v80
  v_fmac_f32 v48, v112, v46
  v_fmac_f32 v49, v113, v46
  v_fmac_f32 v50, v114, v46
  v_fmac_f32 v51, v115, v46
  v_cvt_pk_bf16_f32 v116, v48, v49
  v_cvt_pk_bf16_f32 v117, v50, v51
  buffer_store_dwordx2 v[116:117], v8, s[16:19], s40 offen offset:0 sc1
  v_and_b32 v120, s47, v83
  v_lshlrev_b32 v121, 16, v83
  v_and_b32 v122, s47, v82
  v_lshlrev_b32 v123, 16, v82
  v_fmac_f32 v52, v120, v46
  v_fmac_f32 v53, v121, v46
  v_fmac_f32 v54, v122, v46
  v_fmac_f32 v55, v123, v46
  v_cvt_pk_bf16_f32 v124, v52, v53
  v_cvt_pk_bf16_f32 v125, v54, v55
  buffer_store_dwordx2 v[124:125], v8, s[16:19], s40 offen offset:512 sc1
  v_and_b32 v128, s47, v85
  v_lshlrev_b32 v129, 16, v85
  v_and_b32 v130, s47, v84
  v_lshlrev_b32 v131, 16, v84
  v_fmac_f32 v56, v128, v46
  v_fmac_f32 v57, v129, v46
  v_fmac_f32 v58, v130, v46
  v_fmac_f32 v59, v131, v46
  v_cvt_pk_bf16_f32 v132, v56, v57
  v_cvt_pk_bf16_f32 v133, v58, v59
  buffer_store_dwordx2 v[132:133], v8, s[16:19], s40 offen offset:1024 sc1
  v_and_b32 v136, s47, v87
  v_lshlrev_b32 v137, 16, v87
  v_and_b32 v138, s47, v86
  v_lshlrev_b32 v139, 16, v86
  v_fmac_f32 v60, v136, v46
  v_fmac_f32 v61, v137, v46
  v_fmac_f32 v62, v138, v46
  v_fmac_f32 v63, v139, v46
  v_cvt_pk_bf16_f32 v140, v60, v61
  v_cvt_pk_bf16_f32 v141, v62, v63
  buffer_store_dwordx2 v[140:141], v8, s[16:19], s40 offen offset:1536 sc1
  v_and_b32 v112, s47, v89
  v_lshlrev_b32 v113, 16, v89
  v_and_b32 v114, s47, v88
  v_lshlrev_b32 v115, 16, v88
  v_fmac_f32 v64, v112, v46
  v_fmac_f32 v65, v113, v46
  v_fmac_f32 v66, v114, v46
  v_fmac_f32 v67, v115, v46
  v_cvt_pk_bf16_f32 v116, v64, v65
  v_cvt_pk_bf16_f32 v117, v66, v67
  buffer_store_dwordx2 v[116:117], v8, s[16:19], s40 offen offset:2048 sc1
  v_and_b32 v120, s47, v91
  v_lshlrev_b32 v121, 16, v91
  v_and_b32 v122, s47, v90
  v_lshlrev_b32 v123, 16, v90
  v_fmac_f32 v68, v120, v46
  v_fmac_f32 v69, v121, v46
  v_fmac_f32 v70, v122, v46
  v_fmac_f32 v71, v123, v46
  v_cvt_pk_bf16_f32 v124, v68, v69
  v_cvt_pk_bf16_f32 v125, v70, v71
  buffer_store_dwordx2 v[124:125], v8, s[16:19], s40 offen offset:2560 sc1
  v_and_b32 v128, s47, v93
  v_lshlrev_b32 v129, 16, v93
  v_and_b32 v130, s47, v92
  v_lshlrev_b32 v131, 16, v92
  v_fmac_f32 v72, v128, v46
  v_fmac_f32 v73, v129, v46
  v_fmac_f32 v74, v130, v46
  v_fmac_f32 v75, v131, v46
  v_cvt_pk_bf16_f32 v132, v72, v73
  v_cvt_pk_bf16_f32 v133, v74, v75
  buffer_store_dwordx2 v[132:133], v8, s[16:19], s40 offen offset:3072 sc1
  v_and_b32 v136, s47, v95
  v_lshlrev_b32 v137, 16, v95
  v_and_b32 v138, s47, v94
  v_lshlrev_b32 v139, 16, v94
  v_fmac_f32 v76, v136, v46
  v_fmac_f32 v77, v137, v46
  v_fmac_f32 v78, v138, v46
  v_fmac_f32 v79, v139, v46
  v_cvt_pk_bf16_f32 v140, v76, v77
  v_cvt_pk_bf16_f32 v141, v78, v79
  buffer_store_dwordx2 v[140:141], v8, s[16:19], s40 offen offset:3584 sc1
  s_waitcnt vmcnt(0)
  s_barrier
F3_IDLE:
  s_load_dwordx2 s[56:57], s[0:1], 0
  s_load_dwordx2 s[58:59], s[0:1], 88
  v_lshlrev_b32 v4, 4, v1
  s_lshl_b32 s35, s32, 2
  s_add_u32 s35, s35, s55
  s_lshr_b32 s39, s34, 2
  s_mul_i32 s36, s35, 24576
  s_mul_i32 s40, s39, 12288
  s_add_u32 s36, s36, s40
  s_add_u32 s36, s36, 12582912
  s_mul_i32 s40, s39, 61440
  v_add_u32 v26, s40, v4
  s_lshl_b32 s40, s35, 4
  s_mul_i32 s40, s40, 1280
  s_mul_i32 s41, s33, 160
  s_add_u32 s40, s40, s41
  v_add_u32 v12, 0, v1
  v_mul_u32_u24 v13, 6554, v12
  v_lshrrev_b32 v13, 16, v13
  v_mul_u32_u24 v14, 10, v13
  v_sub_u32 v14, v12, v14
  v_lshlrev_b32 v14, 4, v14
  v_mul_u32_u24 v13, 1280, v13
  v_add_u32 v13, v13, v14
  v_add_u32 v5, s40, v13
  v_lshrrev_b32 v13, 1, v12
  v_lshlrev_b32 v13, 12, v13
  v_and_b32 v14, 1, v12
  v_lshlrev_b32 v14, 4, v14
  v_add_u32 v8, v13, v14
  v_add_u32 v12, 64, v1
  v_mul_u32_u24 v13, 6554, v12
  v_lshrrev_b32 v13, 16, v13
  v_mul_u32_u24 v14, 10, v13
  v_sub_u32 v14, v12, v14
  v_lshlrev_b32 v14, 4, v14
  v_mul_u32_u24 v13, 1280, v13
  v_add_u32 v13, v13, v14
  v_add_u32 v6, s40, v13
  v_lshrrev_b32 v13, 1, v12
  v_lshlrev_b32 v13, 12, v13
  v_and_b32 v14, 1, v12
  v_lshlrev_b32 v14, 4, v14
  v_add_u32 v9, v13, v14
  v_add_u32 v12, 128, v1
  v_mul_u32_u24 v13, 6554, v12
  v_lshrrev_b32 v13, 16, v13
  v_mul_u32_u24 v14, 10, v13
  v_sub_u32 v14, v12, v14
  v_lshlrev_b32 v14, 4, v14
  v_mul_u32_u24 v13, 1280, v13
  v_add_u32 v13, v13, v14
  v_add_u32 v7, s40, v13
  v_lshrrev_b32 v13, 1, v12
  v_lshlrev_b32 v13, 12, v13
  v_and_b32 v14, 1, v12
  v_lshlrev_b32 v14, 4, v14
  v_add_u32 v10, v13, v14
  s_mul_i32 s37, s55, 2560
  s_mul_i32 s38, s33, 327680
  s_lshl_b32 s41, s35, 5
  s_add_u32 s38, s38, s41
  s_add_u32 s38, s38, 9437184
  s_lshl_b32 s40, s55, 6
  s_add_u32 s40, s40, 143360
  v_lshlrev_b32 v21, 2, v3
  v_add_u32 v21, s40, v21
  ds_read_b32 v24, v21
  ds_read_b32 v25, v21 offset:256
  v_mov_b32 v68, 0
  v_mov_b32 v69, 0
  v_mov_b32 v70, 0
  v_mov_b32 v71, 0
  v_mov_b32 v72, 0
  v_mov_b32 v73, 0
  v_mov_b32 v74, 0
  v_mov_b32 v75, 0
  v_mov_b32 v76, 0
  v_mov_b32 v77, 0
  v_mov_b32 v78, 0
  v_mov_b32 v79, 0
  v_mov_b32 v80, 0
  v_mov_b32 v81, 0
  v_mov_b32 v82, 0
  v_mov_b32 v83, 0
  v_mov_b32 v84, 0
  v_mov_b32 v85, 0
  v_mov_b32 v86, 0
  v_mov_b32 v87, 0
  s_waitcnt lgkmcnt(0)
  s_mov_b32 s8, s56
  s_and_b32 s9, s57, 0xffff
  s_mov_b32 s10, 2621440
  s_mov_b32 s11, 0x20000
  s_mov_b32 s12, s58
  s_and_b32 s13, s59, 0xffff
  s_mov_b32 s14, 2621440
  s_mov_b32 s15, 0x20000
  s_barrier
F3_BMAIN:
  s_add_u32 s40, s36, 0
  buffer_load_dwordx4 v[88:91], v4, s[16:19], s40 offen offset:0 sc1
  s_add_u32 s40, s36, 0
  buffer_load_dwordx4 v[92:95], v4, s[16:19], s40 offen offset:1024 sc1
  s_add_u32 s40, s36, 0
  buffer_load_dwordx4 v[96:99], v4, s[16:19], s40 offen offset:2048 sc1
  s_add_u32 s40, s36, 0
  buffer_load_dwordx4 v[100:103], v4, s[16:19], s40 offen offset:3072 sc1
  s_add_u32 s40, s36, 4096
  buffer_load_dwordx4 v[104:107], v4, s[16:19], s40 offen offset:0 sc1
  s_barrier
  ds_read_b128 v[28:31], v26 offset:0
  ds_read_b128 v[32:35], v26 offset:1024
  ds_read_b128 v[36:39], v26 offset:2048
  ds_read_b128 v[40:43], v26 offset:3072
  ds_read_b128 v[44:47], v26 offset:4096
  s_waitcnt vmcnt(4) lgkmcnt(0)
  v_mfma_f32_16x16x32_bf16 v[68:71], v[28:31], v[88:91], v[68:71]
  ds_read_b128 v[48:51], v26 offset:5120
  v_mfma_f32_16x16x32_bf16 v[72:75], v[32:35], v[88:91], v[72:75]
  ds_read_b128 v[52:55], v26 offset:6144
  v_mfma_f32_16x16x32_bf16 v[76:79], v[36:39], v[88:91], v[76:79]
  ds_read_b128 v[56:59], v26 offset:7168
  s_add_u32 s40, s36, 4096
  buffer_load_dwordx4 v[108:111], v4, s[16:19], s40 offen offset:1024 sc1
  v_mfma_f32_16x16x32_bf16 v[80:83], v[40:43], v[88:91], v[80:83]
  ds_read_b128 v[60:63], v26 offset:8192
  v_mfma_f32_16x16x32_bf16 v[84:87], v[44:47], v[88:91], v[84:87]
  ds_read_b128 v[64:67], v26 offset:9216
  s_waitcnt vmcnt(4) lgkmcnt(0)
  v_mfma_f32_16x16x32_bf16 v[68:71], v[48:51], v[92:95], v[68:71]
  ds_read_b128 v[28:31], v26 offset:10240
  v_mfma_f32_16x16x32_bf16 v[72:75], v[52:55], v[92:95], v[72:75]
  ds_read_b128 v[32:35], v26 offset:11264
  v_mfma_f32_16x16x32_bf16 v[76:79], v[56:59], v[92:95], v[76:79]
  ds_read_b128 v[36:39], v26 offset:12288
  s_add_u32 s40, s36, 4096
  buffer_load_dwordx4 v[112:115], v4, s[16:19], s40 offen offset:2048 sc1
  v_mfma_f32_16x16x32_bf16 v[80:83], v[60:63], v[92:95], v[80:83]
  ds_read_b128 v[40:43], v26 offset:13312
  v_mfma_f32_16x16x32_bf16 v[84:87], v[64:67], v[92:95], v[84:87]
  ds_read_b128 v[44:47], v26 offset:14336
  s_waitcnt vmcnt(4) lgkmcnt(0)
  v_mfma_f32_16x16x32_bf16 v[68:71], v[28:31], v[96:99], v[68:71]
  ds_read_b128 v[48:51], v26 offset:15360
  v_mfma_f32_16x16x32_bf16 v[72:75], v[32:35], v[96:99], v[72:75]
  ds_read_b128 v[52:55], v26 offset:16384
  v_mfma_f32_16x16x32_bf16 v[76:79], v[36:39], v[96:99], v[76:79]
  ds_read_b128 v[56:59], v26 offset:17408
  s_add_u32 s40, s36, 4096
  buffer_load_dwordx4 v[116:119], v4, s[16:19], s40 offen offset:3072 sc1
  v_mfma_f32_16x16x32_bf16 v[80:83], v[40:43], v[96:99], v[80:83]
  ds_read_b128 v[60:63], v26 offset:18432
  v_mfma_f32_16x16x32_bf16 v[84:87], v[44:47], v[96:99], v[84:87]
  ds_read_b128 v[64:67], v26 offset:19456
  s_waitcnt vmcnt(4) lgkmcnt(0)
  s_barrier
  v_mfma_f32_16x16x32_bf16 v[68:71], v[48:51], v[100:103], v[68:71]
  ds_read_b128 v[28:31], v26 offset:20480
  v_mfma_f32_16x16x32_bf16 v[72:75], v[52:55], v[100:103], v[72:75]
  ds_read_b128 v[32:35], v26 offset:21504
  v_mfma_f32_16x16x32_bf16 v[76:79], v[56:59], v[100:103], v[76:79]
  ds_read_b128 v[36:39], v26 offset:22528
  s_add_u32 s40, s36, 8192
  buffer_load_dwordx4 v[120:123], v4, s[16:19], s40 offen offset:0 sc1
  v_mfma_f32_16x16x32_bf16 v[80:83], v[60:63], v[100:103], v[80:83]
  ds_read_b128 v[40:43], v26 offset:23552
  v_mfma_f32_16x16x32_bf16 v[84:87], v[64:67], v[100:103], v[84:87]
  ds_read_b128 v[44:47], v26 offset:24576
  s_waitcnt vmcnt(4) lgkmcnt(0)
  v_mfma_f32_16x16x32_bf16 v[68:71], v[28:31], v[104:107], v[68:71]
  ds_read_b128 v[48:51], v26 offset:25600
  v_mfma_f32_16x16x32_bf16 v[72:75], v[32:35], v[104:107], v[72:75]
  ds_read_b128 v[52:55], v26 offset:26624
  v_mfma_f32_16x16x32_bf16 v[76:79], v[36:39], v[104:107], v[76:79]
  ds_read_b128 v[56:59], v26 offset:27648
  s_add_u32 s40, s36, 8192
  buffer_load_dwordx4 v[124:127], v4, s[16:19], s40 offen offset:1024 sc1
  v_mfma_f32_16x16x32_bf16 v[80:83], v[40:43], v[104:107], v[80:83]
  ds_read_b128 v[60:63], v26 offset:28672
  v_mfma_f32_16x16x32_bf16 v[84:87], v[44:47], v[104:107], v[84:87]
  ds_read_b128 v[64:67], v26 offset:29696
  s_add_u32 m0, s37, 133120
  s_nop 0
  buffer_load_dwordx4 v8, s[16:19], s38 offen sc1 lds
  s_waitcnt vmcnt(5) lgkmcnt(0)
  v_mfma_f32_16x16x32_bf16 v[68:71], v[48:51], v[108:111], v[68:71]
  ds_read_b128 v[28:31], v26 offset:30720
  v_mfma_f32_16x16x32_bf16 v[72:75], v[52:55], v[108:111], v[72:75]
  ds_read_b128 v[32:35], v26 offset:31744
  v_mfma_f32_16x16x32_bf16 v[76:79], v[56:59], v[108:111], v[76:79]
  ds_read_b128 v[36:39], v26 offset:32768
  s_add_u32 s40, s36, 8192
  buffer_load_dwordx4 v[128:131], v4, s[16:19], s40 offen offset:2048 sc1
  v_mfma_f32_16x16x32_bf16 v[80:83], v[60:63], v[108:111], v[80:83]
  ds_read_b128 v[40:43], v26 offset:33792
  v_mfma_f32_16x16x32_bf16 v[84:87], v[64:67], v[108:111], v[84:87]
  ds_read_b128 v[44:47], v26 offset:34816
  s_add_u32 m0, s37, 134144
  s_nop 0
  buffer_load_dwordx4 v9, s[16:19], s38 offen sc1 lds
  s_waitcnt vmcnt(6) lgkmcnt(0)
  v_mfma_f32_16x16x32_bf16 v[68:71], v[28:31], v[112:115], v[68:71]
  ds_read_b128 v[48:51], v26 offset:35840
  v_mfma_f32_16x16x32_bf16 v[72:75], v[32:35], v[112:115], v[72:75]
  ds_read_b128 v[52:55], v26 offset:36864
  v_mfma_f32_16x16x32_bf16 v[76:79], v[36:39], v[112:115], v[76:79]
  ds_read_b128 v[56:59], v26 offset:37888
  s_add_u32 s40, s36, 8192
  buffer_load_dwordx4 v[132:135], v4, s[16:19], s40 offen offset:3072 sc1
  v_mfma_f32_16x16x32_bf16 v[80:83], v[40:43], v[112:115], v[80:83]
  ds_read_b128 v[60:63], v26 offset:38912
  v_mfma_f32_16x16x32_bf16 v[84:87], v[44:47], v[112:115], v[84:87]
  ds_read_b128 v[64:67], v26 offset:39936
  s_mov_b32 exec_hi, 0
  s_add_u32 m0, s37, 135168
  s_nop 0
  buffer_load_dwordx4 v10, s[16:19], s38 offen sc1 lds
  s_mov_b32 exec_hi, -1
  s_waitcnt vmcnt(7) lgkmcnt(0)
  s_barrier
  v_mfma_f32_16x16x32_bf16 v[68:71], v[48:51], v[116:119], v[68:71]
  ds_read_b128 v[28:31], v26 offset:40960
  v_mfma_f32_16x16x32_bf16 v[72:75], v[52:55], v[116:119], v[72:75]
  ds_read_b128 v[32:35], v26 offset:41984
  v_mfma_f32_16x16x32_bf16 v[76:79], v[56:59], v[116:119], v[76:79]
  ds_read_b128 v[36:39], v26 offset:43008
  v_mfma_f32_16x16x32_bf16 v[80:83], v[60:63], v[116:119], v[80:83]
  ds_read_b128 v[40:43], v26 offset:44032
  v_mfma_f32_16x16x32_bf16 v[84:87], v[64:67], v[116:119], v[84:87]
  ds_read_b128 v[44:47], v26 offset:45056
  s_waitcnt vmcnt(6) lgkmcnt(0)
  v_mfma_f32_16x16x32_bf16 v[68:71], v[28:31], v[120:123], v[68:71]
  ds_read_b128 v[48:51], v26 offset:46080
  v_mfma_f32_16x16x32_bf16 v[72:75], v[32:35], v[120:123], v[72:75]
  ds_read_b128 v[52:55], v26 offset:47104
  v_mfma_f32_16x16x32_bf16 v[76:79], v[36:39], v[120:123], v[76:79]
  ds_read_b128 v[56:59], v26 offset:48128
  v_mfma_f32_16x16x32_bf16 v[80:83], v[40:43], v[120:123], v[80:83]
  ds_read_b128 v[60:63], v26 offset:49152
  v_mfma_f32_16x16x32_bf16 v[84:87], v[44:47], v[120:123], v[84:87]
  ds_read_b128 v[64:67], v26 offset:50176
  s_waitcnt vmcnt(5) lgkmcnt(0)
  v_mfma_f32_16x16x32_bf16 v[68:71], v[48:51], v[124:127], v[68:71]
  ds_read_b128 v[28:31], v26 offset:51200
  v_mfma_f32_16x16x32_bf16 v[72:75], v[52:55], v[124:127], v[72:75]
  ds_read_b128 v[32:35], v26 offset:52224
  v_mfma_f32_16x16x32_bf16 v[76:79], v[56:59], v[124:127], v[76:79]
  ds_read_b128 v[36:39], v26 offset:53248
  v_mfma_f32_16x16x32_bf16 v[80:83], v[60:63], v[124:127], v[80:83]
  ds_read_b128 v[40:43], v26 offset:54272
  v_mfma_f32_16x16x32_bf16 v[84:87], v[64:67], v[124:127], v[84:87]
  ds_read_b128 v[44:47], v26 offset:55296
  s_waitcnt vmcnt(3) lgkmcnt(0)
  v_mfma_f32_16x16x32_bf16 v[68:71], v[28:31], v[128:131], v[68:71]
  ds_read_b128 v[48:51], v26 offset:56320
  v_mfma_f32_16x16x32_bf16 v[72:75], v[32:35], v[128:131], v[72:75]
  ds_read_b128 v[52:55], v26 offset:57344
  v_mfma_f32_16x16x32_bf16 v[76:79], v[36:39], v[128:131], v[76:79]
  ds_read_b128 v[56:59], v26 offset:58368
  v_mfma_f32_16x16x32_bf16 v[80:83], v[40:43], v[128:131], v[80:83]
  ds_read_b128 v[60:63], v26 offset:59392
  v_mfma_f32_16x16x32_bf16 v[84:87], v[44:47], v[128:131], v[84:87]
  ds_read_b128 v[64:67], v26 offset:60416
  s_waitcnt vmcnt(1) lgkmcnt(0)
  v_mfma_f32_16x16x32_bf16 v[68:71], v[48:51], v[132:135], v[68:71]
  v_mfma_f32_16x16x32_bf16 v[72:75], v[52:55], v[132:135], v[72:75]
  v_mfma_f32_16x16x32_bf16 v[76:79], v[56:59], v[132:135], v[76:79]
  v_mfma_f32_16x16x32_bf16 v[80:83], v[60:63], v[132:135], v[80:83]
  v_mfma_f32_16x16x32_bf16 v[84:87], v[64:67], v[132:135], v[84:87]
  s_mul_i32 s40, s55, 5120
  v_add_u32 v12, s40, v4
  s_nop 1
  ds_write_b128 v12, v[68:71] offset:0
  ds_write_b128 v12, v[72:75] offset:1024
  ds_write_b128 v12, v[76:79] offset:2048
  v_mul_u32_u24 v13, 160, v3
  v_lshlrev_b32 v14, 3, v2
  v_add_u32 v13, v13, v14
  s_add_u32 s40, s37, 122880
  v_add_u32 v13, s40, v13
  v_lshlrev_b32 v14, 7, v2
  v_lshlrev_b32 v15, 3, v3
  v_add_u32 v14, v14, v15
  s_add_u32 s40, s37, 133120
  v_add_u32 v14, s40, v14
  v_sub_f32 v16, 0, v24
  v_mov_b32 v18, v25
  s_mov_b32 s48, 1.0
  s_mov_b32 s49, 1.0
  v_mov_b32 v20, 0xbfb8aa3b
  v_mov_b32 v21, 0xbfb8aa3b
  s_waitcnt vmcnt(0) lgkmcnt(0)
  s_barrier
  ds_read_b64 v[94:95], v13 offset:96
  ds_read_b64_tr_b16 v[104:105], v14 offset:1536
  ds_read_b64 v[96:97], v13 offset:128
  ds_read_b64_tr_b16 v[106:107], v14 offset:2048
  ds_read_b128 v[120:123], v12 offset:3072
  ds_read_b128 v[124:127], v12 offset:4096
  s_waitcnt lgkmcnt(0)
  v_pk_add_f32 v[80:81], v[80:81], v[120:121]
  v_lshlrev_b32 v28, 16, v94
  v_and_b32 v29, s47, v94
  v_pk_mul_f32 v[32:33], v[80:81], v[20:21]
  v_lshlrev_b32 v30, 16, v104
  v_and_b32 v31, s47, v104
  v_exp_f32 v32, v32
  v_exp_f32 v33, v33
  v_pk_add_f32 v[34:35], v[28:29], v[16:17] op_sel_hi:[1,0]
  v_pk_add_f32 v[32:33], v[32:33], s[48:49]
  v_pk_mul_f32 v[34:35], v[34:35], v[18:19] op_sel_hi:[1,0]
  v_rcp_f32 v32, v32
  v_rcp_f32 v33, v33
  v_pk_mul_f32 v[34:35], v[34:35], v[30:31]
  v_pk_mul_f32 v[32:33], v[32:33], v[80:81]
  v_pk_fma_f32 v[34:35], v[34:35], v[32:33], v[28:29]
  v_cvt_pk_bf16_f32 v94, v34, v35
  v_pk_add_f32 v[82:83], v[82:83], v[122:123]
  v_lshlrev_b32 v36, 16, v95
  v_and_b32 v37, s47, v95
  v_pk_mul_f32 v[40:41], v[82:83], v[20:21]
  v_lshlrev_b32 v38, 16, v105
  v_and_b32 v39, s47, v105
  v_exp_f32 v40, v40
  v_exp_f32 v41, v41
  v_pk_add_f32 v[42:43], v[36:37], v[16:17] op_sel_hi:[1,0]
  v_pk_add_f32 v[40:41], v[40:41], s[48:49]
  v_pk_mul_f32 v[42:43], v[42:43], v[18:19] op_sel_hi:[1,0]
  v_rcp_f32 v40, v40
  v_rcp_f32 v41, v41
  v_pk_mul_f32 v[42:43], v[42:43], v[38:39]
  v_pk_mul_f32 v[40:41], v[40:41], v[82:83]
  v_pk_fma_f32 v[42:43], v[42:43], v[40:41], v[36:37]
  v_cvt_pk_bf16_f32 v95, v42, v43
  ds_write_b64 v13, v[94:95] offset:96
  v_pk_add_f32 v[84:85], v[84:85], v[124:125]
  v_lshlrev_b32 v28, 16, v96
  v_and_b32 v29, s47, v96
  v_pk_mul_f32 v[32:33], v[84:85], v[20:21]
  v_lshlrev_b32 v30, 16, v106
  v_and_b32 v31, s47, v106
  v_exp_f32 v32, v32
  v_exp_f32 v33, v33
  v_pk_add_f32 v[34:35], v[28:29], v[16:17] op_sel_hi:[1,0]
  v_pk_add_f32 v[32:33], v[32:33], s[48:49]
  v_pk_mul_f32 v[34:35], v[34:35], v[18:19] op_sel_hi:[1,0]
  v_rcp_f32 v32, v32
  v_rcp_f32 v33, v33
  v_pk_mul_f32 v[34:35], v[34:35], v[30:31]
  v_pk_mul_f32 v[32:33], v[32:33], v[84:85]
  v_pk_fma_f32 v[34:35], v[34:35], v[32:33], v[28:29]
  v_cvt_pk_bf16_f32 v96, v34, v35
  v_pk_add_f32 v[86:87], v[86:87], v[126:127]
  v_lshlrev_b32 v36, 16, v97
  v_and_b32 v37, s47, v97
  v_pk_mul_f32 v[40:41], v[86:87], v[20:21]
  v_lshlrev_b32 v38, 16, v107
  v_and_b32 v39, s47, v107
  v_exp_f32 v40, v40
  v_exp_f32 v41, v41
  v_pk_add_f32 v[42:43], v[36:37], v[16:17] op_sel_hi:[1,0]
  v_pk_add_f32 v[40:41], v[40:41], s[48:49]
  v_pk_mul_f32 v[42:43], v[42:43], v[18:19] op_sel_hi:[1,0]
  v_rcp_f32 v40, v40
  v_rcp_f32 v41, v41
  v_pk_mul_f32 v[42:43], v[42:43], v[38:39]
  v_pk_mul_f32 v[40:41], v[40:41], v[86:87]
  v_pk_fma_f32 v[42:43], v[42:43], v[40:41], v[36:37]
  v_cvt_pk_bf16_f32 v97, v42, v43
  ds_write_b64 v13, v[96:97] offset:128
  s_waitcnt lgkmcnt(0)
  s_barrier
  s_add_u32 s40, s37, 122880
  v_add_u32 v13, s40, v4
  ds_read_b128 v[108:111], v13 offset:2048
  s_waitcnt lgkmcnt(0)
  s_mov_b32 exec_lo, 0xffffffff
  s_mov_b32 exec_hi, 0x0
  buffer_store_dwordx4 v[108:111], v7, s[12:15], 0 offen
  s_mov_b64 exec, s[52:53]
  s_endpgm
F2_IDLE:
  s_waitcnt vmcnt(0)
  s_barrier
  s_sleep 3
  s_sub_u32 s42, s34, 4
  v_lshrrev_b32 v8, 3, v1
  s_lshl_b32 s40, s42, 3
  v_add_u32 v8, s40, v8
  v_and_b32 v9, 7, v1
  v_lshlrev_b32 v9, 4, v9
  v_mul_u32_u24 v10, 144, v8
  v_add_u32 v10, v10, v9
  v_add_u32 v10, 49152, v10
  v_lshlrev_b32 v8, 12, v8
  v_add_u32 v8, v8, v9
  ds_read_b128 v[16:19], v10 offset:0
  ds_read_b128 v[20:23], v10 offset:3456
  ds_read_b128 v[24:27], v10 offset:6912
  ds_read_b128 v[28:31], v10 offset:10368
  s_mul_i32 s40, s33, 327680
  s_lshl_b32 s41, s32, 7
  s_add_u32 s40, s40, s41
  s_add_u32 s40, s40, 6291456
  s_waitcnt lgkmcnt(0)
  buffer_store_dwordx4 v[16:19], v8, s[16:19], s40 offen sc1
  s_add_u32 s40, s40, 98304
  buffer_store_dwordx4 v[20:23], v8, s[16:19], s40 offen sc1
  s_add_u32 s40, s40, 98304
  buffer_store_dwordx4 v[24:27], v8, s[16:19], s40 offen sc1
  s_add_u32 s40, s40, 98304
  s_cmp_eq_u32 s42, 0
  s_cselect_b32 s40, s40, 0x80000000
  buffer_store_dwordx4 v[28:31], v8, s[16:19], s40 offen sc1
  s_add_u32 s40, s40, 98304
  s_barrier
  s_waitcnt vmcnt(0)
  s_barrier
  s_barrier
  s_barrier
  s_barrier
  s_barrier
  s_barrier
  s_barrier
  s_barrier
  s_barrier
  s_barrier
  s_barrier
  s_barrier
  s_barrier
  s_barrier
  s_barrier
  s_barrier
  s_barrier
  s_barrier
  s_barrier
  s_branch F3_IDLE
F2_SYNC:
  s_load_dwordx2 s[72:73], s[0:1], 104
  s_waitcnt lgkmcnt(0)
  s_load_dwordx2 s[70:71], s[0:1], 64
  s_lshl_b32 s40, s32, 6
  s_lshl_b32 s41, s33, 3
  s_add_u32 s40, s40, s41
  v_lshrrev_b32 v20, 3, v1
  v_add_u32 v20, s40, v20
  v_lshlrev_b32 v20, 12, v20
  v_and_b32 v21, 7, v1
  v_lshlrev_b32 v21, 6, v21
  v_add_u32 v20, v20, v21
  v_lshrrev_b32 v22, 2, v1
  v_add_u32 v22, s40, v22
  v_lshlrev_b32 v22, 12, v22
  v_and_b32 v21, 3, v1
  v_lshlrev_b32 v21, 6, v21
  v_add_u32 v22, v22, v21
  s_waitcnt lgkmcnt(0)
  s_mov_b32 s8, s70
  s_and_b32 s9, s71, 0xffff
  s_mov_b32 s10, 8388608
  s_mov_b32 s11, 0x20000
  s_lshl_b32 s40, s33, 7
  s_lshl_b32 s41, s32, 2
  s_add_u32 s40, s40, s41
  s_add_u32 s41, s40, 17040384
  s_add_u32 s40, s40, 17039360
  v_mov_b32 v152, s40
  v_mov_b32 v153, s41
  v_cmp_eq_u32 vcc, 1, v1
  s_nop 1
  v_cndmask_b32 v152, v152, v153, vcc
  s_lshl_b32 s40, s32, 5
  s_lshl_b32 s41, s33, 2
  s_add_u32 s40, s40, s41
  s_add_u32 s40, s40, 17041408
  v_mov_b32 v153, s40
  v_cmp_eq_u32 vcc, 2, v1
  s_nop 1
  v_cndmask_b32 v152, v152, v153, vcc
  s_lshl_b32 s40, s33, 7
  s_lshl_b32 s41, s32, 2
  s_add_u32 s40, s40, s41
  s_add_u32 s40, s40, 17042432
  v_mov_b32 v153, s40
  v_cmp_eq_u32 vcc, 3, v1
  s_nop 1
  v_cndmask_b32 v152, v152, v153, vcc
  v_mov_b32 v154, 1
  s_waitcnt vmcnt(0) lgkmcnt(0)
  s_barrier
  s_mov_b32 exec_lo, 0x1
  s_mov_b32 exec_hi, 0x0
  buffer_store_dword v154, v152, s[16:19], 0 offen sc1
  s_mov_b64 exec, s[52:53]
  s_lshl_b32 s40, s33, 7
  s_add_u32 s75, s40, 17039360
  s_add_u32 s40, s40, 17039360
  v_lshlrev_b32 v150, 2, v1
  v_add_u32 v150, s40, v150
  s_add_u32 s74, s75, 0
  s_mov_b32 s42, 0
SP_F1a:
  s_load_dwordx8 s[56:63], s[72:73], s74 glc
  s_waitcnt lgkmcnt(0)
  s_and_b64 s[56:57], s[56:57], s[60:61]
  s_and_b64 s[58:59], s[58:59], s[62:63]
  s_and_b64 s[56:57], s[56:57], s[58:59]
  s_and_b32 s56, s56, s57
  s_add_u32 s42, s42, 1
  s_cmp_eq_u32 s56, 1
  s_cbranch_scc1 SP_F1a_OK
  s_cmp_lt_u32 s42, 2097152
  s_cbranch_scc1 SP_F1a
SP_F1a_OK:
  s_barrier
  s_barrier
  s_mov_b32 exec_lo, 0x8
  s_mov_b32 exec_hi, 0x0
  buffer_store_dword v154, v152, s[16:19], 0 offen sc1
  s_mov_b64 exec, s[52:53]
  s_add_u32 s74, s75, 32
  s_mov_b32 s42, 0
SP_F1b:
  s_load_dwordx8 s[56:63], s[72:73], s74 glc
  s_waitcnt lgkmcnt(0)
  s_and_b64 s[56:57], s[56:57], s[60:61]
  s_and_b64 s[58:59], s[58:59], s[62:63]
  s_and_b64 s[56:57], s[56:57], s[58:59]
  s_and_b32 s56, s56, s57
  s_add_u32 s42, s42, 1
  s_cmp_eq_u32 s56, 1
  s_cbranch_scc1 SP_F1b_OK
  s_cmp_lt_u32 s42, 2097152
  s_cbranch_scc1 SP_F1b
SP_F1b_OK:
  s_barrier
  s_barrier
  s_add_u32 s74, s75, 64
  s_mov_b32 s42, 0
SP_F1c:
  s_load_dwordx16 s[56:71], s[72:73], s74 glc
  s_waitcnt lgkmcnt(0)
  s_and_b64 s[56:57], s[56:57], s[64:65]
  s_and_b64 s[58:59], s[58:59], s[66:67]
  s_and_b64 s[60:61], s[60:61], s[68:69]
  s_and_b64 s[62:63], s[62:63], s[70:71]
  s_and_b64 s[56:57], s[56:57], s[60:61]
  s_and_b64 s[58:59], s[58:59], s[62:63]
  s_and_b64 s[56:57], s[56:57], s[58:59]
  s_and_b32 s56, s56, s57
  s_add_u32 s42, s42, 1
  s_cmp_eq_u32 s56, 1
  s_cbranch_scc1 SP_F1c_OK
  s_cmp_lt_u32 s42, 2097152
  s_cbranch_scc1 SP_F1c
SP_F1c_OK:
  s_barrier
  s_add_u32 s75, s75, 3072
  s_add_u32 s74, s75, 0
  s_mov_b32 s42, 0
SP_FKa:
  s_load_dwordx16 s[56:71], s[72:73], s74 glc
  s_waitcnt lgkmcnt(0)
  s_and_b64 s[56:57], s[56:57], s[64:65]
  s_and_b64 s[58:59], s[58:59], s[66:67]
  s_and_b64 s[60:61], s[60:61], s[68:69]
  s_and_b64 s[62:63], s[62:63], s[70:71]
  s_and_b64 s[56:57], s[56:57], s[60:61]
  s_and_b64 s[58:59], s[58:59], s[62:63]
  s_and_b64 s[56:57], s[56:57], s[58:59]
  s_and_b32 s56, s56, s57
  s_add_u32 s42, s42, 1
  s_cmp_eq_u32 s56, 1
  s_cbranch_scc1 SP_FKa_OK
  s_cmp_lt_u32 s42, 2097152
  s_cbranch_scc1 SP_FKa
SP_FKa_OK:
  s_add_u32 s74, s75, 64
  s_mov_b32 s42, 0
SP_FKb:
  s_load_dwordx16 s[56:71], s[72:73], s74 glc
  s_waitcnt lgkmcnt(0)
  s_and_b64 s[56:57], s[56:57], s[64:65]
  s_and_b64 s[58:59], s[58:59], s[66:67]
  s_and_b64 s[60:61], s[60:61], s[68:69]
  s_and_b64 s[62:63], s[62:63], s[70:71]
  s_and_b64 s[56:57], s[56:57], s[60:61]
  s_and_b64 s[58:59], s[58:59], s[62:63]
  s_and_b64 s[56:57], s[56:57], s[58:59]
  s_and_b32 s56, s56, s57
  s_add_u32 s42, s42, 1
  s_cmp_eq_u32 s56, 1
  s_cbranch_scc1 SP_FKb_OK
  s_cmp_lt_u32 s42, 2097152
  s_cbranch_scc1 SP_FKb
SP_FKb_OK:
  s_barrier
  s_barrier
  s_barrier
  s_barrier
  s_barrier
  s_barrier
  s_barrier
  s_barrier
  s_barrier
  s_barrier
  s_barrier
  s_barrier
  s_barrier
  s_load_dwordx2 s[56:57], s[0:1], 0
  s_load_dwordx2 s[58:59], s[0:1], 88
  v_lshlrev_b32 v4, 4, v1
  s_lshl_b32 s35, s32, 2
  s_add_u32 s35, s35, s55
  s_lshr_b32 s39, s34, 2
  s_mul_i32 s36, s35, 24576
  s_mul_i32 s40, s39, 12288
  s_add_u32 s36, s36, s40
  s_add_u32 s36, s36, 12582912
  s_mul_i32 s40, s39, 61440
  v_add_u32 v26, s40, v4
  s_lshl_b32 s40, s35, 4
  s_mul_i32 s40, s40, 1280
  s_mul_i32 s41, s33, 160
  s_add_u32 s40, s40, s41
  v_add_u32 v12, 0, v1
  v_mul_u32_u24 v13, 6554, v12
  v_lshrrev_b32 v13, 16, v13
  v_mul_u32_u24 v14, 10, v13
  v_sub_u32 v14, v12, v14
  v_lshlrev_b32 v14, 4, v14
  v_mul_u32_u24 v13, 1280, v13
  v_add_u32 v13, v13, v14
  v_add_u32 v5, s40, v13
  v_lshrrev_b32 v13, 1, v12
  v_lshlrev_b32 v13, 12, v13
  v_and_b32 v14, 1, v12
  v_lshlrev_b32 v14, 4, v14
  v_add_u32 v8, v13, v14
  v_add_u32 v12, 64, v1
  v_mul_u32_u24 v13, 6554, v12
  v_lshrrev_b32 v13, 16, v13
  v_mul_u32_u24 v14, 10, v13
  v_sub_u32 v14, v12, v14
  v_lshlrev_b32 v14, 4, v14
  v_mul_u32_u24 v13, 1280, v13
  v_add_u32 v13, v13, v14
  v_add_u32 v6, s40, v13
  v_lshrrev_b32 v13, 1, v12
  v_lshlrev_b32 v13, 12, v13
  v_and_b32 v14, 1, v12
  v_lshlrev_b32 v14, 4, v14
  v_add_u32 v9, v13, v14
  v_add_u32 v12, 128, v1
  v_mul_u32_u24 v13, 6554, v12
  v_lshrrev_b32 v13, 16, v13
  v_mul_u32_u24 v14, 10, v13
  v_sub_u32 v14, v12, v14
  v_lshlrev_b32 v14, 4, v14
  v_mul_u32_u24 v13, 1280, v13
  v_add_u32 v13, v13, v14
  v_add_u32 v7, s40, v13
  v_lshrrev_b32 v13, 1, v12
  v_lshlrev_b32 v13, 12, v13
  v_and_b32 v14, 1, v12
  v_lshlrev_b32 v14, 4, v14
  v_add_u32 v10, v13, v14
  s_mul_i32 s37, s55, 2560
  s_mul_i32 s38, s33, 327680
  s_lshl_b32 s41, s35, 5
  s_add_u32 s38, s38, s41
  s_add_u32 s38, s38, 9437184
  s_lshl_b32 s40, s55, 6
  s_add_u32 s40, s40, 143360
  v_lshlrev_b32 v21, 2, v3
  v_add_u32 v21, s40, v21
  ds_read_b32 v24, v21
  ds_read_b32 v25, v21 offset:256
  v_mov_b32 v68, 0
  v_mov_b32 v69, 0
  v_mov_b32 v70, 0
  v_mov_b32 v71, 0
  v_mov_b32 v72, 0
  v_mov_b32 v73, 0
  v_mov_b32 v74, 0
  v_mov_b32 v75, 0
  v_mov_b32 v76, 0
  v_mov_b32 v77, 0
  v_mov_b32 v78, 0
  v_mov_b32 v79, 0
  v_mov_b32 v80, 0
  v_mov_b32 v81, 0
  v_mov_b32 v82, 0
  v_mov_b32 v83, 0
  v_mov_b32 v84, 0
  v_mov_b32 v85, 0
  v_mov_b32 v86, 0
  v_mov_b32 v87, 0
  s_waitcnt lgkmcnt(0)
  s_mov_b32 s8, s56
  s_and_b32 s9, s57, 0xffff
  s_mov_b32 s10, 2621440
  s_mov_b32 s11, 0x20000
  s_mov_b32 s12, s58
  s_and_b32 s13, s59, 0xffff
  s_mov_b32 s14, 2621440
  s_mov_b32 s15, 0x20000
  s_barrier
  s_barrier
  s_mov_b32 exec_lo, 0x6
  s_mov_b32 exec_hi, 0x0
  buffer_store_dword v154, v152, s[16:19], 0 offen sc1
  s_mov_b64 exec, s[52:53]
  s_lshl_b32 s40, s32, 5
  s_add_u32 s75, s40, 17041408
  s_add_u32 s74, s75, 0
  s_mov_b32 s42, 0
SP_F2B:
  s_load_dwordx8 s[56:63], s[72:73], s74 glc
  s_waitcnt lgkmcnt(0)
  s_and_b64 s[56:57], s[56:57], s[60:61]
  s_and_b64 s[58:59], s[58:59], s[62:63]
  s_and_b64 s[56:57], s[56:57], s[58:59]
  s_and_b32 s56, s56, s57
  s_add_u32 s42, s42, 1
  s_cmp_eq_u32 s56, 1
  s_cbranch_scc1 SP_F2B_OK
  s_cmp_lt_u32 s42, 2097152
  s_cbranch_scc1 SP_F2B
SP_F2B_OK:
  s_barrier
  s_branch F3_BMAIN
K1_END:
  s_endpgm
KF_CODE_END:

.section .rodata,"a"
.p2align 6
.amdhsa_kernel recurrent_scan__ssm_conv_h3__mixer_gmlp__prompt_kernel
  .amdhsa_next_free_vgpr 168
  .amdhsa_next_free_sgpr 96
  .amdhsa_accum_offset 168
  .amdhsa_group_segment_fixed_size 0
  .amdhsa_kernarg_size 112
  .amdhsa_user_sgpr_count 2
  .amdhsa_user_sgpr_kernarg_segment_ptr 1
  .amdhsa_system_sgpr_workgroup_id_x 1
  .amdhsa_float_denorm_mode_32 3
.end_amdhsa_kernel
.text
```

```asm
; @launch grid=(256,1,1) block=(768,1,1) lds=159744
.amdgcn_target "amdgcn-amd-amdhsa--gfx950"
.text
.globl recurrent_scan__ssm_conv_h3__mixer_gmlp__prompt_kernel
.p2align 8
.type recurrent_scan__ssm_conv_h3__mixer_gmlp__prompt_kernel,@function
recurrent_scan__ssm_conv_h3__mixer_gmlp__prompt_kernel:
  s_cmp_ge_u32 s2, 256
  s_cbranch_scc1 K1_END
  s_load_dwordx4 s[56:59], s[0:1], 0
  s_load_dwordx4 s[60:63], s[0:1], 16
  s_load_dwordx2 s[64:65], s[0:1], 56
  s_load_dwordx2 s[66:67], s[0:1], 80
  s_load_dwordx4 s[68:71], s[0:1], 96
  s_load_dwordx2 s[74:75], s[0:1], 64
  s_load_dwordx2 s[76:77], s[0:1], 32
  v_and_b32 v1, 63, v0
  v_lshrrev_b32 v14, 6, v0
  v_lshrrev_b32 v2, 4, v1
  v_readfirstlane_b32 s34, v14
  v_and_b32 v3, 15, v1
  s_and_b32 s40, s2, 7
  s_lshr_b32 s41, s2, 3
  s_lshr_b32 s32, s40, 1
  s_lshl_b32 s32, s32, 3
  s_lshr_b32 s42, s41, 2
  s_add_u32 s32, s32, s42
  s_and_b32 s33, s40, 1
  s_lshl_b32 s33, s33, 2
  s_and_b32 s42, s41, 3
  s_add_u32 s33, s33, s42
  s_and_b32 s55, s34, 3
  s_lshr_b32 s35, s55, 1
  s_and_b32 s36, s55, 1
  s_mov_b32 s47, 0xffff0000
  s_mov_b64 s[52:53], exec
  s_mul_i32 s44, s33, 192
  s_add_u32 s43, s44, 1536
  s_cmp_ge_u32 s34, 8
  s_cbranch_scc0 K1_AB
  s_lshl_b32 s40, s32, 6
  s_lshl_b32 s41, s55, 3
  s_add_u32 s40, s40, s41
  s_lshl_b32 s45, s55, 10
  v_lshrrev_b32 v30, 3, v1
  v_add_u32 v32, s41, v30
  v_lshrrev_b32 v31, 1, v32
  v_xor_b32 v31, v31, v1
  v_and_b32 v31, 7, v31
  v_lshlrev_b32 v31, 4, v31
  v_add_u32 v30, s40, v30
  v_mul_u32_u24 v30, 1280, v30
  v_add_u32 v8, v30, v31
  v_add_u32 v9, 40960, v8
  s_waitcnt lgkmcnt(0)
  s_mov_b32 s8, s56
  s_and_b32 s9, s57, 0xffff
  s_mov_b32 s10, 2621440
  s_mov_b32 s11, 0x20000
  s_mov_b32 s12, s64
  s_and_b32 s13, s65, 0xffff
  s_mov_b32 s14, 1966080
  s_mov_b32 s15, 0x20000
  s_and_b32 s40, s32, 7
  s_and_b32 s41, s33, 3
  s_mul_i32 s41, s41, 3
  s_add_u32 s37, s40, s41
  s_sub_u32 s40, s37, 10
  s_cmp_ge_u32 s37, 10
  s_cselect_b32 s37, s40, s37
  s_lshl_b32 s40, s55, 6
  s_add_u32 s40, s40, 0
  v_add_u32 v30, s40, v1
  v_mul_u32_u24 v31, 5462, v30
  v_lshrrev_b32 v31, 16, v31
  v_mul_u32_u24 v32, 12, v31
  v_sub_u32 v32, v30, v32
  v_lshrrev_b32 v33, 2, v31
  v_and_b32 v33, 2, v33
  v_xor_b32 v32, v32, v33
  v_lshlrev_b32 v32, 4, v32
  v_mul_u32_u24 v31, 3072, v31
  v_add_u32 v12, v31, v32
  s_lshl_b32 s40, s55, 6
  s_add_u32 s40, s40, 256
  v_add_u32 v30, s40, v1
  v_mul_u32_u24 v31, 5462, v30
  v_lshrrev_b32 v31, 16, v31
  v_mul_u32_u24 v32, 12, v31
  v_sub_u32 v32, v30, v32
  v_lshrrev_b32 v33, 2, v31
  v_and_b32 v33, 2, v33
  v_xor_b32 v32, v32, v33
  v_lshlrev_b32 v32, 4, v32
  v_mul_u32_u24 v31, 3072, v31
  v_add_u32 v13, v31, v32
  s_lshl_b32 s40, s55, 6
  s_add_u32 s40, s40, 512
  v_add_u32 v30, s40, v1
  v_mul_u32_u24 v31, 5462, v30
  v_lshrrev_b32 v31, 16, v31
  v_mul_u32_u24 v32, 12, v31
  v_sub_u32 v32, v30, v32
  v_lshrrev_b32 v33, 2, v31
  v_and_b32 v33, 2, v33
  v_xor_b32 v32, v32, v33
  v_lshlrev_b32 v32, 4, v32
  v_mul_u32_u24 v31, 3072, v31
  v_add_u32 v14, v31, v32
  s_add_u32 s38, s37, 0
  s_sub_u32 s40, s38, 10
  s_cmp_ge_u32 s38, 10
  s_cselect_b32 s38, s40, s38
  s_lshl_b32 s38, s38, 7
  s_add_u32 m0, s45, 61440
  s_nop 0
  buffer_load_dwordx4 v8, s[8:11], s38 offen  lds
  s_add_u32 m0, s45, 65536
  s_nop 0
  buffer_load_dwordx4 v9, s[8:11], s38 offen  lds
  s_add_u32 s39, s37, 0
  s_sub_u32 s40, s39, 10
  s_cmp_ge_u32 s39, 10
  s_cselect_b32 s39, s40, s39
  s_mul_i32 s39, s39, 196608
  s_add_u32 s39, s39, s43
  s_add_u32 m0, s45, 0
  s_nop 0
  buffer_load_dwordx4 v12, s[12:15], s39 offen  lds
  s_add_u32 m0, s45, 4096
  s_nop 0
  buffer_load_dwordx4 v13, s[12:15], s39 offen  lds
  s_add_u32 m0, s45, 8192
  s_nop 0
  buffer_load_dwordx4 v14, s[12:15], s39 offen  lds
  s_add_u32 s38, s37, 1
  s_sub_u32 s40, s38, 10
  s_cmp_ge_u32 s38, 10
  s_cselect_b32 s38, s40, s38
  s_lshl_b32 s38, s38, 7
  s_add_u32 m0, s45, 69632
  s_nop 0
  buffer_load_dwordx4 v8, s[8:11], s38 offen  lds
  s_add_u32 m0, s45, 73728
  s_nop 0
  buffer_load_dwordx4 v9, s[8:11], s38 offen  lds
  s_add_u32 s39, s37, 1
  s_sub_u32 s40, s39, 10
  s_cmp_ge_u32 s39, 10
  s_cselect_b32 s39, s40, s39
  s_mul_i32 s39, s39, 196608
  s_add_u32 s39, s39, s43
  s_add_u32 m0, s45, 12288
  s_nop 0
  buffer_load_dwordx4 v12, s[12:15], s39 offen  lds
  s_add_u32 m0, s45, 16384
  s_nop 0
  buffer_load_dwordx4 v13, s[12:15], s39 offen  lds
  s_add_u32 m0, s45, 20480
  s_nop 0
  buffer_load_dwordx4 v14, s[12:15], s39 offen  lds
  s_waitcnt vmcnt(5)
  s_barrier
  s_add_u32 s38, s37, 2
  s_sub_u32 s40, s38, 10
  s_cmp_ge_u32 s38, 10
  s_cselect_b32 s38, s40, s38
  s_lshl_b32 s38, s38, 7
  s_add_u32 m0, s45, 77824
  s_nop 0
  buffer_load_dwordx4 v8, s[8:11], s38 offen  lds
  s_add_u32 m0, s45, 81920
  s_nop 0
  buffer_load_dwordx4 v9, s[8:11], s38 offen  lds
  s_add_u32 s39, s37, 2
  s_sub_u32 s40, s39, 10
  s_cmp_ge_u32 s39, 10
  s_cselect_b32 s39, s40, s39
  s_mul_i32 s39, s39, 196608
  s_add_u32 s39, s39, s43
  s_add_u32 m0, s45, 24576
  s_nop 0
  buffer_load_dwordx4 v12, s[12:15], s39 offen  lds
  s_add_u32 m0, s45, 28672
  s_nop 0
  buffer_load_dwordx4 v13, s[12:15], s39 offen  lds
  s_add_u32 m0, s45, 32768
  s_nop 0
  buffer_load_dwordx4 v14, s[12:15], s39 offen  lds
  s_add_u32 s38, s37, 3
  s_sub_u32 s40, s38, 10
  s_cmp_ge_u32 s38, 10
  s_cselect_b32 s38, s40, s38
  s_lshl_b32 s38, s38, 7
  s_add_u32 m0, s45, 86016
  s_nop 0
  buffer_load_dwordx4 v8, s[8:11], s38 offen  lds
  s_add_u32 m0, s45, 90112
  s_nop 0
  buffer_load_dwordx4 v9, s[8:11], s38 offen  lds
  s_add_u32 s39, s37, 3
  s_sub_u32 s40, s39, 10
  s_cmp_ge_u32 s39, 10
  s_cselect_b32 s39, s40, s39
  s_mul_i32 s39, s39, 196608
  s_add_u32 s39, s39, s43
  s_add_u32 m0, s45, 36864
  s_nop 0
  buffer_load_dwordx4 v12, s[12:15], s39 offen  lds
  s_add_u32 m0, s45, 40960
  s_nop 0
  buffer_load_dwordx4 v13, s[12:15], s39 offen  lds
  s_add_u32 m0, s45, 45056
  s_nop 0
  buffer_load_dwordx4 v14, s[12:15], s39 offen  lds
  s_waitcnt vmcnt(10)
  s_barrier
  s_add_u32 s38, s37, 4
  s_sub_u32 s40, s38, 10
  s_cmp_ge_u32 s38, 10
  s_cselect_b32 s38, s40, s38
  s_lshl_b32 s38, s38, 7
  s_add_u32 m0, s45, 94208
  s_nop 0
  buffer_load_dwordx4 v8, s[8:11], s38 offen  lds
  s_add_u32 m0, s45, 98304
  s_nop 0
  buffer_load_dwordx4 v9, s[8:11], s38 offen  lds
  s_add_u32 s39, s37, 4
  s_sub_u32 s40, s39, 10
  s_cmp_ge_u32 s39, 10
  s_cselect_b32 s39, s40, s39
  s_mul_i32 s39, s39, 196608
  s_add_u32 s39, s39, s43
  s_add_u32 m0, s45, 49152
  s_nop 0
  buffer_load_dwordx4 v12, s[12:15], s39 offen  lds
  s_add_u32 m0, s45, 53248
  s_nop 0
  buffer_load_dwordx4 v13, s[12:15], s39 offen  lds
  s_add_u32 m0, s45, 57344
  s_nop 0
  buffer_load_dwordx4 v14, s[12:15], s39 offen  lds
  s_add_u32 s38, s37, 5
  s_sub_u32 s40, s38, 10
  s_cmp_ge_u32 s38, 10
  s_cselect_b32 s38, s40, s38
  s_lshl_b32 s38, s38, 7
  s_add_u32 m0, s45, 102400
  s_nop 0
  buffer_load_dwordx4 v8, s[8:11], s38 offen  lds
  s_add_u32 m0, s45, 106496
  s_nop 0
  buffer_load_dwordx4 v9, s[8:11], s38 offen  lds
  s_waitcnt vmcnt(12)
  s_barrier
  s_add_u32 s38, s37, 6
  s_sub_u32 s40, s38, 10
  s_cmp_ge_u32 s38, 10
  s_cselect_b32 s38, s40, s38
  s_lshl_b32 s38, s38, 7
  s_add_u32 m0, s45, 110592
  s_nop 0
  buffer_load_dwordx4 v8, s[8:11], s38 offen  lds
  s_add_u32 m0, s45, 114688
  s_nop 0
  buffer_load_dwordx4 v9, s[8:11], s38 offen  lds
  s_add_u32 s39, s37, 5
  s_sub_u32 s40, s39, 10
  s_cmp_ge_u32 s39, 10
  s_cselect_b32 s39, s40, s39
  s_mul_i32 s39, s39, 196608
  s_add_u32 s39, s39, s43
  s_add_u32 m0, s45, 0
  s_nop 0
  buffer_load_dwordx4 v12, s[12:15], s39 offen  lds
  s_add_u32 m0, s45, 4096
  s_nop 0
  buffer_load_dwordx4 v13, s[12:15], s39 offen  lds
  s_add_u32 m0, s45, 8192
  s_nop 0
  buffer_load_dwordx4 v14, s[12:15], s39 offen  lds
  s_add_u32 s38, s37, 7
  s_sub_u32 s40, s38, 10
  s_cmp_ge_u32 s38, 10
  s_cselect_b32 s38, s40, s38
  s_lshl_b32 s38, s38, 7
  s_add_u32 m0, s45, 118784
  s_nop 0
  buffer_load_dwordx4 v8, s[8:11], s38 offen  lds
  s_add_u32 m0, s45, 122880
  s_nop 0
  buffer_load_dwordx4 v9, s[8:11], s38 offen  lds
  s_waitcnt vmcnt(14)
  s_barrier
  s_add_u32 s38, s37, 8
  s_sub_u32 s40, s38, 10
  s_cmp_ge_u32 s38, 10
  s_cselect_b32 s38, s40, s38
  s_lshl_b32 s38, s38, 7
  s_add_u32 m0, s45, 126976
  s_nop 0
  buffer_load_dwordx4 v8, s[8:11], s38 offen  lds
  s_add_u32 m0, s45, 131072
  s_nop 0
  buffer_load_dwordx4 v9, s[8:11], s38 offen  lds
  s_add_u32 s39, s37, 6
  s_sub_u32 s40, s39, 10
  s_cmp_ge_u32 s39, 10
  s_cselect_b32 s39, s40, s39
  s_mul_i32 s39, s39, 196608
  s_add_u32 s39, s39, s43
  s_add_u32 m0, s45, 12288
  s_nop 0
  buffer_load_dwordx4 v12, s[12:15], s39 offen  lds
  s_add_u32 m0, s45, 16384
  s_nop 0
  buffer_load_dwordx4 v13, s[12:15], s39 offen  lds
  s_add_u32 m0, s45, 20480
  s_nop 0
  buffer_load_dwordx4 v14, s[12:15], s39 offen  lds
  s_add_u32 s38, s37, 9
  s_sub_u32 s40, s38, 10
  s_cmp_ge_u32 s38, 10
  s_cselect_b32 s38, s40, s38
  s_lshl_b32 s38, s38, 7
  s_add_u32 m0, s45, 135168
  s_nop 0
  buffer_load_dwordx4 v8, s[8:11], s38 offen  lds
  s_add_u32 m0, s45, 139264
  s_nop 0
  buffer_load_dwordx4 v9, s[8:11], s38 offen  lds
  s_waitcnt vmcnt(16)
  s_barrier
  s_add_u32 s39, s37, 7
  s_sub_u32 s40, s39, 10
  s_cmp_ge_u32 s39, 10
  s_cselect_b32 s39, s40, s39
  s_mul_i32 s39, s39, 196608
  s_add_u32 s39, s39, s43
  s_add_u32 m0, s45, 24576
  s_nop 0
  buffer_load_dwordx4 v12, s[12:15], s39 offen  lds
  s_add_u32 m0, s45, 28672
  s_nop 0
  buffer_load_dwordx4 v13, s[12:15], s39 offen  lds
  s_add_u32 m0, s45, 32768
  s_nop 0
  buffer_load_dwordx4 v14, s[12:15], s39 offen  lds
  s_waitcnt vmcnt(12)
  s_barrier
  s_add_u32 s39, s37, 8
  s_sub_u32 s40, s39, 10
  s_cmp_ge_u32 s39, 10
  s_cselect_b32 s39, s40, s39
  s_mul_i32 s39, s39, 196608
  s_add_u32 s39, s39, s43
  s_add_u32 m0, s45, 36864
  s_nop 0
  buffer_load_dwordx4 v12, s[12:15], s39 offen  lds
  s_add_u32 m0, s45, 40960
  s_nop 0
  buffer_load_dwordx4 v13, s[12:15], s39 offen  lds
  s_add_u32 m0, s45, 45056
  s_nop 0
  buffer_load_dwordx4 v14, s[12:15], s39 offen  lds
  s_add_u32 s39, s37, 9
  s_sub_u32 s40, s39, 10
  s_cmp_ge_u32 s39, 10
  s_cselect_b32 s39, s40, s39
  s_mul_i32 s39, s39, 196608
  s_add_u32 s39, s39, s43
  s_add_u32 m0, s45, 49152
  s_nop 0
  buffer_load_dwordx4 v12, s[12:15], s39 offen  lds
  s_add_u32 m0, s45, 53248
  s_nop 0
  buffer_load_dwordx4 v13, s[12:15], s39 offen  lds
  s_add_u32 m0, s45, 57344
  s_nop 0
  buffer_load_dwordx4 v14, s[12:15], s39 offen  lds
  s_waitcnt vmcnt(11)
  s_barrier
  s_add_u32 s39, s37, 0
  s_sub_u32 s40, s39, 10
  s_cmp_ge_u32 s39, 10
  s_cselect_b32 s39, s40, s39
  s_mul_i32 s39, s39, 196608
  s_add_u32 s39, s39, s44
  s_add_u32 m0, s45, 0
  s_nop 0
  buffer_load_dwordx4 v12, s[12:15], s39 offen  lds
  s_add_u32 m0, s45, 4096
  s_nop 0
  buffer_load_dwordx4 v13, s[12:15], s39 offen  lds
  s_add_u32 m0, s45, 8192
  s_nop 0
  buffer_load_dwordx4 v14, s[12:15], s39 offen  lds
  s_waitcnt vmcnt(9)
  s_barrier
  s_add_u32 s39, s37, 1
  s_sub_u32 s40, s39, 10
  s_cmp_ge_u32 s39, 10
  s_cselect_b32 s39, s40, s39
  s_mul_i32 s39, s39, 196608
  s_add_u32 s39, s39, s44
  s_add_u32 m0, s45, 12288
  s_nop 0
  buffer_load_dwordx4 v12, s[12:15], s39 offen  lds
  s_add_u32 m0, s45, 16384
  s_nop 0
  buffer_load_dwordx4 v13, s[12:15], s39 offen  lds
  s_add_u32 m0, s45, 20480
  s_nop 0
  buffer_load_dwordx4 v14, s[12:15], s39 offen  lds
  s_waitcnt vmcnt(9)
  s_barrier
  s_add_u32 s39, s37, 2
  s_sub_u32 s40, s39, 10
  s_cmp_ge_u32 s39, 10
  s_cselect_b32 s39, s40, s39
  s_mul_i32 s39, s39, 196608
  s_add_u32 s39, s39, s44
  s_add_u32 m0, s45, 24576
  s_nop 0
  buffer_load_dwordx4 v12, s[12:15], s39 offen  lds
  s_add_u32 m0, s45, 28672
  s_nop 0
  buffer_load_dwordx4 v13, s[12:15], s39 offen  lds
  s_add_u32 m0, s45, 32768
  s_nop 0
  buffer_load_dwordx4 v14, s[12:15], s39 offen  lds
  s_waitcnt vmcnt(9)
  s_barrier
  s_add_u32 s39, s37, 3
  s_sub_u32 s40, s39, 10
  s_cmp_ge_u32 s39, 10
  s_cselect_b32 s39, s40, s39
  s_mul_i32 s39, s39, 196608
  s_add_u32 s39, s39, s44
  s_add_u32 m0, s45, 36864
  s_nop 0
  buffer_load_dwordx4 v12, s[12:15], s39 offen  lds
  s_add_u32 m0, s45, 40960
  s_nop 0
  buffer_load_dwordx4 v13, s[12:15], s39 offen  lds
  s_add_u32 m0, s45, 45056
  s_nop 0
  buffer_load_dwordx4 v14, s[12:15], s39 offen  lds
  s_waitcnt vmcnt(9)
  s_barrier
  s_add_u32 s39, s37, 4
  s_sub_u32 s40, s39, 10
  s_cmp_ge_u32 s39, 10
  s_cselect_b32 s39, s40, s39
  s_mul_i32 s39, s39, 196608
  s_add_u32 s39, s39, s44
  s_add_u32 m0, s45, 49152
  s_nop 0
  buffer_load_dwordx4 v12, s[12:15], s39 offen  lds
  s_add_u32 m0, s45, 53248
  s_nop 0
  buffer_load_dwordx4 v13, s[12:15], s39 offen  lds
  s_add_u32 m0, s45, 57344
  s_nop 0
  buffer_load_dwordx4 v14, s[12:15], s39 offen  lds
  v_mul_u32_u24 v5, 6554, v1
  v_lshrrev_b32 v5, 16, v5
  v_mul_u32_u24 v4, 10, v5
  v_sub_u32 v4, v1, v4
  v_lshlrev_b32 v4, 4, v4
  v_mul_u32_u24 v30, 1280, v5
  v_add_u32 v4, v4, v30
  s_mov_b32 s20, s58
  s_and_b32 s21, s59, 0xffff
  s_mov_b32 s22, 2621440
  s_mov_b32 s23, 0x20000
  s_mov_b32 s24, s60
  s_and_b32 s25, s61, 0xffff
  s_mov_b32 s26, 2621440
  s_mov_b32 s27, 0x20000
  s_lshl_b32 s40, s32, 6
  s_lshl_b32 s41, s55, 4
  s_add_u32 s40, s40, s41
  s_mul_i32 s46, s40, 1280
  s_mul_i32 s41, s33, 160
  s_add_u32 s46, s46, s41
  s_mul_i32 s78, s55, 6720
  s_add_u32 s78, s78, 61440
  v_mov_b32 v20, v4
  s_sub_u32 s79, s46, 3840
  s_cmp_eq_u32 s40, 0
  s_cbranch_scc0 K1_NONNEG
  v_subrev_u32 v20, 3840, v4
  v_cmp_gt_u32 vcc, 3, v5
  v_mov_b32 v31, 0x80000000
  s_nop 0
  v_cndmask_b32 v20, v20, v31, vcc
  s_mov_b32 s79, s46
K1_NONNEG:
  s_mov_b32 s28, s62
  s_and_b32 s29, s63, 0xffff
  s_mov_b32 s30, 5120
  s_mov_b32 s31, 0x20000
  v_lshlrev_b32 v21, 4, v1
  s_mul_i32 s54, s33, 640
  s_waitcnt vmcnt(9)
  s_barrier
  s_add_u32 s39, s37, 5
  s_sub_u32 s40, s39, 10
  s_cmp_ge_u32 s39, 10
  s_cselect_b32 s39, s40, s39
  s_mul_i32 s39, s39, 196608
  s_add_u32 s39, s39, s44
  s_add_u32 m0, s45, 0
  s_nop 0
  buffer_load_dwordx4 v12, s[12:15], s39 offen  lds
  s_add_u32 m0, s45, 4096
  s_nop 0
  buffer_load_dwordx4 v13, s[12:15], s39 offen  lds
  s_add_u32 m0, s45, 8192
  s_nop 0
  buffer_load_dwordx4 v14, s[12:15], s39 offen  lds
  s_waitcnt vmcnt(9)
  s_barrier
  s_add_u32 s39, s37, 6
  s_sub_u32 s40, s39, 10
  s_cmp_ge_u32 s39, 10
  s_cselect_b32 s39, s40, s39
  s_mul_i32 s39, s39, 196608
  s_add_u32 s39, s39, s44
  s_add_u32 m0, s45, 12288
  s_nop 0
  buffer_load_dwordx4 v12, s[12:15], s39 offen  lds
  s_add_u32 m0, s45, 16384
  s_nop 0
  buffer_load_dwordx4 v13, s[12:15], s39 offen  lds
  s_add_u32 m0, s45, 20480
  s_nop 0
  buffer_load_dwordx4 v14, s[12:15], s39 offen  lds
  s_waitcnt vmcnt(9)
  s_barrier
  s_add_u32 s39, s37, 7
  s_sub_u32 s40, s39, 10
  s_cmp_ge_u32 s39, 10
  s_cselect_b32 s39, s40, s39
  s_mul_i32 s39, s39, 196608
  s_add_u32 s39, s39, s44
  s_add_u32 m0, s45, 24576
  s_nop 0
  buffer_load_dwordx4 v12, s[12:15], s39 offen  lds
  s_add_u32 m0, s45, 28672
  s_nop 0
  buffer_load_dwordx4 v13, s[12:15], s39 offen  lds
  s_add_u32 m0, s45, 32768
  s_nop 0
  buffer_load_dwordx4 v14, s[12:15], s39 offen  lds
  s_waitcnt vmcnt(9)
  s_barrier
  s_add_u32 s39, s37, 8
  s_sub_u32 s40, s39, 10
  s_cmp_ge_u32 s39, 10
  s_cselect_b32 s39, s40, s39
  s_mul_i32 s39, s39, 196608
  s_add_u32 s39, s39, s44
  s_add_u32 m0, s45, 36864
  s_nop 0
  buffer_load_dwordx4 v12, s[12:15], s39 offen  lds
  s_add_u32 m0, s45, 40960
  s_nop 0
  buffer_load_dwordx4 v13, s[12:15], s39 offen  lds
  s_add_u32 m0, s45, 45056
  s_nop 0
  buffer_load_dwordx4 v14, s[12:15], s39 offen  lds
  s_waitcnt vmcnt(9)
  s_barrier
  s_add_u32 s39, s37, 9
  s_sub_u32 s40, s39, 10
  s_cmp_ge_u32 s39, 10
  s_cselect_b32 s39, s40, s39
  s_mul_i32 s39, s39, 196608
  s_add_u32 s39, s39, s44
  s_add_u32 m0, s45, 49152
  s_nop 0
  buffer_load_dwordx4 v12, s[12:15], s39 offen  lds
  s_add_u32 m0, s45, 53248
  s_nop 0
  buffer_load_dwordx4 v13, s[12:15], s39 offen  lds
  s_add_u32 m0, s45, 57344
  s_nop 0
  buffer_load_dwordx4 v14, s[12:15], s39 offen  lds
  s_mov_b32 exec_lo, 0xffffffff
  s_mov_b32 exec_hi, 0xfffffff
  s_add_u32 m0, s78, 0
  s_nop 0
  buffer_load_dwordx4 v20, s[20:23], s79 offen  lds
  s_add_u32 m0, s78, 960
  s_add_u32 s79, s46, 3840
  buffer_load_dwordx4 v4, s[20:23], s79 offen  lds
  s_add_u32 m0, s78, 1920
  s_add_u32 s79, s46, 11520
  buffer_load_dwordx4 v4, s[20:23], s79 offen  lds
  s_add_u32 m0, s78, 2880
  s_add_u32 s79, s46, 19200
  buffer_load_dwordx4 v4, s[20:23], s79 offen  lds
  s_add_u32 m0, s78, 3840
  s_add_u32 s79, s46, 0
  buffer_load_dwordx4 v4, s[24:27], s79 offen  lds
  s_add_u32 m0, s78, 4800
  s_add_u32 s79, s46, 7680
  buffer_load_dwordx4 v4, s[24:27], s79 offen  lds
  s_add_u32 m0, s78, 5760
  s_add_u32 s79, s46, 15360
  buffer_load_dwordx4 v4, s[24:27], s79 offen  lds
  s_mov_b64 exec, s[52:53]
  buffer_load_dwordx4 v[156:159], v21, s[28:31], s54 offen
  s_waitcnt vmcnt(17)
  s_barrier
  s_waitcnt vmcnt(14)
  s_barrier
  s_waitcnt vmcnt(11)
  s_barrier
  s_waitcnt vmcnt(8)
  s_barrier
  s_waitcnt vmcnt(0)
  v_lshlrev_b32 v30, 2, v1
  v_min_u32 v30, 156, v30
  v_add_u32 v30, s78, v30
  ds_read_b32 v40, v30 offset:0
  ds_read_b32 v41, v30 offset:160
  ds_read_b32 v42, v30 offset:320
  ds_read_b32 v43, v30 offset:480
  ds_read_b32 v44, v30 offset:640
  ds_read_b32 v45, v30 offset:800
  ds_read_b32 v46, v30 offset:960
  ds_read_b32 v47, v30 offset:1120
  ds_read_b32 v48, v30 offset:1280
  ds_read_b32 v49, v30 offset:1440
  ds_read_b32 v50, v30 offset:1600
  ds_read_b32 v51, v30 offset:1760
  ds_read_b32 v52, v30 offset:1920
  ds_read_b32 v53, v30 offset:2080
  s_waitcnt lgkmcnt(6)
  ds_read_b32 v54, v30 offset:2240
  ds_read_b32 v55, v30 offset:2400
  ds_read_b32 v56, v30 offset:2560
  ds_read_b32 v57, v30 offset:2720
  ds_read_b32 v58, v30 offset:2880
  s_barrier
  ds_read_b32 v59, v30 offset:3840
  ds_read_b32 v60, v30 offset:4000
  s_waitcnt lgkmcnt(6)
  ds_read_b32 v61, v30 offset:4160
  ds_read_b32 v62, v30 offset:4320
  ds_read_b32 v63, v30 offset:4480
  ds_read_b32 v64, v30 offset:4640
  ds_read_b32 v65, v30 offset:4800
  ds_read_b32 v66, v30 offset:4960
  ds_read_b32 v67, v30 offset:5120
  ds_read_b32 v68, v30 offset:5280
  s_waitcnt lgkmcnt(6)
  ds_read_b32 v69, v30 offset:5440
  ds_read_b32 v70, v30 offset:5600
  ds_read_b32 v71, v30 offset:5760
  ds_read_b32 v72, v30 offset:5920
  ds_read_b32 v73, v30 offset:6080
  ds_read_b32 v74, v30 offset:6240
  v_lshlrev_b32 v114, 16, v156
  v_lshlrev_b32 v115, 16, v158
  v_and_b32 v116, s47, v156
  v_and_b32 v117, s47, v158
  v_lshlrev_b32 v118, 16, v157
  v_lshlrev_b32 v119, 16, v159
  v_and_b32 v120, s47, v157
  v_and_b32 v121, s47, v159
  s_waitcnt lgkmcnt(0)
  s_barrier
  v_lshlrev_b32 v76, 16, v40
  v_and_b32 v77, s47, v40
  v_lshlrev_b32 v78, 16, v41
  v_and_b32 v79, s47, v41
  v_lshlrev_b32 v80, 16, v42
  v_and_b32 v81, s47, v42
  v_lshlrev_b32 v82, 16, v43
  v_and_b32 v83, s47, v43
  v_lshlrev_b32 v84, 16, v44
  v_and_b32 v85, s47, v44
  v_lshlrev_b32 v86, 16, v45
  v_and_b32 v87, s47, v45
  v_lshlrev_b32 v88, 16, v46
  v_and_b32 v89, s47, v46
  v_lshlrev_b32 v90, 16, v47
  v_and_b32 v91, s47, v47
  v_lshlrev_b32 v92, 16, v48
  v_and_b32 v93, s47, v48
  v_lshlrev_b32 v94, 16, v49
  v_and_b32 v95, s47, v49
  v_lshlrev_b32 v96, 16, v50
  v_and_b32 v97, s47, v50
  v_lshlrev_b32 v98, 16, v51
  v_and_b32 v99, s47, v51
  v_lshlrev_b32 v100, 16, v52
  v_and_b32 v101, s47, v52
  v_lshlrev_b32 v102, 16, v53
  v_and_b32 v103, s47, v53
  v_lshlrev_b32 v104, 16, v54
  v_and_b32 v105, s47, v54
  v_lshlrev_b32 v106, 16, v55
  v_and_b32 v107, s47, v55
  v_lshlrev_b32 v108, 16, v56
  v_and_b32 v109, s47, v56
  v_lshlrev_b32 v110, 16, v57
  v_and_b32 v111, s47, v57
  v_lshlrev_b32 v112, 16, v58
  v_and_b32 v113, s47, v58
  v_pk_mul_f32 v[122:123], v[120:121], v[76:77]
  v_lshlrev_b32 v32, 16, v59
  v_pk_fma_f32 v[122:123], v[118:119], v[78:79], v[122:123]
  v_and_b32 v33, s47, v59
  v_pk_fma_f32 v[122:123], v[116:117], v[80:81], v[122:123]
  v_pk_fma_f32 v[122:123], v[114:115], v[82:83], v[122:123]
  v_pk_mul_f32 v[122:123], v[122:123], v[32:33]
  v_pk_mul_f32 v[124:125], v[120:121], v[78:79]
  v_lshlrev_b32 v32, 16, v60
  v_pk_fma_f32 v[124:125], v[118:119], v[80:81], v[124:125]
  v_and_b32 v33, s47, v60
  v_pk_fma_f32 v[124:125], v[116:117], v[82:83], v[124:125]
  v_pk_fma_f32 v[124:125], v[114:115], v[84:85], v[124:125]
  v_pk_mul_f32 v[124:125], v[124:125], v[32:33]
  v_pk_mul_f32 v[126:127], v[120:121], v[80:81]
  v_lshlrev_b32 v32, 16, v61
  v_pk_fma_f32 v[126:127], v[118:119], v[82:83], v[126:127]
  v_and_b32 v33, s47, v61
  v_pk_fma_f32 v[126:127], v[116:117], v[84:85], v[126:127]
  v_pk_fma_f32 v[126:127], v[114:115], v[86:87], v[126:127]
  v_pk_mul_f32 v[126:127], v[126:127], v[32:33]
  v_pk_mul_f32 v[128:129], v[120:121], v[82:83]
  v_lshlrev_b32 v32, 16, v62
  v_pk_fma_f32 v[128:129], v[118:119], v[84:85], v[128:129]
  v_and_b32 v33, s47, v62
  v_pk_fma_f32 v[128:129], v[116:117], v[86:87], v[128:129]
  v_pk_fma_f32 v[128:129], v[114:115], v[88:89], v[128:129]
  v_pk_mul_f32 v[128:129], v[128:129], v[32:33]
  v_pk_mul_f32 v[130:131], v[120:121], v[84:85]
  v_lshlrev_b32 v32, 16, v63
  v_pk_fma_f32 v[130:131], v[118:119], v[86:87], v[130:131]
  v_and_b32 v33, s47, v63
  v_pk_fma_f32 v[130:131], v[116:117], v[88:89], v[130:131]
  v_pk_fma_f32 v[130:131], v[114:115], v[90:91], v[130:131]
  v_pk_mul_f32 v[130:131], v[130:131], v[32:33]
  v_pk_mul_f32 v[132:133], v[120:121], v[86:87]
  v_lshlrev_b32 v32, 16, v64
  v_pk_fma_f32 v[132:133], v[118:119], v[88:89], v[132:133]
  v_and_b32 v33, s47, v64
  v_pk_fma_f32 v[132:133], v[116:117], v[90:91], v[132:133]
  v_pk_fma_f32 v[132:133], v[114:115], v[92:93], v[132:133]
  v_pk_mul_f32 v[132:133], v[132:133], v[32:33]
  v_pk_mul_f32 v[134:135], v[120:121], v[88:89]
  v_lshlrev_b32 v32, 16, v65
  v_pk_fma_f32 v[134:135], v[118:119], v[90:91], v[134:135]
  v_and_b32 v33, s47, v65
  v_pk_fma_f32 v[134:135], v[116:117], v[92:93], v[134:135]
  v_pk_fma_f32 v[134:135], v[114:115], v[94:95], v[134:135]
  v_pk_mul_f32 v[134:135], v[134:135], v[32:33]
  v_pk_mul_f32 v[136:137], v[120:121], v[90:91]
  v_lshlrev_b32 v32, 16, v66
  v_pk_fma_f32 v[136:137], v[118:119], v[92:93], v[136:137]
  v_and_b32 v33, s47, v66
  v_pk_fma_f32 v[136:137], v[116:117], v[94:95], v[136:137]
  v_pk_fma_f32 v[136:137], v[114:115], v[96:97], v[136:137]
  v_pk_mul_f32 v[136:137], v[136:137], v[32:33]
  v_pk_mul_f32 v[138:139], v[120:121], v[92:93]
  v_lshlrev_b32 v32, 16, v67
  v_pk_fma_f32 v[138:139], v[118:119], v[94:95], v[138:139]
  v_and_b32 v33, s47, v67
  v_pk_fma_f32 v[138:139], v[116:117], v[96:97], v[138:139]
  v_pk_fma_f32 v[138:139], v[114:115], v[98:99], v[138:139]
  v_pk_mul_f32 v[138:139], v[138:139], v[32:33]
  v_pk_mul_f32 v[140:141], v[120:121], v[94:95]
  v_lshlrev_b32 v32, 16, v68
  v_pk_fma_f32 v[140:141], v[118:119], v[96:97], v[140:141]
  v_and_b32 v33, s47, v68
  v_pk_fma_f32 v[140:141], v[116:117], v[98:99], v[140:141]
  v_pk_fma_f32 v[140:141], v[114:115], v[100:101], v[140:141]
  v_pk_mul_f32 v[140:141], v[140:141], v[32:33]
  v_pk_mul_f32 v[142:143], v[120:121], v[96:97]
  v_lshlrev_b32 v32, 16, v69
  v_pk_fma_f32 v[142:143], v[118:119], v[98:99], v[142:143]
  v_and_b32 v33, s47, v69
  v_pk_fma_f32 v[142:143], v[116:117], v[100:101], v[142:143]
  v_pk_fma_f32 v[142:143], v[114:115], v[102:103], v[142:143]
  v_pk_mul_f32 v[142:143], v[142:143], v[32:33]
  v_pk_mul_f32 v[144:145], v[120:121], v[98:99]
  v_lshlrev_b32 v32, 16, v70
  v_pk_fma_f32 v[144:145], v[118:119], v[100:101], v[144:145]
  v_and_b32 v33, s47, v70
  v_pk_fma_f32 v[144:145], v[116:117], v[102:103], v[144:145]
  v_pk_fma_f32 v[144:145], v[114:115], v[104:105], v[144:145]
  v_pk_mul_f32 v[144:145], v[144:145], v[32:33]
  v_pk_mul_f32 v[146:147], v[120:121], v[100:101]
  v_lshlrev_b32 v32, 16, v71
  v_pk_fma_f32 v[146:147], v[118:119], v[102:103], v[146:147]
  v_and_b32 v33, s47, v71
  v_pk_fma_f32 v[146:147], v[116:117], v[104:105], v[146:147]
  v_pk_fma_f32 v[146:147], v[114:115], v[106:107], v[146:147]
  v_pk_mul_f32 v[146:147], v[146:147], v[32:33]
  v_pk_mul_f32 v[148:149], v[120:121], v[102:103]
  v_lshlrev_b32 v32, 16, v72
  v_pk_fma_f32 v[148:149], v[118:119], v[104:105], v[148:149]
  v_and_b32 v33, s47, v72
  v_pk_fma_f32 v[148:149], v[116:117], v[106:107], v[148:149]
  v_pk_fma_f32 v[148:149], v[114:115], v[108:109], v[148:149]
  v_pk_mul_f32 v[148:149], v[148:149], v[32:33]
  v_pk_mul_f32 v[150:151], v[120:121], v[104:105]
  v_lshlrev_b32 v32, 16, v73
  v_pk_fma_f32 v[150:151], v[118:119], v[106:107], v[150:151]
  v_and_b32 v33, s47, v73
  v_pk_fma_f32 v[150:151], v[116:117], v[108:109], v[150:151]
  v_pk_fma_f32 v[150:151], v[114:115], v[110:111], v[150:151]
  v_pk_mul_f32 v[150:151], v[150:151], v[32:33]
  v_pk_mul_f32 v[152:153], v[120:121], v[106:107]
  v_lshlrev_b32 v32, 16, v74
  v_pk_fma_f32 v[152:153], v[118:119], v[108:109], v[152:153]
  v_and_b32 v33, s47, v74
  v_pk_fma_f32 v[152:153], v[116:117], v[110:111], v[152:153]
  v_pk_fma_f32 v[152:153], v[114:115], v[112:113], v[152:153]
  v_pk_mul_f32 v[152:153], v[152:153], v[32:33]
  v_cvt_pk_bf16_f32 v40, v136, v134
  v_cvt_pk_bf16_f32 v41, v132, v130
  v_cvt_pk_bf16_f32 v42, v128, v126
  v_cvt_pk_bf16_f32 v43, v124, v122
  v_cvt_pk_bf16_f32 v44, v152, v150
  v_cvt_pk_bf16_f32 v45, v148, v146
  v_cvt_pk_bf16_f32 v46, v144, v142
  v_cvt_pk_bf16_f32 v47, v140, v138
  v_cvt_pk_bf16_f32 v48, v137, v135
  v_cvt_pk_bf16_f32 v49, v133, v131
  v_cvt_pk_bf16_f32 v50, v129, v127
  v_cvt_pk_bf16_f32 v51, v125, v123
  v_cvt_pk_bf16_f32 v52, v153, v151
  v_cvt_pk_bf16_f32 v53, v149, v147
  v_cvt_pk_bf16_f32 v54, v145, v143
  v_cvt_pk_bf16_f32 v55, v141, v139
  v_mul_u32_u24 v30, 288, v1
  s_lshl_b32 s40, s55, 5
  s_add_u32 s40, s40, 49152
  v_add_u32 v30, s40, v30
  s_mov_b32 exec_lo, 0xffffffff
  s_mov_b32 exec_hi, 0xff
  ds_write_b128 v30, v[40:43] offset:0
  ds_write_b128 v30, v[44:47] offset:16
  ds_write_b128 v30, v[48:51] offset:144
  ds_write_b128 v30, v[52:55] offset:160
  s_mov_b64 exec, s[52:53]
  s_load_dwordx2 s[56:57], s[0:1], 64
  s_load_dwordx2 s[60:61], s[0:1], 104
  s_lshl_b32 s40, s32, 6
  s_lshl_b32 s41, s55, 4
  s_add_u32 s40, s40, s41
  v_add_u32 v10, 0, v2
  v_xor_b32 v11, v10, v3
  v_lshlrev_b32 v11, 4, v11
  v_add_u32 v10, s40, v10
  v_lshlrev_b32 v10, 12, v10
  v_add_u32 v4, v10, v11
  v_add_u32 v10, 4, v2
  v_xor_b32 v11, v10, v3
  v_lshlrev_b32 v11, 4, v11
  v_add_u32 v10, s40, v10
  v_lshlrev_b32 v10, 12, v10
  v_add_u32 v5, v10, v11
  v_add_u32 v10, 8, v2
  v_xor_b32 v11, v10, v3
  v_lshlrev_b32 v11, 4, v11
  v_add_u32 v10, s40, v10
  v_lshlrev_b32 v10, 12, v10
  v_add_u32 v6, v10, v11
  v_add_u32 v10, 12, v2
  v_xor_b32 v11, v10, v3
  v_lshlrev_b32 v11, 4, v11
  v_add_u32 v10, s40, v10
  v_lshlrev_b32 v10, 12, v10
  v_add_u32 v7, v10, v11
  s_lshl_b32 s39, s55, 12
  s_waitcnt lgkmcnt(0)
  s_mov_b32 s8, s56
  s_and_b32 s9, s57, 0xffff
  s_mov_b32 s10, 8388608
  s_mov_b32 s11, 0x20000
  s_mov_b32 s16, s60
  s_and_b32 s17, s61, 0xffff
  s_mov_b32 s18, 18874368
  s_mov_b32 s19, 0x20000
  s_waitcnt lgkmcnt(0)
  s_barrier
  s_movk_i32 s38, 0
  s_add_u32 m0, s39, 0
  s_nop 0
  buffer_load_dwordx4 v4, s[8:11], s38 offen  lds
  s_add_u32 m0, s39, 1024
  s_nop 0
  buffer_load_dwordx4 v5, s[8:11], s38 offen  lds
  s_add_u32 m0, s39, 2048
  s_nop 0
  buffer_load_dwordx4 v6, s[8:11], s38 offen  lds
  s_add_u32 m0, s39, 3072
  s_nop 0
  buffer_load_dwordx4 v7, s[8:11], s38 offen  lds
  s_movk_i32 s38, 256
  s_add_u32 m0, s39, 16384
  s_nop 0
  buffer_load_dwordx4 v4, s[8:11], s38 offen  lds
  s_add_u32 m0, s39, 17408
  s_nop 0
  buffer_load_dwordx4 v5, s[8:11], s38 offen  lds
  s_add_u32 m0, s39, 18432
  s_nop 0
  buffer_load_dwordx4 v6, s[8:11], s38 offen  lds
  s_add_u32 m0, s39, 19456
  s_nop 0
  buffer_load_dwordx4 v7, s[8:11], s38 offen  lds
  s_movk_i32 s38, 512
  s_add_u32 m0, s39, 32768
  s_nop 0
  buffer_load_dwordx4 v4, s[8:11], s38 offen  lds
  s_add_u32 m0, s39, 33792
  s_nop 0
  buffer_load_dwordx4 v5, s[8:11], s38 offen  lds
  s_add_u32 m0, s39, 34816
  s_nop 0
  buffer_load_dwordx4 v6, s[8:11], s38 offen  lds
  s_add_u32 m0, s39, 35840
  s_nop 0
  buffer_load_dwordx4 v7, s[8:11], s38 offen  lds
  s_waitcnt vmcnt(8)
  s_barrier
  s_waitcnt vmcnt(4)
  s_barrier
  s_movk_i32 s38, 768
  s_add_u32 m0, s39, 49152
  s_nop 0
  buffer_load_dwordx4 v4, s[8:11], s38 offen  lds
  s_add_u32 m0, s39, 50176
  s_nop 0
  buffer_load_dwordx4 v5, s[8:11], s38 offen  lds
  s_add_u32 m0, s39, 51200
  s_nop 0
  buffer_load_dwordx4 v6, s[8:11], s38 offen  lds
  s_add_u32 m0, s39, 52224
  s_nop 0
  buffer_load_dwordx4 v7, s[8:11], s38 offen  lds
  s_waitcnt vmcnt(4)
  s_barrier
  s_movk_i32 s38, 1024
  s_add_u32 m0, s39, 0
  s_nop 0
  buffer_load_dwordx4 v4, s[8:11], s38 offen  lds
  s_add_u32 m0, s39, 1024
  s_nop 0
  buffer_load_dwordx4 v5, s[8:11], s38 offen  lds
  s_add_u32 m0, s39, 2048
  s_nop 0
  buffer_load_dwordx4 v6, s[8:11], s38 offen  lds
  s_add_u32 m0, s39, 3072
  s_nop 0
  buffer_load_dwordx4 v7, s[8:11], s38 offen  lds
  s_waitcnt vmcnt(4)
  s_barrier
  s_movk_i32 s38, 1280
  s_add_u32 m0, s39, 16384
  s_nop 0
  buffer_load_dwordx4 v4, s[8:11], s38 offen  lds
  s_add_u32 m0, s39, 17408
  s_nop 0
  buffer_load_dwordx4 v5, s[8:11], s38 offen  lds
  s_add_u32 m0, s39, 18432
  s_nop 0
  buffer_load_dwordx4 v6, s[8:11], s38 offen  lds
  s_add_u32 m0, s39, 19456
  s_nop 0
  buffer_load_dwordx4 v7, s[8:11], s38 offen  lds
  s_waitcnt vmcnt(4)
  s_barrier
  s_movk_i32 s38, 1536
  s_add_u32 m0, s39, 32768
  s_nop 0
  buffer_load_dwordx4 v4, s[8:11], s38 offen  lds
  s_add_u32 m0, s39, 33792
  s_nop 0
  buffer_load_dwordx4 v5, s[8:11], s38 offen  lds
  s_add_u32 m0, s39, 34816
  s_nop 0
  buffer_load_dwordx4 v6, s[8:11], s38 offen  lds
  s_add_u32 m0, s39, 35840
  s_nop 0
  buffer_load_dwordx4 v7, s[8:11], s38 offen  lds
  s_waitcnt vmcnt(4)
  s_barrier
  s_movk_i32 s38, 1792
  s_add_u32 m0, s39, 49152
  s_nop 0
  buffer_load_dwordx4 v4, s[8:11], s38 offen  lds
  s_add_u32 m0, s39, 50176
  s_nop 0
  buffer_load_dwordx4 v5, s[8:11], s38 offen  lds
  s_add_u32 m0, s39, 51200
  s_nop 0
  buffer_load_dwordx4 v6, s[8:11], s38 offen  lds
  s_add_u32 m0, s39, 52224
  s_nop 0
  buffer_load_dwordx4 v7, s[8:11], s38 offen  lds
  s_waitcnt vmcnt(4)
  s_barrier
  s_movk_i32 s38, 2048
  s_add_u32 m0, s39, 0
  s_nop 0
  buffer_load_dwordx4 v4, s[8:11], s38 offen  lds
  s_add_u32 m0, s39, 1024
  s_nop 0
  buffer_load_dwordx4 v5, s[8:11], s38 offen  lds
  s_add_u32 m0, s39, 2048
  s_nop 0
  buffer_load_dwordx4 v6, s[8:11], s38 offen  lds
  s_add_u32 m0, s39, 3072
  s_nop 0
  buffer_load_dwordx4 v7, s[8:11], s38 offen  lds
  s_waitcnt vmcnt(4)
  s_barrier
  s_movk_i32 s38, 2304
  s_add_u32 m0, s39, 16384
  s_nop 0
  buffer_load_dwordx4 v4, s[8:11], s38 offen  lds
  s_add_u32 m0, s39, 17408
  s_nop 0
  buffer_load_dwordx4 v5, s[8:11], s38 offen  lds
  s_add_u32 m0, s39, 18432
  s_nop 0
  buffer_load_dwordx4 v6, s[8:11], s38 offen  lds
  s_add_u32 m0, s39, 19456
  s_nop 0
  buffer_load_dwordx4 v7, s[8:11], s38 offen  lds
  s_waitcnt vmcnt(4)
  s_barrier
  s_movk_i32 s38, 2560
  s_add_u32 m0, s39, 32768
  s_nop 0
  buffer_load_dwordx4 v4, s[8:11], s38 offen  lds
  s_add_u32 m0, s39, 33792
  s_nop 0
  buffer_load_dwordx4 v5, s[8:11], s38 offen  lds
  s_add_u32 m0, s39, 34816
  s_nop 0
  buffer_load_dwordx4 v6, s[8:11], s38 offen  lds
  s_add_u32 m0, s39, 35840
  s_nop 0
  buffer_load_dwordx4 v7, s[8:11], s38 offen  lds
  s_waitcnt vmcnt(4)
  s_barrier
  s_movk_i32 s38, 2816
  s_add_u32 m0, s39, 49152
  s_nop 0
  buffer_load_dwordx4 v4, s[8:11], s38 offen  lds
  s_add_u32 m0, s39, 50176
  s_nop 0
  buffer_load_dwordx4 v5, s[8:11], s38 offen  lds
  s_add_u32 m0, s39, 51200
  s_nop 0
  buffer_load_dwordx4 v6, s[8:11], s38 offen  lds
  s_add_u32 m0, s39, 52224
  s_nop 0
  buffer_load_dwordx4 v7, s[8:11], s38 offen  lds
  s_waitcnt vmcnt(4)
  s_barrier
  s_movk_i32 s38, 3072
  s_add_u32 m0, s39, 0
  s_nop 0
  buffer_load_dwordx4 v4, s[8:11], s38 offen  lds
  s_add_u32 m0, s39, 1024
  s_nop 0
  buffer_load_dwordx4 v5, s[8:11], s38 offen  lds
  s_add_u32 m0, s39, 2048
  s_nop 0
  buffer_load_dwordx4 v6, s[8:11], s38 offen  lds
  s_add_u32 m0, s39, 3072
  s_nop 0
  buffer_load_dwordx4 v7, s[8:11], s38 offen  lds
  s_waitcnt vmcnt(4)
  s_barrier
  s_movk_i32 s38, 3328
  s_add_u32 m0, s39, 16384
  s_nop 0
  buffer_load_dwordx4 v4, s[8:11], s38 offen  lds
  s_add_u32 m0, s39, 17408
  s_nop 0
  buffer_load_dwordx4 v5, s[8:11], s38 offen  lds
  s_add_u32 m0, s39, 18432
  s_nop 0
  buffer_load_dwordx4 v6, s[8:11], s38 offen  lds
  s_add_u32 m0, s39, 19456
  s_nop 0
  buffer_load_dwordx4 v7, s[8:11], s38 offen  lds
  s_waitcnt vmcnt(4)
  s_barrier
  s_movk_i32 s38, 3584
  s_add_u32 m0, s39, 32768
  s_nop 0
  buffer_load_dwordx4 v4, s[8:11], s38 offen  lds
  s_add_u32 m0, s39, 33792
  s_nop 0
  buffer_load_dwordx4 v5, s[8:11], s38 offen  lds
  s_add_u32 m0, s39, 34816
  s_nop 0
  buffer_load_dwordx4 v6, s[8:11], s38 offen  lds
  s_add_u32 m0, s39, 35840
  s_nop 0
  buffer_load_dwordx4 v7, s[8:11], s38 offen  lds
  s_waitcnt vmcnt(4)
  s_barrier
  s_movk_i32 s38, 3840
  s_add_u32 m0, s39, 49152
  s_nop 0
  buffer_load_dwordx4 v4, s[8:11], s38 offen  lds
  s_add_u32 m0, s39, 50176
  s_nop 0
  buffer_load_dwordx4 v5, s[8:11], s38 offen  lds
  s_add_u32 m0, s39, 51200
  s_nop 0
  buffer_load_dwordx4 v6, s[8:11], s38 offen  lds
  s_add_u32 m0, s39, 52224
  s_nop 0
  buffer_load_dwordx4 v7, s[8:11], s38 offen  lds
  s_waitcnt vmcnt(4)
  s_barrier
  s_waitcnt vmcnt(0)
  s_barrier
  s_barrier
  s_barrier
  s_barrier
  s_barrier
  v_lshlrev_b32 v4, 4, v1
  s_mul_i32 s35, s33, 122880
  s_lshl_b32 s40, s55, 10
  s_add_u32 s35, s35, s40
  s_add_u32 s35, s35, 15728640
  s_mul_i32 s36, s55, 5120
  s_add_u32 m0, s36, 0
  s_add_u32 s40, s35, 0
  buffer_load_dwordx4 v4, s[16:19], s40 offen sc1 lds
  s_add_u32 m0, s36, 1024
  s_add_u32 s40, s35, 24576
  buffer_load_dwordx4 v4, s[16:19], s40 offen sc1 lds
  s_add_u32 m0, s36, 2048
  s_add_u32 s40, s35, 49152
  buffer_load_dwordx4 v4, s[16:19], s40 offen sc1 lds
  s_add_u32 m0, s36, 3072
  s_add_u32 s40, s35, 73728
  buffer_load_dwordx4 v4, s[16:19], s40 offen sc1 lds
  s_add_u32 m0, s36, 4096
  s_add_u32 s40, s35, 98304
  buffer_load_dwordx4 v4, s[16:19], s40 offen sc1 lds
  s_add_u32 m0, s36, 61440
  s_add_u32 s40, s35, 12288
  buffer_load_dwordx4 v4, s[16:19], s40 offen sc1 lds
  s_add_u32 m0, s36, 62464
  s_add_u32 s40, s35, 36864
  buffer_load_dwordx4 v4, s[16:19], s40 offen sc1 lds
  s_add_u32 m0, s36, 63488
  s_add_u32 s40, s35, 61440
  buffer_load_dwordx4 v4, s[16:19], s40 offen sc1 lds
  s_add_u32 m0, s36, 64512
  s_add_u32 s40, s35, 86016
  buffer_load_dwordx4 v4, s[16:19], s40 offen sc1 lds
  s_add_u32 m0, s36, 65536
  s_add_u32 s40, s35, 110592
  buffer_load_dwordx4 v4, s[16:19], s40 offen sc1 lds
  s_add_u32 m0, s36, 20480
  s_add_u32 s40, s35, 4096
  buffer_load_dwordx4 v4, s[16:19], s40 offen sc1 lds
  s_add_u32 m0, s36, 21504
  s_add_u32 s40, s35, 28672
  buffer_load_dwordx4 v4, s[16:19], s40 offen sc1 lds
  s_add_u32 m0, s36, 22528
  s_add_u32 s40, s35, 53248
  buffer_load_dwordx4 v4, s[16:19], s40 offen sc1 lds
  s_add_u32 m0, s36, 23552
  s_add_u32 s40, s35, 77824
  buffer_load_dwordx4 v4, s[16:19], s40 offen sc1 lds
  s_add_u32 m0, s36, 24576
  s_add_u32 s40, s35, 102400
  buffer_load_dwordx4 v4, s[16:19], s40 offen sc1 lds
  s_add_u32 m0, s36, 81920
  s_add_u32 s40, s35, 16384
  buffer_load_dwordx4 v4, s[16:19], s40 offen sc1 lds
  s_add_u32 m0, s36, 82944
  s_add_u32 s40, s35, 40960
  buffer_load_dwordx4 v4, s[16:19], s40 offen sc1 lds
  s_add_u32 m0, s36, 83968
  s_add_u32 s40, s35, 65536
  buffer_load_dwordx4 v4, s[16:19], s40 offen sc1 lds
  s_add_u32 m0, s36, 84992
  s_add_u32 s40, s35, 90112
  buffer_load_dwordx4 v4, s[16:19], s40 offen sc1 lds
  s_add_u32 m0, s36, 86016
  s_add_u32 s40, s35, 114688
  buffer_load_dwordx4 v4, s[16:19], s40 offen sc1 lds
  s_add_u32 m0, s36, 40960
  s_add_u32 s40, s35, 8192
  buffer_load_dwordx4 v4, s[16:19], s40 offen sc1 lds
  s_add_u32 m0, s36, 41984
  s_add_u32 s40, s35, 32768
  buffer_load_dwordx4 v4, s[16:19], s40 offen sc1 lds
  s_add_u32 m0, s36, 43008
  s_add_u32 s40, s35, 57344
  buffer_load_dwordx4 v4, s[16:19], s40 offen sc1 lds
  s_add_u32 m0, s36, 44032
  s_add_u32 s40, s35, 81920
  buffer_load_dwordx4 v4, s[16:19], s40 offen sc1 lds
  s_add_u32 m0, s36, 45056
  s_add_u32 s40, s35, 106496
  buffer_load_dwordx4 v4, s[16:19], s40 offen sc1 lds
  s_add_u32 m0, s36, 102400
  s_add_u32 s40, s35, 20480
  buffer_load_dwordx4 v4, s[16:19], s40 offen sc1 lds
  s_add_u32 m0, s36, 103424
  s_add_u32 s40, s35, 45056
  buffer_load_dwordx4 v4, s[16:19], s40 offen sc1 lds
  s_add_u32 m0, s36, 104448
  s_add_u32 s40, s35, 69632
  buffer_load_dwordx4 v4, s[16:19], s40 offen sc1 lds
  s_add_u32 m0, s36, 105472
  s_add_u32 s40, s35, 94208
  buffer_load_dwordx4 v4, s[16:19], s40 offen sc1 lds
  s_add_u32 m0, s36, 106496
  s_add_u32 s40, s35, 118784
  buffer_load_dwordx4 v4, s[16:19], s40 offen sc1 lds
  s_barrier
  s_waitcnt vmcnt(20)
  s_barrier
  s_cmp_eq_u32 s34, 8
  s_cbranch_scc0 F3_NOYP
  s_load_dwordx2 s[72:73], s[0:1], 104
  s_lshl_b32 s75, s33, 7
  s_add_u32 s75, s75, 17040384
  s_waitcnt lgkmcnt(0)
  s_add_u32 s74, s75, 0
  s_mov_b32 s42, 0
SP_F2Aa:
  s_load_dwordx16 s[56:71], s[72:73], s74 glc
  s_waitcnt lgkmcnt(0)
  s_and_b64 s[56:57], s[56:57], s[64:65]
  s_and_b64 s[58:59], s[58:59], s[66:67]
  s_and_b64 s[60:61], s[60:61], s[68:69]
  s_and_b64 s[62:63], s[62:63], s[70:71]
  s_and_b64 s[56:57], s[56:57], s[60:61]
  s_and_b64 s[58:59], s[58:59], s[62:63]
  s_and_b64 s[56:57], s[56:57], s[58:59]
  s_and_b32 s56, s56, s57
  s_add_u32 s42, s42, 1
  s_cmp_eq_u32 s56, 1
  s_cbranch_scc1 SP_F2Aa_OK
  s_cmp_lt_u32 s42, 2097152
  s_cbranch_scc1 SP_F2Aa
SP_F2Aa_OK:
  s_add_u32 s74, s75, 64
  s_mov_b32 s42, 0
SP_F2Ab:
  s_load_dwordx16 s[56:71], s[72:73], s74 glc
  s_waitcnt lgkmcnt(0)
  s_and_b64 s[56:57], s[56:57], s[64:65]
  s_and_b64 s[58:59], s[58:59], s[66:67]
  s_and_b64 s[60:61], s[60:61], s[68:69]
  s_and_b64 s[62:63], s[62:63], s[70:71]
  s_and_b64 s[56:57], s[56:57], s[60:61]
  s_and_b64 s[58:59], s[58:59], s[62:63]
  s_and_b64 s[56:57], s[56:57], s[58:59]
  s_and_b32 s56, s56, s57
  s_add_u32 s42, s42, 1
  s_cmp_eq_u32 s56, 1
  s_cbranch_scc1 SP_F2Ab_OK
  s_cmp_lt_u32 s42, 2097152
  s_cbranch_scc1 SP_F2Ab
SP_F2Ab_OK:
F3_NOYP:
  s_waitcnt vmcnt(10)
  s_barrier
  s_waitcnt vmcnt(0)
  s_barrier
  s_barrier
  s_barrier
  s_endpgm
K1_AB:
  v_lshrrev_b32 v17, 1, v3
  v_xor_b32 v17, v17, v2
  v_lshlrev_b32 v17, 4, v17
  v_lshlrev_b32 v18, 7, v3
  v_add_u32 v17, v17, v18
  v_xor_b32 v18, 64, v17
  s_lshl_b32 s40, s35, 12
  s_lshl_b32 s41, s36, 11
  s_add_u32 s42, s40, s41
  s_add_u32 s42, s42, 61440
  v_add_u32 v4, s42, v17
  v_add_u32 v5, s42, v18
  s_xor_b32 s41, s41, 2048
  s_add_u32 s42, s40, s41
  s_add_u32 s42, s42, 61440
  v_add_u32 v6, s42, v17
  v_add_u32 v7, s42, v18
  v_lshrrev_b32 v17, 2, v1
  v_and_b32 v17, 3, v17
  v_lshlrev_b32 v18, 3, v2
  v_add_u32 v17, v17, v18
  v_mul_u32_u24 v17, 192, v17
  v_and_b32 v18, 3, v1
  v_lshlrev_b32 v18, 3, v18
  v_add_u32 v17, v17, v18
  v_and_b32 v19, 1, v2
  s_mul_i32 s40, s36, 3
  s_add_u32 s41, s40, 0
  v_xor_b32 v18, s41, v19
  v_lshlrev_b32 v18, 5, v18
  v_add_u32 v8, v17, v18
  s_add_u32 s41, s40, 1
  v_xor_b32 v18, s41, v19
  v_lshlrev_b32 v18, 5, v18
  v_add_u32 v9, v17, v18
  s_add_u32 s41, s40, 2
  v_xor_b32 v18, s41, v19
  v_lshlrev_b32 v18, 5, v18
  v_add_u32 v10, v17, v18
  s_mov_b32 s48, 0xbdd2d3e8
  s_mov_b32 s49, 0xbdd2d3e8
  s_mov_b32 s50, 1.0
  s_mov_b32 s51, 1.0
  s_waitcnt lgkmcnt(0)
  s_mov_b32 s16, s70
  s_and_b32 s17, s71, 0xffff
  s_mov_b32 s18, 18874368
  s_mov_b32 s19, 0x20000
  s_mov_b32 s4, s68
  s_and_b32 s5, s69, 0xffff
  s_mov_b32 s6, 256
  s_mov_b32 s7, 0x20000
  s_cmp_ge_u32 s34, 4
  s_cbranch_scc1 K1_B
  v_mov_b32 v102, 0x3f803f80
  v_mov_b32 v103, 0x3f803f80
  v_mov_b32 v104, 0x3f803f80
  v_mov_b32 v105, 0x3f803f80
  v_mov_b32 v66, 0
  v_mov_b32 v67, 0
  v_mov_b32 v68, 0
  v_mov_b32 v69, 0
  v_mov_b32 v70, 0
  v_mov_b32 v71, 0
  v_mov_b32 v72, 0
  v_mov_b32 v73, 0
  v_mov_b32 v74, 0
  v_mov_b32 v75, 0
  v_mov_b32 v76, 0
  v_mov_b32 v77, 0
  v_mov_b32 v78, 0
  v_mov_b32 v79, 0
  v_mov_b32 v80, 0
  v_mov_b32 v81, 0
  v_mov_b32 v82, 0
  v_mov_b32 v83, 0
  v_mov_b32 v84, 0
  v_mov_b32 v85, 0
  v_mov_b32 v86, 0
  v_mov_b32 v87, 0
  v_mov_b32 v88, 0
  v_mov_b32 v89, 0
  v_mov_b32 v90, 0
  v_mov_b32 v91, 0
  v_mov_b32 v92, 0
  v_mov_b32 v93, 0
  v_mov_b32 v94, 0
  v_mov_b32 v95, 0
  v_mov_b32 v96, 0
  v_mov_b32 v97, 0
  v_mov_b32 v98, 0
  v_mov_b32 v99, 0
  v_mov_b32 v100, 0
  v_mov_b32 v101, 0
  v_mov_b32 v106, 0
  v_mov_b32 v107, 0
  v_mov_b32 v108, 0
  v_mov_b32 v109, 0
  v_mov_b32 v110, 0
  v_mov_b32 v111, 0
  v_mov_b32 v112, 0
  v_mov_b32 v113, 0
  s_barrier
  s_mov_b32 s37, 0
  ds_read_b128 v[26:29], v4 offset:0
  ds_read_b64_tr_b16 v[42:43], v8 offset:0
  ds_read_b64_tr_b16 v[44:45], v8 offset:768
  ds_read_b128 v[30:33], v6 offset:0
  ds_read_b64_tr_b16 v[46:47], v9 offset:0
  ds_read_b64_tr_b16 v[48:49], v9 offset:768
  ds_read_b64_tr_b16 v[50:51], v10 offset:0
  ds_read_b64_tr_b16 v[52:53], v10 offset:768
K1_LOOP1:
  s_waitcnt lgkmcnt(0)
  v_mfma_f32_16x16x32_bf16 v[66:69], v[26:29], v[42:45], v[66:69]
  ds_read_b128 v[34:37], v5 offset:0
  ds_read_b64_tr_b16 v[54:55], v8 offset:6144
  v_mfma_f32_16x16x32_bf16 v[78:81], v[30:33], v[42:45], v[78:81]
  ds_read_b64_tr_b16 v[56:57], v8 offset:6912
  ds_read_b128 v[38:41], v7 offset:0
  v_mfma_f32_16x16x32_bf16 v[70:73], v[26:29], v[46:49], v[70:73]
  ds_read_b64_tr_b16 v[58:59], v9 offset:6144
  ds_read_b64_tr_b16 v[60:61], v9 offset:6912
  v_mfma_f32_16x16x32_bf16 v[82:85], v[30:33], v[46:49], v[82:85]
  ds_read_b64_tr_b16 v[62:63], v10 offset:6144
  ds_read_b64_tr_b16 v[64:65], v10 offset:6912
  v_mfma_f32_16x16x32_bf16 v[74:77], v[26:29], v[50:53], v[74:77]
  v_mfma_f32_16x16x32_bf16 v[86:89], v[30:33], v[50:53], v[86:89]
  v_mfma_f32_16x16x32_bf16 v[106:109], v[102:105], v[26:29], v[106:109]
  v_mfma_f32_16x16x32_bf16 v[110:113], v[26:29], v[26:29], v[110:113]
  s_cmp_eq_u32 s35, 0
  s_cbranch_scc0 K1_SK_1a0
  v_mfma_f32_16x16x32_bf16 v[90:93], v[102:105], v[42:45], v[90:93]
  v_mfma_f32_16x16x32_bf16 v[94:97], v[102:105], v[46:49], v[94:97]
  v_mfma_f32_16x16x32_bf16 v[98:101], v[102:105], v[50:53], v[98:101]
K1_SK_1a0:
  s_waitcnt lgkmcnt(0)
  s_barrier
  v_mfma_f32_16x16x32_bf16 v[66:69], v[34:37], v[54:57], v[66:69]
  ds_read_b128 v[26:29], v4 offset:8192
  ds_read_b64_tr_b16 v[42:43], v8 offset:12288
  v_mfma_f32_16x16x32_bf16 v[78:81], v[38:41], v[54:57], v[78:81]
  ds_read_b64_tr_b16 v[44:45], v8 offset:13056
  ds_read_b128 v[30:33], v6 offset:8192
  v_mfma_f32_16x16x32_bf16 v[70:73], v[34:37], v[58:61], v[70:73]
  ds_read_b64_tr_b16 v[46:47], v9 offset:12288
  ds_read_b64_tr_b16 v[48:49], v9 offset:13056
  v_mfma_f32_16x16x32_bf16 v[82:85], v[38:41], v[58:61], v[82:85]
  ds_read_b64_tr_b16 v[50:51], v10 offset:12288
  ds_read_b64_tr_b16 v[52:53], v10 offset:13056
  v_mfma_f32_16x16x32_bf16 v[74:77], v[34:37], v[62:65], v[74:77]
  v_mfma_f32_16x16x32_bf16 v[86:89], v[38:41], v[62:65], v[86:89]
  v_mfma_f32_16x16x32_bf16 v[106:109], v[102:105], v[34:37], v[106:109]
  v_mfma_f32_16x16x32_bf16 v[110:113], v[34:37], v[34:37], v[110:113]
  s_cmp_eq_u32 s35, 1
  s_cbranch_scc0 K1_SK_1b0
  v_mfma_f32_16x16x32_bf16 v[90:93], v[102:105], v[54:57], v[90:93]
  v_mfma_f32_16x16x32_bf16 v[94:97], v[102:105], v[58:61], v[94:97]
  v_mfma_f32_16x16x32_bf16 v[98:101], v[102:105], v[62:65], v[98:101]
K1_SK_1b0:
  s_waitcnt lgkmcnt(0)
  v_mfma_f32_16x16x32_bf16 v[66:69], v[26:29], v[42:45], v[66:69]
  ds_read_b128 v[34:37], v5 offset:8192
  ds_read_b64_tr_b16 v[54:55], v8 offset:18432
  v_mfma_f32_16x16x32_bf16 v[78:81], v[30:33], v[42:45], v[78:81]
  ds_read_b64_tr_b16 v[56:57], v8 offset:19200
  ds_read_b128 v[38:41], v7 offset:8192
  v_mfma_f32_16x16x32_bf16 v[70:73], v[26:29], v[46:49], v[70:73]
  ds_read_b64_tr_b16 v[58:59], v9 offset:18432
  ds_read_b64_tr_b16 v[60:61], v9 offset:19200
  v_mfma_f32_16x16x32_bf16 v[82:85], v[30:33], v[46:49], v[82:85]
  ds_read_b64_tr_b16 v[62:63], v10 offset:18432
  ds_read_b64_tr_b16 v[64:65], v10 offset:19200
  v_mfma_f32_16x16x32_bf16 v[74:77], v[26:29], v[50:53], v[74:77]
  v_mfma_f32_16x16x32_bf16 v[86:89], v[30:33], v[50:53], v[86:89]
  v_mfma_f32_16x16x32_bf16 v[106:109], v[102:105], v[26:29], v[106:109]
  v_mfma_f32_16x16x32_bf16 v[110:113], v[26:29], v[26:29], v[110:113]
  s_cmp_eq_u32 s35, 0
  s_cbranch_scc0 K1_SK_1a1
  v_mfma_f32_16x16x32_bf16 v[90:93], v[102:105], v[42:45], v[90:93]
  v_mfma_f32_16x16x32_bf16 v[94:97], v[102:105], v[46:49], v[94:97]
  v_mfma_f32_16x16x32_bf16 v[98:101], v[102:105], v[50:53], v[98:101]
K1_SK_1a1:
  s_waitcnt lgkmcnt(0)
  s_barrier
  v_mfma_f32_16x16x32_bf16 v[66:69], v[34:37], v[54:57], v[66:69]
  ds_read_b128 v[26:29], v4 offset:16384
  ds_read_b64_tr_b16 v[42:43], v8 offset:24576
  v_mfma_f32_16x16x32_bf16 v[78:81], v[38:41], v[54:57], v[78:81]
  ds_read_b64_tr_b16 v[44:45], v8 offset:25344
  ds_read_b128 v[30:33], v6 offset:16384
  v_mfma_f32_16x16x32_bf16 v[70:73], v[34:37], v[58:61], v[70:73]
  ds_read_b64_tr_b16 v[46:47], v9 offset:24576
  ds_read_b64_tr_b16 v[48:49], v9 offset:25344
  v_mfma_f32_16x16x32_bf16 v[82:85], v[38:41], v[58:61], v[82:85]
  ds_read_b64_tr_b16 v[50:51], v10 offset:24576
  ds_read_b64_tr_b16 v[52:53], v10 offset:25344
  v_mfma_f32_16x16x32_bf16 v[74:77], v[34:37], v[62:65], v[74:77]
  v_mfma_f32_16x16x32_bf16 v[86:89], v[38:41], v[62:65], v[86:89]
  v_mfma_f32_16x16x32_bf16 v[106:109], v[102:105], v[34:37], v[106:109]
  v_mfma_f32_16x16x32_bf16 v[110:113], v[34:37], v[34:37], v[110:113]
  s_cmp_eq_u32 s35, 1
  s_cbranch_scc0 K1_SK_1b1
  v_mfma_f32_16x16x32_bf16 v[90:93], v[102:105], v[54:57], v[90:93]
  v_mfma_f32_16x16x32_bf16 v[94:97], v[102:105], v[58:61], v[94:97]
  v_mfma_f32_16x16x32_bf16 v[98:101], v[102:105], v[62:65], v[98:101]
K1_SK_1b1:
  s_waitcnt lgkmcnt(0)
  v_mfma_f32_16x16x32_bf16 v[66:69], v[26:29], v[42:45], v[66:69]
  ds_read_b128 v[34:37], v5 offset:16384
  ds_read_b64_tr_b16 v[54:55], v8 offset:30720
  v_mfma_f32_16x16x32_bf16 v[78:81], v[30:33], v[42:45], v[78:81]
  ds_read_b64_tr_b16 v[56:57], v8 offset:31488
  ds_read_b128 v[38:41], v7 offset:16384
  v_mfma_f32_16x16x32_bf16 v[70:73], v[26:29], v[46:49], v[70:73]
  ds_read_b64_tr_b16 v[58:59], v9 offset:30720
  ds_read_b64_tr_b16 v[60:61], v9 offset:31488
  v_mfma_f32_16x16x32_bf16 v[82:85], v[30:33], v[46:49], v[82:85]
  ds_read_b64_tr_b16 v[62:63], v10 offset:30720
  ds_read_b64_tr_b16 v[64:65], v10 offset:31488
  v_mfma_f32_16x16x32_bf16 v[74:77], v[26:29], v[50:53], v[74:77]
  v_mfma_f32_16x16x32_bf16 v[86:89], v[30:33], v[50:53], v[86:89]
  v_mfma_f32_16x16x32_bf16 v[106:109], v[102:105], v[26:29], v[106:109]
  v_mfma_f32_16x16x32_bf16 v[110:113], v[26:29], v[26:29], v[110:113]
  s_cmp_eq_u32 s35, 0
  s_cbranch_scc0 K1_SK_1a2
  v_mfma_f32_16x16x32_bf16 v[90:93], v[102:105], v[42:45], v[90:93]
  v_mfma_f32_16x16x32_bf16 v[94:97], v[102:105], v[46:49], v[94:97]
  v_mfma_f32_16x16x32_bf16 v[98:101], v[102:105], v[50:53], v[98:101]
K1_SK_1a2:
  s_waitcnt lgkmcnt(0)
  s_barrier
  v_mfma_f32_16x16x32_bf16 v[66:69], v[34:37], v[54:57], v[66:69]
  ds_read_b128 v[26:29], v4 offset:24576
  ds_read_b64_tr_b16 v[42:43], v8 offset:36864
  v_mfma_f32_16x16x32_bf16 v[78:81], v[38:41], v[54:57], v[78:81]
  ds_read_b64_tr_b16 v[44:45], v8 offset:37632
  ds_read_b128 v[30:33], v6 offset:24576
  v_mfma_f32_16x16x32_bf16 v[70:73], v[34:37], v[58:61], v[70:73]
  ds_read_b64_tr_b16 v[46:47], v9 offset:36864
  ds_read_b64_tr_b16 v[48:49], v9 offset:37632
  v_mfma_f32_16x16x32_bf16 v[82:85], v[38:41], v[58:61], v[82:85]
  ds_read_b64_tr_b16 v[50:51], v10 offset:36864
  ds_read_b64_tr_b16 v[52:53], v10 offset:37632
  v_mfma_f32_16x16x32_bf16 v[74:77], v[34:37], v[62:65], v[74:77]
  v_mfma_f32_16x16x32_bf16 v[86:89], v[38:41], v[62:65], v[86:89]
  v_mfma_f32_16x16x32_bf16 v[106:109], v[102:105], v[34:37], v[106:109]
  v_mfma_f32_16x16x32_bf16 v[110:113], v[34:37], v[34:37], v[110:113]
  s_cmp_eq_u32 s35, 1
  s_cbranch_scc0 K1_SK_1b2
  v_mfma_f32_16x16x32_bf16 v[90:93], v[102:105], v[54:57], v[90:93]
  v_mfma_f32_16x16x32_bf16 v[94:97], v[102:105], v[58:61], v[94:97]
  v_mfma_f32_16x16x32_bf16 v[98:101], v[102:105], v[62:65], v[98:101]
K1_SK_1b2:
  s_waitcnt lgkmcnt(0)
  v_mfma_f32_16x16x32_bf16 v[66:69], v[26:29], v[42:45], v[66:69]
  ds_read_b128 v[34:37], v5 offset:24576
  ds_read_b64_tr_b16 v[54:55], v8 offset:43008
  v_mfma_f32_16x16x32_bf16 v[78:81], v[30:33], v[42:45], v[78:81]
  ds_read_b64_tr_b16 v[56:57], v8 offset:43776
  ds_read_b128 v[38:41], v7 offset:24576
  v_mfma_f32_16x16x32_bf16 v[70:73], v[26:29], v[46:49], v[70:73]
  ds_read_b64_tr_b16 v[58:59], v9 offset:43008
  ds_read_b64_tr_b16 v[60:61], v9 offset:43776
  v_mfma_f32_16x16x32_bf16 v[82:85], v[30:33], v[46:49], v[82:85]
  ds_read_b64_tr_b16 v[62:63], v10 offset:43008
  ds_read_b64_tr_b16 v[64:65], v10 offset:43776
  v_mfma_f32_16x16x32_bf16 v[74:77], v[26:29], v[50:53], v[74:77]
  v_mfma_f32_16x16x32_bf16 v[86:89], v[30:33], v[50:53], v[86:89]
  v_mfma_f32_16x16x32_bf16 v[106:109], v[102:105], v[26:29], v[106:109]
  v_mfma_f32_16x16x32_bf16 v[110:113], v[26:29], v[26:29], v[110:113]
  s_cmp_eq_u32 s35, 0
  s_cbranch_scc0 K1_SK_1a3
  v_mfma_f32_16x16x32_bf16 v[90:93], v[102:105], v[42:45], v[90:93]
  v_mfma_f32_16x16x32_bf16 v[94:97], v[102:105], v[46:49], v[94:97]
  v_mfma_f32_16x16x32_bf16 v[98:101], v[102:105], v[50:53], v[98:101]
K1_SK_1a3:
  s_waitcnt lgkmcnt(0)
  s_barrier
  v_mfma_f32_16x16x32_bf16 v[66:69], v[34:37], v[54:57], v[66:69]
  ds_read_b128 v[26:29], v4 offset:32768
  ds_read_b64_tr_b16 v[42:43], v8 offset:49152
  v_mfma_f32_16x16x32_bf16 v[78:81], v[38:41], v[54:57], v[78:81]
  ds_read_b64_tr_b16 v[44:45], v8 offset:49920
  ds_read_b128 v[30:33], v6 offset:32768
  v_mfma_f32_16x16x32_bf16 v[70:73], v[34:37], v[58:61], v[70:73]
  ds_read_b64_tr_b16 v[46:47], v9 offset:49152
  ds_read_b64_tr_b16 v[48:49], v9 offset:49920
  v_mfma_f32_16x16x32_bf16 v[82:85], v[38:41], v[58:61], v[82:85]
  ds_read_b64_tr_b16 v[50:51], v10 offset:49152
  ds_read_b64_tr_b16 v[52:53], v10 offset:49920
  v_mfma_f32_16x16x32_bf16 v[74:77], v[34:37], v[62:65], v[74:77]
  v_mfma_f32_16x16x32_bf16 v[86:89], v[38:41], v[62:65], v[86:89]
  v_mfma_f32_16x16x32_bf16 v[106:109], v[102:105], v[34:37], v[106:109]
  v_mfma_f32_16x16x32_bf16 v[110:113], v[34:37], v[34:37], v[110:113]
  s_cmp_eq_u32 s35, 1
  s_cbranch_scc0 K1_SK_1b3
  v_mfma_f32_16x16x32_bf16 v[90:93], v[102:105], v[54:57], v[90:93]
  v_mfma_f32_16x16x32_bf16 v[94:97], v[102:105], v[58:61], v[94:97]
  v_mfma_f32_16x16x32_bf16 v[98:101], v[102:105], v[62:65], v[98:101]
K1_SK_1b3:
  s_waitcnt lgkmcnt(0)
  v_mfma_f32_16x16x32_bf16 v[66:69], v[26:29], v[42:45], v[66:69]
  ds_read_b128 v[34:37], v5 offset:32768
  ds_read_b64_tr_b16 v[54:55], v8 offset:55296
  v_mfma_f32_16x16x32_bf16 v[78:81], v[30:33], v[42:45], v[78:81]
  ds_read_b64_tr_b16 v[56:57], v8 offset:56064
  ds_read_b128 v[38:41], v7 offset:32768
  v_mfma_f32_16x16x32_bf16 v[70:73], v[26:29], v[46:49], v[70:73]
  ds_read_b64_tr_b16 v[58:59], v9 offset:55296
  ds_read_b64_tr_b16 v[60:61], v9 offset:56064
  v_mfma_f32_16x16x32_bf16 v[82:85], v[30:33], v[46:49], v[82:85]
  ds_read_b64_tr_b16 v[62:63], v10 offset:55296
  ds_read_b64_tr_b16 v[64:65], v10 offset:56064
  v_mfma_f32_16x16x32_bf16 v[74:77], v[26:29], v[50:53], v[74:77]
  v_mfma_f32_16x16x32_bf16 v[86:89], v[30:33], v[50:53], v[86:89]
  v_mfma_f32_16x16x32_bf16 v[106:109], v[102:105], v[26:29], v[106:109]
  v_mfma_f32_16x16x32_bf16 v[110:113], v[26:29], v[26:29], v[110:113]
  s_cmp_eq_u32 s35, 0
  s_cbranch_scc0 K1_SK_1a4
  v_mfma_f32_16x16x32_bf16 v[90:93], v[102:105], v[42:45], v[90:93]
  v_mfma_f32_16x16x32_bf16 v[94:97], v[102:105], v[46:49], v[94:97]
  v_mfma_f32_16x16x32_bf16 v[98:101], v[102:105], v[50:53], v[98:101]
K1_SK_1a4:
  s_waitcnt lgkmcnt(0)
  s_barrier
  v_add_u32 v4, 40960, v4
  v_add_u32 v5, 40960, v5
  v_add_u32 v6, 40960, v6
  v_add_u32 v7, 40960, v7
  v_mfma_f32_16x16x32_bf16 v[66:69], v[34:37], v[54:57], v[66:69]
  ds_read_b128 v[26:29], v4 offset:0
  ds_read_b64_tr_b16 v[42:43], v8 offset:0
  v_mfma_f32_16x16x32_bf16 v[78:81], v[38:41], v[54:57], v[78:81]
  ds_read_b64_tr_b16 v[44:45], v8 offset:768
  ds_read_b128 v[30:33], v6 offset:0
  v_mfma_f32_16x16x32_bf16 v[70:73], v[34:37], v[58:61], v[70:73]
  ds_read_b64_tr_b16 v[46:47], v9 offset:0
  ds_read_b64_tr_b16 v[48:49], v9 offset:768
  v_mfma_f32_16x16x32_bf16 v[82:85], v[38:41], v[58:61], v[82:85]
  ds_read_b64_tr_b16 v[50:51], v10 offset:0
  ds_read_b64_tr_b16 v[52:53], v10 offset:768
  v_mfma_f32_16x16x32_bf16 v[74:77], v[34:37], v[62:65], v[74:77]
  v_mfma_f32_16x16x32_bf16 v[86:89], v[38:41], v[62:65], v[86:89]
  v_mfma_f32_16x16x32_bf16 v[106:109], v[102:105], v[34:37], v[106:109]
  v_mfma_f32_16x16x32_bf16 v[110:113], v[34:37], v[34:37], v[110:113]
  s_cmp_eq_u32 s35, 1
  s_cbranch_scc0 K1_SK_1b4
  v_mfma_f32_16x16x32_bf16 v[90:93], v[102:105], v[54:57], v[90:93]
  v_mfma_f32_16x16x32_bf16 v[94:97], v[102:105], v[58:61], v[94:97]
  v_mfma_f32_16x16x32_bf16 v[98:101], v[102:105], v[62:65], v[98:101]
K1_SK_1b4:
  s_add_u32 s37, s37, 1
  s_cmp_lt_u32 s37, 2
  s_cbranch_scc1 K1_LOOP1
  s_setprio 2
  s_lshl_b32 s40, s32, 2
  v_mov_b32 v22, s40
  v_and_b32 v14, 3, v3
  v_cmp_eq_u32 vcc, 1, v14
  s_nop 1
  v_cndmask_b32 v110, v110, v111, vcc
  v_cmp_eq_u32 vcc, 2, v14
  s_nop 1
  v_cndmask_b32 v110, v110, v112, vcc
  v_cmp_eq_u32 vcc, 3, v14
  s_nop 1
  v_cndmask_b32 v110, v110, v113, vcc
  v_mul_f32 v16, 0x3acccccd, v106
  v_mul_f32 v18, 0x3acccccd, v110
  v_fma_f32 v18, -v16, v16, v18
  v_max_f32 v18, 0, v18
  v_cvt_pk_bf16_f32 v16, v16, v16
  v_lshlrev_b32 v16, 16, v16
  v_cvt_pk_bf16_f32 v18, v18, v18
  v_lshlrev_b32 v18, 16, v18
  v_add_f32 v18, 0x3727c5ac, v18
  v_cvt_pk_bf16_f32 v18, v18, v18
  v_lshlrev_b32 v18, 16, v18
  v_sqrt_f32 v18, v18
  s_nop 0
  v_cvt_pk_bf16_f32 v18, v18, v18
  v_lshlrev_b32 v18, 16, v18
  v_rcp_f32 v17, v18
  s_lshl_b32 s40, s35, 5
  s_lshl_b32 s41, s36, 4
  s_add_u32 s40, s40, s41
  v_add_u32 v18, s40, v3
  v_lshlrev_b32 v19, 2, v18
  v_add_u32 v19, 143360, v19
  s_mov_b32 exec_lo, 0xf0000f
  s_mov_b32 exec_hi, 0xf0000f00
  ds_write_b32 v19, v16
  ds_write_b32 v19, v17 offset:256
  s_branch K1_NOST1X
  s_cmp_eq_u32 s33, 0
  s_cbranch_scc0 K1_NOST1X
  s_lshl_b32 s41, s32, 9
  s_add_u32 s41, s41, 16777216
  v_lshlrev_b32 v18, 3, v18
  buffer_store_dwordx2 v[16:17], v18, s[16:19], s41 offen sc1
K1_NOST1X:
  s_mov_b64 exec, s[52:53]
  s_mul_i32 s40, s55, 192
  s_add_u32 s40, s40, 143872
  v_lshlrev_b32 v20, 2, v3
  v_add_u32 v20, s40, v20
  ds_write_b32 v20, v90 offset:0
  ds_write_b32 v20, v94 offset:64
  ds_write_b32 v20, v98 offset:128
  s_waitcnt lgkmcnt(0)
  s_barrier
  s_xor_b32 s41, s55, 2
  s_mul_i32 s41, s41, 192
  s_add_u32 s41, s41, 143872
  v_lshlrev_b32 v18, 2, v3
  v_add_u32 v18, s41, v18
  ds_read_b32 v136, v18 offset:0
  ds_read_b32 v138, v18 offset:64
  ds_read_b32 v140, v18 offset:128
  s_lshl_b32 s40, s35, 7
  s_lshl_b32 s41, s36, 6
  s_add_u32 s40, s40, s41
  s_add_u32 s40, s40, 143360
  v_lshlrev_b32 v19, 4, v2
  v_add_u32 v19, s40, v19
  v_xor_b32 v20, 64, v19
  ds_read_b128 v[26:29], v19
  ds_read_b128 v[30:33], v20
  ds_read_b128 v[34:37], v19 offset:256
  ds_read_b128 v[38:41], v20 offset:256
  v_mov_b32 v126, 0xc0135761
  v_mov_b32 v127, 0xc0135761
  v_mov_b32 v42, 0
  v_mov_b32 v43, 0
  v_mov_b32 v44, 0
  v_mov_b32 v45, 0
  v_mov_b32 v46, 0
  v_mov_b32 v47, 0
  v_mov_b32 v48, 0
  v_mov_b32 v49, 0
  v_mov_b32 v50, 0
  v_mov_b32 v51, 0
  v_mov_b32 v52, 0
  v_mov_b32 v53, 0
  v_mov_b32 v54, 0
  v_mov_b32 v55, 0
  v_mov_b32 v56, 0
  v_mov_b32 v57, 0
  s_waitcnt lgkmcnt(0)
  v_add_f32 v136, v136, v90
  v_sub_f32 v136, 0, v136
  v_add_f32 v138, v138, v94
  v_sub_f32 v138, 0, v138
  v_add_f32 v140, v140, v98
  v_sub_f32 v140, 0, v140
  v_fma_f32 v66, v26, v136, v66
  v_fma_f32 v67, v27, v136, v67
  v_mul_f32 v66, v66, v34
  v_mul_f32 v67, v67, v35
  v_mul_f32 v128, v66, v66
  v_mul_f32 v129, v67, v67
  v_fma_f32 v128, v128, s48, v126
  v_fma_f32 v129, v129, s48, v126
  v_mul_f32 v128, v128, v66
  v_mul_f32 v129, v129, v67
  v_exp_f32 v128, v128
  v_exp_f32 v129, v129
  v_add_f32 v128, 1.0, v128
  v_add_f32 v129, 1.0, v129
  v_rcp_f32 v128, v128
  v_rcp_f32 v129, v129
  v_mul_f32 v128, v128, v66
  v_mul_f32 v129, v129, v67
  v_cvt_pk_bf16_f32 v114, v128, v129
  v_add_f32 v42, v42, v128
  v_add_f32 v43, v43, v129
  v_fma_f32 v50, v128, v128, v50
  v_fma_f32 v51, v129, v129, v51
  v_fma_f32 v68, v28, v136, v68
  v_fma_f32 v69, v29, v136, v69
  v_mul_f32 v68, v68, v36
  v_mul_f32 v69, v69, v37
  v_mul_f32 v132, v68, v68
  v_mul_f32 v133, v69, v69
  v_fma_f32 v132, v132, s48, v126
  v_fma_f32 v133, v133, s48, v126
  v_mul_f32 v132, v132, v68
  v_mul_f32 v133, v133, v69
  v_exp_f32 v132, v132
  v_exp_f32 v133, v133
  v_add_f32 v132, 1.0, v132
  v_add_f32 v133, 1.0, v133
  v_rcp_f32 v132, v132
  v_rcp_f32 v133, v133
  v_mul_f32 v132, v132, v68
  v_mul_f32 v133, v133, v69
  v_cvt_pk_bf16_f32 v115, v132, v133
  v_add_f32 v44, v44, v132
  v_add_f32 v45, v45, v133
  v_fma_f32 v52, v132, v132, v52
  v_fma_f32 v53, v133, v133, v53
  s_barrier
  v_fma_f32 v78, v30, v136, v78
  v_fma_f32 v79, v31, v136, v79
  v_mul_f32 v78, v78, v38
  v_mul_f32 v79, v79, v39
  v_mul_f32 v128, v78, v78
  v_mul_f32 v129, v79, v79
  v_fma_f32 v128, v128, s48, v126
  v_fma_f32 v129, v129, s48, v126
  v_mul_f32 v128, v128, v78
  v_mul_f32 v129, v129, v79
  v_exp_f32 v128, v128
  v_exp_f32 v129, v129
  v_add_f32 v128, 1.0, v128
  v_add_f32 v129, 1.0, v129
  v_rcp_f32 v128, v128
  v_rcp_f32 v129, v129
  v_mul_f32 v128, v128, v78
  v_mul_f32 v129, v129, v79
  v_cvt_pk_bf16_f32 v116, v128, v129
  v_add_f32 v46, v46, v128
  v_add_f32 v47, v47, v129
  v_fma_f32 v54, v128, v128, v54
  v_fma_f32 v55, v129, v129, v55
  v_fma_f32 v80, v32, v136, v80
  v_fma_f32 v81, v33, v136, v81
  v_mul_f32 v80, v80, v40
  v_mul_f32 v81, v81, v41
  v_mul_f32 v132, v80, v80
  v_mul_f32 v133, v81, v81
  v_fma_f32 v132, v132, s48, v126
  v_fma_f32 v133, v133, s48, v126
  v_mul_f32 v132, v132, v80
  v_mul_f32 v133, v133, v81
  v_exp_f32 v132, v132
  v_exp_f32 v133, v133
  v_add_f32 v132, 1.0, v132
  v_add_f32 v133, 1.0, v133
  v_rcp_f32 v132, v132
  v_rcp_f32 v133, v133
  v_mul_f32 v132, v132, v80
  v_mul_f32 v133, v133, v81
  v_cvt_pk_bf16_f32 v117, v132, v133
  v_add_f32 v48, v48, v132
  v_add_f32 v49, v49, v133
  v_fma_f32 v56, v132, v132, v56
  v_fma_f32 v57, v133, v133, v57
  v_fma_f32 v70, v26, v138, v70
  v_fma_f32 v71, v27, v138, v71
  v_mul_f32 v70, v70, v34
  v_mul_f32 v71, v71, v35
  v_mul_f32 v128, v70, v70
  v_mul_f32 v129, v71, v71
  v_fma_f32 v128, v128, s48, v126
  v_fma_f32 v129, v129, s48, v126
  v_mul_f32 v128, v128, v70
  v_mul_f32 v129, v129, v71
  v_exp_f32 v128, v128
  v_exp_f32 v129, v129
  v_add_f32 v128, 1.0, v128
  v_add_f32 v129, 1.0, v129
  v_rcp_f32 v128, v128
  v_rcp_f32 v129, v129
  v_mul_f32 v128, v128, v70
  v_mul_f32 v129, v129, v71
  v_cvt_pk_bf16_f32 v118, v128, v129
  v_add_f32 v42, v42, v128
  v_add_f32 v43, v43, v129
  v_fma_f32 v50, v128, v128, v50
  v_fma_f32 v51, v129, v129, v51
  s_barrier
  v_fma_f32 v72, v28, v138, v72
  v_fma_f32 v73, v29, v138, v73
  v_mul_f32 v72, v72, v36
  v_mul_f32 v73, v73, v37
  v_mul_f32 v132, v72, v72
  v_mul_f32 v133, v73, v73
  v_fma_f32 v132, v132, s48, v126
  v_fma_f32 v133, v133, s48, v126
  v_mul_f32 v132, v132, v72
  v_mul_f32 v133, v133, v73
  v_exp_f32 v132, v132
  v_exp_f32 v133, v133
  v_add_f32 v132, 1.0, v132
  v_add_f32 v133, 1.0, v133
  v_rcp_f32 v132, v132
  v_rcp_f32 v133, v133
  v_mul_f32 v132, v132, v72
  v_mul_f32 v133, v133, v73
  v_cvt_pk_bf16_f32 v119, v132, v133
  v_add_f32 v44, v44, v132
  v_add_f32 v45, v45, v133
  v_fma_f32 v52, v132, v132, v52
  v_fma_f32 v53, v133, v133, v53
  v_fma_f32 v82, v30, v138, v82
  v_fma_f32 v83, v31, v138, v83
  v_mul_f32 v82, v82, v38
  v_mul_f32 v83, v83, v39
  v_mul_f32 v128, v82, v82
  v_mul_f32 v129, v83, v83
  v_fma_f32 v128, v128, s48, v126
  v_fma_f32 v129, v129, s48, v126
  v_mul_f32 v128, v128, v82
  v_mul_f32 v129, v129, v83
  v_exp_f32 v128, v128
  v_exp_f32 v129, v129
  v_add_f32 v128, 1.0, v128
  v_add_f32 v129, 1.0, v129
  v_rcp_f32 v128, v128
  v_rcp_f32 v129, v129
  v_mul_f32 v128, v128, v82
  v_mul_f32 v129, v129, v83
  v_cvt_pk_bf16_f32 v120, v128, v129
  v_add_f32 v46, v46, v128
  v_add_f32 v47, v47, v129
  v_fma_f32 v54, v128, v128, v54
  v_fma_f32 v55, v129, v129, v55
  s_barrier
  v_fma_f32 v84, v32, v138, v84
  v_fma_f32 v85, v33, v138, v85
  v_mul_f32 v84, v84, v40
  v_mul_f32 v85, v85, v41
  v_mul_f32 v132, v84, v84
  v_mul_f32 v133, v85, v85
  v_fma_f32 v132, v132, s48, v126
  v_fma_f32 v133, v133, s48, v126
  v_mul_f32 v132, v132, v84
  v_mul_f32 v133, v133, v85
  v_exp_f32 v132, v132
  v_exp_f32 v133, v133
  v_add_f32 v132, 1.0, v132
  v_add_f32 v133, 1.0, v133
  v_rcp_f32 v132, v132
  v_rcp_f32 v133, v133
  v_mul_f32 v132, v132, v84
  v_mul_f32 v133, v133, v85
  v_cvt_pk_bf16_f32 v121, v132, v133
  v_add_f32 v48, v48, v132
  v_add_f32 v49, v49, v133
  v_fma_f32 v56, v132, v132, v56
  v_fma_f32 v57, v133, v133, v57
  v_fma_f32 v74, v26, v140, v74
  v_fma_f32 v75, v27, v140, v75
  v_mul_f32 v74, v74, v34
  v_mul_f32 v75, v75, v35
  v_mul_f32 v128, v74, v74
  v_mul_f32 v129, v75, v75
  v_fma_f32 v128, v128, s48, v126
  v_fma_f32 v129, v129, s48, v126
  v_mul_f32 v128, v128, v74
  v_mul_f32 v129, v129, v75
  v_exp_f32 v128, v128
  v_exp_f32 v129, v129
  v_add_f32 v128, 1.0, v128
  v_add_f32 v129, 1.0, v129
  v_rcp_f32 v128, v128
  v_rcp_f32 v129, v129
  v_mul_f32 v128, v128, v74
  v_mul_f32 v129, v129, v75
  v_cvt_pk_bf16_f32 v122, v128, v129
  v_add_f32 v42, v42, v128
  v_add_f32 v43, v43, v129
  v_fma_f32 v50, v128, v128, v50
  v_fma_f32 v51, v129, v129, v51
  v_fma_f32 v76, v28, v140, v76
  v_fma_f32 v77, v29, v140, v77
  v_mul_f32 v76, v76, v36
  v_mul_f32 v77, v77, v37
  v_mul_f32 v132, v76, v76
  v_mul_f32 v133, v77, v77
  v_fma_f32 v132, v132, s48, v126
  v_fma_f32 v133, v133, s48, v126
  v_mul_f32 v132, v132, v76
  v_mul_f32 v133, v133, v77
  v_exp_f32 v132, v132
  v_exp_f32 v133, v133
  v_add_f32 v132, 1.0, v132
  v_add_f32 v133, 1.0, v133
  v_rcp_f32 v132, v132
  v_rcp_f32 v133, v133
  v_mul_f32 v132, v132, v76
  v_mul_f32 v133, v133, v77
  v_cvt_pk_bf16_f32 v123, v132, v133
  v_add_f32 v44, v44, v132
  v_add_f32 v45, v45, v133
  v_fma_f32 v52, v132, v132, v52
  v_fma_f32 v53, v133, v133, v53
  s_barrier
  v_fma_f32 v86, v30, v140, v86
  v_fma_f32 v87, v31, v140, v87
  v_mul_f32 v86, v86, v38
  v_mul_f32 v87, v87, v39
  v_mul_f32 v128, v86, v86
  v_mul_f32 v129, v87, v87
  v_fma_f32 v128, v128, s48, v126
  v_fma_f32 v129, v129, s48, v126
  v_mul_f32 v128, v128, v86
  v_mul_f32 v129, v129, v87
  v_exp_f32 v128, v128
  v_exp_f32 v129, v129
  v_add_f32 v128, 1.0, v128
  v_add_f32 v129, 1.0, v129
  v_rcp_f32 v128, v128
  v_rcp_f32 v129, v129
  v_mul_f32 v128, v128, v86
  v_mul_f32 v129, v129, v87
  v_cvt_pk_bf16_f32 v124, v128, v129
  v_add_f32 v46, v46, v128
  v_add_f32 v47, v47, v129
  v_fma_f32 v54, v128, v128, v54
  v_fma_f32 v55, v129, v129, v55
  v_fma_f32 v88, v32, v140, v88
  v_fma_f32 v89, v33, v140, v89
  v_mul_f32 v88, v88, v40
  v_mul_f32 v89, v89, v41
  v_mul_f32 v132, v88, v88
  v_mul_f32 v133, v89, v89
  v_fma_f32 v132, v132, s48, v126
  v_fma_f32 v133, v133, s48, v126
  v_mul_f32 v132, v132, v88
  v_mul_f32 v133, v133, v89
  v_exp_f32 v132, v132
  v_exp_f32 v133, v133
  v_add_f32 v132, 1.0, v132
  v_add_f32 v133, 1.0, v133
  v_rcp_f32 v132, v132
  v_rcp_f32 v133, v133
  v_mul_f32 v132, v132, v88
  v_mul_f32 v133, v133, v89
  v_cvt_pk_bf16_f32 v125, v132, v133
  v_add_f32 v48, v48, v132
  v_add_f32 v49, v49, v133
  v_fma_f32 v56, v132, v132, v56
  v_fma_f32 v57, v133, v133, v57
  s_barrier
  v_add_f32_dpp v42, v42, v42 row_ror:8 row_mask:0xf bank_mask:0xf
  v_add_f32_dpp v43, v43, v43 row_ror:8 row_mask:0xf bank_mask:0xf
  v_add_f32_dpp v44, v44, v44 row_ror:8 row_mask:0xf bank_mask:0xf
  v_add_f32_dpp v45, v45, v45 row_ror:8 row_mask:0xf bank_mask:0xf
  v_add_f32_dpp v46, v46, v46 row_ror:8 row_mask:0xf bank_mask:0xf
  v_add_f32_dpp v47, v47, v47 row_ror:8 row_mask:0xf bank_mask:0xf
  v_add_f32_dpp v48, v48, v48 row_ror:8 row_mask:0xf bank_mask:0xf
  v_add_f32_dpp v49, v49, v49 row_ror:8 row_mask:0xf bank_mask:0xf
  v_add_f32_dpp v50, v50, v50 row_ror:8 row_mask:0xf bank_mask:0xf
  v_add_f32_dpp v51, v51, v51 row_ror:8 row_mask:0xf bank_mask:0xf
  v_add_f32_dpp v52, v52, v52 row_ror:8 row_mask:0xf bank_mask:0xf
  v_add_f32_dpp v53, v53, v53 row_ror:8 row_mask:0xf bank_mask:0xf
  v_add_f32_dpp v54, v54, v54 row_ror:8 row_mask:0xf bank_mask:0xf
  v_add_f32_dpp v55, v55, v55 row_ror:8 row_mask:0xf bank_mask:0xf
  v_add_f32_dpp v56, v56, v56 row_ror:8 row_mask:0xf bank_mask:0xf
  v_add_f32_dpp v57, v57, v57 row_ror:8 row_mask:0xf bank_mask:0xf
  v_add_f32_dpp v42, v42, v42 row_ror:4 row_mask:0xf bank_mask:0xf
  v_add_f32_dpp v43, v43, v43 row_ror:4 row_mask:0xf bank_mask:0xf
  v_add_f32_dpp v44, v44, v44 row_ror:4 row_mask:0xf bank_mask:0xf
  v_add_f32_dpp v45, v45, v45 row_ror:4 row_mask:0xf bank_mask:0xf
  v_add_f32_dpp v46, v46, v46 row_ror:4 row_mask:0xf bank_mask:0xf
  v_add_f32_dpp v47, v47, v47 row_ror:4 row_mask:0xf bank_mask:0xf
  v_add_f32_dpp v48, v48, v48 row_ror:4 row_mask:0xf bank_mask:0xf
  v_add_f32_dpp v49, v49, v49 row_ror:4 row_mask:0xf bank_mask:0xf
  v_add_f32_dpp v50, v50, v50 row_ror:4 row_mask:0xf bank_mask:0xf
  v_add_f32_dpp v51, v51, v51 row_ror:4 row_mask:0xf bank_mask:0xf
  v_add_f32_dpp v52, v52, v52 row_ror:4 row_mask:0xf bank_mask:0xf
  v_add_f32_dpp v53, v53, v53 row_ror:4 row_mask:0xf bank_mask:0xf
  v_add_f32_dpp v54, v54, v54 row_ror:4 row_mask:0xf bank_mask:0xf
  v_add_f32_dpp v55, v55, v55 row_ror:4 row_mask:0xf bank_mask:0xf
  v_add_f32_dpp v56, v56, v56 row_ror:4 row_mask:0xf bank_mask:0xf
  v_add_f32_dpp v57, v57, v57 row_ror:4 row_mask:0xf bank_mask:0xf
  v_add_f32_dpp v42, v42, v42 row_ror:2 row_mask:0xf bank_mask:0xf
  v_add_f32_dpp v43, v43, v43 row_ror:2 row_mask:0xf bank_mask:0xf
  v_add_f32_dpp v44, v44, v44 row_ror:2 row_mask:0xf bank_mask:0xf
  v_add_f32_dpp v45, v45, v45 row_ror:2 row_mask:0xf bank_mask:0xf
  v_add_f32_dpp v46, v46, v46 row_ror:2 row_mask:0xf bank_mask:0xf
  v_add_f32_dpp v47, v47, v47 row_ror:2 row_mask:0xf bank_mask:0xf
  v_add_f32_dpp v48, v48, v48 row_ror:2 row_mask:0xf bank_mask:0xf
  v_add_f32_dpp v49, v49, v49 row_ror:2 row_mask:0xf bank_mask:0xf
  v_add_f32_dpp v50, v50, v50 row_ror:2 row_mask:0xf bank_mask:0xf
  v_add_f32_dpp v51, v51, v51 row_ror:2 row_mask:0xf bank_mask:0xf
  v_add_f32_dpp v52, v52, v52 row_ror:2 row_mask:0xf bank_mask:0xf
  v_add_f32_dpp v53, v53, v53 row_ror:2 row_mask:0xf bank_mask:0xf
  v_add_f32_dpp v54, v54, v54 row_ror:2 row_mask:0xf bank_mask:0xf
  v_add_f32_dpp v55, v55, v55 row_ror:2 row_mask:0xf bank_mask:0xf
  v_add_f32_dpp v56, v56, v56 row_ror:2 row_mask:0xf bank_mask:0xf
  v_add_f32_dpp v57, v57, v57 row_ror:2 row_mask:0xf bank_mask:0xf
  v_add_f32_dpp v42, v42, v42 row_ror:1 row_mask:0xf bank_mask:0xf
  v_add_f32_dpp v43, v43, v43 row_ror:1 row_mask:0xf bank_mask:0xf
  v_add_f32_dpp v44, v44, v44 row_ror:1 row_mask:0xf bank_mask:0xf
  v_add_f32_dpp v45, v45, v45 row_ror:1 row_mask:0xf bank_mask:0xf
  v_add_f32_dpp v46, v46, v46 row_ror:1 row_mask:0xf bank_mask:0xf
  v_add_f32_dpp v47, v47, v47 row_ror:1 row_mask:0xf bank_mask:0xf
  v_add_f32_dpp v48, v48, v48 row_ror:1 row_mask:0xf bank_mask:0xf
  v_add_f32_dpp v49, v49, v49 row_ror:1 row_mask:0xf bank_mask:0xf
  v_add_f32_dpp v50, v50, v50 row_ror:1 row_mask:0xf bank_mask:0xf
  v_add_f32_dpp v51, v51, v51 row_ror:1 row_mask:0xf bank_mask:0xf
  v_add_f32_dpp v52, v52, v52 row_ror:1 row_mask:0xf bank_mask:0xf
  v_add_f32_dpp v53, v53, v53 row_ror:1 row_mask:0xf bank_mask:0xf
  v_add_f32_dpp v54, v54, v54 row_ror:1 row_mask:0xf bank_mask:0xf
  v_add_f32_dpp v55, v55, v55 row_ror:1 row_mask:0xf bank_mask:0xf
  v_add_f32_dpp v56, v56, v56 row_ror:1 row_mask:0xf bank_mask:0xf
  v_add_f32_dpp v57, v57, v57 row_ror:1 row_mask:0xf bank_mask:0xf
  s_lshl_b32 s40, s36, 8
  s_add_u32 s40, s40, 2048
  v_add_u32 v19, s40, v19
  v_add_u32 v20, s40, v20
  s_mov_b32 exec_lo, 0x10001
  s_mov_b32 exec_hi, 0x10001
  ds_write_b128 v19, v[42:45]
  ds_write_b128 v20, v[46:49]
  ds_write_b128 v19, v[50:53] offset:512
  ds_write_b128 v20, v[54:57] offset:512
  s_mov_b64 exec, s[52:53]
  s_waitcnt lgkmcnt(0)
  s_barrier
  s_cmp_eq_u32 s34, 0
  s_cbranch_scc0 K1_NOPUB
  v_lshlrev_b32 v14, 2, v1
  v_add_u32 v14, 145408, v14
  ds_read_b32 v16, v14
  ds_read_b32 v18, v14 offset:256
  ds_read_b32 v17, v14 offset:512
  ds_read_b32 v19, v14 offset:768
  s_lshl_b32 s40, s32, 3
  s_add_u32 s40, s40, s33
  s_lshl_b32 s40, s40, 9
  s_add_u32 s40, s40, 16842752
  v_lshlrev_b32 v15, 3, v1
  s_waitcnt lgkmcnt(0)
  v_add_f32 v16, v16, v18
  v_add_f32 v17, v17, v19
  v_max_f32 v17, 0, v17
  buffer_store_dwordx2 v[16:17], v15, s[16:19], s40 offen sc1
K1_NOPUB:
  s_mul_i32 s40, s33, 6
  s_mul_i32 s41, s36, 3
  s_add_u32 s40, s40, s41
  s_lshl_b32 s40, s40, 6
  s_lshl_b32 s41, s32, 1
  s_add_u32 s40, s40, s41
  s_add_u32 s40, s40, s35
  s_lshl_b32 s40, s40, 10
  s_add_u32 s39, s40, 3145728
  v_and_b32 v21, 1, v2
  v_lshlrev_b32 v21, 1, v21
  v_lshrrev_b32 v24, 1, v2
  v_or_b32 v21, v21, v24
  s_lshl_b32 s41, s36, 1
  v_xor_b32 v21, s41, v21
  v_lshlrev_b32 v21, 4, v21
  v_add_u32 v21, v21, v3
  v_lshlrev_b32 v21, 4, v21
  v_and_b32 v24, 31, v1
  s_lshl_b32 s38, s35, 5
  v_add_u32 v24, s38, v24
  v_lshlrev_b32 v24, 3, v24
  s_lshl_b32 s38, s32, 12
  s_add_u32 s38, s38, 16842752
  buffer_load_dword v23, v22, s[4:7], 0 offen offset:0 sc1
  s_barrier
  s_barrier
  s_barrier
  s_waitcnt vmcnt(0)
  s_mov_b32 s54, 0
K1_CCHK:
  v_readfirstlane_b32 s40, v23
  s_nop 0
  s_cmp_ge_u32 s40, 8
  s_cbranch_scc1 K1_COK
  s_add_u32 s54, s54, 1
  s_cmp_lt_u32 s54, 0x200000
  s_cbranch_scc0 K1_COK
  s_sleep 4
  buffer_load_dword v23, v22, s[4:7], 0 offen offset:0 sc1
  s_waitcnt vmcnt(0)
  s_branch K1_CCHK
K1_COK:
  buffer_load_dwordx2 v[44:45], v24, s[16:19], s38 offen offset:0 sc1
  buffer_load_dwordx2 v[46:47], v24, s[16:19], s38 offen offset:512 sc1
  buffer_load_dwordx2 v[48:49], v24, s[16:19], s38 offen offset:1024 sc1
  buffer_load_dwordx2 v[50:51], v24, s[16:19], s38 offen offset:1536 sc1
  buffer_load_dwordx2 v[52:53], v24, s[16:19], s38 offen offset:2048 sc1
  buffer_load_dwordx2 v[54:55], v24, s[16:19], s38 offen offset:2560 sc1
  buffer_load_dwordx2 v[56:57], v24, s[16:19], s38 offen offset:3072 sc1
  buffer_load_dwordx2 v[58:59], v24, s[16:19], s38 offen offset:3584 sc1
  s_barrier
  s_setprio 0
  s_waitcnt vmcnt(0)
  s_mov_b32 s54, 0
K1_CHECK:
  s_mov_b32 s40, 0xbf800000
  v_cmp_eq_u32 vcc, s40, v45
  v_cmp_eq_u32 s[56:57], s40, v47
  s_nop 0
  s_or_b64 vcc, vcc, s[56:57]
  v_cmp_eq_u32 s[56:57], s40, v49
  s_nop 0
  s_or_b64 vcc, vcc, s[56:57]
  v_cmp_eq_u32 s[56:57], s40, v51
  s_nop 0
  s_or_b64 vcc, vcc, s[56:57]
  v_cmp_eq_u32 s[56:57], s40, v53
  s_nop 0
  s_or_b64 vcc, vcc, s[56:57]
  v_cmp_eq_u32 s[56:57], s40, v55
  s_nop 0
  s_or_b64 vcc, vcc, s[56:57]
  v_cmp_eq_u32 s[56:57], s40, v57
  s_nop 0
  s_or_b64 vcc, vcc, s[56:57]
  v_cmp_eq_u32 s[56:57], s40, v59
  s_nop 0
  s_or_b64 vcc, vcc, s[56:57]
  s_cmp_eq_u64 vcc, 0
  s_cbranch_scc1 K1_POLLED
  s_add_u32 s54, s54, 1
  s_cmp_lt_u32 s54, 0x200000
  s_cbranch_scc0 K1_POLLED
  buffer_load_dwordx2 v[44:45], v24, s[16:19], s38 offen offset:0 sc1
  buffer_load_dwordx2 v[46:47], v24, s[16:19], s38 offen offset:512 sc1
  buffer_load_dwordx2 v[48:49], v24, s[16:19], s38 offen offset:1024 sc1
  buffer_load_dwordx2 v[50:51], v24, s[16:19], s38 offen offset:1536 sc1
  buffer_load_dwordx2 v[52:53], v24, s[16:19], s38 offen offset:2048 sc1
  buffer_load_dwordx2 v[54:55], v24, s[16:19], s38 offen offset:2560 sc1
  buffer_load_dwordx2 v[56:57], v24, s[16:19], s38 offen offset:3072 sc1
  buffer_load_dwordx2 v[58:59], v24, s[16:19], s38 offen offset:3584 sc1
  s_waitcnt vmcnt(0)
  s_branch K1_CHECK
K1_POLLED:
  v_add_f32 v44, v44, v46
  v_add_f32 v45, v45, v47
  v_add_f32 v44, v44, v48
  v_add_f32 v45, v45, v49
  v_add_f32 v44, v44, v50
  v_add_f32 v45, v45, v51
  v_add_f32 v44, v44, v52
  v_add_f32 v45, v45, v53
  v_add_f32 v44, v44, v54
  v_add_f32 v45, v45, v55
  v_add_f32 v44, v44, v56
  v_add_f32 v45, v45, v57
  v_add_f32 v44, v44, v58
  v_add_f32 v45, v45, v59
  v_mul_f32 v16, 0x3aaaaaab, v44
  v_mul_f32 v18, 0x3aaaaaab, v45
  v_fma_f32 v18, -v16, v16, v18
  v_max_f32 v18, 0, v18
  v_cvt_pk_bf16_f32 v16, v16, v16
  v_lshlrev_b32 v16, 16, v16
  v_cvt_pk_bf16_f32 v18, v18, v18
  v_lshlrev_b32 v18, 16, v18
  v_add_f32 v18, 0x3727c5ac, v18
  v_cvt_pk_bf16_f32 v18, v18, v18
  v_lshlrev_b32 v18, 16, v18
  v_sqrt_f32 v18, v18
  s_nop 0
  v_cvt_pk_bf16_f32 v18, v18, v18
  v_lshlrev_b32 v18, 16, v18
  v_rcp_f32 v17, v18
  s_nop 0
  v_mul_f32 v16, v16, v17
  v_sub_f32 v16, 0, v16
  s_lshl_b32 s40, s55, 8
  s_add_u32 s40, s40, 146432
  v_and_b32 v18, 31, v1
  v_lshlrev_b32 v18, 2, v18
  v_add_u32 v18, s40, v18
  ds_write_b32 v18, v16
  ds_write_b32 v18, v17 offset:128
  s_lshl_b32 s41, s36, 6
  s_add_u32 s40, s40, s41
  v_lshlrev_b32 v19, 4, v2
  v_add_u32 v19, s40, v19
  v_xor_b32 v20, 64, v19
  s_waitcnt lgkmcnt(0)
  ds_read_b128 v[26:29], v19
  ds_read_b128 v[30:33], v20
  ds_read_b128 v[34:37], v19 offset:128
  ds_read_b128 v[38:41], v20 offset:128
  s_waitcnt lgkmcnt(0)
  v_lshlrev_b32 v128, 16, v114
  v_and_b32 v129, s47, v114
  v_pk_fma_f32 v[128:129], v[128:129], v[34:35], v[26:27]
  v_cvt_pk_bf16_f32 v114, v128, v129
  v_lshlrev_b32 v132, 16, v115
  v_and_b32 v133, s47, v115
  v_pk_fma_f32 v[132:133], v[132:133], v[36:37], v[28:29]
  v_cvt_pk_bf16_f32 v115, v132, v133
  v_lshlrev_b32 v128, 16, v116
  v_and_b32 v129, s47, v116
  v_pk_fma_f32 v[128:129], v[128:129], v[38:39], v[30:31]
  v_cvt_pk_bf16_f32 v116, v128, v129
  v_lshlrev_b32 v132, 16, v117
  v_and_b32 v133, s47, v117
  v_pk_fma_f32 v[132:133], v[132:133], v[40:41], v[32:33]
  v_cvt_pk_bf16_f32 v117, v132, v133
  v_permlane16_swap_b32 v114, v116
  s_nop 0
  v_permlane16_swap_b32 v115, v117
  s_add_u32 s41, s39, 0
  buffer_store_dwordx4 v[114:117], v21, s[16:19], s41 offen sc1
  v_lshlrev_b32 v128, 16, v118
  v_and_b32 v129, s47, v118
  v_pk_fma_f32 v[128:129], v[128:129], v[34:35], v[26:27]
  v_cvt_pk_bf16_f32 v118, v128, v129
  v_lshlrev_b32 v132, 16, v119
  v_and_b32 v133, s47, v119
  v_pk_fma_f32 v[132:133], v[132:133], v[36:37], v[28:29]
  v_cvt_pk_bf16_f32 v119, v132, v133
  v_lshlrev_b32 v128, 16, v120
  v_and_b32 v129, s47, v120
  v_pk_fma_f32 v[128:129], v[128:129], v[38:39], v[30:31]
  v_cvt_pk_bf16_f32 v120, v128, v129
  v_lshlrev_b32 v132, 16, v121
  v_and_b32 v133, s47, v121
  v_pk_fma_f32 v[132:133], v[132:133], v[40:41], v[32:33]
  v_cvt_pk_bf16_f32 v121, v132, v133
  v_permlane16_swap_b32 v118, v120
  s_nop 0
  v_permlane16_swap_b32 v119, v121
  s_add_u32 s41, s39, 65536
  buffer_store_dwordx4 v[118:121], v21, s[16:19], s41 offen sc1
  v_lshlrev_b32 v128, 16, v122
  v_and_b32 v129, s47, v122
  v_pk_fma_f32 v[128:129], v[128:129], v[34:35], v[26:27]
  v_cvt_pk_bf16_f32 v122, v128, v129
  v_lshlrev_b32 v132, 16, v123
  v_and_b32 v133, s47, v123
  v_pk_fma_f32 v[132:133], v[132:133], v[36:37], v[28:29]
  v_cvt_pk_bf16_f32 v123, v132, v133
  v_lshlrev_b32 v128, 16, v124
  v_and_b32 v129, s47, v124
  v_pk_fma_f32 v[128:129], v[128:129], v[38:39], v[30:31]
  v_cvt_pk_bf16_f32 v124, v128, v129
  v_lshlrev_b32 v132, 16, v125
  v_and_b32 v133, s47, v125
  v_pk_fma_f32 v[132:133], v[132:133], v[40:41], v[32:33]
  v_cvt_pk_bf16_f32 v125, v132, v133
  v_permlane16_swap_b32 v122, v124
  s_nop 0
  v_permlane16_swap_b32 v123, v125
  s_add_u32 s41, s39, 131072
  buffer_store_dwordx4 v[122:125], v21, s[16:19], s41 offen sc1
  s_waitcnt vmcnt(0)
  s_barrier
  s_load_dwordx2 s[56:57], s[0:1], 72
  s_and_b32 s35, s34, 1
  s_lshr_b32 s36, s34, 1
  v_xor_b32 v9, v2, v3
  v_lshlrev_b32 v9, 4, v9
  s_lshl_b32 s40, s36, 6
  v_xor_b32 v9, s40, v9
  v_lshlrev_b32 v10, 8, v3
  v_add_u32 v4, v9, v10
  v_xor_b32 v5, 128, v4
  s_mul_i32 s40, s33, 6
  s_mul_i32 s41, s35, 3
  s_add_u32 s40, s40, s41
  s_lshl_b32 s40, s40, 16
  s_add_u32 s40, s40, 3145728
  v_lshlrev_b32 v9, 4, v1
  s_add_u32 s41, s40, 0
  v_add_u32 v6, s41, v9
  s_add_u32 s41, s40, 65536
  v_add_u32 v7, s41, v9
  s_add_u32 s41, s40, 131072
  v_add_u32 v8, s41, v9
  s_lshl_b32 s39, s36, 10
  v_mov_b32 v48, 0
  v_mov_b32 v49, 0
  v_mov_b32 v50, 0
  v_mov_b32 v51, 0
  v_mov_b32 v52, 0
  v_mov_b32 v53, 0
  v_mov_b32 v54, 0
  v_mov_b32 v55, 0
  v_mov_b32 v56, 0
  v_mov_b32 v57, 0
  v_mov_b32 v58, 0
  v_mov_b32 v59, 0
  v_mov_b32 v60, 0
  v_mov_b32 v61, 0
  v_mov_b32 v62, 0
  v_mov_b32 v63, 0
  v_mov_b32 v64, 0
  v_mov_b32 v65, 0
  v_mov_b32 v66, 0
  v_mov_b32 v67, 0
  v_mov_b32 v68, 0
  v_mov_b32 v69, 0
  v_mov_b32 v70, 0
  v_mov_b32 v71, 0
  v_mov_b32 v72, 0
  v_mov_b32 v73, 0
  v_mov_b32 v74, 0
  v_mov_b32 v75, 0
  v_mov_b32 v76, 0
  v_mov_b32 v77, 0
  v_mov_b32 v78, 0
  v_mov_b32 v79, 0
  v_mov_b32 v80, 0
  v_mov_b32 v81, 0
  v_mov_b32 v82, 0
  v_mov_b32 v83, 0
  v_mov_b32 v84, 0
  v_mov_b32 v85, 0
  v_mov_b32 v86, 0
  v_mov_b32 v87, 0
  v_mov_b32 v88, 0
  v_mov_b32 v89, 0
  v_mov_b32 v90, 0
  v_mov_b32 v91, 0
  v_mov_b32 v92, 0
  v_mov_b32 v93, 0
  v_mov_b32 v94, 0
  v_mov_b32 v95, 0
  s_waitcnt lgkmcnt(0)
  s_mov_b32 s12, s56
  s_and_b32 s13, s57, 0xffff
  s_mov_b32 s14, 4096
  s_mov_b32 s15, 0x20000
  s_barrier
  s_add_u32 s38, s39, 0
  buffer_load_dwordx4 v[96:99], v6, s[16:19], s38 offen sc1
  buffer_load_dwordx4 v[100:103], v7, s[16:19], s38 offen sc1
  buffer_load_dwordx4 v[104:107], v8, s[16:19], s38 offen sc1
  s_add_u32 s38, s39, 2048
  buffer_load_dwordx4 v[108:111], v6, s[16:19], s38 offen sc1
  buffer_load_dwordx4 v[112:115], v7, s[16:19], s38 offen sc1
  buffer_load_dwordx4 v[116:119], v8, s[16:19], s38 offen sc1
  s_add_u32 s38, s39, 4096
  buffer_load_dwordx4 v[120:123], v6, s[16:19], s38 offen sc1
  buffer_load_dwordx4 v[124:127], v7, s[16:19], s38 offen sc1
  buffer_load_dwordx4 v[128:131], v8, s[16:19], s38 offen sc1
  s_add_u32 s38, s39, 6144
  buffer_load_dwordx4 v[132:135], v6, s[16:19], s38 offen sc1
  buffer_load_dwordx4 v[136:139], v7, s[16:19], s38 offen sc1
  buffer_load_dwordx4 v[140:143], v8, s[16:19], s38 offen sc1
  s_add_u32 s38, s39, 8192
  buffer_load_dwordx4 v[144:147], v6, s[16:19], s38 offen sc1
  buffer_load_dwordx4 v[148:151], v7, s[16:19], s38 offen sc1
  buffer_load_dwordx4 v[152:155], v8, s[16:19], s38 offen sc1
  s_mov_b32 s37, 0
  ds_read_b128 v[16:19], v4 offset:0
  ds_read_b128 v[20:23], v4 offset:4096
  ds_read_b128 v[24:27], v4 offset:8192
  ds_read_b128 v[28:31], v4 offset:12288
F2_GLOOP:
  s_lshl_b32 s40, s37, 1
  s_add_u32 s40, s40, 5
  s_lshl_b32 s38, s40, 11
  s_add_u32 s38, s38, s39
  s_cmp_lt_u32 s40, 32
  s_cselect_b32 s38, s38, 0x80000000
  s_waitcnt vmcnt(12) lgkmcnt(0)
  v_mfma_f32_16x16x32_bf16 v[48:51], v[96:99], v[16:19], v[48:51]
  ds_read_b128 v[32:35], v5 offset:0
  v_mfma_f32_16x16x32_bf16 v[64:67], v[100:103], v[16:19], v[64:67]
  ds_read_b128 v[36:39], v5 offset:4096
  v_mfma_f32_16x16x32_bf16 v[80:83], v[104:107], v[16:19], v[80:83]
  ds_read_b128 v[40:43], v5 offset:8192
  v_mfma_f32_16x16x32_bf16 v[52:55], v[96:99], v[20:23], v[52:55]
  ds_read_b128 v[44:47], v5 offset:12288
  v_mfma_f32_16x16x32_bf16 v[68:71], v[100:103], v[20:23], v[68:71]
  buffer_load_dwordx4 v[156:159], v6, s[16:19], s38 offen sc1
  v_mfma_f32_16x16x32_bf16 v[84:87], v[104:107], v[20:23], v[84:87]
  v_mfma_f32_16x16x32_bf16 v[56:59], v[96:99], v[24:27], v[56:59]
  buffer_load_dwordx4 v[160:163], v7, s[16:19], s38 offen sc1
  v_mfma_f32_16x16x32_bf16 v[72:75], v[100:103], v[24:27], v[72:75]
  v_mfma_f32_16x16x32_bf16 v[88:91], v[104:107], v[24:27], v[88:91]
  buffer_load_dwordx4 v[164:167], v8, s[16:19], s38 offen sc1
  v_mfma_f32_16x16x32_bf16 v[60:63], v[96:99], v[28:31], v[60:63]
  v_mfma_f32_16x16x32_bf16 v[76:79], v[100:103], v[28:31], v[76:79]
  v_mfma_f32_16x16x32_bf16 v[92:95], v[104:107], v[28:31], v[92:95]
  s_and_b32 s40, s37, 3
  s_movk_i32 s43, 16384
  s_cmp_eq_u32 s40, 3
  s_cselect_b32 s43, 4294918144, s43
  s_lshl_b32 s40, s37, 1
  s_add_u32 s40, s40, 6
  s_lshl_b32 s38, s40, 11
  s_add_u32 s38, s38, s39
  s_cmp_lt_u32 s40, 32
  s_cselect_b32 s38, s38, 0x80000000
  s_waitcnt lgkmcnt(0)
  s_barrier
  v_add_u32 v4, s43, v4
  s_waitcnt vmcnt(12)
  v_mfma_f32_16x16x32_bf16 v[48:51], v[108:111], v[32:35], v[48:51]
  ds_read_b128 v[16:19], v4 offset:0
  v_mfma_f32_16x16x32_bf16 v[64:67], v[112:115], v[32:35], v[64:67]
  ds_read_b128 v[20:23], v4 offset:4096
  v_mfma_f32_16x16x32_bf16 v[80:83], v[116:119], v[32:35], v[80:83]
  ds_read_b128 v[24:27], v4 offset:8192
  v_mfma_f32_16x16x32_bf16 v[52:55], v[108:111], v[36:39], v[52:55]
  ds_read_b128 v[28:31], v4 offset:12288
  v_mfma_f32_16x16x32_bf16 v[68:71], v[112:115], v[36:39], v[68:71]
  buffer_load_dwordx4 v[96:99], v6, s[16:19], s38 offen sc1
  v_mfma_f32_16x16x32_bf16 v[84:87], v[116:119], v[36:39], v[84:87]
  v_mfma_f32_16x16x32_bf16 v[56:59], v[108:111], v[40:43], v[56:59]
  buffer_load_dwordx4 v[100:103], v7, s[16:19], s38 offen sc1
  v_mfma_f32_16x16x32_bf16 v[72:75], v[112:115], v[40:43], v[72:75]
  v_mfma_f32_16x16x32_bf16 v[88:91], v[116:119], v[40:43], v[88:91]
  buffer_load_dwordx4 v[104:107], v8, s[16:19], s38 offen sc1
  v_mfma_f32_16x16x32_bf16 v[60:63], v[108:111], v[44:47], v[60:63]
  v_mfma_f32_16x16x32_bf16 v[76:79], v[112:115], v[44:47], v[76:79]
  v_mfma_f32_16x16x32_bf16 v[92:95], v[116:119], v[44:47], v[92:95]
  v_add_u32 v5, s43, v5
  s_add_u32 s37, s37, 1
  s_cmp_eq_u32 s37, 16
  s_cbranch_scc1 F2_GDONE
  s_lshl_b32 s40, s37, 1
  s_add_u32 s40, s40, 5
  s_lshl_b32 s38, s40, 11
  s_add_u32 s38, s38, s39
  s_cmp_lt_u32 s40, 32
  s_cselect_b32 s38, s38, 0x80000000
  s_waitcnt vmcnt(12) lgkmcnt(0)
  v_mfma_f32_16x16x32_bf16 v[48:51], v[120:123], v[16:19], v[48:51]
  ds_read_b128 v[32:35], v5 offset:0
  v_mfma_f32_16x16x32_bf16 v[64:67], v[124:127], v[16:19], v[64:67]
  ds_read_b128 v[36:39], v5 offset:4096
  v_mfma_f32_16x16x32_bf16 v[80:83], v[128:131], v[16:19], v[80:83]
  ds_read_b128 v[40:43], v5 offset:8192
  v_mfma_f32_16x16x32_bf16 v[52:55], v[120:123], v[20:23], v[52:55]
  ds_read_b128 v[44:47], v5 offset:12288
  v_mfma_f32_16x16x32_bf16 v[68:71], v[124:127], v[20:23], v[68:71]
  buffer_load_dwordx4 v[108:111], v6, s[16:19], s38 offen sc1
  v_mfma_f32_16x16x32_bf16 v[84:87], v[128:131], v[20:23], v[84:87]
  v_mfma_f32_16x16x32_bf16 v[56:59], v[120:123], v[24:27], v[56:59]
  buffer_load_dwordx4 v[112:115], v7, s[16:19], s38 offen sc1
  v_mfma_f32_16x16x32_bf16 v[72:75], v[124:127], v[24:27], v[72:75]
  v_mfma_f32_16x16x32_bf16 v[88:91], v[128:131], v[24:27], v[88:91]
  buffer_load_dwordx4 v[116:119], v8, s[16:19], s38 offen sc1
  v_mfma_f32_16x16x32_bf16 v[60:63], v[120:123], v[28:31], v[60:63]
  v_mfma_f32_16x16x32_bf16 v[76:79], v[124:127], v[28:31], v[76:79]
  v_mfma_f32_16x16x32_bf16 v[92:95], v[128:131], v[28:31], v[92:95]
  s_and_b32 s40, s37, 3
  s_movk_i32 s43, 16384
  s_cmp_eq_u32 s40, 3
  s_cselect_b32 s43, 4294918144, s43
  s_lshl_b32 s40, s37, 1
  s_add_u32 s40, s40, 6
  s_lshl_b32 s38, s40, 11
  s_add_u32 s38, s38, s39
  s_cmp_lt_u32 s40, 32
  s_cselect_b32 s38, s38, 0x80000000
  s_waitcnt lgkmcnt(0)
  s_barrier
  v_add_u32 v4, s43, v4
  s_waitcnt vmcnt(12)
  v_mfma_f32_16x16x32_bf16 v[48:51], v[132:135], v[32:35], v[48:51]
  ds_read_b128 v[16:19], v4 offset:0
  v_mfma_f32_16x16x32_bf16 v[64:67], v[136:139], v[32:35], v[64:67]
  ds_read_b128 v[20:23], v4 offset:4096
  v_mfma_f32_16x16x32_bf16 v[80:83], v[140:143], v[32:35], v[80:83]
  ds_read_b128 v[24:27], v4 offset:8192
  v_mfma_f32_16x16x32_bf16 v[52:55], v[132:135], v[36:39], v[52:55]
  ds_read_b128 v[28:31], v4 offset:12288
  v_mfma_f32_16x16x32_bf16 v[68:71], v[136:139], v[36:39], v[68:71]
  buffer_load_dwordx4 v[120:123], v6, s[16:19], s38 offen sc1
  v_mfma_f32_16x16x32_bf16 v[84:87], v[140:143], v[36:39], v[84:87]
  v_mfma_f32_16x16x32_bf16 v[56:59], v[132:135], v[40:43], v[56:59]
  buffer_load_dwordx4 v[124:127], v7, s[16:19], s38 offen sc1
  v_mfma_f32_16x16x32_bf16 v[72:75], v[136:139], v[40:43], v[72:75]
  v_mfma_f32_16x16x32_bf16 v[88:91], v[140:143], v[40:43], v[88:91]
  buffer_load_dwordx4 v[128:131], v8, s[16:19], s38 offen sc1
  v_mfma_f32_16x16x32_bf16 v[60:63], v[132:135], v[44:47], v[60:63]
  v_mfma_f32_16x16x32_bf16 v[76:79], v[136:139], v[44:47], v[76:79]
  v_mfma_f32_16x16x32_bf16 v[92:95], v[140:143], v[44:47], v[92:95]
  v_add_u32 v5, s43, v5
  s_add_u32 s37, s37, 1
  s_cmp_eq_u32 s37, 16
  s_cbranch_scc1 F2_GDONE
  s_lshl_b32 s40, s37, 1
  s_add_u32 s40, s40, 5
  s_lshl_b32 s38, s40, 11
  s_add_u32 s38, s38, s39
  s_cmp_lt_u32 s40, 32
  s_cselect_b32 s38, s38, 0x80000000
  s_waitcnt vmcnt(12) lgkmcnt(0)
  v_mfma_f32_16x16x32_bf16 v[48:51], v[144:147], v[16:19], v[48:51]
  ds_read_b128 v[32:35], v5 offset:0
  v_mfma_f32_16x16x32_bf16 v[64:67], v[148:151], v[16:19], v[64:67]
  ds_read_b128 v[36:39], v5 offset:4096
  v_mfma_f32_16x16x32_bf16 v[80:83], v[152:155], v[16:19], v[80:83]
  ds_read_b128 v[40:43], v5 offset:8192
  v_mfma_f32_16x16x32_bf16 v[52:55], v[144:147], v[20:23], v[52:55]
  ds_read_b128 v[44:47], v5 offset:12288
  v_mfma_f32_16x16x32_bf16 v[68:71], v[148:151], v[20:23], v[68:71]
  buffer_load_dwordx4 v[132:135], v6, s[16:19], s38 offen sc1
  v_mfma_f32_16x16x32_bf16 v[84:87], v[152:155], v[20:23], v[84:87]
  v_mfma_f32_16x16x32_bf16 v[56:59], v[144:147], v[24:27], v[56:59]
  buffer_load_dwordx4 v[136:139], v7, s[16:19], s38 offen sc1
  v_mfma_f32_16x16x32_bf16 v[72:75], v[148:151], v[24:27], v[72:75]
  v_mfma_f32_16x16x32_bf16 v[88:91], v[152:155], v[24:27], v[88:91]
  buffer_load_dwordx4 v[140:143], v8, s[16:19], s38 offen sc1
  v_mfma_f32_16x16x32_bf16 v[60:63], v[144:147], v[28:31], v[60:63]
  v_mfma_f32_16x16x32_bf16 v[76:79], v[148:151], v[28:31], v[76:79]
  v_mfma_f32_16x16x32_bf16 v[92:95], v[152:155], v[28:31], v[92:95]
  s_and_b32 s40, s37, 3
  s_movk_i32 s43, 16384
  s_cmp_eq_u32 s40, 3
  s_cselect_b32 s43, 4294918144, s43
  s_lshl_b32 s40, s37, 1
  s_add_u32 s40, s40, 6
  s_lshl_b32 s38, s40, 11
  s_add_u32 s38, s38, s39
  s_cmp_lt_u32 s40, 32
  s_cselect_b32 s38, s38, 0x80000000
  s_waitcnt lgkmcnt(0)
  s_barrier
  v_add_u32 v4, s43, v4
  s_waitcnt vmcnt(12)
  v_mfma_f32_16x16x32_bf16 v[48:51], v[156:159], v[32:35], v[48:51]
  ds_read_b128 v[16:19], v4 offset:0
  v_mfma_f32_16x16x32_bf16 v[64:67], v[160:163], v[32:35], v[64:67]
  ds_read_b128 v[20:23], v4 offset:4096
  v_mfma_f32_16x16x32_bf16 v[80:83], v[164:167], v[32:35], v[80:83]
  ds_read_b128 v[24:27], v4 offset:8192
  v_mfma_f32_16x16x32_bf16 v[52:55], v[156:159], v[36:39], v[52:55]
  ds_read_b128 v[28:31], v4 offset:12288
  v_mfma_f32_16x16x32_bf16 v[68:71], v[160:163], v[36:39], v[68:71]
  buffer_load_dwordx4 v[144:147], v6, s[16:19], s38 offen sc1
  v_mfma_f32_16x16x32_bf16 v[84:87], v[164:167], v[36:39], v[84:87]
  v_mfma_f32_16x16x32_bf16 v[56:59], v[156:159], v[40:43], v[56:59]
  buffer_load_dwordx4 v[148:151], v7, s[16:19], s38 offen sc1
  v_mfma_f32_16x16x32_bf16 v[72:75], v[160:163], v[40:43], v[72:75]
  v_mfma_f32_16x16x32_bf16 v[88:91], v[164:167], v[40:43], v[88:91]
  buffer_load_dwordx4 v[152:155], v8, s[16:19], s38 offen sc1
  v_mfma_f32_16x16x32_bf16 v[60:63], v[156:159], v[44:47], v[60:63]
  v_mfma_f32_16x16x32_bf16 v[76:79], v[160:163], v[44:47], v[76:79]
  v_mfma_f32_16x16x32_bf16 v[92:95], v[164:167], v[44:47], v[92:95]
  v_add_u32 v5, s43, v5
  s_add_u32 s37, s37, 1
  s_cmp_eq_u32 s37, 16
  s_cbranch_scc0 F2_GLOOP
F2_GDONE:
  s_lshl_b32 s40, s32, 2
  s_add_u32 s45, s40, s34
  v_lshlrev_b32 v10, 1, v3
  s_lshl_b32 s40, s45, 5
  buffer_load_ushort v15, v10, s[12:15], s40 offen
  s_mul_i32 s40, s34, 3072
  v_lshlrev_b32 v9, 4, v1
  v_add_u32 v10, s40, v9
  ds_write_b128 v10, v[48:51] offset:0
  ds_write_b128 v10, v[64:67] offset:1024
  ds_write_b128 v10, v[80:83] offset:2048
  ds_write_b128 v10, v[52:55] offset:12288
  ds_write_b128 v10, v[68:71] offset:13312
  ds_write_b128 v10, v[84:87] offset:14336
  s_waitcnt lgkmcnt(6)
  ds_write_b128 v10, v[56:59] offset:24576
  ds_write_b128 v10, v[72:75] offset:25600
  ds_write_b128 v10, v[88:91] offset:26624
  ds_write_b128 v10, v[60:63] offset:36864
  ds_write_b128 v10, v[76:79] offset:37888
  ds_write_b128 v10, v[92:95] offset:38912
  s_waitcnt lgkmcnt(6)
  s_waitcnt lgkmcnt(0)
  s_barrier
  s_mul_i32 s40, s34, 12288
  v_add_u32 v10, s40, v9
  ds_read_b128 v[16:19], v10 offset:0
  ds_read_b128 v[20:23], v10 offset:1024
  ds_read_b128 v[24:27], v10 offset:2048
  ds_read_b128 v[28:31], v10 offset:3072
  ds_read_b128 v[32:35], v10 offset:4096
  ds_read_b128 v[36:39], v10 offset:5120
  ds_read_b128 v[40:43], v10 offset:6144
  ds_read_b128 v[44:47], v10 offset:7168
  ds_read_b128 v[48:51], v10 offset:8192
  s_waitcnt lgkmcnt(6)
  ds_read_b128 v[52:55], v10 offset:9216
  ds_read_b128 v[56:59], v10 offset:10240
  ds_read_b128 v[60:63], v10 offset:11264
  s_mul_i32 s40, s34, 3072
  s_add_u32 s40, s40, 147456
  v_lshlrev_b32 v11, 3, v1
  v_add_u32 v11, s40, v11
  s_waitcnt lgkmcnt(6)
  ds_read_b64 v[64:65], v11 offset:0
  ds_read_b64 v[66:67], v11 offset:512
  ds_read_b64 v[68:69], v11 offset:1024
  ds_read_b64 v[70:71], v11 offset:1536
  ds_read_b64 v[72:73], v11 offset:2048
  ds_read_b64 v[74:75], v11 offset:2560
  s_barrier
  s_waitcnt vmcnt(0)
  v_lshlrev_b32 v92, 16, v15
  s_mul_i32 s40, s45, 24576
  s_mul_i32 s41, s33, 3072
  s_add_u32 s40, s40, s41
  s_add_u32 s40, s40, 12582912
  s_waitcnt lgkmcnt(0)
  v_pk_add_f32 v[16:17], v[16:17], v[40:41]
  v_pk_add_f32 v[18:19], v[18:19], v[42:43]
  v_lshlrev_b32 v88, 16, v64
  v_and_b32 v89, s47, v64
  v_lshlrev_b32 v90, 16, v65
  v_and_b32 v91, s47, v65
  v_pk_add_f32 v[16:17], v[16:17], v[92:93] op_sel_hi:[1,0]
  v_pk_add_f32 v[18:19], v[18:19], v[92:93] op_sel_hi:[1,0]
  v_pk_mul_f32 v[16:17], v[16:17], v[88:89]
  v_pk_mul_f32 v[18:19], v[18:19], v[90:91]
  v_cvt_pk_bf16_f32 v76, v16, v17
  v_cvt_pk_bf16_f32 v77, v18, v19
  v_pk_add_f32 v[20:21], v[20:21], v[44:45]
  v_pk_add_f32 v[22:23], v[22:23], v[46:47]
  v_lshlrev_b32 v88, 16, v66
  v_and_b32 v89, s47, v66
  v_lshlrev_b32 v90, 16, v67
  v_and_b32 v91, s47, v67
  v_pk_add_f32 v[20:21], v[20:21], v[92:93] op_sel_hi:[1,0]
  v_pk_add_f32 v[22:23], v[22:23], v[92:93] op_sel_hi:[1,0]
  v_pk_mul_f32 v[20:21], v[20:21], v[88:89]
  v_pk_mul_f32 v[22:23], v[22:23], v[90:91]
  v_cvt_pk_bf16_f32 v78, v20, v21
  v_cvt_pk_bf16_f32 v79, v22, v23
  buffer_store_dwordx4 v[76:79], v9, s[16:19], s40 offen offset:0 sc1
  v_pk_add_f32 v[24:25], v[24:25], v[48:49]
  v_pk_add_f32 v[26:27], v[26:27], v[50:51]
  v_lshlrev_b32 v88, 16, v68
  v_and_b32 v89, s47, v68
  v_lshlrev_b32 v90, 16, v69
  v_and_b32 v91, s47, v69
  v_pk_add_f32 v[24:25], v[24:25], v[92:93] op_sel_hi:[1,0]
  v_pk_add_f32 v[26:27], v[26:27], v[92:93] op_sel_hi:[1,0]
  v_pk_mul_f32 v[24:25], v[24:25], v[88:89]
  v_pk_mul_f32 v[26:27], v[26:27], v[90:91]
  v_cvt_pk_bf16_f32 v80, v24, v25
  v_cvt_pk_bf16_f32 v81, v26, v27
  v_pk_add_f32 v[28:29], v[28:29], v[52:53]
  v_pk_add_f32 v[30:31], v[30:31], v[54:55]
  v_lshlrev_b32 v88, 16, v70
  v_and_b32 v89, s47, v70
  v_lshlrev_b32 v90, 16, v71
  v_and_b32 v91, s47, v71
  v_pk_add_f32 v[28:29], v[28:29], v[92:93] op_sel_hi:[1,0]
  v_pk_add_f32 v[30:31], v[30:31], v[92:93] op_sel_hi:[1,0]
  v_pk_mul_f32 v[28:29], v[28:29], v[88:89]
  v_pk_mul_f32 v[30:31], v[30:31], v[90:91]
  v_cvt_pk_bf16_f32 v82, v28, v29
  v_cvt_pk_bf16_f32 v83, v30, v31
  buffer_store_dwordx4 v[80:83], v9, s[16:19], s40 offen offset:1024 sc1
  v_pk_add_f32 v[32:33], v[32:33], v[56:57]
  v_pk_add_f32 v[34:35], v[34:35], v[58:59]
  v_lshlrev_b32 v88, 16, v72
  v_and_b32 v89, s47, v72
  v_lshlrev_b32 v90, 16, v73
  v_and_b32 v91, s47, v73
  v_pk_add_f32 v[32:33], v[32:33], v[92:93] op_sel_hi:[1,0]
  v_pk_add_f32 v[34:35], v[34:35], v[92:93] op_sel_hi:[1,0]
  v_pk_mul_f32 v[32:33], v[32:33], v[88:89]
  v_pk_mul_f32 v[34:35], v[34:35], v[90:91]
  v_cvt_pk_bf16_f32 v84, v32, v33
  v_cvt_pk_bf16_f32 v85, v34, v35
  v_pk_add_f32 v[36:37], v[36:37], v[60:61]
  v_pk_add_f32 v[38:39], v[38:39], v[62:63]
  v_lshlrev_b32 v88, 16, v74
  v_and_b32 v89, s47, v74
  v_lshlrev_b32 v90, 16, v75
  v_and_b32 v91, s47, v75
  v_pk_add_f32 v[36:37], v[36:37], v[92:93] op_sel_hi:[1,0]
  v_pk_add_f32 v[38:39], v[38:39], v[92:93] op_sel_hi:[1,0]
  v_pk_mul_f32 v[36:37], v[36:37], v[88:89]
  v_pk_mul_f32 v[38:39], v[38:39], v[90:91]
  v_cvt_pk_bf16_f32 v86, v36, v37
  v_cvt_pk_bf16_f32 v87, v38, v39
  buffer_store_dwordx4 v[84:87], v9, s[16:19], s40 offen offset:2048 sc1
  s_waitcnt vmcnt(0)
  s_barrier
  s_load_dwordx2 s[56:57], s[0:1], 0
  s_load_dwordx2 s[58:59], s[0:1], 88
  v_lshlrev_b32 v4, 4, v1
  s_lshl_b32 s35, s32, 2
  s_add_u32 s35, s35, s55
  s_lshr_b32 s39, s34, 2
  s_mul_i32 s36, s35, 24576
  s_mul_i32 s40, s39, 12288
  s_add_u32 s36, s36, s40
  s_add_u32 s36, s36, 12582912
  s_mul_i32 s40, s39, 61440
  v_add_u32 v26, s40, v4
  s_lshl_b32 s40, s35, 4
  s_mul_i32 s40, s40, 1280
  s_mul_i32 s41, s33, 160
  s_add_u32 s40, s40, s41
  v_add_u32 v12, 0, v1
  v_mul_u32_u24 v13, 6554, v12
  v_lshrrev_b32 v13, 16, v13
  v_mul_u32_u24 v14, 10, v13
  v_sub_u32 v14, v12, v14
  v_lshlrev_b32 v14, 4, v14
  v_mul_u32_u24 v13, 1280, v13
  v_add_u32 v13, v13, v14
  v_add_u32 v5, s40, v13
  v_add_u32 v12, 64, v1
  v_mul_u32_u24 v13, 6554, v12
  v_lshrrev_b32 v13, 16, v13
  v_mul_u32_u24 v14, 10, v13
  v_sub_u32 v14, v12, v14
  v_lshlrev_b32 v14, 4, v14
  v_mul_u32_u24 v13, 1280, v13
  v_add_u32 v13, v13, v14
  v_add_u32 v6, s40, v13
  v_add_u32 v12, 128, v1
  v_mul_u32_u24 v13, 6554, v12
  v_lshrrev_b32 v13, 16, v13
  v_mul_u32_u24 v14, 10, v13
  v_sub_u32 v14, v12, v14
  v_lshlrev_b32 v14, 4, v14
  v_mul_u32_u24 v13, 1280, v13
  v_add_u32 v13, v13, v14
  v_add_u32 v7, s40, v13
  s_mul_i32 s37, s55, 2560
  s_mul_i32 s38, s33, 327680
  s_lshl_b32 s41, s35, 5
  s_add_u32 s38, s38, s41
  s_add_u32 s38, s38, 9437184
  s_lshl_b32 s40, s55, 6
  s_add_u32 s40, s40, 143360
  v_lshlrev_b32 v21, 2, v3
  v_add_u32 v21, s40, v21
  ds_read_b32 v24, v21
  ds_read_b32 v25, v21 offset:256
  v_mov_b32 v68, 0
  v_mov_b32 v69, 0
  v_mov_b32 v70, 0
  v_mov_b32 v71, 0
  v_mov_b32 v72, 0
  v_mov_b32 v73, 0
  v_mov_b32 v74, 0
  v_mov_b32 v75, 0
  v_mov_b32 v76, 0
  v_mov_b32 v77, 0
  v_mov_b32 v78, 0
  v_mov_b32 v79, 0
  v_mov_b32 v80, 0
  v_mov_b32 v81, 0
  v_mov_b32 v82, 0
  v_mov_b32 v83, 0
  v_mov_b32 v84, 0
  v_mov_b32 v85, 0
  v_mov_b32 v86, 0
  v_mov_b32 v87, 0
  s_waitcnt lgkmcnt(0)
  s_mov_b32 s8, s56
  s_and_b32 s9, s57, 0xffff
  s_mov_b32 s10, 2621440
  s_mov_b32 s11, 0x20000
  s_mov_b32 s12, s58
  s_and_b32 s13, s59, 0xffff
  s_mov_b32 s14, 2621440
  s_mov_b32 s15, 0x20000
  s_add_u32 m0, s37, 122880
  s_nop 0
  buffer_load_dwordx4 v5, s[8:11], 0 offen lds
  s_add_u32 m0, s37, 123904
  s_nop 0
  buffer_load_dwordx4 v6, s[8:11], 0 offen lds
  s_mov_b32 exec_hi, 0
  s_add_u32 m0, s37, 124928
  s_nop 0
  buffer_load_dwordx4 v7, s[8:11], 0 offen lds
  s_mov_b32 exec_hi, -1
  s_barrier
  s_add_u32 s40, s36, 0
  buffer_load_dwordx4 v[88:91], v4, s[16:19], s40 offen offset:0 sc1
  s_add_u32 s40, s36, 0
  buffer_load_dwordx4 v[92:95], v4, s[16:19], s40 offen offset:1024 sc1
  s_add_u32 s40, s36, 0
  buffer_load_dwordx4 v[96:99], v4, s[16:19], s40 offen offset:2048 sc1
  s_add_u32 s40, s36, 0
  buffer_load_dwordx4 v[100:103], v4, s[16:19], s40 offen offset:3072 sc1
  s_add_u32 s40, s36, 4096
  buffer_load_dwordx4 v[104:107], v4, s[16:19], s40 offen offset:0 sc1
  s_barrier
  ds_read_b128 v[28:31], v26 offset:0
  ds_read_b128 v[32:35], v26 offset:1024
  ds_read_b128 v[36:39], v26 offset:2048
  ds_read_b128 v[40:43], v26 offset:3072
  ds_read_b128 v[44:47], v26 offset:4096
  s_waitcnt vmcnt(4) lgkmcnt(0)
  v_mfma_f32_16x16x32_bf16 v[68:71], v[28:31], v[88:91], v[68:71]
  ds_read_b128 v[48:51], v26 offset:5120
  v_mfma_f32_16x16x32_bf16 v[72:75], v[32:35], v[88:91], v[72:75]
  ds_read_b128 v[52:55], v26 offset:6144
  v_mfma_f32_16x16x32_bf16 v[76:79], v[36:39], v[88:91], v[76:79]
  ds_read_b128 v[56:59], v26 offset:7168
  s_add_u32 s40, s36, 4096
  buffer_load_dwordx4 v[108:111], v4, s[16:19], s40 offen offset:1024 sc1
  v_mfma_f32_16x16x32_bf16 v[80:83], v[40:43], v[88:91], v[80:83]
  ds_read_b128 v[60:63], v26 offset:8192
  v_mfma_f32_16x16x32_bf16 v[84:87], v[44:47], v[88:91], v[84:87]
  ds_read_b128 v[64:67], v26 offset:9216
  s_waitcnt vmcnt(4) lgkmcnt(0)
  v_mfma_f32_16x16x32_bf16 v[68:71], v[48:51], v[92:95], v[68:71]
  ds_read_b128 v[28:31], v26 offset:10240
  v_mfma_f32_16x16x32_bf16 v[72:75], v[52:55], v[92:95], v[72:75]
  ds_read_b128 v[32:35], v26 offset:11264
  v_mfma_f32_16x16x32_bf16 v[76:79], v[56:59], v[92:95], v[76:79]
  ds_read_b128 v[36:39], v26 offset:12288
  s_add_u32 s40, s36, 4096
  buffer_load_dwordx4 v[112:115], v4, s[16:19], s40 offen offset:2048 sc1
  v_mfma_f32_16x16x32_bf16 v[80:83], v[60:63], v[92:95], v[80:83]
  ds_read_b128 v[40:43], v26 offset:13312
  v_mfma_f32_16x16x32_bf16 v[84:87], v[64:67], v[92:95], v[84:87]
  ds_read_b128 v[44:47], v26 offset:14336
  s_waitcnt vmcnt(4) lgkmcnt(0)
  v_mfma_f32_16x16x32_bf16 v[68:71], v[28:31], v[96:99], v[68:71]
  ds_read_b128 v[48:51], v26 offset:15360
  v_mfma_f32_16x16x32_bf16 v[72:75], v[32:35], v[96:99], v[72:75]
  ds_read_b128 v[52:55], v26 offset:16384
  v_mfma_f32_16x16x32_bf16 v[76:79], v[36:39], v[96:99], v[76:79]
  ds_read_b128 v[56:59], v26 offset:17408
  s_add_u32 s40, s36, 4096
  buffer_load_dwordx4 v[116:119], v4, s[16:19], s40 offen offset:3072 sc1
  v_mfma_f32_16x16x32_bf16 v[80:83], v[40:43], v[96:99], v[80:83]
  ds_read_b128 v[60:63], v26 offset:18432
  v_mfma_f32_16x16x32_bf16 v[84:87], v[44:47], v[96:99], v[84:87]
  ds_read_b128 v[64:67], v26 offset:19456
  s_waitcnt vmcnt(4) lgkmcnt(0)
  s_barrier
  v_mfma_f32_16x16x32_bf16 v[68:71], v[48:51], v[100:103], v[68:71]
  ds_read_b128 v[28:31], v26 offset:20480
  v_mfma_f32_16x16x32_bf16 v[72:75], v[52:55], v[100:103], v[72:75]
  ds_read_b128 v[32:35], v26 offset:21504
  v_mfma_f32_16x16x32_bf16 v[76:79], v[56:59], v[100:103], v[76:79]
  ds_read_b128 v[36:39], v26 offset:22528
  s_add_u32 s40, s36, 8192
  buffer_load_dwordx4 v[120:123], v4, s[16:19], s40 offen offset:0 sc1
  v_mfma_f32_16x16x32_bf16 v[80:83], v[60:63], v[100:103], v[80:83]
  ds_read_b128 v[40:43], v26 offset:23552
  v_mfma_f32_16x16x32_bf16 v[84:87], v[64:67], v[100:103], v[84:87]
  ds_read_b128 v[44:47], v26 offset:24576
  s_waitcnt vmcnt(4) lgkmcnt(0)
  v_mfma_f32_16x16x32_bf16 v[68:71], v[28:31], v[104:107], v[68:71]
  ds_read_b128 v[48:51], v26 offset:25600
  v_mfma_f32_16x16x32_bf16 v[72:75], v[32:35], v[104:107], v[72:75]
  ds_read_b128 v[52:55], v26 offset:26624
  v_mfma_f32_16x16x32_bf16 v[76:79], v[36:39], v[104:107], v[76:79]
  ds_read_b128 v[56:59], v26 offset:27648
  s_add_u32 s40, s36, 8192
  buffer_load_dwordx4 v[124:127], v4, s[16:19], s40 offen offset:1024 sc1
  v_mfma_f32_16x16x32_bf16 v[80:83], v[40:43], v[104:107], v[80:83]
  ds_read_b128 v[60:63], v26 offset:28672
  v_mfma_f32_16x16x32_bf16 v[84:87], v[44:47], v[104:107], v[84:87]
  ds_read_b128 v[64:67], v26 offset:29696
  s_waitcnt vmcnt(4) lgkmcnt(0)
  v_mfma_f32_16x16x32_bf16 v[68:71], v[48:51], v[108:111], v[68:71]
  ds_read_b128 v[28:31], v26 offset:30720
  v_mfma_f32_16x16x32_bf16 v[72:75], v[52:55], v[108:111], v[72:75]
  ds_read_b128 v[32:35], v26 offset:31744
  v_mfma_f32_16x16x32_bf16 v[76:79], v[56:59], v[108:111], v[76:79]
  ds_read_b128 v[36:39], v26 offset:32768
  s_add_u32 s40, s36, 8192
  buffer_load_dwordx4 v[128:131], v4, s[16:19], s40 offen offset:2048 sc1
  v_mfma_f32_16x16x32_bf16 v[80:83], v[60:63], v[108:111], v[80:83]
  ds_read_b128 v[40:43], v26 offset:33792
  v_mfma_f32_16x16x32_bf16 v[84:87], v[64:67], v[108:111], v[84:87]
  ds_read_b128 v[44:47], v26 offset:34816
  s_waitcnt vmcnt(4) lgkmcnt(0)
  v_mfma_f32_16x16x32_bf16 v[68:71], v[28:31], v[112:115], v[68:71]
  ds_read_b128 v[48:51], v26 offset:35840
  v_mfma_f32_16x16x32_bf16 v[72:75], v[32:35], v[112:115], v[72:75]
  ds_read_b128 v[52:55], v26 offset:36864
  v_mfma_f32_16x16x32_bf16 v[76:79], v[36:39], v[112:115], v[76:79]
  ds_read_b128 v[56:59], v26 offset:37888
  s_add_u32 s40, s36, 8192
  buffer_load_dwordx4 v[132:135], v4, s[16:19], s40 offen offset:3072 sc1
  v_mfma_f32_16x16x32_bf16 v[80:83], v[40:43], v[112:115], v[80:83]
  ds_read_b128 v[60:63], v26 offset:38912
  v_mfma_f32_16x16x32_bf16 v[84:87], v[44:47], v[112:115], v[84:87]
  ds_read_b128 v[64:67], v26 offset:39936
  s_waitcnt vmcnt(4) lgkmcnt(0)
  s_barrier
  v_mfma_f32_16x16x32_bf16 v[68:71], v[48:51], v[116:119], v[68:71]
  ds_read_b128 v[28:31], v26 offset:40960
  v_mfma_f32_16x16x32_bf16 v[72:75], v[52:55], v[116:119], v[72:75]
  ds_read_b128 v[32:35], v26 offset:41984
  v_mfma_f32_16x16x32_bf16 v[76:79], v[56:59], v[116:119], v[76:79]
  ds_read_b128 v[36:39], v26 offset:43008
  v_mfma_f32_16x16x32_bf16 v[80:83], v[60:63], v[116:119], v[80:83]
  ds_read_b128 v[40:43], v26 offset:44032
  v_mfma_f32_16x16x32_bf16 v[84:87], v[64:67], v[116:119], v[84:87]
  ds_read_b128 v[44:47], v26 offset:45056
  s_waitcnt vmcnt(3) lgkmcnt(0)
  v_mfma_f32_16x16x32_bf16 v[68:71], v[28:31], v[120:123], v[68:71]
  ds_read_b128 v[48:51], v26 offset:46080
  v_mfma_f32_16x16x32_bf16 v[72:75], v[32:35], v[120:123], v[72:75]
  ds_read_b128 v[52:55], v26 offset:47104
  v_mfma_f32_16x16x32_bf16 v[76:79], v[36:39], v[120:123], v[76:79]
  ds_read_b128 v[56:59], v26 offset:48128
  v_mfma_f32_16x16x32_bf16 v[80:83], v[40:43], v[120:123], v[80:83]
  ds_read_b128 v[60:63], v26 offset:49152
  v_mfma_f32_16x16x32_bf16 v[84:87], v[44:47], v[120:123], v[84:87]
  ds_read_b128 v[64:67], v26 offset:50176
  s_waitcnt vmcnt(2) lgkmcnt(0)
  v_mfma_f32_16x16x32_bf16 v[68:71], v[48:51], v[124:127], v[68:71]
  ds_read_b128 v[28:31], v26 offset:51200
  v_mfma_f32_16x16x32_bf16 v[72:75], v[52:55], v[124:127], v[72:75]
  ds_read_b128 v[32:35], v26 offset:52224
  v_mfma_f32_16x16x32_bf16 v[76:79], v[56:59], v[124:127], v[76:79]
  ds_read_b128 v[36:39], v26 offset:53248
  v_mfma_f32_16x16x32_bf16 v[80:83], v[60:63], v[124:127], v[80:83]
  ds_read_b128 v[40:43], v26 offset:54272
  v_mfma_f32_16x16x32_bf16 v[84:87], v[64:67], v[124:127], v[84:87]
  ds_read_b128 v[44:47], v26 offset:55296
  s_waitcnt vmcnt(1) lgkmcnt(0)
  v_mfma_f32_16x16x32_bf16 v[68:71], v[28:31], v[128:131], v[68:71]
  ds_read_b128 v[48:51], v26 offset:56320
  v_mfma_f32_16x16x32_bf16 v[72:75], v[32:35], v[128:131], v[72:75]
  ds_read_b128 v[52:55], v26 offset:57344
  v_mfma_f32_16x16x32_bf16 v[76:79], v[36:39], v[128:131], v[76:79]
  ds_read_b128 v[56:59], v26 offset:58368
  v_mfma_f32_16x16x32_bf16 v[80:83], v[40:43], v[128:131], v[80:83]
  ds_read_b128 v[60:63], v26 offset:59392
  v_mfma_f32_16x16x32_bf16 v[84:87], v[44:47], v[128:131], v[84:87]
  ds_read_b128 v[64:67], v26 offset:60416
  s_waitcnt vmcnt(0) lgkmcnt(0)
  v_mfma_f32_16x16x32_bf16 v[68:71], v[48:51], v[132:135], v[68:71]
  v_mfma_f32_16x16x32_bf16 v[72:75], v[52:55], v[132:135], v[72:75]
  v_mfma_f32_16x16x32_bf16 v[76:79], v[56:59], v[132:135], v[76:79]
  v_mfma_f32_16x16x32_bf16 v[80:83], v[60:63], v[132:135], v[80:83]
  v_mfma_f32_16x16x32_bf16 v[84:87], v[64:67], v[132:135], v[84:87]
  s_mul_i32 s40, s55, 5120
  v_add_u32 v12, s40, v4
  s_nop 4
  ds_write_b128 v12, v[80:83] offset:3072
  ds_write_b128 v12, v[84:87] offset:4096
  v_mul_u32_u24 v13, 160, v3
  v_lshlrev_b32 v14, 3, v2
  v_add_u32 v13, v13, v14
  s_add_u32 s40, s37, 122880
  v_add_u32 v13, s40, v13
  v_lshlrev_b32 v14, 7, v2
  v_lshlrev_b32 v15, 3, v3
  v_add_u32 v14, v14, v15
  s_add_u32 s40, s37, 133120
  v_add_u32 v14, s40, v14
  v_sub_f32 v16, 0, v24
  v_mov_b32 v18, v25
  s_mov_b32 s48, 1.0
  s_mov_b32 s49, 1.0
  v_mov_b32 v20, 0xbfb8aa3b
  v_mov_b32 v21, 0xbfb8aa3b
  s_waitcnt vmcnt(0) lgkmcnt(0)
  s_barrier
  ds_read_b64 v[88:89], v13 offset:0
  ds_read_b64_tr_b16 v[98:99], v14 offset:0
  ds_read_b64 v[90:91], v13 offset:32
  ds_read_b64_tr_b16 v[100:101], v14 offset:512
  ds_read_b64 v[92:93], v13 offset:64
  ds_read_b64_tr_b16 v[102:103], v14 offset:1024
  ds_read_b128 v[108:111], v12 offset:0
  ds_read_b128 v[112:115], v12 offset:1024
  ds_read_b128 v[116:119], v12 offset:2048
  s_waitcnt lgkmcnt(0)
  v_pk_add_f32 v[68:69], v[68:69], v[108:109]
  v_lshlrev_b32 v28, 16, v88
  v_and_b32 v29, s47, v88
  v_pk_mul_f32 v[32:33], v[68:69], v[20:21]
  v_lshlrev_b32 v30, 16, v98
  v_and_b32 v31, s47, v98
  v_exp_f32 v32, v32
  v_exp_f32 v33, v33
  v_pk_add_f32 v[34:35], v[28:29], v[16:17] op_sel_hi:[1,0]
  v_pk_add_f32 v[32:33], v[32:33], s[48:49]
  v_pk_mul_f32 v[34:35], v[34:35], v[18:19] op_sel_hi:[1,0]
  v_rcp_f32 v32, v32
  v_rcp_f32 v33, v33
  v_pk_mul_f32 v[34:35], v[34:35], v[30:31]
  v_pk_mul_f32 v[32:33], v[32:33], v[68:69]
  v_pk_fma_f32 v[34:35], v[34:35], v[32:33], v[28:29]
  v_cvt_pk_bf16_f32 v88, v34, v35
  v_pk_add_f32 v[70:71], v[70:71], v[110:111]
  v_lshlrev_b32 v36, 16, v89
  v_and_b32 v37, s47, v89
  v_pk_mul_f32 v[40:41], v[70:71], v[20:21]
  v_lshlrev_b32 v38, 16, v99
  v_and_b32 v39, s47, v99
  v_exp_f32 v40, v40
  v_exp_f32 v41, v41
  v_pk_add_f32 v[42:43], v[36:37], v[16:17] op_sel_hi:[1,0]
  v_pk_add_f32 v[40:41], v[40:41], s[48:49]
  v_pk_mul_f32 v[42:43], v[42:43], v[18:19] op_sel_hi:[1,0]
  v_rcp_f32 v40, v40
  v_rcp_f32 v41, v41
  v_pk_mul_f32 v[42:43], v[42:43], v[38:39]
  v_pk_mul_f32 v[40:41], v[40:41], v[70:71]
  v_pk_fma_f32 v[42:43], v[42:43], v[40:41], v[36:37]
  v_cvt_pk_bf16_f32 v89, v42, v43
  ds_write_b64 v13, v[88:89] offset:0
  v_pk_add_f32 v[72:73], v[72:73], v[112:113]
  v_lshlrev_b32 v28, 16, v90
  v_and_b32 v29, s47, v90
  v_pk_mul_f32 v[32:33], v[72:73], v[20:21]
  v_lshlrev_b32 v30, 16, v100
  v_and_b32 v31, s47, v100
  v_exp_f32 v32, v32
  v_exp_f32 v33, v33
  v_pk_add_f32 v[34:35], v[28:29], v[16:17] op_sel_hi:[1,0]
  v_pk_add_f32 v[32:33], v[32:33], s[48:49]
  v_pk_mul_f32 v[34:35], v[34:35], v[18:19] op_sel_hi:[1,0]
  v_rcp_f32 v32, v32
  v_rcp_f32 v33, v33
  v_pk_mul_f32 v[34:35], v[34:35], v[30:31]
  v_pk_mul_f32 v[32:33], v[32:33], v[72:73]
  v_pk_fma_f32 v[34:35], v[34:35], v[32:33], v[28:29]
  v_cvt_pk_bf16_f32 v90, v34, v35
  v_pk_add_f32 v[74:75], v[74:75], v[114:115]
  v_lshlrev_b32 v36, 16, v91
  v_and_b32 v37, s47, v91
  v_pk_mul_f32 v[40:41], v[74:75], v[20:21]
  v_lshlrev_b32 v38, 16, v101
  v_and_b32 v39, s47, v101
  v_exp_f32 v40, v40
  v_exp_f32 v41, v41
  v_pk_add_f32 v[42:43], v[36:37], v[16:17] op_sel_hi:[1,0]
  v_pk_add_f32 v[40:41], v[40:41], s[48:49]
  v_pk_mul_f32 v[42:43], v[42:43], v[18:19] op_sel_hi:[1,0]
  v_rcp_f32 v40, v40
  v_rcp_f32 v41, v41
  v_pk_mul_f32 v[42:43], v[42:43], v[38:39]
  v_pk_mul_f32 v[40:41], v[40:41], v[74:75]
  v_pk_fma_f32 v[42:43], v[42:43], v[40:41], v[36:37]
  v_cvt_pk_bf16_f32 v91, v42, v43
  ds_write_b64 v13, v[90:91] offset:32
  v_pk_add_f32 v[76:77], v[76:77], v[116:117]
  v_lshlrev_b32 v28, 16, v92
  v_and_b32 v29, s47, v92
  v_pk_mul_f32 v[32:33], v[76:77], v[20:21]
  v_lshlrev_b32 v30, 16, v102
  v_and_b32 v31, s47, v102
  v_exp_f32 v32, v32
  v_exp_f32 v33, v33
  v_pk_add_f32 v[34:35], v[28:29], v[16:17] op_sel_hi:[1,0]
  v_pk_add_f32 v[32:33], v[32:33], s[48:49]
  v_pk_mul_f32 v[34:35], v[34:35], v[18:19] op_sel_hi:[1,0]
  v_rcp_f32 v32, v32
  v_rcp_f32 v33, v33
  v_pk_mul_f32 v[34:35], v[34:35], v[30:31]
  v_pk_mul_f32 v[32:33], v[32:33], v[76:77]
  v_pk_fma_f32 v[34:35], v[34:35], v[32:33], v[28:29]
  v_cvt_pk_bf16_f32 v92, v34, v35
  v_pk_add_f32 v[78:79], v[78:79], v[118:119]
  v_lshlrev_b32 v36, 16, v93
  v_and_b32 v37, s47, v93
  v_pk_mul_f32 v[40:41], v[78:79], v[20:21]
  v_lshlrev_b32 v38, 16, v103
  v_and_b32 v39, s47, v103
  v_exp_f32 v40, v40
  v_exp_f32 v41, v41
  v_pk_add_f32 v[42:43], v[36:37], v[16:17] op_sel_hi:[1,0]
  v_pk_add_f32 v[40:41], v[40:41], s[48:49]
  v_pk_mul_f32 v[42:43], v[42:43], v[18:19] op_sel_hi:[1,0]
  v_rcp_f32 v40, v40
  v_rcp_f32 v41, v41
  v_pk_mul_f32 v[42:43], v[42:43], v[38:39]
  v_pk_mul_f32 v[40:41], v[40:41], v[78:79]
  v_pk_fma_f32 v[42:43], v[42:43], v[40:41], v[36:37]
  v_cvt_pk_bf16_f32 v93, v42, v43
  ds_write_b64 v13, v[92:93] offset:64
  s_waitcnt lgkmcnt(0)
  s_barrier
  s_add_u32 s40, s37, 122880
  v_add_u32 v13, s40, v4
  ds_read_b128 v[108:111], v13 offset:0
  ds_read_b128 v[112:115], v13 offset:1024
  s_waitcnt lgkmcnt(0)
  buffer_store_dwordx4 v[108:111], v5, s[12:15], 0 offen
  buffer_store_dwordx4 v[112:115], v6, s[12:15], 0 offen
  s_mov_b64 exec, s[52:53]
  s_endpgm
K1_B:
  s_cmp_eq_u32 s34, 4
  s_cbranch_scc0 K1_NORST
  s_lshl_b32 s40, s32, 3
  s_add_u32 s40, s40, s33
  s_lshl_b32 s40, s40, 9
  s_add_u32 s40, s40, 16842752
  v_lshlrev_b32 v15, 3, v1
  v_mov_b32 v20, 0
  v_mov_b32 v21, 0xbf800000
  buffer_store_dwordx2 v[20:21], v15, s[16:19], s40 offen sc1
  s_lshl_b32 s40, s33, 7
  s_lshl_b32 s41, s32, 2
  s_add_u32 s40, s40, s41
  s_add_u32 s41, s40, 17040384
  s_add_u32 s40, s40, 17039360
  v_mov_b32 v15, s40
  v_mov_b32 v16, s41
  v_cmp_eq_u32 vcc, 1, v1
  s_nop 1
  v_cndmask_b32 v15, v15, v16, vcc
  s_lshl_b32 s40, s32, 5
  s_lshl_b32 s41, s33, 2
  s_add_u32 s40, s40, s41
  s_add_u32 s40, s40, 17041408
  v_mov_b32 v16, s40
  v_cmp_eq_u32 vcc, 2, v1
  s_nop 1
  v_cndmask_b32 v15, v15, v16, vcc
  s_lshl_b32 s40, s33, 7
  s_lshl_b32 s41, s32, 2
  s_add_u32 s40, s40, s41
  s_add_u32 s40, s40, 17042432
  v_mov_b32 v16, s40
  v_cmp_eq_u32 vcc, 3, v1
  s_nop 1
  v_cndmask_b32 v15, v15, v16, vcc
  s_mov_b32 exec_lo, 0xf
  s_mov_b32 exec_hi, 0x0
  buffer_store_dword v20, v15, s[16:19], 0 offen sc1
  s_mov_b64 exec, s[52:53]
K1_NORST:
  s_lshl_b32 s40, s2, 2
  s_add_u32 s40, s40, s55
  s_mul_i32 s41, s40, 2731
  s_lshr_b32 s41, s41, 16
  s_mul_i32 s42, s41, 24
  s_sub_u32 s42, s40, s42
  s_mov_b32 s72, s40
  v_mul_u32_u24 v17, 5120, v2
  v_lshlrev_b32 v18, 1, v3
  v_add_u32 v17, v17, v18
  s_lshl_b32 s41, s41, 5
  s_mul_i32 s42, s42, 40960
  s_add_u32 s41, s41, s42
  s_add_u32 s42, s41, 20480
  s_barrier
  s_mov_b32 s28, s66
  s_and_b32 s29, s67, 0xffff
  s_mov_b32 s30, 983040
  s_mov_b32 s31, 0x20000
  buffer_load_ushort v152, v17, s[28:31], s41 offen offset:0
  buffer_load_ushort v153, v17, s[28:31], s41 offen offset:1280
  buffer_load_ushort v154, v17, s[28:31], s41 offen offset:2560
  buffer_load_ushort v155, v17, s[28:31], s41 offen offset:3840
  buffer_load_ushort v156, v17, s[28:31], s42 offen offset:0
  buffer_load_ushort v157, v17, s[28:31], s42 offen offset:1280
  buffer_load_ushort v158, v17, s[28:31], s42 offen offset:2560
  buffer_load_ushort v159, v17, s[28:31], s42 offen offset:3840
  s_barrier
  s_barrier
  s_cmp_eq_u32 s34, 4
  s_cbranch_scc0 K1_NOCNT
  s_waitcnt vmcnt(8)
  s_lshl_b32 s39, s32, 2
  v_mov_b32 v20, s39
  v_mov_b32 v21, 1
  s_mov_b32 exec_lo, 0x1
  s_mov_b32 exec_hi, 0x0
  buffer_atomic_add v21, v20, s[4:7], 0 offen offset:0 sc1
  s_mov_b64 exec, s[52:53]
K1_NOCNT:
  s_barrier
  s_barrier
  s_barrier
  s_barrier
  s_barrier
  s_barrier
  v_lshlrev_b32 v144, 6, v1
  s_and_b32 s54, s2, 7
  s_lshl_b32 s54, s54, 8
  s_lshr_b32 s39, s2, 3
  s_lshl_b32 s39, s39, 3
  s_add_u32 s54, s54, s39
  s_lshl_b32 s54, s54, 12
  s_mov_b32 s20, s74
  s_and_b32 s21, s75, 0xffff
  s_mov_b32 s22, 8388608
  s_mov_b32 s23, 0x20000
  s_mov_b32 s46, 0
  s_cmp_ge_u32 s72, 960
  s_cbranch_scc1 K1_NOWOF
  s_waitcnt vmcnt(0)
  v_lshl_or_b32 v164, v153, 16, v152
  v_lshl_or_b32 v165, v155, 16, v154
  v_lshl_or_b32 v166, v157, 16, v156
  v_lshl_or_b32 v167, v159, 16, v158
  v_lshlrev_b32 v17, 4, v1
  s_lshl_b32 s40, s72, 10
  s_add_u32 s40, s40, 15728640
  buffer_store_dwordx4 v[164:167], v17, s[16:19], s40 offen sc1
K1_NOWOF:
  s_barrier
  v_mov_b32 v102, 0x3f803f80
  v_mov_b32 v103, 0x3f803f80
  v_mov_b32 v104, 0x3f803f80
  v_mov_b32 v105, 0x3f803f80
  v_mov_b32 v66, 0
  v_mov_b32 v67, 0
  v_mov_b32 v68, 0
  v_mov_b32 v69, 0
  v_mov_b32 v70, 0
  v_mov_b32 v71, 0
  v_mov_b32 v72, 0
  v_mov_b32 v73, 0
  v_mov_b32 v74, 0
  v_mov_b32 v75, 0
  v_mov_b32 v76, 0
  v_mov_b32 v77, 0
  v_mov_b32 v78, 0
  v_mov_b32 v79, 0
  v_mov_b32 v80, 0
  v_mov_b32 v81, 0
  v_mov_b32 v82, 0
  v_mov_b32 v83, 0
  v_mov_b32 v84, 0
  v_mov_b32 v85, 0
  v_mov_b32 v86, 0
  v_mov_b32 v87, 0
  v_mov_b32 v88, 0
  v_mov_b32 v89, 0
  v_mov_b32 v90, 0
  v_mov_b32 v91, 0
  v_mov_b32 v92, 0
  v_mov_b32 v93, 0
  v_mov_b32 v94, 0
  v_mov_b32 v95, 0
  v_mov_b32 v96, 0
  v_mov_b32 v97, 0
  v_mov_b32 v98, 0
  v_mov_b32 v99, 0
  v_mov_b32 v100, 0
  v_mov_b32 v101, 0
  v_mov_b32 v106, 0
  v_mov_b32 v107, 0
  v_mov_b32 v108, 0
  v_mov_b32 v109, 0
  v_mov_b32 v110, 0
  v_mov_b32 v111, 0
  v_mov_b32 v112, 0
  v_mov_b32 v113, 0
  s_barrier
  s_mov_b32 s37, 0
  ds_read_b128 v[26:29], v4 offset:0
  ds_read_b64_tr_b16 v[42:43], v8 offset:0
  ds_read_b64_tr_b16 v[44:45], v8 offset:768
  ds_read_b128 v[30:33], v6 offset:0
  ds_read_b64_tr_b16 v[46:47], v9 offset:0
  ds_read_b64_tr_b16 v[48:49], v9 offset:768
  ds_read_b64_tr_b16 v[50:51], v10 offset:0
  ds_read_b64_tr_b16 v[52:53], v10 offset:768
K1_LOOP2:
  s_waitcnt lgkmcnt(0)
  v_mfma_f32_16x16x32_bf16 v[66:69], v[42:45], v[26:29], v[66:69]
  ds_read_b128 v[34:37], v5 offset:0
  ds_read_b64_tr_b16 v[54:55], v8 offset:6144
  v_mfma_f32_16x16x32_bf16 v[78:81], v[42:45], v[30:33], v[78:81]
  ds_read_b64_tr_b16 v[56:57], v8 offset:6912
  ds_read_b128 v[38:41], v7 offset:0
  v_mfma_f32_16x16x32_bf16 v[70:73], v[46:49], v[26:29], v[70:73]
  ds_read_b64_tr_b16 v[58:59], v9 offset:6144
  ds_read_b64_tr_b16 v[60:61], v9 offset:6912
  v_mfma_f32_16x16x32_bf16 v[82:85], v[46:49], v[30:33], v[82:85]
  ds_read_b64_tr_b16 v[62:63], v10 offset:6144
  ds_read_b64_tr_b16 v[64:65], v10 offset:6912
  v_mfma_f32_16x16x32_bf16 v[74:77], v[50:53], v[26:29], v[74:77]
  v_mfma_f32_16x16x32_bf16 v[86:89], v[50:53], v[30:33], v[86:89]
  s_cmp_eq_u32 s35, 0
  s_cbranch_scc0 K1_SK_2a0
  v_mfma_f32_16x16x32_bf16 v[90:93], v[42:45], v[102:105], v[90:93]
  v_mfma_f32_16x16x32_bf16 v[94:97], v[46:49], v[102:105], v[94:97]
  v_mfma_f32_16x16x32_bf16 v[98:101], v[50:53], v[102:105], v[98:101]
K1_SK_2a0:
  s_waitcnt lgkmcnt(0)
  s_barrier
  v_mfma_f32_16x16x32_bf16 v[66:69], v[54:57], v[34:37], v[66:69]
  ds_read_b128 v[26:29], v4 offset:8192
  ds_read_b64_tr_b16 v[42:43], v8 offset:12288
  v_mfma_f32_16x16x32_bf16 v[78:81], v[54:57], v[38:41], v[78:81]
  ds_read_b64_tr_b16 v[44:45], v8 offset:13056
  ds_read_b128 v[30:33], v6 offset:8192
  v_mfma_f32_16x16x32_bf16 v[70:73], v[58:61], v[34:37], v[70:73]
  ds_read_b64_tr_b16 v[46:47], v9 offset:12288
  ds_read_b64_tr_b16 v[48:49], v9 offset:13056
  v_mfma_f32_16x16x32_bf16 v[82:85], v[58:61], v[38:41], v[82:85]
  ds_read_b64_tr_b16 v[50:51], v10 offset:12288
  ds_read_b64_tr_b16 v[52:53], v10 offset:13056
  v_mfma_f32_16x16x32_bf16 v[74:77], v[62:65], v[34:37], v[74:77]
  v_mfma_f32_16x16x32_bf16 v[86:89], v[62:65], v[38:41], v[86:89]
  s_cmp_eq_u32 s35, 1
  s_cbranch_scc0 K1_SK_2b0
  v_mfma_f32_16x16x32_bf16 v[90:93], v[54:57], v[102:105], v[90:93]
  v_mfma_f32_16x16x32_bf16 v[94:97], v[58:61], v[102:105], v[94:97]
  v_mfma_f32_16x16x32_bf16 v[98:101], v[62:65], v[102:105], v[98:101]
K1_SK_2b0:
  s_and_b32 s40, s46, 3
  s_cmp_eq_u32 s40, s55
  s_cbranch_scc0 K1_NT0
  s_cmp_lt_u32 s46, 8
  s_cbranch_scc0 K1_NT0
  buffer_load_dword v148, v144, s[20:23], s54 offen
K1_NT0:
  s_add_u32 s46, s46, 1
  s_add_u32 s54, s54, 4096
  s_waitcnt lgkmcnt(0)
  v_mfma_f32_16x16x32_bf16 v[66:69], v[42:45], v[26:29], v[66:69]
  ds_read_b128 v[34:37], v5 offset:8192
  ds_read_b64_tr_b16 v[54:55], v8 offset:18432
  v_mfma_f32_16x16x32_bf16 v[78:81], v[42:45], v[30:33], v[78:81]
  ds_read_b64_tr_b16 v[56:57], v8 offset:19200
  ds_read_b128 v[38:41], v7 offset:8192
  v_mfma_f32_16x16x32_bf16 v[70:73], v[46:49], v[26:29], v[70:73]
  ds_read_b64_tr_b16 v[58:59], v9 offset:18432
  ds_read_b64_tr_b16 v[60:61], v9 offset:19200
  v_mfma_f32_16x16x32_bf16 v[82:85], v[46:49], v[30:33], v[82:85]
  ds_read_b64_tr_b16 v[62:63], v10 offset:18432
  ds_read_b64_tr_b16 v[64:65], v10 offset:19200
  v_mfma_f32_16x16x32_bf16 v[74:77], v[50:53], v[26:29], v[74:77]
  v_mfma_f32_16x16x32_bf16 v[86:89], v[50:53], v[30:33], v[86:89]
  s_cmp_eq_u32 s35, 0
  s_cbranch_scc0 K1_SK_2a1
  v_mfma_f32_16x16x32_bf16 v[90:93], v[42:45], v[102:105], v[90:93]
  v_mfma_f32_16x16x32_bf16 v[94:97], v[46:49], v[102:105], v[94:97]
  v_mfma_f32_16x16x32_bf16 v[98:101], v[50:53], v[102:105], v[98:101]
K1_SK_2a1:
  s_waitcnt lgkmcnt(0)
  s_barrier
  v_mfma_f32_16x16x32_bf16 v[66:69], v[54:57], v[34:37], v[66:69]
  ds_read_b128 v[26:29], v4 offset:16384
  ds_read_b64_tr_b16 v[42:43], v8 offset:24576
  v_mfma_f32_16x16x32_bf16 v[78:81], v[54:57], v[38:41], v[78:81]
  ds_read_b64_tr_b16 v[44:45], v8 offset:25344
  ds_read_b128 v[30:33], v6 offset:16384
  v_mfma_f32_16x16x32_bf16 v[70:73], v[58:61], v[34:37], v[70:73]
  ds_read_b64_tr_b16 v[46:47], v9 offset:24576
  ds_read_b64_tr_b16 v[48:49], v9 offset:25344
  v_mfma_f32_16x16x32_bf16 v[82:85], v[58:61], v[38:41], v[82:85]
  ds_read_b64_tr_b16 v[50:51], v10 offset:24576
  ds_read_b64_tr_b16 v[52:53], v10 offset:25344
  v_mfma_f32_16x16x32_bf16 v[74:77], v[62:65], v[34:37], v[74:77]
  v_mfma_f32_16x16x32_bf16 v[86:89], v[62:65], v[38:41], v[86:89]
  s_cmp_eq_u32 s35, 1
  s_cbranch_scc0 K1_SK_2b1
  v_mfma_f32_16x16x32_bf16 v[90:93], v[54:57], v[102:105], v[90:93]
  v_mfma_f32_16x16x32_bf16 v[94:97], v[58:61], v[102:105], v[94:97]
  v_mfma_f32_16x16x32_bf16 v[98:101], v[62:65], v[102:105], v[98:101]
K1_SK_2b1:
  s_and_b32 s40, s46, 3
  s_cmp_eq_u32 s40, s55
  s_cbranch_scc0 K1_NT1
  s_cmp_lt_u32 s46, 8
  s_cbranch_scc0 K1_NT1
  buffer_load_dword v148, v144, s[20:23], s54 offen
K1_NT1:
  s_add_u32 s46, s46, 1
  s_add_u32 s54, s54, 4096
  s_waitcnt lgkmcnt(0)
  v_mfma_f32_16x16x32_bf16 v[66:69], v[42:45], v[26:29], v[66:69]
  ds_read_b128 v[34:37], v5 offset:16384
  ds_read_b64_tr_b16 v[54:55], v8 offset:30720
  v_mfma_f32_16x16x32_bf16 v[78:81], v[42:45], v[30:33], v[78:81]
  ds_read_b64_tr_b16 v[56:57], v8 offset:31488
  ds_read_b128 v[38:41], v7 offset:16384
  v_mfma_f32_16x16x32_bf16 v[70:73], v[46:49], v[26:29], v[70:73]
  ds_read_b64_tr_b16 v[58:59], v9 offset:30720
  ds_read_b64_tr_b16 v[60:61], v9 offset:31488
  v_mfma_f32_16x16x32_bf16 v[82:85], v[46:49], v[30:33], v[82:85]
  ds_read_b64_tr_b16 v[62:63], v10 offset:30720
  ds_read_b64_tr_b16 v[64:65], v10 offset:31488
  v_mfma_f32_16x16x32_bf16 v[74:77], v[50:53], v[26:29], v[74:77]
  v_mfma_f32_16x16x32_bf16 v[86:89], v[50:53], v[30:33], v[86:89]
  s_cmp_eq_u32 s35, 0
  s_cbranch_scc0 K1_SK_2a2
  v_mfma_f32_16x16x32_bf16 v[90:93], v[42:45], v[102:105], v[90:93]
  v_mfma_f32_16x16x32_bf16 v[94:97], v[46:49], v[102:105], v[94:97]
  v_mfma_f32_16x16x32_bf16 v[98:101], v[50:53], v[102:105], v[98:101]
K1_SK_2a2:
  s_waitcnt lgkmcnt(0)
  s_barrier
  v_mfma_f32_16x16x32_bf16 v[66:69], v[54:57], v[34:37], v[66:69]
  ds_read_b128 v[26:29], v4 offset:24576
  ds_read_b64_tr_b16 v[42:43], v8 offset:36864
  v_mfma_f32_16x16x32_bf16 v[78:81], v[54:57], v[38:41], v[78:81]
  ds_read_b64_tr_b16 v[44:45], v8 offset:37632
  ds_read_b128 v[30:33], v6 offset:24576
  v_mfma_f32_16x16x32_bf16 v[70:73], v[58:61], v[34:37], v[70:73]
  ds_read_b64_tr_b16 v[46:47], v9 offset:36864
  ds_read_b64_tr_b16 v[48:49], v9 offset:37632
  v_mfma_f32_16x16x32_bf16 v[82:85], v[58:61], v[38:41], v[82:85]
  ds_read_b64_tr_b16 v[50:51], v10 offset:36864
  ds_read_b64_tr_b16 v[52:53], v10 offset:37632
  v_mfma_f32_16x16x32_bf16 v[74:77], v[62:65], v[34:37], v[74:77]
  v_mfma_f32_16x16x32_bf16 v[86:89], v[62:65], v[38:41], v[86:89]
  s_cmp_eq_u32 s35, 1
  s_cbranch_scc0 K1_SK_2b2
  v_mfma_f32_16x16x32_bf16 v[90:93], v[54:57], v[102:105], v[90:93]
  v_mfma_f32_16x16x32_bf16 v[94:97], v[58:61], v[102:105], v[94:97]
  v_mfma_f32_16x16x32_bf16 v[98:101], v[62:65], v[102:105], v[98:101]
K1_SK_2b2:
  s_and_b32 s40, s46, 3
  s_cmp_eq_u32 s40, s55
  s_cbranch_scc0 K1_NT2
  s_cmp_lt_u32 s46, 8
  s_cbranch_scc0 K1_NT2
  buffer_load_dword v148, v144, s[20:23], s54 offen
K1_NT2:
  s_add_u32 s46, s46, 1
  s_add_u32 s54, s54, 4096
  s_waitcnt lgkmcnt(0)
  v_mfma_f32_16x16x32_bf16 v[66:69], v[42:45], v[26:29], v[66:69]
  ds_read_b128 v[34:37], v5 offset:24576
  ds_read_b64_tr_b16 v[54:55], v8 offset:43008
  v_mfma_f32_16x16x32_bf16 v[78:81], v[42:45], v[30:33], v[78:81]
  ds_read_b64_tr_b16 v[56:57], v8 offset:43776
  ds_read_b128 v[38:41], v7 offset:24576
  v_mfma_f32_16x16x32_bf16 v[70:73], v[46:49], v[26:29], v[70:73]
  ds_read_b64_tr_b16 v[58:59], v9 offset:43008
  ds_read_b64_tr_b16 v[60:61], v9 offset:43776
  v_mfma_f32_16x16x32_bf16 v[82:85], v[46:49], v[30:33], v[82:85]
  ds_read_b64_tr_b16 v[62:63], v10 offset:43008
  ds_read_b64_tr_b16 v[64:65], v10 offset:43776
  v_mfma_f32_16x16x32_bf16 v[74:77], v[50:53], v[26:29], v[74:77]
  v_mfma_f32_16x16x32_bf16 v[86:89], v[50:53], v[30:33], v[86:89]
  s_cmp_eq_u32 s35, 0
  s_cbranch_scc0 K1_SK_2a3
  v_mfma_f32_16x16x32_bf16 v[90:93], v[42:45], v[102:105], v[90:93]
  v_mfma_f32_16x16x32_bf16 v[94:97], v[46:49], v[102:105], v[94:97]
  v_mfma_f32_16x16x32_bf16 v[98:101], v[50:53], v[102:105], v[98:101]
K1_SK_2a3:
  s_waitcnt lgkmcnt(0)
  s_barrier
  v_mfma_f32_16x16x32_bf16 v[66:69], v[54:57], v[34:37], v[66:69]
  ds_read_b128 v[26:29], v4 offset:32768
  ds_read_b64_tr_b16 v[42:43], v8 offset:49152
  v_mfma_f32_16x16x32_bf16 v[78:81], v[54:57], v[38:41], v[78:81]
  ds_read_b64_tr_b16 v[44:45], v8 offset:49920
  ds_read_b128 v[30:33], v6 offset:32768
  v_mfma_f32_16x16x32_bf16 v[70:73], v[58:61], v[34:37], v[70:73]
  ds_read_b64_tr_b16 v[46:47], v9 offset:49152
  ds_read_b64_tr_b16 v[48:49], v9 offset:49920
  v_mfma_f32_16x16x32_bf16 v[82:85], v[58:61], v[38:41], v[82:85]
  ds_read_b64_tr_b16 v[50:51], v10 offset:49152
  ds_read_b64_tr_b16 v[52:53], v10 offset:49920
  v_mfma_f32_16x16x32_bf16 v[74:77], v[62:65], v[34:37], v[74:77]
  v_mfma_f32_16x16x32_bf16 v[86:89], v[62:65], v[38:41], v[86:89]
  s_cmp_eq_u32 s35, 1
  s_cbranch_scc0 K1_SK_2b3
  v_mfma_f32_16x16x32_bf16 v[90:93], v[54:57], v[102:105], v[90:93]
  v_mfma_f32_16x16x32_bf16 v[94:97], v[58:61], v[102:105], v[94:97]
  v_mfma_f32_16x16x32_bf16 v[98:101], v[62:65], v[102:105], v[98:101]
K1_SK_2b3:
  s_and_b32 s40, s46, 3
  s_cmp_eq_u32 s40, s55
  s_cbranch_scc0 K1_NT3
  s_cmp_lt_u32 s46, 8
  s_cbranch_scc0 K1_NT3
  buffer_load_dword v148, v144, s[20:23], s54 offen
K1_NT3:
  s_add_u32 s46, s46, 1
  s_add_u32 s54, s54, 4096
  s_waitcnt lgkmcnt(0)
  v_mfma_f32_16x16x32_bf16 v[66:69], v[42:45], v[26:29], v[66:69]
  ds_read_b128 v[34:37], v5 offset:32768
  ds_read_b64_tr_b16 v[54:55], v8 offset:55296
  v_mfma_f32_16x16x32_bf16 v[78:81], v[42:45], v[30:33], v[78:81]
  ds_read_b64_tr_b16 v[56:57], v8 offset:56064
  ds_read_b128 v[38:41], v7 offset:32768
  v_mfma_f32_16x16x32_bf16 v[70:73], v[46:49], v[26:29], v[70:73]
  ds_read_b64_tr_b16 v[58:59], v9 offset:55296
  ds_read_b64_tr_b16 v[60:61], v9 offset:56064
  v_mfma_f32_16x16x32_bf16 v[82:85], v[46:49], v[30:33], v[82:85]
  ds_read_b64_tr_b16 v[62:63], v10 offset:55296
  ds_read_b64_tr_b16 v[64:65], v10 offset:56064
  v_mfma_f32_16x16x32_bf16 v[74:77], v[50:53], v[26:29], v[74:77]
  v_mfma_f32_16x16x32_bf16 v[86:89], v[50:53], v[30:33], v[86:89]
  s_cmp_eq_u32 s35, 0
  s_cbranch_scc0 K1_SK_2a4
  v_mfma_f32_16x16x32_bf16 v[90:93], v[42:45], v[102:105], v[90:93]
  v_mfma_f32_16x16x32_bf16 v[94:97], v[46:49], v[102:105], v[94:97]
  v_mfma_f32_16x16x32_bf16 v[98:101], v[50:53], v[102:105], v[98:101]
K1_SK_2a4:
  s_waitcnt lgkmcnt(0)
  s_barrier
  v_add_u32 v4, 40960, v4
  v_add_u32 v5, 40960, v5
  v_add_u32 v6, 40960, v6
  v_add_u32 v7, 40960, v7
  v_mfma_f32_16x16x32_bf16 v[66:69], v[54:57], v[34:37], v[66:69]
  ds_read_b128 v[26:29], v4 offset:0
  ds_read_b64_tr_b16 v[42:43], v8 offset:0
  v_mfma_f32_16x16x32_bf16 v[78:81], v[54:57], v[38:41], v[78:81]
  ds_read_b64_tr_b16 v[44:45], v8 offset:768
  ds_read_b128 v[30:33], v6 offset:0
  v_mfma_f32_16x16x32_bf16 v[70:73], v[58:61], v[34:37], v[70:73]
  ds_read_b64_tr_b16 v[46:47], v9 offset:0
  ds_read_b64_tr_b16 v[48:49], v9 offset:768
  v_mfma_f32_16x16x32_bf16 v[82:85], v[58:61], v[38:41], v[82:85]
  ds_read_b64_tr_b16 v[50:51], v10 offset:0
  ds_read_b64_tr_b16 v[52:53], v10 offset:768
  v_mfma_f32_16x16x32_bf16 v[74:77], v[62:65], v[34:37], v[74:77]
  v_mfma_f32_16x16x32_bf16 v[86:89], v[62:65], v[38:41], v[86:89]
  s_cmp_eq_u32 s35, 1
  s_cbranch_scc0 K1_SK_2b4
  v_mfma_f32_16x16x32_bf16 v[90:93], v[54:57], v[102:105], v[90:93]
  v_mfma_f32_16x16x32_bf16 v[94:97], v[58:61], v[102:105], v[94:97]
  v_mfma_f32_16x16x32_bf16 v[98:101], v[62:65], v[102:105], v[98:101]
K1_SK_2b4:
  s_and_b32 s40, s46, 3
  s_cmp_eq_u32 s40, s55
  s_cbranch_scc0 K1_NT4
  s_cmp_lt_u32 s46, 8
  s_cbranch_scc0 K1_NT4
  buffer_load_dword v148, v144, s[20:23], s54 offen
K1_NT4:
  s_add_u32 s46, s46, 1
  s_add_u32 s54, s54, 4096
  s_add_u32 s37, s37, 1
  s_cmp_lt_u32 s37, 2
  s_cbranch_scc1 K1_LOOP2
  s_mul_i32 s40, s55, 192
  s_add_u32 s40, s40, 144640
  v_lshlrev_b32 v18, 4, v2
  v_add_u32 v19, s40, v18
  s_mov_b32 exec_lo, 0x10001
  s_mov_b32 exec_hi, 0x10001
  ds_write_b128 v19, v[90:93] offset:0
  ds_write_b128 v19, v[94:97] offset:64
  ds_write_b128 v19, v[98:101] offset:128
  s_mov_b64 exec, s[52:53]
  v_mov_b32 v126, 0xc0135761
  v_mov_b32 v127, 0xc0135761
  s_waitcnt lgkmcnt(0)
  s_barrier
  s_load_dwordx4 s[64:67], s[0:1], 32
  s_sub_u32 s42, s34, 4
  s_mul_i32 s44, s33, 80
  s_mul_i32 s40, s32, 3
  s_lshl_b32 s41, s32, 1
  s_add_u32 s41, s41, 16
  s_cmp_lt_u32 s32, 16
  s_cselect_b32 s40, s40, s41
  s_cselect_b32 s41, 3, 2
  s_add_u32 s44, s44, s40
  s_add_u32 s44, s44, s42
  s_cmp_lt_u32 s42, s41
  s_cselect_b32 s45, 1, 0
  s_cmp_eq_u32 s34, 7
  s_cbranch_scc0 F2_NOCE
  v_lshlrev_b32 v166, 2, v1
  buffer_load_dword v167, v166, s[4:7], 0 offen offset:0 sc1
F2_NOCE:
  s_xor_b32 s41, s55, 2
  s_mul_i32 s41, s41, 192
  s_add_u32 s41, s41, 144640
  v_add_u32 v19, s41, v18
  ds_read_b128 v[26:29], v19 offset:0
  ds_read_b128 v[30:33], v19 offset:64
  ds_read_b128 v[34:37], v19 offset:128
  s_lshl_b32 s40, s35, 7
  s_lshl_b32 s41, s36, 6
  s_add_u32 s40, s40, s41
  s_add_u32 s40, s40, 143360
  v_lshlrev_b32 v20, 2, v3
  v_add_u32 v20, s40, v20
  v_xor_b32 v21, 64, v20
  ds_read_b32 v42, v20
  ds_read_b32 v44, v21
  ds_read_b32 v46, v20 offset:256
  ds_read_b32 v48, v21 offset:256
  s_lshl_b32 s40, s32, 2
  s_lshl_b32 s41, s35, 1
  s_add_u32 s40, s40, s41
  s_add_u32 s41, s40, s36
  s_xor_b32 s42, s41, 1
  s_mul_i32 s39, s33, 6
  s_mul_i32 s38, s36, 3
  s_add_u32 s39, s39, s38
  s_mul_i32 s41, s41, 48
  s_add_u32 s41, s41, s39
  s_lshl_b32 s41, s41, 9
  s_add_u32 s41, s41, 0
  s_mul_i32 s42, s42, 48
  s_add_u32 s42, s42, s39
  s_lshl_b32 s42, s42, 9
  s_add_u32 s42, s42, 0
  v_lshlrev_b32 v20, 3, v1
  s_lshl_b32 s38, s35, 1
  s_add_u32 s38, s38, s36
  s_mul_i32 s39, s38, 3072
  s_mul_i32 s40, s36, 1536
  s_add_u32 s39, s39, s40
  s_add_u32 s39, s39, 147456
  v_add_u32 v22, s39, v20
  s_xor_b32 s38, s38, 1
  s_mul_i32 s39, s38, 3072
  s_add_u32 s39, s39, s40
  s_add_u32 s39, s39, 147456
  v_add_u32 v23, s39, v20
  s_waitcnt lgkmcnt(0)
  v_add_f32 v26, v26, v90
  v_sub_f32 v26, 0, v26
  v_add_f32 v27, v27, v91
  v_sub_f32 v27, 0, v27
  v_add_f32 v28, v28, v92
  v_sub_f32 v28, 0, v28
  v_add_f32 v29, v29, v93
  v_sub_f32 v29, 0, v29
  v_add_f32 v30, v30, v94
  v_sub_f32 v30, 0, v30
  v_add_f32 v31, v31, v95
  v_sub_f32 v31, 0, v31
  v_add_f32 v32, v32, v96
  v_sub_f32 v32, 0, v32
  v_add_f32 v33, v33, v97
  v_sub_f32 v33, 0, v33
  v_add_f32 v34, v34, v98
  v_sub_f32 v34, 0, v34
  v_add_f32 v35, v35, v99
  v_sub_f32 v35, 0, v35
  v_add_f32 v36, v36, v100
  v_sub_f32 v36, 0, v36
  v_add_f32 v37, v37, v101
  v_sub_f32 v37, 0, v37
  v_pk_fma_f32 v[66:67], v[26:27], v[42:43], v[66:67] op_sel_hi:[1,0,1]
  v_pk_mul_f32 v[66:67], v[66:67], v[46:47] op_sel_hi:[1,0]
  v_pk_mul_f32 v[128:129], v[66:67], v[66:67]
  v_pk_fma_f32 v[128:129], v[128:129], s[48:49], v[126:127]
  v_pk_mul_f32 v[128:129], v[128:129], v[66:67]
  v_exp_f32 v128, v128
  v_exp_f32 v129, v129
  s_nop 0
  v_pk_add_f32 v[128:129], v[128:129], s[50:51]
  v_rcp_f32 v128, v128
  v_rcp_f32 v129, v129
  s_nop 0
  v_pk_mul_f32 v[128:129], v[128:129], v[66:67]
  v_cvt_pk_bf16_f32 v114, v128, v129
  v_pk_fma_f32 v[68:69], v[28:29], v[42:43], v[68:69] op_sel_hi:[1,0,1]
  v_pk_mul_f32 v[68:69], v[68:69], v[46:47] op_sel_hi:[1,0]
  v_pk_mul_f32 v[132:133], v[68:69], v[68:69]
  v_pk_fma_f32 v[132:133], v[132:133], s[48:49], v[126:127]
  v_pk_mul_f32 v[132:133], v[132:133], v[68:69]
  v_exp_f32 v132, v132
  v_exp_f32 v133, v133
  s_nop 0
  v_pk_add_f32 v[132:133], v[132:133], s[50:51]
  v_rcp_f32 v132, v132
  v_rcp_f32 v133, v133
  s_nop 0
  v_pk_mul_f32 v[132:133], v[132:133], v[68:69]
  v_cvt_pk_bf16_f32 v115, v132, v133
  ds_write_b64 v22, v[114:115] offset:0
  v_pk_fma_f32 v[70:71], v[30:31], v[42:43], v[70:71] op_sel_hi:[1,0,1]
  v_pk_mul_f32 v[70:71], v[70:71], v[46:47] op_sel_hi:[1,0]
  v_pk_mul_f32 v[128:129], v[70:71], v[70:71]
  v_pk_fma_f32 v[128:129], v[128:129], s[48:49], v[126:127]
  v_pk_mul_f32 v[128:129], v[128:129], v[70:71]
  v_exp_f32 v128, v128
  v_exp_f32 v129, v129
  s_nop 0
  v_pk_add_f32 v[128:129], v[128:129], s[50:51]
  v_rcp_f32 v128, v128
  v_rcp_f32 v129, v129
  s_nop 0
  v_pk_mul_f32 v[128:129], v[128:129], v[70:71]
  v_cvt_pk_bf16_f32 v116, v128, v129
  v_pk_fma_f32 v[72:73], v[32:33], v[42:43], v[72:73] op_sel_hi:[1,0,1]
  v_pk_mul_f32 v[72:73], v[72:73], v[46:47] op_sel_hi:[1,0]
  v_pk_mul_f32 v[132:133], v[72:73], v[72:73]
  v_pk_fma_f32 v[132:133], v[132:133], s[48:49], v[126:127]
  v_pk_mul_f32 v[132:133], v[132:133], v[72:73]
  v_exp_f32 v132, v132
  v_exp_f32 v133, v133
  s_nop 0
  v_pk_add_f32 v[132:133], v[132:133], s[50:51]
  v_rcp_f32 v132, v132
  v_rcp_f32 v133, v133
  s_nop 0
  v_pk_mul_f32 v[132:133], v[132:133], v[72:73]
  v_cvt_pk_bf16_f32 v117, v132, v133
  ds_write_b64 v22, v[116:117] offset:512
  v_pk_fma_f32 v[74:75], v[34:35], v[42:43], v[74:75] op_sel_hi:[1,0,1]
  v_pk_mul_f32 v[74:75], v[74:75], v[46:47] op_sel_hi:[1,0]
  v_pk_mul_f32 v[128:129], v[74:75], v[74:75]
  v_pk_fma_f32 v[128:129], v[128:129], s[48:49], v[126:127]
  v_pk_mul_f32 v[128:129], v[128:129], v[74:75]
  v_exp_f32 v128, v128
  v_exp_f32 v129, v129
  s_nop 0
  v_pk_add_f32 v[128:129], v[128:129], s[50:51]
  v_rcp_f32 v128, v128
  v_rcp_f32 v129, v129
  s_nop 0
  v_pk_mul_f32 v[128:129], v[128:129], v[74:75]
  v_cvt_pk_bf16_f32 v118, v128, v129
  v_pk_fma_f32 v[76:77], v[36:37], v[42:43], v[76:77] op_sel_hi:[1,0,1]
  v_pk_mul_f32 v[76:77], v[76:77], v[46:47] op_sel_hi:[1,0]
  v_pk_mul_f32 v[132:133], v[76:77], v[76:77]
  v_pk_fma_f32 v[132:133], v[132:133], s[48:49], v[126:127]
  v_pk_mul_f32 v[132:133], v[132:133], v[76:77]
  v_exp_f32 v132, v132
  v_exp_f32 v133, v133
  s_nop 0
  v_pk_add_f32 v[132:133], v[132:133], s[50:51]
  v_rcp_f32 v132, v132
  v_rcp_f32 v133, v133
  s_nop 0
  v_pk_mul_f32 v[132:133], v[132:133], v[76:77]
  v_cvt_pk_bf16_f32 v119, v132, v133
  ds_write_b64 v22, v[118:119] offset:1024
  v_pk_fma_f32 v[78:79], v[26:27], v[44:45], v[78:79] op_sel_hi:[1,0,1]
  v_pk_mul_f32 v[78:79], v[78:79], v[48:49] op_sel_hi:[1,0]
  v_pk_mul_f32 v[128:129], v[78:79], v[78:79]
  v_pk_fma_f32 v[128:129], v[128:129], s[48:49], v[126:127]
  v_pk_mul_f32 v[128:129], v[128:129], v[78:79]
  v_exp_f32 v128, v128
  v_exp_f32 v129, v129
  s_nop 0
  v_pk_add_f32 v[128:129], v[128:129], s[50:51]
  v_rcp_f32 v128, v128
  v_rcp_f32 v129, v129
  s_nop 0
  v_pk_mul_f32 v[128:129], v[128:129], v[78:79]
  v_cvt_pk_bf16_f32 v120, v128, v129
  v_pk_fma_f32 v[80:81], v[28:29], v[44:45], v[80:81] op_sel_hi:[1,0,1]
  v_pk_mul_f32 v[80:81], v[80:81], v[48:49] op_sel_hi:[1,0]
  v_pk_mul_f32 v[132:133], v[80:81], v[80:81]
  v_pk_fma_f32 v[132:133], v[132:133], s[48:49], v[126:127]
  v_pk_mul_f32 v[132:133], v[132:133], v[80:81]
  v_exp_f32 v132, v132
  v_exp_f32 v133, v133
  s_nop 0
  v_pk_add_f32 v[132:133], v[132:133], s[50:51]
  v_rcp_f32 v132, v132
  v_rcp_f32 v133, v133
  s_nop 0
  v_pk_mul_f32 v[132:133], v[132:133], v[80:81]
  v_cvt_pk_bf16_f32 v121, v132, v133
  ds_write_b64 v23, v[120:121] offset:0
  v_pk_fma_f32 v[82:83], v[30:31], v[44:45], v[82:83] op_sel_hi:[1,0,1]
  v_pk_mul_f32 v[82:83], v[82:83], v[48:49] op_sel_hi:[1,0]
  v_pk_mul_f32 v[128:129], v[82:83], v[82:83]
  v_pk_fma_f32 v[128:129], v[128:129], s[48:49], v[126:127]
  v_pk_mul_f32 v[128:129], v[128:129], v[82:83]
  v_exp_f32 v128, v128
  v_exp_f32 v129, v129
  s_nop 0
  v_pk_add_f32 v[128:129], v[128:129], s[50:51]
  v_rcp_f32 v128, v128
  v_rcp_f32 v129, v129
  s_nop 0
  v_pk_mul_f32 v[128:129], v[128:129], v[82:83]
  v_cvt_pk_bf16_f32 v122, v128, v129
  v_pk_fma_f32 v[84:85], v[32:33], v[44:45], v[84:85] op_sel_hi:[1,0,1]
  v_pk_mul_f32 v[84:85], v[84:85], v[48:49] op_sel_hi:[1,0]
  v_pk_mul_f32 v[132:133], v[84:85], v[84:85]
  v_pk_fma_f32 v[132:133], v[132:133], s[48:49], v[126:127]
  v_pk_mul_f32 v[132:133], v[132:133], v[84:85]
  v_exp_f32 v132, v132
  v_exp_f32 v133, v133
  s_nop 0
  v_pk_add_f32 v[132:133], v[132:133], s[50:51]
  v_rcp_f32 v132, v132
  v_rcp_f32 v133, v133
  s_nop 0
  v_pk_mul_f32 v[132:133], v[132:133], v[84:85]
  v_cvt_pk_bf16_f32 v123, v132, v133
  ds_write_b64 v23, v[122:123] offset:512
  v_pk_fma_f32 v[86:87], v[34:35], v[44:45], v[86:87] op_sel_hi:[1,0,1]
  v_pk_mul_f32 v[86:87], v[86:87], v[48:49] op_sel_hi:[1,0]
  v_pk_mul_f32 v[128:129], v[86:87], v[86:87]
  v_pk_fma_f32 v[128:129], v[128:129], s[48:49], v[126:127]
  v_pk_mul_f32 v[128:129], v[128:129], v[86:87]
  v_exp_f32 v128, v128
  v_exp_f32 v129, v129
  s_nop 0
  v_pk_add_f32 v[128:129], v[128:129], s[50:51]
  v_rcp_f32 v128, v128
  v_rcp_f32 v129, v129
  s_nop 0
  v_pk_mul_f32 v[128:129], v[128:129], v[86:87]
  v_cvt_pk_bf16_f32 v124, v128, v129
  v_pk_fma_f32 v[88:89], v[36:37], v[44:45], v[88:89] op_sel_hi:[1,0,1]
  v_pk_mul_f32 v[88:89], v[88:89], v[48:49] op_sel_hi:[1,0]
  v_pk_mul_f32 v[132:133], v[88:89], v[88:89]
  v_pk_fma_f32 v[132:133], v[132:133], s[48:49], v[126:127]
  v_pk_mul_f32 v[132:133], v[132:133], v[88:89]
  v_exp_f32 v132, v132
  v_exp_f32 v133, v133
  s_nop 0
  v_pk_add_f32 v[132:133], v[132:133], s[50:51]
  v_rcp_f32 v132, v132
  v_rcp_f32 v133, v133
  s_nop 0
  v_pk_mul_f32 v[132:133], v[132:133], v[88:89]
  v_cvt_pk_bf16_f32 v125, v132, v133
  ds_write_b64 v23, v[124:125] offset:1024
  s_cmp_eq_u32 s34, 7
  s_cbranch_scc0 F2_NOCNT
  s_waitcnt vmcnt(0)
  s_mov_b32 exec_lo, 0xffffffff
  s_mov_b32 exec_hi, 0x0
  v_cmp_gt_u32 vcc, 8, v167
  s_mov_b64 exec, s[52:53]
  s_cmp_eq_u64 vcc, 0
  s_cbranch_scc1 F2_NOCNT
  v_lshlrev_b32 v6, 2, v1
  s_mov_b32 s42, 0
  s_mov_b32 exec_lo, 0xffffffff
  s_mov_b32 exec_hi, 0x0
FP_CNT:
  buffer_load_dword v7, v6, s[4:7], 0 offen offset:0 sc1
  s_waitcnt vmcnt(0)
  v_cmp_gt_u32 vcc, 8, v7
  s_add_u32 s42, s42, 1
  s_cmp_eq_u64 vcc, 0
  s_cbranch_scc1 FP_CNT_OK
  s_cmp_lt_u32 s42, 2097152
  s_cbranch_scc0 FP_CNT_OK
  s_sleep 1
  s_branch FP_CNT
FP_CNT_OK:
  s_mov_b64 exec, s[52:53]
F2_NOCNT:
  s_waitcnt lgkmcnt(0)
  s_cmp_eq_u32 s34, 7
  s_cbranch_scc1 F2_SYNC
  s_cmp_eq_u32 s45, 0
  s_cbranch_scc1 F2_IDLE
  s_mov_b32 s35, s44
  s_sub_u32 s42, s34, 4
  s_mul_i32 s36, s42, 21248
  s_add_u32 s36, s36, 65536
  v_add_u32 v10, 1, v3
  v_and_b32 v10, 3, v10
  v_lshrrev_b32 v11, 1, v2
  v_and_b32 v12, 1, v2
  v_lshlrev_b32 v13, 4, v11
  v_add_u32 v13, v13, v3
  v_lshlrev_b32 v14, 3, v12
  v_sub_u32 v13, v13, v14
  v_add_u32 v13, 9, v13
  v_sub_u32 v13, v13, v10
  v_lshlrev_b32 v13, 1, v13
  v_mul_u32_u24 v10, 4160, v10
  v_add_u32 v13, v13, v10
  v_add_u32 v4, s36, v13
  v_sub_u32 v13, v3, v11
  v_lshlrev_b32 v13, 1, v13
  v_add_u32 v13, v13, v12
  v_lshlrev_b32 v13, 4, v13
  s_add_u32 s40, s36, 17152
  v_add_u32 v5, s40, v13
  s_waitcnt vmcnt(0)
  s_barrier
  s_sub_u32 s42, s34, 4
  v_lshrrev_b32 v8, 3, v1
  s_lshl_b32 s40, s42, 3
  v_add_u32 v8, s40, v8
  v_and_b32 v9, 7, v1
  v_lshlrev_b32 v9, 4, v9
  v_mul_u32_u24 v10, 144, v8
  v_add_u32 v10, v10, v9
  v_add_u32 v10, 49152, v10
  v_lshlrev_b32 v8, 12, v8
  v_add_u32 v8, v8, v9
  ds_read_b128 v[16:19], v10 offset:0
  ds_read_b128 v[20:23], v10 offset:3456
  ds_read_b128 v[24:27], v10 offset:6912
  ds_read_b128 v[28:31], v10 offset:10368
  s_mul_i32 s40, s33, 327680
  s_lshl_b32 s41, s32, 7
  s_add_u32 s40, s40, s41
  s_add_u32 s40, s40, 6291456
  s_waitcnt lgkmcnt(0)
  buffer_store_dwordx4 v[16:19], v8, s[16:19], s40 offen sc1
  s_add_u32 s40, s40, 98304
  buffer_store_dwordx4 v[20:23], v8, s[16:19], s40 offen sc1
  s_add_u32 s40, s40, 98304
  buffer_store_dwordx4 v[24:27], v8, s[16:19], s40 offen sc1
  s_add_u32 s40, s40, 98304
  s_cmp_eq_u32 s42, 0
  s_cselect_b32 s40, s40, 0x80000000
  buffer_store_dwordx4 v[28:31], v8, s[16:19], s40 offen sc1
  s_add_u32 s40, s40, 98304
  s_waitcnt lgkmcnt(0)
  s_lshl_b32 s40, s44, 12
  s_add_u32 s20, s64, s40
  s_addc_u32 s21, s65, 0
  s_and_b32 s21, s21, 0xffff
  s_mov_b32 s22, 4096
  s_mov_b32 s23, 0x20000
  s_mov_b32 s24, s66
  s_and_b32 s25, s67, 0xffff
  s_mov_b32 s26, 1280
  s_mov_b32 s27, 0x20000
  v_lshlrev_b32 v167, 4, v1
  buffer_load_dwordx4 v[136:139], v167, s[20:23], 0 offen offset:0
  buffer_load_dwordx2 v[140:141], v167, s[20:23], 0 offen offset:16
  buffer_load_dwordx4 v[142:145], v167, s[20:23], 0 offen offset:1024
  buffer_load_dwordx2 v[146:147], v167, s[20:23], 0 offen offset:1040
  buffer_load_dwordx4 v[148:151], v167, s[20:23], 0 offen offset:2048
  buffer_load_dwordx2 v[152:153], v167, s[20:23], 0 offen offset:2064
  buffer_load_dwordx4 v[154:157], v167, s[20:23], 0 offen offset:3072
  buffer_load_dwordx2 v[158:159], v167, s[20:23], 0 offen offset:3088
  v_mov_b32 v167, 0
  buffer_load_dwordx2 v[164:165], v167, s[20:23], 0 offen
  s_lshl_b32 s40, s44, 1
  buffer_load_ushort v166, v167, s[24:27], s40 offen
  s_barrier
  s_waitcnt vmcnt(0)
  v_mov_b32 v46, v166
  v_mov_b32 v8, 0
  v_mov_b32 v9, 0
  v_lshlrev_b32 v10, 3, v1
  v_add_u32 v10, s36, v10
  ds_write_b64 v10, v[8:9] offset:16640
  v_lshlrev_b32 v10, 4, v1
  v_add_u32 v10, s36, v10
  v_alignbit_b32 v80, v137, v136, 16
  v_alignbit_b32 v81, v138, v137, 16
  v_alignbit_b32 v82, v139, v138, 16
  v_alignbit_b32 v83, v140, v139, 16
  v_mov_b32 v84, v137
  v_mov_b32 v85, v138
  v_mov_b32 v86, v139
  v_mov_b32 v87, v140
  v_mov_b32 v88, v81
  v_mov_b32 v89, v82
  v_mov_b32 v90, v83
  v_alignbit_b32 v91, v141, v140, 16
  ds_write_b128 v10, v[136:139] offset:32
  ds_write_b128 v10, v[80:83] offset:4192
  ds_write_b128 v10, v[84:87] offset:8352
  ds_write_b128 v10, v[88:91] offset:12512
  s_waitcnt lgkmcnt(4)
  v_alignbit_b32 v92, v143, v142, 16
  v_alignbit_b32 v93, v144, v143, 16
  v_alignbit_b32 v94, v145, v144, 16
  v_alignbit_b32 v95, v146, v145, 16
  v_mov_b32 v96, v143
  v_mov_b32 v97, v144
  v_mov_b32 v98, v145
  v_mov_b32 v99, v146
  v_mov_b32 v100, v93
  v_mov_b32 v101, v94
  v_mov_b32 v102, v95
  v_alignbit_b32 v103, v147, v146, 16
  ds_write_b128 v10, v[142:145] offset:1056
  ds_write_b128 v10, v[92:95] offset:5216
  ds_write_b128 v10, v[96:99] offset:9376
  ds_write_b128 v10, v[100:103] offset:13536
  s_waitcnt lgkmcnt(4)
  s_waitcnt vmcnt(0)
  s_barrier
  v_alignbit_b32 v104, v149, v148, 16
  v_alignbit_b32 v105, v150, v149, 16
  v_alignbit_b32 v106, v151, v150, 16
  v_alignbit_b32 v107, v152, v151, 16
  v_mov_b32 v108, v149
  v_mov_b32 v109, v150
  v_mov_b32 v110, v151
  v_mov_b32 v111, v152
  v_mov_b32 v112, v105
  v_mov_b32 v113, v106
  v_mov_b32 v114, v107
  v_alignbit_b32 v115, v153, v152, 16
  ds_write_b128 v10, v[148:151] offset:2080
  ds_write_b128 v10, v[104:107] offset:6240
  ds_write_b128 v10, v[108:111] offset:10400
  ds_write_b128 v10, v[112:115] offset:14560
  s_waitcnt lgkmcnt(4)
  s_barrier
  v_alignbit_b32 v116, v155, v154, 16
  v_alignbit_b32 v117, v156, v155, 16
  v_alignbit_b32 v118, v157, v156, 16
  v_alignbit_b32 v119, v158, v157, 16
  v_mov_b32 v120, v155
  v_mov_b32 v121, v156
  v_mov_b32 v122, v157
  v_mov_b32 v123, v158
  v_mov_b32 v124, v117
  v_mov_b32 v125, v118
  v_mov_b32 v126, v119
  v_alignbit_b32 v127, v159, v158, 16
  ds_write_b128 v10, v[154:157] offset:3104
  ds_write_b128 v10, v[116:119] offset:7264
  ds_write_b128 v10, v[120:123] offset:11424
  ds_write_b128 v10, v[124:127] offset:15584
  s_waitcnt lgkmcnt(4)
  v_mov_b32 v160, 0
  v_mov_b32 v161, 0
  v_mov_b32 v162, 0
  v_mov_b32 v163, 0
  v_cmp_eq_u32 vcc, 1, v1
  s_nop 1
  v_cndmask_b32 v164, 0, v164, vcc
  v_cndmask_b32 v165, 0, v165, vcc
  s_waitcnt lgkmcnt(0)
  s_mov_b32 exec_lo, 0x3
  s_mov_b32 exec_hi, 0x0
  v_alignbit_b32 v80, v161, v160, 16
  v_alignbit_b32 v81, v162, v161, 16
  v_alignbit_b32 v82, v163, v162, 16
  v_alignbit_b32 v83, v164, v163, 16
  v_mov_b32 v84, v161
  v_mov_b32 v85, v162
  v_mov_b32 v86, v163
  v_mov_b32 v87, v164
  v_mov_b32 v88, v81
  v_mov_b32 v89, v82
  v_mov_b32 v90, v83
  v_alignbit_b32 v91, v165, v164, 16
  ds_write_b128 v10, v[160:163] offset:0
  ds_write_b128 v10, v[80:83] offset:4160
  ds_write_b128 v10, v[84:87] offset:8320
  ds_write_b128 v10, v[88:91] offset:12480
  s_mov_b64 exec, s[52:53]
  v_lshlrev_b32 v46, 16, v46
  v_mov_b32 v48, 0
  v_mov_b32 v49, 0
  v_mov_b32 v50, 0
  v_mov_b32 v51, 0
  v_mov_b32 v52, 0
  v_mov_b32 v53, 0
  v_mov_b32 v54, 0
  v_mov_b32 v55, 0
  v_mov_b32 v56, 0
  v_mov_b32 v57, 0
  v_mov_b32 v58, 0
  v_mov_b32 v59, 0
  v_mov_b32 v60, 0
  v_mov_b32 v61, 0
  v_mov_b32 v62, 0
  v_mov_b32 v63, 0
  v_mov_b32 v64, 0
  v_mov_b32 v65, 0
  v_mov_b32 v66, 0
  v_mov_b32 v67, 0
  v_mov_b32 v68, 0
  v_mov_b32 v69, 0
  v_mov_b32 v70, 0
  v_mov_b32 v71, 0
  v_mov_b32 v72, 0
  v_mov_b32 v73, 0
  v_mov_b32 v74, 0
  v_mov_b32 v75, 0
  v_mov_b32 v76, 0
  v_mov_b32 v77, 0
  v_mov_b32 v78, 0
  v_mov_b32 v79, 0
  s_waitcnt vmcnt(0) lgkmcnt(0)
  s_barrier
  s_barrier
  s_barrier
  v_lshlrev_b32 v6, 4, v1
  s_lshl_b32 s40, s35, 12
  s_add_u32 s40, s40, 6291456
  s_add_u32 m0, s36, 17152
  s_add_u32 s41, s40, 0
  buffer_load_dwordx4 v6, s[16:19], s41 offen sc1 lds
  s_add_u32 m0, s36, 18176
  s_add_u32 s41, s40, 1024
  buffer_load_dwordx4 v6, s[16:19], s41 offen sc1 lds
  s_add_u32 m0, s36, 19200
  s_add_u32 s41, s40, 2048
  buffer_load_dwordx4 v6, s[16:19], s41 offen sc1 lds
  s_add_u32 m0, s36, 20224
  s_add_u32 s41, s40, 3072
  buffer_load_dwordx4 v6, s[16:19], s41 offen sc1 lds
  ds_read_b64 v[80:81], v4 offset:0
  ds_read_b64 v[82:83], v4 offset:8
  ds_read_b64 v[84:85], v4 offset:512
  ds_read_b64 v[86:87], v4 offset:520
  ds_read_b64 v[88:89], v4 offset:1024
  ds_read_b64 v[90:91], v4 offset:1032
  ds_read_b64 v[92:93], v4 offset:1536
  ds_read_b64 v[94:95], v4 offset:1544
  s_waitcnt lgkmcnt(6)
  ds_read_b64 v[96:97], v4 offset:2048
  ds_read_b64 v[98:99], v4 offset:2056
  ds_read_b64 v[100:101], v4 offset:2560
  ds_read_b64 v[102:103], v4 offset:2568
  ds_read_b64 v[104:105], v4 offset:3072
  ds_read_b64 v[106:107], v4 offset:3080
  ds_read_b64 v[108:109], v4 offset:3584
  ds_read_b64 v[110:111], v4 offset:3592
  s_waitcnt lgkmcnt(6)
  s_barrier
  s_waitcnt vmcnt(0)
  ds_read_b128 v[112:115], v5 offset:0
  ds_read_b128 v[116:119], v5 offset:512
  ds_read_b128 v[120:123], v5 offset:1024
  ds_read_b128 v[124:127], v5 offset:1536
  ds_read_b128 v[128:131], v5 offset:2048
  ds_read_b128 v[132:135], v5 offset:2560
  ds_read_b128 v[136:139], v5 offset:3072
  ds_read_b128 v[140:143], v5 offset:3584
  s_mov_b32 s37, 0
F2_CLOOP:
  v_add_u32 v4, 64, v4
  v_subrev_u32 v5, 64, v5
  s_waitcnt lgkmcnt(0)
  v_mfma_f32_16x16x32_bf16 v[48:51], v[80:83], v[112:115], v[48:51]
  v_mfma_f32_16x16x32_bf16 v[52:55], v[80:83], v[116:119], v[52:55]
  v_mfma_f32_16x16x32_bf16 v[56:59], v[80:83], v[120:123], v[56:59]
  v_mfma_f32_16x16x32_bf16 v[60:63], v[80:83], v[124:127], v[60:63]
  v_mfma_f32_16x16x32_bf16 v[64:67], v[80:83], v[128:131], v[64:67]
  v_mfma_f32_16x16x32_bf16 v[68:71], v[80:83], v[132:135], v[68:71]
  v_mfma_f32_16x16x32_bf16 v[72:75], v[80:83], v[136:139], v[72:75]
  v_mfma_f32_16x16x32_bf16 v[76:79], v[80:83], v[140:143], v[76:79]
  ds_read_b64 v[80:81], v4 offset:0
  ds_read_b64 v[82:83], v4 offset:8
  ds_read_b128 v[140:143], v5 offset:3584
  v_mfma_f32_16x16x32_bf16 v[52:55], v[84:87], v[112:115], v[52:55]
  v_mfma_f32_16x16x32_bf16 v[56:59], v[84:87], v[116:119], v[56:59]
  v_mfma_f32_16x16x32_bf16 v[60:63], v[84:87], v[120:123], v[60:63]
  v_mfma_f32_16x16x32_bf16 v[64:67], v[84:87], v[124:127], v[64:67]
  v_mfma_f32_16x16x32_bf16 v[68:71], v[84:87], v[128:131], v[68:71]
  v_mfma_f32_16x16x32_bf16 v[72:75], v[84:87], v[132:135], v[72:75]
  v_mfma_f32_16x16x32_bf16 v[76:79], v[84:87], v[136:139], v[76:79]
  ds_read_b64 v[84:85], v4 offset:512
  ds_read_b64 v[86:87], v4 offset:520
  ds_read_b128 v[136:139], v5 offset:3072
  v_mfma_f32_16x16x32_bf16 v[56:59], v[88:91], v[112:115], v[56:59]
  v_mfma_f32_16x16x32_bf16 v[60:63], v[88:91], v[116:119], v[60:63]
  v_mfma_f32_16x16x32_bf16 v[64:67], v[88:91], v[120:123], v[64:67]
  v_mfma_f32_16x16x32_bf16 v[68:71], v[88:91], v[124:127], v[68:71]
  v_mfma_f32_16x16x32_bf16 v[72:75], v[88:91], v[128:131], v[72:75]
  v_mfma_f32_16x16x32_bf16 v[76:79], v[88:91], v[132:135], v[76:79]
  ds_read_b64 v[88:89], v4 offset:1024
  ds_read_b64 v[90:91], v4 offset:1032
  ds_read_b128 v[132:135], v5 offset:2560
  v_mfma_f32_16x16x32_bf16 v[60:63], v[92:95], v[112:115], v[60:63]
  v_mfma_f32_16x16x32_bf16 v[64:67], v[92:95], v[116:119], v[64:67]
  v_mfma_f32_16x16x32_bf16 v[68:71], v[92:95], v[120:123], v[68:71]
  v_mfma_f32_16x16x32_bf16 v[72:75], v[92:95], v[124:127], v[72:75]
  v_mfma_f32_16x16x32_bf16 v[76:79], v[92:95], v[128:131], v[76:79]
  ds_read_b64 v[92:93], v4 offset:1536
  ds_read_b64 v[94:95], v4 offset:1544
  ds_read_b128 v[128:131], v5 offset:2048
  s_waitcnt lgkmcnt(6)
  s_barrier
  v_mfma_f32_16x16x32_bf16 v[64:67], v[96:99], v[112:115], v[64:67]
  v_mfma_f32_16x16x32_bf16 v[68:71], v[96:99], v[116:119], v[68:71]
  v_mfma_f32_16x16x32_bf16 v[72:75], v[96:99], v[120:123], v[72:75]
  v_mfma_f32_16x16x32_bf16 v[76:79], v[96:99], v[124:127], v[76:79]
  ds_read_b64 v[96:97], v4 offset:2048
  ds_read_b64 v[98:99], v4 offset:2056
  ds_read_b128 v[124:127], v5 offset:1536
  v_mfma_f32_16x16x32_bf16 v[68:71], v[100:103], v[112:115], v[68:71]
  v_mfma_f32_16x16x32_bf16 v[72:75], v[100:103], v[116:119], v[72:75]
  v_mfma_f32_16x16x32_bf16 v[76:79], v[100:103], v[120:123], v[76:79]
  ds_read_b64 v[100:101], v4 offset:2560
  ds_read_b64 v[102:103], v4 offset:2568
  ds_read_b128 v[120:123], v5 offset:1024
  v_mfma_f32_16x16x32_bf16 v[72:75], v[104:107], v[112:115], v[72:75]
  v_mfma_f32_16x16x32_bf16 v[76:79], v[104:107], v[116:119], v[76:79]
  ds_read_b64 v[104:105], v4 offset:3072
  ds_read_b64 v[106:107], v4 offset:3080
  ds_read_b128 v[116:119], v5 offset:512
  s_waitcnt lgkmcnt(6)
  v_mfma_f32_16x16x32_bf16 v[76:79], v[108:111], v[112:115], v[76:79]
  ds_read_b64 v[108:109], v4 offset:3584
  ds_read_b64 v[110:111], v4 offset:3592
  ds_read_b128 v[112:115], v5 offset:0
  v_add_u32 v4, 64, v4
  v_subrev_u32 v5, 64, v5
  s_waitcnt lgkmcnt(0)
  v_mfma_f32_16x16x32_bf16 v[48:51], v[80:83], v[112:115], v[48:51]
  v_mfma_f32_16x16x32_bf16 v[52:55], v[80:83], v[116:119], v[52:55]
  v_mfma_f32_16x16x32_bf16 v[56:59], v[80:83], v[120:123], v[56:59]
  v_mfma_f32_16x16x32_bf16 v[60:63], v[80:83], v[124:127], v[60:63]
  v_mfma_f32_16x16x32_bf16 v[64:67], v[80:83], v[128:131], v[64:67]
  v_mfma_f32_16x16x32_bf16 v[68:71], v[80:83], v[132:135], v[68:71]
  v_mfma_f32_16x16x32_bf16 v[72:75], v[80:83], v[136:139], v[72:75]
  v_mfma_f32_16x16x32_bf16 v[76:79], v[80:83], v[140:143], v[76:79]
  ds_read_b64 v[80:81], v4 offset:0
  ds_read_b64 v[82:83], v4 offset:8
  ds_read_b128 v[140:143], v5 offset:3584
  v_mfma_f32_16x16x32_bf16 v[52:55], v[84:87], v[112:115], v[52:55]
  v_mfma_f32_16x16x32_bf16 v[56:59], v[84:87], v[116:119], v[56:59]
  v_mfma_f32_16x16x32_bf16 v[60:63], v[84:87], v[120:123], v[60:63]
  v_mfma_f32_16x16x32_bf16 v[64:67], v[84:87], v[124:127], v[64:67]
  v_mfma_f32_16x16x32_bf16 v[68:71], v[84:87], v[128:131], v[68:71]
  v_mfma_f32_16x16x32_bf16 v[72:75], v[84:87], v[132:135], v[72:75]
  v_mfma_f32_16x16x32_bf16 v[76:79], v[84:87], v[136:139], v[76:79]
  ds_read_b64 v[84:85], v4 offset:512
  ds_read_b64 v[86:87], v4 offset:520
  ds_read_b128 v[136:139], v5 offset:3072
  s_barrier
  v_mfma_f32_16x16x32_bf16 v[56:59], v[88:91], v[112:115], v[56:59]
  v_mfma_f32_16x16x32_bf16 v[60:63], v[88:91], v[116:119], v[60:63]
  v_mfma_f32_16x16x32_bf16 v[64:67], v[88:91], v[120:123], v[64:67]
  v_mfma_f32_16x16x32_bf16 v[68:71], v[88:91], v[124:127], v[68:71]
  v_mfma_f32_16x16x32_bf16 v[72:75], v[88:91], v[128:131], v[72:75]
  v_mfma_f32_16x16x32_bf16 v[76:79], v[88:91], v[132:135], v[76:79]
  ds_read_b64 v[88:89], v4 offset:1024
  ds_read_b64 v[90:91], v4 offset:1032
  ds_read_b128 v[132:135], v5 offset:2560
  v_mfma_f32_16x16x32_bf16 v[60:63], v[92:95], v[112:115], v[60:63]
  v_mfma_f32_16x16x32_bf16 v[64:67], v[92:95], v[116:119], v[64:67]
  v_mfma_f32_16x16x32_bf16 v[68:71], v[92:95], v[120:123], v[68:71]
  v_mfma_f32_16x16x32_bf16 v[72:75], v[92:95], v[124:127], v[72:75]
  v_mfma_f32_16x16x32_bf16 v[76:79], v[92:95], v[128:131], v[76:79]
  ds_read_b64 v[92:93], v4 offset:1536
  ds_read_b64 v[94:95], v4 offset:1544
  ds_read_b128 v[128:131], v5 offset:2048
  s_waitcnt lgkmcnt(6)
  v_mfma_f32_16x16x32_bf16 v[64:67], v[96:99], v[112:115], v[64:67]
  v_mfma_f32_16x16x32_bf16 v[68:71], v[96:99], v[116:119], v[68:71]
  v_mfma_f32_16x16x32_bf16 v[72:75], v[96:99], v[120:123], v[72:75]
  v_mfma_f32_16x16x32_bf16 v[76:79], v[96:99], v[124:127], v[76:79]
  ds_read_b64 v[96:97], v4 offset:2048
  ds_read_b64 v[98:99], v4 offset:2056
  ds_read_b128 v[124:127], v5 offset:1536
  v_mfma_f32_16x16x32_bf16 v[68:71], v[100:103], v[112:115], v[68:71]
  v_mfma_f32_16x16x32_bf16 v[72:75], v[100:103], v[116:119], v[72:75]
  v_mfma_f32_16x16x32_bf16 v[76:79], v[100:103], v[120:123], v[76:79]
  ds_read_b64 v[100:101], v4 offset:2560
  ds_read_b64 v[102:103], v4 offset:2568
  ds_read_b128 v[120:123], v5 offset:1024
  v_mfma_f32_16x16x32_bf16 v[72:75], v[104:107], v[112:115], v[72:75]
  v_mfma_f32_16x16x32_bf16 v[76:79], v[104:107], v[116:119], v[76:79]
  ds_read_b64 v[104:105], v4 offset:3072
  ds_read_b64 v[106:107], v4 offset:3080
  ds_read_b128 v[116:119], v5 offset:512
  s_waitcnt lgkmcnt(6)
  v_mfma_f32_16x16x32_bf16 v[76:79], v[108:111], v[112:115], v[76:79]
  ds_read_b64 v[108:109], v4 offset:3584
  ds_read_b64 v[110:111], v4 offset:3592
  ds_read_b128 v[112:115], v5 offset:0
  s_barrier
  s_add_u32 s37, s37, 2
  s_cmp_lt_u32 s37, 8
  s_cbranch_scc1 F2_CLOOP
  s_waitcnt lgkmcnt(0)
  v_lshlrev_b32 v6, 5, v3
  v_lshrrev_b32 v7, 1, v2
  v_lshlrev_b32 v7, 4, v7
  v_add_u32 v6, v6, v7
  v_and_b32 v7, 1, v2
  v_xor_b32 v7, 1, v7
  v_lshlrev_b32 v7, 3, v7
  v_add_u32 v6, v6, v7
  s_add_u32 s40, s36, 17152
  v_add_u32 v6, s40, v6
  ds_read_b64 v[80:81], v6 offset:0
  ds_read_b64 v[82:83], v6 offset:512
  ds_read_b64 v[84:85], v6 offset:1024
  ds_read_b64 v[86:87], v6 offset:1536
  ds_read_b64 v[88:89], v6 offset:2048
  ds_read_b64 v[90:91], v6 offset:2560
  ds_read_b64 v[92:93], v6 offset:3072
  ds_read_b64 v[94:95], v6 offset:3584
  v_lshlrev_b32 v8, 5, v3
  v_lshlrev_b32 v9, 3, v2
  v_add_u32 v8, v8, v9
  s_lshl_b32 s40, s35, 12
  s_add_u32 s40, s40, 9437184
  s_waitcnt lgkmcnt(0)
  v_and_b32 v112, s47, v81
  v_lshlrev_b32 v113, 16, v81
  v_and_b32 v114, s47, v80
  v_lshlrev_b32 v115, 16, v80
  v_fmac_f32 v48, v112, v46
  v_fmac_f32 v49, v113, v46
  v_fmac_f32 v50, v114, v46
  v_fmac_f32 v51, v115, v46
  v_cvt_pk_bf16_f32 v116, v48, v49
  v_cvt_pk_bf16_f32 v117, v50, v51
  buffer_store_dwordx2 v[116:117], v8, s[16:19], s40 offen offset:0 sc1
  v_and_b32 v120, s47, v83
  v_lshlrev_b32 v121, 16, v83
  v_and_b32 v122, s47, v82
  v_lshlrev_b32 v123, 16, v82
  v_fmac_f32 v52, v120, v46
  v_fmac_f32 v53, v121, v46
  v_fmac_f32 v54, v122, v46
  v_fmac_f32 v55, v123, v46
  v_cvt_pk_bf16_f32 v124, v52, v53
  v_cvt_pk_bf16_f32 v125, v54, v55
  buffer_store_dwordx2 v[124:125], v8, s[16:19], s40 offen offset:512 sc1
  v_and_b32 v128, s47, v85
  v_lshlrev_b32 v129, 16, v85
  v_and_b32 v130, s47, v84
  v_lshlrev_b32 v131, 16, v84
  v_fmac_f32 v56, v128, v46
  v_fmac_f32 v57, v129, v46
  v_fmac_f32 v58, v130, v46
  v_fmac_f32 v59, v131, v46
  v_cvt_pk_bf16_f32 v132, v56, v57
  v_cvt_pk_bf16_f32 v133, v58, v59
  buffer_store_dwordx2 v[132:133], v8, s[16:19], s40 offen offset:1024 sc1
  v_and_b32 v136, s47, v87
  v_lshlrev_b32 v137, 16, v87
  v_and_b32 v138, s47, v86
  v_lshlrev_b32 v139, 16, v86
  v_fmac_f32 v60, v136, v46
  v_fmac_f32 v61, v137, v46
  v_fmac_f32 v62, v138, v46
  v_fmac_f32 v63, v139, v46
  v_cvt_pk_bf16_f32 v140, v60, v61
  v_cvt_pk_bf16_f32 v141, v62, v63
  buffer_store_dwordx2 v[140:141], v8, s[16:19], s40 offen offset:1536 sc1
  v_and_b32 v112, s47, v89
  v_lshlrev_b32 v113, 16, v89
  v_and_b32 v114, s47, v88
  v_lshlrev_b32 v115, 16, v88
  v_fmac_f32 v64, v112, v46
  v_fmac_f32 v65, v113, v46
  v_fmac_f32 v66, v114, v46
  v_fmac_f32 v67, v115, v46
  v_cvt_pk_bf16_f32 v116, v64, v65
  v_cvt_pk_bf16_f32 v117, v66, v67
  buffer_store_dwordx2 v[116:117], v8, s[16:19], s40 offen offset:2048 sc1
  v_and_b32 v120, s47, v91
  v_lshlrev_b32 v121, 16, v91
  v_and_b32 v122, s47, v90
  v_lshlrev_b32 v123, 16, v90
  v_fmac_f32 v68, v120, v46
  v_fmac_f32 v69, v121, v46
  v_fmac_f32 v70, v122, v46
  v_fmac_f32 v71, v123, v46
  v_cvt_pk_bf16_f32 v124, v68, v69
  v_cvt_pk_bf16_f32 v125, v70, v71
  buffer_store_dwordx2 v[124:125], v8, s[16:19], s40 offen offset:2560 sc1
  v_and_b32 v128, s47, v93
  v_lshlrev_b32 v129, 16, v93
  v_and_b32 v130, s47, v92
  v_lshlrev_b32 v131, 16, v92
  v_fmac_f32 v72, v128, v46
  v_fmac_f32 v73, v129, v46
  v_fmac_f32 v74, v130, v46
  v_fmac_f32 v75, v131, v46
  v_cvt_pk_bf16_f32 v132, v72, v73
  v_cvt_pk_bf16_f32 v133, v74, v75
  buffer_store_dwordx2 v[132:133], v8, s[16:19], s40 offen offset:3072 sc1
  v_and_b32 v136, s47, v95
  v_lshlrev_b32 v137, 16, v95
  v_and_b32 v138, s47, v94
  v_lshlrev_b32 v139, 16, v94
  v_fmac_f32 v76, v136, v46
  v_fmac_f32 v77, v137, v46
  v_fmac_f32 v78, v138, v46
  v_fmac_f32 v79, v139, v46
  v_cvt_pk_bf16_f32 v140, v76, v77
  v_cvt_pk_bf16_f32 v141, v78, v79
  buffer_store_dwordx2 v[140:141], v8, s[16:19], s40 offen offset:3584 sc1
  s_waitcnt vmcnt(0)
  s_barrier
F3_IDLE:
  s_load_dwordx2 s[56:57], s[0:1], 0
  s_load_dwordx2 s[58:59], s[0:1], 88
  v_lshlrev_b32 v4, 4, v1
  s_lshl_b32 s35, s32, 2
  s_add_u32 s35, s35, s55
  s_lshr_b32 s39, s34, 2
  s_mul_i32 s36, s35, 24576
  s_mul_i32 s40, s39, 12288
  s_add_u32 s36, s36, s40
  s_add_u32 s36, s36, 12582912
  s_mul_i32 s40, s39, 61440
  v_add_u32 v26, s40, v4
  s_lshl_b32 s40, s35, 4
  s_mul_i32 s40, s40, 1280
  s_mul_i32 s41, s33, 160
  s_add_u32 s40, s40, s41
  v_add_u32 v12, 0, v1
  v_mul_u32_u24 v13, 6554, v12
  v_lshrrev_b32 v13, 16, v13
  v_mul_u32_u24 v14, 10, v13
  v_sub_u32 v14, v12, v14
  v_lshlrev_b32 v14, 4, v14
  v_mul_u32_u24 v13, 1280, v13
  v_add_u32 v13, v13, v14
  v_add_u32 v5, s40, v13
  v_lshrrev_b32 v13, 1, v12
  v_lshlrev_b32 v13, 12, v13
  v_and_b32 v14, 1, v12
  v_lshlrev_b32 v14, 4, v14
  v_add_u32 v8, v13, v14
  v_add_u32 v12, 64, v1
  v_mul_u32_u24 v13, 6554, v12
  v_lshrrev_b32 v13, 16, v13
  v_mul_u32_u24 v14, 10, v13
  v_sub_u32 v14, v12, v14
  v_lshlrev_b32 v14, 4, v14
  v_mul_u32_u24 v13, 1280, v13
  v_add_u32 v13, v13, v14
  v_add_u32 v6, s40, v13
  v_lshrrev_b32 v13, 1, v12
  v_lshlrev_b32 v13, 12, v13
  v_and_b32 v14, 1, v12
  v_lshlrev_b32 v14, 4, v14
  v_add_u32 v9, v13, v14
  v_add_u32 v12, 128, v1
  v_mul_u32_u24 v13, 6554, v12
  v_lshrrev_b32 v13, 16, v13
  v_mul_u32_u24 v14, 10, v13
  v_sub_u32 v14, v12, v14
  v_lshlrev_b32 v14, 4, v14
  v_mul_u32_u24 v13, 1280, v13
  v_add_u32 v13, v13, v14
  v_add_u32 v7, s40, v13
  v_lshrrev_b32 v13, 1, v12
  v_lshlrev_b32 v13, 12, v13
  v_and_b32 v14, 1, v12
  v_lshlrev_b32 v14, 4, v14
  v_add_u32 v10, v13, v14
  s_mul_i32 s37, s55, 2560
  s_mul_i32 s38, s33, 327680
  s_lshl_b32 s41, s35, 5
  s_add_u32 s38, s38, s41
  s_add_u32 s38, s38, 9437184
  s_lshl_b32 s40, s55, 6
  s_add_u32 s40, s40, 143360
  v_lshlrev_b32 v21, 2, v3
  v_add_u32 v21, s40, v21
  ds_read_b32 v24, v21
  ds_read_b32 v25, v21 offset:256
  v_mov_b32 v68, 0
  v_mov_b32 v69, 0
  v_mov_b32 v70, 0
  v_mov_b32 v71, 0
  v_mov_b32 v72, 0
  v_mov_b32 v73, 0
  v_mov_b32 v74, 0
  v_mov_b32 v75, 0
  v_mov_b32 v76, 0
  v_mov_b32 v77, 0
  v_mov_b32 v78, 0
  v_mov_b32 v79, 0
  v_mov_b32 v80, 0
  v_mov_b32 v81, 0
  v_mov_b32 v82, 0
  v_mov_b32 v83, 0
  v_mov_b32 v84, 0
  v_mov_b32 v85, 0
  v_mov_b32 v86, 0
  v_mov_b32 v87, 0
  s_waitcnt lgkmcnt(0)
  s_mov_b32 s8, s56
  s_and_b32 s9, s57, 0xffff
  s_mov_b32 s10, 2621440
  s_mov_b32 s11, 0x20000
  s_mov_b32 s12, s58
  s_and_b32 s13, s59, 0xffff
  s_mov_b32 s14, 2621440
  s_mov_b32 s15, 0x20000
  s_barrier
F3_BMAIN:
  s_add_u32 s40, s36, 0
  buffer_load_dwordx4 v[88:91], v4, s[16:19], s40 offen offset:0 sc1
  s_add_u32 s40, s36, 0
  buffer_load_dwordx4 v[92:95], v4, s[16:19], s40 offen offset:1024 sc1
  s_add_u32 s40, s36, 0
  buffer_load_dwordx4 v[96:99], v4, s[16:19], s40 offen offset:2048 sc1
  s_add_u32 s40, s36, 0
  buffer_load_dwordx4 v[100:103], v4, s[16:19], s40 offen offset:3072 sc1
  s_add_u32 s40, s36, 4096
  buffer_load_dwordx4 v[104:107], v4, s[16:19], s40 offen offset:0 sc1
  s_barrier
  ds_read_b128 v[28:31], v26 offset:0
  ds_read_b128 v[32:35], v26 offset:1024
  ds_read_b128 v[36:39], v26 offset:2048
  ds_read_b128 v[40:43], v26 offset:3072
  ds_read_b128 v[44:47], v26 offset:4096
  s_waitcnt vmcnt(4) lgkmcnt(0)
  v_mfma_f32_16x16x32_bf16 v[68:71], v[28:31], v[88:91], v[68:71]
  ds_read_b128 v[48:51], v26 offset:5120
  v_mfma_f32_16x16x32_bf16 v[72:75], v[32:35], v[88:91], v[72:75]
  ds_read_b128 v[52:55], v26 offset:6144
  v_mfma_f32_16x16x32_bf16 v[76:79], v[36:39], v[88:91], v[76:79]
  ds_read_b128 v[56:59], v26 offset:7168
  s_add_u32 s40, s36, 4096
  buffer_load_dwordx4 v[108:111], v4, s[16:19], s40 offen offset:1024 sc1
  v_mfma_f32_16x16x32_bf16 v[80:83], v[40:43], v[88:91], v[80:83]
  ds_read_b128 v[60:63], v26 offset:8192
  v_mfma_f32_16x16x32_bf16 v[84:87], v[44:47], v[88:91], v[84:87]
  ds_read_b128 v[64:67], v26 offset:9216
  s_waitcnt vmcnt(4) lgkmcnt(0)
  v_mfma_f32_16x16x32_bf16 v[68:71], v[48:51], v[92:95], v[68:71]
  ds_read_b128 v[28:31], v26 offset:10240
  v_mfma_f32_16x16x32_bf16 v[72:75], v[52:55], v[92:95], v[72:75]
  ds_read_b128 v[32:35], v26 offset:11264
  v_mfma_f32_16x16x32_bf16 v[76:79], v[56:59], v[92:95], v[76:79]
  ds_read_b128 v[36:39], v26 offset:12288
  s_add_u32 s40, s36, 4096
  buffer_load_dwordx4 v[112:115], v4, s[16:19], s40 offen offset:2048 sc1
  v_mfma_f32_16x16x32_bf16 v[80:83], v[60:63], v[92:95], v[80:83]
  ds_read_b128 v[40:43], v26 offset:13312
  v_mfma_f32_16x16x32_bf16 v[84:87], v[64:67], v[92:95], v[84:87]
  ds_read_b128 v[44:47], v26 offset:14336
  s_waitcnt vmcnt(4) lgkmcnt(0)
  v_mfma_f32_16x16x32_bf16 v[68:71], v[28:31], v[96:99], v[68:71]
  ds_read_b128 v[48:51], v26 offset:15360
  v_mfma_f32_16x16x32_bf16 v[72:75], v[32:35], v[96:99], v[72:75]
  ds_read_b128 v[52:55], v26 offset:16384
  v_mfma_f32_16x16x32_bf16 v[76:79], v[36:39], v[96:99], v[76:79]
  ds_read_b128 v[56:59], v26 offset:17408
  s_add_u32 s40, s36, 4096
  buffer_load_dwordx4 v[116:119], v4, s[16:19], s40 offen offset:3072 sc1
  v_mfma_f32_16x16x32_bf16 v[80:83], v[40:43], v[96:99], v[80:83]
  ds_read_b128 v[60:63], v26 offset:18432
  v_mfma_f32_16x16x32_bf16 v[84:87], v[44:47], v[96:99], v[84:87]
  ds_read_b128 v[64:67], v26 offset:19456
  s_waitcnt vmcnt(4) lgkmcnt(0)
  s_barrier
  v_mfma_f32_16x16x32_bf16 v[68:71], v[48:51], v[100:103], v[68:71]
  ds_read_b128 v[28:31], v26 offset:20480
  v_mfma_f32_16x16x32_bf16 v[72:75], v[52:55], v[100:103], v[72:75]
  ds_read_b128 v[32:35], v26 offset:21504
  v_mfma_f32_16x16x32_bf16 v[76:79], v[56:59], v[100:103], v[76:79]
  ds_read_b128 v[36:39], v26 offset:22528
  s_add_u32 s40, s36, 8192
  buffer_load_dwordx4 v[120:123], v4, s[16:19], s40 offen offset:0 sc1
  v_mfma_f32_16x16x32_bf16 v[80:83], v[60:63], v[100:103], v[80:83]
  ds_read_b128 v[40:43], v26 offset:23552
  v_mfma_f32_16x16x32_bf16 v[84:87], v[64:67], v[100:103], v[84:87]
  ds_read_b128 v[44:47], v26 offset:24576
  s_waitcnt vmcnt(4) lgkmcnt(0)
  v_mfma_f32_16x16x32_bf16 v[68:71], v[28:31], v[104:107], v[68:71]
  ds_read_b128 v[48:51], v26 offset:25600
  v_mfma_f32_16x16x32_bf16 v[72:75], v[32:35], v[104:107], v[72:75]
  ds_read_b128 v[52:55], v26 offset:26624
  v_mfma_f32_16x16x32_bf16 v[76:79], v[36:39], v[104:107], v[76:79]
  ds_read_b128 v[56:59], v26 offset:27648
  s_add_u32 s40, s36, 8192
  buffer_load_dwordx4 v[124:127], v4, s[16:19], s40 offen offset:1024 sc1
  v_mfma_f32_16x16x32_bf16 v[80:83], v[40:43], v[104:107], v[80:83]
  ds_read_b128 v[60:63], v26 offset:28672
  v_mfma_f32_16x16x32_bf16 v[84:87], v[44:47], v[104:107], v[84:87]
  ds_read_b128 v[64:67], v26 offset:29696
  s_add_u32 m0, s37, 133120
  s_nop 0
  buffer_load_dwordx4 v8, s[16:19], s38 offen sc1 lds
  s_waitcnt vmcnt(5) lgkmcnt(0)
  v_mfma_f32_16x16x32_bf16 v[68:71], v[48:51], v[108:111], v[68:71]
  ds_read_b128 v[28:31], v26 offset:30720
  v_mfma_f32_16x16x32_bf16 v[72:75], v[52:55], v[108:111], v[72:75]
  ds_read_b128 v[32:35], v26 offset:31744
  v_mfma_f32_16x16x32_bf16 v[76:79], v[56:59], v[108:111], v[76:79]
  ds_read_b128 v[36:39], v26 offset:32768
  s_add_u32 s40, s36, 8192
  buffer_load_dwordx4 v[128:131], v4, s[16:19], s40 offen offset:2048 sc1
  v_mfma_f32_16x16x32_bf16 v[80:83], v[60:63], v[108:111], v[80:83]
  ds_read_b128 v[40:43], v26 offset:33792
  v_mfma_f32_16x16x32_bf16 v[84:87], v[64:67], v[108:111], v[84:87]
  ds_read_b128 v[44:47], v26 offset:34816
  s_add_u32 m0, s37, 134144
  s_nop 0
  buffer_load_dwordx4 v9, s[16:19], s38 offen sc1 lds
  s_waitcnt vmcnt(6) lgkmcnt(0)
  v_mfma_f32_16x16x32_bf16 v[68:71], v[28:31], v[112:115], v[68:71]
  ds_read_b128 v[48:51], v26 offset:35840
  v_mfma_f32_16x16x32_bf16 v[72:75], v[32:35], v[112:115], v[72:75]
  ds_read_b128 v[52:55], v26 offset:36864
  v_mfma_f32_16x16x32_bf16 v[76:79], v[36:39], v[112:115], v[76:79]
  ds_read_b128 v[56:59], v26 offset:37888
  s_add_u32 s40, s36, 8192
  buffer_load_dwordx4 v[132:135], v4, s[16:19], s40 offen offset:3072 sc1
  v_mfma_f32_16x16x32_bf16 v[80:83], v[40:43], v[112:115], v[80:83]
  ds_read_b128 v[60:63], v26 offset:38912
  v_mfma_f32_16x16x32_bf16 v[84:87], v[44:47], v[112:115], v[84:87]
  ds_read_b128 v[64:67], v26 offset:39936
  s_mov_b32 exec_hi, 0
  s_add_u32 m0, s37, 135168
  s_nop 0
  buffer_load_dwordx4 v10, s[16:19], s38 offen sc1 lds
  s_mov_b32 exec_hi, -1
  s_waitcnt vmcnt(7) lgkmcnt(0)
  s_barrier
  v_mfma_f32_16x16x32_bf16 v[68:71], v[48:51], v[116:119], v[68:71]
  ds_read_b128 v[28:31], v26 offset:40960
  v_mfma_f32_16x16x32_bf16 v[72:75], v[52:55], v[116:119], v[72:75]
  ds_read_b128 v[32:35], v26 offset:41984
  v_mfma_f32_16x16x32_bf16 v[76:79], v[56:59], v[116:119], v[76:79]
  ds_read_b128 v[36:39], v26 offset:43008
  v_mfma_f32_16x16x32_bf16 v[80:83], v[60:63], v[116:119], v[80:83]
  ds_read_b128 v[40:43], v26 offset:44032
  v_mfma_f32_16x16x32_bf16 v[84:87], v[64:67], v[116:119], v[84:87]
  ds_read_b128 v[44:47], v26 offset:45056
  s_waitcnt vmcnt(6) lgkmcnt(0)
  v_mfma_f32_16x16x32_bf16 v[68:71], v[28:31], v[120:123], v[68:71]
  ds_read_b128 v[48:51], v26 offset:46080
  v_mfma_f32_16x16x32_bf16 v[72:75], v[32:35], v[120:123], v[72:75]
  ds_read_b128 v[52:55], v26 offset:47104
  v_mfma_f32_16x16x32_bf16 v[76:79], v[36:39], v[120:123], v[76:79]
  ds_read_b128 v[56:59], v26 offset:48128
  v_mfma_f32_16x16x32_bf16 v[80:83], v[40:43], v[120:123], v[80:83]
  ds_read_b128 v[60:63], v26 offset:49152
  v_mfma_f32_16x16x32_bf16 v[84:87], v[44:47], v[120:123], v[84:87]
  ds_read_b128 v[64:67], v26 offset:50176
  s_waitcnt vmcnt(5) lgkmcnt(0)
  v_mfma_f32_16x16x32_bf16 v[68:71], v[48:51], v[124:127], v[68:71]
  ds_read_b128 v[28:31], v26 offset:51200
  v_mfma_f32_16x16x32_bf16 v[72:75], v[52:55], v[124:127], v[72:75]
  ds_read_b128 v[32:35], v26 offset:52224
  v_mfma_f32_16x16x32_bf16 v[76:79], v[56:59], v[124:127], v[76:79]
  ds_read_b128 v[36:39], v26 offset:53248
  v_mfma_f32_16x16x32_bf16 v[80:83], v[60:63], v[124:127], v[80:83]
  ds_read_b128 v[40:43], v26 offset:54272
  v_mfma_f32_16x16x32_bf16 v[84:87], v[64:67], v[124:127], v[84:87]
  ds_read_b128 v[44:47], v26 offset:55296
  s_waitcnt vmcnt(3) lgkmcnt(0)
  v_mfma_f32_16x16x32_bf16 v[68:71], v[28:31], v[128:131], v[68:71]
  ds_read_b128 v[48:51], v26 offset:56320
  v_mfma_f32_16x16x32_bf16 v[72:75], v[32:35], v[128:131], v[72:75]
  ds_read_b128 v[52:55], v26 offset:57344
  v_mfma_f32_16x16x32_bf16 v[76:79], v[36:39], v[128:131], v[76:79]
  ds_read_b128 v[56:59], v26 offset:58368
  v_mfma_f32_16x16x32_bf16 v[80:83], v[40:43], v[128:131], v[80:83]
  ds_read_b128 v[60:63], v26 offset:59392
  v_mfma_f32_16x16x32_bf16 v[84:87], v[44:47], v[128:131], v[84:87]
  ds_read_b128 v[64:67], v26 offset:60416
  s_waitcnt vmcnt(1) lgkmcnt(0)
  v_mfma_f32_16x16x32_bf16 v[68:71], v[48:51], v[132:135], v[68:71]
  v_mfma_f32_16x16x32_bf16 v[72:75], v[52:55], v[132:135], v[72:75]
  v_mfma_f32_16x16x32_bf16 v[76:79], v[56:59], v[132:135], v[76:79]
  v_mfma_f32_16x16x32_bf16 v[80:83], v[60:63], v[132:135], v[80:83]
  v_mfma_f32_16x16x32_bf16 v[84:87], v[64:67], v[132:135], v[84:87]
  s_mul_i32 s40, s55, 5120
  v_add_u32 v12, s40, v4
  s_nop 1
  ds_write_b128 v12, v[68:71] offset:0
  ds_write_b128 v12, v[72:75] offset:1024
  ds_write_b128 v12, v[76:79] offset:2048
  v_mul_u32_u24 v13, 160, v3
  v_lshlrev_b32 v14, 3, v2
  v_add_u32 v13, v13, v14
  s_add_u32 s40, s37, 122880
  v_add_u32 v13, s40, v13
  v_lshlrev_b32 v14, 7, v2
  v_lshlrev_b32 v15, 3, v3
  v_add_u32 v14, v14, v15
  s_add_u32 s40, s37, 133120
  v_add_u32 v14, s40, v14
  v_sub_f32 v16, 0, v24
  v_mov_b32 v18, v25
  s_mov_b32 s48, 1.0
  s_mov_b32 s49, 1.0
  v_mov_b32 v20, 0xbfb8aa3b
  v_mov_b32 v21, 0xbfb8aa3b
  s_waitcnt vmcnt(0) lgkmcnt(0)
  s_barrier
  ds_read_b64 v[94:95], v13 offset:96
  ds_read_b64_tr_b16 v[104:105], v14 offset:1536
  ds_read_b64 v[96:97], v13 offset:128
  ds_read_b64_tr_b16 v[106:107], v14 offset:2048
  ds_read_b128 v[120:123], v12 offset:3072
  ds_read_b128 v[124:127], v12 offset:4096
  s_waitcnt lgkmcnt(0)
  v_pk_add_f32 v[80:81], v[80:81], v[120:121]
  v_lshlrev_b32 v28, 16, v94
  v_and_b32 v29, s47, v94
  v_pk_mul_f32 v[32:33], v[80:81], v[20:21]
  v_lshlrev_b32 v30, 16, v104
  v_and_b32 v31, s47, v104
  v_exp_f32 v32, v32
  v_exp_f32 v33, v33
  v_pk_add_f32 v[34:35], v[28:29], v[16:17] op_sel_hi:[1,0]
  v_pk_add_f32 v[32:33], v[32:33], s[48:49]
  v_pk_mul_f32 v[34:35], v[34:35], v[18:19] op_sel_hi:[1,0]
  v_rcp_f32 v32, v32
  v_rcp_f32 v33, v33
  v_pk_mul_f32 v[34:35], v[34:35], v[30:31]
  v_pk_mul_f32 v[32:33], v[32:33], v[80:81]
  v_pk_fma_f32 v[34:35], v[34:35], v[32:33], v[28:29]
  v_cvt_pk_bf16_f32 v94, v34, v35
  v_pk_add_f32 v[82:83], v[82:83], v[122:123]
  v_lshlrev_b32 v36, 16, v95
  v_and_b32 v37, s47, v95
  v_pk_mul_f32 v[40:41], v[82:83], v[20:21]
  v_lshlrev_b32 v38, 16, v105
  v_and_b32 v39, s47, v105
  v_exp_f32 v40, v40
  v_exp_f32 v41, v41
  v_pk_add_f32 v[42:43], v[36:37], v[16:17] op_sel_hi:[1,0]
  v_pk_add_f32 v[40:41], v[40:41], s[48:49]
  v_pk_mul_f32 v[42:43], v[42:43], v[18:19] op_sel_hi:[1,0]
  v_rcp_f32 v40, v40
  v_rcp_f32 v41, v41
  v_pk_mul_f32 v[42:43], v[42:43], v[38:39]
  v_pk_mul_f32 v[40:41], v[40:41], v[82:83]
  v_pk_fma_f32 v[42:43], v[42:43], v[40:41], v[36:37]
  v_cvt_pk_bf16_f32 v95, v42, v43
  ds_write_b64 v13, v[94:95] offset:96
  v_pk_add_f32 v[84:85], v[84:85], v[124:125]
  v_lshlrev_b32 v28, 16, v96
  v_and_b32 v29, s47, v96
  v_pk_mul_f32 v[32:33], v[84:85], v[20:21]
  v_lshlrev_b32 v30, 16, v106
  v_and_b32 v31, s47, v106
  v_exp_f32 v32, v32
  v_exp_f32 v33, v33
  v_pk_add_f32 v[34:35], v[28:29], v[16:17] op_sel_hi:[1,0]
  v_pk_add_f32 v[32:33], v[32:33], s[48:49]
  v_pk_mul_f32 v[34:35], v[34:35], v[18:19] op_sel_hi:[1,0]
  v_rcp_f32 v32, v32
  v_rcp_f32 v33, v33
  v_pk_mul_f32 v[34:35], v[34:35], v[30:31]
  v_pk_mul_f32 v[32:33], v[32:33], v[84:85]
  v_pk_fma_f32 v[34:35], v[34:35], v[32:33], v[28:29]
  v_cvt_pk_bf16_f32 v96, v34, v35
  v_pk_add_f32 v[86:87], v[86:87], v[126:127]
  v_lshlrev_b32 v36, 16, v97
  v_and_b32 v37, s47, v97
  v_pk_mul_f32 v[40:41], v[86:87], v[20:21]
  v_lshlrev_b32 v38, 16, v107
  v_and_b32 v39, s47, v107
  v_exp_f32 v40, v40
  v_exp_f32 v41, v41
  v_pk_add_f32 v[42:43], v[36:37], v[16:17] op_sel_hi:[1,0]
  v_pk_add_f32 v[40:41], v[40:41], s[48:49]
  v_pk_mul_f32 v[42:43], v[42:43], v[18:19] op_sel_hi:[1,0]
  v_rcp_f32 v40, v40
  v_rcp_f32 v41, v41
  v_pk_mul_f32 v[42:43], v[42:43], v[38:39]
  v_pk_mul_f32 v[40:41], v[40:41], v[86:87]
  v_pk_fma_f32 v[42:43], v[42:43], v[40:41], v[36:37]
  v_cvt_pk_bf16_f32 v97, v42, v43
  ds_write_b64 v13, v[96:97] offset:128
  s_waitcnt lgkmcnt(0)
  s_barrier
  s_add_u32 s40, s37, 122880
  v_add_u32 v13, s40, v4
  ds_read_b128 v[108:111], v13 offset:2048
  s_waitcnt lgkmcnt(0)
  s_mov_b32 exec_lo, 0xffffffff
  s_mov_b32 exec_hi, 0x0
  buffer_store_dwordx4 v[108:111], v7, s[12:15], 0 offen
  s_mov_b64 exec, s[52:53]
  s_endpgm
F2_IDLE:
  s_waitcnt vmcnt(0)
  s_barrier
  s_sub_u32 s42, s34, 4
  v_lshrrev_b32 v8, 3, v1
  s_lshl_b32 s40, s42, 3
  v_add_u32 v8, s40, v8
  v_and_b32 v9, 7, v1
  v_lshlrev_b32 v9, 4, v9
  v_mul_u32_u24 v10, 144, v8
  v_add_u32 v10, v10, v9
  v_add_u32 v10, 49152, v10
  v_lshlrev_b32 v8, 12, v8
  v_add_u32 v8, v8, v9
  ds_read_b128 v[16:19], v10 offset:0
  ds_read_b128 v[20:23], v10 offset:3456
  ds_read_b128 v[24:27], v10 offset:6912
  ds_read_b128 v[28:31], v10 offset:10368
  s_mul_i32 s40, s33, 327680
  s_lshl_b32 s41, s32, 7
  s_add_u32 s40, s40, s41
  s_add_u32 s40, s40, 6291456
  s_waitcnt lgkmcnt(0)
  buffer_store_dwordx4 v[16:19], v8, s[16:19], s40 offen sc1
  s_add_u32 s40, s40, 98304
  buffer_store_dwordx4 v[20:23], v8, s[16:19], s40 offen sc1
  s_add_u32 s40, s40, 98304
  buffer_store_dwordx4 v[24:27], v8, s[16:19], s40 offen sc1
  s_add_u32 s40, s40, 98304
  s_cmp_eq_u32 s42, 0
  s_cselect_b32 s40, s40, 0x80000000
  buffer_store_dwordx4 v[28:31], v8, s[16:19], s40 offen sc1
  s_add_u32 s40, s40, 98304
  s_barrier
  s_waitcnt vmcnt(0)
  s_barrier
  s_barrier
  s_barrier
  s_barrier
  s_barrier
  s_barrier
  s_barrier
  s_barrier
  s_barrier
  s_barrier
  s_barrier
  s_barrier
  s_barrier
  s_barrier
  s_barrier
  s_barrier
  s_barrier
  s_barrier
  s_barrier
  s_branch F3_IDLE
F2_SYNC:
  s_load_dwordx2 s[72:73], s[0:1], 104
  s_lshl_b32 s40, s33, 7
  s_lshl_b32 s41, s32, 2
  s_add_u32 s40, s40, s41
  s_add_u32 s41, s40, 17040384
  s_add_u32 s40, s40, 17039360
  v_mov_b32 v152, s40
  v_mov_b32 v153, s41
  v_cmp_eq_u32 vcc, 1, v1
  s_nop 1
  v_cndmask_b32 v152, v152, v153, vcc
  s_lshl_b32 s40, s32, 5
  s_lshl_b32 s41, s33, 2
  s_add_u32 s40, s40, s41
  s_add_u32 s40, s40, 17041408
  v_mov_b32 v153, s40
  v_cmp_eq_u32 vcc, 2, v1
  s_nop 1
  v_cndmask_b32 v152, v152, v153, vcc
  s_lshl_b32 s40, s33, 7
  s_lshl_b32 s41, s32, 2
  s_add_u32 s40, s40, s41
  s_add_u32 s40, s40, 17042432
  v_mov_b32 v153, s40
  v_cmp_eq_u32 vcc, 3, v1
  s_nop 1
  v_cndmask_b32 v152, v152, v153, vcc
  v_mov_b32 v154, 1
  s_waitcnt vmcnt(0) lgkmcnt(0)
  s_barrier
  s_mov_b32 exec_lo, 0x1
  s_mov_b32 exec_hi, 0x0
  buffer_store_dword v154, v152, s[16:19], 0 offen sc1
  s_mov_b64 exec, s[52:53]
  s_lshl_b32 s40, s33, 7
  s_add_u32 s75, s40, 17039360
  s_add_u32 s40, s40, 17039360
  v_lshlrev_b32 v150, 2, v1
  v_add_u32 v150, s40, v150
  s_add_u32 s74, s75, 0
  s_mov_b32 s42, 0
SP_F1a:
  s_load_dwordx8 s[56:63], s[72:73], s74 glc
  s_waitcnt lgkmcnt(0)
  s_and_b64 s[56:57], s[56:57], s[60:61]
  s_and_b64 s[58:59], s[58:59], s[62:63]
  s_and_b64 s[56:57], s[56:57], s[58:59]
  s_and_b32 s56, s56, s57
  s_add_u32 s42, s42, 1
  s_cmp_eq_u32 s56, 1
  s_cbranch_scc1 SP_F1a_OK
  s_cmp_lt_u32 s42, 2097152
  s_cbranch_scc1 SP_F1a
SP_F1a_OK:
  s_barrier
  s_barrier
  s_mov_b32 exec_lo, 0x8
  s_mov_b32 exec_hi, 0x0
  buffer_store_dword v154, v152, s[16:19], 0 offen sc1
  s_mov_b64 exec, s[52:53]
  s_add_u32 s74, s75, 32
  s_mov_b32 s42, 0
SP_F1b:
  s_load_dwordx8 s[56:63], s[72:73], s74 glc
  s_waitcnt lgkmcnt(0)
  s_and_b64 s[56:57], s[56:57], s[60:61]
  s_and_b64 s[58:59], s[58:59], s[62:63]
  s_and_b64 s[56:57], s[56:57], s[58:59]
  s_and_b32 s56, s56, s57
  s_add_u32 s42, s42, 1
  s_cmp_eq_u32 s56, 1
  s_cbranch_scc1 SP_F1b_OK
  s_cmp_lt_u32 s42, 2097152
  s_cbranch_scc1 SP_F1b
SP_F1b_OK:
  s_barrier
  s_barrier
  s_add_u32 s74, s75, 64
  s_mov_b32 s42, 0
SP_F1c:
  s_load_dwordx16 s[56:71], s[72:73], s74 glc
  s_waitcnt lgkmcnt(0)
  s_and_b64 s[56:57], s[56:57], s[64:65]
  s_and_b64 s[58:59], s[58:59], s[66:67]
  s_and_b64 s[60:61], s[60:61], s[68:69]
  s_and_b64 s[62:63], s[62:63], s[70:71]
  s_and_b64 s[56:57], s[56:57], s[60:61]
  s_and_b64 s[58:59], s[58:59], s[62:63]
  s_and_b64 s[56:57], s[56:57], s[58:59]
  s_and_b32 s56, s56, s57
  s_add_u32 s42, s42, 1
  s_cmp_eq_u32 s56, 1
  s_cbranch_scc1 SP_F1c_OK
  s_cmp_lt_u32 s42, 2097152
  s_cbranch_scc1 SP_F1c
SP_F1c_OK:
  s_barrier
  s_add_u32 s75, s75, 3072
  s_add_u32 s74, s75, 0
  s_mov_b32 s42, 0
SP_FKa:
  s_load_dwordx16 s[56:71], s[72:73], s74 glc
  s_waitcnt lgkmcnt(0)
  s_and_b64 s[56:57], s[56:57], s[64:65]
  s_and_b64 s[58:59], s[58:59], s[66:67]
  s_and_b64 s[60:61], s[60:61], s[68:69]
  s_and_b64 s[62:63], s[62:63], s[70:71]
  s_and_b64 s[56:57], s[56:57], s[60:61]
  s_and_b64 s[58:59], s[58:59], s[62:63]
  s_and_b64 s[56:57], s[56:57], s[58:59]
  s_and_b32 s56, s56, s57
  s_add_u32 s42, s42, 1
  s_cmp_eq_u32 s56, 1
  s_cbranch_scc1 SP_FKa_OK
  s_cmp_lt_u32 s42, 2097152
  s_cbranch_scc1 SP_FKa
SP_FKa_OK:
  s_add_u32 s74, s75, 64
  s_mov_b32 s42, 0
SP_FKb:
  s_load_dwordx16 s[56:71], s[72:73], s74 glc
  s_waitcnt lgkmcnt(0)
  s_and_b64 s[56:57], s[56:57], s[64:65]
  s_and_b64 s[58:59], s[58:59], s[66:67]
  s_and_b64 s[60:61], s[60:61], s[68:69]
  s_and_b64 s[62:63], s[62:63], s[70:71]
  s_and_b64 s[56:57], s[56:57], s[60:61]
  s_and_b64 s[58:59], s[58:59], s[62:63]
  s_and_b64 s[56:57], s[56:57], s[58:59]
  s_and_b32 s56, s56, s57
  s_add_u32 s42, s42, 1
  s_cmp_eq_u32 s56, 1
  s_cbranch_scc1 SP_FKb_OK
  s_cmp_lt_u32 s42, 2097152
  s_cbranch_scc1 SP_FKb
SP_FKb_OK:
  s_barrier
  s_barrier
  s_barrier
  s_barrier
  s_barrier
  s_barrier
  s_barrier
  s_barrier
  s_barrier
  s_barrier
  s_barrier
  s_barrier
  s_barrier
  s_load_dwordx2 s[56:57], s[0:1], 0
  s_load_dwordx2 s[58:59], s[0:1], 88
  v_lshlrev_b32 v4, 4, v1
  s_lshl_b32 s35, s32, 2
  s_add_u32 s35, s35, s55
  s_lshr_b32 s39, s34, 2
  s_mul_i32 s36, s35, 24576
  s_mul_i32 s40, s39, 12288
  s_add_u32 s36, s36, s40
  s_add_u32 s36, s36, 12582912
  s_mul_i32 s40, s39, 61440
  v_add_u32 v26, s40, v4
  s_lshl_b32 s40, s35, 4
  s_mul_i32 s40, s40, 1280
  s_mul_i32 s41, s33, 160
  s_add_u32 s40, s40, s41
  v_add_u32 v12, 0, v1
  v_mul_u32_u24 v13, 6554, v12
  v_lshrrev_b32 v13, 16, v13
  v_mul_u32_u24 v14, 10, v13
  v_sub_u32 v14, v12, v14
  v_lshlrev_b32 v14, 4, v14
  v_mul_u32_u24 v13, 1280, v13
  v_add_u32 v13, v13, v14
  v_add_u32 v5, s40, v13
  v_lshrrev_b32 v13, 1, v12
  v_lshlrev_b32 v13, 12, v13
  v_and_b32 v14, 1, v12
  v_lshlrev_b32 v14, 4, v14
  v_add_u32 v8, v13, v14
  v_add_u32 v12, 64, v1
  v_mul_u32_u24 v13, 6554, v12
  v_lshrrev_b32 v13, 16, v13
  v_mul_u32_u24 v14, 10, v13
  v_sub_u32 v14, v12, v14
  v_lshlrev_b32 v14, 4, v14
  v_mul_u32_u24 v13, 1280, v13
  v_add_u32 v13, v13, v14
  v_add_u32 v6, s40, v13
  v_lshrrev_b32 v13, 1, v12
  v_lshlrev_b32 v13, 12, v13
  v_and_b32 v14, 1, v12
  v_lshlrev_b32 v14, 4, v14
  v_add_u32 v9, v13, v14
  v_add_u32 v12, 128, v1
  v_mul_u32_u24 v13, 6554, v12
  v_lshrrev_b32 v13, 16, v13
  v_mul_u32_u24 v14, 10, v13
  v_sub_u32 v14, v12, v14
  v_lshlrev_b32 v14, 4, v14
  v_mul_u32_u24 v13, 1280, v13
  v_add_u32 v13, v13, v14
  v_add_u32 v7, s40, v13
  v_lshrrev_b32 v13, 1, v12
  v_lshlrev_b32 v13, 12, v13
  v_and_b32 v14, 1, v12
  v_lshlrev_b32 v14, 4, v14
  v_add_u32 v10, v13, v14
  s_mul_i32 s37, s55, 2560
  s_mul_i32 s38, s33, 327680
  s_lshl_b32 s41, s35, 5
  s_add_u32 s38, s38, s41
  s_add_u32 s38, s38, 9437184
  s_lshl_b32 s40, s55, 6
  s_add_u32 s40, s40, 143360
  v_lshlrev_b32 v21, 2, v3
  v_add_u32 v21, s40, v21
  ds_read_b32 v24, v21
  ds_read_b32 v25, v21 offset:256
  v_mov_b32 v68, 0
  v_mov_b32 v69, 0
  v_mov_b32 v70, 0
  v_mov_b32 v71, 0
  v_mov_b32 v72, 0
  v_mov_b32 v73, 0
  v_mov_b32 v74, 0
  v_mov_b32 v75, 0
  v_mov_b32 v76, 0
  v_mov_b32 v77, 0
  v_mov_b32 v78, 0
  v_mov_b32 v79, 0
  v_mov_b32 v80, 0
  v_mov_b32 v81, 0
  v_mov_b32 v82, 0
  v_mov_b32 v83, 0
  v_mov_b32 v84, 0
  v_mov_b32 v85, 0
  v_mov_b32 v86, 0
  v_mov_b32 v87, 0
  s_waitcnt lgkmcnt(0)
  s_mov_b32 s8, s56
  s_and_b32 s9, s57, 0xffff
  s_mov_b32 s10, 2621440
  s_mov_b32 s11, 0x20000
  s_mov_b32 s12, s58
  s_and_b32 s13, s59, 0xffff
  s_mov_b32 s14, 2621440
  s_mov_b32 s15, 0x20000
  s_barrier
  s_barrier
  s_mov_b32 exec_lo, 0x6
  s_mov_b32 exec_hi, 0x0
  buffer_store_dword v154, v152, s[16:19], 0 offen sc1
  s_mov_b64 exec, s[52:53]
  s_lshl_b32 s40, s32, 5
  s_add_u32 s75, s40, 17041408
  s_add_u32 s74, s75, 0
  s_mov_b32 s42, 0
SP_F2B:
  s_load_dwordx8 s[56:63], s[72:73], s74 glc
  s_waitcnt lgkmcnt(0)
  s_and_b64 s[56:57], s[56:57], s[60:61]
  s_and_b64 s[58:59], s[58:59], s[62:63]
  s_and_b64 s[56:57], s[56:57], s[58:59]
  s_and_b32 s56, s56, s57
  s_add_u32 s42, s42, 1
  s_cmp_eq_u32 s56, 1
  s_cbranch_scc1 SP_F2B_OK
  s_cmp_lt_u32 s42, 2097152
  s_cbranch_scc1 SP_F2B
SP_F2B_OK:
  s_barrier
  s_branch F3_BMAIN
K1_END:
  s_endpgm
KF_CODE_END:

.section .rodata,"a"
.p2align 6
.amdhsa_kernel recurrent_scan__ssm_conv_h3__mixer_gmlp__prompt_kernel
  .amdhsa_next_free_vgpr 168
  .amdhsa_next_free_sgpr 96
  .amdhsa_accum_offset 168
  .amdhsa_group_segment_fixed_size 0
  .amdhsa_kernarg_size 112
  .amdhsa_user_sgpr_count 2
  .amdhsa_user_sgpr_kernarg_segment_ptr 1
  .amdhsa_system_sgpr_workgroup_id_x 1
  .amdhsa_float_denorm_mode_32 3
.end_amdhsa_kernel
.text
```
